```python
import torch

def _softmax(x, axis=-1):
    return torch.softmax(x, dim=axis)
def _gelu(x):
    return torch.nn.functional.gelu(x, approximate="tanh")
def _silu(x):
    return torch.nn.functional.silu(x)
def _sigmoid(x):
    return torch.sigmoid(x)
def _layernorm(x, axis=-1, eps=1e-5):
    m = x.mean(dim=axis, keepdim=True)
    v = x.var(dim=axis, keepdim=True, unbiased=False)
    return (x - m) / torch.sqrt(v + eps)
def _scatter_add(tgt, idx, src, axis=0):
    return tgt.clone().index_add_(axis, idx, src)
def _segment_sum(src, seg, n):
    out = torch.zeros((n,) + src.shape[1:], dtype=src.dtype)
    return out.index_add_(0, seg, src)
def _pad(x, pw):
    flat = tuple(v for pair in reversed(pw) for v in pair)
    return torch.nn.functional.pad(x, flat)

kernel_name = 'interleave_layers__linear_kernel_hedgehog__geglu_ffn__prompt'

def setup_inputs():

    _w = (lambda a: (lambda t: t.to(torch.bfloat16) if t.is_floating_point() else t)(torch.as_tensor(a)))
    def _A_setup():
        B, S, D, H = 1, 2048, 1024, 32
        Dh = D // H
        return {
            "x": _w((lambda *s: torch.randn(*s, dtype=torch.bfloat16) * 0.05)(B, S, D)),
            "wqkv": _w((lambda *s: torch.randn(*s, dtype=torch.bfloat16) * 0.2)(D, 3 * D)),
            "w_phi": _w((lambda *s: torch.randn(*s, dtype=torch.bfloat16) * 0.2)(H, Dh, Dh) * (Dh ** -0.5)),
            "wo": _w((lambda *s: torch.randn(*s, dtype=torch.bfloat16) * 0.05)(D, D)),
        }
    _A_in = _A_setup()

    def _B_setup():
        B, S, D, F = 1, 2048, 1024, 3584
        return {
            "x": _w((lambda *s: torch.randn(*s, dtype=torch.bfloat16) * 0.05)(B, S, D)),
            "w_gate": _w((lambda *s: torch.randn(*s, dtype=torch.bfloat16) * 0.05)(D, F)),
            "w_up": _w((lambda *s: torch.randn(*s, dtype=torch.bfloat16) * 0.05)(D, F)),
            "w_down": _w((lambda *s: torch.randn(*s, dtype=torch.bfloat16) * 0.05)(F, D)),
        }
    _B_in = _B_setup()

    return {
        "A_x": _A_in["x"],
        "A_wqkv": _A_in["wqkv"],
        "A_w_phi": _A_in["w_phi"],
        "A_wo": _A_in["wo"],
        "B_x": _B_in["x"],
        "B_w_gate": _B_in["w_gate"],
        "B_w_up": _B_in["w_up"],
        "B_w_down": _B_in["w_down"],
    }

def reference(A_x, A_wqkv, A_w_phi, A_wo, B_x, B_w_gate, B_w_up, B_w_down):
    def _A_ref(x, wqkv, w_phi, wo):
        B, S, D = x.shape
        H = 32; Dh = D // H
        qkv = (lambda x, *d: x.permute(*d))((x @ wqkv).reshape(B, S, 3, H, Dh), 2, 0, 3, 1, 4)
        q, k, v = qkv[0], qkv[1], qkv[2]
        pq = torch.einsum("bhsd,hdf->bhsf", q, w_phi)
        pk = torch.einsum("bhsd,hdf->bhsf", k, w_phi)
        phi_q = torch.concatenate([_softmax(pq, axis=-1), _softmax(-pq, axis=-1)], axis=-1)
        phi_k = torch.concatenate([_softmax(pk, axis=-1), _softmax(-pk, axis=-1)], axis=-1)
        kv = torch.einsum("bhsf,bhsd->bhfd", phi_k, v)
        z  = torch.einsum("bhsf->bhf", phi_k)
        num = torch.einsum("bhqf,bhfd->bhqd", phi_q, kv)
        den = torch.einsum("bhqf,bhf->bhq", phi_q, z)[..., None] + 1e-6
        o = num / den
        return (lambda x, *d: x.permute(*d))(o, 0, 2, 1, 3).reshape(B, S, D) @ wo

    def _B_ref(x, w_gate, w_up, w_down):
        return (_gelu(x @ w_gate) * (x @ w_up)) @ w_down

    x = A_x
    x = x + _A_ref(_layernorm(x, axis=-1), A_wqkv, A_w_phi, A_wo)
    x = x + _B_ref(_layernorm(x, axis=-1), B_w_gate, B_w_up, B_w_down)
    x = x + _A_ref(_layernorm(x, axis=-1), A_wqkv, A_w_phi, A_wo)
    x = x + _B_ref(_layernorm(x, axis=-1), B_w_gate, B_w_up, B_w_down)
    return x
```

```asm
; @launch grid=(256,1,1) block=(256,1,1) lds=163840
.amdgcn_target "amdgcn-amd-amdhsa--gfx950"
.text
.globl interleave_layers__linear_kernel_hedgehog__geglu_ffn__prompt_kernel
.p2align 8
.type interleave_layers__linear_kernel_hedgehog__geglu_ffn__prompt_kernel,@function
interleave_layers__linear_kernel_hedgehog__geglu_ffn__prompt_kernel:
s_cmp_lt_u32 s2,256
s_cbranch_scc1 Lgo
s_endpgm
Lgo:
s_load_dwordx16 s[64:79],s[0:1],0
s_load_dwordx4 s[80:83],s[0:1],64
s_load_dwordx2 s[16:17],s[0:1],80
v_lshrrev_b32 v1,6,v0
v_and_b32 v2,63,v0
v_readfirstlane_b32 s20,v1
v_and_b32 v30,15,v2
v_lshrrev_b32 v31,4,v2
s_and_b32 s21,s2,7
s_lshr_b32 s22,s2,3
s_lshr_b32 s23,s21,1
s_and_b32 s88,s21,1
s_lshl_b32 s18,s23,2
s_and_b32 s19,s22,3
s_add_u32 s84,s18,s19
s_lshl_b32 s18,s88,3
s_lshr_b32 s19,s22,2
s_add_u32 s85,s18,s19
s_lshl_b32 s18,s88,2
s_and_b32 s19,s22,3
s_add_u32 s86,s18,s19
s_lshl_b32 s18,s23,3
s_lshr_b32 s19,s22,2
s_add_u32 s87,s18,s19
s_mov_b32 s11,0x00020000
s_mov_b32 s15,0x00020000
s_mov_b32 s26,268435456
s_mov_b32 s27,0x00020000
s_mov_b32 s59,0x00020000
s_mov_b32 s46,0x3a800000
s_mov_b32 s47,0x3727c5ac
s_lshl_b32 s89,s2,2
s_add_u32 s89,s89,s20
s_lshl_b32 s89,s89,10
s_add_u32 s89,s89,98566144
s_waitcnt lgkmcnt(0)
s_add_u32 s16,s16,0
s_addc_u32 s17,s17,0
s_mov_b32 s24,s16
s_mov_b32 s25,s17
s_mov_b32 s12,s66
s_mov_b32 s13,s67
s_mov_b32 s14,6291456
s_lshl_b32 s18,s20,4
s_lshl_b32 s19,s85,7
v_lshrrev_b32 v3,3,v2
v_add_u32 v3,s18,v3
v_mul_u32_u24 v3,6144,v3
v_add_u32 v3,s19,v3
v_and_b32 v1,1,v31
v_lshlrev_b32 v1,1,v1
v_and_b32 v0,7,v2
v_xor_b32 v1,v1,v0
v_lshl_add_u32 v8,v1,4,v3
v_xor_b32 v1,4,v1
v_lshl_add_u32 v9,v1,4,v3
v_add_u32 v9,48128,v9
s_andn2_b32 s95,s84,1
s_mul_i32 s32,s95,393216
s_add_u32 s32,s32,2048
s_add_u32 s33,s32,2048
s_mov_b32 s35,0
s_lshl_b32 s41,s20,11
s_add_u32 s41,s41,16384
s_add_u32 s43,s41,8192
s_add_u32 m0,s35,s41
s_nop 0
buffer_load_dwordx4 v8,s[12:15],s32 offen lds
buffer_load_dwordx4 v9,s[12:15],s32 offen offset:1024 lds
s_add_u32 m0,s35,s43
s_nop 0
buffer_load_dwordx4 v8,s[12:15],s33 offen lds
buffer_load_dwordx4 v9,s[12:15],s33 offen offset:1024 lds
s_add_u32 s35,s35,32768
s_cmp_eq_u32 s35,163840
s_cselect_b32 s35,0,s35
s_add_u32 s32,s32,393216
s_cmp_eq_u32 s32,6293504
s_cselect_b32 s32,2048,s32
s_add_u32 s33,s32,2048
s_add_u32 m0,s35,s41
s_nop 0
buffer_load_dwordx4 v8,s[12:15],s32 offen lds
buffer_load_dwordx4 v9,s[12:15],s32 offen offset:1024 lds
s_add_u32 m0,s35,s43
s_nop 0
buffer_load_dwordx4 v8,s[12:15],s33 offen lds
buffer_load_dwordx4 v9,s[12:15],s33 offen offset:1024 lds
s_add_u32 s35,s35,32768
s_cmp_eq_u32 s35,163840
s_cselect_b32 s35,0,s35
s_add_u32 s32,s32,393216
s_cmp_eq_u32 s32,6293504
s_cselect_b32 s32,2048,s32
s_add_u32 s33,s32,2048
s_mov_b32 s8,s64
s_mov_b32 s9,s65
s_mov_b32 s10,4194304
s_lshl_b32 s23,s84,7
s_lshr_b32 s28,s20,1
s_and_b32 s29,s20,1
s_lshl_b32 s18,s20,5
s_add_u32 s18,s18,s23
v_lshrrev_b32 v3,3,v2
v_add_u32 v3,s18,v3
v_mul_u32_u24 v3,2048,v3
v_and_b32 v1,7,v2
v_xor_b32 v1,v1,v31
v_lshl_add_u32 v4,v1,4,v3
v_xor_b32 v1,4,v1
v_lshl_add_u32 v5,v1,4,v3
v_add_u32 v5,15360,v5
v_add_u32 v6,30720,v4
v_add_u32 v7,30720,v5
s_mul_i32 s30,s95,128
s_and_b32 s31,s84,1
s_mov_b32 s34,0
s_lshl_b32 s40,s20,12
s_add_u32 m0,s34,s40
s_nop 0
buffer_load_dwordx4 v4,s[8:11],s30 offen lds
buffer_load_dwordx4 v5,s[8:11],s30 offen offset:1024 lds
buffer_load_dwordx4 v6,s[8:11],s30 offen offset:2048 lds
buffer_load_dwordx4 v7,s[8:11],s30 offen offset:3072 lds
s_add_u32 s34,s34,32768
s_cmp_eq_u32 s34,163840
s_cselect_b32 s34,0,s34
s_add_u32 s30,s30,128
s_and_b32 s30,s30,0x7ff
s_add_u32 m0,s34,s40
s_nop 0
buffer_load_dwordx4 v4,s[8:11],s30 offen lds
buffer_load_dwordx4 v5,s[8:11],s30 offen offset:1024 lds
buffer_load_dwordx4 v6,s[8:11],s30 offen offset:2048 lds
buffer_load_dwordx4 v7,s[8:11],s30 offen offset:3072 lds
s_add_u32 s34,s34,32768
s_cmp_eq_u32 s34,163840
s_cselect_b32 s34,0,s34
s_add_u32 s30,s30,128
s_and_b32 s30,s30,0x7ff
s_mov_b32 s8,s64
s_mov_b32 s9,s65
s_mov_b32 s10,4194304
s_lshl_b32 s18,s84,7
s_lshl_b32 s19,s85,3
s_add_u32 s18,s18,s19
s_lshl_b32 s19,s20,1
s_add_u32 s48,s18,s19
s_lshl_b32 s18,s48,11
v_lshlrev_b32 v1,5,v2
buffer_load_dwordx4 v[208:211],v1,s[8:11],s18 offen offset:0
buffer_load_dwordx4 v[212:215],v1,s[8:11],s18 offen offset:16
buffer_load_dwordx4 v[216:219],v1,s[8:11],s18 offen offset:2048
buffer_load_dwordx4 v[220:223],v1,s[8:11],s18 offen offset:2064
s_getpc_b64 s[90:91]
Lpc1:
s_sub_u32 s90,s90,Lpc1-Lgo
s_subb_u32 s91,s91,0
s_lshr_b32 s18,s2,3
s_lshl_b32 s18,s18,2
s_add_u32 s18,s18,s20
s_mul_i32 s18,s18,1024
s_add_u32 s18,s18,0
v_min_u32 v1,7,v2
v_lshlrev_b32 v1,7,v1
v_add_u32 v1,s18,v1
s_mov_b32 s18,Lend-Lgo
v_min_u32 v1,s18,v1
global_load_dword a64,v1,s[90:91]
s_or_b32 s18,s2,s20
s_cmp_lg_u32 s18,0
s_cbranch_scc1 Ltw2
s_memrealtime s[90:91]
s_waitcnt lgkmcnt(0)
s_or_b32 s18,s90,1
v_mov_b32 v1,0
v_mov_b32 v3,s18
s_mov_b64 exec,1
global_store_dword v1,v3,s[82:83] sc1
s_mov_b64 exec,-1
Ltw2:
s_lshl_b32 s18,s28,13
v_lshrrev_b32 v1,1,v30
v_lshlrev_b32 v3,7,v30
v_add_u32 v3,s18,v3
v_xor_b32 v12,v31,v1
v_xor_b32 v13,4,v12
v_lshl_add_u32 v12,v12,4,v3
v_lshl_add_u32 v13,v13,4,v3
s_mov_b32 s18,16384
s_lshl_b32 s19,s29,2
v_bfe_u32 v1,v2,2,2
v_lshl_add_u32 v3,v31,3,v1
v_lshlrev_b32 v3,7,v3
v_add_u32 v3,s18,v3
v_and_b32 v0,1,v2
v_lshl_add_u32 v3,v0,3,v3
v_and_b32 v1,2,v1
v_and_b32 v0,1,v31
v_lshl_add_u32 v1,v0,2,v1
v_bfe_u32 v0,v2,1,1
v_or_b32 v1,v1,v0
v_xor_b32 v1,s19,v1
v_xor_b32 v0,0,v1
v_lshl_add_u32 v14,v0,4,v3
v_xor_b32 v0,2,v1
v_lshl_add_u32 v15,v0,4,v3
s_lshl_b32 s18,s85,1
s_add_u32 s54,s18,s29
s_lshl_b32 s18,s84,3
s_lshl_b32 s19,s28,2
s_add_u32 s18,s18,s19
s_lshl_b32 s18,s18,11
s_add_u32 s60,s18,34668544
v_lshlrev_b32 v23,11,v31
v_lshl_add_u32 v23,v30,4,v23
s_lshl_b32 s18,s54,5
v_add_u32 v1,s18,v30
v_lshlrev_b32 v24,4,v1
v_mov_b32 v16,v24
v_mul_u32_u24 v1,163840,v31
v_add_u32 v24,v24,v1
s_mov_b32 s62,94371840
s_mov_b32 s63,94388224
s_mov_b32 s55,94404608
v_lshlrev_b32 v25,8,v31
v_lshl_add_u32 v25,v30,1,v25
s_lshl_b32 s45,s54,11
s_lshl_b32 s18,s28,6
v_add_u32 v1,s18,v30
v_mul_u32_u24 v1,352,v1
v_lshrrev_b32 v3,2,v30
v_xor_b32 v3,v3,v31
v_lshl_add_u32 v1,v3,3,v1
s_mul_i32 s18,s29,45056
v_add_u32 v18,s18,v1
v_bfe_u32 v1,v2,2,2
v_lshl_add_u32 v1,v31,2,v1
v_mul_u32_u24 v1,352,v1
v_and_b32 v3,3,v2
v_xor_b32 v3,v3,v31
v_lshl_add_u32 v1,v3,3,v1
v_add_u32 v19,s18,v1
s_lshl_b32 s18,s84,5
s_add_u32 s18,s18,s54
s_mul_i32 s18,s18,8448
s_add_u32 s18,s18,28377088
s_lshl_b32 s19,s28,7
s_add_u32 s19,s19,s18
s_add_u32 s19,s19,8192
v_lshlrev_b32 v1,4,v31
v_add_u32 v22,s19,v1
s_lshl_b32 s19,s28,12
s_add_u32 s18,s18,s19
v_lshlrev_b32 v1,4,v2
v_add_u32 v20,s18,v1
s_lshl_b32 s18,s28,6
s_add_u32 s18,s18,s23
s_lshl_b32 s18,s18,11
s_lshl_b32 s19,s54,10
s_add_u32 s18,s18,s19
s_add_u32 s18,s18,65536
v_lshlrev_b32 v21,4,v30
v_and_b32 v1,1,v31
v_lshl_add_u32 v21,v1,9,v21
v_lshrrev_b32 v1,1,v31
v_lshl_add_u32 v21,v1,8,v21
v_add_u32 v21,s18,v21
s_mov_b32 s36,0
s_mov_b32 s42,0
s_mov_b32 s50,32768
s_mov_b32 s51,0xfffe0000
s_mov_b32 s56,s68
s_mov_b32 s57,s69
s_mov_b32 s58,65536
s_lshr_b32 s18,s84,3
s_lshl_b32 s19,s85,1
s_add_u32 s18,s18,s19
s_mul_i32 s44,s18,6144
s_bfe_u32 s18,s84,0x10002
s_mul_i32 s18,s18,3072
s_add_u32 s44,s44,s18
s_and_b32 s18,s84,1
s_lshl_b32 s18,s18,10
s_add_u32 s44,s44,s18
s_and_b32 s18,s84,2
s_lshl_b32 s18,s18,2
s_add_u32 s44,s44,s18
s_lshr_b32 s18,s84,2
s_add_u32 s18,s18,s19
s_mul_i32 s39,s18,6144
s_bfe_u32 s18,s84,0x10001
s_mul_i32 s18,s18,3072
s_add_u32 s39,s39,s18
s_and_b32 s18,s84,1
s_lshl_b32 s18,s18,3
s_add_u32 s39,s39,s18
s_add_u32 s39,s39,2048
s_lshr_b32 s18,s84,3
s_lshl_b32 s18,s18,2
s_add_u32 s18,s18,s20
s_add_u32 s92,s44,33619968
s_add_u32 s93,s39,33619968
s_cmp_eq_u32 s18,1
s_cselect_b32 s44,s93,s92
v_mov_b32 v1,0x3f803f80
v_accvgpr_write_b32 a48,v1
v_accvgpr_write_b32 a49,v1
v_accvgpr_write_b32 a50,v1
v_accvgpr_write_b32 a51,v1
s_lshr_b32 s18,s84,2
s_mul_i32 s18,s18,163840
s_and_b32 s19,s84,3
s_lshl_b32 s19,s19,2
s_add_u32 s18,s18,s19
v_add_u32 v16,s18,v16
s_lshr_b32 s18,s48,4
s_lshl_b32 s18,s18,11
s_and_b32 s19,s48,15
s_lshl_b32 s19,s19,4
s_add_u32 s18,s18,s19
s_add_u32 s48,s18,34668544
v_lshrrev_b32 v17,3,v2
v_lshlrev_b32 v17,8,v17
v_bfe_u32 v1,v2,2,1
v_lshl_add_u32 v17,v1,3,v17
s_lshl_b32 s49,s84,8
s_add_u32 s49,s49,95535104
s_lshl_b32 s52,s85,8
s_add_u32 s52,s52,95551488
v_lshlrev_b32 v28,2,v30
s_cmp_lt_u32 s20,2
s_cselect_b32 s4,s74,s76
s_cselect_b32 s5,s75,s77
s_mov_b32 s6,7340032
s_mov_b32 s7,0x00020000
s_lshl_b32 s18,s2,1
s_and_b32 s19,s20,1
s_add_u32 s18,s18,s19
s_mul_i32 s37,s18,14336
v_lshlrev_b32 v11,7,v31
s_mov_b32 s18,0x3f803f80
s_waitcnt vmcnt(9)
s_barrier
ds_read_b128 v[128:131],v12 offset:0
ds_read_b64_tr_b16 v[144:145],v14 offset:0
ds_read_b64_tr_b16 v[146:147],v14 offset:512
ds_read_b128 v[132:135],v12 offset:2048
ds_read_b128 v[136:139],v12 offset:4096
ds_read_b128 v[140:143],v12 offset:6144
ds_read_b64_tr_b16 v[148:149],v15 offset:0
ds_read_b64_tr_b16 v[150:151],v15 offset:512
ds_read_b64_tr_b16 v[152:153],v14 offset:8192
ds_read_b64_tr_b16 v[154:155],v14 offset:8704
ds_read_b64_tr_b16 v[156:157],v15 offset:8192
ds_read_b64_tr_b16 v[158:159],v15 offset:8704
s_waitcnt lgkmcnt(4)
v_mfma_f32_16x16x32_bf16 v[64:67],v[144:147],v[128:131],0
v_add_u32 v13,s42,v13
ds_read_b128 v[160:163],v13 offset:0
v_mfma_f32_16x16x32_bf16 v[68:71],v[144:147],v[132:135],0
ds_read_b64_tr_b16 v[176:177],v14 offset:4096
s_add_u32 m0,s34,s40
v_mfma_f32_16x16x32_bf16 v[72:75],v[144:147],v[136:139],0
ds_read_b64_tr_b16 v[178:179],v14 offset:4608
buffer_load_dwordx4 v4,s[8:11],s30 offen lds
v_mfma_f32_16x16x32_bf16 v[76:79],v[144:147],v[140:143],0
ds_read_b128 v[164:167],v13 offset:2048
v_mfma_f32_16x16x32_bf16 v[80:83],v[148:151],v[128:131],0
ds_read_b128 v[168:171],v13 offset:4096
buffer_load_dwordx4 v5,s[8:11],s30 offen offset:1024 lds
v_mfma_f32_16x16x32_bf16 v[84:87],v[148:151],v[132:135],0
v_mfma_f32_16x16x32_bf16 v[88:91],v[148:151],v[136:139],0
ds_read_b128 v[172:175],v13 offset:6144
buffer_load_dwordx4 v6,s[8:11],s30 offen offset:2048 lds
v_mfma_f32_16x16x32_bf16 v[92:95],v[148:151],v[140:143],0
ds_read_b64_tr_b16 v[180:181],v15 offset:4096
s_waitcnt lgkmcnt(7)
v_mfma_f32_16x16x32_bf16 v[96:99],v[152:155],v[128:131],0
ds_read_b64_tr_b16 v[182:183],v15 offset:4608
buffer_load_dwordx4 v7,s[8:11],s30 offen offset:3072 lds
v_mfma_f32_16x16x32_bf16 v[100:103],v[152:155],v[132:135],0
ds_read_b64_tr_b16 v[184:185],v14 offset:12288
ds_read_b64_tr_b16 v[186:187],v14 offset:12800
v_mfma_f32_16x16x32_bf16 v[104:107],v[152:155],v[136:139],0
ds_read_b64_tr_b16 v[188:189],v15 offset:12288
s_add_u32 s34,s34,32768
v_mfma_f32_16x16x32_bf16 v[108:111],v[152:155],v[140:143],0
ds_read_b64_tr_b16 v[190:191],v15 offset:12800
v_mfma_f32_16x16x32_bf16 v[112:115],v[156:159],v[128:131],0
s_cmp_eq_u32 s34,163840
s_cselect_b32 s34,0,s34
v_mfma_f32_16x16x32_bf16 v[116:119],v[156:159],v[132:135],0
s_add_u32 s30,s30,128
s_and_b32 s30,s30,0x7ff
v_mfma_f32_16x16x32_bf16 v[120:123],v[156:159],v[136:139],0
s_add_u32 m0,s35,s41
s_nop 0
buffer_load_dwordx4 v8,s[12:15],s32 offen lds
v_mfma_f32_16x16x32_bf16 v[124:127],v[156:159],v[140:143],0
buffer_load_dwordx4 v9,s[12:15],s32 offen offset:1024 lds
s_cmp_lg_u32 s31,0
s_cbranch_scc1 Lcqe4
s_cmp_lg_u32 s28,0
s_cbranch_scc1 Lcq3
v_mfma_f32_16x16x32_bf16 a[52:55],a[48:51],v[144:147],0
v_mfma_f32_16x16x32_bf16 a[56:59],a[48:51],v[148:151],0
s_branch Lcqe4
Lcq3:
s_nop 5
v_mfma_f32_16x16x32_bf16 a[52:55],a[48:51],v[152:155],0
v_mfma_f32_16x16x32_bf16 a[56:59],a[48:51],v[156:159],0
Lcqe4:
s_waitcnt lgkmcnt(4)
v_mfma_f32_16x16x32_bf16 v[64:67],v[176:179],v[160:163],v[64:67]
s_add_u32 s36,s36,32768
v_mfma_f32_16x16x32_bf16 v[68:71],v[176:179],v[164:167],v[68:71]
v_mfma_f32_16x16x32_bf16 v[72:75],v[176:179],v[168:171],v[72:75]
s_cmp_eq_u32 s36,163840
s_cselect_b32 s42,s51,s50
s_cselect_b32 s36,0,s36
v_add_u32 v12,s42,v12
v_add_u32 v14,s42,v14
v_add_u32 v15,s42,v15
s_waitcnt vmcnt(11)
s_waitcnt lgkmcnt(0)
s_barrier
ds_read_b128 v[128:131],v12 offset:0
v_mfma_f32_16x16x32_bf16 v[76:79],v[176:179],v[172:175],v[76:79]
ds_read_b64_tr_b16 v[144:145],v14 offset:0
ds_read_b64_tr_b16 v[146:147],v14 offset:512
v_mfma_f32_16x16x32_bf16 v[80:83],v[180:183],v[160:163],v[80:83]
ds_read_b128 v[132:135],v12 offset:2048
s_add_u32 m0,s35,s43
v_mfma_f32_16x16x32_bf16 v[84:87],v[180:183],v[164:167],v[84:87]
ds_read_b128 v[136:139],v12 offset:4096
buffer_load_dwordx4 v8,s[12:15],s33 offen lds
v_mfma_f32_16x16x32_bf16 v[88:91],v[180:183],v[168:171],v[88:91]
buffer_load_dwordx4 v9,s[12:15],s33 offen offset:1024 lds
s_add_u32 s35,s35,32768
v_mfma_f32_16x16x32_bf16 v[92:95],v[180:183],v[172:175],v[92:95]
ds_read_b128 v[140:143],v12 offset:6144
v_mfma_f32_16x16x32_bf16 v[96:99],v[184:187],v[160:163],v[96:99]
ds_read_b64_tr_b16 v[148:149],v15 offset:0
ds_read_b64_tr_b16 v[150:151],v15 offset:512
v_mfma_f32_16x16x32_bf16 v[100:103],v[184:187],v[164:167],v[100:103]
ds_read_b64_tr_b16 v[152:153],v14 offset:8192
v_mfma_f32_16x16x32_bf16 v[104:107],v[184:187],v[168:171],v[104:107]
ds_read_b64_tr_b16 v[154:155],v14 offset:8704
ds_read_b64_tr_b16 v[156:157],v15 offset:8192
v_mfma_f32_16x16x32_bf16 v[108:111],v[184:187],v[172:175],v[108:111]
ds_read_b64_tr_b16 v[158:159],v15 offset:8704
v_mfma_f32_16x16x32_bf16 v[112:115],v[188:191],v[160:163],v[112:115]
s_cmp_eq_u32 s35,163840
s_cselect_b32 s35,0,s35
v_mfma_f32_16x16x32_bf16 v[116:119],v[188:191],v[164:167],v[116:119]
s_add_u32 s32,s32,393216
v_mfma_f32_16x16x32_bf16 v[120:123],v[188:191],v[168:171],v[120:123]
s_cmp_eq_u32 s32,6293504
s_cselect_b32 s32,2048,s32
v_mfma_f32_16x16x32_bf16 v[124:127],v[188:191],v[172:175],v[124:127]
s_add_u32 s33,s32,2048
s_add_u32 m0,s34,s40
s_nop 0
buffer_load_dwordx4 v4,s[8:11],s30 offen lds
buffer_load_dwordx4 v5,s[8:11],s30 offen offset:1024 lds
buffer_load_dwordx4 v6,s[8:11],s30 offen offset:2048 lds
buffer_load_dwordx4 v7,s[8:11],s30 offen offset:3072 lds
s_add_u32 s34,s34,32768
s_cmp_eq_u32 s34,163840
s_cselect_b32 s34,0,s34
s_add_u32 s30,s30,128
s_and_b32 s30,s30,0x7ff
s_cmp_lg_u32 s31,0
s_cbranch_scc1 Lcqe6
s_cmp_lg_u32 s28,0
s_cbranch_scc1 Lcq5
v_mfma_f32_16x16x32_bf16 a[52:55],a[48:51],v[176:179],a[52:55]
v_mfma_f32_16x16x32_bf16 a[56:59],a[48:51],v[180:183],a[56:59]
s_branch Lcqe6
Lcq5:
v_mfma_f32_16x16x32_bf16 a[52:55],a[48:51],v[184:187],a[52:55]
v_mfma_f32_16x16x32_bf16 a[56:59],a[48:51],v[188:191],a[56:59]
Lcqe6:
s_waitcnt lgkmcnt(4)
v_mfma_f32_16x16x32_bf16 v[64:67],v[144:147],v[128:131],v[64:67]
v_add_u32 v13,s42,v13
ds_read_b128 v[160:163],v13 offset:0
v_mfma_f32_16x16x32_bf16 v[68:71],v[144:147],v[132:135],v[68:71]
ds_read_b64_tr_b16 v[176:177],v14 offset:4096
s_add_u32 m0,s35,s41
v_mfma_f32_16x16x32_bf16 v[72:75],v[144:147],v[136:139],v[72:75]
ds_read_b64_tr_b16 v[178:179],v14 offset:4608
buffer_load_dwordx4 v8,s[12:15],s32 offen lds
v_mfma_f32_16x16x32_bf16 v[76:79],v[144:147],v[140:143],v[76:79]
ds_read_b128 v[164:167],v13 offset:2048
v_mfma_f32_16x16x32_bf16 v[80:83],v[148:151],v[128:131],v[80:83]
ds_read_b128 v[168:171],v13 offset:4096
buffer_load_dwordx4 v9,s[12:15],s32 offen offset:1024 lds
v_mfma_f32_16x16x32_bf16 v[84:87],v[148:151],v[132:135],v[84:87]
s_add_u32 m0,s35,s43
v_mfma_f32_16x16x32_bf16 v[88:91],v[148:151],v[136:139],v[88:91]
ds_read_b128 v[172:175],v13 offset:6144
buffer_load_dwordx4 v8,s[12:15],s33 offen lds
v_mfma_f32_16x16x32_bf16 v[92:95],v[148:151],v[140:143],v[92:95]
ds_read_b64_tr_b16 v[180:181],v15 offset:4096
s_waitcnt lgkmcnt(7)
v_mfma_f32_16x16x32_bf16 v[96:99],v[152:155],v[128:131],v[96:99]
ds_read_b64_tr_b16 v[182:183],v15 offset:4608
buffer_load_dwordx4 v9,s[12:15],s33 offen offset:1024 lds
v_mfma_f32_16x16x32_bf16 v[100:103],v[152:155],v[132:135],v[100:103]
ds_read_b64_tr_b16 v[184:185],v14 offset:12288
ds_read_b64_tr_b16 v[186:187],v14 offset:12800
v_mfma_f32_16x16x32_bf16 v[104:107],v[152:155],v[136:139],v[104:107]
ds_read_b64_tr_b16 v[188:189],v15 offset:12288
s_add_u32 s35,s35,32768
v_mfma_f32_16x16x32_bf16 v[108:111],v[152:155],v[140:143],v[108:111]
ds_read_b64_tr_b16 v[190:191],v15 offset:12800
v_mfma_f32_16x16x32_bf16 v[112:115],v[156:159],v[128:131],v[112:115]
s_cmp_eq_u32 s35,163840
s_cselect_b32 s35,0,s35
v_mfma_f32_16x16x32_bf16 v[116:119],v[156:159],v[132:135],v[116:119]
s_add_u32 s32,s32,393216
v_mfma_f32_16x16x32_bf16 v[120:123],v[156:159],v[136:139],v[120:123]
s_cmp_eq_u32 s32,6293504
s_cselect_b32 s32,2048,s32
v_mfma_f32_16x16x32_bf16 v[124:127],v[156:159],v[140:143],v[124:127]
s_add_u32 s33,s32,2048
s_add_u32 m0,s34,s40
s_nop 0
buffer_load_dwordx4 v4,s[8:11],s30 offen lds
buffer_load_dwordx4 v5,s[8:11],s30 offen offset:1024 lds
s_cmp_lg_u32 s31,1
s_cbranch_scc1 Lcqe8
s_cmp_lg_u32 s28,0
s_cbranch_scc1 Lcq7
v_mfma_f32_16x16x32_bf16 a[52:55],a[48:51],v[144:147],0
v_mfma_f32_16x16x32_bf16 a[56:59],a[48:51],v[148:151],0
s_branch Lcqe8
Lcq7:
s_nop 5
v_mfma_f32_16x16x32_bf16 a[52:55],a[48:51],v[152:155],0
v_mfma_f32_16x16x32_bf16 a[56:59],a[48:51],v[156:159],0
Lcqe8:
s_waitcnt lgkmcnt(4)
v_mfma_f32_16x16x32_bf16 v[64:67],v[176:179],v[160:163],v[64:67]
s_add_u32 s36,s36,32768
v_mfma_f32_16x16x32_bf16 v[68:71],v[176:179],v[164:167],v[68:71]
v_mfma_f32_16x16x32_bf16 v[72:75],v[176:179],v[168:171],v[72:75]
s_cmp_eq_u32 s36,163840
s_cselect_b32 s42,s51,s50
s_cselect_b32 s36,0,s36
v_add_u32 v12,s42,v12
v_add_u32 v14,s42,v14
v_add_u32 v15,s42,v15
s_waitcnt vmcnt(10)
v_mov_b32 v224,0
v_mov_b32 v225,0
v_mov_b32 v226,0
v_mov_b32 v227,0
s_mov_b32 s18,0x3f803f80
v_dot2_f32_bf16 v224,v208,s18,v224
v_dot2_f32_bf16 v225,v208,v208,v225
v_dot2_f32_bf16 v226,v216,s18,v226
v_dot2_f32_bf16 v227,v216,v216,v227
v_dot2_f32_bf16 v224,v209,s18,v224
v_dot2_f32_bf16 v225,v209,v209,v225
v_dot2_f32_bf16 v226,v217,s18,v226
v_dot2_f32_bf16 v227,v217,v217,v227
v_dot2_f32_bf16 v224,v210,s18,v224
v_dot2_f32_bf16 v225,v210,v210,v225
v_dot2_f32_bf16 v226,v218,s18,v226
v_dot2_f32_bf16 v227,v218,v218,v227
v_dot2_f32_bf16 v224,v211,s18,v224
v_dot2_f32_bf16 v225,v211,v211,v225
v_dot2_f32_bf16 v226,v219,s18,v226
v_dot2_f32_bf16 v227,v219,v219,v227
v_dot2_f32_bf16 v224,v212,s18,v224
v_dot2_f32_bf16 v225,v212,v212,v225
v_dot2_f32_bf16 v226,v220,s18,v226
v_dot2_f32_bf16 v227,v220,v220,v227
v_dot2_f32_bf16 v224,v213,s18,v224
v_dot2_f32_bf16 v225,v213,v213,v225
v_dot2_f32_bf16 v226,v221,s18,v226
v_dot2_f32_bf16 v227,v221,v221,v227
v_dot2_f32_bf16 v224,v214,s18,v224
v_dot2_f32_bf16 v225,v214,v214,v225
v_dot2_f32_bf16 v226,v222,s18,v226
v_dot2_f32_bf16 v227,v222,v222,v227
v_dot2_f32_bf16 v224,v215,s18,v224
v_dot2_f32_bf16 v225,v215,v215,v225
v_dot2_f32_bf16 v226,v223,s18,v226
v_dot2_f32_bf16 v227,v223,v223,v227
s_nop 4
v_add_f32_dpp v224,v224,v224 quad_perm:[1,0,3,2] row_mask:0xf bank_mask:0xf
v_add_f32_dpp v225,v225,v225 quad_perm:[1,0,3,2] row_mask:0xf bank_mask:0xf
v_add_f32_dpp v226,v226,v226 quad_perm:[1,0,3,2] row_mask:0xf bank_mask:0xf
v_add_f32_dpp v227,v227,v227 quad_perm:[1,0,3,2] row_mask:0xf bank_mask:0xf
v_add_f32_dpp v224,v224,v224 quad_perm:[2,3,0,1] row_mask:0xf bank_mask:0xf
v_add_f32_dpp v225,v225,v225 quad_perm:[2,3,0,1] row_mask:0xf bank_mask:0xf
v_add_f32_dpp v226,v226,v226 quad_perm:[2,3,0,1] row_mask:0xf bank_mask:0xf
v_add_f32_dpp v227,v227,v227 quad_perm:[2,3,0,1] row_mask:0xf bank_mask:0xf
s_waitcnt lgkmcnt(0)
s_barrier
ds_read_b128 v[128:131],v12 offset:0
v_mfma_f32_16x16x32_bf16 v[76:79],v[176:179],v[172:175],v[76:79]
ds_read_b64_tr_b16 v[144:145],v14 offset:0
ds_read_b64_tr_b16 v[146:147],v14 offset:512
v_mfma_f32_16x16x32_bf16 v[80:83],v[180:183],v[160:163],v[80:83]
ds_read_b128 v[132:135],v12 offset:2048
buffer_load_dwordx4 v6,s[8:11],s30 offen offset:2048 lds
v_mfma_f32_16x16x32_bf16 v[84:87],v[180:183],v[164:167],v[84:87]
ds_read_b128 v[136:139],v12 offset:4096
buffer_load_dwordx4 v7,s[8:11],s30 offen offset:3072 lds
v_mfma_f32_16x16x32_bf16 v[88:91],v[180:183],v[168:171],v[88:91]
s_add_u32 s34,s34,32768
v_mfma_f32_16x16x32_bf16 v[92:95],v[180:183],v[172:175],v[92:95]
ds_read_b128 v[140:143],v12 offset:6144
v_mfma_f32_16x16x32_bf16 v[96:99],v[184:187],v[160:163],v[96:99]
ds_read_b64_tr_b16 v[148:149],v15 offset:0
ds_read_b64_tr_b16 v[150:151],v15 offset:512
v_mfma_f32_16x16x32_bf16 v[100:103],v[184:187],v[164:167],v[100:103]
ds_read_b64_tr_b16 v[152:153],v14 offset:8192
v_mfma_f32_16x16x32_bf16 v[104:107],v[184:187],v[168:171],v[104:107]
ds_read_b64_tr_b16 v[154:155],v14 offset:8704
ds_read_b64_tr_b16 v[156:157],v15 offset:8192
v_mfma_f32_16x16x32_bf16 v[108:111],v[184:187],v[172:175],v[108:111]
ds_read_b64_tr_b16 v[158:159],v15 offset:8704
v_mfma_f32_16x16x32_bf16 v[112:115],v[188:191],v[160:163],v[112:115]
s_cmp_eq_u32 s34,163840
s_cselect_b32 s34,0,s34
v_mfma_f32_16x16x32_bf16 v[116:119],v[188:191],v[164:167],v[116:119]
s_add_u32 s30,s30,128
s_and_b32 s30,s30,0x7ff
v_mfma_f32_16x16x32_bf16 v[120:123],v[188:191],v[168:171],v[120:123]
s_add_u32 m0,s35,s41
s_nop 0
buffer_load_dwordx4 v8,s[12:15],s32 offen lds
v_mfma_f32_16x16x32_bf16 v[124:127],v[188:191],v[172:175],v[124:127]
buffer_load_dwordx4 v9,s[12:15],s32 offen offset:1024 lds
s_add_u32 m0,s35,s43
s_nop 0
buffer_load_dwordx4 v8,s[12:15],s33 offen lds
buffer_load_dwordx4 v9,s[12:15],s33 offen offset:1024 lds
s_add_u32 s35,s35,32768
s_cmp_eq_u32 s35,163840
s_cselect_b32 s35,0,s35
s_add_u32 s32,s32,393216
s_cmp_eq_u32 s32,6293504
s_cselect_b32 s32,2048,s32
s_add_u32 s33,s32,2048
s_cmp_lg_u32 s31,1
s_cbranch_scc1 Lcqe10
s_cmp_lg_u32 s28,0
s_cbranch_scc1 Lcq9
v_mfma_f32_16x16x32_bf16 a[52:55],a[48:51],v[176:179],a[52:55]
v_mfma_f32_16x16x32_bf16 a[56:59],a[48:51],v[180:183],a[56:59]
s_branch Lcqe10
Lcq9:
v_mfma_f32_16x16x32_bf16 a[52:55],a[48:51],v[184:187],a[52:55]
v_mfma_f32_16x16x32_bf16 a[56:59],a[48:51],v[188:191],a[56:59]
Lcqe10:
s_waitcnt lgkmcnt(4)
v_mfma_f32_16x16x32_bf16 v[64:67],v[144:147],v[128:131],v[64:67]
v_add_u32 v13,s42,v13
ds_read_b128 v[160:163],v13 offset:0
v_mfma_f32_16x16x32_bf16 v[68:71],v[144:147],v[132:135],v[68:71]
ds_read_b64_tr_b16 v[176:177],v14 offset:4096
s_add_u32 m0,s34,s40
v_mfma_f32_16x16x32_bf16 v[72:75],v[144:147],v[136:139],v[72:75]
ds_read_b64_tr_b16 v[178:179],v14 offset:4608
buffer_load_dwordx4 v4,s[8:11],s30 offen lds
v_mfma_f32_16x16x32_bf16 v[76:79],v[144:147],v[140:143],v[76:79]
ds_read_b128 v[164:167],v13 offset:2048
v_mfma_f32_16x16x32_bf16 v[80:83],v[148:151],v[128:131],v[80:83]
ds_read_b128 v[168:171],v13 offset:4096
buffer_load_dwordx4 v5,s[8:11],s30 offen offset:1024 lds
v_mfma_f32_16x16x32_bf16 v[84:87],v[148:151],v[132:135],v[84:87]
v_mfma_f32_16x16x32_bf16 v[88:91],v[148:151],v[136:139],v[88:91]
ds_read_b128 v[172:175],v13 offset:6144
buffer_load_dwordx4 v6,s[8:11],s30 offen offset:2048 lds
v_mfma_f32_16x16x32_bf16 v[92:95],v[148:151],v[140:143],v[92:95]
ds_read_b64_tr_b16 v[180:181],v15 offset:4096
s_waitcnt lgkmcnt(7)
v_mfma_f32_16x16x32_bf16 v[96:99],v[152:155],v[128:131],v[96:99]
ds_read_b64_tr_b16 v[182:183],v15 offset:4608
buffer_load_dwordx4 v7,s[8:11],s30 offen offset:3072 lds
v_mfma_f32_16x16x32_bf16 v[100:103],v[152:155],v[132:135],v[100:103]
ds_read_b64_tr_b16 v[184:185],v14 offset:12288
ds_read_b64_tr_b16 v[186:187],v14 offset:12800
v_mfma_f32_16x16x32_bf16 v[104:107],v[152:155],v[136:139],v[104:107]
ds_read_b64_tr_b16 v[188:189],v15 offset:12288
s_add_u32 s34,s34,32768
v_mfma_f32_16x16x32_bf16 v[108:111],v[152:155],v[140:143],v[108:111]
ds_read_b64_tr_b16 v[190:191],v15 offset:12800
v_mfma_f32_16x16x32_bf16 v[112:115],v[156:159],v[128:131],v[112:115]
s_cmp_eq_u32 s34,163840
s_cselect_b32 s34,0,s34
v_mfma_f32_16x16x32_bf16 v[116:119],v[156:159],v[132:135],v[116:119]
s_add_u32 s30,s30,128
s_and_b32 s30,s30,0x7ff
v_mfma_f32_16x16x32_bf16 v[120:123],v[156:159],v[136:139],v[120:123]
s_add_u32 m0,s35,s41
s_nop 0
buffer_load_dwordx4 v8,s[12:15],s32 offen lds
v_mfma_f32_16x16x32_bf16 v[124:127],v[156:159],v[140:143],v[124:127]
buffer_load_dwordx4 v9,s[12:15],s32 offen offset:1024 lds
s_waitcnt lgkmcnt(4)
v_mfma_f32_16x16x32_bf16 v[64:67],v[176:179],v[160:163],v[64:67]
s_add_u32 s36,s36,32768
v_mfma_f32_16x16x32_bf16 v[68:71],v[176:179],v[164:167],v[68:71]
v_mfma_f32_16x16x32_bf16 v[72:75],v[176:179],v[168:171],v[72:75]
s_cmp_eq_u32 s36,163840
s_cselect_b32 s42,s51,s50
s_cselect_b32 s36,0,s36
v_add_u32 v12,s42,v12
v_add_u32 v14,s42,v14
v_add_u32 v15,s42,v15
s_waitcnt vmcnt(14)
s_waitcnt lgkmcnt(0)
s_barrier
ds_read_b128 v[128:131],v12 offset:0
v_mfma_f32_16x16x32_bf16 v[76:79],v[176:179],v[172:175],v[76:79]
ds_read_b64_tr_b16 v[144:145],v14 offset:0
ds_read_b64_tr_b16 v[146:147],v14 offset:512
v_accvgpr_read_b32 v232,a52
v_mfma_f32_16x16x32_bf16 v[80:83],v[180:183],v[160:163],v[80:83]
ds_read_b128 v[132:135],v12 offset:2048
s_add_u32 m0,s35,s43
v_accvgpr_read_b32 v233,a56
v_mfma_f32_16x16x32_bf16 v[84:87],v[180:183],v[164:167],v[84:87]
ds_read_b128 v[136:139],v12 offset:4096
buffer_load_dwordx4 v8,s[12:15],s33 offen lds
v_cvt_pk_bf16_f32 v236,v232,v232
v_mfma_f32_16x16x32_bf16 v[88:91],v[180:183],v[168:171],v[88:91]
buffer_load_dwordx4 v9,s[12:15],s33 offen offset:1024 lds
s_add_u32 s35,s35,32768
v_cvt_pk_bf16_f32 v237,v233,v233
v_mfma_f32_16x16x32_bf16 v[92:95],v[180:183],v[172:175],v[92:95]
ds_read_b128 v[140:143],v12 offset:6144
v_and_b32 v236,0xffff0000,v236
v_and_b32 v237,0xffff0000,v237
v_mfma_f32_16x16x32_bf16 v[96:99],v[184:187],v[160:163],v[96:99]
ds_read_b64_tr_b16 v[148:149],v15 offset:0
ds_read_b64_tr_b16 v[150:151],v15 offset:512
v_sub_f32 v236,v232,v236
v_mfma_f32_16x16x32_bf16 v[100:103],v[184:187],v[164:167],v[100:103]
ds_read_b64_tr_b16 v[152:153],v14 offset:8192
v_sub_f32 v237,v233,v237
v_cvt_pk_bf16_f32 v236,v232,v236
v_mfma_f32_16x16x32_bf16 v[104:107],v[184:187],v[168:171],v[104:107]
ds_read_b64_tr_b16 v[154:155],v14 offset:8704
ds_read_b64_tr_b16 v[156:157],v15 offset:8192
v_cvt_pk_bf16_f32 v237,v233,v237
v_mfma_f32_16x16x32_bf16 v[108:111],v[184:187],v[172:175],v[108:111]
ds_read_b64_tr_b16 v[158:159],v15 offset:8704
v_mfma_f32_16x16x32_bf16 v[112:115],v[188:191],v[160:163],v[112:115]
s_cmp_eq_u32 s35,163840
s_cselect_b32 s35,0,s35
v_mfma_f32_16x16x32_bf16 v[116:119],v[188:191],v[164:167],v[116:119]
s_add_u32 s32,s32,393216
v_mfma_f32_16x16x32_bf16 v[120:123],v[188:191],v[168:171],v[120:123]
s_cmp_eq_u32 s32,6293504
s_cselect_b32 s32,2048,s32
v_mfma_f32_16x16x32_bf16 v[124:127],v[188:191],v[172:175],v[124:127]
s_add_u32 s33,s32,2048
s_add_u32 m0,s34,s40
s_nop 0
buffer_load_dwordx4 v4,s[8:11],s30 offen lds
buffer_load_dwordx4 v5,s[8:11],s30 offen offset:1024 lds
buffer_load_dwordx4 v6,s[8:11],s30 offen offset:2048 lds
buffer_load_dwordx4 v7,s[8:11],s30 offen offset:3072 lds
s_add_u32 s34,s34,32768
s_cmp_eq_u32 s34,163840
s_cselect_b32 s34,0,s34
s_add_u32 s30,s30,128
s_and_b32 s30,s30,0x7ff
v_mov_b32 v26,0
global_load_dword v27,v26,s[82:83] sc1
s_mov_b32 exec_lo,0x11111111
s_mov_b32 exec_hi,0x11111111
buffer_store_dwordx2 v[224:225],v17,s[24:27],s48 offen sc1
buffer_store_dwordx2 v[226:227],v17,s[24:27],s48 offen offset:16 sc1
s_mov_b64 exec,0xffff
s_cmp_lg_u32 s28,0
s_cbranch_scc1 Lcw11
buffer_store_dword v236,v16,s[24:27],s63 offen sc1
buffer_store_dword v237,v16,s[24:27],s63 offen offset:256 sc1
s_branch Lcwe12
Lcw11:
buffer_store_dword v236,v16,s[24:27],s55 offen sc1
buffer_store_dword v237,v16,s[24:27],s55 offen offset:256 sc1
Lcwe12:
s_mov_b64 exec,-1
s_waitcnt lgkmcnt(4)
v_mfma_f32_16x16x32_bf16 v[64:67],v[144:147],v[128:131],v[64:67]
v_add_u32 v13,s42,v13
ds_read_b128 v[160:163],v13 offset:0
v_mfma_f32_16x16x32_bf16 v[68:71],v[144:147],v[132:135],v[68:71]
ds_read_b64_tr_b16 v[176:177],v14 offset:4096
s_add_u32 m0,s35,s41
v_mfma_f32_16x16x32_bf16 v[72:75],v[144:147],v[136:139],v[72:75]
ds_read_b64_tr_b16 v[178:179],v14 offset:4608
buffer_load_dwordx4 v8,s[12:15],s32 offen lds
v_mfma_f32_16x16x32_bf16 v[76:79],v[144:147],v[140:143],v[76:79]
ds_read_b128 v[164:167],v13 offset:2048
v_mfma_f32_16x16x32_bf16 v[80:83],v[148:151],v[128:131],v[80:83]
ds_read_b128 v[168:171],v13 offset:4096
buffer_load_dwordx4 v9,s[12:15],s32 offen offset:1024 lds
v_mfma_f32_16x16x32_bf16 v[84:87],v[148:151],v[132:135],v[84:87]
s_add_u32 m0,s35,s43
v_mfma_f32_16x16x32_bf16 v[88:91],v[148:151],v[136:139],v[88:91]
ds_read_b128 v[172:175],v13 offset:6144
buffer_load_dwordx4 v8,s[12:15],s33 offen lds
v_mfma_f32_16x16x32_bf16 v[92:95],v[148:151],v[140:143],v[92:95]
ds_read_b64_tr_b16 v[180:181],v15 offset:4096
s_waitcnt lgkmcnt(7)
v_mfma_f32_16x16x32_bf16 v[96:99],v[152:155],v[128:131],v[96:99]
ds_read_b64_tr_b16 v[182:183],v15 offset:4608
buffer_load_dwordx4 v9,s[12:15],s33 offen offset:1024 lds
v_mfma_f32_16x16x32_bf16 v[100:103],v[152:155],v[132:135],v[100:103]
ds_read_b64_tr_b16 v[184:185],v14 offset:12288
ds_read_b64_tr_b16 v[186:187],v14 offset:12800
v_mfma_f32_16x16x32_bf16 v[104:107],v[152:155],v[136:139],v[104:107]
ds_read_b64_tr_b16 v[188:189],v15 offset:12288
s_add_u32 s35,s35,32768
v_mfma_f32_16x16x32_bf16 v[108:111],v[152:155],v[140:143],v[108:111]
ds_read_b64_tr_b16 v[190:191],v15 offset:12800
v_mfma_f32_16x16x32_bf16 v[112:115],v[156:159],v[128:131],v[112:115]
s_cmp_eq_u32 s35,163840
s_cselect_b32 s35,0,s35
v_mfma_f32_16x16x32_bf16 v[116:119],v[156:159],v[132:135],v[116:119]
s_add_u32 s32,s32,393216
v_mfma_f32_16x16x32_bf16 v[120:123],v[156:159],v[136:139],v[120:123]
s_cmp_eq_u32 s32,6293504
s_cselect_b32 s32,2048,s32
v_mfma_f32_16x16x32_bf16 v[124:127],v[156:159],v[140:143],v[124:127]
s_add_u32 s33,s32,2048
s_add_u32 m0,s34,s40
s_nop 0
buffer_load_dwordx4 v4,s[8:11],s30 offen lds
buffer_load_dwordx4 v5,s[8:11],s30 offen offset:1024 lds
s_waitcnt lgkmcnt(4)
v_mfma_f32_16x16x32_bf16 v[64:67],v[176:179],v[160:163],v[64:67]
s_add_u32 s36,s36,32768
v_mfma_f32_16x16x32_bf16 v[68:71],v[176:179],v[164:167],v[68:71]
v_mfma_f32_16x16x32_bf16 v[72:75],v[176:179],v[168:171],v[72:75]
s_cmp_eq_u32 s36,163840
s_cselect_b32 s42,s51,s50
s_cselect_b32 s36,0,s36
v_add_u32 v12,s42,v12
v_add_u32 v14,s42,v14
v_add_u32 v15,s42,v15
s_waitcnt vmcnt(23)
s_waitcnt lgkmcnt(0)
s_barrier
ds_read_b128 v[128:131],v12 offset:0
v_mfma_f32_16x16x32_bf16 v[76:79],v[176:179],v[172:175],v[76:79]
ds_read_b64_tr_b16 v[144:145],v14 offset:0
ds_read_b64_tr_b16 v[146:147],v14 offset:512
v_mfma_f32_16x16x32_bf16 v[80:83],v[180:183],v[160:163],v[80:83]
ds_read_b128 v[132:135],v12 offset:2048
buffer_load_dwordx4 v6,s[8:11],s30 offen offset:2048 lds
v_mfma_f32_16x16x32_bf16 v[84:87],v[180:183],v[164:167],v[84:87]
ds_read_b128 v[136:139],v12 offset:4096
buffer_load_dwordx4 v7,s[8:11],s30 offen offset:3072 lds
v_mfma_f32_16x16x32_bf16 v[88:91],v[180:183],v[168:171],v[88:91]
s_add_u32 s34,s34,32768
v_mfma_f32_16x16x32_bf16 v[92:95],v[180:183],v[172:175],v[92:95]
ds_read_b128 v[140:143],v12 offset:6144
v_mfma_f32_16x16x32_bf16 v[96:99],v[184:187],v[160:163],v[96:99]
ds_read_b64_tr_b16 v[148:149],v15 offset:0
ds_read_b64_tr_b16 v[150:151],v15 offset:512
v_mfma_f32_16x16x32_bf16 v[100:103],v[184:187],v[164:167],v[100:103]
ds_read_b64_tr_b16 v[152:153],v14 offset:8192
v_mfma_f32_16x16x32_bf16 v[104:107],v[184:187],v[168:171],v[104:107]
ds_read_b64_tr_b16 v[154:155],v14 offset:8704
ds_read_b64_tr_b16 v[156:157],v15 offset:8192
v_mfma_f32_16x16x32_bf16 v[108:111],v[184:187],v[172:175],v[108:111]
ds_read_b64_tr_b16 v[158:159],v15 offset:8704
v_mfma_f32_16x16x32_bf16 v[112:115],v[188:191],v[160:163],v[112:115]
s_cmp_eq_u32 s34,163840
s_cselect_b32 s34,0,s34
v_mfma_f32_16x16x32_bf16 v[116:119],v[188:191],v[164:167],v[116:119]
s_add_u32 s30,s30,128
s_and_b32 s30,s30,0x7ff
v_mfma_f32_16x16x32_bf16 v[120:123],v[188:191],v[168:171],v[120:123]
s_add_u32 m0,s35,s41
s_nop 0
buffer_load_dwordx4 v8,s[12:15],s32 offen lds
v_mfma_f32_16x16x32_bf16 v[124:127],v[188:191],v[172:175],v[124:127]
buffer_load_dwordx4 v9,s[12:15],s32 offen offset:1024 lds
s_add_u32 m0,s35,s43
s_nop 0
buffer_load_dwordx4 v8,s[12:15],s33 offen lds
buffer_load_dwordx4 v9,s[12:15],s33 offen offset:1024 lds
s_add_u32 s35,s35,32768
s_cmp_eq_u32 s35,163840
s_cselect_b32 s35,0,s35
s_add_u32 s32,s32,393216
s_cmp_eq_u32 s32,6293504
s_cselect_b32 s32,2048,s32
s_add_u32 s33,s32,2048
s_waitcnt lgkmcnt(4)
v_mfma_f32_16x16x32_bf16 v[64:67],v[144:147],v[128:131],v[64:67]
v_add_u32 v13,s42,v13
ds_read_b128 v[160:163],v13 offset:0
v_mfma_f32_16x16x32_bf16 v[68:71],v[144:147],v[132:135],v[68:71]
ds_read_b64_tr_b16 v[176:177],v14 offset:4096
s_add_u32 m0,s34,s40
v_mfma_f32_16x16x32_bf16 v[72:75],v[144:147],v[136:139],v[72:75]
ds_read_b64_tr_b16 v[178:179],v14 offset:4608
buffer_load_dwordx4 v4,s[8:11],s30 offen lds
v_mfma_f32_16x16x32_bf16 v[76:79],v[144:147],v[140:143],v[76:79]
ds_read_b128 v[164:167],v13 offset:2048
v_mfma_f32_16x16x32_bf16 v[80:83],v[148:151],v[128:131],v[80:83]
ds_read_b128 v[168:171],v13 offset:4096
buffer_load_dwordx4 v5,s[8:11],s30 offen offset:1024 lds
v_mfma_f32_16x16x32_bf16 v[84:87],v[148:151],v[132:135],v[84:87]
v_mfma_f32_16x16x32_bf16 v[88:91],v[148:151],v[136:139],v[88:91]
ds_read_b128 v[172:175],v13 offset:6144
buffer_load_dwordx4 v6,s[8:11],s30 offen offset:2048 lds
v_mfma_f32_16x16x32_bf16 v[92:95],v[148:151],v[140:143],v[92:95]
ds_read_b64_tr_b16 v[180:181],v15 offset:4096
s_waitcnt lgkmcnt(7)
v_mfma_f32_16x16x32_bf16 v[96:99],v[152:155],v[128:131],v[96:99]
ds_read_b64_tr_b16 v[182:183],v15 offset:4608
buffer_load_dwordx4 v7,s[8:11],s30 offen offset:3072 lds
v_mfma_f32_16x16x32_bf16 v[100:103],v[152:155],v[132:135],v[100:103]
ds_read_b64_tr_b16 v[184:185],v14 offset:12288
ds_read_b64_tr_b16 v[186:187],v14 offset:12800
v_mfma_f32_16x16x32_bf16 v[104:107],v[152:155],v[136:139],v[104:107]
ds_read_b64_tr_b16 v[188:189],v15 offset:12288
s_add_u32 s34,s34,32768
v_mfma_f32_16x16x32_bf16 v[108:111],v[152:155],v[140:143],v[108:111]
ds_read_b64_tr_b16 v[190:191],v15 offset:12800
v_mfma_f32_16x16x32_bf16 v[112:115],v[156:159],v[128:131],v[112:115]
s_cmp_eq_u32 s34,163840
s_cselect_b32 s34,0,s34
v_mfma_f32_16x16x32_bf16 v[116:119],v[156:159],v[132:135],v[116:119]
s_add_u32 s30,s30,128
s_and_b32 s30,s30,0x7ff
v_mfma_f32_16x16x32_bf16 v[120:123],v[156:159],v[136:139],v[120:123]
s_add_u32 m0,s35,s41
s_nop 0
buffer_load_dwordx4 v8,s[12:15],s32 offen lds
v_mfma_f32_16x16x32_bf16 v[124:127],v[156:159],v[140:143],v[124:127]
buffer_load_dwordx4 v9,s[12:15],s32 offen offset:1024 lds
s_waitcnt lgkmcnt(4)
v_mfma_f32_16x16x32_bf16 v[64:67],v[176:179],v[160:163],v[64:67]
s_add_u32 s36,s36,32768
v_mfma_f32_16x16x32_bf16 v[68:71],v[176:179],v[164:167],v[68:71]
v_mfma_f32_16x16x32_bf16 v[72:75],v[176:179],v[168:171],v[72:75]
s_cmp_eq_u32 s36,163840
s_cselect_b32 s42,s51,s50
s_cselect_b32 s36,0,s36
v_add_u32 v12,s42,v12
v_add_u32 v14,s42,v14
v_add_u32 v15,s42,v15
s_waitcnt vmcnt(27)
s_waitcnt lgkmcnt(0)
s_barrier
ds_read_b128 v[128:131],v12 offset:0
v_mfma_f32_16x16x32_bf16 v[76:79],v[176:179],v[172:175],v[76:79]
ds_read_b64_tr_b16 v[144:145],v14 offset:0
ds_read_b64_tr_b16 v[146:147],v14 offset:512
v_mfma_f32_16x16x32_bf16 v[80:83],v[180:183],v[160:163],v[80:83]
ds_read_b128 v[132:135],v12 offset:2048
s_add_u32 m0,s35,s43
v_mfma_f32_16x16x32_bf16 v[84:87],v[180:183],v[164:167],v[84:87]
ds_read_b128 v[136:139],v12 offset:4096
buffer_load_dwordx4 v8,s[12:15],s33 offen lds
v_mfma_f32_16x16x32_bf16 v[88:91],v[180:183],v[168:171],v[88:91]
buffer_load_dwordx4 v9,s[12:15],s33 offen offset:1024 lds
s_add_u32 s35,s35,32768
v_mfma_f32_16x16x32_bf16 v[92:95],v[180:183],v[172:175],v[92:95]
ds_read_b128 v[140:143],v12 offset:6144
v_mfma_f32_16x16x32_bf16 v[96:99],v[184:187],v[160:163],v[96:99]
ds_read_b64_tr_b16 v[148:149],v15 offset:0
ds_read_b64_tr_b16 v[150:151],v15 offset:512
v_mfma_f32_16x16x32_bf16 v[100:103],v[184:187],v[164:167],v[100:103]
ds_read_b64_tr_b16 v[152:153],v14 offset:8192
v_mfma_f32_16x16x32_bf16 v[104:107],v[184:187],v[168:171],v[104:107]
ds_read_b64_tr_b16 v[154:155],v14 offset:8704
ds_read_b64_tr_b16 v[156:157],v15 offset:8192
v_mfma_f32_16x16x32_bf16 v[108:111],v[184:187],v[172:175],v[108:111]
ds_read_b64_tr_b16 v[158:159],v15 offset:8704
v_mfma_f32_16x16x32_bf16 v[112:115],v[188:191],v[160:163],v[112:115]
s_cmp_eq_u32 s35,163840
s_cselect_b32 s35,0,s35
v_mfma_f32_16x16x32_bf16 v[116:119],v[188:191],v[164:167],v[116:119]
s_add_u32 s32,s32,393216
v_mfma_f32_16x16x32_bf16 v[120:123],v[188:191],v[168:171],v[120:123]
s_cmp_eq_u32 s32,6293504
s_cselect_b32 s32,2048,s32
v_mfma_f32_16x16x32_bf16 v[124:127],v[188:191],v[172:175],v[124:127]
s_add_u32 s33,s32,2048
s_add_u32 m0,s34,s40
s_nop 0
buffer_load_dwordx4 v4,s[8:11],s30 offen lds
buffer_load_dwordx4 v5,s[8:11],s30 offen offset:1024 lds
buffer_load_dwordx4 v6,s[8:11],s30 offen offset:2048 lds
buffer_load_dwordx4 v7,s[8:11],s30 offen offset:3072 lds
s_add_u32 s34,s34,32768
s_cmp_eq_u32 s34,163840
s_cselect_b32 s34,0,s34
s_add_u32 s30,s30,128
s_and_b32 s30,s30,0x7ff
s_waitcnt lgkmcnt(4)
v_mfma_f32_16x16x32_bf16 v[64:67],v[144:147],v[128:131],v[64:67]
v_add_u32 v13,s42,v13
ds_read_b128 v[160:163],v13 offset:0
v_mfma_f32_16x16x32_bf16 v[68:71],v[144:147],v[132:135],v[68:71]
ds_read_b64_tr_b16 v[176:177],v14 offset:4096
s_add_u32 m0,s35,s41
v_mfma_f32_16x16x32_bf16 v[72:75],v[144:147],v[136:139],v[72:75]
ds_read_b64_tr_b16 v[178:179],v14 offset:4608
buffer_load_dwordx4 v8,s[12:15],s32 offen lds
v_mfma_f32_16x16x32_bf16 v[76:79],v[144:147],v[140:143],v[76:79]
ds_read_b128 v[164:167],v13 offset:2048
v_mfma_f32_16x16x32_bf16 v[80:83],v[148:151],v[128:131],v[80:83]
ds_read_b128 v[168:171],v13 offset:4096
v_mfma_f32_16x16x32_bf16 v[84:87],v[148:151],v[132:135],v[84:87]
buffer_load_dwordx4 v9,s[12:15],s32 offen offset:1024 lds
s_add_u32 m0,s35,s43
v_mfma_f32_16x16x32_bf16 v[88:91],v[148:151],v[136:139],v[88:91]
ds_read_b128 v[172:175],v13 offset:6144
v_mfma_f32_16x16x32_bf16 v[92:95],v[148:151],v[140:143],v[92:95]
ds_read_b64_tr_b16 v[180:181],v15 offset:4096
s_waitcnt lgkmcnt(7)
v_mfma_f32_16x16x32_bf16 v[96:99],v[152:155],v[128:131],v[96:99]
ds_read_b64_tr_b16 v[182:183],v15 offset:4608
buffer_load_dwordx4 v8,s[12:15],s33 offen lds
v_mfma_f32_16x16x32_bf16 v[100:103],v[152:155],v[132:135],v[100:103]
ds_read_b64_tr_b16 v[184:185],v14 offset:12288
ds_read_b64_tr_b16 v[186:187],v14 offset:12800
v_mfma_f32_16x16x32_bf16 v[104:107],v[152:155],v[136:139],v[104:107]
ds_read_b64_tr_b16 v[188:189],v15 offset:12288
v_mfma_f32_16x16x32_bf16 v[108:111],v[152:155],v[140:143],v[108:111]
ds_read_b64_tr_b16 v[190:191],v15 offset:12800
buffer_load_dwordx4 v9,s[12:15],s33 offen offset:1024 lds
v_mfma_f32_16x16x32_bf16 v[112:115],v[156:159],v[128:131],v[112:115]
s_add_u32 s35,s35,32768
v_mfma_f32_16x16x32_bf16 v[116:119],v[156:159],v[132:135],v[116:119]
s_cmp_eq_u32 s35,163840
s_cselect_b32 s35,0,s35
v_mfma_f32_16x16x32_bf16 v[120:123],v[156:159],v[136:139],v[120:123]
s_add_u32 s32,s32,393216
v_mfma_f32_16x16x32_bf16 v[124:127],v[156:159],v[140:143],v[124:127]
s_cmp_eq_u32 s32,6293504
s_cselect_b32 s32,2048,s32
s_add_u32 s33,s32,2048
s_waitcnt lgkmcnt(4)
v_mfma_f32_16x16x32_bf16 v[64:67],v[176:179],v[160:163],v[64:67]
s_add_u32 s36,s36,32768
v_mfma_f32_16x16x32_bf16 v[68:71],v[176:179],v[164:167],v[68:71]
v_mfma_f32_16x16x32_bf16 v[72:75],v[176:179],v[168:171],v[72:75]
s_cmp_eq_u32 s36,163840
s_cselect_b32 s42,s51,s50
s_cselect_b32 s36,0,s36
v_add_u32 v12,s42,v12
v_add_u32 v14,s42,v14
v_add_u32 v15,s42,v15
s_waitcnt vmcnt(24)
s_waitcnt lgkmcnt(0)
s_barrier
ds_read_b128 v[128:131],v12 offset:0
v_mfma_f32_16x16x32_bf16 v[76:79],v[176:179],v[172:175],v[76:79]
ds_read_b64_tr_b16 v[144:145],v14 offset:0
ds_read_b64_tr_b16 v[146:147],v14 offset:512
v_mfma_f32_16x16x32_bf16 v[80:83],v[180:183],v[160:163],v[80:83]
ds_read_b128 v[132:135],v12 offset:2048
s_add_u32 m0,s34,s40
v_mfma_f32_16x16x32_bf16 v[84:87],v[180:183],v[164:167],v[84:87]
ds_read_b128 v[136:139],v12 offset:4096
buffer_load_dwordx4 v4,s[8:11],s30 offen lds
v_mfma_f32_16x16x32_bf16 v[88:91],v[180:183],v[168:171],v[88:91]
buffer_load_dwordx4 v5,s[8:11],s30 offen offset:1024 lds
v_mfma_f32_16x16x32_bf16 v[92:95],v[180:183],v[172:175],v[92:95]
ds_read_b128 v[140:143],v12 offset:6144
v_mfma_f32_16x16x32_bf16 v[96:99],v[184:187],v[160:163],v[96:99]
ds_read_b64_tr_b16 v[148:149],v15 offset:0
ds_read_b64_tr_b16 v[150:151],v15 offset:512
v_mfma_f32_16x16x32_bf16 v[100:103],v[184:187],v[164:167],v[100:103]
ds_read_b64_tr_b16 v[152:153],v14 offset:8192
buffer_load_dwordx4 v6,s[8:11],s30 offen offset:2048 lds
v_mfma_f32_16x16x32_bf16 v[104:107],v[184:187],v[168:171],v[104:107]
ds_read_b64_tr_b16 v[154:155],v14 offset:8704
ds_read_b64_tr_b16 v[156:157],v15 offset:8192
v_mfma_f32_16x16x32_bf16 v[108:111],v[184:187],v[172:175],v[108:111]
ds_read_b64_tr_b16 v[158:159],v15 offset:8704
v_mfma_f32_16x16x32_bf16 v[112:115],v[188:191],v[160:163],v[112:115]
buffer_load_dwordx4 v7,s[8:11],s30 offen offset:3072 lds
s_add_u32 s34,s34,32768
v_mfma_f32_16x16x32_bf16 v[116:119],v[188:191],v[164:167],v[116:119]
s_cmp_eq_u32 s34,163840
s_cselect_b32 s34,0,s34
v_mfma_f32_16x16x32_bf16 v[120:123],v[188:191],v[168:171],v[120:123]
s_add_u32 s30,s30,128
s_and_b32 s30,s30,0x7ff
v_mfma_f32_16x16x32_bf16 v[124:127],v[188:191],v[172:175],v[124:127]
s_waitcnt lgkmcnt(4)
v_mfma_f32_16x16x32_bf16 v[64:67],v[144:147],v[128:131],v[64:67]
v_add_u32 v13,s42,v13
ds_read_b128 v[160:163],v13 offset:0
v_mfma_f32_16x16x32_bf16 v[68:71],v[144:147],v[132:135],v[68:71]
ds_read_b64_tr_b16 v[176:177],v14 offset:4096
s_add_u32 m0,s35,s41
v_mfma_f32_16x16x32_bf16 v[72:75],v[144:147],v[136:139],v[72:75]
ds_read_b64_tr_b16 v[178:179],v14 offset:4608
buffer_load_dwordx4 v8,s[12:15],s32 offen lds
v_mfma_f32_16x16x32_bf16 v[76:79],v[144:147],v[140:143],v[76:79]
ds_read_b128 v[164:167],v13 offset:2048
v_mfma_f32_16x16x32_bf16 v[80:83],v[148:151],v[128:131],v[80:83]
ds_read_b128 v[168:171],v13 offset:4096
v_mfma_f32_16x16x32_bf16 v[84:87],v[148:151],v[132:135],v[84:87]
buffer_load_dwordx4 v9,s[12:15],s32 offen offset:1024 lds
s_add_u32 m0,s35,s43
v_mfma_f32_16x16x32_bf16 v[88:91],v[148:151],v[136:139],v[88:91]
ds_read_b128 v[172:175],v13 offset:6144
v_mfma_f32_16x16x32_bf16 v[92:95],v[148:151],v[140:143],v[92:95]
ds_read_b64_tr_b16 v[180:181],v15 offset:4096
s_waitcnt lgkmcnt(7)
v_mfma_f32_16x16x32_bf16 v[96:99],v[152:155],v[128:131],v[96:99]
ds_read_b64_tr_b16 v[182:183],v15 offset:4608
buffer_load_dwordx4 v8,s[12:15],s33 offen lds
v_mfma_f32_16x16x32_bf16 v[100:103],v[152:155],v[132:135],v[100:103]
ds_read_b64_tr_b16 v[184:185],v14 offset:12288
ds_read_b64_tr_b16 v[186:187],v14 offset:12800
v_mfma_f32_16x16x32_bf16 v[104:107],v[152:155],v[136:139],v[104:107]
ds_read_b64_tr_b16 v[188:189],v15 offset:12288
v_mfma_f32_16x16x32_bf16 v[108:111],v[152:155],v[140:143],v[108:111]
ds_read_b64_tr_b16 v[190:191],v15 offset:12800
buffer_load_dwordx4 v9,s[12:15],s33 offen offset:1024 lds
v_mfma_f32_16x16x32_bf16 v[112:115],v[156:159],v[128:131],v[112:115]
s_add_u32 s35,s35,32768
v_mfma_f32_16x16x32_bf16 v[116:119],v[156:159],v[132:135],v[116:119]
s_cmp_eq_u32 s35,163840
s_cselect_b32 s35,0,s35
v_mfma_f32_16x16x32_bf16 v[120:123],v[156:159],v[136:139],v[120:123]
s_add_u32 s32,s32,393216
v_mfma_f32_16x16x32_bf16 v[124:127],v[156:159],v[140:143],v[124:127]
s_cmp_eq_u32 s32,6293504
s_cselect_b32 s32,2048,s32
s_add_u32 s33,s32,2048
s_waitcnt lgkmcnt(4)
v_mfma_f32_16x16x32_bf16 v[64:67],v[176:179],v[160:163],v[64:67]
s_add_u32 s36,s36,32768
v_mfma_f32_16x16x32_bf16 v[68:71],v[176:179],v[164:167],v[68:71]
v_mfma_f32_16x16x32_bf16 v[72:75],v[176:179],v[168:171],v[72:75]
s_cmp_eq_u32 s36,163840
s_cselect_b32 s42,s51,s50
s_cselect_b32 s36,0,s36
v_add_u32 v12,s42,v12
v_add_u32 v14,s42,v14
v_add_u32 v15,s42,v15
s_waitcnt vmcnt(24)
s_waitcnt lgkmcnt(0)
s_barrier
s_mov_b32 s39,131072
Ltpl14:
v_readfirstlane_b32 s94,v27
s_nop 0
s_cmp_lg_u32 s94,0
s_cbranch_scc1 Ltok13
s_sleep 1
global_load_dword v27,v26,s[82:83] sc1
s_waitcnt vmcnt(0)
s_sub_u32 s39,s39,1
s_cmp_lg_u32 s39,0
s_cbranch_scc1 Ltpl14
Ltok13:
s_cmp_lg_u32 s20,0
s_cbranch_scc1 Lpub15
s_mov_b32 s18,s84
s_mov_b32 s19,s85
s_lshl_b32 s18,s18,8
s_lshl_b32 s19,s19,2
s_add_u32 s18,s18,s19
s_add_u32 s18,s18,95535104
v_mov_b32 v1,0
v_mov_b32 v3,s94
s_mov_b64 exec,1
buffer_store_dword v3,v1,s[24:27],s18 offen sc1
s_mov_b64 exec,-1
Lpub15:
s_cmp_lg_u32 s20,0
s_cbranch_scc1 Lpub16
s_mov_b32 s18,s85
s_mov_b32 s19,s84
s_lshl_b32 s18,s18,8
s_lshl_b32 s19,s19,2
s_add_u32 s18,s18,s19
s_add_u32 s18,s18,95551488
v_mov_b32 v1,0
v_mov_b32 v3,s94
s_mov_b64 exec,1
buffer_store_dword v3,v1,s[24:27],s18 offen sc1
s_mov_b64 exec,-1
Lpub16:
ds_read_b128 v[128:131],v12 offset:0
v_mfma_f32_16x16x32_bf16 v[76:79],v[176:179],v[172:175],v[76:79]
ds_read_b64_tr_b16 v[144:145],v14 offset:0
ds_read_b64_tr_b16 v[146:147],v14 offset:512
v_mfma_f32_16x16x32_bf16 v[80:83],v[180:183],v[160:163],v[80:83]
ds_read_b128 v[132:135],v12 offset:2048
s_add_u32 m0,s34,s40
v_mfma_f32_16x16x32_bf16 v[84:87],v[180:183],v[164:167],v[84:87]
ds_read_b128 v[136:139],v12 offset:4096
buffer_load_dwordx4 v4,s[8:11],s30 offen lds
v_mfma_f32_16x16x32_bf16 v[88:91],v[180:183],v[168:171],v[88:91]
buffer_load_dwordx4 v5,s[8:11],s30 offen offset:1024 lds
v_mfma_f32_16x16x32_bf16 v[92:95],v[180:183],v[172:175],v[92:95]
ds_read_b128 v[140:143],v12 offset:6144
v_mfma_f32_16x16x32_bf16 v[96:99],v[184:187],v[160:163],v[96:99]
ds_read_b64_tr_b16 v[148:149],v15 offset:0
ds_read_b64_tr_b16 v[150:151],v15 offset:512
v_mfma_f32_16x16x32_bf16 v[100:103],v[184:187],v[164:167],v[100:103]
ds_read_b64_tr_b16 v[152:153],v14 offset:8192
buffer_load_dwordx4 v6,s[8:11],s30 offen offset:2048 lds
v_mfma_f32_16x16x32_bf16 v[104:107],v[184:187],v[168:171],v[104:107]
ds_read_b64_tr_b16 v[154:155],v14 offset:8704
ds_read_b64_tr_b16 v[156:157],v15 offset:8192
v_mfma_f32_16x16x32_bf16 v[108:111],v[184:187],v[172:175],v[108:111]
ds_read_b64_tr_b16 v[158:159],v15 offset:8704
v_mfma_f32_16x16x32_bf16 v[112:115],v[188:191],v[160:163],v[112:115]
buffer_load_dwordx4 v7,s[8:11],s30 offen offset:3072 lds
s_add_u32 s34,s34,32768
v_mfma_f32_16x16x32_bf16 v[116:119],v[188:191],v[164:167],v[116:119]
s_cmp_eq_u32 s34,163840
s_cselect_b32 s34,0,s34
v_mfma_f32_16x16x32_bf16 v[120:123],v[188:191],v[168:171],v[120:123]
s_add_u32 s30,s30,128
s_and_b32 s30,s30,0x7ff
v_mfma_f32_16x16x32_bf16 v[124:127],v[188:191],v[172:175],v[124:127]
s_waitcnt lgkmcnt(4)
v_mfma_f32_16x16x32_bf16 v[64:67],v[144:147],v[128:131],v[64:67]
v_add_u32 v13,s42,v13
ds_read_b128 v[160:163],v13 offset:0
v_mfma_f32_16x16x32_bf16 v[68:71],v[144:147],v[132:135],v[68:71]
ds_read_b64_tr_b16 v[176:177],v14 offset:4096
s_add_u32 m0,s35,s41
v_mfma_f32_16x16x32_bf16 v[72:75],v[144:147],v[136:139],v[72:75]
ds_read_b64_tr_b16 v[178:179],v14 offset:4608
buffer_load_dwordx4 v8,s[12:15],s32 offen lds
v_mfma_f32_16x16x32_bf16 v[76:79],v[144:147],v[140:143],v[76:79]
ds_read_b128 v[164:167],v13 offset:2048
v_mfma_f32_16x16x32_bf16 v[80:83],v[148:151],v[128:131],v[80:83]
ds_read_b128 v[168:171],v13 offset:4096
v_mfma_f32_16x16x32_bf16 v[84:87],v[148:151],v[132:135],v[84:87]
buffer_load_dwordx4 v9,s[12:15],s32 offen offset:1024 lds
s_add_u32 m0,s35,s43
v_mfma_f32_16x16x32_bf16 v[88:91],v[148:151],v[136:139],v[88:91]
ds_read_b128 v[172:175],v13 offset:6144
v_mfma_f32_16x16x32_bf16 v[92:95],v[148:151],v[140:143],v[92:95]
ds_read_b64_tr_b16 v[180:181],v15 offset:4096
s_waitcnt lgkmcnt(7)
v_mfma_f32_16x16x32_bf16 v[96:99],v[152:155],v[128:131],v[96:99]
ds_read_b64_tr_b16 v[182:183],v15 offset:4608
buffer_load_dwordx4 v8,s[12:15],s33 offen lds
v_mfma_f32_16x16x32_bf16 v[100:103],v[152:155],v[132:135],v[100:103]
ds_read_b64_tr_b16 v[184:185],v14 offset:12288
ds_read_b64_tr_b16 v[186:187],v14 offset:12800
v_mfma_f32_16x16x32_bf16 v[104:107],v[152:155],v[136:139],v[104:107]
ds_read_b64_tr_b16 v[188:189],v15 offset:12288
v_mfma_f32_16x16x32_bf16 v[108:111],v[152:155],v[140:143],v[108:111]
ds_read_b64_tr_b16 v[190:191],v15 offset:12800
buffer_load_dwordx4 v9,s[12:15],s33 offen offset:1024 lds
v_mfma_f32_16x16x32_bf16 v[112:115],v[156:159],v[128:131],v[112:115]
s_add_u32 s35,s35,32768
v_mfma_f32_16x16x32_bf16 v[116:119],v[156:159],v[132:135],v[116:119]
s_cmp_eq_u32 s35,163840
s_cselect_b32 s35,0,s35
v_mfma_f32_16x16x32_bf16 v[120:123],v[156:159],v[136:139],v[120:123]
s_add_u32 s32,s32,393216
v_mfma_f32_16x16x32_bf16 v[124:127],v[156:159],v[140:143],v[124:127]
s_cmp_eq_u32 s32,6293504
s_cselect_b32 s32,2048,s32
s_add_u32 s33,s32,2048
s_waitcnt lgkmcnt(4)
v_mfma_f32_16x16x32_bf16 v[64:67],v[176:179],v[160:163],v[64:67]
s_add_u32 s36,s36,32768
v_mfma_f32_16x16x32_bf16 v[68:71],v[176:179],v[164:167],v[68:71]
v_mfma_f32_16x16x32_bf16 v[72:75],v[176:179],v[168:171],v[72:75]
s_cmp_eq_u32 s36,163840
s_cselect_b32 s42,s51,s50
s_cselect_b32 s36,0,s36
v_add_u32 v12,s42,v12
v_add_u32 v14,s42,v14
v_add_u32 v15,s42,v15
s_waitcnt vmcnt(24)
s_waitcnt lgkmcnt(0)
s_barrier
ds_read_b128 v[128:131],v12 offset:0
v_mfma_f32_16x16x32_bf16 v[76:79],v[176:179],v[172:175],v[76:79]
ds_read_b64_tr_b16 v[144:145],v14 offset:0
ds_read_b64_tr_b16 v[146:147],v14 offset:512
v_mfma_f32_16x16x32_bf16 v[80:83],v[180:183],v[160:163],v[80:83]
ds_read_b128 v[132:135],v12 offset:2048
s_add_u32 m0,s34,s40
v_mfma_f32_16x16x32_bf16 v[84:87],v[180:183],v[164:167],v[84:87]
ds_read_b128 v[136:139],v12 offset:4096
buffer_load_dwordx4 v4,s[8:11],s30 offen lds
v_mfma_f32_16x16x32_bf16 v[88:91],v[180:183],v[168:171],v[88:91]
buffer_load_dwordx4 v5,s[8:11],s30 offen offset:1024 lds
v_mfma_f32_16x16x32_bf16 v[92:95],v[180:183],v[172:175],v[92:95]
ds_read_b128 v[140:143],v12 offset:6144
v_mfma_f32_16x16x32_bf16 v[96:99],v[184:187],v[160:163],v[96:99]
ds_read_b64_tr_b16 v[148:149],v15 offset:0
ds_read_b64_tr_b16 v[150:151],v15 offset:512
v_mfma_f32_16x16x32_bf16 v[100:103],v[184:187],v[164:167],v[100:103]
ds_read_b64_tr_b16 v[152:153],v14 offset:8192
buffer_load_dwordx4 v6,s[8:11],s30 offen offset:2048 lds
v_mfma_f32_16x16x32_bf16 v[104:107],v[184:187],v[168:171],v[104:107]
ds_read_b64_tr_b16 v[154:155],v14 offset:8704
ds_read_b64_tr_b16 v[156:157],v15 offset:8192
v_mfma_f32_16x16x32_bf16 v[108:111],v[184:187],v[172:175],v[108:111]
ds_read_b64_tr_b16 v[158:159],v15 offset:8704
v_mfma_f32_16x16x32_bf16 v[112:115],v[188:191],v[160:163],v[112:115]
buffer_load_dwordx4 v7,s[8:11],s30 offen offset:3072 lds
s_add_u32 s34,s34,32768
v_mfma_f32_16x16x32_bf16 v[116:119],v[188:191],v[164:167],v[116:119]
s_cmp_eq_u32 s34,163840
s_cselect_b32 s34,0,s34
v_mfma_f32_16x16x32_bf16 v[120:123],v[188:191],v[168:171],v[120:123]
s_add_u32 s30,s30,128
s_and_b32 s30,s30,0x7ff
v_mfma_f32_16x16x32_bf16 v[124:127],v[188:191],v[172:175],v[124:127]
s_waitcnt lgkmcnt(4)
v_mfma_f32_16x16x32_bf16 v[64:67],v[144:147],v[128:131],v[64:67]
v_add_u32 v13,s42,v13
ds_read_b128 v[160:163],v13 offset:0
v_mfma_f32_16x16x32_bf16 v[68:71],v[144:147],v[132:135],v[68:71]
ds_read_b64_tr_b16 v[176:177],v14 offset:4096
s_add_u32 m0,s35,s41
v_mfma_f32_16x16x32_bf16 v[72:75],v[144:147],v[136:139],v[72:75]
ds_read_b64_tr_b16 v[178:179],v14 offset:4608
buffer_load_dwordx4 v8,s[12:15],s32 offen lds
v_mfma_f32_16x16x32_bf16 v[76:79],v[144:147],v[140:143],v[76:79]
ds_read_b128 v[164:167],v13 offset:2048
v_mfma_f32_16x16x32_bf16 v[80:83],v[148:151],v[128:131],v[80:83]
ds_read_b128 v[168:171],v13 offset:4096
v_mfma_f32_16x16x32_bf16 v[84:87],v[148:151],v[132:135],v[84:87]
buffer_load_dwordx4 v9,s[12:15],s32 offen offset:1024 lds
s_add_u32 m0,s35,s43
v_mfma_f32_16x16x32_bf16 v[88:91],v[148:151],v[136:139],v[88:91]
ds_read_b128 v[172:175],v13 offset:6144
v_mfma_f32_16x16x32_bf16 v[92:95],v[148:151],v[140:143],v[92:95]
ds_read_b64_tr_b16 v[180:181],v15 offset:4096
s_waitcnt lgkmcnt(7)
v_mfma_f32_16x16x32_bf16 v[96:99],v[152:155],v[128:131],v[96:99]
ds_read_b64_tr_b16 v[182:183],v15 offset:4608
buffer_load_dwordx4 v8,s[12:15],s33 offen lds
v_mfma_f32_16x16x32_bf16 v[100:103],v[152:155],v[132:135],v[100:103]
ds_read_b64_tr_b16 v[184:185],v14 offset:12288
ds_read_b64_tr_b16 v[186:187],v14 offset:12800
v_mfma_f32_16x16x32_bf16 v[104:107],v[152:155],v[136:139],v[104:107]
ds_read_b64_tr_b16 v[188:189],v15 offset:12288
v_mfma_f32_16x16x32_bf16 v[108:111],v[152:155],v[140:143],v[108:111]
ds_read_b64_tr_b16 v[190:191],v15 offset:12800
buffer_load_dwordx4 v9,s[12:15],s33 offen offset:1024 lds
v_mfma_f32_16x16x32_bf16 v[112:115],v[156:159],v[128:131],v[112:115]
s_add_u32 s35,s35,32768
v_mfma_f32_16x16x32_bf16 v[116:119],v[156:159],v[132:135],v[116:119]
s_cmp_eq_u32 s35,163840
s_cselect_b32 s35,0,s35
v_mfma_f32_16x16x32_bf16 v[120:123],v[156:159],v[136:139],v[120:123]
s_add_u32 s32,s32,393216
v_mfma_f32_16x16x32_bf16 v[124:127],v[156:159],v[140:143],v[124:127]
s_cmp_eq_u32 s32,6293504
s_cselect_b32 s32,2048,s32
s_add_u32 s33,s32,2048
s_waitcnt lgkmcnt(4)
v_mfma_f32_16x16x32_bf16 v[64:67],v[176:179],v[160:163],v[64:67]
s_add_u32 s36,s36,32768
v_mfma_f32_16x16x32_bf16 v[68:71],v[176:179],v[164:167],v[68:71]
v_mfma_f32_16x16x32_bf16 v[72:75],v[176:179],v[168:171],v[72:75]
s_cmp_eq_u32 s36,163840
s_cselect_b32 s42,s51,s50
s_cselect_b32 s36,0,s36
v_add_u32 v12,s42,v12
v_add_u32 v14,s42,v14
v_add_u32 v15,s42,v15
s_waitcnt vmcnt(24)
s_waitcnt lgkmcnt(0)
s_barrier
ds_read_b128 v[128:131],v12 offset:0
v_mfma_f32_16x16x32_bf16 v[76:79],v[176:179],v[172:175],v[76:79]
ds_read_b64_tr_b16 v[144:145],v14 offset:0
ds_read_b64_tr_b16 v[146:147],v14 offset:512
v_mfma_f32_16x16x32_bf16 v[80:83],v[180:183],v[160:163],v[80:83]
ds_read_b128 v[132:135],v12 offset:2048
s_add_u32 m0,s34,s40
v_mfma_f32_16x16x32_bf16 v[84:87],v[180:183],v[164:167],v[84:87]
ds_read_b128 v[136:139],v12 offset:4096
buffer_load_dwordx4 v4,s[8:11],s30 offen lds
v_mfma_f32_16x16x32_bf16 v[88:91],v[180:183],v[168:171],v[88:91]
buffer_load_dwordx4 v5,s[8:11],s30 offen offset:1024 lds
v_mfma_f32_16x16x32_bf16 v[92:95],v[180:183],v[172:175],v[92:95]
ds_read_b128 v[140:143],v12 offset:6144
buffer_load_dwordx4 v6,s[8:11],s30 offen offset:2048 lds
v_mfma_f32_16x16x32_bf16 v[96:99],v[184:187],v[160:163],v[96:99]
ds_read_b64_tr_b16 v[148:149],v15 offset:0
ds_read_b64_tr_b16 v[150:151],v15 offset:512
v_mfma_f32_16x16x32_bf16 v[100:103],v[184:187],v[164:167],v[100:103]
ds_read_b64_tr_b16 v[152:153],v14 offset:8192
buffer_load_dwordx4 v7,s[8:11],s30 offen offset:3072 lds
v_mfma_f32_16x16x32_bf16 v[104:107],v[184:187],v[168:171],v[104:107]
ds_read_b64_tr_b16 v[154:155],v14 offset:8704
ds_read_b64_tr_b16 v[156:157],v15 offset:8192
v_mfma_f32_16x16x32_bf16 v[108:111],v[184:187],v[172:175],v[108:111]
ds_read_b64_tr_b16 v[158:159],v15 offset:8704
s_add_u32 s34,s34,32768
v_mfma_f32_16x16x32_bf16 v[112:115],v[188:191],v[160:163],v[112:115]
s_cmp_eq_u32 s34,163840
s_cselect_b32 s34,0,s34
v_mfma_f32_16x16x32_bf16 v[116:119],v[188:191],v[164:167],v[116:119]
s_add_u32 s30,s30,128
s_and_b32 s30,s30,0x7ff
v_mfma_f32_16x16x32_bf16 v[120:123],v[188:191],v[168:171],v[120:123]
buffer_load_dword v26,v28,s[24:27],s49 offen sc1
buffer_load_dword v27,v28,s[24:27],s52 offen sc1
v_mfma_f32_16x16x32_bf16 v[124:127],v[188:191],v[172:175],v[124:127]
buffer_load_ushort v240,v25,s[56:59],s45 offen offset:0
s_waitcnt lgkmcnt(4)
v_mfma_f32_16x16x32_bf16 v[64:67],v[144:147],v[128:131],v[64:67]
v_add_u32 v13,s42,v13
ds_read_b128 v[160:163],v13 offset:0
v_mfma_f32_16x16x32_bf16 v[68:71],v[144:147],v[132:135],v[68:71]
ds_read_b64_tr_b16 v[176:177],v14 offset:4096
s_add_u32 m0,s35,s41
v_mfma_f32_16x16x32_bf16 v[72:75],v[144:147],v[136:139],v[72:75]
ds_read_b64_tr_b16 v[178:179],v14 offset:4608
buffer_load_dwordx4 v8,s[12:15],s32 offen lds
v_mfma_f32_16x16x32_bf16 v[76:79],v[144:147],v[140:143],v[76:79]
ds_read_b128 v[164:167],v13 offset:2048
buffer_load_dwordx4 v9,s[12:15],s32 offen offset:1024 lds
v_mfma_f32_16x16x32_bf16 v[80:83],v[148:151],v[128:131],v[80:83]
ds_read_b128 v[168:171],v13 offset:4096
s_add_u32 m0,s35,s43
v_mfma_f32_16x16x32_bf16 v[84:87],v[148:151],v[132:135],v[84:87]
buffer_load_dwordx4 v8,s[12:15],s33 offen lds
v_mfma_f32_16x16x32_bf16 v[88:91],v[148:151],v[136:139],v[88:91]
ds_read_b128 v[172:175],v13 offset:6144
v_mfma_f32_16x16x32_bf16 v[92:95],v[148:151],v[140:143],v[92:95]
ds_read_b64_tr_b16 v[180:181],v15 offset:4096
buffer_load_dwordx4 v9,s[12:15],s33 offen offset:1024 lds
s_waitcnt lgkmcnt(7)
v_mfma_f32_16x16x32_bf16 v[96:99],v[152:155],v[128:131],v[96:99]
ds_read_b64_tr_b16 v[182:183],v15 offset:4608
s_add_u32 s35,s35,32768
v_mfma_f32_16x16x32_bf16 v[100:103],v[152:155],v[132:135],v[100:103]
ds_read_b64_tr_b16 v[184:185],v14 offset:12288
ds_read_b64_tr_b16 v[186:187],v14 offset:12800
v_mfma_f32_16x16x32_bf16 v[104:107],v[152:155],v[136:139],v[104:107]
ds_read_b64_tr_b16 v[188:189],v15 offset:12288
v_mfma_f32_16x16x32_bf16 v[108:111],v[152:155],v[140:143],v[108:111]
ds_read_b64_tr_b16 v[190:191],v15 offset:12800
v_mfma_f32_16x16x32_bf16 v[112:115],v[156:159],v[128:131],v[112:115]
s_cmp_eq_u32 s35,163840
s_cselect_b32 s35,0,s35
v_mfma_f32_16x16x32_bf16 v[116:119],v[156:159],v[132:135],v[116:119]
s_add_u32 s32,s32,393216
v_mfma_f32_16x16x32_bf16 v[120:123],v[156:159],v[136:139],v[120:123]
s_cmp_eq_u32 s32,6293504
s_cselect_b32 s32,2048,s32
v_mfma_f32_16x16x32_bf16 v[124:127],v[156:159],v[140:143],v[124:127]
s_add_u32 s33,s32,2048
buffer_load_ushort a40,v25,s[56:59],s45 offen offset:64
buffer_load_ushort v241,v25,s[56:59],s45 offen offset:128
buffer_load_ushort a41,v25,s[56:59],s45 offen offset:192
s_waitcnt lgkmcnt(4)
v_mfma_f32_16x16x32_bf16 v[64:67],v[176:179],v[160:163],v[64:67]
s_add_u32 s36,s36,32768
v_mfma_f32_16x16x32_bf16 v[68:71],v[176:179],v[164:167],v[68:71]
v_mfma_f32_16x16x32_bf16 v[72:75],v[176:179],v[168:171],v[72:75]
s_cmp_eq_u32 s36,163840
s_cselect_b32 s42,s51,s50
s_cselect_b32 s36,0,s36
v_add_u32 v12,s42,v12
v_add_u32 v14,s42,v14
v_add_u32 v15,s42,v15
s_waitcnt vmcnt(30)
s_waitcnt lgkmcnt(0)
s_barrier
ds_read_b128 v[128:131],v12 offset:0
v_mfma_f32_16x16x32_bf16 v[76:79],v[176:179],v[172:175],v[76:79]
ds_read_b64_tr_b16 v[144:145],v14 offset:0
ds_read_b64_tr_b16 v[146:147],v14 offset:512
v_mfma_f32_16x16x32_bf16 v[80:83],v[180:183],v[160:163],v[80:83]
ds_read_b128 v[132:135],v12 offset:2048
s_add_u32 m0,s34,s40
v_mfma_f32_16x16x32_bf16 v[84:87],v[180:183],v[164:167],v[84:87]
ds_read_b128 v[136:139],v12 offset:4096
buffer_load_dwordx4 v4,s[8:11],s30 offen lds
v_mfma_f32_16x16x32_bf16 v[88:91],v[180:183],v[168:171],v[88:91]
buffer_load_dwordx4 v5,s[8:11],s30 offen offset:1024 lds
v_mfma_f32_16x16x32_bf16 v[92:95],v[180:183],v[172:175],v[92:95]
ds_read_b128 v[140:143],v12 offset:6144
buffer_load_dwordx4 v6,s[8:11],s30 offen offset:2048 lds
v_mfma_f32_16x16x32_bf16 v[96:99],v[184:187],v[160:163],v[96:99]
ds_read_b64_tr_b16 v[148:149],v15 offset:0
ds_read_b64_tr_b16 v[150:151],v15 offset:512
v_mfma_f32_16x16x32_bf16 v[100:103],v[184:187],v[164:167],v[100:103]
ds_read_b64_tr_b16 v[152:153],v14 offset:8192
buffer_load_dwordx4 v7,s[8:11],s30 offen offset:3072 lds
v_mfma_f32_16x16x32_bf16 v[104:107],v[184:187],v[168:171],v[104:107]
ds_read_b64_tr_b16 v[154:155],v14 offset:8704
ds_read_b64_tr_b16 v[156:157],v15 offset:8192
v_mfma_f32_16x16x32_bf16 v[108:111],v[184:187],v[172:175],v[108:111]
ds_read_b64_tr_b16 v[158:159],v15 offset:8704
s_add_u32 s34,s34,32768
v_mfma_f32_16x16x32_bf16 v[112:115],v[188:191],v[160:163],v[112:115]
s_cmp_eq_u32 s34,163840
s_cselect_b32 s34,0,s34
v_mfma_f32_16x16x32_bf16 v[116:119],v[188:191],v[164:167],v[116:119]
s_add_u32 s30,s30,128
s_and_b32 s30,s30,0x7ff
v_mfma_f32_16x16x32_bf16 v[120:123],v[188:191],v[168:171],v[120:123]
buffer_load_ushort v242,v25,s[56:59],s45 offen offset:1024
buffer_load_ushort a42,v25,s[56:59],s45 offen offset:1088
v_mfma_f32_16x16x32_bf16 v[124:127],v[188:191],v[172:175],v[124:127]
buffer_load_ushort v243,v25,s[56:59],s45 offen offset:1152
s_waitcnt lgkmcnt(4)
v_mfma_f32_16x16x32_bf16 v[64:67],v[144:147],v[128:131],v[64:67]
v_add_u32 v13,s42,v13
ds_read_b128 v[160:163],v13 offset:0
v_mfma_f32_16x16x32_bf16 v[68:71],v[144:147],v[132:135],v[68:71]
ds_read_b64_tr_b16 v[176:177],v14 offset:4096
s_add_u32 m0,s35,s41
v_mfma_f32_16x16x32_bf16 v[72:75],v[144:147],v[136:139],v[72:75]
ds_read_b64_tr_b16 v[178:179],v14 offset:4608
buffer_load_dwordx4 v8,s[12:15],s32 offen lds
v_mfma_f32_16x16x32_bf16 v[76:79],v[144:147],v[140:143],v[76:79]
ds_read_b128 v[164:167],v13 offset:2048
buffer_load_dwordx4 v9,s[12:15],s32 offen offset:1024 lds
v_mfma_f32_16x16x32_bf16 v[80:83],v[148:151],v[128:131],v[80:83]
ds_read_b128 v[168:171],v13 offset:4096
s_add_u32 m0,s35,s43
v_mfma_f32_16x16x32_bf16 v[84:87],v[148:151],v[132:135],v[84:87]
buffer_load_dwordx4 v8,s[12:15],s33 offen lds
v_mfma_f32_16x16x32_bf16 v[88:91],v[148:151],v[136:139],v[88:91]
ds_read_b128 v[172:175],v13 offset:6144
v_mfma_f32_16x16x32_bf16 v[92:95],v[148:151],v[140:143],v[92:95]
ds_read_b64_tr_b16 v[180:181],v15 offset:4096
buffer_load_dwordx4 v9,s[12:15],s33 offen offset:1024 lds
s_waitcnt lgkmcnt(7)
v_mfma_f32_16x16x32_bf16 v[96:99],v[152:155],v[128:131],v[96:99]
ds_read_b64_tr_b16 v[182:183],v15 offset:4608
s_add_u32 s35,s35,32768
v_mfma_f32_16x16x32_bf16 v[100:103],v[152:155],v[132:135],v[100:103]
ds_read_b64_tr_b16 v[184:185],v14 offset:12288
ds_read_b64_tr_b16 v[186:187],v14 offset:12800
v_mfma_f32_16x16x32_bf16 v[104:107],v[152:155],v[136:139],v[104:107]
ds_read_b64_tr_b16 v[188:189],v15 offset:12288
v_mfma_f32_16x16x32_bf16 v[108:111],v[152:155],v[140:143],v[108:111]
ds_read_b64_tr_b16 v[190:191],v15 offset:12800
v_mfma_f32_16x16x32_bf16 v[112:115],v[156:159],v[128:131],v[112:115]
s_cmp_eq_u32 s35,163840
s_cselect_b32 s35,0,s35
v_mfma_f32_16x16x32_bf16 v[116:119],v[156:159],v[132:135],v[116:119]
s_add_u32 s32,s32,393216
v_mfma_f32_16x16x32_bf16 v[120:123],v[156:159],v[136:139],v[120:123]
s_cmp_eq_u32 s32,6293504
s_cselect_b32 s32,2048,s32
v_mfma_f32_16x16x32_bf16 v[124:127],v[156:159],v[140:143],v[124:127]
s_add_u32 s33,s32,2048
buffer_load_ushort a43,v25,s[56:59],s45 offen offset:1216
buffer_load_ushort v244,v25,s[56:59],s45 offen offset:32
buffer_load_ushort a44,v25,s[56:59],s45 offen offset:96
s_waitcnt lgkmcnt(4)
v_mfma_f32_16x16x32_bf16 v[64:67],v[176:179],v[160:163],v[64:67]
s_add_u32 s36,s36,32768
v_mfma_f32_16x16x32_bf16 v[68:71],v[176:179],v[164:167],v[68:71]
v_mfma_f32_16x16x32_bf16 v[72:75],v[176:179],v[168:171],v[72:75]
s_cmp_eq_u32 s36,163840
s_cselect_b32 s42,s51,s50
s_cselect_b32 s36,0,s36
v_add_u32 v12,s42,v12
v_add_u32 v14,s42,v14
v_add_u32 v15,s42,v15
s_waitcnt vmcnt(36)
s_waitcnt lgkmcnt(0)
s_barrier
ds_read_b128 a[68:71],v12 offset:0
v_mfma_f32_16x16x32_bf16 v[76:79],v[176:179],v[172:175],v[76:79]
ds_read_b64_tr_b16 v[144:145],v14 offset:0
ds_read_b64_tr_b16 v[146:147],v14 offset:512
v_mfma_f32_16x16x32_bf16 v[80:83],v[180:183],v[160:163],v[80:83]
ds_read_b128 a[72:75],v12 offset:2048
s_add_u32 m0,s34,s40
v_mfma_f32_16x16x32_bf16 v[84:87],v[180:183],v[164:167],v[84:87]
ds_read_b128 a[76:79],v12 offset:4096
buffer_load_dwordx4 v4,s[8:11],s30 offen lds
v_mfma_f32_16x16x32_bf16 v[88:91],v[180:183],v[168:171],v[88:91]
buffer_load_dwordx4 v5,s[8:11],s30 offen offset:1024 lds
v_mfma_f32_16x16x32_bf16 v[92:95],v[180:183],v[172:175],v[92:95]
ds_read_b128 a[80:83],v12 offset:6144
buffer_load_dwordx4 v6,s[8:11],s30 offen offset:2048 lds
v_mfma_f32_16x16x32_bf16 v[96:99],v[184:187],v[160:163],v[96:99]
ds_read_b64_tr_b16 v[148:149],v15 offset:0
ds_read_b64_tr_b16 v[150:151],v15 offset:512
v_mfma_f32_16x16x32_bf16 v[100:103],v[184:187],v[164:167],v[100:103]
ds_read_b64_tr_b16 v[152:153],v14 offset:8192
buffer_load_dwordx4 v7,s[8:11],s30 offen offset:3072 lds
v_mfma_f32_16x16x32_bf16 v[104:107],v[184:187],v[168:171],v[104:107]
ds_read_b64_tr_b16 v[154:155],v14 offset:8704
ds_read_b64_tr_b16 v[156:157],v15 offset:8192
v_mfma_f32_16x16x32_bf16 v[108:111],v[184:187],v[172:175],v[108:111]
ds_read_b64_tr_b16 v[158:159],v15 offset:8704
s_add_u32 s34,s34,32768
v_mfma_f32_16x16x32_bf16 v[112:115],v[188:191],v[160:163],v[112:115]
s_cmp_eq_u32 s34,163840
s_cselect_b32 s34,0,s34
v_mfma_f32_16x16x32_bf16 v[116:119],v[188:191],v[164:167],v[116:119]
s_add_u32 s30,s30,128
s_and_b32 s30,s30,0x7ff
v_mfma_f32_16x16x32_bf16 v[120:123],v[188:191],v[168:171],v[120:123]
buffer_load_ushort v245,v25,s[56:59],s45 offen offset:160
buffer_load_ushort a45,v25,s[56:59],s45 offen offset:224
v_mfma_f32_16x16x32_bf16 v[124:127],v[188:191],v[172:175],v[124:127]
buffer_load_ushort v246,v25,s[56:59],s45 offen offset:1056
s_waitcnt lgkmcnt(4)
v_mfma_f32_16x16x32_bf16 v[64:67],v[144:147],a[68:71],v[64:67]
v_add_u32 v13,s42,v13
ds_read_b128 a[84:87],v13 offset:0
v_mfma_f32_16x16x32_bf16 v[68:71],v[144:147],a[72:75],v[68:71]
ds_read_b64_tr_b16 v[176:177],v14 offset:4096
s_add_u32 m0,s35,s41
v_mfma_f32_16x16x32_bf16 v[72:75],v[144:147],a[76:79],v[72:75]
ds_read_b64_tr_b16 v[178:179],v14 offset:4608
buffer_load_dwordx4 v8,s[12:15],s32 offen lds
v_mfma_f32_16x16x32_bf16 v[76:79],v[144:147],a[80:83],v[76:79]
ds_read_b128 a[88:91],v13 offset:2048
buffer_load_dwordx4 v9,s[12:15],s32 offen offset:1024 lds
v_mfma_f32_16x16x32_bf16 v[80:83],v[148:151],a[68:71],v[80:83]
ds_read_b128 a[92:95],v13 offset:4096
s_add_u32 m0,s35,s43
v_mfma_f32_16x16x32_bf16 v[84:87],v[148:151],a[72:75],v[84:87]
buffer_load_dwordx4 v8,s[12:15],s33 offen lds
v_mfma_f32_16x16x32_bf16 v[88:91],v[148:151],a[76:79],v[88:91]
ds_read_b128 a[96:99],v13 offset:6144
v_mfma_f32_16x16x32_bf16 v[92:95],v[148:151],a[80:83],v[92:95]
ds_read_b64_tr_b16 v[180:181],v15 offset:4096
buffer_load_dwordx4 v9,s[12:15],s33 offen offset:1024 lds
s_waitcnt lgkmcnt(7)
v_mfma_f32_16x16x32_bf16 v[96:99],v[152:155],a[68:71],v[96:99]
ds_read_b64_tr_b16 v[182:183],v15 offset:4608
s_add_u32 s35,s35,32768
v_mfma_f32_16x16x32_bf16 v[100:103],v[152:155],a[72:75],v[100:103]
ds_read_b64_tr_b16 v[184:185],v14 offset:12288
ds_read_b64_tr_b16 v[186:187],v14 offset:12800
v_mfma_f32_16x16x32_bf16 v[104:107],v[152:155],a[76:79],v[104:107]
ds_read_b64_tr_b16 v[188:189],v15 offset:12288
v_mfma_f32_16x16x32_bf16 v[108:111],v[152:155],a[80:83],v[108:111]
ds_read_b64_tr_b16 v[190:191],v15 offset:12800
v_mfma_f32_16x16x32_bf16 v[112:115],v[156:159],a[68:71],v[112:115]
s_cmp_eq_u32 s35,163840
s_cselect_b32 s35,0,s35
v_mfma_f32_16x16x32_bf16 v[116:119],v[156:159],a[72:75],v[116:119]
s_add_u32 s32,s32,393216
v_mfma_f32_16x16x32_bf16 v[120:123],v[156:159],a[76:79],v[120:123]
s_cmp_eq_u32 s32,6293504
s_cselect_b32 s32,2048,s32
v_mfma_f32_16x16x32_bf16 v[124:127],v[156:159],a[80:83],v[124:127]
s_add_u32 s33,s32,2048
buffer_load_ushort a46,v25,s[56:59],s45 offen offset:1120
buffer_load_ushort v247,v25,s[56:59],s45 offen offset:1184
buffer_load_ushort a47,v25,s[56:59],s45 offen offset:1248
s_waitcnt lgkmcnt(4)
v_mfma_f32_16x16x32_bf16 v[64:67],v[176:179],a[84:87],v[64:67]
s_add_u32 s36,s36,32768
v_mfma_f32_16x16x32_bf16 v[68:71],v[176:179],a[88:91],v[68:71]
v_mfma_f32_16x16x32_bf16 v[72:75],v[176:179],a[92:95],v[72:75]
s_cmp_eq_u32 s36,163840
s_cselect_b32 s42,s51,s50
s_cselect_b32 s36,0,s36
v_add_u32 v12,s42,v12
v_add_u32 v14,s42,v14
v_add_u32 v15,s42,v15
s_waitcnt vmcnt(36)
s_waitcnt lgkmcnt(0)
s_barrier
s_mov_b32 s39,131072
Lspl18:
v_cmp_ne_u32 s[90:91],s94,v26
s_nop 1
s_cmp_eq_u64 s[90:91],0
s_cbranch_scc1 Lsok17
s_sleep 1
buffer_load_dword v26,v28,s[24:27],s49 offen sc1
s_waitcnt vmcnt(0)
s_sub_u32 s39,s39,1
s_cmp_lg_u32 s39,0
s_cbranch_scc1 Lspl18
Lsok17:
s_mov_b32 s39,131072
Lspl20:
v_cmp_ne_u32 s[90:91],s94,v27
s_nop 1
s_cmp_eq_u64 s[90:91],0
s_cbranch_scc1 Lsok19
s_sleep 1
buffer_load_dword v27,v28,s[24:27],s52 offen sc1
s_waitcnt vmcnt(0)
s_sub_u32 s39,s39,1
s_cmp_lg_u32 s39,0
s_cbranch_scc1 Lspl20
Lsok19:
ds_read_b128 a[100:103],v12 offset:0
v_mfma_f32_16x16x32_bf16 v[76:79],v[176:179],a[96:99],v[76:79]
ds_read_b64_tr_b16 v[144:145],v14 offset:0
ds_read_b64_tr_b16 v[146:147],v14 offset:512
v_mfma_f32_16x16x32_bf16 v[80:83],v[180:183],a[84:87],v[80:83]
ds_read_b128 a[104:107],v12 offset:2048
buffer_load_dwordx4 a[8:11],v24,s[24:27],s63 offen sc1
v_mfma_f32_16x16x32_bf16 v[84:87],v[180:183],a[88:91],v[84:87]
ds_read_b128 a[108:111],v12 offset:4096
buffer_load_dwordx4 a[12:15],v24,s[24:27],s63 offen offset:256 sc1
v_mfma_f32_16x16x32_bf16 v[88:91],v[180:183],a[92:95],v[88:91]
v_mfma_f32_16x16x32_bf16 v[92:95],v[180:183],a[96:99],v[92:95]
ds_read_b128 a[112:115],v12 offset:6144
buffer_load_dwordx4 a[16:19],v24,s[24:27],s55 offen sc1
v_mfma_f32_16x16x32_bf16 v[96:99],v[184:187],a[84:87],v[96:99]
ds_read_b64_tr_b16 v[148:149],v15 offset:0
ds_read_b64_tr_b16 v[150:151],v15 offset:512
v_mfma_f32_16x16x32_bf16 v[100:103],v[184:187],a[88:91],v[100:103]
ds_read_b64_tr_b16 v[152:153],v14 offset:8192
buffer_load_dwordx4 a[20:23],v24,s[24:27],s55 offen offset:256 sc1
v_mfma_f32_16x16x32_bf16 v[104:107],v[184:187],a[92:95],v[104:107]
ds_read_b64_tr_b16 v[154:155],v14 offset:8704
ds_read_b64_tr_b16 v[156:157],v15 offset:8192
v_mfma_f32_16x16x32_bf16 v[108:111],v[184:187],a[96:99],v[108:111]
ds_read_b64_tr_b16 v[158:159],v15 offset:8704
buffer_load_dwordx4 v[208:211],v23,s[24:27],s60 offen sc1
v_mfma_f32_16x16x32_bf16 v[112:115],v[188:191],a[84:87],v[112:115]
buffer_load_dwordx4 v[212:215],v23,s[24:27],s60 offen offset:256 sc1
v_mfma_f32_16x16x32_bf16 v[116:119],v[188:191],a[88:91],v[116:119]
buffer_load_dwordx4 v[216:219],v23,s[24:27],s60 offen offset:512 sc1
v_mfma_f32_16x16x32_bf16 v[120:123],v[188:191],a[92:95],v[120:123]
v_mfma_f32_16x16x32_bf16 v[124:127],v[188:191],a[96:99],v[124:127]
s_waitcnt lgkmcnt(4)
v_mfma_f32_16x16x32_bf16 v[64:67],v[144:147],a[100:103],v[64:67]
v_add_u32 v13,s42,v13
ds_read_b128 a[116:119],v13 offset:0
v_mfma_f32_16x16x32_bf16 v[68:71],v[144:147],a[104:107],v[68:71]
ds_read_b64_tr_b16 v[176:177],v14 offset:4096
v_mfma_f32_16x16x32_bf16 v[72:75],v[144:147],a[108:111],v[72:75]
ds_read_b64_tr_b16 v[178:179],v14 offset:4608
buffer_load_dwordx4 v[220:223],v23,s[24:27],s60 offen offset:768 sc1
v_mfma_f32_16x16x32_bf16 v[76:79],v[144:147],a[112:115],v[76:79]
ds_read_b128 a[120:123],v13 offset:2048
v_mfma_f32_16x16x32_bf16 v[80:83],v[148:151],a[100:103],v[80:83]
ds_read_b128 a[124:127],v13 offset:4096
buffer_load_dwordx4 v[224:227],v23,s[24:27],s60 offen offset:1024 sc1
v_mfma_f32_16x16x32_bf16 v[84:87],v[148:151],a[104:107],v[84:87]
v_mfma_f32_16x16x32_bf16 v[88:91],v[148:151],a[108:111],v[88:91]
ds_read_b128 a[128:131],v13 offset:6144
v_mfma_f32_16x16x32_bf16 v[92:95],v[148:151],a[112:115],v[92:95]
ds_read_b64_tr_b16 v[180:181],v15 offset:4096
buffer_load_dwordx4 v[228:231],v23,s[24:27],s60 offen offset:1280 sc1
s_waitcnt lgkmcnt(7)
v_mfma_f32_16x16x32_bf16 v[96:99],v[152:155],a[100:103],v[96:99]
ds_read_b64_tr_b16 v[182:183],v15 offset:4608
v_mfma_f32_16x16x32_bf16 v[100:103],v[152:155],a[104:107],v[100:103]
ds_read_b64_tr_b16 v[184:185],v14 offset:12288
ds_read_b64_tr_b16 v[186:187],v14 offset:12800
v_mfma_f32_16x16x32_bf16 v[104:107],v[152:155],a[108:111],v[104:107]
ds_read_b64_tr_b16 v[188:189],v15 offset:12288
buffer_load_dwordx4 v[232:235],v23,s[24:27],s60 offen offset:1536 sc1
v_mfma_f32_16x16x32_bf16 v[108:111],v[152:155],a[112:115],v[108:111]
ds_read_b64_tr_b16 v[190:191],v15 offset:12800
v_mfma_f32_16x16x32_bf16 v[112:115],v[156:159],a[100:103],v[112:115]
buffer_load_dwordx4 v[236:239],v23,s[24:27],s60 offen offset:1792 sc1
v_mfma_f32_16x16x32_bf16 v[116:119],v[156:159],a[104:107],v[116:119]
v_mfma_f32_16x16x32_bf16 v[120:123],v[156:159],a[108:111],v[120:123]
v_mfma_f32_16x16x32_bf16 v[124:127],v[156:159],a[112:115],v[124:127]
s_waitcnt lgkmcnt(4)
v_mfma_f32_16x16x32_bf16 v[64:67],v[176:179],a[116:119],v[64:67]
s_add_u32 s36,s36,32768
v_mfma_f32_16x16x32_bf16 v[68:71],v[176:179],a[120:123],v[68:71]
v_mfma_f32_16x16x32_bf16 v[72:75],v[176:179],a[124:127],v[72:75]
s_cmp_eq_u32 s36,163840
s_cselect_b32 s42,s51,s50
s_cselect_b32 s36,0,s36
v_add_u32 v12,s42,v12
v_add_u32 v14,s42,v14
v_add_u32 v15,s42,v15
s_waitcnt vmcnt(43)
s_waitcnt lgkmcnt(0)
s_barrier
ds_read_b128 a[132:135],v12 offset:0
v_mfma_f32_16x16x32_bf16 v[76:79],v[176:179],a[128:131],v[76:79]
ds_read_b64_tr_b16 v[144:145],v14 offset:0
ds_read_b64_tr_b16 v[146:147],v14 offset:512
v_mfma_f32_16x16x32_bf16 v[80:83],v[180:183],a[116:119],v[80:83]
ds_read_b128 a[136:139],v12 offset:2048
v_mfma_f32_16x16x32_bf16 v[84:87],v[180:183],a[120:123],v[84:87]
ds_read_b128 a[140:143],v12 offset:4096
v_mfma_f32_16x16x32_bf16 v[88:91],v[180:183],a[124:127],v[88:91]
v_mfma_f32_16x16x32_bf16 v[92:95],v[180:183],a[128:131],v[92:95]
ds_read_b128 a[144:147],v12 offset:6144
v_mfma_f32_16x16x32_bf16 v[96:99],v[184:187],a[116:119],v[96:99]
ds_read_b64_tr_b16 v[148:149],v15 offset:0
ds_read_b64_tr_b16 v[150:151],v15 offset:512
v_mfma_f32_16x16x32_bf16 v[100:103],v[184:187],a[120:123],v[100:103]
ds_read_b64_tr_b16 v[152:153],v14 offset:8192
v_mfma_f32_16x16x32_bf16 v[104:107],v[184:187],a[124:127],v[104:107]
ds_read_b64_tr_b16 v[154:155],v14 offset:8704
ds_read_b64_tr_b16 v[156:157],v15 offset:8192
v_mfma_f32_16x16x32_bf16 v[108:111],v[184:187],a[128:131],v[108:111]
ds_read_b64_tr_b16 v[158:159],v15 offset:8704
v_mfma_f32_16x16x32_bf16 v[112:115],v[188:191],a[116:119],v[112:115]
v_mfma_f32_16x16x32_bf16 v[116:119],v[188:191],a[120:123],v[116:119]
v_mfma_f32_16x16x32_bf16 v[120:123],v[188:191],a[124:127],v[120:123]
v_mfma_f32_16x16x32_bf16 v[124:127],v[188:191],a[128:131],v[124:127]
s_waitcnt lgkmcnt(4)
v_mfma_f32_16x16x32_bf16 v[64:67],v[144:147],a[132:135],v[64:67]
v_add_u32 v13,s42,v13
ds_read_b128 a[148:151],v13 offset:0
v_mfma_f32_16x16x32_bf16 v[68:71],v[144:147],a[136:139],v[68:71]
ds_read_b64_tr_b16 v[176:177],v14 offset:4096
v_mfma_f32_16x16x32_bf16 v[72:75],v[144:147],a[140:143],v[72:75]
ds_read_b64_tr_b16 v[178:179],v14 offset:4608
v_mfma_f32_16x16x32_bf16 v[76:79],v[144:147],a[144:147],v[76:79]
ds_read_b128 a[152:155],v13 offset:2048
v_mfma_f32_16x16x32_bf16 v[80:83],v[148:151],a[132:135],v[80:83]
ds_read_b128 a[156:159],v13 offset:4096
v_mfma_f32_16x16x32_bf16 v[84:87],v[148:151],a[136:139],v[84:87]
v_mfma_f32_16x16x32_bf16 v[88:91],v[148:151],a[140:143],v[88:91]
ds_read_b128 a[160:163],v13 offset:6144
v_mfma_f32_16x16x32_bf16 v[92:95],v[148:151],a[144:147],v[92:95]
ds_read_b64_tr_b16 v[180:181],v15 offset:4096
s_waitcnt lgkmcnt(7)
v_mfma_f32_16x16x32_bf16 v[96:99],v[152:155],a[132:135],v[96:99]
ds_read_b64_tr_b16 v[182:183],v15 offset:4608
v_mfma_f32_16x16x32_bf16 v[100:103],v[152:155],a[136:139],v[100:103]
ds_read_b64_tr_b16 v[184:185],v14 offset:12288
ds_read_b64_tr_b16 v[186:187],v14 offset:12800
v_mfma_f32_16x16x32_bf16 v[104:107],v[152:155],a[140:143],v[104:107]
ds_read_b64_tr_b16 v[188:189],v15 offset:12288
v_mfma_f32_16x16x32_bf16 v[108:111],v[152:155],a[144:147],v[108:111]
ds_read_b64_tr_b16 v[190:191],v15 offset:12800
v_mfma_f32_16x16x32_bf16 v[112:115],v[156:159],a[132:135],v[112:115]
v_mfma_f32_16x16x32_bf16 v[116:119],v[156:159],a[136:139],v[116:119]
v_mfma_f32_16x16x32_bf16 v[120:123],v[156:159],a[140:143],v[120:123]
v_mfma_f32_16x16x32_bf16 v[124:127],v[156:159],a[144:147],v[124:127]
s_waitcnt lgkmcnt(4)
v_mfma_f32_16x16x32_bf16 v[64:67],v[176:179],a[148:151],v[64:67]
s_add_u32 s36,s36,32768
v_mfma_f32_16x16x32_bf16 v[68:71],v[176:179],a[152:155],v[68:71]
v_mfma_f32_16x16x32_bf16 v[72:75],v[176:179],a[156:159],v[72:75]
s_cmp_eq_u32 s36,163840
s_cselect_b32 s42,s51,s50
s_cselect_b32 s36,0,s36
v_add_u32 v12,s42,v12
v_add_u32 v14,s42,v14
v_add_u32 v15,s42,v15
s_waitcnt vmcnt(0)
s_waitcnt lgkmcnt(0)
s_barrier
ds_read_b128 a[164:167],v12 offset:0
v_mfma_f32_16x16x32_bf16 v[76:79],v[176:179],a[160:163],v[76:79]
ds_read_b64_tr_b16 v[144:145],v14 offset:0
ds_read_b64_tr_b16 v[146:147],v14 offset:512
v_accvgpr_read_b32 v26,a40
v_lshl_or_b32 v240,v26,16,v240
v_mfma_f32_16x16x32_bf16 v[80:83],v[180:183],a[148:151],v[80:83]
ds_read_b128 a[168:171],v12 offset:2048
s_add_u32 s31,s95,11
v_accvgpr_read_b32 v26,a41
v_lshl_or_b32 v241,v26,16,v241
v_mfma_f32_16x16x32_bf16 v[84:87],v[180:183],a[152:155],v[84:87]
ds_read_b128 a[172:175],v12 offset:4096
s_and_b32 s31,s31,15
v_accvgpr_read_b32 v26,a42
v_lshl_or_b32 v242,v26,16,v242
v_mfma_f32_16x16x32_bf16 v[88:91],v[180:183],a[156:159],v[88:91]
s_mul_i32 s31,s31,393216
s_lshl_b32 s53,s20,11
v_accvgpr_read_b32 v26,a43
v_lshl_or_b32 v243,v26,16,v243
v_mfma_f32_16x16x32_bf16 v[92:95],v[180:183],a[160:163],v[92:95]
ds_read_b128 a[176:179],v12 offset:6144
s_add_u32 s53,s53,32768
v_accvgpr_read_b32 v26,a44
v_lshl_or_b32 v244,v26,16,v244
v_mfma_f32_16x16x32_bf16 v[96:99],v[184:187],a[148:151],v[96:99]
ds_read_b64_tr_b16 v[148:149],v15 offset:0
ds_read_b64_tr_b16 v[150:151],v15 offset:512
v_accvgpr_read_b32 v26,a45
v_lshl_or_b32 v245,v26,16,v245
v_mfma_f32_16x16x32_bf16 v[100:103],v[184:187],a[152:155],v[100:103]
ds_read_b64_tr_b16 v[152:153],v14 offset:8192
s_add_u32 m0,s53,0
v_accvgpr_read_b32 v26,a46
v_lshl_or_b32 v246,v26,16,v246
v_mfma_f32_16x16x32_bf16 v[104:107],v[184:187],a[156:159],v[104:107]
ds_read_b64_tr_b16 v[154:155],v14 offset:8704
ds_read_b64_tr_b16 v[156:157],v15 offset:8192
v_accvgpr_read_b32 v26,a47
v_lshl_or_b32 v247,v26,16,v247
v_mfma_f32_16x16x32_bf16 v[108:111],v[184:187],a[160:163],v[108:111]
ds_read_b64_tr_b16 v[158:159],v15 offset:8704
buffer_load_dwordx4 v8,s[12:15],s31 offen lds
v_add_f32 v208,v208,v224
v_add_f32 v209,v209,v225
v_mfma_f32_16x16x32_bf16 v[112:115],v[188:191],a[148:151],v[112:115]
buffer_load_dwordx4 v9,s[12:15],s31 offen offset:1024 lds
s_add_u32 s31,s31,393216
v_add_f32 v210,v210,v226
v_mfma_f32_16x16x32_bf16 v[116:119],v[188:191],a[152:155],v[116:119]
s_cmp_eq_u32 s31,6291456
s_cselect_b32 s31,0,s31
v_mfma_f32_16x16x32_bf16 v[120:123],v[188:191],a[156:159],v[120:123]
s_add_u32 m0,s53,8192
s_nop 0
buffer_load_dwordx4 v8,s[12:15],s31 offen lds
v_mfma_f32_16x16x32_bf16 v[124:127],v[188:191],a[160:163],v[124:127]
buffer_load_dwordx4 v9,s[12:15],s31 offen offset:1024 lds
s_add_u32 s31,s31,393216
s_cmp_eq_u32 s31,6291456
s_cselect_b32 s31,0,s31
v_mov_b32 v252,-1
v_mov_b32 v253,-1
v_mov_b32 v254,-1
v_mov_b32 v255,-1
v_lshlrev_b32 v29,4,v2
buffer_store_dwordx2 v[252:253],v29,s[24:27],s44 offen sc1
s_waitcnt lgkmcnt(4)
v_mfma_f32_16x16x32_bf16 v[64:67],v[144:147],a[164:167],v[64:67]
v_add_u32 v13,s42,v13
ds_read_b128 a[180:183],v13 offset:0
v_mfma_f32_16x16x32_bf16 v[68:71],v[144:147],a[168:171],v[68:71]
ds_read_b64_tr_b16 v[176:177],v14 offset:4096
s_add_u32 m0,s53,16384
v_add_f32 v211,v211,v227
v_mfma_f32_16x16x32_bf16 v[72:75],v[144:147],a[172:175],v[72:75]
ds_read_b64_tr_b16 v[178:179],v14 offset:4608
buffer_load_dwordx4 v8,s[12:15],s31 offen lds
v_add_f32 v212,v212,v228
v_mfma_f32_16x16x32_bf16 v[76:79],v[144:147],a[176:179],v[76:79]
ds_read_b128 a[184:187],v13 offset:2048
v_add_f32 v213,v213,v229
v_add_f32 v214,v214,v230
v_mfma_f32_16x16x32_bf16 v[80:83],v[148:151],a[164:167],v[80:83]
ds_read_b128 a[188:191],v13 offset:4096
v_add_f32 v215,v215,v231
v_add_f32 v216,v216,v232
v_mfma_f32_16x16x32_bf16 v[84:87],v[148:151],a[168:171],v[84:87]
buffer_load_dwordx4 v9,s[12:15],s31 offen offset:1024 lds
s_add_u32 s31,s31,393216
v_add_f32 v217,v217,v233
v_mfma_f32_16x16x32_bf16 v[88:91],v[148:151],a[172:175],v[88:91]
ds_read_b128 a[192:195],v13 offset:6144
v_add_f32 v218,v218,v234
v_add_f32 v219,v219,v235
v_mfma_f32_16x16x32_bf16 v[92:95],v[148:151],a[176:179],v[92:95]
ds_read_b64_tr_b16 v[180:181],v15 offset:4096
v_add_f32 v220,v220,v236
v_add_f32 v221,v221,v237
s_waitcnt lgkmcnt(7)
v_mfma_f32_16x16x32_bf16 v[96:99],v[152:155],a[164:167],v[96:99]
ds_read_b64_tr_b16 v[182:183],v15 offset:4608
v_add_f32 v222,v222,v238
v_add_f32 v223,v223,v239
v_mfma_f32_16x16x32_bf16 v[100:103],v[152:155],a[168:171],v[100:103]
ds_read_b64_tr_b16 v[184:185],v14 offset:12288
ds_read_b64_tr_b16 v[186:187],v14 offset:12800
v_add_f32 v208,v208,v216
v_mfma_f32_16x16x32_bf16 v[104:107],v[152:155],a[172:175],v[104:107]
ds_read_b64_tr_b16 v[188:189],v15 offset:12288
v_add_f32 v209,v209,v217
v_add_f32 v210,v210,v218
v_mfma_f32_16x16x32_bf16 v[108:111],v[152:155],a[176:179],v[108:111]
ds_read_b64_tr_b16 v[190:191],v15 offset:12800
v_add_f32 v211,v211,v219
v_add_f32 v212,v212,v220
v_mfma_f32_16x16x32_bf16 v[112:115],v[156:159],a[164:167],v[112:115]
s_cmp_eq_u32 s31,6291456
s_cselect_b32 s31,0,s31
v_add_f32 v213,v213,v221
v_mfma_f32_16x16x32_bf16 v[116:119],v[156:159],a[168:171],v[116:119]
s_add_u32 m0,s53,24576
s_nop 0
buffer_load_dwordx4 v8,s[12:15],s31 offen lds
v_mfma_f32_16x16x32_bf16 v[120:123],v[156:159],a[172:175],v[120:123]
buffer_load_dwordx4 v9,s[12:15],s31 offen offset:1024 lds
s_add_u32 s31,s31,393216
v_mfma_f32_16x16x32_bf16 v[124:127],v[156:159],a[176:179],v[124:127]
s_cmp_eq_u32 s31,6291456
s_cselect_b32 s31,0,s31
s_waitcnt lgkmcnt(4)
v_mfma_f32_16x16x32_bf16 v[64:67],v[176:179],a[180:183],v[64:67]
s_add_u32 s36,s36,32768
v_mfma_f32_16x16x32_bf16 v[68:71],v[176:179],a[184:187],v[68:71]
v_mfma_f32_16x16x32_bf16 v[72:75],v[176:179],a[188:191],v[72:75]
s_cmp_eq_u32 s36,163840
s_cselect_b32 s42,s51,s50
s_cselect_b32 s36,0,s36
v_add_u32 v12,s42,v12
v_add_u32 v14,s42,v14
v_add_u32 v15,s42,v15
s_waitcnt vmcnt(9)
s_waitcnt lgkmcnt(0)
s_barrier
ds_read_b128 a[196:199],v12 offset:0
v_mfma_f32_16x16x32_bf16 v[76:79],v[176:179],a[192:195],v[76:79]
ds_read_b64_tr_b16 v[144:145],v14 offset:0
ds_read_b64_tr_b16 v[146:147],v14 offset:512
v_add_f32 v214,v214,v222
v_mfma_f32_16x16x32_bf16 v[80:83],v[180:183],a[180:183],v[80:83]
ds_read_b128 a[200:203],v12 offset:2048
s_add_u32 m0,s53,32768
v_add_f32 v215,v215,v223
v_mfma_f32_16x16x32_bf16 v[84:87],v[180:183],a[184:187],v[84:87]
ds_read_b128 a[204:207],v12 offset:4096
buffer_load_dwordx4 v8,s[12:15],s31 offen lds
v_add_f32 v208,v208,v212
v_mfma_f32_16x16x32_bf16 v[88:91],v[180:183],a[188:191],v[88:91]
v_add_f32 v209,v209,v213
v_add_f32 v210,v210,v214
v_add_f32 v211,v211,v215
v_mfma_f32_16x16x32_bf16 v[92:95],v[180:183],a[192:195],v[92:95]
ds_read_b128 a[208:211],v12 offset:6144
v_add_f32 v208,v208,v210
v_add_f32 v209,v209,v211
v_mfma_f32_16x16x32_bf16 v[96:99],v[184:187],a[180:183],v[96:99]
ds_read_b64_tr_b16 v[148:149],v15 offset:0
ds_read_b64_tr_b16 v[150:151],v15 offset:512
v_mul_f32 v208,s46,v208
v_mfma_f32_16x16x32_bf16 v[100:103],v[184:187],a[184:187],v[100:103]
ds_read_b64_tr_b16 v[152:153],v14 offset:8192
buffer_load_dwordx4 v9,s[12:15],s31 offen offset:1024 lds
v_mul_f32 v209,s46,v209
v_mfma_f32_16x16x32_bf16 v[104:107],v[184:187],a[188:191],v[104:107]
ds_read_b64_tr_b16 v[154:155],v14 offset:8704
ds_read_b64_tr_b16 v[156:157],v15 offset:8192
v_fma_f32 v209,-v208,v208,v209
v_mfma_f32_16x16x32_bf16 v[108:111],v[184:187],a[192:195],v[108:111]
ds_read_b64_tr_b16 v[158:159],v15 offset:8704
s_add_u32 s31,s31,393216
v_max_f32 v209,0,v209
v_mfma_f32_16x16x32_bf16 v[112:115],v[188:191],a[180:183],v[112:115]
s_cmp_eq_u32 s31,6291456
s_cselect_b32 s31,0,s31
v_cvt_pk_bf16_f32 v210,v209,v209
v_mfma_f32_16x16x32_bf16 v[116:119],v[188:191],a[184:187],v[116:119]
v_cvt_pk_bf16_f32 v216,-v208,-v208
v_and_b32 v210,0xffff0000,v210
v_add_f32 v210,s47,v210
v_mfma_f32_16x16x32_bf16 v[120:123],v[188:191],a[188:191],v[120:123]
v_cvt_pk_bf16_f32 v210,v210,v210
v_mov_b32 v217,v216
v_mfma_f32_16x16x32_bf16 v[124:127],v[188:191],a[192:195],v[124:127]
s_waitcnt lgkmcnt(4)
v_mfma_f32_16x16x32_bf16 v[64:67],v[144:147],a[196:199],v[64:67]
v_add_u32 v13,s42,v13
ds_read_b128 a[212:215],v13 offset:0
v_mfma_f32_16x16x32_bf16 v[68:71],v[144:147],a[200:203],v[68:71]
ds_read_b64_tr_b16 v[176:177],v14 offset:4096
v_and_b32 v210,0xffff0000,v210
v_mfma_f32_16x16x32_bf16 v[72:75],v[144:147],a[204:207],v[72:75]
ds_read_b64_tr_b16 v[178:179],v14 offset:4608
v_sqrt_f32 v210,v210
v_mfma_f32_16x16x32_bf16 v[76:79],v[144:147],a[208:211],v[76:79]
ds_read_b128 a[216:219],v13 offset:2048
v_permlane16_swap_b32 v216,v217
v_mfma_f32_16x16x32_bf16 v[80:83],v[148:151],a[196:199],v[80:83]
ds_read_b128 a[220:223],v13 offset:4096
v_cvt_pk_bf16_f32 v210,v210,v210
v_and_b32 v248,0xffff0000,v210
v_mfma_f32_16x16x32_bf16 v[84:87],v[148:151],a[200:203],v[84:87]
v_mov_b32 v218,v216
v_mov_b32 v219,v217
v_mov_b32 v249,v248
v_mfma_f32_16x16x32_bf16 v[88:91],v[148:151],a[204:207],v[88:91]
ds_read_b128 a[224:227],v13 offset:6144
v_permlane32_swap_b32 v216,v218
v_mfma_f32_16x16x32_bf16 v[92:95],v[148:151],a[208:211],v[92:95]
ds_read_b64_tr_b16 v[180:181],v15 offset:4096
v_permlane32_swap_b32 v217,v219
s_waitcnt lgkmcnt(7)
v_mfma_f32_16x16x32_bf16 v[96:99],v[152:155],a[196:199],v[96:99]
ds_read_b64_tr_b16 v[182:183],v15 offset:4608
v_permlane16_swap_b32 v248,v249
v_mfma_f32_16x16x32_bf16 v[100:103],v[152:155],a[200:203],v[100:103]
ds_read_b64_tr_b16 v[184:185],v14 offset:12288
ds_read_b64_tr_b16 v[186:187],v14 offset:12800
v_mov_b32 v250,v248
v_mfma_f32_16x16x32_bf16 v[104:107],v[152:155],a[204:207],v[104:107]
ds_read_b64_tr_b16 v[188:189],v15 offset:12288
v_mov_b32 v251,v249
s_nop 0
v_mfma_f32_16x16x32_bf16 v[108:111],v[152:155],a[208:211],v[108:111]
ds_read_b64_tr_b16 v[190:191],v15 offset:12800
v_permlane32_swap_b32 v248,v250
v_mfma_f32_16x16x32_bf16 v[112:115],v[156:159],a[196:199],v[112:115]
v_permlane32_swap_b32 v249,v251
v_mfma_f32_16x16x32_bf16 v[116:119],v[156:159],a[200:203],v[116:119]
v_rcp_f32 v248,v248
v_mfma_f32_16x16x32_bf16 v[120:123],v[156:159],a[204:207],v[120:123]
v_rcp_f32 v249,v249
v_mfma_f32_16x16x32_bf16 v[124:127],v[156:159],a[208:211],v[124:127]
s_waitcnt lgkmcnt(4)
v_mfma_f32_16x16x32_bf16 v[64:67],v[176:179],a[212:215],v[64:67]
v_mfma_f32_16x16x32_bf16 v[68:71],v[176:179],a[216:219],v[68:71]
v_mfma_f32_16x16x32_bf16 v[72:75],v[176:179],a[220:223],v[72:75]
v_mfma_f32_16x16x32_bf16 v[76:79],v[176:179],a[224:227],v[76:79]
v_rcp_f32 v250,v250
v_mfma_f32_16x16x32_bf16 v[80:83],v[180:183],a[212:215],v[80:83]
v_rcp_f32 v251,v251
v_mfma_f32_16x16x32_bf16 v[84:87],v[180:183],a[216:219],v[84:87]
v_accvgpr_write_b32 a24,v216
v_accvgpr_write_b32 a25,v216
v_mfma_f32_16x16x32_bf16 v[88:91],v[180:183],a[220:223],v[88:91]
v_accvgpr_write_b32 a26,v216
v_accvgpr_write_b32 a27,v216
v_mfma_f32_16x16x32_bf16 v[92:95],v[180:183],a[224:227],v[92:95]
v_accvgpr_write_b32 a28,v217
v_accvgpr_write_b32 a29,v217
s_waitcnt lgkmcnt(0)
v_mfma_f32_16x16x32_bf16 v[96:99],v[184:187],a[212:215],v[96:99]
v_accvgpr_write_b32 a30,v217
v_accvgpr_write_b32 a31,v217
v_mfma_f32_16x16x32_bf16 v[100:103],v[184:187],a[216:219],v[100:103]
v_accvgpr_write_b32 a32,v218
v_accvgpr_write_b32 a33,v218
v_mfma_f32_16x16x32_bf16 v[104:107],v[184:187],a[220:223],v[104:107]
v_accvgpr_write_b32 a34,v218
v_accvgpr_write_b32 a35,v218
v_mfma_f32_16x16x32_bf16 v[108:111],v[184:187],a[224:227],v[108:111]
v_accvgpr_write_b32 a36,v219
v_accvgpr_write_b32 a37,v219
v_mfma_f32_16x16x32_bf16 v[112:115],v[188:191],a[212:215],v[112:115]
v_accvgpr_write_b32 a38,v219
v_accvgpr_write_b32 a39,v219
v_mfma_f32_16x16x32_bf16 v[116:119],v[188:191],a[216:219],v[116:119]
v_mfma_f32_16x16x32_bf16 v[120:123],v[188:191],a[220:223],v[120:123]
v_mfma_f32_16x16x32_bf16 v[124:127],v[188:191],a[224:227],v[124:127]
v_mfma_f32_16x16x32_bf16 v[64:67],a[8:11],a[24:27],v[64:67]
v_mfma_f32_16x16x32_bf16 v[68:71],a[8:11],a[28:31],v[68:71]
v_mfma_f32_16x16x32_bf16 v[72:75],a[8:11],a[32:35],v[72:75]
v_mfma_f32_16x16x32_bf16 v[76:79],a[8:11],a[36:39],v[76:79]
v_mfma_f32_16x16x32_bf16 v[80:83],a[12:15],a[24:27],v[80:83]
v_mfma_f32_16x16x32_bf16 v[84:87],a[12:15],a[28:31],v[84:87]
v_mfma_f32_16x16x32_bf16 v[88:91],a[12:15],a[32:35],v[88:91]
v_mfma_f32_16x16x32_bf16 v[92:95],a[12:15],a[36:39],v[92:95]
v_mfma_f32_16x16x32_bf16 v[96:99],a[16:19],a[24:27],v[96:99]
v_mfma_f32_16x16x32_bf16 v[100:103],a[16:19],a[28:31],v[100:103]
v_mfma_f32_16x16x32_bf16 v[104:107],a[16:19],a[32:35],v[104:107]
v_mfma_f32_16x16x32_bf16 v[108:111],a[16:19],a[36:39],v[108:111]
v_mfma_f32_16x16x32_bf16 v[112:115],a[20:23],a[24:27],v[112:115]
v_mfma_f32_16x16x32_bf16 v[116:119],a[20:23],a[28:31],v[116:119]
v_mfma_f32_16x16x32_bf16 v[120:123],a[20:23],a[32:35],v[120:123]
v_mfma_f32_16x16x32_bf16 v[124:127],a[20:23],a[36:39],v[124:127]
s_waitcnt vmcnt(0)
s_barrier
s_mul_i32 s30,s95,128
s_mul_i32 s32,s95,393216
v_mov_b32 v23,v24
s_and_b32 s31,s84,1
s_mov_b32 s34,90112
s_mov_b32 s35,90112
s_mov_b32 s36,90112
s_mov_b32 s42,0
s_mov_b32 s50,24576
s_mov_b32 s51,0xfffe2000
s_lshl_b32 s18,s28,13
s_add_u32 s18,s18,90112
v_lshrrev_b32 v1,1,v30
v_lshlrev_b32 v3,7,v30
v_add_u32 v3,s18,v3
v_xor_b32 v12,v31,v1
v_xor_b32 v13,4,v12
v_lshl_add_u32 v12,v12,4,v3
v_lshl_add_u32 v13,v13,4,v3
s_mov_b32 s18,106496
s_lshl_b32 s19,s29,2
v_bfe_u32 v1,v2,2,2
v_lshl_add_u32 v3,v31,3,v1
v_lshlrev_b32 v3,7,v3
v_add_u32 v3,s18,v3
v_and_b32 v0,1,v2
v_lshl_add_u32 v3,v0,3,v3
v_and_b32 v1,2,v1
v_and_b32 v0,1,v31
v_lshl_add_u32 v1,v0,2,v1
v_bfe_u32 v0,v2,1,1
v_or_b32 v1,v1,v0
v_xor_b32 v1,s19,v1
v_xor_b32 v0,0,v1
v_lshl_add_u32 v14,v0,4,v3
v_xor_b32 v0,2,v1
v_lshl_add_u32 v15,v0,4,v3
s_mov_b32 s44,0x3fb8aa3b
s_mov_b32 s45,0x3fb8aa3b
v_mov_b32 v24,0x3f803f80
v_mov_b32 v25,0x3f803f80
v_mov_b32 v26,0x3f803f80
v_mov_b32 v27,0x3f803f80
v_pk_mul_f32 v[64:65],v[64:65],v[248:249] op_sel:[0,0] op_sel_hi:[1,0]
v_pk_mul_f32 v[66:67],v[66:67],v[248:249] op_sel:[0,0] op_sel_hi:[1,0]
v_pk_mul_f32 v[80:81],v[80:81],v[248:249] op_sel:[0,0] op_sel_hi:[1,0]
v_pk_mul_f32 v[82:83],v[82:83],v[248:249] op_sel:[0,0] op_sel_hi:[1,0]
v_pk_mul_f32 v[68:69],v[68:69],v[248:249] op_sel:[0,1] op_sel_hi:[1,1]
v_pk_mul_f32 v[70:71],v[70:71],v[248:249] op_sel:[0,1] op_sel_hi:[1,1]
v_pk_mul_f32 v[84:85],v[84:85],v[248:249] op_sel:[0,1] op_sel_hi:[1,1]
v_pk_mul_f32 v[86:87],v[86:87],v[248:249] op_sel:[0,1] op_sel_hi:[1,1]
s_add_u32 m0,s34,s40
s_nop 0
buffer_load_dwordx4 v4,s[8:11],s30 offen lds
v_pk_mul_f32 v[72:73],v[72:73],v[250:251] op_sel:[0,0] op_sel_hi:[1,0]
v_pk_mul_f32 v[74:75],v[74:75],v[250:251] op_sel:[0,0] op_sel_hi:[1,0]
v_pk_mul_f32 v[88:89],v[88:89],v[250:251] op_sel:[0,0] op_sel_hi:[1,0]
v_pk_mul_f32 v[90:91],v[90:91],v[250:251] op_sel:[0,0] op_sel_hi:[1,0]
v_pk_mul_f32 v[76:77],v[76:77],v[250:251] op_sel:[0,1] op_sel_hi:[1,1]
v_pk_mul_f32 v[78:79],v[78:79],v[250:251] op_sel:[0,1] op_sel_hi:[1,1]
v_pk_mul_f32 v[92:93],v[92:93],v[250:251] op_sel:[0,1] op_sel_hi:[1,1]
v_pk_mul_f32 v[94:95],v[94:95],v[250:251] op_sel:[0,1] op_sel_hi:[1,1]
buffer_load_dwordx4 v5,s[8:11],s30 offen offset:1024 lds
v_cvt_pk_bf16_f32 v128,v64,v65
v_cvt_pk_bf16_f32 v129,v66,v67
v_cvt_pk_bf16_f32 v130,v80,v81
v_cvt_pk_bf16_f32 v131,v82,v83
v_cvt_pk_bf16_f32 v132,v68,v69
v_cvt_pk_bf16_f32 v133,v70,v71
v_cvt_pk_bf16_f32 v134,v84,v85
v_cvt_pk_bf16_f32 v135,v86,v87
buffer_load_dwordx4 v6,s[8:11],s30 offen offset:2048 lds
v_cvt_pk_bf16_f32 v136,v72,v73
v_cvt_pk_bf16_f32 v137,v74,v75
v_cvt_pk_bf16_f32 v138,v88,v89
v_cvt_pk_bf16_f32 v139,v90,v91
v_cvt_pk_bf16_f32 v140,v76,v77
v_cvt_pk_bf16_f32 v141,v78,v79
v_cvt_pk_bf16_f32 v142,v92,v93
v_cvt_pk_bf16_f32 v143,v94,v95
buffer_load_dwordx4 v7,s[8:11],s30 offen offset:3072 lds
s_add_u32 s34,s34,24576
s_cmp_eq_u32 s34,163840
s_cselect_b32 s34,16384,s34
s_add_u32 s30,s30,128
s_and_b32 s30,s30,0x7ff
v_mfma_f32_16x16x32_bf16 v[144:147],v[240:243],v[128:131],0
v_mfma_f32_16x16x32_bf16 v[148:151],v[244:247],v[128:131],0
v_mfma_f32_16x16x32_bf16 v[152:155],v[240:243],v[132:135],0
v_mfma_f32_16x16x32_bf16 v[156:159],v[244:247],v[132:135],0
v_mfma_f32_16x16x32_bf16 v[160:163],v[240:243],v[136:139],0
v_mfma_f32_16x16x32_bf16 v[164:167],v[244:247],v[136:139],0
v_mfma_f32_16x16x32_bf16 v[168:171],v[240:243],v[140:143],0
v_mfma_f32_16x16x32_bf16 v[172:175],v[244:247],v[140:143],0
s_add_u32 m0,s35,s41
s_nop 0
buffer_load_dwordx4 v8,s[12:15],s32 offen lds
v_max3_f32 v176,v144,v145,v146
v_max3_f32 v177,-v144,-v145,-v146
v_max3_f32 v178,v152,v153,v154
v_max3_f32 v179,-v152,-v153,-v154
v_max3_f32 v180,v160,v161,v162
v_max3_f32 v181,-v160,-v161,-v162
v_max3_f32 v182,v168,v169,v170
v_max3_f32 v183,-v168,-v169,-v170
buffer_load_dwordx4 v9,s[12:15],s32 offen offset:1024 lds
s_add_u32 s35,s35,24576
s_cmp_eq_u32 s35,163840
s_cselect_b32 s35,16384,s35
s_add_u32 s32,s32,393216
s_cmp_eq_u32 s32,6291456
s_cselect_b32 s32,0,s32
v_max3_f32 v176,v176,v147,v148
v_max3_f32 v177,v177,-v147,-v148
v_max3_f32 v178,v178,v155,v156
v_max3_f32 v179,v179,-v155,-v156
v_max3_f32 v180,v180,v163,v164
v_max3_f32 v181,v181,-v163,-v164
v_max3_f32 v182,v182,v171,v172
v_max3_f32 v183,v183,-v171,-v172
s_add_u32 m0,s34,s40
s_nop 0
buffer_load_dwordx4 v4,s[8:11],s30 offen lds
v_max3_f32 v176,v176,v149,v150
v_max3_f32 v177,v177,-v149,-v150
v_max3_f32 v178,v178,v157,v158
v_max3_f32 v179,v179,-v157,-v158
v_max3_f32 v180,v180,v165,v166
v_max3_f32 v181,v181,-v165,-v166
v_max3_f32 v182,v182,v173,v174
v_max3_f32 v183,v183,-v173,-v174
buffer_load_dwordx4 v5,s[8:11],s30 offen offset:1024 lds
v_max_f32 v176,v176,v151
v_max_f32_e64 v177,v177,-v151
v_max_f32 v178,v178,v159
v_max_f32_e64 v179,v179,-v159
v_max_f32 v180,v180,v167
v_max_f32_e64 v181,v181,-v167
v_max_f32 v182,v182,v175
v_max_f32_e64 v183,v183,-v175
buffer_load_dwordx4 v6,s[8:11],s30 offen offset:2048 lds
v_permlane32_swap_b32 v176,v177
v_permlane32_swap_b32 v178,v179
v_permlane32_swap_b32 v180,v181
v_permlane32_swap_b32 v182,v183
v_max_f32 v176,v176,v177
v_max_f32 v178,v178,v179
v_max_f32 v180,v180,v181
v_max_f32 v182,v182,v183
buffer_load_dwordx4 v7,s[8:11],s30 offen offset:3072 lds
s_add_u32 s34,s34,24576
s_cmp_eq_u32 s34,163840
s_cselect_b32 s34,16384,s34
s_add_u32 s30,s30,128
s_and_b32 s30,s30,0x7ff
v_permlane16_swap_b32 v176,v178
v_permlane16_swap_b32 v180,v182
v_max_f32 v176,v176,v178
v_max_f32 v180,v180,v182
v_mul_f32 v176,s44,v176
v_mul_f32 v180,s44,v180
v_mov_b32 v178,v176
v_mov_b32 v182,v180
s_add_u32 m0,s35,s41
s_nop 0
buffer_load_dwordx4 v8,s[12:15],s32 offen lds
v_permlane16_swap_b32 v176,v178
v_permlane16_swap_b32 v180,v182
v_mov_b32 v177,v176
v_mov_b32 v179,v178
v_mov_b32 v181,v180
v_mov_b32 v183,v182
v_permlane32_swap_b32 v176,v177
v_permlane32_swap_b32 v178,v179
buffer_load_dwordx4 v9,s[12:15],s32 offen offset:1024 lds
s_add_u32 s35,s35,24576
s_cmp_eq_u32 s35,163840
s_cselect_b32 s35,16384,s35
s_add_u32 s32,s32,393216
s_cmp_eq_u32 s32,6291456
s_cselect_b32 s32,0,s32
v_permlane32_swap_b32 v180,v181
v_permlane32_swap_b32 v182,v183
v_subrev_u32 v0,73728,v14
v_subrev_u32 v1,73728,v15
ds_read_b64_tr_b16 a[228:229],v0 offset:0
ds_read_b64_tr_b16 a[230:231],v0 offset:512
ds_read_b64_tr_b16 a[232:233],v1 offset:0
ds_read_b64_tr_b16 a[234:235],v1 offset:512
v_pk_fma_f32 v[192:193],v[144:145],s[44:45],v[176:177] op_sel:[0,0,0] op_sel_hi:[1,1,0] neg_lo:[0,0,1] neg_hi:[0,0,1]
v_pk_fma_f32 v[194:195],v[146:147],s[44:45],v[176:177] op_sel:[0,0,0] op_sel_hi:[1,1,0] neg_lo:[0,0,1] neg_hi:[0,0,1]
v_pk_fma_f32 v[196:197],v[148:149],s[44:45],v[176:177] op_sel:[0,0,0] op_sel_hi:[1,1,0] neg_lo:[0,0,1] neg_hi:[0,0,1]
v_pk_fma_f32 v[198:199],v[150:151],s[44:45],v[176:177] op_sel:[0,0,0] op_sel_hi:[1,1,0] neg_lo:[0,0,1] neg_hi:[0,0,1]
v_pk_fma_f32 v[200:201],v[144:145],s[44:45],v[176:177] op_sel:[0,0,1] op_sel_hi:[1,1,1] neg_lo:[1,0,1] neg_hi:[1,0,1]
v_pk_fma_f32 v[202:203],v[146:147],s[44:45],v[176:177] op_sel:[0,0,1] op_sel_hi:[1,1,1] neg_lo:[1,0,1] neg_hi:[1,0,1]
v_pk_fma_f32 v[204:205],v[148:149],s[44:45],v[176:177] op_sel:[0,0,1] op_sel_hi:[1,1,1] neg_lo:[1,0,1] neg_hi:[1,0,1]
v_pk_fma_f32 v[206:207],v[150:151],s[44:45],v[176:177] op_sel:[0,0,1] op_sel_hi:[1,1,1] neg_lo:[1,0,1] neg_hi:[1,0,1]
s_waitcnt lgkmcnt(0)
v_mfma_f32_16x16x32_bf16 v[32:35],a[228:231],a[68:71],0
ds_read_b64_tr_b16 a[236:237],v0 offset:4096
v_exp_f32 v192,v192
v_mfma_f32_16x16x32_bf16 v[36:39],a[228:231],a[72:75],0
ds_read_b64_tr_b16 a[238:239],v0 offset:4608
v_exp_f32 v193,v193
v_mfma_f32_16x16x32_bf16 v[40:43],a[228:231],a[76:79],0
ds_read_b64_tr_b16 a[240:241],v1 offset:4096
v_exp_f32 v194,v194
v_mfma_f32_16x16x32_bf16 v[44:47],a[228:231],a[80:83],0
ds_read_b64_tr_b16 a[242:243],v1 offset:4608
v_exp_f32 v195,v195
v_mfma_f32_16x16x32_bf16 v[48:51],a[232:235],a[68:71],0
v_exp_f32 v196,v196
v_mfma_f32_16x16x32_bf16 v[52:55],a[232:235],a[72:75],0
v_exp_f32 v197,v197
v_mfma_f32_16x16x32_bf16 v[56:59],a[232:235],a[76:79],0
v_exp_f32 v198,v198
v_mfma_f32_16x16x32_bf16 v[60:63],a[232:235],a[80:83],0
v_exp_f32 v199,v199
s_waitcnt lgkmcnt(0)
v_mfma_f32_16x16x32_bf16 v[32:35],a[236:239],a[84:87],v[32:35]
ds_read_b64_tr_b16 a[228:229],v0 offset:8192
v_exp_f32 v200,v200
v_mfma_f32_16x16x32_bf16 v[36:39],a[236:239],a[88:91],v[36:39]
ds_read_b64_tr_b16 a[230:231],v0 offset:8704
v_exp_f32 v201,v201
v_mfma_f32_16x16x32_bf16 v[40:43],a[236:239],a[92:95],v[40:43]
ds_read_b64_tr_b16 a[232:233],v1 offset:8192
v_exp_f32 v202,v202
v_mfma_f32_16x16x32_bf16 v[44:47],a[236:239],a[96:99],v[44:47]
ds_read_b64_tr_b16 a[234:235],v1 offset:8704
v_exp_f32 v203,v203
v_mfma_f32_16x16x32_bf16 v[48:51],a[240:243],a[84:87],v[48:51]
v_exp_f32 v204,v204
v_mfma_f32_16x16x32_bf16 v[52:55],a[240:243],a[88:91],v[52:55]
v_exp_f32 v205,v205
v_mfma_f32_16x16x32_bf16 v[56:59],a[240:243],a[92:95],v[56:59]
v_exp_f32 v206,v206
v_mfma_f32_16x16x32_bf16 v[60:63],a[240:243],a[96:99],v[60:63]
v_exp_f32 v207,v207
s_waitcnt lgkmcnt(0)
v_mfma_f32_16x16x32_bf16 v[32:35],a[228:231],a[100:103],v[32:35]
ds_read_b64_tr_b16 a[236:237],v0 offset:12288
v_cvt_pk_bf16_f32 v208,v192,v193
v_cvt_pk_bf16_f32 v209,v194,v195
v_mfma_f32_16x16x32_bf16 v[36:39],a[228:231],a[104:107],v[36:39]
ds_read_b64_tr_b16 a[238:239],v0 offset:12800
v_cvt_pk_bf16_f32 v210,v196,v197
v_cvt_pk_bf16_f32 v211,v198,v199
v_mfma_f32_16x16x32_bf16 v[40:43],a[228:231],a[108:111],v[40:43]
ds_read_b64_tr_b16 a[240:241],v1 offset:12288
v_cvt_pk_bf16_f32 v212,v200,v201
v_cvt_pk_bf16_f32 v213,v202,v203
v_mfma_f32_16x16x32_bf16 v[44:47],a[228:231],a[112:115],v[44:47]
ds_read_b64_tr_b16 a[242:243],v1 offset:12800
v_cvt_pk_bf16_f32 v214,v204,v205
v_cvt_pk_bf16_f32 v215,v206,v207
v_pk_fma_f32 v[192:193],v[152:153],s[44:45],v[178:179] op_sel:[0,0,0] op_sel_hi:[1,1,0] neg_lo:[0,0,1] neg_hi:[0,0,1]
v_pk_fma_f32 v[194:195],v[154:155],s[44:45],v[178:179] op_sel:[0,0,0] op_sel_hi:[1,1,0] neg_lo:[0,0,1] neg_hi:[0,0,1]
v_pk_fma_f32 v[196:197],v[156:157],s[44:45],v[178:179] op_sel:[0,0,0] op_sel_hi:[1,1,0] neg_lo:[0,0,1] neg_hi:[0,0,1]
v_pk_fma_f32 v[198:199],v[158:159],s[44:45],v[178:179] op_sel:[0,0,0] op_sel_hi:[1,1,0] neg_lo:[0,0,1] neg_hi:[0,0,1]
v_pk_fma_f32 v[200:201],v[152:153],s[44:45],v[178:179] op_sel:[0,0,1] op_sel_hi:[1,1,1] neg_lo:[1,0,1] neg_hi:[1,0,1]
v_pk_fma_f32 v[202:203],v[154:155],s[44:45],v[178:179] op_sel:[0,0,1] op_sel_hi:[1,1,1] neg_lo:[1,0,1] neg_hi:[1,0,1]
v_pk_fma_f32 v[204:205],v[156:157],s[44:45],v[178:179] op_sel:[0,0,1] op_sel_hi:[1,1,1] neg_lo:[1,0,1] neg_hi:[1,0,1]
v_pk_fma_f32 v[206:207],v[158:159],s[44:45],v[178:179] op_sel:[0,0,1] op_sel_hi:[1,1,1] neg_lo:[1,0,1] neg_hi:[1,0,1]
v_mfma_f32_16x16x32_bf16 v[48:51],a[232:235],a[100:103],v[48:51]
v_exp_f32 v192,v192
v_mfma_f32_16x16x32_bf16 v[52:55],a[232:235],a[104:107],v[52:55]
v_exp_f32 v193,v193
v_mfma_f32_16x16x32_bf16 v[56:59],a[232:235],a[108:111],v[56:59]
v_exp_f32 v194,v194
v_mfma_f32_16x16x32_bf16 v[60:63],a[232:235],a[112:115],v[60:63]
v_exp_f32 v195,v195
s_waitcnt lgkmcnt(0)
v_mfma_f32_16x16x32_bf16 v[32:35],a[236:239],a[116:119],v[32:35]
ds_read_b64_tr_b16 a[228:229],v0 offset:16384
v_exp_f32 v196,v196
v_mfma_f32_16x16x32_bf16 v[36:39],a[236:239],a[120:123],v[36:39]
ds_read_b64_tr_b16 a[230:231],v0 offset:16896
v_exp_f32 v197,v197
v_mfma_f32_16x16x32_bf16 v[40:43],a[236:239],a[124:127],v[40:43]
ds_read_b64_tr_b16 a[232:233],v1 offset:16384
v_exp_f32 v198,v198
v_mfma_f32_16x16x32_bf16 v[44:47],a[236:239],a[128:131],v[44:47]
ds_read_b64_tr_b16 a[234:235],v1 offset:16896
v_exp_f32 v199,v199
v_mfma_f32_16x16x32_bf16 v[48:51],a[240:243],a[116:119],v[48:51]
v_exp_f32 v200,v200
v_mfma_f32_16x16x32_bf16 v[52:55],a[240:243],a[120:123],v[52:55]
v_exp_f32 v201,v201
v_mfma_f32_16x16x32_bf16 v[56:59],a[240:243],a[124:127],v[56:59]
v_exp_f32 v202,v202
v_mfma_f32_16x16x32_bf16 v[60:63],a[240:243],a[128:131],v[60:63]
v_exp_f32 v203,v203
s_waitcnt lgkmcnt(0)
v_mfma_f32_16x16x32_bf16 v[32:35],a[228:231],a[132:135],v[32:35]
ds_read_b64_tr_b16 a[236:237],v0 offset:20480
v_exp_f32 v204,v204
v_mfma_f32_16x16x32_bf16 v[36:39],a[228:231],a[136:139],v[36:39]
ds_read_b64_tr_b16 a[238:239],v0 offset:20992
v_exp_f32 v205,v205
v_mfma_f32_16x16x32_bf16 v[40:43],a[228:231],a[140:143],v[40:43]
ds_read_b64_tr_b16 a[240:241],v1 offset:20480
v_exp_f32 v206,v206
v_mfma_f32_16x16x32_bf16 v[44:47],a[228:231],a[144:147],v[44:47]
ds_read_b64_tr_b16 a[242:243],v1 offset:20992
v_exp_f32 v207,v207
v_mfma_f32_16x16x32_bf16 v[48:51],a[232:235],a[132:135],v[48:51]
v_cvt_pk_bf16_f32 v216,v192,v193
v_cvt_pk_bf16_f32 v217,v194,v195
v_mfma_f32_16x16x32_bf16 v[52:55],a[232:235],a[136:139],v[52:55]
v_cvt_pk_bf16_f32 v218,v196,v197
v_cvt_pk_bf16_f32 v219,v198,v199
v_mfma_f32_16x16x32_bf16 v[56:59],a[232:235],a[140:143],v[56:59]
v_cvt_pk_bf16_f32 v220,v200,v201
v_cvt_pk_bf16_f32 v221,v202,v203
v_mfma_f32_16x16x32_bf16 v[60:63],a[232:235],a[144:147],v[60:63]
v_cvt_pk_bf16_f32 v222,v204,v205
v_cvt_pk_bf16_f32 v223,v206,v207
v_pk_fma_f32 v[192:193],v[160:161],s[44:45],v[180:181] op_sel:[0,0,0] op_sel_hi:[1,1,0] neg_lo:[0,0,1] neg_hi:[0,0,1]
v_pk_fma_f32 v[194:195],v[162:163],s[44:45],v[180:181] op_sel:[0,0,0] op_sel_hi:[1,1,0] neg_lo:[0,0,1] neg_hi:[0,0,1]
v_pk_fma_f32 v[196:197],v[164:165],s[44:45],v[180:181] op_sel:[0,0,0] op_sel_hi:[1,1,0] neg_lo:[0,0,1] neg_hi:[0,0,1]
v_pk_fma_f32 v[198:199],v[166:167],s[44:45],v[180:181] op_sel:[0,0,0] op_sel_hi:[1,1,0] neg_lo:[0,0,1] neg_hi:[0,0,1]
v_pk_fma_f32 v[200:201],v[160:161],s[44:45],v[180:181] op_sel:[0,0,1] op_sel_hi:[1,1,1] neg_lo:[1,0,1] neg_hi:[1,0,1]
v_pk_fma_f32 v[202:203],v[162:163],s[44:45],v[180:181] op_sel:[0,0,1] op_sel_hi:[1,1,1] neg_lo:[1,0,1] neg_hi:[1,0,1]
v_pk_fma_f32 v[204:205],v[164:165],s[44:45],v[180:181] op_sel:[0,0,1] op_sel_hi:[1,1,1] neg_lo:[1,0,1] neg_hi:[1,0,1]
v_pk_fma_f32 v[206:207],v[166:167],s[44:45],v[180:181] op_sel:[0,0,1] op_sel_hi:[1,1,1] neg_lo:[1,0,1] neg_hi:[1,0,1]
s_waitcnt lgkmcnt(0)
v_mfma_f32_16x16x32_bf16 v[32:35],a[236:239],a[148:151],v[32:35]
ds_read_b64_tr_b16 a[228:229],v0 offset:24576
v_exp_f32 v192,v192
v_mfma_f32_16x16x32_bf16 v[36:39],a[236:239],a[152:155],v[36:39]
ds_read_b64_tr_b16 a[230:231],v0 offset:25088
v_exp_f32 v193,v193
v_mfma_f32_16x16x32_bf16 v[40:43],a[236:239],a[156:159],v[40:43]
ds_read_b64_tr_b16 a[232:233],v1 offset:24576
v_exp_f32 v194,v194
v_mfma_f32_16x16x32_bf16 v[44:47],a[236:239],a[160:163],v[44:47]
ds_read_b64_tr_b16 a[234:235],v1 offset:25088
v_exp_f32 v195,v195
v_mfma_f32_16x16x32_bf16 v[48:51],a[240:243],a[148:151],v[48:51]
v_exp_f32 v196,v196
v_mfma_f32_16x16x32_bf16 v[52:55],a[240:243],a[152:155],v[52:55]
v_exp_f32 v197,v197
v_mfma_f32_16x16x32_bf16 v[56:59],a[240:243],a[156:159],v[56:59]
v_exp_f32 v198,v198
v_mfma_f32_16x16x32_bf16 v[60:63],a[240:243],a[160:163],v[60:63]
v_exp_f32 v199,v199
s_waitcnt lgkmcnt(0)
v_mfma_f32_16x16x32_bf16 v[32:35],a[228:231],a[164:167],v[32:35]
ds_read_b64_tr_b16 a[236:237],v0 offset:28672
v_exp_f32 v200,v200
v_mfma_f32_16x16x32_bf16 v[36:39],a[228:231],a[168:171],v[36:39]
ds_read_b64_tr_b16 a[238:239],v0 offset:29184
v_exp_f32 v201,v201
v_mfma_f32_16x16x32_bf16 v[40:43],a[228:231],a[172:175],v[40:43]
ds_read_b64_tr_b16 a[240:241],v1 offset:28672
v_exp_f32 v202,v202
v_mfma_f32_16x16x32_bf16 v[44:47],a[228:231],a[176:179],v[44:47]
ds_read_b64_tr_b16 a[242:243],v1 offset:29184
v_exp_f32 v203,v203
v_mfma_f32_16x16x32_bf16 v[48:51],a[232:235],a[164:167],v[48:51]
v_exp_f32 v204,v204
v_mfma_f32_16x16x32_bf16 v[52:55],a[232:235],a[168:171],v[52:55]
v_exp_f32 v205,v205
v_mfma_f32_16x16x32_bf16 v[56:59],a[232:235],a[172:175],v[56:59]
v_exp_f32 v206,v206
v_mfma_f32_16x16x32_bf16 v[60:63],a[232:235],a[176:179],v[60:63]
v_exp_f32 v207,v207
s_waitcnt lgkmcnt(0)
v_mfma_f32_16x16x32_bf16 v[32:35],a[236:239],a[180:183],v[32:35]
ds_read_b64_tr_b16 a[228:229],v0 offset:32768
v_cvt_pk_bf16_f32 v224,v192,v193
v_cvt_pk_bf16_f32 v225,v194,v195
v_mfma_f32_16x16x32_bf16 v[36:39],a[236:239],a[184:187],v[36:39]
ds_read_b64_tr_b16 a[230:231],v0 offset:33280
v_cvt_pk_bf16_f32 v226,v196,v197
v_cvt_pk_bf16_f32 v227,v198,v199
v_mfma_f32_16x16x32_bf16 v[40:43],a[236:239],a[188:191],v[40:43]
ds_read_b64_tr_b16 a[232:233],v1 offset:32768
v_cvt_pk_bf16_f32 v228,v200,v201
v_cvt_pk_bf16_f32 v229,v202,v203
v_mfma_f32_16x16x32_bf16 v[44:47],a[236:239],a[192:195],v[44:47]
ds_read_b64_tr_b16 a[234:235],v1 offset:33280
v_cvt_pk_bf16_f32 v230,v204,v205
v_cvt_pk_bf16_f32 v231,v206,v207
v_pk_fma_f32 v[192:193],v[168:169],s[44:45],v[182:183] op_sel:[0,0,0] op_sel_hi:[1,1,0] neg_lo:[0,0,1] neg_hi:[0,0,1]
v_pk_fma_f32 v[194:195],v[170:171],s[44:45],v[182:183] op_sel:[0,0,0] op_sel_hi:[1,1,0] neg_lo:[0,0,1] neg_hi:[0,0,1]
v_pk_fma_f32 v[196:197],v[172:173],s[44:45],v[182:183] op_sel:[0,0,0] op_sel_hi:[1,1,0] neg_lo:[0,0,1] neg_hi:[0,0,1]
v_pk_fma_f32 v[198:199],v[174:175],s[44:45],v[182:183] op_sel:[0,0,0] op_sel_hi:[1,1,0] neg_lo:[0,0,1] neg_hi:[0,0,1]
v_pk_fma_f32 v[200:201],v[168:169],s[44:45],v[182:183] op_sel:[0,0,1] op_sel_hi:[1,1,1] neg_lo:[1,0,1] neg_hi:[1,0,1]
v_pk_fma_f32 v[202:203],v[170:171],s[44:45],v[182:183] op_sel:[0,0,1] op_sel_hi:[1,1,1] neg_lo:[1,0,1] neg_hi:[1,0,1]
v_pk_fma_f32 v[204:205],v[172:173],s[44:45],v[182:183] op_sel:[0,0,1] op_sel_hi:[1,1,1] neg_lo:[1,0,1] neg_hi:[1,0,1]
v_pk_fma_f32 v[206:207],v[174:175],s[44:45],v[182:183] op_sel:[0,0,1] op_sel_hi:[1,1,1] neg_lo:[1,0,1] neg_hi:[1,0,1]
v_mfma_f32_16x16x32_bf16 v[48:51],a[240:243],a[180:183],v[48:51]
v_exp_f32 v192,v192
v_mfma_f32_16x16x32_bf16 v[52:55],a[240:243],a[184:187],v[52:55]
v_exp_f32 v193,v193
v_mfma_f32_16x16x32_bf16 v[56:59],a[240:243],a[188:191],v[56:59]
v_exp_f32 v194,v194
v_mfma_f32_16x16x32_bf16 v[60:63],a[240:243],a[192:195],v[60:63]
v_exp_f32 v195,v195
s_waitcnt lgkmcnt(0)
v_mfma_f32_16x16x32_bf16 v[32:35],a[228:231],a[196:199],v[32:35]
ds_read_b64_tr_b16 a[236:237],v0 offset:36864
v_exp_f32 v196,v196
v_mfma_f32_16x16x32_bf16 v[36:39],a[228:231],a[200:203],v[36:39]
ds_read_b64_tr_b16 a[238:239],v0 offset:37376
v_exp_f32 v197,v197
v_mfma_f32_16x16x32_bf16 v[40:43],a[228:231],a[204:207],v[40:43]
ds_read_b64_tr_b16 a[240:241],v1 offset:36864
v_exp_f32 v198,v198
v_mfma_f32_16x16x32_bf16 v[44:47],a[228:231],a[208:211],v[44:47]
ds_read_b64_tr_b16 a[242:243],v1 offset:37376
v_exp_f32 v199,v199
v_mfma_f32_16x16x32_bf16 v[48:51],a[232:235],a[196:199],v[48:51]
v_exp_f32 v200,v200
v_mfma_f32_16x16x32_bf16 v[52:55],a[232:235],a[200:203],v[52:55]
v_exp_f32 v201,v201
v_mfma_f32_16x16x32_bf16 v[56:59],a[232:235],a[204:207],v[56:59]
v_exp_f32 v202,v202
v_mfma_f32_16x16x32_bf16 v[60:63],a[232:235],a[208:211],v[60:63]
v_exp_f32 v203,v203
s_waitcnt lgkmcnt(0)
v_mfma_f32_16x16x32_bf16 v[32:35],a[236:239],a[212:215],v[32:35]
v_exp_f32 v204,v204
v_mfma_f32_16x16x32_bf16 v[36:39],a[236:239],a[216:219],v[36:39]
v_exp_f32 v205,v205
v_mfma_f32_16x16x32_bf16 v[40:43],a[236:239],a[220:223],v[40:43]
v_exp_f32 v206,v206
v_mfma_f32_16x16x32_bf16 v[44:47],a[236:239],a[224:227],v[44:47]
v_exp_f32 v207,v207
v_mfma_f32_16x16x32_bf16 v[48:51],a[240:243],a[212:215],v[48:51]
v_cvt_pk_bf16_f32 v232,v192,v193
v_cvt_pk_bf16_f32 v233,v194,v195
v_mfma_f32_16x16x32_bf16 v[52:55],a[240:243],a[216:219],v[52:55]
v_cvt_pk_bf16_f32 v234,v196,v197
v_cvt_pk_bf16_f32 v235,v198,v199
v_mfma_f32_16x16x32_bf16 v[56:59],a[240:243],a[220:223],v[56:59]
v_cvt_pk_bf16_f32 v236,v200,v201
v_cvt_pk_bf16_f32 v237,v202,v203
v_mfma_f32_16x16x32_bf16 v[60:63],a[240:243],a[224:227],v[60:63]
v_cvt_pk_bf16_f32 v238,v204,v205
v_cvt_pk_bf16_f32 v239,v206,v207
s_barrier
s_add_u32 m0,s34,s40
s_nop 0
buffer_load_dwordx4 v4,s[8:11],s30 offen lds
buffer_load_dwordx4 v5,s[8:11],s30 offen offset:1024 lds
buffer_load_dwordx4 v6,s[8:11],s30 offen offset:2048 lds
buffer_load_dwordx4 v7,s[8:11],s30 offen offset:3072 lds
s_add_u32 s34,s34,24576
s_cmp_eq_u32 s34,163840
s_cselect_b32 s34,16384,s34
s_add_u32 s30,s30,128
s_and_b32 s30,s30,0x7ff
s_add_u32 m0,s35,s41
s_nop 0
buffer_load_dwordx4 v8,s[12:15],s32 offen lds
buffer_load_dwordx4 v9,s[12:15],s32 offen offset:1024 lds
s_add_u32 s35,s35,24576
s_cmp_eq_u32 s35,163840
s_cselect_b32 s35,16384,s35
s_add_u32 s32,s32,393216
s_cmp_eq_u32 s32,6291456
s_cselect_b32 s32,0,s32
v_mfma_f32_16x16x32_bf16 v[144:147],v[24:27],v[208:211],0
v_mfma_f32_16x16x32_bf16 v[148:151],v[24:27],v[212:215],0
v_mfma_f32_16x16x32_bf16 v[152:155],v[24:27],v[216:219],0
v_mfma_f32_16x16x32_bf16 v[156:159],v[24:27],v[220:223],0
v_mfma_f32_16x16x32_bf16 v[160:163],v[24:27],v[224:227],0
v_mfma_f32_16x16x32_bf16 v[164:167],v[24:27],v[228:231],0
v_mfma_f32_16x16x32_bf16 v[168:171],v[24:27],v[232:235],0
v_mfma_f32_16x16x32_bf16 v[172:175],v[24:27],v[236:239],0
ds_write_b64 v18,v[208:209] offset:0
ds_write_b64 v18,v[210:211] offset:32
ds_write_b64 v18,v[212:213] offset:64
ds_write_b64 v18,v[214:215] offset:96
ds_write_b64 v18,v[216:217] offset:5632
ds_write_b64 v18,v[218:219] offset:5664
ds_write_b64 v18,v[220:221] offset:5696
ds_write_b64 v18,v[222:223] offset:5728
ds_write_b64 v18,v[224:225] offset:11264
ds_write_b64 v18,v[226:227] offset:11296
ds_write_b64 v18,v[228:229] offset:11328
ds_write_b64 v18,v[230:231] offset:11360
ds_write_b64 v18,v[232:233] offset:16896
ds_write_b64 v18,v[234:235] offset:16928
ds_write_b64 v18,v[236:237] offset:16960
ds_write_b64 v18,v[238:239] offset:16992
v_rcp_f32 v144,v144
v_rcp_f32 v148,v148
v_rcp_f32 v152,v152
v_rcp_f32 v156,v156
v_rcp_f32 v160,v160
v_rcp_f32 v164,v164
v_rcp_f32 v168,v168
v_rcp_f32 v172,v172
v_mul_f32 v146,v144,v248
v_cvt_pk_bf16_f32 v144,v144,0
v_mov_b32 v145,0
v_mul_f32 v150,v148,v248
v_cvt_pk_bf16_f32 v148,v148,0
v_mov_b32 v149,0
v_mul_f32 v154,v152,v249
v_cvt_pk_bf16_f32 v152,v152,0
v_mov_b32 v153,0
v_mul_f32 v158,v156,v249
v_cvt_pk_bf16_f32 v156,v156,0
v_mov_b32 v157,0
v_mul_f32 v162,v160,v250
v_cvt_pk_bf16_f32 v160,v160,0
v_mov_b32 v161,0
v_mul_f32 v166,v164,v250
v_cvt_pk_bf16_f32 v164,v164,0
v_mov_b32 v165,0
v_mul_f32 v170,v168,v251
v_cvt_pk_bf16_f32 v168,v168,0
v_mov_b32 v169,0
v_mul_f32 v174,v172,v251
v_cvt_pk_bf16_f32 v172,v172,0
v_mov_b32 v173,0
v_pk_mul_f32 v[176:177],v[96:97],v[146:147] op_sel:[0,0] op_sel_hi:[1,0]
v_pk_mul_f32 v[178:179],v[98:99],v[146:147] op_sel:[0,0] op_sel_hi:[1,0]
v_pk_mul_f32 v[180:181],v[112:113],v[146:147] op_sel:[0,0] op_sel_hi:[1,0]
v_pk_mul_f32 v[182:183],v[114:115],v[146:147] op_sel:[0,0] op_sel_hi:[1,0]
v_cvt_pk_bf16_f32 v192,v176,v177
v_cvt_pk_bf16_f32 v193,v178,v179
v_cvt_pk_bf16_f32 v194,v180,v181
v_cvt_pk_bf16_f32 v195,v182,v183
ds_write_b64 v18,v[192:193] offset:128
ds_write_b64 v18,v[194:195] offset:160
ds_write_b64 v18,v[144:145] offset:256
v_pk_mul_f32 v[184:185],v[96:97],v[150:151] op_sel:[0,0] op_sel_hi:[1,0]
v_pk_mul_f32 v[186:187],v[98:99],v[150:151] op_sel:[0,0] op_sel_hi:[1,0]
v_pk_mul_f32 v[188:189],v[112:113],v[150:151] op_sel:[0,0] op_sel_hi:[1,0]
v_pk_mul_f32 v[190:191],v[114:115],v[150:151] op_sel:[0,0] op_sel_hi:[1,0]
v_cvt_pk_bf16_f32 v196,v184,v185
v_cvt_pk_bf16_f32 v197,v186,v187
v_cvt_pk_bf16_f32 v198,v188,v189
v_cvt_pk_bf16_f32 v199,v190,v191
ds_write_b64 v18,v[196:197] offset:192
ds_write_b64 v18,v[198:199] offset:224
ds_write_b64 v18,v[148:149] offset:288
v_pk_mul_f32 v[176:177],v[100:101],v[154:155] op_sel:[0,0] op_sel_hi:[1,0]
v_pk_mul_f32 v[178:179],v[102:103],v[154:155] op_sel:[0,0] op_sel_hi:[1,0]
v_pk_mul_f32 v[180:181],v[116:117],v[154:155] op_sel:[0,0] op_sel_hi:[1,0]
v_pk_mul_f32 v[182:183],v[118:119],v[154:155] op_sel:[0,0] op_sel_hi:[1,0]
v_cvt_pk_bf16_f32 v200,v176,v177
v_cvt_pk_bf16_f32 v201,v178,v179
v_cvt_pk_bf16_f32 v202,v180,v181
v_cvt_pk_bf16_f32 v203,v182,v183
ds_write_b64 v18,v[200:201] offset:5760
ds_write_b64 v18,v[202:203] offset:5792
ds_write_b64 v18,v[152:153] offset:5888
v_pk_mul_f32 v[184:185],v[100:101],v[158:159] op_sel:[0,0] op_sel_hi:[1,0]
v_pk_mul_f32 v[186:187],v[102:103],v[158:159] op_sel:[0,0] op_sel_hi:[1,0]
v_pk_mul_f32 v[188:189],v[116:117],v[158:159] op_sel:[0,0] op_sel_hi:[1,0]
v_pk_mul_f32 v[190:191],v[118:119],v[158:159] op_sel:[0,0] op_sel_hi:[1,0]
v_cvt_pk_bf16_f32 v204,v184,v185
v_cvt_pk_bf16_f32 v205,v186,v187
v_cvt_pk_bf16_f32 v206,v188,v189
v_cvt_pk_bf16_f32 v207,v190,v191
ds_write_b64 v18,v[204:205] offset:5824
ds_write_b64 v18,v[206:207] offset:5856
ds_write_b64 v18,v[156:157] offset:5920
v_pk_mul_f32 v[176:177],v[104:105],v[162:163] op_sel:[0,0] op_sel_hi:[1,0]
v_pk_mul_f32 v[178:179],v[106:107],v[162:163] op_sel:[0,0] op_sel_hi:[1,0]
v_pk_mul_f32 v[180:181],v[120:121],v[162:163] op_sel:[0,0] op_sel_hi:[1,0]
v_pk_mul_f32 v[182:183],v[122:123],v[162:163] op_sel:[0,0] op_sel_hi:[1,0]
v_cvt_pk_bf16_f32 v192,v176,v177
v_cvt_pk_bf16_f32 v193,v178,v179
v_cvt_pk_bf16_f32 v194,v180,v181
v_cvt_pk_bf16_f32 v195,v182,v183
ds_write_b64 v18,v[192:193] offset:11392
ds_write_b64 v18,v[194:195] offset:11424
ds_write_b64 v18,v[160:161] offset:11520
v_pk_mul_f32 v[184:185],v[104:105],v[166:167] op_sel:[0,0] op_sel_hi:[1,0]
v_pk_mul_f32 v[186:187],v[106:107],v[166:167] op_sel:[0,0] op_sel_hi:[1,0]
v_pk_mul_f32 v[188:189],v[120:121],v[166:167] op_sel:[0,0] op_sel_hi:[1,0]
v_pk_mul_f32 v[190:191],v[122:123],v[166:167] op_sel:[0,0] op_sel_hi:[1,0]
v_cvt_pk_bf16_f32 v196,v184,v185
v_cvt_pk_bf16_f32 v197,v186,v187
v_cvt_pk_bf16_f32 v198,v188,v189
v_cvt_pk_bf16_f32 v199,v190,v191
ds_write_b64 v18,v[196:197] offset:11456
ds_write_b64 v18,v[198:199] offset:11488
ds_write_b64 v18,v[164:165] offset:11552
v_pk_mul_f32 v[176:177],v[108:109],v[170:171] op_sel:[0,0] op_sel_hi:[1,0]
v_pk_mul_f32 v[178:179],v[110:111],v[170:171] op_sel:[0,0] op_sel_hi:[1,0]
v_pk_mul_f32 v[180:181],v[124:125],v[170:171] op_sel:[0,0] op_sel_hi:[1,0]
v_pk_mul_f32 v[182:183],v[126:127],v[170:171] op_sel:[0,0] op_sel_hi:[1,0]
v_cvt_pk_bf16_f32 v200,v176,v177
v_cvt_pk_bf16_f32 v201,v178,v179
v_cvt_pk_bf16_f32 v202,v180,v181
v_cvt_pk_bf16_f32 v203,v182,v183
ds_write_b64 v18,v[200:201] offset:17024
ds_write_b64 v18,v[202:203] offset:17056
ds_write_b64 v18,v[168:169] offset:17152
v_pk_mul_f32 v[184:185],v[108:109],v[174:175] op_sel:[0,0] op_sel_hi:[1,0]
v_pk_mul_f32 v[186:187],v[110:111],v[174:175] op_sel:[0,0] op_sel_hi:[1,0]
v_pk_mul_f32 v[188:189],v[124:125],v[174:175] op_sel:[0,0] op_sel_hi:[1,0]
v_pk_mul_f32 v[190:191],v[126:127],v[174:175] op_sel:[0,0] op_sel_hi:[1,0]
v_cvt_pk_bf16_f32 v204,v184,v185
v_cvt_pk_bf16_f32 v205,v186,v187
v_cvt_pk_bf16_f32 v206,v188,v189
v_cvt_pk_bf16_f32 v207,v190,v191
ds_write_b64 v18,v[204:205] offset:17088
ds_write_b64 v18,v[206:207] offset:17120
ds_write_b64 v18,v[172:173] offset:17184
s_waitcnt lgkmcnt(0)
s_barrier
s_lshl_b32 s18,s28,6
v_add_u32 v28,s18,v19
s_lshl_b32 s18,s28,5
v_add_u32 v29,s18,v19
ds_read_b64_tr_b16 v[128:129],v28 offset:0
ds_read_b64_tr_b16 v[132:133],v28 offset:32
ds_read_b64_tr_b16 v[136:137],v28 offset:128
ds_read_b64_tr_b16 v[140:141],v28 offset:160
ds_read_b64_tr_b16 v[144:145],v29 offset:256
ds_read_b64_tr_b16 v[130:131],v28 offset:5632
ds_read_b64_tr_b16 v[134:135],v28 offset:5664
ds_read_b64_tr_b16 v[138:139],v28 offset:5760
ds_read_b64_tr_b16 v[142:143],v28 offset:5792
ds_read_b64_tr_b16 v[146:147],v29 offset:5888
ds_read_b64_tr_b16 v[148:149],v28 offset:11264
ds_read_b64_tr_b16 v[152:153],v28 offset:11296
ds_read_b64_tr_b16 v[156:157],v28 offset:11392
ds_read_b64_tr_b16 v[160:161],v28 offset:11424
ds_read_b64_tr_b16 v[164:165],v29 offset:11520
ds_read_b64_tr_b16 v[150:151],v28 offset:16896
ds_read_b64_tr_b16 v[154:155],v28 offset:16928
ds_read_b64_tr_b16 v[158:159],v28 offset:17024
ds_read_b64_tr_b16 v[162:163],v28 offset:17056
ds_read_b64_tr_b16 v[166:167],v29 offset:17152
ds_read_b64_tr_b16 v[168:169],v28 offset:22528
ds_read_b64_tr_b16 v[172:173],v28 offset:22560
ds_read_b64_tr_b16 v[176:177],v28 offset:22656
ds_read_b64_tr_b16 v[180:181],v28 offset:22688
ds_read_b64_tr_b16 v[184:185],v29 offset:22784
ds_read_b64_tr_b16 v[170:171],v28 offset:28160
ds_read_b64_tr_b16 v[174:175],v28 offset:28192
ds_read_b64_tr_b16 v[178:179],v28 offset:28288
ds_read_b64_tr_b16 v[182:183],v28 offset:28320
ds_read_b64_tr_b16 v[186:187],v29 offset:28416
ds_read_b64_tr_b16 v[188:189],v28 offset:33792
ds_read_b64_tr_b16 v[192:193],v28 offset:33824
ds_read_b64_tr_b16 v[196:197],v28 offset:33920
ds_read_b64_tr_b16 v[200:201],v28 offset:33952
ds_read_b64_tr_b16 v[204:205],v29 offset:34048
ds_read_b64_tr_b16 v[190:191],v28 offset:39424
ds_read_b64_tr_b16 v[194:195],v28 offset:39456
ds_read_b64_tr_b16 v[198:199],v28 offset:39552
ds_read_b64_tr_b16 v[202:203],v28 offset:39584
ds_read_b64_tr_b16 v[206:207],v29 offset:39680
s_waitcnt lgkmcnt(15)
v_mfma_f32_16x16x32_bf16 v[64:67],v[128:131],v[136:139],0
v_mfma_f32_16x16x32_bf16 v[68:71],v[128:131],v[140:143],0
v_mfma_f32_16x16x32_bf16 v[72:75],v[128:131],v[144:147],0
v_mfma_f32_16x16x32_bf16 v[76:79],v[132:135],v[136:139],0
v_mfma_f32_16x16x32_bf16 v[80:83],v[132:135],v[140:143],0
v_mfma_f32_16x16x32_bf16 v[84:87],v[132:135],v[144:147],0
s_waitcnt lgkmcnt(10)
v_mfma_f32_16x16x32_bf16 v[64:67],v[148:151],v[156:159],v[64:67]
v_mfma_f32_16x16x32_bf16 v[68:71],v[148:151],v[160:163],v[68:71]
v_mfma_f32_16x16x32_bf16 v[72:75],v[148:151],v[164:167],v[72:75]
v_mfma_f32_16x16x32_bf16 v[76:79],v[152:155],v[156:159],v[76:79]
v_mfma_f32_16x16x32_bf16 v[80:83],v[152:155],v[160:163],v[80:83]
v_mfma_f32_16x16x32_bf16 v[84:87],v[152:155],v[164:167],v[84:87]
s_waitcnt vmcnt(12) lgkmcnt(0)
s_barrier
v_mfma_f32_16x16x32_bf16 v[64:67],v[168:171],v[176:179],v[64:67]
ds_read_b128 v[128:131],v12 offset:0
s_add_u32 m0,s34,s40
s_nop 0
buffer_load_dwordx4 v4,s[8:11],s30 offen lds
v_mfma_f32_16x16x32_bf16 v[68:71],v[168:171],v[180:183],v[68:71]
ds_read_b64_tr_b16 v[144:145],v14 offset:0
buffer_load_dwordx4 v5,s[8:11],s30 offen offset:1024 lds
v_mfma_f32_16x16x32_bf16 v[72:75],v[168:171],v[184:187],v[72:75]
ds_read_b64_tr_b16 v[146:147],v14 offset:512
buffer_load_dwordx4 v6,s[8:11],s30 offen offset:2048 lds
v_mfma_f32_16x16x32_bf16 v[76:79],v[172:175],v[176:179],v[76:79]
ds_read_b128 v[132:135],v12 offset:2048
buffer_load_dwordx4 v7,s[8:11],s30 offen offset:3072 lds
s_add_u32 s34,s34,24576
s_cmp_eq_u32 s34,163840
s_cselect_b32 s34,16384,s34
s_add_u32 s30,s30,128
s_and_b32 s30,s30,0x7ff
v_mfma_f32_16x16x32_bf16 v[80:83],v[172:175],v[180:183],v[80:83]
ds_read_b128 v[136:139],v12 offset:4096
s_add_u32 m0,s35,s41
s_nop 0
buffer_load_dwordx4 v8,s[12:15],s32 offen lds
v_mfma_f32_16x16x32_bf16 v[84:87],v[172:175],v[184:187],v[84:87]
ds_read_b128 v[140:143],v12 offset:6144
buffer_load_dwordx4 v9,s[12:15],s32 offen offset:1024 lds
s_add_u32 s35,s35,24576
s_cmp_eq_u32 s35,163840
s_cselect_b32 s35,16384,s35
s_add_u32 s32,s32,393216
s_cmp_eq_u32 s32,6291456
s_cselect_b32 s32,0,s32
v_mfma_f32_16x16x32_bf16 v[64:67],v[188:191],v[196:199],v[64:67]
ds_read_b64_tr_b16 v[148:149],v15 offset:0
v_mfma_f32_16x16x32_bf16 v[68:71],v[188:191],v[200:203],v[68:71]
ds_read_b64_tr_b16 v[150:151],v15 offset:512
v_mfma_f32_16x16x32_bf16 v[72:75],v[188:191],v[204:207],v[72:75]
v_mfma_f32_16x16x32_bf16 v[76:79],v[192:195],v[196:199],v[76:79]
v_mfma_f32_16x16x32_bf16 v[80:83],v[192:195],v[200:203],v[80:83]
v_mfma_f32_16x16x32_bf16 v[84:87],v[192:195],v[204:207],v[84:87]
s_nop 0
buffer_store_dwordx4 v[64:67],v20,s[24:27],0 offen sc1
s_nop 0
buffer_store_dwordx4 v[68:71],v20,s[24:27],0 offen offset:1024 sc1
s_nop 1
buffer_store_dwordx4 v[76:79],v20,s[24:27],0 offen offset:2048 sc1
buffer_store_dwordx4 v[80:83],v20,s[24:27],0 offen offset:3072 sc1
s_mov_b32 exec_lo,0x00010001
s_mov_b32 exec_hi,0x00010001
buffer_store_dwordx4 v[72:75],v22,s[24:27],0 offen sc1
buffer_store_dwordx4 v[84:87],v22,s[24:27],0 offen offset:64 sc1
s_mov_b64 exec,-1
s_lshr_b32 s18,s84,3
s_lshl_b32 s19,s85,1
s_add_u32 s18,s18,s19
s_mul_i32 s60,s18,8448
s_and_b32 s18,s84,7
s_lshl_b32 s18,s18,10
s_add_u32 s60,s60,s18
s_lshl_b32 s18,s20,8
s_add_u32 s60,s60,s18
s_add_u32 s60,s60,28377088
s_bfe_u32 s18,s84,0x10002
s_add_u32 s18,s18,s19
s_mul_i32 s61,s18,8448
s_and_b32 s18,s84,3
s_lshl_b32 s18,s18,6
s_add_u32 s61,s61,s18
s_add_u32 s61,s61,28385280
s_mov_b32 s18,270336
v_mul_lo_u32 v25,v31,s18
v_lshl_add_u32 v25,v30,4,v25
v_mul_lo_u32 v29,v30,s18
v_lshl_add_u32 v29,v31,4,v29
s_lshl_b32 s49,s85,8
s_add_u32 s49,s49,95420416
s_lshl_b32 s52,s85,8
s_add_u32 s52,s52,95436800
v_lshlrev_b32 v28,2,v30
s_waitcnt lgkmcnt(0)
v_mfma_f32_16x16x32_bf16 v[32:35],v[144:147],v[128:131],v[32:35]
v_add_u32 v13,s42,v13
ds_read_b128 v[160:163],v13 offset:0
v_mfma_f32_16x16x32_bf16 v[36:39],v[144:147],v[132:135],v[36:39]
ds_read_b64_tr_b16 v[176:177],v14 offset:4096
ds_read_b64_tr_b16 v[178:179],v14 offset:4608
s_add_u32 s36,s36,24576
v_mfma_f32_16x16x32_bf16 v[40:43],v[144:147],v[136:139],v[40:43]
ds_read_b128 v[164:167],v13 offset:2048
s_add_u32 m0,s34,s40
v_mfma_f32_16x16x32_bf16 v[44:47],v[144:147],v[140:143],v[44:47]
ds_read_b128 v[168:171],v13 offset:4096
buffer_load_dwordx4 v4,s[8:11],s30 offen lds
v_mfma_f32_16x16x32_bf16 v[48:51],v[148:151],v[128:131],v[48:51]
ds_read_b128 v[172:175],v13 offset:6144
buffer_load_dwordx4 v5,s[8:11],s30 offen offset:1024 lds
v_mfma_f32_16x16x32_bf16 v[52:55],v[148:151],v[132:135],v[52:55]
ds_read_b64_tr_b16 v[180:181],v15 offset:4096
ds_read_b64_tr_b16 v[182:183],v15 offset:4608
v_mfma_f32_16x16x32_bf16 v[56:59],v[148:151],v[136:139],v[56:59]
buffer_load_dwordx4 v6,s[8:11],s30 offen offset:2048 lds
buffer_load_dwordx4 v7,s[8:11],s30 offen offset:3072 lds
v_mfma_f32_16x16x32_bf16 v[60:63],v[148:151],v[140:143],v[60:63]
s_add_u32 s34,s34,24576
s_cmp_eq_u32 s34,163840
s_cselect_b32 s34,16384,s34
s_add_u32 s30,s30,128
s_and_b32 s30,s30,0x7ff
s_add_u32 m0,s35,s41
s_nop 0
buffer_load_dwordx4 v8,s[12:15],s32 offen lds
buffer_load_dwordx4 v9,s[12:15],s32 offen offset:1024 lds
s_add_u32 s35,s35,24576
s_cmp_eq_u32 s35,163840
s_cselect_b32 s35,16384,s35
s_add_u32 s32,s32,393216
s_cmp_eq_u32 s32,6291456
s_cselect_b32 s32,0,s32
s_cmp_eq_u32 s36,163840
s_cselect_b32 s42,s51,s50
s_cselect_b32 s36,16384,s36
s_cmp_lg_u32 s31,0
s_cbranch_scc1 Lcqe24
s_cmp_lg_u32 s28,0
s_cbranch_scc1 Lcq23
v_mfma_f32_16x16x32_bf16 a[52:55],a[48:51],v[144:147],0
s_branch Lcqe24
Lcq23:
s_nop 6
v_mfma_f32_16x16x32_bf16 a[52:55],a[48:51],v[148:151],0
Lcqe24:
s_waitcnt lgkmcnt(0)
v_mfma_f32_16x16x32_bf16 v[32:35],v[176:179],v[160:163],v[32:35]
v_add_u32 v12,s42,v12
v_add_u32 v14,s42,v14
v_mfma_f32_16x16x32_bf16 v[36:39],v[176:179],v[164:167],v[36:39]
v_add_u32 v15,s42,v15
s_waitcnt vmcnt(24)
s_barrier
ds_read_b128 v[128:131],v12 offset:0
v_mfma_f32_16x16x32_bf16 v[40:43],v[176:179],v[168:171],v[40:43]
ds_read_b64_tr_b16 v[144:145],v14 offset:0
ds_read_b64_tr_b16 v[146:147],v14 offset:512
v_mfma_f32_16x16x32_bf16 v[44:47],v[176:179],v[172:175],v[44:47]
ds_read_b128 v[132:135],v12 offset:2048
s_add_u32 m0,s34,s40
v_mfma_f32_16x16x32_bf16 v[48:51],v[180:183],v[160:163],v[48:51]
ds_read_b128 v[136:139],v12 offset:4096
buffer_load_dwordx4 v4,s[8:11],s30 offen lds
v_mfma_f32_16x16x32_bf16 v[52:55],v[180:183],v[164:167],v[52:55]
ds_read_b128 v[140:143],v12 offset:6144
buffer_load_dwordx4 v5,s[8:11],s30 offen offset:1024 lds
v_mfma_f32_16x16x32_bf16 v[56:59],v[180:183],v[168:171],v[56:59]
ds_read_b64_tr_b16 v[148:149],v15 offset:0
ds_read_b64_tr_b16 v[150:151],v15 offset:512
v_mfma_f32_16x16x32_bf16 v[60:63],v[180:183],v[172:175],v[60:63]
buffer_load_dwordx4 v6,s[8:11],s30 offen offset:2048 lds
buffer_load_dwordx4 v7,s[8:11],s30 offen offset:3072 lds
s_add_u32 s34,s34,24576
s_cmp_eq_u32 s34,163840
s_cselect_b32 s34,16384,s34
s_add_u32 s30,s30,128
s_and_b32 s30,s30,0x7ff
s_add_u32 m0,s35,s41
s_nop 0
buffer_load_dwordx4 v8,s[12:15],s32 offen lds
buffer_load_dwordx4 v9,s[12:15],s32 offen offset:1024 lds
s_add_u32 s35,s35,24576
s_cmp_eq_u32 s35,163840
s_cselect_b32 s35,16384,s35
s_add_u32 s32,s32,393216
s_cmp_eq_u32 s32,6291456
s_cselect_b32 s32,0,s32
s_cmp_lg_u32 s31,0
s_cbranch_scc1 Lcqe26
s_cmp_lg_u32 s28,0
s_cbranch_scc1 Lcq25
v_mfma_f32_16x16x32_bf16 a[52:55],a[48:51],v[176:179],a[52:55]
s_branch Lcqe26
Lcq25:
v_mfma_f32_16x16x32_bf16 a[52:55],a[48:51],v[180:183],a[52:55]
Lcqe26:
s_waitcnt lgkmcnt(0)
v_mfma_f32_16x16x32_bf16 v[32:35],v[144:147],v[128:131],v[32:35]
v_add_u32 v13,s42,v13
ds_read_b128 v[160:163],v13 offset:0
v_mfma_f32_16x16x32_bf16 v[36:39],v[144:147],v[132:135],v[36:39]
ds_read_b64_tr_b16 v[176:177],v14 offset:4096
ds_read_b64_tr_b16 v[178:179],v14 offset:4608
v_mfma_f32_16x16x32_bf16 v[40:43],v[144:147],v[136:139],v[40:43]
ds_read_b128 v[164:167],v13 offset:2048
s_add_u32 m0,s34,s40
s_add_u32 s36,s36,24576
v_mfma_f32_16x16x32_bf16 v[44:47],v[144:147],v[140:143],v[44:47]
ds_read_b128 v[168:171],v13 offset:4096
buffer_load_dwordx4 v4,s[8:11],s30 offen lds
v_mfma_f32_16x16x32_bf16 v[48:51],v[148:151],v[128:131],v[48:51]
ds_read_b128 v[172:175],v13 offset:6144
buffer_load_dwordx4 v5,s[8:11],s30 offen offset:1024 lds
v_mfma_f32_16x16x32_bf16 v[52:55],v[148:151],v[132:135],v[52:55]
ds_read_b64_tr_b16 v[180:181],v15 offset:4096
ds_read_b64_tr_b16 v[182:183],v15 offset:4608
v_mfma_f32_16x16x32_bf16 v[56:59],v[148:151],v[136:139],v[56:59]
buffer_load_dwordx4 v6,s[8:11],s30 offen offset:2048 lds
v_mfma_f32_16x16x32_bf16 v[60:63],v[148:151],v[140:143],v[60:63]
s_cmp_eq_u32 s36,163840
s_cselect_b32 s42,s51,s50
s_cselect_b32 s36,16384,s36
s_cmp_lg_u32 s31,1
s_cbranch_scc1 Lcqe28
s_cmp_lg_u32 s28,0
s_cbranch_scc1 Lcq27
v_mfma_f32_16x16x32_bf16 a[52:55],a[48:51],v[144:147],0
s_branch Lcqe28
Lcq27:
s_nop 6
v_mfma_f32_16x16x32_bf16 a[52:55],a[48:51],v[148:151],0
Lcqe28:
s_waitcnt lgkmcnt(0)
v_mfma_f32_16x16x32_bf16 v[32:35],v[176:179],v[160:163],v[32:35]
v_add_u32 v12,s42,v12
v_add_u32 v14,s42,v14
v_mfma_f32_16x16x32_bf16 v[36:39],v[176:179],v[164:167],v[36:39]
v_add_u32 v15,s42,v15
s_waitcnt vmcnt(27)
s_barrier
ds_read_b128 v[128:131],v12 offset:0
v_mfma_f32_16x16x32_bf16 v[40:43],v[176:179],v[168:171],v[40:43]
ds_read_b64_tr_b16 v[144:145],v14 offset:0
ds_read_b64_tr_b16 v[146:147],v14 offset:512
v_mfma_f32_16x16x32_bf16 v[44:47],v[176:179],v[172:175],v[44:47]
ds_read_b128 v[132:135],v12 offset:2048
buffer_load_dwordx4 v7,s[8:11],s30 offen offset:3072 lds
v_mfma_f32_16x16x32_bf16 v[48:51],v[180:183],v[160:163],v[48:51]
ds_read_b128 v[136:139],v12 offset:4096
s_add_u32 s34,s34,24576
v_mfma_f32_16x16x32_bf16 v[52:55],v[180:183],v[164:167],v[52:55]
ds_read_b128 v[140:143],v12 offset:6144
v_mfma_f32_16x16x32_bf16 v[56:59],v[180:183],v[168:171],v[56:59]
ds_read_b64_tr_b16 v[148:149],v15 offset:0
ds_read_b64_tr_b16 v[150:151],v15 offset:512
v_mfma_f32_16x16x32_bf16 v[60:63],v[180:183],v[172:175],v[60:63]
s_cmp_eq_u32 s34,163840
s_cselect_b32 s34,16384,s34
s_add_u32 s30,s30,128
s_and_b32 s30,s30,0x7ff
s_add_u32 m0,s35,s41
s_nop 0
buffer_load_dwordx4 v8,s[12:15],s32 offen lds
buffer_load_dwordx4 v9,s[12:15],s32 offen offset:1024 lds
s_add_u32 s35,s35,24576
s_cmp_eq_u32 s35,163840
s_cselect_b32 s35,16384,s35
s_add_u32 s32,s32,393216
s_cmp_eq_u32 s32,6291456
s_cselect_b32 s32,0,s32
s_cmp_lg_u32 s31,1
s_cbranch_scc1 Lcqe30
s_cmp_lg_u32 s28,0
s_cbranch_scc1 Lcq29
v_mfma_f32_16x16x32_bf16 a[52:55],a[48:51],v[176:179],a[52:55]
s_branch Lcqe30
Lcq29:
v_mfma_f32_16x16x32_bf16 a[52:55],a[48:51],v[180:183],a[52:55]
Lcqe30:
s_waitcnt lgkmcnt(0)
v_mfma_f32_16x16x32_bf16 v[32:35],v[144:147],v[128:131],v[32:35]
v_add_u32 v13,s42,v13
ds_read_b128 v[160:163],v13 offset:0
v_mfma_f32_16x16x32_bf16 v[36:39],v[144:147],v[132:135],v[36:39]
ds_read_b64_tr_b16 v[176:177],v14 offset:4096
ds_read_b64_tr_b16 v[178:179],v14 offset:4608
v_mfma_f32_16x16x32_bf16 v[40:43],v[144:147],v[136:139],v[40:43]
ds_read_b128 v[164:167],v13 offset:2048
s_add_u32 m0,s34,s40
s_add_u32 s36,s36,24576
v_mfma_f32_16x16x32_bf16 v[44:47],v[144:147],v[140:143],v[44:47]
ds_read_b128 v[168:171],v13 offset:4096
buffer_load_dwordx4 v4,s[8:11],s30 offen lds
v_mfma_f32_16x16x32_bf16 v[48:51],v[148:151],v[128:131],v[48:51]
ds_read_b128 v[172:175],v13 offset:6144
buffer_load_dwordx4 v5,s[8:11],s30 offen offset:1024 lds
v_mfma_f32_16x16x32_bf16 v[52:55],v[148:151],v[132:135],v[52:55]
ds_read_b64_tr_b16 v[180:181],v15 offset:4096
ds_read_b64_tr_b16 v[182:183],v15 offset:4608
v_mfma_f32_16x16x32_bf16 v[56:59],v[148:151],v[136:139],v[56:59]
buffer_load_dwordx4 v6,s[8:11],s30 offen offset:2048 lds
v_mfma_f32_16x16x32_bf16 v[60:63],v[148:151],v[140:143],v[60:63]
s_cmp_eq_u32 s36,163840
s_cselect_b32 s42,s51,s50
s_cselect_b32 s36,16384,s36
s_waitcnt lgkmcnt(0)
v_mfma_f32_16x16x32_bf16 v[32:35],v[176:179],v[160:163],v[32:35]
v_add_u32 v12,s42,v12
v_add_u32 v14,s42,v14
v_mfma_f32_16x16x32_bf16 v[36:39],v[176:179],v[164:167],v[36:39]
v_add_u32 v15,s42,v15
s_waitcnt vmcnt(21)
s_barrier
s_cmp_lg_u32 s20,0
s_cbranch_scc1 Lpub31
s_mov_b32 s18,s85
s_mov_b32 s19,s84
s_lshl_b32 s18,s18,8
s_lshl_b32 s19,s19,2
s_add_u32 s18,s18,s19
s_add_u32 s18,s18,95420416
v_mov_b32 v1,0
v_mov_b32 v3,s94
s_mov_b64 exec,1
buffer_store_dword v3,v1,s[24:27],s18 offen sc1
s_mov_b64 exec,-1
Lpub31:
ds_read_b128 v[128:131],v12 offset:0
v_mfma_f32_16x16x32_bf16 v[40:43],v[176:179],v[168:171],v[40:43]
ds_read_b64_tr_b16 v[144:145],v14 offset:0
ds_read_b64_tr_b16 v[146:147],v14 offset:512
v_accvgpr_read_b32 v232,a52
v_mfma_f32_16x16x32_bf16 v[44:47],v[176:179],v[172:175],v[44:47]
ds_read_b128 v[132:135],v12 offset:2048
buffer_load_dwordx4 v7,s[8:11],s30 offen offset:3072 lds
v_cvt_pk_bf16_f32 v236,v232,v232
v_mfma_f32_16x16x32_bf16 v[48:51],v[180:183],v[160:163],v[48:51]
ds_read_b128 v[136:139],v12 offset:4096
s_add_u32 s34,s34,24576
v_and_b32 v236,0xffff0000,v236
v_mfma_f32_16x16x32_bf16 v[52:55],v[180:183],v[164:167],v[52:55]
ds_read_b128 v[140:143],v12 offset:6144
v_sub_f32 v236,v232,v236
v_cvt_pk_bf16_f32 v236,v232,v236
v_mfma_f32_16x16x32_bf16 v[56:59],v[180:183],v[168:171],v[56:59]
ds_read_b64_tr_b16 v[148:149],v15 offset:0
ds_read_b64_tr_b16 v[150:151],v15 offset:512
v_mfma_f32_16x16x32_bf16 v[60:63],v[180:183],v[172:175],v[60:63]
s_cmp_eq_u32 s34,163840
s_cselect_b32 s34,16384,s34
s_add_u32 s30,s30,128
s_and_b32 s30,s30,0x7ff
s_add_u32 m0,s35,s41
s_nop 0
buffer_load_dwordx4 v8,s[12:15],s32 offen lds
buffer_load_dwordx4 v9,s[12:15],s32 offen offset:1024 lds
s_add_u32 s35,s35,24576
s_cmp_eq_u32 s35,163840
s_cselect_b32 s35,16384,s35
s_add_u32 s32,s32,393216
s_cmp_eq_u32 s32,6291456
s_cselect_b32 s32,0,s32
s_lshl_b32 s18,s28,8
s_add_u32 s18,s18,s62
s_mov_b64 exec,0xffff
buffer_store_dword v236,v16,s[24:27],s18 offen sc1
s_mov_b64 exec,-1
s_waitcnt lgkmcnt(0)
v_mfma_f32_16x16x32_bf16 v[32:35],v[144:147],v[128:131],v[32:35]
v_add_u32 v13,s42,v13
ds_read_b128 v[160:163],v13 offset:0
v_mfma_f32_16x16x32_bf16 v[36:39],v[144:147],v[132:135],v[36:39]
ds_read_b64_tr_b16 v[176:177],v14 offset:4096
ds_read_b64_tr_b16 v[178:179],v14 offset:4608
v_mfma_f32_16x16x32_bf16 v[40:43],v[144:147],v[136:139],v[40:43]
ds_read_b128 v[164:167],v13 offset:2048
s_add_u32 m0,s34,s40
s_add_u32 s36,s36,24576
v_mfma_f32_16x16x32_bf16 v[44:47],v[144:147],v[140:143],v[44:47]
ds_read_b128 v[168:171],v13 offset:4096
buffer_load_dwordx4 v4,s[8:11],s30 offen lds
v_mfma_f32_16x16x32_bf16 v[48:51],v[148:151],v[128:131],v[48:51]
ds_read_b128 v[172:175],v13 offset:6144
buffer_load_dwordx4 v5,s[8:11],s30 offen offset:1024 lds
v_mfma_f32_16x16x32_bf16 v[52:55],v[148:151],v[132:135],v[52:55]
ds_read_b64_tr_b16 v[180:181],v15 offset:4096
ds_read_b64_tr_b16 v[182:183],v15 offset:4608
v_mfma_f32_16x16x32_bf16 v[56:59],v[148:151],v[136:139],v[56:59]
buffer_load_dwordx4 v6,s[8:11],s30 offen offset:2048 lds
v_mfma_f32_16x16x32_bf16 v[60:63],v[148:151],v[140:143],v[60:63]
s_cmp_eq_u32 s36,163840
s_cselect_b32 s42,s51,s50
s_cselect_b32 s36,16384,s36
s_waitcnt lgkmcnt(0)
v_mfma_f32_16x16x32_bf16 v[32:35],v[176:179],v[160:163],v[32:35]
v_add_u32 v12,s42,v12
v_add_u32 v14,s42,v14
v_mfma_f32_16x16x32_bf16 v[36:39],v[176:179],v[164:167],v[36:39]
v_add_u32 v15,s42,v15
s_waitcnt vmcnt(22)
s_barrier
ds_read_b128 v[128:131],v12 offset:0
v_mfma_f32_16x16x32_bf16 v[40:43],v[176:179],v[168:171],v[40:43]
ds_read_b64_tr_b16 v[144:145],v14 offset:0
ds_read_b64_tr_b16 v[146:147],v14 offset:512
v_mfma_f32_16x16x32_bf16 v[44:47],v[176:179],v[172:175],v[44:47]
ds_read_b128 v[132:135],v12 offset:2048
buffer_load_dwordx4 v7,s[8:11],s30 offen offset:3072 lds
v_mfma_f32_16x16x32_bf16 v[48:51],v[180:183],v[160:163],v[48:51]
ds_read_b128 v[136:139],v12 offset:4096
s_add_u32 s34,s34,24576
v_mfma_f32_16x16x32_bf16 v[52:55],v[180:183],v[164:167],v[52:55]
ds_read_b128 v[140:143],v12 offset:6144
v_mfma_f32_16x16x32_bf16 v[56:59],v[180:183],v[168:171],v[56:59]
ds_read_b64_tr_b16 v[148:149],v15 offset:0
ds_read_b64_tr_b16 v[150:151],v15 offset:512
v_mfma_f32_16x16x32_bf16 v[60:63],v[180:183],v[172:175],v[60:63]
s_cmp_eq_u32 s34,163840
s_cselect_b32 s34,16384,s34
s_add_u32 s30,s30,128
s_and_b32 s30,s30,0x7ff
s_add_u32 m0,s35,s41
s_nop 0
buffer_load_dwordx4 v8,s[12:15],s32 offen lds
buffer_load_dwordx4 v9,s[12:15],s32 offen offset:1024 lds
s_add_u32 s35,s35,24576
s_cmp_eq_u32 s35,163840
s_cselect_b32 s35,16384,s35
s_add_u32 s32,s32,393216
s_cmp_eq_u32 s32,6291456
s_cselect_b32 s32,0,s32
s_waitcnt lgkmcnt(0)
v_mfma_f32_16x16x32_bf16 v[32:35],v[144:147],v[128:131],v[32:35]
v_add_u32 v13,s42,v13
ds_read_b128 v[160:163],v13 offset:0
v_mfma_f32_16x16x32_bf16 v[36:39],v[144:147],v[132:135],v[36:39]
ds_read_b64_tr_b16 v[176:177],v14 offset:4096
ds_read_b64_tr_b16 v[178:179],v14 offset:4608
v_mfma_f32_16x16x32_bf16 v[40:43],v[144:147],v[136:139],v[40:43]
ds_read_b128 v[164:167],v13 offset:2048
s_add_u32 m0,s34,s40
s_add_u32 s36,s36,24576
v_mfma_f32_16x16x32_bf16 v[44:47],v[144:147],v[140:143],v[44:47]
ds_read_b128 v[168:171],v13 offset:4096
buffer_load_dwordx4 v4,s[8:11],s30 offen lds
v_mfma_f32_16x16x32_bf16 v[48:51],v[148:151],v[128:131],v[48:51]
ds_read_b128 v[172:175],v13 offset:6144
buffer_load_dwordx4 v5,s[8:11],s30 offen offset:1024 lds
v_mfma_f32_16x16x32_bf16 v[52:55],v[148:151],v[132:135],v[52:55]
ds_read_b64_tr_b16 v[180:181],v15 offset:4096
ds_read_b64_tr_b16 v[182:183],v15 offset:4608
v_mfma_f32_16x16x32_bf16 v[56:59],v[148:151],v[136:139],v[56:59]
buffer_load_dwordx4 v6,s[8:11],s30 offen offset:2048 lds
v_mfma_f32_16x16x32_bf16 v[60:63],v[148:151],v[140:143],v[60:63]
s_cmp_eq_u32 s36,163840
s_cselect_b32 s42,s51,s50
s_cselect_b32 s36,16384,s36
s_waitcnt lgkmcnt(0)
v_mfma_f32_16x16x32_bf16 v[32:35],v[176:179],v[160:163],v[32:35]
v_add_u32 v12,s42,v12
v_add_u32 v14,s42,v14
v_mfma_f32_16x16x32_bf16 v[36:39],v[176:179],v[164:167],v[36:39]
v_add_u32 v15,s42,v15
s_waitcnt vmcnt(22)
s_barrier
ds_read_b128 v[128:131],v12 offset:0
v_mfma_f32_16x16x32_bf16 v[40:43],v[176:179],v[168:171],v[40:43]
ds_read_b64_tr_b16 v[144:145],v14 offset:0
ds_read_b64_tr_b16 v[146:147],v14 offset:512
v_mfma_f32_16x16x32_bf16 v[44:47],v[176:179],v[172:175],v[44:47]
ds_read_b128 v[132:135],v12 offset:2048
buffer_load_dwordx4 v7,s[8:11],s30 offen offset:3072 lds
v_mfma_f32_16x16x32_bf16 v[48:51],v[180:183],v[160:163],v[48:51]
ds_read_b128 v[136:139],v12 offset:4096
s_add_u32 s34,s34,24576
v_mfma_f32_16x16x32_bf16 v[52:55],v[180:183],v[164:167],v[52:55]
ds_read_b128 v[140:143],v12 offset:6144
v_mfma_f32_16x16x32_bf16 v[56:59],v[180:183],v[168:171],v[56:59]
ds_read_b64_tr_b16 v[148:149],v15 offset:0
ds_read_b64_tr_b16 v[150:151],v15 offset:512
v_mfma_f32_16x16x32_bf16 v[60:63],v[180:183],v[172:175],v[60:63]
s_cmp_eq_u32 s34,163840
s_cselect_b32 s34,16384,s34
s_add_u32 s30,s30,128
s_and_b32 s30,s30,0x7ff
s_add_u32 m0,s35,s41
s_nop 0
buffer_load_dwordx4 v8,s[12:15],s32 offen lds
buffer_load_dwordx4 v9,s[12:15],s32 offen offset:1024 lds
s_add_u32 s35,s35,24576
s_cmp_eq_u32 s35,163840
s_cselect_b32 s35,16384,s35
s_add_u32 s32,s32,393216
s_cmp_eq_u32 s32,6291456
s_cselect_b32 s32,0,s32
buffer_load_dword v26,v28,s[24:27],s49 offen sc1
s_waitcnt lgkmcnt(0)
v_mfma_f32_16x16x32_bf16 v[32:35],v[144:147],v[128:131],v[32:35]
v_add_u32 v13,s42,v13
ds_read_b128 v[160:163],v13 offset:0
v_mfma_f32_16x16x32_bf16 v[36:39],v[144:147],v[132:135],v[36:39]
ds_read_b64_tr_b16 v[176:177],v14 offset:4096
ds_read_b64_tr_b16 v[178:179],v14 offset:4608
v_mfma_f32_16x16x32_bf16 v[40:43],v[144:147],v[136:139],v[40:43]
ds_read_b128 v[164:167],v13 offset:2048
s_add_u32 m0,s34,s40
s_add_u32 s36,s36,24576
v_mfma_f32_16x16x32_bf16 v[44:47],v[144:147],v[140:143],v[44:47]
ds_read_b128 v[168:171],v13 offset:4096
buffer_load_dwordx4 v4,s[8:11],s30 offen lds
v_mfma_f32_16x16x32_bf16 v[48:51],v[148:151],v[128:131],v[48:51]
ds_read_b128 v[172:175],v13 offset:6144
buffer_load_dwordx4 v5,s[8:11],s30 offen offset:1024 lds
v_mfma_f32_16x16x32_bf16 v[52:55],v[148:151],v[132:135],v[52:55]
ds_read_b64_tr_b16 v[180:181],v15 offset:4096
ds_read_b64_tr_b16 v[182:183],v15 offset:4608
v_mfma_f32_16x16x32_bf16 v[56:59],v[148:151],v[136:139],v[56:59]
buffer_load_dwordx4 v6,s[8:11],s30 offen offset:2048 lds
v_mfma_f32_16x16x32_bf16 v[60:63],v[148:151],v[140:143],v[60:63]
s_cmp_eq_u32 s36,163840
s_cselect_b32 s42,s51,s50
s_cselect_b32 s36,16384,s36
s_waitcnt lgkmcnt(0)
v_mfma_f32_16x16x32_bf16 v[32:35],v[176:179],v[160:163],v[32:35]
v_add_u32 v12,s42,v12
v_add_u32 v14,s42,v14
v_mfma_f32_16x16x32_bf16 v[36:39],v[176:179],v[164:167],v[36:39]
v_add_u32 v15,s42,v15
s_waitcnt vmcnt(16)
s_barrier
s_cmp_lg_u32 s20,0
s_cbranch_scc1 Lpub32
s_mov_b32 s18,s85
s_mov_b32 s19,s84
s_lshl_b32 s18,s18,8
s_lshl_b32 s19,s19,2
s_add_u32 s18,s18,s19
s_add_u32 s18,s18,95436800
v_mov_b32 v1,0
v_mov_b32 v3,s94
s_mov_b64 exec,1
buffer_store_dword v3,v1,s[24:27],s18 offen sc1
s_mov_b64 exec,-1
Lpub32:
ds_read_b128 v[128:131],v12 offset:0
v_mfma_f32_16x16x32_bf16 v[40:43],v[176:179],v[168:171],v[40:43]
ds_read_b64_tr_b16 v[144:145],v14 offset:0
ds_read_b64_tr_b16 v[146:147],v14 offset:512
v_mfma_f32_16x16x32_bf16 v[44:47],v[176:179],v[172:175],v[44:47]
ds_read_b128 v[132:135],v12 offset:2048
buffer_load_dwordx4 v7,s[8:11],s30 offen offset:3072 lds
v_mfma_f32_16x16x32_bf16 v[48:51],v[180:183],v[160:163],v[48:51]
ds_read_b128 v[136:139],v12 offset:4096
s_add_u32 s34,s34,24576
v_mfma_f32_16x16x32_bf16 v[52:55],v[180:183],v[164:167],v[52:55]
ds_read_b128 v[140:143],v12 offset:6144
v_mfma_f32_16x16x32_bf16 v[56:59],v[180:183],v[168:171],v[56:59]
ds_read_b64_tr_b16 v[148:149],v15 offset:0
ds_read_b64_tr_b16 v[150:151],v15 offset:512
v_mfma_f32_16x16x32_bf16 v[60:63],v[180:183],v[172:175],v[60:63]
s_cmp_eq_u32 s34,163840
s_cselect_b32 s34,16384,s34
s_add_u32 s30,s30,128
s_and_b32 s30,s30,0x7ff
s_add_u32 m0,s35,s41
s_nop 0
buffer_load_dwordx4 v8,s[12:15],s32 offen lds
buffer_load_dwordx4 v9,s[12:15],s32 offen offset:1024 lds
s_add_u32 s35,s35,24576
s_cmp_eq_u32 s35,163840
s_cselect_b32 s35,16384,s35
s_add_u32 s32,s32,393216
s_cmp_eq_u32 s32,6291456
s_cselect_b32 s32,0,s32
s_waitcnt lgkmcnt(0)
v_mfma_f32_16x16x32_bf16 v[32:35],v[144:147],v[128:131],v[32:35]
v_add_u32 v13,s42,v13
ds_read_b128 v[160:163],v13 offset:0
v_mfma_f32_16x16x32_bf16 v[36:39],v[144:147],v[132:135],v[36:39]
ds_read_b64_tr_b16 v[176:177],v14 offset:4096
ds_read_b64_tr_b16 v[178:179],v14 offset:4608
v_mfma_f32_16x16x32_bf16 v[40:43],v[144:147],v[136:139],v[40:43]
ds_read_b128 v[164:167],v13 offset:2048
s_add_u32 s36,s36,24576
v_mfma_f32_16x16x32_bf16 v[44:47],v[144:147],v[140:143],v[44:47]
ds_read_b128 v[168:171],v13 offset:4096
v_mfma_f32_16x16x32_bf16 v[48:51],v[148:151],v[128:131],v[48:51]
ds_read_b128 v[172:175],v13 offset:6144
v_mfma_f32_16x16x32_bf16 v[52:55],v[148:151],v[132:135],v[52:55]
ds_read_b64_tr_b16 v[180:181],v15 offset:4096
ds_read_b64_tr_b16 v[182:183],v15 offset:4608
v_mfma_f32_16x16x32_bf16 v[56:59],v[148:151],v[136:139],v[56:59]
v_mfma_f32_16x16x32_bf16 v[60:63],v[148:151],v[140:143],v[60:63]
s_cmp_eq_u32 s36,163840
s_cselect_b32 s42,s51,s50
s_cselect_b32 s36,16384,s36
s_waitcnt lgkmcnt(0)
v_mfma_f32_16x16x32_bf16 v[32:35],v[176:179],v[160:163],v[32:35]
v_add_u32 v12,s42,v12
v_add_u32 v14,s42,v14
v_mfma_f32_16x16x32_bf16 v[36:39],v[176:179],v[164:167],v[36:39]
v_add_u32 v15,s42,v15
s_waitcnt vmcnt(6)
s_barrier
s_mov_b32 s39,131072
Lspl34:
v_cmp_ne_u32 s[90:91],s94,v26
s_nop 1
s_cmp_eq_u64 s[90:91],0
s_cbranch_scc1 Lsok33
s_sleep 1
buffer_load_dword v26,v28,s[24:27],s49 offen sc1
s_waitcnt vmcnt(0)
s_sub_u32 s39,s39,1
s_cmp_lg_u32 s39,0
s_cbranch_scc1 Lspl34
Lsok33:
ds_read_b128 v[128:131],v12 offset:0
v_mfma_f32_16x16x32_bf16 v[40:43],v[176:179],v[168:171],v[40:43]
ds_read_b64_tr_b16 v[144:145],v14 offset:0
ds_read_b64_tr_b16 v[146:147],v14 offset:512
v_mfma_f32_16x16x32_bf16 v[44:47],v[176:179],v[172:175],v[44:47]
ds_read_b128 v[132:135],v12 offset:2048
buffer_load_dwordx4 v[64:67],v25,s[24:27],s60 offen sc1
v_mfma_f32_16x16x32_bf16 v[48:51],v[180:183],v[160:163],v[48:51]
ds_read_b128 v[136:139],v12 offset:4096
s_add_u32 s60,s60,1081344
v_mfma_f32_16x16x32_bf16 v[52:55],v[180:183],v[164:167],v[52:55]
ds_read_b128 v[140:143],v12 offset:6144
buffer_load_dwordx4 v[68:71],v25,s[24:27],s60 offen sc1
v_mfma_f32_16x16x32_bf16 v[56:59],v[180:183],v[168:171],v[56:59]
ds_read_b64_tr_b16 v[148:149],v15 offset:0
ds_read_b64_tr_b16 v[150:151],v15 offset:512
v_mfma_f32_16x16x32_bf16 v[60:63],v[180:183],v[172:175],v[60:63]
s_add_u32 s60,s60,1081344
buffer_load_dwordx4 v[72:75],v25,s[24:27],s60 offen sc1
s_add_u32 s60,s60,1081344
buffer_load_dwordx4 v[76:79],v25,s[24:27],s60 offen sc1
buffer_load_dwordx4 v[80:83],v29,s[24:27],s61 offen sc1
s_waitcnt lgkmcnt(0)
v_mfma_f32_16x16x32_bf16 v[32:35],v[144:147],v[128:131],v[32:35]
v_add_u32 v13,s42,v13
ds_read_b128 v[160:163],v13 offset:0
v_mfma_f32_16x16x32_bf16 v[36:39],v[144:147],v[132:135],v[36:39]
ds_read_b64_tr_b16 v[176:177],v14 offset:4096
ds_read_b64_tr_b16 v[178:179],v14 offset:4608
v_mfma_f32_16x16x32_bf16 v[40:43],v[144:147],v[136:139],v[40:43]
ds_read_b128 v[164:167],v13 offset:2048
s_add_u32 s36,s36,24576
v_mfma_f32_16x16x32_bf16 v[44:47],v[144:147],v[140:143],v[44:47]
ds_read_b128 v[168:171],v13 offset:4096
v_mfma_f32_16x16x32_bf16 v[48:51],v[148:151],v[128:131],v[48:51]
ds_read_b128 v[172:175],v13 offset:6144
v_mfma_f32_16x16x32_bf16 v[52:55],v[148:151],v[132:135],v[52:55]
ds_read_b64_tr_b16 v[180:181],v15 offset:4096
ds_read_b64_tr_b16 v[182:183],v15 offset:4608
v_mfma_f32_16x16x32_bf16 v[56:59],v[148:151],v[136:139],v[56:59]
v_mfma_f32_16x16x32_bf16 v[60:63],v[148:151],v[140:143],v[60:63]
s_cmp_eq_u32 s36,163840
s_cselect_b32 s42,s51,s50
s_cselect_b32 s36,16384,s36
s_waitcnt lgkmcnt(0)
v_mfma_f32_16x16x32_bf16 v[32:35],v[176:179],v[160:163],v[32:35]
v_add_u32 v12,s42,v12
v_add_u32 v14,s42,v14
v_mfma_f32_16x16x32_bf16 v[36:39],v[176:179],v[164:167],v[36:39]
v_add_u32 v15,s42,v15
s_waitcnt vmcnt(11)
s_barrier
ds_read_b128 v[128:131],v12 offset:0
v_mfma_f32_16x16x32_bf16 v[40:43],v[176:179],v[168:171],v[40:43]
ds_read_b64_tr_b16 v[144:145],v14 offset:0
ds_read_b64_tr_b16 v[146:147],v14 offset:512
v_mfma_f32_16x16x32_bf16 v[44:47],v[176:179],v[172:175],v[44:47]
ds_read_b128 v[132:135],v12 offset:2048
buffer_load_dword v27,v28,s[24:27],s52 offen sc1
v_mfma_f32_16x16x32_bf16 v[48:51],v[180:183],v[160:163],v[48:51]
ds_read_b128 v[136:139],v12 offset:4096
v_mfma_f32_16x16x32_bf16 v[52:55],v[180:183],v[164:167],v[52:55]
ds_read_b128 v[140:143],v12 offset:6144
v_mfma_f32_16x16x32_bf16 v[56:59],v[180:183],v[168:171],v[56:59]
ds_read_b64_tr_b16 v[148:149],v15 offset:0
ds_read_b64_tr_b16 v[150:151],v15 offset:512
v_mfma_f32_16x16x32_bf16 v[60:63],v[180:183],v[172:175],v[60:63]
s_waitcnt lgkmcnt(0)
v_mfma_f32_16x16x32_bf16 v[32:35],v[144:147],v[128:131],v[32:35]
v_add_u32 v13,s42,v13
ds_read_b128 v[160:163],v13 offset:0
v_mfma_f32_16x16x32_bf16 v[36:39],v[144:147],v[132:135],v[36:39]
ds_read_b64_tr_b16 v[176:177],v14 offset:4096
ds_read_b64_tr_b16 v[178:179],v14 offset:4608
v_mfma_f32_16x16x32_bf16 v[40:43],v[144:147],v[136:139],v[40:43]
ds_read_b128 v[164:167],v13 offset:2048
s_add_u32 s36,s36,24576
v_mfma_f32_16x16x32_bf16 v[44:47],v[144:147],v[140:143],v[44:47]
ds_read_b128 v[168:171],v13 offset:4096
v_mfma_f32_16x16x32_bf16 v[48:51],v[148:151],v[128:131],v[48:51]
ds_read_b128 v[172:175],v13 offset:6144
v_mfma_f32_16x16x32_bf16 v[52:55],v[148:151],v[132:135],v[52:55]
ds_read_b64_tr_b16 v[180:181],v15 offset:4096
ds_read_b64_tr_b16 v[182:183],v15 offset:4608
v_mfma_f32_16x16x32_bf16 v[56:59],v[148:151],v[136:139],v[56:59]
v_mfma_f32_16x16x32_bf16 v[60:63],v[148:151],v[140:143],v[60:63]
s_cmp_eq_u32 s36,163840
s_cselect_b32 s42,s51,s50
s_cselect_b32 s36,16384,s36
s_waitcnt vmcnt(1)
s_waitcnt lgkmcnt(0)
v_mfma_f32_16x16x32_bf16 v[32:35],v[176:179],v[160:163],v[32:35]
v_add_u32 v12,s42,v12
v_add_u32 v14,s42,v14
v_mfma_f32_16x16x32_bf16 v[36:39],v[176:179],v[164:167],v[36:39]
v_add_u32 v15,s42,v15
s_waitcnt vmcnt(12)
s_barrier
ds_read_b128 v[128:131],v12 offset:0
v_mfma_f32_16x16x32_bf16 v[40:43],v[176:179],v[168:171],v[40:43]
ds_read_b64_tr_b16 v[144:145],v14 offset:0
ds_read_b64_tr_b16 v[146:147],v14 offset:512
v_add_f32 v64,v64,v68
v_add_f32 v65,v65,v69
v_add_f32 v66,v66,v70
v_add_f32 v67,v67,v71
v_add_f32 v72,v72,v76
v_mfma_f32_16x16x32_bf16 v[44:47],v[176:179],v[172:175],v[44:47]
ds_read_b128 v[132:135],v12 offset:2048
v_add_f32 v73,v73,v77
v_add_f32 v74,v74,v78
v_add_f32 v75,v75,v79
v_add_f32 v64,v64,v72
v_add_f32 v65,v65,v73
v_add_f32 v66,v66,v74
v_mfma_f32_16x16x32_bf16 v[48:51],v[180:183],v[160:163],v[48:51]
ds_read_b128 v[136:139],v12 offset:4096
v_add_f32 v67,v67,v75
v_add_f32_dpp v80,v80,v80 row_ror:8 row_mask:0xf bank_mask:0xf
v_add_f32_dpp v81,v81,v81 row_ror:8 row_mask:0xf bank_mask:0xf
v_add_f32_dpp v82,v82,v82 row_ror:8 row_mask:0xf bank_mask:0xf
v_add_f32_dpp v83,v83,v83 row_ror:8 row_mask:0xf bank_mask:0xf
v_add_f32_dpp v80,v80,v80 row_ror:4 row_mask:0xf bank_mask:0xf
v_mfma_f32_16x16x32_bf16 v[52:55],v[180:183],v[164:167],v[52:55]
ds_read_b128 v[140:143],v12 offset:6144
v_add_f32_dpp v81,v81,v81 row_ror:4 row_mask:0xf bank_mask:0xf
v_add_f32_dpp v82,v82,v82 row_ror:4 row_mask:0xf bank_mask:0xf
v_add_f32_dpp v83,v83,v83 row_ror:4 row_mask:0xf bank_mask:0xf
v_add_f32_dpp v80,v80,v80 row_ror:2 row_mask:0xf bank_mask:0xf
v_add_f32_dpp v81,v81,v81 row_ror:2 row_mask:0xf bank_mask:0xf
v_add_f32_dpp v82,v82,v82 row_ror:2 row_mask:0xf bank_mask:0xf
v_mfma_f32_16x16x32_bf16 v[56:59],v[180:183],v[168:171],v[56:59]
ds_read_b64_tr_b16 v[148:149],v15 offset:0
ds_read_b64_tr_b16 v[150:151],v15 offset:512
v_add_f32_dpp v83,v83,v83 row_ror:2 row_mask:0xf bank_mask:0xf
v_add_f32_dpp v80,v80,v80 row_ror:1 row_mask:0xf bank_mask:0xf
v_add_f32_dpp v81,v81,v81 row_ror:1 row_mask:0xf bank_mask:0xf
v_add_f32_dpp v82,v82,v82 row_ror:1 row_mask:0xf bank_mask:0xf
v_add_f32_dpp v83,v83,v83 row_ror:1 row_mask:0xf bank_mask:0xf
v_mfma_f32_16x16x32_bf16 v[60:63],v[180:183],v[172:175],v[60:63]
v_mov_b32 v84,v64
v_mov_b32 v85,v65
v_mov_b32 v86,v66
v_mov_b32 v87,v67
s_waitcnt lgkmcnt(0)
v_mfma_f32_16x16x32_bf16 v[32:35],v[144:147],v[128:131],v[32:35]
v_add_u32 v13,s42,v13
ds_read_b128 v[160:163],v13 offset:0
v_mfma_f32_16x16x32_bf16 v[36:39],v[144:147],v[132:135],v[36:39]
ds_read_b64_tr_b16 v[176:177],v14 offset:4096
ds_read_b64_tr_b16 v[178:179],v14 offset:4608
s_add_u32 s36,s36,24576
s_cmp_eq_u32 s36,163840
s_cselect_b32 s42,s51,s50
s_cselect_b32 s36,16384,s36
v_permlane32_swap_b32 v64,v84
v_mfma_f32_16x16x32_bf16 v[40:43],v[144:147],v[136:139],v[40:43]
ds_read_b128 v[164:167],v13 offset:2048
v_permlane32_swap_b32 v65,v85
v_permlane32_swap_b32 v66,v86
v_permlane32_swap_b32 v67,v87
v_add_f32 v64,v64,v84
v_mfma_f32_16x16x32_bf16 v[44:47],v[144:147],v[140:143],v[44:47]
ds_read_b128 v[168:171],v13 offset:4096
v_add_f32 v65,v65,v85
v_add_f32 v66,v66,v86
v_add_f32 v67,v67,v87
v_mov_b32 v84,v64
v_mov_b32 v85,v65
v_mov_b32 v86,v66
v_mov_b32 v87,v67
v_mfma_f32_16x16x32_bf16 v[48:51],v[148:151],v[128:131],v[48:51]
ds_read_b128 v[172:175],v13 offset:6144
v_permlane16_swap_b32 v64,v84
v_permlane16_swap_b32 v65,v85
v_permlane16_swap_b32 v66,v86
v_mfma_f32_16x16x32_bf16 v[52:55],v[148:151],v[132:135],v[52:55]
ds_read_b64_tr_b16 v[180:181],v15 offset:4096
ds_read_b64_tr_b16 v[182:183],v15 offset:4608
v_permlane16_swap_b32 v67,v87
v_add_f32 v64,v64,v84
v_add_f32 v65,v65,v85
v_add_f32 v66,v66,v86
v_add_f32 v67,v67,v87
v_mfma_f32_16x16x32_bf16 v[56:59],v[148:151],v[136:139],v[56:59]
v_cvt_pk_bf16_f32 v68,v64,v65
v_cvt_pk_bf16_f32 v69,v66,v67
v_cvt_pk_bf16_f32 v70,v80,v81
v_cvt_pk_bf16_f32 v71,v82,v83
v_and_b32 v3,3,v2
v_cmp_eq_u32 vcc,0,v3
v_cmp_eq_u32 s[90:91],1,v3
v_lshlrev_b32 v1,4,v2
v_mfma_f32_16x16x32_bf16 v[60:63],v[148:151],v[140:143],v[60:63]
v_cndmask_b32 v3,0,v24,s[90:91]
v_cndmask_b32 v70,v3,v70,vcc
v_cndmask_b32 v71,v3,v71,vcc
s_lshl_b32 s18,s20,8
s_add_u32 s18,s18,s92
s_mov_b64 exec,0xffff
buffer_store_dwordx2 v[68:69],v1,s[24:27],s18 offen sc1
s_mov_b64 exec,-1
s_lshr_b32 s18,s84,3
s_lshl_b32 s18,s18,2
s_add_u32 s18,s18,s20
s_cmp_lg_u32 s18,1
s_cbranch_scc1 Lhz22
buffer_store_dwordx2 v[70:71],v1,s[24:27],s93 offen sc1
Lhz22:
s_waitcnt lgkmcnt(0)
v_mfma_f32_16x16x32_bf16 v[32:35],v[176:179],v[160:163],v[32:35]
v_add_u32 v12,s42,v12
v_add_u32 v14,s42,v14
v_mfma_f32_16x16x32_bf16 v[36:39],v[176:179],v[164:167],v[36:39]
v_add_u32 v15,s42,v15
s_waitcnt vmcnt(1)
s_barrier
s_mov_b32 s39,131072
Lspl36:
v_cmp_ne_u32 s[90:91],s94,v27
s_nop 1
s_cmp_eq_u64 s[90:91],0
s_cbranch_scc1 Lsok35
s_sleep 1
buffer_load_dword v27,v28,s[24:27],s52 offen sc1
s_waitcnt vmcnt(0)
s_sub_u32 s39,s39,1
s_cmp_lg_u32 s39,0
s_cbranch_scc1 Lspl36
Lsok35:
ds_read_b128 v[128:131],v12 offset:0
v_mfma_f32_16x16x32_bf16 v[40:43],v[176:179],v[168:171],v[40:43]
ds_read_b64_tr_b16 v[144:145],v14 offset:0
ds_read_b64_tr_b16 v[146:147],v14 offset:512
v_mfma_f32_16x16x32_bf16 v[44:47],v[176:179],v[172:175],v[44:47]
ds_read_b128 v[132:135],v12 offset:2048
buffer_load_dwordx4 a[0:3],v23,s[24:27],s62 offen sc1
v_mfma_f32_16x16x32_bf16 v[48:51],v[180:183],v[160:163],v[48:51]
ds_read_b128 v[136:139],v12 offset:4096
v_mfma_f32_16x16x32_bf16 v[52:55],v[180:183],v[164:167],v[52:55]
ds_read_b128 v[140:143],v12 offset:6144
buffer_load_dwordx4 a[4:7],v23,s[24:27],s62 offen offset:256 sc1
v_mfma_f32_16x16x32_bf16 v[56:59],v[180:183],v[168:171],v[56:59]
ds_read_b64_tr_b16 v[148:149],v15 offset:0
ds_read_b64_tr_b16 v[150:151],v15 offset:512
v_mfma_f32_16x16x32_bf16 v[60:63],v[180:183],v[172:175],v[60:63]
s_waitcnt lgkmcnt(0)
v_mfma_f32_16x16x32_bf16 v[32:35],v[144:147],v[128:131],v[32:35]
v_add_u32 v13,s42,v13
ds_read_b128 v[160:163],v13 offset:0
v_mfma_f32_16x16x32_bf16 v[36:39],v[144:147],v[132:135],v[36:39]
ds_read_b64_tr_b16 v[176:177],v14 offset:4096
ds_read_b64_tr_b16 v[178:179],v14 offset:4608
s_add_u32 s36,s36,24576
v_mfma_f32_16x16x32_bf16 v[40:43],v[144:147],v[136:139],v[40:43]
ds_read_b128 v[164:167],v13 offset:2048
s_mov_b32 s4,s70
v_mfma_f32_16x16x32_bf16 v[44:47],v[144:147],v[140:143],v[44:47]
ds_read_b128 v[168:171],v13 offset:4096
s_mov_b32 s5,s71
v_mfma_f32_16x16x32_bf16 v[48:51],v[148:151],v[128:131],v[48:51]
ds_read_b128 v[172:175],v13 offset:6144
s_mov_b32 s6,2097152
v_mfma_f32_16x16x32_bf16 v[52:55],v[148:151],v[132:135],v[52:55]
ds_read_b64_tr_b16 v[180:181],v15 offset:4096
ds_read_b64_tr_b16 v[182:183],v15 offset:4608
v_mfma_f32_16x16x32_bf16 v[56:59],v[148:151],v[136:139],v[56:59]
s_mov_b32 s7,0x00020000
s_lshl_b32 s39,s2,2
v_mfma_f32_16x16x32_bf16 v[60:63],v[148:151],v[140:143],v[60:63]
s_add_u32 s39,s39,s20
s_lshl_b32 s39,s39,11
v_lshlrev_b32 v0,7,v30
buffer_load_dword a64,v0,s[4:7],s39 offen
s_cmp_eq_u32 s36,163840
s_cselect_b32 s42,s51,s50
s_cselect_b32 s36,16384,s36
s_waitcnt lgkmcnt(0)
v_mfma_f32_16x16x32_bf16 v[32:35],v[176:179],v[160:163],v[32:35]
v_mfma_f32_16x16x32_bf16 v[36:39],v[176:179],v[164:167],v[36:39]
v_mfma_f32_16x16x32_bf16 v[40:43],v[176:179],v[168:171],v[40:43]
v_mfma_f32_16x16x32_bf16 v[44:47],v[176:179],v[172:175],v[44:47]
v_mfma_f32_16x16x32_bf16 v[48:51],v[180:183],v[160:163],v[48:51]
v_mfma_f32_16x16x32_bf16 v[52:55],v[180:183],v[164:167],v[52:55]
v_mfma_f32_16x16x32_bf16 v[56:59],v[180:183],v[168:171],v[56:59]
v_mfma_f32_16x16x32_bf16 v[60:63],v[180:183],v[172:175],v[60:63]
s_waitcnt vmcnt(1)
v_mfma_f32_16x16x32_bf16 v[32:35],a[0:3],a[24:27],v[32:35]
v_mfma_f32_16x16x32_bf16 v[36:39],a[0:3],a[28:31],v[36:39]
v_mfma_f32_16x16x32_bf16 v[40:43],a[0:3],a[32:35],v[40:43]
v_mfma_f32_16x16x32_bf16 v[44:47],a[0:3],a[36:39],v[44:47]
v_mfma_f32_16x16x32_bf16 v[48:51],a[4:7],a[24:27],v[48:51]
v_mfma_f32_16x16x32_bf16 v[52:55],a[4:7],a[28:31],v[52:55]
v_mfma_f32_16x16x32_bf16 v[56:59],a[4:7],a[32:35],v[56:59]
v_mfma_f32_16x16x32_bf16 v[60:63],a[4:7],a[36:39],v[60:63]
s_barrier
s_mov_b32 s12,s70
s_mov_b32 s13,s71
s_mov_b32 s14,2097152
s_lshl_b32 s18,s20,5
s_lshl_b32 s19,s85,7
v_lshrrev_b32 v3,3,v2
v_add_u32 v3,s18,v3
v_mul_u32_u24 v3,2048,v3
v_add_u32 v3,s19,v3
v_and_b32 v1,1,v31
v_lshlrev_b32 v1,1,v1
v_and_b32 v0,7,v2
v_xor_b32 v1,v1,v0
v_lshl_add_u32 v8,v1,4,v3
v_xor_b32 v1,4,v1
v_lshl_add_u32 v9,v1,4,v3
v_add_u32 v9,15360,v9
v_add_u32 v10,30720,v8
v_add_u32 v11,30720,v9
s_mov_b32 s32,0
s_mov_b32 s35,0
s_lshl_b32 s41,s20,12
s_add_u32 s41,s41,32768
s_lshl_b32 s18,s2,2
s_add_u32 s18,s18,s20
s_lshl_b32 s18,s18,12
s_add_u32 s18,s18,35717120
v_lshlrev_b32 v29,4,v2
buffer_store_dwordx4 v[252:255],v29,s[24:27],s18 offen sc1
buffer_store_dwordx4 v[252:255],v29,s[24:27],s18 offen offset:1024 sc1
buffer_store_dwordx4 v[252:255],v29,s[24:27],s18 offen offset:2048 sc1
buffer_store_dwordx4 v[252:255],v29,s[24:27],s18 offen offset:3072 sc1
s_mul_i32 s48,s54,6144
s_add_u32 s48,s48,33619968
s_add_u32 s49,s48,4096
v_pk_mul_f32 v[32:33],v[32:33],v[248:249] op_sel:[0,0] op_sel_hi:[1,0]
v_pk_mul_f32 v[34:35],v[34:35],v[248:249] op_sel:[0,0] op_sel_hi:[1,0]
v_pk_mul_f32 v[48:49],v[48:49],v[248:249] op_sel:[0,0] op_sel_hi:[1,0]
v_pk_mul_f32 v[50:51],v[50:51],v[248:249] op_sel:[0,0] op_sel_hi:[1,0]
v_pk_mul_f32 v[36:37],v[36:37],v[248:249] op_sel:[0,1] op_sel_hi:[1,1]
v_pk_mul_f32 v[38:39],v[38:39],v[248:249] op_sel:[0,1] op_sel_hi:[1,1]
v_pk_mul_f32 v[52:53],v[52:53],v[248:249] op_sel:[0,1] op_sel_hi:[1,1]
v_pk_mul_f32 v[54:55],v[54:55],v[248:249] op_sel:[0,1] op_sel_hi:[1,1]
v_pk_mul_f32 v[40:41],v[40:41],v[250:251] op_sel:[0,0] op_sel_hi:[1,0]
v_pk_mul_f32 v[42:43],v[42:43],v[250:251] op_sel:[0,0] op_sel_hi:[1,0]
s_add_u32 m0,s35,s41
s_nop 0
buffer_load_dwordx4 v8,s[12:15],s32 offen lds
v_pk_mul_f32 v[56:57],v[56:57],v[250:251] op_sel:[0,0] op_sel_hi:[1,0]
v_pk_mul_f32 v[58:59],v[58:59],v[250:251] op_sel:[0,0] op_sel_hi:[1,0]
v_pk_mul_f32 v[44:45],v[44:45],v[250:251] op_sel:[0,1] op_sel_hi:[1,1]
v_pk_mul_f32 v[46:47],v[46:47],v[250:251] op_sel:[0,1] op_sel_hi:[1,1]
v_pk_mul_f32 v[60:61],v[60:61],v[250:251] op_sel:[0,1] op_sel_hi:[1,1]
v_pk_mul_f32 v[62:63],v[62:63],v[250:251] op_sel:[0,1] op_sel_hi:[1,1]
v_cvt_pk_bf16_f32 v128,v32,v33
v_cvt_pk_bf16_f32 v129,v34,v35
v_cvt_pk_bf16_f32 v130,v48,v49
v_cvt_pk_bf16_f32 v131,v50,v51
buffer_load_dwordx4 v9,s[12:15],s32 offen offset:1024 lds
v_cvt_pk_bf16_f32 v132,v36,v37
v_cvt_pk_bf16_f32 v133,v38,v39
v_cvt_pk_bf16_f32 v134,v52,v53
v_cvt_pk_bf16_f32 v135,v54,v55
v_cvt_pk_bf16_f32 v136,v40,v41
v_cvt_pk_bf16_f32 v137,v42,v43
v_cvt_pk_bf16_f32 v138,v56,v57
v_cvt_pk_bf16_f32 v139,v58,v59
v_cvt_pk_bf16_f32 v140,v44,v45
v_cvt_pk_bf16_f32 v141,v46,v47
buffer_load_dwordx4 v10,s[12:15],s32 offen offset:2048 lds
v_cvt_pk_bf16_f32 v142,v60,v61
v_cvt_pk_bf16_f32 v143,v62,v63
v_mfma_f32_16x16x32_bf16 v[144:147],v[240:243],v[128:131],0
v_mfma_f32_16x16x32_bf16 v[148:151],v[244:247],v[128:131],0
v_mfma_f32_16x16x32_bf16 v[152:155],v[240:243],v[132:135],0
v_mfma_f32_16x16x32_bf16 v[156:159],v[244:247],v[132:135],0
v_mfma_f32_16x16x32_bf16 v[160:163],v[240:243],v[136:139],0
v_mfma_f32_16x16x32_bf16 v[164:167],v[244:247],v[136:139],0
v_mfma_f32_16x16x32_bf16 v[168:171],v[240:243],v[140:143],0
v_mfma_f32_16x16x32_bf16 v[172:175],v[244:247],v[140:143],0
buffer_load_dwordx4 v11,s[12:15],s32 offen offset:3072 lds
s_add_u32 s35,s35,49152
s_cmp_eq_u32 s35,147456
s_cselect_b32 s35,0,s35
s_add_u32 s32,s32,262144
v_max3_f32 v176,v144,v145,v146
v_max3_f32 v177,-v144,-v145,-v146
v_max3_f32 v178,v152,v153,v154
v_max3_f32 v179,-v152,-v153,-v154
v_max3_f32 v180,v160,v161,v162
v_max3_f32 v181,-v160,-v161,-v162
v_max3_f32 v182,v168,v169,v170
v_max3_f32 v183,-v168,-v169,-v170
v_max3_f32 v176,v176,v147,v148
v_max3_f32 v177,v177,-v147,-v148
s_add_u32 m0,s35,s41
s_nop 0
buffer_load_dwordx4 v8,s[12:15],s32 offen lds
v_max3_f32 v178,v178,v155,v156
v_max3_f32 v179,v179,-v155,-v156
v_max3_f32 v180,v180,v163,v164
v_max3_f32 v181,v181,-v163,-v164
v_max3_f32 v182,v182,v171,v172
v_max3_f32 v183,v183,-v171,-v172
v_max3_f32 v176,v176,v149,v150
v_max3_f32 v177,v177,-v149,-v150
v_max3_f32 v178,v178,v157,v158
v_max3_f32 v179,v179,-v157,-v158
buffer_load_dwordx4 v9,s[12:15],s32 offen offset:1024 lds
v_max3_f32 v180,v180,v165,v166
v_max3_f32 v181,v181,-v165,-v166
v_max3_f32 v182,v182,v173,v174
v_max3_f32 v183,v183,-v173,-v174
v_max_f32 v176,v176,v151
v_max_f32_e64 v177,v177,-v151
v_max_f32 v178,v178,v159
v_max_f32_e64 v179,v179,-v159
v_max_f32 v180,v180,v167
v_max_f32_e64 v181,v181,-v167
buffer_load_dwordx4 v10,s[12:15],s32 offen offset:2048 lds
v_max_f32 v182,v182,v175
v_max_f32_e64 v183,v183,-v175
v_permlane32_swap_b32 v176,v177
v_permlane32_swap_b32 v178,v179
v_permlane32_swap_b32 v180,v181
v_permlane32_swap_b32 v182,v183
v_max_f32 v176,v176,v177
v_max_f32 v178,v178,v179
v_max_f32 v180,v180,v181
v_max_f32 v182,v182,v183
buffer_load_dwordx4 v11,s[12:15],s32 offen offset:3072 lds
s_add_u32 s35,s35,49152
s_cmp_eq_u32 s35,147456
s_cselect_b32 s35,0,s35
s_add_u32 s32,s32,262144
v_permlane16_swap_b32 v176,v178
v_permlane16_swap_b32 v180,v182
v_max_f32 v176,v176,v178
v_max_f32 v180,v180,v182
v_mul_f32 v176,s44,v176
v_mul_f32 v180,s44,v180
v_mov_b32 v178,v176
v_mov_b32 v182,v180
s_nop 0
v_permlane16_swap_b32 v176,v178
v_permlane16_swap_b32 v180,v182
s_add_u32 m0,s35,s41
s_nop 0
buffer_load_dwordx4 v8,s[12:15],s32 offen lds
v_mov_b32 v177,v176
v_mov_b32 v179,v178
v_mov_b32 v181,v180
v_mov_b32 v183,v182
v_permlane32_swap_b32 v176,v177
v_permlane32_swap_b32 v178,v179
v_permlane32_swap_b32 v180,v181
v_permlane32_swap_b32 v182,v183
v_pk_fma_f32 v[192:193],v[144:145],s[44:45],v[176:177] op_sel:[0,0,0] op_sel_hi:[1,1,0] neg_lo:[0,0,1] neg_hi:[0,0,1]
v_pk_fma_f32 v[194:195],v[146:147],s[44:45],v[176:177] op_sel:[0,0,0] op_sel_hi:[1,1,0] neg_lo:[0,0,1] neg_hi:[0,0,1]
buffer_load_dwordx4 v9,s[12:15],s32 offen offset:1024 lds
v_pk_fma_f32 v[196:197],v[148:149],s[44:45],v[176:177] op_sel:[0,0,0] op_sel_hi:[1,1,0] neg_lo:[0,0,1] neg_hi:[0,0,1]
v_pk_fma_f32 v[198:199],v[150:151],s[44:45],v[176:177] op_sel:[0,0,0] op_sel_hi:[1,1,0] neg_lo:[0,0,1] neg_hi:[0,0,1]
v_pk_fma_f32 v[200:201],v[144:145],s[44:45],v[176:177] op_sel:[0,0,1] op_sel_hi:[1,1,1] neg_lo:[1,0,1] neg_hi:[1,0,1]
v_pk_fma_f32 v[202:203],v[146:147],s[44:45],v[176:177] op_sel:[0,0,1] op_sel_hi:[1,1,1] neg_lo:[1,0,1] neg_hi:[1,0,1]
v_pk_fma_f32 v[204:205],v[148:149],s[44:45],v[176:177] op_sel:[0,0,1] op_sel_hi:[1,1,1] neg_lo:[1,0,1] neg_hi:[1,0,1]
v_pk_fma_f32 v[206:207],v[150:151],s[44:45],v[176:177] op_sel:[0,0,1] op_sel_hi:[1,1,1] neg_lo:[1,0,1] neg_hi:[1,0,1]
v_exp_f32 v192,v192
v_exp_f32 v193,v193
v_exp_f32 v194,v194
v_exp_f32 v195,v195
buffer_load_dwordx4 v10,s[12:15],s32 offen offset:2048 lds
v_exp_f32 v196,v196
v_exp_f32 v197,v197
v_exp_f32 v198,v198
v_exp_f32 v199,v199
v_exp_f32 v200,v200
v_exp_f32 v201,v201
v_exp_f32 v202,v202
v_exp_f32 v203,v203
v_exp_f32 v204,v204
v_exp_f32 v205,v205
buffer_load_dwordx4 v11,s[12:15],s32 offen offset:3072 lds
s_add_u32 s35,s35,49152
s_cmp_eq_u32 s35,147456
s_cselect_b32 s35,0,s35
s_add_u32 s32,s32,262144
v_exp_f32 v206,v206
v_exp_f32 v207,v207
v_cvt_pk_bf16_f32 v208,v192,v193
v_cvt_pk_bf16_f32 v209,v194,v195
v_cvt_pk_bf16_f32 v210,v196,v197
v_cvt_pk_bf16_f32 v211,v198,v199
v_cvt_pk_bf16_f32 v212,v200,v201
v_cvt_pk_bf16_f32 v213,v202,v203
v_cvt_pk_bf16_f32 v214,v204,v205
v_cvt_pk_bf16_f32 v215,v206,v207
v_pk_fma_f32 v[192:193],v[152:153],s[44:45],v[178:179] op_sel:[0,0,0] op_sel_hi:[1,1,0] neg_lo:[0,0,1] neg_hi:[0,0,1]
v_pk_fma_f32 v[194:195],v[154:155],s[44:45],v[178:179] op_sel:[0,0,0] op_sel_hi:[1,1,0] neg_lo:[0,0,1] neg_hi:[0,0,1]
v_pk_fma_f32 v[196:197],v[156:157],s[44:45],v[178:179] op_sel:[0,0,0] op_sel_hi:[1,1,0] neg_lo:[0,0,1] neg_hi:[0,0,1]
v_pk_fma_f32 v[198:199],v[158:159],s[44:45],v[178:179] op_sel:[0,0,0] op_sel_hi:[1,1,0] neg_lo:[0,0,1] neg_hi:[0,0,1]
v_pk_fma_f32 v[200:201],v[152:153],s[44:45],v[178:179] op_sel:[0,0,1] op_sel_hi:[1,1,1] neg_lo:[1,0,1] neg_hi:[1,0,1]
v_pk_fma_f32 v[202:203],v[154:155],s[44:45],v[178:179] op_sel:[0,0,1] op_sel_hi:[1,1,1] neg_lo:[1,0,1] neg_hi:[1,0,1]
v_pk_fma_f32 v[204:205],v[156:157],s[44:45],v[178:179] op_sel:[0,0,1] op_sel_hi:[1,1,1] neg_lo:[1,0,1] neg_hi:[1,0,1]
v_pk_fma_f32 v[206:207],v[158:159],s[44:45],v[178:179] op_sel:[0,0,1] op_sel_hi:[1,1,1] neg_lo:[1,0,1] neg_hi:[1,0,1]
v_exp_f32 v192,v192
v_exp_f32 v193,v193
v_exp_f32 v194,v194
v_exp_f32 v195,v195
v_exp_f32 v196,v196
v_exp_f32 v197,v197
v_exp_f32 v198,v198
v_exp_f32 v199,v199
v_exp_f32 v200,v200
v_exp_f32 v201,v201
v_exp_f32 v202,v202
v_exp_f32 v203,v203
v_exp_f32 v204,v204
v_exp_f32 v205,v205
v_exp_f32 v206,v206
v_exp_f32 v207,v207
v_cvt_pk_bf16_f32 v216,v192,v193
v_cvt_pk_bf16_f32 v217,v194,v195
buffer_load_dwordx4 v[100:103],v29,s[24:27],s48 offen sc1
buffer_load_dwordx4 v[104:107],v29,s[24:27],s48 offen offset:1024 sc1
buffer_load_dwordx4 v[108:111],v29,s[24:27],s48 offen offset:2048 sc1
buffer_load_dwordx4 v[112:115],v29,s[24:27],s48 offen offset:3072 sc1
buffer_load_dwordx4 v[116:119],v29,s[24:27],s49 offen sc1
buffer_load_dwordx4 v[120:123],v29,s[24:27],s49 offen offset:1024 sc1
v_cvt_pk_bf16_f32 v218,v196,v197
v_cvt_pk_bf16_f32 v219,v198,v199
v_cvt_pk_bf16_f32 v220,v200,v201
v_cvt_pk_bf16_f32 v221,v202,v203
v_cvt_pk_bf16_f32 v222,v204,v205
v_cvt_pk_bf16_f32 v223,v206,v207
v_pk_fma_f32 v[192:193],v[160:161],s[44:45],v[180:181] op_sel:[0,0,0] op_sel_hi:[1,1,0] neg_lo:[0,0,1] neg_hi:[0,0,1]
v_pk_fma_f32 v[194:195],v[162:163],s[44:45],v[180:181] op_sel:[0,0,0] op_sel_hi:[1,1,0] neg_lo:[0,0,1] neg_hi:[0,0,1]
v_pk_fma_f32 v[196:197],v[164:165],s[44:45],v[180:181] op_sel:[0,0,0] op_sel_hi:[1,1,0] neg_lo:[0,0,1] neg_hi:[0,0,1]
v_pk_fma_f32 v[198:199],v[166:167],s[44:45],v[180:181] op_sel:[0,0,0] op_sel_hi:[1,1,0] neg_lo:[0,0,1] neg_hi:[0,0,1]
v_pk_fma_f32 v[200:201],v[160:161],s[44:45],v[180:181] op_sel:[0,0,1] op_sel_hi:[1,1,1] neg_lo:[1,0,1] neg_hi:[1,0,1]
v_pk_fma_f32 v[202:203],v[162:163],s[44:45],v[180:181] op_sel:[0,0,1] op_sel_hi:[1,1,1] neg_lo:[1,0,1] neg_hi:[1,0,1]
v_pk_fma_f32 v[204:205],v[164:165],s[44:45],v[180:181] op_sel:[0,0,1] op_sel_hi:[1,1,1] neg_lo:[1,0,1] neg_hi:[1,0,1]
v_pk_fma_f32 v[206:207],v[166:167],s[44:45],v[180:181] op_sel:[0,0,1] op_sel_hi:[1,1,1] neg_lo:[1,0,1] neg_hi:[1,0,1]
v_exp_f32 v192,v192
v_exp_f32 v193,v193
v_exp_f32 v194,v194
v_exp_f32 v195,v195
v_exp_f32 v196,v196
v_exp_f32 v197,v197
v_exp_f32 v198,v198
v_exp_f32 v199,v199
v_exp_f32 v200,v200
v_exp_f32 v201,v201
v_exp_f32 v202,v202
v_exp_f32 v203,v203
v_exp_f32 v204,v204
v_exp_f32 v205,v205
v_exp_f32 v206,v206
v_exp_f32 v207,v207
v_cvt_pk_bf16_f32 v224,v192,v193
v_cvt_pk_bf16_f32 v225,v194,v195
v_cvt_pk_bf16_f32 v226,v196,v197
v_cvt_pk_bf16_f32 v227,v198,v199
v_cvt_pk_bf16_f32 v228,v200,v201
v_cvt_pk_bf16_f32 v229,v202,v203
v_cvt_pk_bf16_f32 v230,v204,v205
v_cvt_pk_bf16_f32 v231,v206,v207
v_pk_fma_f32 v[192:193],v[168:169],s[44:45],v[182:183] op_sel:[0,0,0] op_sel_hi:[1,1,0] neg_lo:[0,0,1] neg_hi:[0,0,1]
v_pk_fma_f32 v[194:195],v[170:171],s[44:45],v[182:183] op_sel:[0,0,0] op_sel_hi:[1,1,0] neg_lo:[0,0,1] neg_hi:[0,0,1]
v_pk_fma_f32 v[196:197],v[172:173],s[44:45],v[182:183] op_sel:[0,0,0] op_sel_hi:[1,1,0] neg_lo:[0,0,1] neg_hi:[0,0,1]
v_pk_fma_f32 v[198:199],v[174:175],s[44:45],v[182:183] op_sel:[0,0,0] op_sel_hi:[1,1,0] neg_lo:[0,0,1] neg_hi:[0,0,1]
v_pk_fma_f32 v[200:201],v[168:169],s[44:45],v[182:183] op_sel:[0,0,1] op_sel_hi:[1,1,1] neg_lo:[1,0,1] neg_hi:[1,0,1]
v_pk_fma_f32 v[202:203],v[170:171],s[44:45],v[182:183] op_sel:[0,0,1] op_sel_hi:[1,1,1] neg_lo:[1,0,1] neg_hi:[1,0,1]
v_pk_fma_f32 v[204:205],v[172:173],s[44:45],v[182:183] op_sel:[0,0,1] op_sel_hi:[1,1,1] neg_lo:[1,0,1] neg_hi:[1,0,1]
v_pk_fma_f32 v[206:207],v[174:175],s[44:45],v[182:183] op_sel:[0,0,1] op_sel_hi:[1,1,1] neg_lo:[1,0,1] neg_hi:[1,0,1]
v_exp_f32 v192,v192
v_exp_f32 v193,v193
v_exp_f32 v194,v194
v_exp_f32 v195,v195
v_exp_f32 v196,v196
v_exp_f32 v197,v197
v_exp_f32 v198,v198
v_exp_f32 v199,v199
v_exp_f32 v200,v200
v_exp_f32 v201,v201
v_exp_f32 v202,v202
v_exp_f32 v203,v203
v_exp_f32 v204,v204
v_exp_f32 v205,v205
v_exp_f32 v206,v206
v_exp_f32 v207,v207
v_cvt_pk_bf16_f32 v232,v192,v193
v_cvt_pk_bf16_f32 v233,v194,v195
v_cvt_pk_bf16_f32 v234,v196,v197
v_cvt_pk_bf16_f32 v235,v198,v199
v_cvt_pk_bf16_f32 v236,v200,v201
v_cvt_pk_bf16_f32 v237,v202,v203
v_cvt_pk_bf16_f32 v238,v204,v205
v_cvt_pk_bf16_f32 v239,v206,v207
s_mov_b32 s44,0x358637bd
s_mov_b32 s39,65536
s_mov_b32 s60,0
s_mov_b32 s61,32768
s_mov_b32 s62,65536
s_mov_b32 s63,98304
Lkpl38:
s_waitcnt vmcnt(0)
v_max3_u32 v3,v100,v101,v102
v_max3_u32 v3,v3,v103,v104
v_max3_u32 v3,v3,v105,v106
v_max3_u32 v3,v3,v107,v108
v_max3_u32 v3,v3,v109,v110
v_max3_u32 v3,v3,v111,v112
v_max3_u32 v3,v3,v113,v114
v_max3_u32 v3,v3,v115,v116
v_max3_u32 v3,v3,v117,v118
v_max3_u32 v3,v3,v119,v120
v_max3_u32 v3,v3,v121,v122
v_max_u32 v3,v3,v123
v_cmp_eq_u32 vcc,-1,v3
s_nop 1
s_cmp_eq_u64 vcc,0
s_cbranch_scc1 Lkok39
buffer_load_dwordx4 v[100:103],v29,s[24:27],s48 offen sc1
buffer_load_dwordx4 v[104:107],v29,s[24:27],s48 offen offset:1024 sc1
buffer_load_dwordx4 v[108:111],v29,s[24:27],s48 offen offset:2048 sc1
buffer_load_dwordx4 v[112:115],v29,s[24:27],s48 offen offset:3072 sc1
buffer_load_dwordx4 v[116:119],v29,s[24:27],s49 offen sc1
buffer_load_dwordx4 v[120:123],v29,s[24:27],s49 offen offset:1024 sc1
s_sub_u32 s39,s39,1
s_cmp_lg_u32 s39,0
s_cbranch_scc1 Lkpl38
s_waitcnt vmcnt(0)
Lkok39:
v_mfma_f32_16x16x32_bf16 v[32:35],v[100:103],v[208:211],0
v_mfma_f32_16x16x32_bf16 v[36:39],v[104:107],v[208:211],0
v_mfma_f32_16x16x32_bf16 v[40:43],v[108:111],v[208:211],0
v_mfma_f32_16x16x32_bf16 v[44:47],v[112:115],v[212:215],0
v_mfma_f32_16x16x32_bf16 v[48:51],v[116:119],v[212:215],0
v_mfma_f32_16x16x32_bf16 v[52:55],v[120:123],v[212:215],0
v_mfma_f32_16x16x32_bf16 v[56:59],v[100:103],v[216:219],0
v_mfma_f32_16x16x32_bf16 v[60:63],v[104:107],v[216:219],0
v_mfma_f32_16x16x32_bf16 v[64:67],v[108:111],v[216:219],0
v_mfma_f32_16x16x32_bf16 v[68:71],v[112:115],v[220:223],0
v_mfma_f32_16x16x32_bf16 v[72:75],v[116:119],v[220:223],0
v_mfma_f32_16x16x32_bf16 v[76:79],v[120:123],v[220:223],0
v_mfma_f32_16x16x32_bf16 v[128:131],v[100:103],v[224:227],0
v_mfma_f32_16x16x32_bf16 v[132:135],v[104:107],v[224:227],0
v_mfma_f32_16x16x32_bf16 v[136:139],v[108:111],v[224:227],0
v_mfma_f32_16x16x32_bf16 v[140:143],v[112:115],v[228:231],0
v_mfma_f32_16x16x32_bf16 v[144:147],v[116:119],v[228:231],0
v_mfma_f32_16x16x32_bf16 v[148:151],v[120:123],v[228:231],0
v_mfma_f32_16x16x32_bf16 v[176:179],v[100:103],v[232:235],0
v_mfma_f32_16x16x32_bf16 v[180:183],v[104:107],v[232:235],0
v_mfma_f32_16x16x32_bf16 v[184:187],v[108:111],v[232:235],0
v_mfma_f32_16x16x32_bf16 v[188:191],v[112:115],v[236:239],0
v_mfma_f32_16x16x32_bf16 v[192:195],v[116:119],v[236:239],0
v_mfma_f32_16x16x32_bf16 v[196:199],v[120:123],v[236:239],0
v_rcp_f32 v41,v41
v_rcp_f32 v53,v53
v_rcp_f32 v65,v65
v_rcp_f32 v77,v77
v_rcp_f32 v137,v137
v_rcp_f32 v149,v149
v_rcp_f32 v185,v185
s_nop 0
v_rcp_f32 v197,v197
v_fma_f32 v42,v40,v41,s44
v_fma_f32 v42,v52,v53,v42
v_fma_f32 v66,v64,v65,s44
v_fma_f32 v66,v76,v77,v66
v_fma_f32 v138,v136,v137,s44
v_fma_f32 v138,v148,v149,v138
v_fma_f32 v186,v184,v185,s44
v_fma_f32 v186,v196,v197,v186
v_rcp_f32 v42,v42
v_rcp_f32 v66,v66
v_rcp_f32 v138,v138
v_rcp_f32 v186,v186
v_mul_f32 v40,v41,v42
v_mul_f32 v52,v53,v42
v_mul_f32 v64,v65,v66
v_mul_f32 v76,v77,v66
v_mul_f32 v136,v137,v138
v_mul_f32 v148,v149,v138
v_mul_f32 v184,v185,v186
v_mul_f32 v196,v197,v186
v_pk_mul_f32 v[32:33],v[32:33],v[40:41] op_sel:[0,0] op_sel_hi:[1,0]
v_pk_mul_f32 v[34:35],v[34:35],v[40:41] op_sel:[0,0] op_sel_hi:[1,0]
v_pk_mul_f32 v[36:37],v[36:37],v[40:41] op_sel:[0,0] op_sel_hi:[1,0]
v_pk_mul_f32 v[38:39],v[38:39],v[40:41] op_sel:[0,0] op_sel_hi:[1,0]
v_pk_fma_f32 v[32:33],v[44:45],v[52:53],v[32:33] op_sel:[0,0,0] op_sel_hi:[1,0,1]
v_pk_fma_f32 v[34:35],v[46:47],v[52:53],v[34:35] op_sel:[0,0,0] op_sel_hi:[1,0,1]
v_pk_fma_f32 v[36:37],v[48:49],v[52:53],v[36:37] op_sel:[0,0,0] op_sel_hi:[1,0,1]
v_pk_fma_f32 v[38:39],v[50:51],v[52:53],v[38:39] op_sel:[0,0,0] op_sel_hi:[1,0,1]
v_pk_mul_f32 v[56:57],v[56:57],v[64:65] op_sel:[0,0] op_sel_hi:[1,0]
v_pk_mul_f32 v[58:59],v[58:59],v[64:65] op_sel:[0,0] op_sel_hi:[1,0]
v_pk_mul_f32 v[60:61],v[60:61],v[64:65] op_sel:[0,0] op_sel_hi:[1,0]
v_pk_mul_f32 v[62:63],v[62:63],v[64:65] op_sel:[0,0] op_sel_hi:[1,0]
v_pk_fma_f32 v[56:57],v[68:69],v[76:77],v[56:57] op_sel:[0,0,0] op_sel_hi:[1,0,1]
v_pk_fma_f32 v[58:59],v[70:71],v[76:77],v[58:59] op_sel:[0,0,0] op_sel_hi:[1,0,1]
v_pk_fma_f32 v[60:61],v[72:73],v[76:77],v[60:61] op_sel:[0,0,0] op_sel_hi:[1,0,1]
v_pk_fma_f32 v[62:63],v[74:75],v[76:77],v[62:63] op_sel:[0,0,0] op_sel_hi:[1,0,1]
v_pk_mul_f32 v[128:129],v[128:129],v[136:137] op_sel:[0,0] op_sel_hi:[1,0]
v_pk_mul_f32 v[130:131],v[130:131],v[136:137] op_sel:[0,0] op_sel_hi:[1,0]
v_pk_mul_f32 v[132:133],v[132:133],v[136:137] op_sel:[0,0] op_sel_hi:[1,0]
v_pk_mul_f32 v[134:135],v[134:135],v[136:137] op_sel:[0,0] op_sel_hi:[1,0]
v_pk_fma_f32 v[128:129],v[140:141],v[148:149],v[128:129] op_sel:[0,0,0] op_sel_hi:[1,0,1]
v_pk_fma_f32 v[130:131],v[142:143],v[148:149],v[130:131] op_sel:[0,0,0] op_sel_hi:[1,0,1]
v_pk_fma_f32 v[132:133],v[144:145],v[148:149],v[132:133] op_sel:[0,0,0] op_sel_hi:[1,0,1]
v_pk_fma_f32 v[134:135],v[146:147],v[148:149],v[134:135] op_sel:[0,0,0] op_sel_hi:[1,0,1]
v_pk_mul_f32 v[176:177],v[176:177],v[184:185] op_sel:[0,0] op_sel_hi:[1,0]
v_pk_mul_f32 v[178:179],v[178:179],v[184:185] op_sel:[0,0] op_sel_hi:[1,0]
v_pk_mul_f32 v[180:181],v[180:181],v[184:185] op_sel:[0,0] op_sel_hi:[1,0]
v_pk_mul_f32 v[182:183],v[182:183],v[184:185] op_sel:[0,0] op_sel_hi:[1,0]
v_pk_fma_f32 v[176:177],v[188:189],v[196:197],v[176:177] op_sel:[0,0,0] op_sel_hi:[1,0,1]
v_pk_fma_f32 v[178:179],v[190:191],v[196:197],v[178:179] op_sel:[0,0,0] op_sel_hi:[1,0,1]
v_pk_fma_f32 v[180:181],v[192:193],v[196:197],v[180:181] op_sel:[0,0,0] op_sel_hi:[1,0,1]
v_pk_fma_f32 v[182:183],v[194:195],v[196:197],v[182:183] op_sel:[0,0,0] op_sel_hi:[1,0,1]
v_cvt_pk_bf16_f32 v160,v32,v33
v_cvt_pk_bf16_f32 v161,v34,v35
v_cvt_pk_bf16_f32 v162,v36,v37
v_cvt_pk_bf16_f32 v163,v38,v39
v_cvt_pk_bf16_f32 v164,v56,v57
v_cvt_pk_bf16_f32 v165,v58,v59
v_cvt_pk_bf16_f32 v166,v60,v61
v_cvt_pk_bf16_f32 v167,v62,v63
v_cvt_pk_bf16_f32 v168,v128,v129
v_cvt_pk_bf16_f32 v169,v130,v131
v_cvt_pk_bf16_f32 v170,v132,v133
v_cvt_pk_bf16_f32 v171,v134,v135
v_cvt_pk_bf16_f32 v172,v176,v177
v_cvt_pk_bf16_f32 v173,v178,v179
v_cvt_pk_bf16_f32 v174,v180,v181
v_cvt_pk_bf16_f32 v175,v182,v183
v_permlane16_swap_b32 v160,v162
v_permlane16_swap_b32 v161,v163
v_permlane16_swap_b32 v164,v166
v_permlane16_swap_b32 v165,v167
v_permlane16_swap_b32 v168,v170
v_permlane16_swap_b32 v169,v171
v_permlane16_swap_b32 v172,v174
v_permlane16_swap_b32 v173,v175
buffer_store_dwordx4 v[160:163],v21,s[24:27],s60 offen sc1
buffer_store_dwordx4 v[164:167],v21,s[24:27],s61 offen sc1
buffer_store_dwordx4 v[168:171],v21,s[24:27],s62 offen sc1
buffer_store_dwordx4 v[172:175],v21,s[24:27],s63 offen sc1
s_waitcnt vmcnt(0)
s_barrier
s_cmp_lg_u32 s20,0
s_cbranch_scc1 Lpub40
s_mov_b32 s18,s84
s_mov_b32 s19,s85
s_lshl_b32 s18,s18,8
s_lshl_b32 s19,s19,2
s_add_u32 s18,s18,s19
s_add_u32 s18,s18,95453184
v_mov_b32 v1,0
v_mov_b32 v3,s94
s_mov_b64 exec,1
buffer_store_dword v3,v1,s[24:27],s18 offen sc1
s_mov_b64 exec,-1
Lpub40:
s_add_u32 s8,s16,65536
s_addc_u32 s9,s17,0
s_mov_b32 s10,4194304
s_mov_b32 s56,s64
s_mov_b32 s57,s65
s_mov_b32 s58,4194304
s_lshl_b32 s23,s84,7
s_and_b32 s28,s20,1
s_lshr_b32 s29,s20,1
s_lshl_b32 s18,s28,6
s_add_u32 s33,s23,s18
s_lshl_b32 s18,s29,11
s_mul_i32 s19,s33,2048
v_lshlrev_b32 v4,4,v2
v_add_u32 v4,s19,v4
v_add_u32 v4,s18,v4
v_add_u32 v5,30720,v4
s_mov_b32 s30,0
s_mov_b32 s31,65536
s_mov_b32 s34,0
s_lshl_b32 s40,s20,13
s_add_u32 s52,s40,4096
s_lshl_b32 s18,s29,5
s_add_u32 s18,s18,s33
s_mov_b32 s60,32768
s_lshl_b32 s61,s18,11
s_lshl_b32 s19,s85,7
s_add_u32 s19,s19,s61
s_mov_b32 s93,s19
v_lshlrev_b32 v22,11,v30
v_lshl_add_u32 v22,v31,3,v22
v_add_u32 v22,s19,v22
s_lshl_b32 s19,s85,11
s_add_u32 s19,s19,s61
v_lshlrev_b32 v18,4,v30
v_and_b32 v1,1,v31
v_lshl_add_u32 v18,v1,9,v18
v_lshrrev_b32 v1,1,v31
v_lshl_add_u32 v18,v1,8,v18
v_add_u32 v18,s19,v18
s_lshl_b32 s18,s18,7
s_lshr_b32 s19,s85,1
s_lshl_b32 s19,s19,8
s_add_u32 s18,s18,s19
s_and_b32 s19,s85,1
s_lshl_b32 s19,s19,3
s_add_u32 s18,s18,s19
v_lshlrev_b32 v19,4,v30
v_add_u32 v19,s18,v19
v_lshlrev_b32 v12,4,v2
v_add_u32 v12,s40,v12
v_add_u32 v13,1024,v12
s_lshl_b32 s18,s29,13
s_add_u32 s18,s18,32768
v_bfe_u32 v1,v2,2,2
v_lshl_add_u32 v3,v31,3,v1
v_lshlrev_b32 v3,7,v3
v_add_u32 v3,s18,v3
v_and_b32 v0,1,v2
v_lshl_add_u32 v3,v0,3,v3
v_and_b32 v1,2,v1
v_and_b32 v0,1,v31
v_lshl_add_u32 v1,v0,2,v1
v_bfe_u32 v0,v2,1,1
v_or_b32 v1,v1,v0
v_xor_b32 v0,0,v1
v_lshl_add_u32 v14,v0,4,v3
v_xor_b32 v0,2,v1
v_lshl_add_u32 v15,v0,4,v3
v_xor_b32 v0,4,v1
v_lshl_add_u32 v16,v0,4,v3
v_xor_b32 v0,6,v1
v_lshl_add_u32 v17,v0,4,v3
v_lshlrev_b32 v20,4,v2
v_add_u32 v20,s40,v20
v_xor_b32 v21,16384,v20
s_mov_b32 s36,0
s_mov_b32 s42,0
s_mov_b32 s50,49152
s_mov_b32 s51,0xfffe8000
s_cmp_lg_u32 s20,0
s_cbranch_scc1 Lwbar41
s_mov_b32 s18,s84
s_lshl_b32 s18,s18,8
s_add_u32 s18,s18,95453184
v_lshlrev_b32 v1,2,v30
v_lshl_add_u32 v1,v31,8,v1
s_mov_b32 exec_lo,0xffff
s_mov_b32 exec_hi,0
s_mov_b32 s39,131072
Lpoll42:
buffer_load_dword v3,v1,s[24:27],s18 offen sc1
s_waitcnt vmcnt(0)
v_cmp_ne_u32 vcc,s94,v3
s_nop 1
s_cmp_eq_u64 vcc,0
s_cbranch_scc1 Lgot43
s_sleep 1
s_sub_u32 s39,s39,1
s_cmp_lg_u32 s39,0
s_cbranch_scc1 Lpoll42
Lgot43:
s_mov_b64 exec,-1
Lwbar41:
s_barrier
s_add_u32 m0,s34,s40
s_nop 0
buffer_load_dwordx4 v4,s[8:11],s30 offen sc1 lds
buffer_load_dwordx4 v4,s[8:11],s30 offen offset:1024 sc1 lds
buffer_load_dwordx4 v5,s[8:11],s30 offen offset:2048 sc1 lds
buffer_load_dwordx4 v5,s[8:11],s30 offen offset:3072 sc1 lds
s_add_u32 s30,s30,4096
s_add_u32 m0,s34,s52
s_nop 0
buffer_load_dwordx4 v4,s[8:11],s31 offen sc1 lds
buffer_load_dwordx4 v4,s[8:11],s31 offen offset:1024 sc1 lds
buffer_load_dwordx4 v5,s[8:11],s31 offen offset:2048 sc1 lds
buffer_load_dwordx4 v5,s[8:11],s31 offen offset:3072 sc1 lds
s_add_u32 s34,s34,49152
s_cmp_eq_u32 s34,147456
s_cselect_b32 s34,0,s34
s_add_u32 s31,s31,4096
s_add_u32 m0,s34,s40
s_nop 0
buffer_load_dwordx4 v4,s[8:11],s30 offen sc1 lds
buffer_load_dwordx4 v4,s[8:11],s30 offen offset:1024 sc1 lds
buffer_load_dwordx4 v5,s[8:11],s30 offen offset:2048 sc1 lds
buffer_load_dwordx4 v5,s[8:11],s30 offen offset:3072 sc1 lds
s_add_u32 s30,s30,4096
s_add_u32 m0,s34,s52
s_nop 0
buffer_load_dwordx4 v4,s[8:11],s31 offen sc1 lds
buffer_load_dwordx4 v4,s[8:11],s31 offen offset:1024 sc1 lds
buffer_load_dwordx4 v5,s[8:11],s31 offen offset:2048 sc1 lds
buffer_load_dwordx4 v5,s[8:11],s31 offen offset:3072 sc1 lds
s_add_u32 s34,s34,49152
s_cmp_eq_u32 s34,147456
s_cselect_b32 s34,0,s34
s_add_u32 s31,s31,4096
s_waitcnt vmcnt(8)
s_barrier
ds_read_b128 v[96:99],v12 offset:0
ds_read_b64_tr_b16 v[112:113],v14 offset:0
ds_read_b64_tr_b16 v[114:115],v14 offset:512
ds_read_b128 v[100:103],v12 offset:2048
ds_read_b128 v[104:107],v12 offset:4096
ds_read_b128 v[108:111],v12 offset:6144
ds_read_b64_tr_b16 v[116:117],v15 offset:0
ds_read_b64_tr_b16 v[118:119],v15 offset:512
ds_read_b64_tr_b16 v[120:121],v16 offset:0
ds_read_b64_tr_b16 v[122:123],v16 offset:512
ds_read_b64_tr_b16 v[124:125],v17 offset:0
ds_read_b64_tr_b16 v[126:127],v17 offset:512
s_waitcnt lgkmcnt(4)
v_mfma_f32_16x16x32_bf16 v[32:35],v[112:115],v[96:99],0
v_add_u32 v13,s42,v13
ds_read_b128 v[128:131],v13 offset:0
v_mfma_f32_16x16x32_bf16 v[36:39],v[112:115],v[100:103],0
ds_read_b64_tr_b16 v[144:145],v14 offset:4096
s_add_u32 m0,s34,s40
v_mfma_f32_16x16x32_bf16 v[40:43],v[112:115],v[104:107],0
ds_read_b64_tr_b16 v[146:147],v14 offset:4608
buffer_load_dwordx4 v4,s[8:11],s30 offen sc1 lds
v_mfma_f32_16x16x32_bf16 v[44:47],v[112:115],v[108:111],0
ds_read_b128 v[132:135],v13 offset:2048
buffer_load_dwordx4 v4,s[8:11],s30 offen offset:1024 sc1 lds
v_mfma_f32_16x16x32_bf16 v[48:51],v[116:119],v[96:99],0
ds_read_b128 v[136:139],v13 offset:4096
v_mfma_f32_16x16x32_bf16 v[52:55],v[116:119],v[100:103],0
buffer_load_dwordx4 v5,s[8:11],s30 offen offset:2048 sc1 lds
v_mfma_f32_16x16x32_bf16 v[56:59],v[116:119],v[104:107],0
ds_read_b128 v[140:143],v13 offset:6144
buffer_load_dwordx4 v5,s[8:11],s30 offen offset:3072 sc1 lds
v_mfma_f32_16x16x32_bf16 v[60:63],v[116:119],v[108:111],0
ds_read_b64_tr_b16 v[148:149],v15 offset:4096
s_add_u32 s30,s30,4096
s_waitcnt lgkmcnt(7)
v_mfma_f32_16x16x32_bf16 v[64:67],v[120:123],v[96:99],0
ds_read_b64_tr_b16 v[150:151],v15 offset:4608
s_add_u32 m0,s34,s52
v_mfma_f32_16x16x32_bf16 v[68:71],v[120:123],v[100:103],0
ds_read_b64_tr_b16 v[152:153],v16 offset:4096
ds_read_b64_tr_b16 v[154:155],v16 offset:4608
v_mfma_f32_16x16x32_bf16 v[72:75],v[120:123],v[104:107],0
ds_read_b64_tr_b16 v[156:157],v17 offset:4096
buffer_load_dwordx4 v4,s[8:11],s31 offen sc1 lds
v_mfma_f32_16x16x32_bf16 v[76:79],v[120:123],v[108:111],0
ds_read_b64_tr_b16 v[158:159],v17 offset:4608
buffer_load_dwordx4 v4,s[8:11],s31 offen offset:1024 sc1 lds
v_mfma_f32_16x16x32_bf16 v[80:83],v[124:127],v[96:99],0
buffer_load_dwordx4 v5,s[8:11],s31 offen offset:2048 sc1 lds
v_mfma_f32_16x16x32_bf16 v[84:87],v[124:127],v[100:103],0
buffer_load_dwordx4 v5,s[8:11],s31 offen offset:3072 sc1 lds
s_add_u32 s34,s34,49152
v_mfma_f32_16x16x32_bf16 v[88:91],v[124:127],v[104:107],0
s_cmp_eq_u32 s34,147456
s_cselect_b32 s34,0,s34
v_mfma_f32_16x16x32_bf16 v[92:95],v[124:127],v[108:111],0
s_add_u32 s31,s31,4096
s_waitcnt lgkmcnt(4)
v_mfma_f32_16x16x32_bf16 v[32:35],v[144:147],v[128:131],v[32:35]
s_add_u32 s36,s36,49152
v_mfma_f32_16x16x32_bf16 v[36:39],v[144:147],v[132:135],v[36:39]
v_mfma_f32_16x16x32_bf16 v[40:43],v[144:147],v[136:139],v[40:43]
s_cmp_eq_u32 s36,147456
s_cselect_b32 s42,s51,s50
s_cselect_b32 s36,0,s36
v_add_u32 v12,s42,v12
v_add_u32 v14,s42,v14
v_add_u32 v15,s42,v15
v_add_u32 v16,s42,v16
v_add_u32 v17,s42,v17
s_waitcnt vmcnt(8)
s_waitcnt lgkmcnt(0)
s_barrier
ds_read_b128 v[96:99],v12 offset:0
v_mfma_f32_16x16x32_bf16 v[44:47],v[144:147],v[140:143],v[44:47]
ds_read_b64_tr_b16 v[112:113],v14 offset:0
ds_read_b64_tr_b16 v[114:115],v14 offset:512
v_mfma_f32_16x16x32_bf16 v[48:51],v[148:151],v[128:131],v[48:51]
ds_read_b128 v[100:103],v12 offset:2048
s_add_u32 m0,s34,s40
v_mfma_f32_16x16x32_bf16 v[52:55],v[148:151],v[132:135],v[52:55]
ds_read_b128 v[104:107],v12 offset:4096
buffer_load_dwordx4 v4,s[8:11],s30 offen sc1 lds
v_mfma_f32_16x16x32_bf16 v[56:59],v[148:151],v[136:139],v[56:59]
buffer_load_dwordx4 v4,s[8:11],s30 offen offset:1024 sc1 lds
buffer_load_dwordx4 v5,s[8:11],s30 offen offset:2048 sc1 lds
v_mfma_f32_16x16x32_bf16 v[60:63],v[148:151],v[140:143],v[60:63]
ds_read_b128 v[108:111],v12 offset:6144
v_mfma_f32_16x16x32_bf16 v[64:67],v[152:155],v[128:131],v[64:67]
ds_read_b64_tr_b16 v[116:117],v15 offset:0
ds_read_b64_tr_b16 v[118:119],v15 offset:512
v_mfma_f32_16x16x32_bf16 v[68:71],v[152:155],v[132:135],v[68:71]
ds_read_b64_tr_b16 v[120:121],v16 offset:0
buffer_load_dwordx4 v5,s[8:11],s30 offen offset:3072 sc1 lds
v_mfma_f32_16x16x32_bf16 v[72:75],v[152:155],v[136:139],v[72:75]
ds_read_b64_tr_b16 v[122:123],v16 offset:512
ds_read_b64_tr_b16 v[124:125],v17 offset:0
v_mfma_f32_16x16x32_bf16 v[76:79],v[152:155],v[140:143],v[76:79]
ds_read_b64_tr_b16 v[126:127],v17 offset:512
s_add_u32 s30,s30,4096
v_mfma_f32_16x16x32_bf16 v[80:83],v[156:159],v[128:131],v[80:83]
s_add_u32 m0,s34,s52
s_nop 0
buffer_load_dwordx4 v4,s[8:11],s31 offen sc1 lds
v_mfma_f32_16x16x32_bf16 v[84:87],v[156:159],v[132:135],v[84:87]
buffer_load_dwordx4 v4,s[8:11],s31 offen offset:1024 sc1 lds
buffer_load_dwordx4 v5,s[8:11],s31 offen offset:2048 sc1 lds
v_mfma_f32_16x16x32_bf16 v[88:91],v[156:159],v[136:139],v[88:91]
buffer_load_dwordx4 v5,s[8:11],s31 offen offset:3072 sc1 lds
s_add_u32 s34,s34,49152
v_mfma_f32_16x16x32_bf16 v[92:95],v[156:159],v[140:143],v[92:95]
s_cmp_eq_u32 s34,147456
s_cselect_b32 s34,0,s34
s_add_u32 s31,s31,4096
s_mov_b32 s38,4
Lp2L44_0:
s_waitcnt lgkmcnt(4)
v_mfma_f32_16x16x32_bf16 v[32:35],v[112:115],v[96:99],v[32:35]
v_add_u32 v13,s42,v13
ds_read_b128 v[128:131],v13 offset:0
v_mfma_f32_16x16x32_bf16 v[36:39],v[112:115],v[100:103],v[36:39]
ds_read_b64_tr_b16 v[144:145],v14 offset:4096
s_add_u32 m0,s35,s41
v_mfma_f32_16x16x32_bf16 v[40:43],v[112:115],v[104:107],v[40:43]
ds_read_b64_tr_b16 v[146:147],v14 offset:4608
buffer_load_dwordx4 v8,s[12:15],s32 offen lds
v_mfma_f32_16x16x32_bf16 v[44:47],v[112:115],v[108:111],v[44:47]
ds_read_b128 v[132:135],v13 offset:2048
v_mfma_f32_16x16x32_bf16 v[48:51],v[116:119],v[96:99],v[48:51]
ds_read_b128 v[136:139],v13 offset:4096
v_mfma_f32_16x16x32_bf16 v[52:55],v[116:119],v[100:103],v[52:55]
buffer_load_dwordx4 v9,s[12:15],s32 offen offset:1024 lds
v_mfma_f32_16x16x32_bf16 v[56:59],v[116:119],v[104:107],v[56:59]
ds_read_b128 v[140:143],v13 offset:6144
v_mfma_f32_16x16x32_bf16 v[60:63],v[116:119],v[108:111],v[60:63]
ds_read_b64_tr_b16 v[148:149],v15 offset:4096
s_waitcnt lgkmcnt(7)
v_mfma_f32_16x16x32_bf16 v[64:67],v[120:123],v[96:99],v[64:67]
ds_read_b64_tr_b16 v[150:151],v15 offset:4608
buffer_load_dwordx4 v10,s[12:15],s32 offen offset:2048 lds
v_mfma_f32_16x16x32_bf16 v[68:71],v[120:123],v[100:103],v[68:71]
ds_read_b64_tr_b16 v[152:153],v16 offset:4096
ds_read_b64_tr_b16 v[154:155],v16 offset:4608
v_mfma_f32_16x16x32_bf16 v[72:75],v[120:123],v[104:107],v[72:75]
ds_read_b64_tr_b16 v[156:157],v17 offset:4096
v_mfma_f32_16x16x32_bf16 v[76:79],v[120:123],v[108:111],v[76:79]
ds_read_b64_tr_b16 v[158:159],v17 offset:4608
buffer_load_dwordx4 v11,s[12:15],s32 offen offset:3072 lds
v_mfma_f32_16x16x32_bf16 v[80:83],v[124:127],v[96:99],v[80:83]
s_add_u32 s35,s35,49152
v_mfma_f32_16x16x32_bf16 v[84:87],v[124:127],v[100:103],v[84:87]
s_cmp_eq_u32 s35,147456
s_cselect_b32 s35,0,s35
v_mfma_f32_16x16x32_bf16 v[88:91],v[124:127],v[104:107],v[88:91]
s_add_u32 s32,s32,262144
v_mfma_f32_16x16x32_bf16 v[92:95],v[124:127],v[108:111],v[92:95]
s_waitcnt lgkmcnt(4)
v_mfma_f32_16x16x32_bf16 v[32:35],v[144:147],v[128:131],v[32:35]
s_add_u32 s36,s36,49152
v_mfma_f32_16x16x32_bf16 v[36:39],v[144:147],v[132:135],v[36:39]
v_mfma_f32_16x16x32_bf16 v[40:43],v[144:147],v[136:139],v[40:43]
s_cmp_eq_u32 s36,147456
s_cselect_b32 s42,s51,s50
s_cselect_b32 s36,0,s36
v_add_u32 v12,s42,v12
v_add_u32 v14,s42,v14
v_add_u32 v15,s42,v15
v_add_u32 v16,s42,v16
v_add_u32 v17,s42,v17
s_waitcnt vmcnt(12)
s_waitcnt lgkmcnt(0)
s_barrier
ds_read_b128 v[96:99],v12 offset:0
v_mfma_f32_16x16x32_bf16 v[44:47],v[144:147],v[140:143],v[44:47]
ds_read_b64_tr_b16 v[112:113],v14 offset:0
ds_read_b64_tr_b16 v[114:115],v14 offset:512
v_mfma_f32_16x16x32_bf16 v[48:51],v[148:151],v[128:131],v[48:51]
ds_read_b128 v[100:103],v12 offset:2048
s_add_u32 m0,s34,s40
v_mfma_f32_16x16x32_bf16 v[52:55],v[148:151],v[132:135],v[52:55]
ds_read_b128 v[104:107],v12 offset:4096
buffer_load_dwordx4 v4,s[8:11],s30 offen sc1 lds
v_mfma_f32_16x16x32_bf16 v[56:59],v[148:151],v[136:139],v[56:59]
buffer_load_dwordx4 v4,s[8:11],s30 offen offset:1024 sc1 lds
buffer_load_dwordx4 v5,s[8:11],s30 offen offset:2048 sc1 lds
v_mfma_f32_16x16x32_bf16 v[60:63],v[148:151],v[140:143],v[60:63]
ds_read_b128 v[108:111],v12 offset:6144
v_mfma_f32_16x16x32_bf16 v[64:67],v[152:155],v[128:131],v[64:67]
ds_read_b64_tr_b16 v[116:117],v15 offset:0
ds_read_b64_tr_b16 v[118:119],v15 offset:512
v_mfma_f32_16x16x32_bf16 v[68:71],v[152:155],v[132:135],v[68:71]
ds_read_b64_tr_b16 v[120:121],v16 offset:0
buffer_load_dwordx4 v5,s[8:11],s30 offen offset:3072 sc1 lds
v_mfma_f32_16x16x32_bf16 v[72:75],v[152:155],v[136:139],v[72:75]
ds_read_b64_tr_b16 v[122:123],v16 offset:512
ds_read_b64_tr_b16 v[124:125],v17 offset:0
v_mfma_f32_16x16x32_bf16 v[76:79],v[152:155],v[140:143],v[76:79]
ds_read_b64_tr_b16 v[126:127],v17 offset:512
s_add_u32 s30,s30,4096
v_mfma_f32_16x16x32_bf16 v[80:83],v[156:159],v[128:131],v[80:83]
s_add_u32 m0,s34,s52
s_nop 0
buffer_load_dwordx4 v4,s[8:11],s31 offen sc1 lds
v_mfma_f32_16x16x32_bf16 v[84:87],v[156:159],v[132:135],v[84:87]
buffer_load_dwordx4 v4,s[8:11],s31 offen offset:1024 sc1 lds
buffer_load_dwordx4 v5,s[8:11],s31 offen offset:2048 sc1 lds
v_mfma_f32_16x16x32_bf16 v[88:91],v[156:159],v[136:139],v[88:91]
buffer_load_dwordx4 v5,s[8:11],s31 offen offset:3072 sc1 lds
s_add_u32 s34,s34,49152
v_mfma_f32_16x16x32_bf16 v[92:95],v[156:159],v[140:143],v[92:95]
s_cmp_eq_u32 s34,147456
s_cselect_b32 s34,0,s34
s_add_u32 s31,s31,4096
s_sub_u32 s38,s38,1
s_cmp_lg_u32 s38,0
s_cbranch_scc1 Lp2L44_0
s_waitcnt lgkmcnt(4)
v_mfma_f32_16x16x32_bf16 v[32:35],v[112:115],v[96:99],v[32:35]
v_add_u32 v13,s42,v13
ds_read_b128 v[128:131],v13 offset:0
v_mfma_f32_16x16x32_bf16 v[36:39],v[112:115],v[100:103],v[36:39]
ds_read_b64_tr_b16 v[144:145],v14 offset:4096
s_add_u32 m0,s35,s41
v_mfma_f32_16x16x32_bf16 v[40:43],v[112:115],v[104:107],v[40:43]
ds_read_b64_tr_b16 v[146:147],v14 offset:4608
buffer_load_dwordx4 v8,s[12:15],s32 offen lds
v_mfma_f32_16x16x32_bf16 v[44:47],v[112:115],v[108:111],v[44:47]
ds_read_b128 v[132:135],v13 offset:2048
v_mfma_f32_16x16x32_bf16 v[48:51],v[116:119],v[96:99],v[48:51]
ds_read_b128 v[136:139],v13 offset:4096
v_mfma_f32_16x16x32_bf16 v[52:55],v[116:119],v[100:103],v[52:55]
buffer_load_dwordx4 v9,s[12:15],s32 offen offset:1024 lds
v_mfma_f32_16x16x32_bf16 v[56:59],v[116:119],v[104:107],v[56:59]
ds_read_b128 v[140:143],v13 offset:6144
v_mfma_f32_16x16x32_bf16 v[60:63],v[116:119],v[108:111],v[60:63]
ds_read_b64_tr_b16 v[148:149],v15 offset:4096
s_waitcnt lgkmcnt(7)
v_mfma_f32_16x16x32_bf16 v[64:67],v[120:123],v[96:99],v[64:67]
ds_read_b64_tr_b16 v[150:151],v15 offset:4608
buffer_load_dwordx4 v10,s[12:15],s32 offen offset:2048 lds
v_mfma_f32_16x16x32_bf16 v[68:71],v[120:123],v[100:103],v[68:71]
ds_read_b64_tr_b16 v[152:153],v16 offset:4096
ds_read_b64_tr_b16 v[154:155],v16 offset:4608
v_mfma_f32_16x16x32_bf16 v[72:75],v[120:123],v[104:107],v[72:75]
ds_read_b64_tr_b16 v[156:157],v17 offset:4096
v_mfma_f32_16x16x32_bf16 v[76:79],v[120:123],v[108:111],v[76:79]
ds_read_b64_tr_b16 v[158:159],v17 offset:4608
buffer_load_dwordx4 v11,s[12:15],s32 offen offset:3072 lds
v_mfma_f32_16x16x32_bf16 v[80:83],v[124:127],v[96:99],v[80:83]
s_add_u32 s35,s35,49152
v_mfma_f32_16x16x32_bf16 v[84:87],v[124:127],v[100:103],v[84:87]
s_cmp_eq_u32 s35,147456
s_cselect_b32 s35,0,s35
v_mfma_f32_16x16x32_bf16 v[88:91],v[124:127],v[104:107],v[88:91]
s_add_u32 s32,s32,262144
v_mfma_f32_16x16x32_bf16 v[92:95],v[124:127],v[108:111],v[92:95]
s_waitcnt lgkmcnt(4)
v_mfma_f32_16x16x32_bf16 v[32:35],v[144:147],v[128:131],v[32:35]
s_add_u32 s36,s36,49152
v_mfma_f32_16x16x32_bf16 v[36:39],v[144:147],v[132:135],v[36:39]
v_mfma_f32_16x16x32_bf16 v[40:43],v[144:147],v[136:139],v[40:43]
s_cmp_eq_u32 s36,147456
s_cselect_b32 s42,s51,s50
s_cselect_b32 s36,0,s36
v_add_u32 v12,s42,v12
v_add_u32 v14,s42,v14
v_add_u32 v15,s42,v15
v_add_u32 v16,s42,v16
v_add_u32 v17,s42,v17
s_waitcnt vmcnt(12)
s_waitcnt lgkmcnt(0)
s_barrier
ds_read_b128 v[96:99],v12 offset:0
v_mfma_f32_16x16x32_bf16 v[44:47],v[144:147],v[140:143],v[44:47]
ds_read_b64_tr_b16 v[112:113],v14 offset:0
ds_read_b64_tr_b16 v[114:115],v14 offset:512
v_mfma_f32_16x16x32_bf16 v[48:51],v[148:151],v[128:131],v[48:51]
ds_read_b128 v[100:103],v12 offset:2048
buffer_load_dwordx2 v[160:161],v22,s[56:59],0 offen offset:0
v_mfma_f32_16x16x32_bf16 v[52:55],v[148:151],v[132:135],v[52:55]
ds_read_b128 v[104:107],v12 offset:4096
v_mfma_f32_16x16x32_bf16 v[56:59],v[148:151],v[136:139],v[56:59]
buffer_load_dwordx2 v[162:163],v22,s[56:59],0 offen offset:32
v_mfma_f32_16x16x32_bf16 v[60:63],v[148:151],v[140:143],v[60:63]
ds_read_b128 v[108:111],v12 offset:6144
v_mfma_f32_16x16x32_bf16 v[64:67],v[152:155],v[128:131],v[64:67]
ds_read_b64_tr_b16 v[116:117],v15 offset:0
ds_read_b64_tr_b16 v[118:119],v15 offset:512
v_mfma_f32_16x16x32_bf16 v[68:71],v[152:155],v[132:135],v[68:71]
ds_read_b64_tr_b16 v[120:121],v16 offset:0
buffer_load_dwordx2 v[164:165],v22,s[56:59],0 offen offset:64
v_mfma_f32_16x16x32_bf16 v[72:75],v[152:155],v[136:139],v[72:75]
ds_read_b64_tr_b16 v[122:123],v16 offset:512
ds_read_b64_tr_b16 v[124:125],v17 offset:0
v_mfma_f32_16x16x32_bf16 v[76:79],v[152:155],v[140:143],v[76:79]
ds_read_b64_tr_b16 v[126:127],v17 offset:512
v_mfma_f32_16x16x32_bf16 v[80:83],v[156:159],v[128:131],v[80:83]
buffer_load_dwordx2 v[166:167],v22,s[56:59],0 offen offset:96
v_mfma_f32_16x16x32_bf16 v[84:87],v[156:159],v[132:135],v[84:87]
v_mfma_f32_16x16x32_bf16 v[88:91],v[156:159],v[136:139],v[88:91]
v_mfma_f32_16x16x32_bf16 v[92:95],v[156:159],v[140:143],v[92:95]
s_waitcnt lgkmcnt(4)
v_mfma_f32_16x16x32_bf16 v[32:35],v[112:115],v[96:99],v[32:35]
v_add_u32 v13,s42,v13
ds_read_b128 v[128:131],v13 offset:0
v_mfma_f32_16x16x32_bf16 v[36:39],v[112:115],v[100:103],v[36:39]
ds_read_b64_tr_b16 v[144:145],v14 offset:4096
v_mfma_f32_16x16x32_bf16 v[40:43],v[112:115],v[104:107],v[40:43]
ds_read_b64_tr_b16 v[146:147],v14 offset:4608
buffer_load_dwordx2 v[168:169],v22,s[56:59],s60 offen offset:0
v_mfma_f32_16x16x32_bf16 v[44:47],v[112:115],v[108:111],v[44:47]
ds_read_b128 v[132:135],v13 offset:2048
v_mfma_f32_16x16x32_bf16 v[48:51],v[116:119],v[96:99],v[48:51]
ds_read_b128 v[136:139],v13 offset:4096
v_mfma_f32_16x16x32_bf16 v[52:55],v[116:119],v[100:103],v[52:55]
buffer_load_dwordx2 v[170:171],v22,s[56:59],s60 offen offset:32
v_mfma_f32_16x16x32_bf16 v[56:59],v[116:119],v[104:107],v[56:59]
ds_read_b128 v[140:143],v13 offset:6144
v_mfma_f32_16x16x32_bf16 v[60:63],v[116:119],v[108:111],v[60:63]
ds_read_b64_tr_b16 v[148:149],v15 offset:4096
s_waitcnt lgkmcnt(7)
v_mfma_f32_16x16x32_bf16 v[64:67],v[120:123],v[96:99],v[64:67]
ds_read_b64_tr_b16 v[150:151],v15 offset:4608
buffer_load_dwordx2 v[172:173],v22,s[56:59],s60 offen offset:64
v_mfma_f32_16x16x32_bf16 v[68:71],v[120:123],v[100:103],v[68:71]
ds_read_b64_tr_b16 v[152:153],v16 offset:4096
ds_read_b64_tr_b16 v[154:155],v16 offset:4608
v_mfma_f32_16x16x32_bf16 v[72:75],v[120:123],v[104:107],v[72:75]
ds_read_b64_tr_b16 v[156:157],v17 offset:4096
v_mfma_f32_16x16x32_bf16 v[76:79],v[120:123],v[108:111],v[76:79]
ds_read_b64_tr_b16 v[158:159],v17 offset:4608
buffer_load_dwordx2 v[174:175],v22,s[56:59],s60 offen offset:96
v_mfma_f32_16x16x32_bf16 v[80:83],v[124:127],v[96:99],v[80:83]
v_mfma_f32_16x16x32_bf16 v[84:87],v[124:127],v[100:103],v[84:87]
v_mfma_f32_16x16x32_bf16 v[88:91],v[124:127],v[104:107],v[88:91]
v_mfma_f32_16x16x32_bf16 v[92:95],v[124:127],v[108:111],v[92:95]
s_waitcnt lgkmcnt(4)
v_mfma_f32_16x16x32_bf16 v[32:35],v[144:147],v[128:131],v[32:35]
s_add_u32 s36,s36,49152
v_mfma_f32_16x16x32_bf16 v[36:39],v[144:147],v[132:135],v[36:39]
v_mfma_f32_16x16x32_bf16 v[40:43],v[144:147],v[136:139],v[40:43]
s_cmp_eq_u32 s36,147456
s_cselect_b32 s42,s51,s50
s_cselect_b32 s36,0,s36
v_add_u32 v12,s42,v12
v_add_u32 v14,s42,v14
v_add_u32 v15,s42,v15
v_add_u32 v16,s42,v16
v_add_u32 v17,s42,v17
s_waitcnt vmcnt(8)
s_waitcnt lgkmcnt(0)
s_barrier
ds_read_b128 v[96:99],v12 offset:0
v_mfma_f32_16x16x32_bf16 v[44:47],v[144:147],v[140:143],v[44:47]
ds_read_b64_tr_b16 v[112:113],v14 offset:0
ds_read_b64_tr_b16 v[114:115],v14 offset:512
v_mfma_f32_16x16x32_bf16 v[48:51],v[148:151],v[128:131],v[48:51]
ds_read_b128 v[100:103],v12 offset:2048
v_mfma_f32_16x16x32_bf16 v[52:55],v[148:151],v[132:135],v[52:55]
ds_read_b128 v[104:107],v12 offset:4096
v_mfma_f32_16x16x32_bf16 v[56:59],v[148:151],v[136:139],v[56:59]
v_mfma_f32_16x16x32_bf16 v[60:63],v[148:151],v[140:143],v[60:63]
ds_read_b128 v[108:111],v12 offset:6144
v_mfma_f32_16x16x32_bf16 v[64:67],v[152:155],v[128:131],v[64:67]
ds_read_b64_tr_b16 v[116:117],v15 offset:0
ds_read_b64_tr_b16 v[118:119],v15 offset:512
v_mfma_f32_16x16x32_bf16 v[68:71],v[152:155],v[132:135],v[68:71]
ds_read_b64_tr_b16 v[120:121],v16 offset:0
v_mfma_f32_16x16x32_bf16 v[72:75],v[152:155],v[136:139],v[72:75]
ds_read_b64_tr_b16 v[122:123],v16 offset:512
ds_read_b64_tr_b16 v[124:125],v17 offset:0
v_mfma_f32_16x16x32_bf16 v[76:79],v[152:155],v[140:143],v[76:79]
ds_read_b64_tr_b16 v[126:127],v17 offset:512
v_mfma_f32_16x16x32_bf16 v[80:83],v[156:159],v[128:131],v[80:83]
v_mfma_f32_16x16x32_bf16 v[84:87],v[156:159],v[132:135],v[84:87]
v_mfma_f32_16x16x32_bf16 v[88:91],v[156:159],v[136:139],v[88:91]
v_mfma_f32_16x16x32_bf16 v[92:95],v[156:159],v[140:143],v[92:95]
s_waitcnt lgkmcnt(4)
v_mfma_f32_16x16x32_bf16 v[32:35],v[112:115],v[96:99],v[32:35]
v_add_u32 v13,s42,v13
ds_read_b128 v[128:131],v13 offset:0
v_mfma_f32_16x16x32_bf16 v[36:39],v[112:115],v[100:103],v[36:39]
ds_read_b64_tr_b16 v[144:145],v14 offset:4096
v_mfma_f32_16x16x32_bf16 v[40:43],v[112:115],v[104:107],v[40:43]
ds_read_b64_tr_b16 v[146:147],v14 offset:4608
v_mfma_f32_16x16x32_bf16 v[44:47],v[112:115],v[108:111],v[44:47]
ds_read_b128 v[132:135],v13 offset:2048
v_mfma_f32_16x16x32_bf16 v[48:51],v[116:119],v[96:99],v[48:51]
ds_read_b128 v[136:139],v13 offset:4096
v_mfma_f32_16x16x32_bf16 v[52:55],v[116:119],v[100:103],v[52:55]
v_mfma_f32_16x16x32_bf16 v[56:59],v[116:119],v[104:107],v[56:59]
ds_read_b128 v[140:143],v13 offset:6144
v_mfma_f32_16x16x32_bf16 v[60:63],v[116:119],v[108:111],v[60:63]
ds_read_b64_tr_b16 v[148:149],v15 offset:4096
s_waitcnt lgkmcnt(7)
v_mfma_f32_16x16x32_bf16 v[64:67],v[120:123],v[96:99],v[64:67]
ds_read_b64_tr_b16 v[150:151],v15 offset:4608
v_mfma_f32_16x16x32_bf16 v[68:71],v[120:123],v[100:103],v[68:71]
ds_read_b64_tr_b16 v[152:153],v16 offset:4096
ds_read_b64_tr_b16 v[154:155],v16 offset:4608
v_mfma_f32_16x16x32_bf16 v[72:75],v[120:123],v[104:107],v[72:75]
ds_read_b64_tr_b16 v[156:157],v17 offset:4096
v_mfma_f32_16x16x32_bf16 v[76:79],v[120:123],v[108:111],v[76:79]
ds_read_b64_tr_b16 v[158:159],v17 offset:4608
v_mfma_f32_16x16x32_bf16 v[80:83],v[124:127],v[96:99],v[80:83]
v_mfma_f32_16x16x32_bf16 v[84:87],v[124:127],v[100:103],v[84:87]
v_mfma_f32_16x16x32_bf16 v[88:91],v[124:127],v[104:107],v[88:91]
v_mfma_f32_16x16x32_bf16 v[92:95],v[124:127],v[108:111],v[92:95]
s_waitcnt lgkmcnt(4)
v_mfma_f32_16x16x32_bf16 v[32:35],v[144:147],v[128:131],v[32:35]
v_mfma_f32_16x16x32_bf16 v[36:39],v[144:147],v[132:135],v[36:39]
v_mfma_f32_16x16x32_bf16 v[40:43],v[144:147],v[136:139],v[40:43]
v_mfma_f32_16x16x32_bf16 v[44:47],v[144:147],v[140:143],v[44:47]
v_mfma_f32_16x16x32_bf16 v[48:51],v[148:151],v[128:131],v[48:51]
v_mfma_f32_16x16x32_bf16 v[52:55],v[148:151],v[132:135],v[52:55]
v_mfma_f32_16x16x32_bf16 v[56:59],v[148:151],v[136:139],v[56:59]
v_mfma_f32_16x16x32_bf16 v[60:63],v[148:151],v[140:143],v[60:63]
s_waitcnt lgkmcnt(0)
v_mfma_f32_16x16x32_bf16 v[64:67],v[152:155],v[128:131],v[64:67]
v_mfma_f32_16x16x32_bf16 v[68:71],v[152:155],v[132:135],v[68:71]
v_mfma_f32_16x16x32_bf16 v[72:75],v[152:155],v[136:139],v[72:75]
v_mfma_f32_16x16x32_bf16 v[76:79],v[152:155],v[140:143],v[76:79]
v_mfma_f32_16x16x32_bf16 v[80:83],v[156:159],v[128:131],v[80:83]
v_mfma_f32_16x16x32_bf16 v[84:87],v[156:159],v[132:135],v[84:87]
v_mfma_f32_16x16x32_bf16 v[88:91],v[156:159],v[136:139],v[88:91]
v_mfma_f32_16x16x32_bf16 v[92:95],v[156:159],v[140:143],v[92:95]
s_barrier
s_cmp_lt_u32 s20,2
s_cselect_b32 s12,s74,s76
s_cselect_b32 s13,s75,s77
s_mov_b32 s14,7340032
v_mul_u32_u24 v1,4682,v2
v_lshrrev_b32 v1,16,v1
v_mul_u32_u24 v3,14,v1
v_sub_u32 v3,v2,v3
v_lshlrev_b32 v3,4,v3
s_and_b32 s18,s20,1
s_lshl_b32 s18,s18,4
v_add_u32 v1,s18,v1
v_mul_u32_u24 v1,7168,v1
v_add_u32 v1,v1,v3
s_mul_i32 s19,s87,224
v_add_u32 v8,s19,v1
v_add_u32 v9,27776,v8
v_add_u32 v10,55424,v8
v_add_u32 v11,83200,v8
s_lshr_b32 s32,s86,1
s_mul_i32 s32,s32,1835008
s_mov_b32 s35,0
s_lshr_b32 s18,s20,1
s_mul_i32 s41,s18,7680
s_and_b32 s18,s20,1
s_mul_i32 s18,s18,3840
s_add_u32 s41,s41,s18
s_add_u32 s41,s41,65536
s_add_u32 m0,s35,s41
s_nop 0
buffer_load_dwordx4 v8,s[12:15],s32 offen lds
buffer_load_dwordx4 v9,s[12:15],s32 offen offset:896 lds
buffer_load_dwordx4 v10,s[12:15],s32 offen offset:1920 lds
buffer_load_dwordx4 v11,s[12:15],s32 offen offset:2816 lds
s_add_u32 s35,s35,15360
s_cmp_eq_u32 s35,92160
s_cselect_b32 s35,0,s35
s_add_u32 s32,s32,229376
s_cmp_eq_u32 s32,7340032
s_cselect_b32 s32,0,s32
s_add_u32 m0,s35,s41
s_nop 0
buffer_load_dwordx4 v8,s[12:15],s32 offen lds
buffer_load_dwordx4 v9,s[12:15],s32 offen offset:896 lds
buffer_load_dwordx4 v10,s[12:15],s32 offen offset:1920 lds
buffer_load_dwordx4 v11,s[12:15],s32 offen offset:2816 lds
s_add_u32 s35,s35,15360
s_cmp_eq_u32 s35,92160
s_cselect_b32 s35,0,s35
s_add_u32 s32,s32,229376
s_cmp_eq_u32 s32,7340032
s_cselect_b32 s32,0,s32
s_nop 7
s_cmp_eq_u32 s29,0
s_cbranch_scc1 Lwk045
ds_write_b128 v20,v[32:35] offset:0
ds_write_b128 v20,v[48:51] offset:1024
ds_write_b128 v20,v[64:67] offset:2048
ds_write_b128 v20,v[80:83] offset:3072
ds_write_b128 v20,v[36:39] offset:4096
ds_write_b128 v20,v[52:55] offset:5120
ds_write_b128 v20,v[68:71] offset:6144
ds_write_b128 v20,v[84:87] offset:7168
s_waitcnt vmcnt(8)
v_lshlrev_b32 v176,16,v160
v_and_b32 v177,0xffff0000,v160
v_lshlrev_b32 v178,16,v161
v_and_b32 v179,0xffff0000,v161
v_lshlrev_b32 v180,16,v162
v_and_b32 v181,0xffff0000,v162
v_lshlrev_b32 v182,16,v163
v_and_b32 v183,0xffff0000,v163
v_lshlrev_b32 v184,16,v164
v_and_b32 v185,0xffff0000,v164
v_lshlrev_b32 v186,16,v165
v_and_b32 v187,0xffff0000,v165
v_lshlrev_b32 v188,16,v166
v_and_b32 v189,0xffff0000,v166
v_lshlrev_b32 v190,16,v167
v_and_b32 v191,0xffff0000,v167
v_lshlrev_b32 v192,16,v168
v_and_b32 v193,0xffff0000,v168
v_lshlrev_b32 v194,16,v169
v_and_b32 v195,0xffff0000,v169
v_lshlrev_b32 v196,16,v170
v_and_b32 v197,0xffff0000,v170
v_lshlrev_b32 v198,16,v171
v_and_b32 v199,0xffff0000,v171
v_lshlrev_b32 v200,16,v172
v_and_b32 v201,0xffff0000,v172
v_lshlrev_b32 v202,16,v173
v_and_b32 v203,0xffff0000,v173
v_lshlrev_b32 v204,16,v174
v_and_b32 v205,0xffff0000,v174
v_lshlrev_b32 v206,16,v175
v_and_b32 v207,0xffff0000,v175
s_waitcnt lgkmcnt(0)
s_barrier
ds_read_b128 v[96:99],v21 offset:0
ds_read_b128 v[100:103],v21 offset:1024
ds_read_b128 v[104:107],v21 offset:2048
ds_read_b128 v[108:111],v21 offset:3072
ds_read_b128 v[112:115],v21 offset:4096
ds_read_b128 v[116:119],v21 offset:5120
ds_read_b128 v[120:123],v21 offset:6144
ds_read_b128 v[124:127],v21 offset:7168
v_pk_add_f32 v[176:177],v[176:177],v[40:41]
v_pk_add_f32 v[178:179],v[178:179],v[42:43]
v_pk_add_f32 v[180:181],v[180:181],v[56:57]
v_pk_add_f32 v[182:183],v[182:183],v[58:59]
v_pk_add_f32 v[184:185],v[184:185],v[72:73]
v_pk_add_f32 v[186:187],v[186:187],v[74:75]
v_pk_add_f32 v[188:189],v[188:189],v[88:89]
v_pk_add_f32 v[190:191],v[190:191],v[90:91]
v_pk_add_f32 v[192:193],v[192:193],v[44:45]
v_pk_add_f32 v[194:195],v[194:195],v[46:47]
v_pk_add_f32 v[196:197],v[196:197],v[60:61]
v_pk_add_f32 v[198:199],v[198:199],v[62:63]
v_pk_add_f32 v[200:201],v[200:201],v[76:77]
v_pk_add_f32 v[202:203],v[202:203],v[78:79]
v_pk_add_f32 v[204:205],v[204:205],v[92:93]
v_pk_add_f32 v[206:207],v[206:207],v[94:95]
s_branch Lex46
Lwk045:
ds_write_b128 v20,v[40:43] offset:0
ds_write_b128 v20,v[56:59] offset:1024
ds_write_b128 v20,v[72:75] offset:2048
ds_write_b128 v20,v[88:91] offset:3072
ds_write_b128 v20,v[44:47] offset:4096
ds_write_b128 v20,v[60:63] offset:5120
ds_write_b128 v20,v[76:79] offset:6144
ds_write_b128 v20,v[92:95] offset:7168
s_waitcnt vmcnt(8)
v_lshlrev_b32 v176,16,v160
v_and_b32 v177,0xffff0000,v160
v_lshlrev_b32 v178,16,v161
v_and_b32 v179,0xffff0000,v161
v_lshlrev_b32 v180,16,v162
v_and_b32 v181,0xffff0000,v162
v_lshlrev_b32 v182,16,v163
v_and_b32 v183,0xffff0000,v163
v_lshlrev_b32 v184,16,v164
v_and_b32 v185,0xffff0000,v164
v_lshlrev_b32 v186,16,v165
v_and_b32 v187,0xffff0000,v165
v_lshlrev_b32 v188,16,v166
v_and_b32 v189,0xffff0000,v166
v_lshlrev_b32 v190,16,v167
v_and_b32 v191,0xffff0000,v167
v_lshlrev_b32 v192,16,v168
v_and_b32 v193,0xffff0000,v168
v_lshlrev_b32 v194,16,v169
v_and_b32 v195,0xffff0000,v169
v_lshlrev_b32 v196,16,v170
v_and_b32 v197,0xffff0000,v170
v_lshlrev_b32 v198,16,v171
v_and_b32 v199,0xffff0000,v171
v_lshlrev_b32 v200,16,v172
v_and_b32 v201,0xffff0000,v172
v_lshlrev_b32 v202,16,v173
v_and_b32 v203,0xffff0000,v173
v_lshlrev_b32 v204,16,v174
v_and_b32 v205,0xffff0000,v174
v_lshlrev_b32 v206,16,v175
v_and_b32 v207,0xffff0000,v175
s_waitcnt lgkmcnt(0)
s_barrier
ds_read_b128 v[96:99],v21 offset:0
ds_read_b128 v[100:103],v21 offset:1024
ds_read_b128 v[104:107],v21 offset:2048
ds_read_b128 v[108:111],v21 offset:3072
ds_read_b128 v[112:115],v21 offset:4096
ds_read_b128 v[116:119],v21 offset:5120
ds_read_b128 v[120:123],v21 offset:6144
ds_read_b128 v[124:127],v21 offset:7168
v_pk_add_f32 v[176:177],v[176:177],v[32:33]
v_pk_add_f32 v[178:179],v[178:179],v[34:35]
v_pk_add_f32 v[180:181],v[180:181],v[48:49]
v_pk_add_f32 v[182:183],v[182:183],v[50:51]
v_pk_add_f32 v[184:185],v[184:185],v[64:65]
v_pk_add_f32 v[186:187],v[186:187],v[66:67]
v_pk_add_f32 v[188:189],v[188:189],v[80:81]
v_pk_add_f32 v[190:191],v[190:191],v[82:83]
v_pk_add_f32 v[192:193],v[192:193],v[36:37]
v_pk_add_f32 v[194:195],v[194:195],v[38:39]
v_pk_add_f32 v[196:197],v[196:197],v[52:53]
v_pk_add_f32 v[198:199],v[198:199],v[54:55]
v_pk_add_f32 v[200:201],v[200:201],v[68:69]
v_pk_add_f32 v[202:203],v[202:203],v[70:71]
v_pk_add_f32 v[204:205],v[204:205],v[84:85]
v_pk_add_f32 v[206:207],v[206:207],v[86:87]
Lex46:
s_waitcnt lgkmcnt(0)
s_add_u32 s56,s16,4259840
s_addc_u32 s57,s17,0
s_mov_b32 s58,4194304
v_pk_add_f32 v[176:177],v[176:177],v[96:97]
v_pk_add_f32 v[178:179],v[178:179],v[98:99]
v_pk_add_f32 v[180:181],v[180:181],v[100:101]
v_pk_add_f32 v[182:183],v[182:183],v[102:103]
v_pk_add_f32 v[184:185],v[184:185],v[104:105]
v_pk_add_f32 v[186:187],v[186:187],v[106:107]
v_pk_add_f32 v[188:189],v[188:189],v[108:109]
v_pk_add_f32 v[190:191],v[190:191],v[110:111]
v_pk_add_f32 v[192:193],v[192:193],v[112:113]
v_pk_add_f32 v[194:195],v[194:195],v[114:115]
v_pk_add_f32 v[196:197],v[196:197],v[116:117]
v_pk_add_f32 v[198:199],v[198:199],v[118:119]
v_pk_add_f32 v[200:201],v[200:201],v[120:121]
v_pk_add_f32 v[202:203],v[202:203],v[122:123]
v_pk_add_f32 v[204:205],v[204:205],v[124:125]
v_pk_add_f32 v[206:207],v[206:207],v[126:127]
v_cvt_pk_bf16_f32 v32,v176,v177
v_cvt_pk_bf16_f32 v33,v178,v179
v_cvt_pk_bf16_f32 v34,v180,v181
v_cvt_pk_bf16_f32 v35,v182,v183
v_cvt_pk_bf16_f32 v36,v184,v185
v_cvt_pk_bf16_f32 v37,v186,v187
v_cvt_pk_bf16_f32 v38,v188,v189
v_cvt_pk_bf16_f32 v39,v190,v191
v_cvt_pk_bf16_f32 v40,v192,v193
v_cvt_pk_bf16_f32 v41,v194,v195
v_cvt_pk_bf16_f32 v42,v196,v197
v_cvt_pk_bf16_f32 v43,v198,v199
v_cvt_pk_bf16_f32 v44,v200,v201
v_cvt_pk_bf16_f32 v45,v202,v203
v_cvt_pk_bf16_f32 v46,v204,v205
v_cvt_pk_bf16_f32 v47,v206,v207
v_mov_b32 v64,v32
v_mov_b32 v65,v33
v_mov_b32 v66,v34
v_mov_b32 v67,v35
v_mov_b32 v68,v36
v_mov_b32 v69,v37
v_mov_b32 v70,v38
v_mov_b32 v71,v39
v_mov_b32 v72,v40
v_mov_b32 v73,v41
v_mov_b32 v74,v42
v_mov_b32 v75,v43
v_mov_b32 v76,v44
v_mov_b32 v77,v45
v_mov_b32 v78,v46
v_mov_b32 v79,v47
v_permlane16_swap_b32 v32,v34
v_permlane16_swap_b32 v33,v35
buffer_store_dwordx4 v[32:35],v18,s[56:59],0 offen sc1
v_permlane16_swap_b32 v36,v38
v_permlane16_swap_b32 v37,v39
buffer_store_dwordx4 v[36:39],v18,s[56:59],0 offen offset:1024 sc1
v_permlane16_swap_b32 v40,v42
v_permlane16_swap_b32 v41,v43
buffer_store_dwordx4 v[40:43],v18,s[56:59],s60 offen sc1
v_permlane16_swap_b32 v44,v46
v_permlane16_swap_b32 v45,v47
buffer_store_dwordx4 v[44:47],v18,s[56:59],s60 offen offset:1024 sc1
s_mov_b32 s18,0x3f803f80
v_mov_b32 v48,0
v_mov_b32 v49,0
v_mov_b32 v50,0
v_mov_b32 v51,0
v_dot2_f32_bf16 v48,v64,s18,v48
v_dot2_f32_bf16 v49,v64,v64,v49
v_dot2_f32_bf16 v50,v72,s18,v50
v_dot2_f32_bf16 v51,v72,v72,v51
v_dot2_f32_bf16 v48,v65,s18,v48
v_dot2_f32_bf16 v49,v65,v65,v49
v_dot2_f32_bf16 v50,v73,s18,v50
v_dot2_f32_bf16 v51,v73,v73,v51
v_dot2_f32_bf16 v48,v66,s18,v48
v_dot2_f32_bf16 v49,v66,v66,v49
v_dot2_f32_bf16 v50,v74,s18,v50
v_dot2_f32_bf16 v51,v74,v74,v51
v_dot2_f32_bf16 v48,v67,s18,v48
v_dot2_f32_bf16 v49,v67,v67,v49
v_dot2_f32_bf16 v50,v75,s18,v50
v_dot2_f32_bf16 v51,v75,v75,v51
v_dot2_f32_bf16 v48,v68,s18,v48
v_dot2_f32_bf16 v49,v68,v68,v49
v_dot2_f32_bf16 v50,v76,s18,v50
v_dot2_f32_bf16 v51,v76,v76,v51
v_dot2_f32_bf16 v48,v69,s18,v48
v_dot2_f32_bf16 v49,v69,v69,v49
v_dot2_f32_bf16 v50,v77,s18,v50
v_dot2_f32_bf16 v51,v77,v77,v51
v_dot2_f32_bf16 v48,v70,s18,v48
v_dot2_f32_bf16 v49,v70,v70,v49
v_dot2_f32_bf16 v50,v78,s18,v50
v_dot2_f32_bf16 v51,v78,v78,v51
v_dot2_f32_bf16 v48,v71,s18,v48
v_dot2_f32_bf16 v49,v71,v71,v49
v_dot2_f32_bf16 v50,v79,s18,v50
v_dot2_f32_bf16 v51,v79,v79,v51
s_nop 2
v_mov_b32 v52,v48
v_mov_b32 v53,v49
v_mov_b32 v54,v50
v_mov_b32 v55,v51
v_permlane32_swap_b32 v48,v52
v_permlane32_swap_b32 v49,v53
v_permlane32_swap_b32 v50,v54
v_permlane32_swap_b32 v51,v55
v_pk_add_f32 v[48:49],v[48:49],v[52:53]
v_pk_add_f32 v[50:51],v[50:51],v[54:55]
v_mov_b32 v52,v48
v_mov_b32 v53,v49
v_mov_b32 v54,v50
v_mov_b32 v55,v51
v_permlane16_swap_b32 v48,v52
v_permlane16_swap_b32 v49,v53
v_permlane16_swap_b32 v50,v54
v_permlane16_swap_b32 v51,v55
v_pk_add_f32 v[48:49],v[48:49],v[52:53]
v_pk_add_f32 v[50:51],v[50:51],v[54:55]
s_mov_b32 s18,35192832
s_mov_b64 exec,0xffff
buffer_store_dwordx2 v[48:49],v19,s[24:27],s18 offen sc1
buffer_store_dwordx2 v[50:51],v19,s[24:27],s18 offen offset:2048 sc1
s_mov_b64 exec,-1
s_waitcnt vmcnt(0)
s_barrier
s_cmp_lg_u32 s20,0
s_cbranch_scc1 Lpub47
s_and_b32 s18,s84,14
s_add_u32 s18,s18,s88
s_and_b32 s19,s84,1
s_lshl_b32 s19,s19,3
s_and_b32 s39,s85,7
s_add_u32 s19,s19,s39
s_lshl_b32 s18,s18,8
s_lshl_b32 s19,s19,2
s_add_u32 s18,s18,s19
s_add_u32 s18,s18,95469568
v_mov_b32 v1,0
v_mov_b32 v3,s94
s_mov_b64 exec,1
buffer_store_dword v3,v1,s[24:27],s18 offen sc1
s_mov_b64 exec,-1
Lpub47:
s_add_u32 m0,s35,s41
s_nop 0
buffer_load_dwordx4 v8,s[12:15],s32 offen lds
buffer_load_dwordx4 v9,s[12:15],s32 offen offset:896 lds
buffer_load_dwordx4 v10,s[12:15],s32 offen offset:1920 lds
buffer_load_dwordx4 v11,s[12:15],s32 offen offset:2816 lds
s_add_u32 s35,s35,15360
s_cmp_eq_u32 s35,92160
s_cselect_b32 s35,0,s35
s_add_u32 s32,s32,229376
s_cmp_eq_u32 s32,7340032
s_cselect_b32 s32,0,s32
s_add_u32 m0,s35,s41
s_nop 0
buffer_load_dwordx4 v8,s[12:15],s32 offen lds
buffer_load_dwordx4 v9,s[12:15],s32 offen offset:896 lds
buffer_load_dwordx4 v10,s[12:15],s32 offen offset:1920 lds
buffer_load_dwordx4 v11,s[12:15],s32 offen offset:2816 lds
s_add_u32 s35,s35,15360
s_cmp_eq_u32 s35,92160
s_cselect_b32 s35,0,s35
s_add_u32 s32,s32,229376
s_cmp_eq_u32 s32,7340032
s_cselect_b32 s32,0,s32
s_add_u32 s8,s16,4259840
s_addc_u32 s9,s17,0
s_mov_b32 s10,4194304
s_lshl_b32 s23,s86,8
s_lshl_b32 s18,s20,6
s_add_u32 s23,s23,s18
s_mul_i32 s22,s87,112
s_mul_i32 s19,s23,2048
v_lshlrev_b32 v4,4,v2
v_add_u32 v4,s19,v4
v_add_u32 v5,30720,v4
s_lshr_b32 s30,s86,1
s_mul_i32 s30,s30,8192
s_and_b32 s95,s86,1
s_add_u32 s31,s30,65536
s_mov_b32 s34,0
s_lshl_b32 s40,s20,13
s_add_u32 s52,s40,4096
s_mul_i32 s18,s23,7168
s_mul_i32 s19,s87,3584
s_add_u32 s18,s18,s19
v_lshlrev_b32 v15,4,v30
v_and_b32 v1,1,v31
v_lshl_add_u32 v15,v1,9,v15
v_lshrrev_b32 v1,1,v31
v_lshl_add_u32 v15,v1,8,v15
v_add_u32 v15,s18,v15
s_lshl_b32 s18,s23,7
s_add_u32 s60,s18,35192832
v_lshlrev_b32 v29,11,v31
v_lshl_add_u32 v29,v30,4,v29
v_add_u32 v1,s22,v30
v_lshlrev_b32 v28,4,v1
v_and_b32 v1,1,v31
v_mul_u32_u24 v1,163840,v1
v_add_u32 v28,v28,v1
s_mov_b32 s62,94420992
s_mov_b32 s63,94478336
v_lshlrev_b32 v12,4,v2
v_add_u32 v12,s40,v12
v_add_u32 v13,1024,v12
v_mul_u32_u24 v1,1920,v31
v_bfe_u32 v3,v2,2,2
v_mul_u32_u24 v3,224,v3
v_add_u32 v1,v1,v3
v_and_b32 v3,3,v2
v_lshl_add_u32 v1,v3,3,v1
v_add_u32 v14,65536,v1
s_mov_b32 s36,0
s_mov_b32 s37,0
s_mov_b32 s42,0
s_mov_b32 s48,30720
s_mov_b32 s49,0xffff1000
s_mov_b32 s50,32768
s_mov_b32 s51,0xffff8000
s_mov_b32 s44,0xc0135761
s_mov_b32 s45,0xbdd2d3e8
v_mov_b32 v1,0x3f803f80
v_accvgpr_write_b32 a248,v1
v_accvgpr_write_b32 a249,v1
v_accvgpr_write_b32 a250,v1
v_accvgpr_write_b32 a251,v1
s_lshr_b32 s18,s86,2
s_mul_i32 s18,s18,163840
s_and_b32 s19,s86,3
s_lshl_b32 s19,s19,2
s_add_u32 s18,s18,s19
s_add_u32 s54,s18,s62
s_add_u32 s55,s18,s63
v_add_u32 v1,s22,v30
v_lshlrev_b32 v27,4,v1
s_mov_b32 s4,s78
s_mov_b32 s5,s79
s_mov_b32 s6,7340032
s_mov_b32 s7,0x00020000
s_lshl_b32 s18,s2,2
s_add_u32 s18,s18,s20
s_mul_i32 s33,s18,7168
v_lshlrev_b32 v26,7,v31
s_cmp_lg_u32 s20,0
s_cbranch_scc1 Lwbar48
s_lshl_b32 s18,s86,1
s_lshl_b32 s18,s18,8
s_add_u32 s18,s18,95469568
v_lshlrev_b32 v1,2,v30
v_lshl_add_u32 v1,v31,8,v1
s_mov_b32 exec_lo,0xffffffff
s_mov_b32 exec_hi,0
s_mov_b32 s39,131072
Lpoll49:
buffer_load_dword v3,v1,s[24:27],s18 offen sc1
s_waitcnt vmcnt(0)
v_cmp_ne_u32 vcc,s94,v3
s_nop 1
s_cmp_eq_u64 vcc,0
s_cbranch_scc1 Lgot50
s_sleep 1
s_sub_u32 s39,s39,1
s_cmp_lg_u32 s39,0
s_cbranch_scc1 Lpoll49
Lgot50:
s_mov_b64 exec,-1
Lwbar48:
s_barrier
s_add_u32 m0,s34,s40
s_nop 0
buffer_load_dwordx4 v4,s[8:11],s30 offen sc1 lds
buffer_load_dwordx4 v4,s[8:11],s30 offen offset:1024 sc1 lds
buffer_load_dwordx4 v5,s[8:11],s30 offen offset:2048 sc1 lds
buffer_load_dwordx4 v5,s[8:11],s30 offen offset:3072 sc1 lds
s_add_u32 m0,s34,s52
s_nop 0
buffer_load_dwordx4 v4,s[8:11],s31 offen sc1 lds
buffer_load_dwordx4 v4,s[8:11],s31 offen offset:1024 sc1 lds
buffer_load_dwordx4 v5,s[8:11],s31 offen offset:2048 sc1 lds
buffer_load_dwordx4 v5,s[8:11],s31 offen offset:3072 sc1 lds
s_add_u32 s30,s30,2048
s_and_b32 s30,s30,0x7fff
s_add_u32 s34,s34,32768
s_cmp_eq_u32 s34,65536
s_cselect_b32 s34,0,s34
s_add_u32 s31,s30,65536
s_add_u32 m0,s34,s40
s_nop 0
buffer_load_dwordx4 v4,s[8:11],s30 offen sc1 lds
buffer_load_dwordx4 v4,s[8:11],s30 offen offset:1024 sc1 lds
buffer_load_dwordx4 v5,s[8:11],s30 offen offset:2048 sc1 lds
buffer_load_dwordx4 v5,s[8:11],s30 offen offset:3072 sc1 lds
s_add_u32 m0,s34,s52
s_nop 0
buffer_load_dwordx4 v4,s[8:11],s31 offen sc1 lds
buffer_load_dwordx4 v4,s[8:11],s31 offen offset:1024 sc1 lds
buffer_load_dwordx4 v5,s[8:11],s31 offen offset:2048 sc1 lds
buffer_load_dwordx4 v5,s[8:11],s31 offen offset:3072 sc1 lds
s_add_u32 s30,s30,2048
s_and_b32 s30,s30,0x7fff
s_add_u32 s34,s34,32768
s_cmp_eq_u32 s34,65536
s_cselect_b32 s34,0,s34
s_add_u32 s31,s30,65536
s_waitcnt vmcnt(8)
s_barrier
v_cmp_gt_u32 vcc,32,v2
ds_read_b128 a[112:115],v12 offset:0
ds_read_b128 a[128:131],v12 offset:1024
ds_read_b128 a[116:119],v12 offset:2048
ds_read_b128 a[132:135],v12 offset:3072
ds_read_b128 a[120:123],v12 offset:4096
ds_read_b128 a[136:139],v12 offset:5120
ds_read_b128 a[124:127],v12 offset:6144
ds_read_b128 a[140:143],v12 offset:7168
ds_read_b64_tr_b16 a[0:1],v14 offset:0
ds_read_b64_tr_b16 a[2:3],v14 offset:896
ds_read_b64_tr_b16 a[4:5],v14 offset:15360
ds_read_b64_tr_b16 a[6:7],v14 offset:16256
ds_read_b64_tr_b16 a[8:9],v14 offset:32
ds_read_b64_tr_b16 a[10:11],v14 offset:928
ds_read_b64_tr_b16 a[12:13],v14 offset:15392
ds_read_b64_tr_b16 a[14:15],v14 offset:16288
ds_read_b64_tr_b16 a[16:17],v14 offset:64
ds_read_b64_tr_b16 a[18:19],v14 offset:960
ds_read_b64_tr_b16 a[20:21],v14 offset:15424
ds_read_b64_tr_b16 a[22:23],v14 offset:16320
ds_read_b64_tr_b16 a[24:25],v14 offset:96
ds_read_b64_tr_b16 a[26:27],v14 offset:992
ds_read_b64_tr_b16 a[28:29],v14 offset:15456
ds_read_b64_tr_b16 a[30:31],v14 offset:16352
ds_read_b64_tr_b16 a[32:33],v14 offset:128
ds_read_b64_tr_b16 a[34:35],v14 offset:1024
ds_read_b64_tr_b16 a[36:37],v14 offset:15488
ds_read_b64_tr_b16 a[38:39],v14 offset:16384
ds_read_b64_tr_b16 a[40:41],v14 offset:160
ds_read_b64_tr_b16 a[42:43],v14 offset:1056
ds_read_b64_tr_b16 a[44:45],v14 offset:15520
ds_read_b64_tr_b16 a[46:47],v14 offset:16416
ds_read_b64_tr_b16 a[48:49],v14 offset:192
ds_read_b64_tr_b16 a[50:51],v14 offset:1088
ds_read_b64_tr_b16 a[52:53],v14 offset:15552
ds_read_b64_tr_b16 a[54:55],v14 offset:16448
ds_read_b64_tr_b16 a[56:57],v14 offset:7680
ds_read_b64_tr_b16 a[58:59],v14 offset:8576
ds_read_b64_tr_b16 a[60:61],v14 offset:23040
ds_read_b64_tr_b16 a[62:63],v14 offset:23936
ds_read_b64_tr_b16 a[64:65],v14 offset:7712
ds_read_b64_tr_b16 a[66:67],v14 offset:8608
ds_read_b64_tr_b16 a[68:69],v14 offset:23072
ds_read_b64_tr_b16 a[70:71],v14 offset:23968
ds_read_b64_tr_b16 a[72:73],v14 offset:7744
ds_read_b64_tr_b16 a[74:75],v14 offset:8640
ds_read_b64_tr_b16 a[76:77],v14 offset:23104
ds_read_b64_tr_b16 a[78:79],v14 offset:24000
ds_read_b64_tr_b16 a[80:81],v14 offset:7776
ds_read_b64_tr_b16 a[82:83],v14 offset:8672
ds_read_b64_tr_b16 a[84:85],v14 offset:23136
ds_read_b64_tr_b16 a[86:87],v14 offset:24032
ds_read_b64_tr_b16 a[88:89],v14 offset:7808
ds_read_b64_tr_b16 a[90:91],v14 offset:8704
ds_read_b64_tr_b16 a[92:93],v14 offset:23168
ds_read_b64_tr_b16 a[94:95],v14 offset:24064
ds_read_b64_tr_b16 a[96:97],v14 offset:7840
ds_read_b64_tr_b16 a[98:99],v14 offset:8736
ds_read_b64_tr_b16 a[100:101],v14 offset:23200
ds_read_b64_tr_b16 a[102:103],v14 offset:24096
s_add_u32 s37,s37,30720
s_cmp_eq_u32 s37,92160
s_cselect_b32 s43,s49,s48
s_cselect_b32 s37,0,s37
s_waitcnt lgkmcnt(0)
v_mfma_f32_16x16x32_bf16 v[32:35],a[0:3],a[112:115],0
ds_read_b64_tr_b16 a[104:105],v14 offset:7872
s_cmp_eq_u32 s95,0
s_cselect_b32 s39,s20,9
v_mfma_f32_16x16x32_bf16 v[32:35],a[4:7],a[128:131],v[32:35]
ds_read_b64_tr_b16 a[106:107],v14 offset:8768
v_mfma_f32_16x16x32_bf16 v[36:39],a[0:3],a[116:119],0
ds_read_b64_tr_b16 a[108:109],v14 offset:23232
v_mfma_f32_16x16x32_bf16 v[36:39],a[4:7],a[132:135],v[36:39]
ds_read_b64_tr_b16 a[110:111],v14 offset:24128
v_mfma_f32_16x16x32_bf16 v[40:43],a[0:3],a[120:123],0
v_add_u32 v14,s43,v14
v_mfma_f32_16x16x32_bf16 v[40:43],a[4:7],a[136:139],v[40:43]
v_xor_b32 v12,32768,v12
v_mfma_f32_16x16x32_bf16 v[44:47],a[0:3],a[124:127],0
v_mfma_f32_16x16x32_bf16 v[44:47],a[4:7],a[140:143],v[44:47]
s_waitcnt vmcnt(8) lgkmcnt(0)
s_barrier
s_cmp_eq_u32 s39,0
s_cbranch_scc1 Lco51
Lcb52:
v_mfma_f32_16x16x32_bf16 v[48:51],a[8:11],a[112:115],0
ds_read_b64_tr_b16 a[0:1],v14 offset:0
s_add_u32 m0,s34,s40
v_mfma_f32_16x16x32_bf16 v[48:51],a[12:15],a[128:131],v[48:51]
buffer_load_dwordx4 v4,s[8:11],s30 offen sc1 lds
s_add_u32 s37,s37,30720
v_mfma_f32_16x16x32_bf16 v[52:55],a[8:11],a[116:119],0
ds_read_b64_tr_b16 a[2:3],v14 offset:896
v_mfma_f32_16x16x32_bf16 v[52:55],a[12:15],a[132:135],v[52:55]
s_cmp_eq_u32 s37,92160
s_cselect_b32 s43,s49,s48
s_cselect_b32 s37,0,s37
v_mfma_f32_16x16x32_bf16 v[56:59],a[8:11],a[120:123],0
ds_read_b64_tr_b16 a[4:5],v14 offset:15360
v_mfma_f32_16x16x32_bf16 v[56:59],a[12:15],a[136:139],v[56:59]
buffer_load_dwordx4 v4,s[8:11],s30 offen offset:1024 sc1 lds
v_mfma_f32_16x16x32_bf16 v[60:63],a[8:11],a[124:127],0
ds_read_b64_tr_b16 a[6:7],v14 offset:16256
v_mfma_f32_16x16x32_bf16 v[60:63],a[12:15],a[140:143],v[60:63]
s_cmp_eq_u32 s39,1
s_cbranch_scc1 Lco53
Lcb54:
v_mfma_f32_16x16x32_bf16 v[64:67],a[16:19],a[112:115],0
ds_read_b64_tr_b16 a[8:9],v14 offset:32
v_mfma_f32_16x16x32_bf16 v[64:67],a[20:23],a[128:131],v[64:67]
buffer_load_dwordx4 v5,s[8:11],s30 offen offset:2048 sc1 lds
v_mfma_f32_16x16x32_bf16 v[68:71],a[16:19],a[116:119],0
ds_read_b64_tr_b16 a[10:11],v14 offset:928
v_mfma_f32_16x16x32_bf16 v[68:71],a[20:23],a[132:135],v[68:71]
v_mfma_f32_16x16x32_bf16 v[72:75],a[16:19],a[120:123],0
ds_read_b64_tr_b16 a[12:13],v14 offset:15392
v_mfma_f32_16x16x32_bf16 v[72:75],a[20:23],a[136:139],v[72:75]
buffer_load_dwordx4 v5,s[8:11],s30 offen offset:3072 sc1 lds
s_add_u32 m0,s34,s52
v_mfma_f32_16x16x32_bf16 v[76:79],a[16:19],a[124:127],0
ds_read_b64_tr_b16 a[14:15],v14 offset:16288
v_mfma_f32_16x16x32_bf16 v[76:79],a[20:23],a[140:143],v[76:79]
s_cmp_eq_u32 s39,2
s_cbranch_scc1 Lco55
Lcb56:
v_mfma_f32_16x16x32_bf16 v[80:83],a[24:27],a[112:115],0
ds_read_b64_tr_b16 a[16:17],v14 offset:64
v_mfma_f32_16x16x32_bf16 v[80:83],a[28:31],a[128:131],v[80:83]
buffer_load_dwordx4 v4,s[8:11],s31 offen sc1 lds
v_mfma_f32_16x16x32_bf16 v[84:87],a[24:27],a[116:119],0
ds_read_b64_tr_b16 a[18:19],v14 offset:960
v_mfma_f32_16x16x32_bf16 v[84:87],a[28:31],a[132:135],v[84:87]
v_mfma_f32_16x16x32_bf16 v[88:91],a[24:27],a[120:123],0
ds_read_b64_tr_b16 a[20:21],v14 offset:15424
v_mfma_f32_16x16x32_bf16 v[88:91],a[28:31],a[136:139],v[88:91]
buffer_load_dwordx4 v4,s[8:11],s31 offen offset:1024 sc1 lds
v_mfma_f32_16x16x32_bf16 v[92:95],a[24:27],a[124:127],0
ds_read_b64_tr_b16 a[22:23],v14 offset:16320
v_mfma_f32_16x16x32_bf16 v[92:95],a[28:31],a[140:143],v[92:95]
s_cmp_eq_u32 s39,3
s_cbranch_scc1 Lco57
Lcb58:
v_mfma_f32_16x16x32_bf16 v[96:99],a[32:35],a[112:115],0
ds_read_b64_tr_b16 a[24:25],v14 offset:96
v_mfma_f32_16x16x32_bf16 v[96:99],a[36:39],a[128:131],v[96:99]
buffer_load_dwordx4 v5,s[8:11],s31 offen offset:2048 sc1 lds
v_mfma_f32_16x16x32_bf16 v[100:103],a[32:35],a[116:119],0
ds_read_b64_tr_b16 a[26:27],v14 offset:992
v_mfma_f32_16x16x32_bf16 v[100:103],a[36:39],a[132:135],v[100:103]
v_mfma_f32_16x16x32_bf16 v[104:107],a[32:35],a[120:123],0
ds_read_b64_tr_b16 a[28:29],v14 offset:15456
v_mfma_f32_16x16x32_bf16 v[104:107],a[36:39],a[136:139],v[104:107]
buffer_load_dwordx4 v5,s[8:11],s31 offen offset:3072 sc1 lds
s_add_u32 s30,s30,2048
v_mfma_f32_16x16x32_bf16 v[108:111],a[32:35],a[124:127],0
ds_read_b64_tr_b16 a[30:31],v14 offset:16352
s_and_b32 s30,s30,0x7fff
v_mfma_f32_16x16x32_bf16 v[108:111],a[36:39],a[140:143],v[108:111]
s_add_u32 s34,s34,32768
s_cmp_eq_u32 s34,65536
s_cselect_b32 s34,0,s34
s_cmp_eq_u32 s39,0
s_cbranch_scc1 Lco59
Lcb60:
v_mfma_f32_16x16x32_bf16 v[112:115],a[40:43],a[112:115],0
ds_read_b64_tr_b16 a[32:33],v14 offset:128
s_add_u32 s31,s30,65536
v_mfma_f32_16x16x32_bf16 v[112:115],a[44:47],a[128:131],v[112:115]
s_add_u32 m0,s35,s41
s_nop 0
buffer_load_dwordx4 v8,s[12:15],s32 offen lds
v_mfma_f32_16x16x32_bf16 v[116:119],a[40:43],a[116:119],0
ds_read_b64_tr_b16 a[34:35],v14 offset:1024
v_mfma_f32_16x16x32_bf16 v[116:119],a[44:47],a[132:135],v[116:119]
v_mfma_f32_16x16x32_bf16 v[120:123],a[40:43],a[120:123],0
ds_read_b64_tr_b16 a[36:37],v14 offset:15488
v_mfma_f32_16x16x32_bf16 v[120:123],a[44:47],a[136:139],v[120:123]
buffer_load_dwordx4 v9,s[12:15],s32 offen offset:896 lds
v_mfma_f32_16x16x32_bf16 v[124:127],a[40:43],a[124:127],0
ds_read_b64_tr_b16 a[38:39],v14 offset:16384
v_mfma_f32_16x16x32_bf16 v[124:127],a[44:47],a[140:143],v[124:127]
s_cmp_eq_u32 s39,1
s_cbranch_scc1 Lco61
Lcb62:
v_mfma_f32_16x16x32_bf16 v[128:131],a[48:51],a[112:115],0
ds_read_b64_tr_b16 a[40:41],v14 offset:160
v_mfma_f32_16x16x32_bf16 v[128:131],a[52:55],a[128:131],v[128:131]
buffer_load_dwordx4 v10,s[12:15],s32 offen offset:1920 lds
v_mfma_f32_16x16x32_bf16 v[132:135],a[48:51],a[116:119],0
ds_read_b64_tr_b16 a[42:43],v14 offset:1056
v_mfma_f32_16x16x32_bf16 v[132:135],a[52:55],a[132:135],v[132:135]
v_mfma_f32_16x16x32_bf16 v[136:139],a[48:51],a[120:123],0
ds_read_b64_tr_b16 a[44:45],v14 offset:15520
v_mfma_f32_16x16x32_bf16 v[136:139],a[52:55],a[136:139],v[136:139]
buffer_load_dwordx4 v11,s[12:15],s32 offen offset:2816 lds
s_add_u32 s35,s35,15360
v_mfma_f32_16x16x32_bf16 v[140:143],a[48:51],a[124:127],0
ds_read_b64_tr_b16 a[46:47],v14 offset:16416
v_mfma_f32_16x16x32_bf16 v[140:143],a[52:55],a[140:143],v[140:143]
s_cmp_eq_u32 s35,92160
s_cselect_b32 s35,0,s35
s_add_u32 s32,s32,229376
s_cmp_eq_u32 s39,2
s_cbranch_scc1 Lco63
Lcb64:
v_mfma_f32_16x16x32_bf16 v[144:147],a[56:59],a[112:115],0
ds_read_b64_tr_b16 a[48:49],v14 offset:192
v_mfma_f32_16x16x32_bf16 v[144:147],a[60:63],a[128:131],v[144:147]
s_cmp_eq_u32 s32,7340032
s_cselect_b32 s32,0,s32
s_add_u32 m0,s35,s41
v_mfma_f32_16x16x32_bf16 v[148:151],a[56:59],a[116:119],0
ds_read_b64_tr_b16 a[50:51],v14 offset:1088
v_mfma_f32_16x16x32_bf16 v[148:151],a[60:63],a[132:135],v[148:151]
buffer_load_dwordx4 v8,s[12:15],s32 offen lds
v_mfma_f32_16x16x32_bf16 v[152:155],a[56:59],a[120:123],0
ds_read_b64_tr_b16 a[52:53],v14 offset:15552
v_mfma_f32_16x16x32_bf16 v[152:155],a[60:63],a[136:139],v[152:155]
v_mfma_f32_16x16x32_bf16 v[156:159],a[56:59],a[124:127],0
ds_read_b64_tr_b16 a[54:55],v14 offset:16448
v_mfma_f32_16x16x32_bf16 v[156:159],a[60:63],a[140:143],v[156:159]
buffer_load_dwordx4 v9,s[12:15],s32 offen offset:896 lds
s_cmp_eq_u32 s39,3
s_cbranch_scc1 Lco65
Lcb66:
v_mfma_f32_16x16x32_bf16 v[160:163],a[64:67],a[112:115],0
ds_read_b64_tr_b16 a[56:57],v14 offset:7680
v_mfma_f32_16x16x32_bf16 v[160:163],a[68:71],a[128:131],v[160:163]
v_mfma_f32_16x16x32_bf16 v[164:167],a[64:67],a[116:119],0
ds_read_b64_tr_b16 a[58:59],v14 offset:8576
v_mfma_f32_16x16x32_bf16 v[164:167],a[68:71],a[132:135],v[164:167]
buffer_load_dwordx4 v10,s[12:15],s32 offen offset:1920 lds
v_mfma_f32_16x16x32_bf16 v[168:171],a[64:67],a[120:123],0
ds_read_b64_tr_b16 a[60:61],v14 offset:23040
v_mfma_f32_16x16x32_bf16 v[168:171],a[68:71],a[136:139],v[168:171]
v_mfma_f32_16x16x32_bf16 v[172:175],a[64:67],a[124:127],0
ds_read_b64_tr_b16 a[62:63],v14 offset:23936
v_mfma_f32_16x16x32_bf16 v[172:175],a[68:71],a[140:143],v[172:175]
buffer_load_dwordx4 v11,s[12:15],s32 offen offset:2816 lds
s_add_u32 s35,s35,15360
s_cmp_eq_u32 s39,0
s_cbranch_scc1 Lco67
Lcb68:
v_mfma_f32_16x16x32_bf16 v[176:179],a[72:75],a[112:115],0
ds_read_b64_tr_b16 a[64:65],v14 offset:7712
v_mfma_f32_16x16x32_bf16 v[176:179],a[76:79],a[128:131],v[176:179]
s_cmp_eq_u32 s35,92160
s_cselect_b32 s35,0,s35
s_add_u32 s32,s32,229376
v_mfma_f32_16x16x32_bf16 v[180:183],a[72:75],a[116:119],0
ds_read_b64_tr_b16 a[66:67],v14 offset:8608
v_mfma_f32_16x16x32_bf16 v[180:183],a[76:79],a[132:135],v[180:183]
s_cmp_eq_u32 s32,7340032
s_cselect_b32 s32,0,s32
s_add_u32 m0,s35,s41
v_mfma_f32_16x16x32_bf16 v[184:187],a[72:75],a[120:123],0
ds_read_b64_tr_b16 a[68:69],v14 offset:23072
s_waitcnt vmcnt(16)
v_mfma_f32_16x16x32_bf16 v[184:187],a[76:79],a[136:139],v[184:187]
ds_read_b128 a[144:147],v12 offset:0
v_mfma_f32_16x16x32_bf16 v[188:191],a[72:75],a[124:127],0
ds_read_b64_tr_b16 a[70:71],v14 offset:23968
v_mfma_f32_16x16x32_bf16 v[188:191],a[76:79],a[140:143],v[188:191]
buffer_load_dwordx4 v8,s[12:15],s32 offen lds
s_cmp_eq_u32 s39,1
s_cbranch_scc1 Lco69
Lcb70:
v_mfma_f32_16x16x32_bf16 v[192:195],a[80:83],a[112:115],0
ds_read_b64_tr_b16 a[72:73],v14 offset:7744
v_mfma_f32_16x16x32_bf16 v[192:195],a[84:87],a[128:131],v[192:195]
ds_read_b128 a[160:163],v12 offset:1024
v_mfma_f32_16x16x32_bf16 v[196:199],a[80:83],a[116:119],0
ds_read_b64_tr_b16 a[74:75],v14 offset:8640
v_mfma_f32_16x16x32_bf16 v[196:199],a[84:87],a[132:135],v[196:199]
buffer_load_dwordx4 v9,s[12:15],s32 offen offset:896 lds
v_mfma_f32_16x16x32_bf16 v[200:203],a[80:83],a[120:123],0
ds_read_b64_tr_b16 a[76:77],v14 offset:23104
v_mfma_f32_16x16x32_bf16 v[200:203],a[84:87],a[136:139],v[200:203]
ds_read_b128 a[148:151],v12 offset:2048
v_mfma_f32_16x16x32_bf16 v[204:207],a[80:83],a[124:127],0
ds_read_b64_tr_b16 a[78:79],v14 offset:24000
v_mfma_f32_16x16x32_bf16 v[204:207],a[84:87],a[140:143],v[204:207]
buffer_load_dwordx4 v10,s[12:15],s32 offen offset:1920 lds
s_cmp_eq_u32 s39,2
s_cbranch_scc1 Lco71
Lcb72:
v_mfma_f32_16x16x32_bf16 v[208:211],a[88:91],a[112:115],0
ds_read_b64_tr_b16 a[80:81],v14 offset:7776
v_mfma_f32_16x16x32_bf16 v[208:211],a[92:95],a[128:131],v[208:211]
ds_read_b128 a[164:167],v12 offset:3072
v_mfma_f32_16x16x32_bf16 v[212:215],a[88:91],a[116:119],0
ds_read_b64_tr_b16 a[82:83],v14 offset:8672
v_mfma_f32_16x16x32_bf16 v[212:215],a[92:95],a[132:135],v[212:215]
buffer_load_dwordx4 v11,s[12:15],s32 offen offset:2816 lds
s_add_u32 s35,s35,15360
v_mfma_f32_16x16x32_bf16 v[216:219],a[88:91],a[120:123],0
ds_read_b64_tr_b16 a[84:85],v14 offset:23136
v_mfma_f32_16x16x32_bf16 v[216:219],a[92:95],a[136:139],v[216:219]
s_cmp_eq_u32 s35,92160
s_cselect_b32 s35,0,s35
s_add_u32 s32,s32,229376
ds_read_b128 a[152:155],v12 offset:4096
v_mfma_f32_16x16x32_bf16 v[220:223],a[88:91],a[124:127],0
ds_read_b64_tr_b16 a[86:87],v14 offset:24032
v_mfma_f32_16x16x32_bf16 v[220:223],a[92:95],a[140:143],v[220:223]
s_cmp_eq_u32 s32,7340032
s_cselect_b32 s32,0,s32
s_add_u32 m0,s35,s41
s_cmp_eq_u32 s39,3
s_cbranch_scc1 Lco73
Lcb74:
v_mfma_f32_16x16x32_bf16 v[224:227],a[96:99],a[112:115],0
ds_read_b64_tr_b16 a[88:89],v14 offset:7808
v_mfma_f32_16x16x32_bf16 v[224:227],a[100:103],a[128:131],v[224:227]
ds_read_b128 a[168:171],v12 offset:5120
v_mfma_f32_16x16x32_bf16 v[228:231],a[96:99],a[116:119],0
ds_read_b64_tr_b16 a[90:91],v14 offset:8704
v_mfma_f32_16x16x32_bf16 v[228:231],a[100:103],a[132:135],v[228:231]
buffer_load_dwordx4 v8,s[12:15],s32 offen lds
v_mfma_f32_16x16x32_bf16 v[232:235],a[96:99],a[120:123],0
ds_read_b64_tr_b16 a[92:93],v14 offset:23168
v_mfma_f32_16x16x32_bf16 v[232:235],a[100:103],a[136:139],v[232:235]
ds_read_b128 a[156:159],v12 offset:6144
v_mfma_f32_16x16x32_bf16 v[236:239],a[96:99],a[124:127],0
ds_read_b64_tr_b16 a[94:95],v14 offset:24064
v_mfma_f32_16x16x32_bf16 v[236:239],a[100:103],a[140:143],v[236:239]
buffer_load_dwordx4 v9,s[12:15],s32 offen offset:896 lds
s_cmp_eq_u32 s39,0
s_cbranch_scc1 Lco75
Lcb76:
v_mfma_f32_16x16x32_bf16 v[240:243],a[104:107],a[112:115],0
ds_read_b64_tr_b16 a[96:97],v14 offset:7840
v_mfma_f32_16x16x32_bf16 v[240:243],a[108:111],a[128:131],v[240:243]
ds_read_b128 a[172:175],v12 offset:7168
v_mfma_f32_16x16x32_bf16 v[244:247],a[104:107],a[116:119],0
ds_read_b64_tr_b16 a[98:99],v14 offset:8736
v_mfma_f32_16x16x32_bf16 v[244:247],a[108:111],a[132:135],v[244:247]
buffer_load_dwordx4 v10,s[12:15],s32 offen offset:1920 lds
v_mfma_f32_16x16x32_bf16 v[248:251],a[104:107],a[120:123],0
ds_read_b64_tr_b16 a[100:101],v14 offset:23200
v_mfma_f32_16x16x32_bf16 v[248:251],a[108:111],a[136:139],v[248:251]
buffer_load_dwordx4 v11,s[12:15],s32 offen offset:2816 lds
s_add_u32 s35,s35,15360
v_mfma_f32_16x16x32_bf16 v[252:255],a[104:107],a[124:127],0
ds_read_b64_tr_b16 a[102:103],v14 offset:24096
v_mfma_f32_16x16x32_bf16 v[252:255],a[108:111],a[140:143],v[252:255]
s_cmp_eq_u32 s35,92160
s_cselect_b32 s35,0,s35
s_add_u32 s32,s32,229376
s_cmp_eq_u32 s32,7340032
s_cselect_b32 s32,0,s32
s_cmp_eq_u32 s39,1
s_cbranch_scc1 Lco77
Lcb78:
s_waitcnt lgkmcnt(4)
v_mfma_f32_16x16x32_bf16 v[32:35],a[0:3],a[144:147],v[32:35]
ds_read_b64_tr_b16 a[104:105],v14 offset:7872
s_cmp_eq_u32 s95,1
s_cselect_b32 s39,s20,9
v_mfma_f32_16x16x32_bf16 v[32:35],a[4:7],a[160:163],v[32:35]
ds_read_b64_tr_b16 a[106:107],v14 offset:8768
v_mfma_f32_16x16x32_bf16 v[36:39],a[0:3],a[148:151],v[36:39]
ds_read_b64_tr_b16 a[108:109],v14 offset:23232
v_mfma_f32_16x16x32_bf16 v[36:39],a[4:7],a[164:167],v[36:39]
ds_read_b64_tr_b16 a[110:111],v14 offset:24128
v_mfma_f32_16x16x32_bf16 v[40:43],a[0:3],a[152:155],v[40:43]
v_add_u32 v14,s43,v14
v_mfma_f32_16x16x32_bf16 v[40:43],a[4:7],a[168:171],v[40:43]
v_xor_b32 v12,32768,v12
v_mfma_f32_16x16x32_bf16 v[44:47],a[0:3],a[156:159],v[44:47]
v_mfma_f32_16x16x32_bf16 v[44:47],a[4:7],a[172:175],v[44:47]
s_waitcnt vmcnt(8) lgkmcnt(0)
s_barrier
s_cmp_eq_u32 s39,0
s_cbranch_scc1 Lco79
Lcb80:
v_mfma_f32_16x16x32_bf16 v[48:51],a[8:11],a[144:147],v[48:51]
ds_read_b64_tr_b16 a[0:1],v14 offset:0
s_add_u32 m0,s34,s40
v_mfma_f32_16x16x32_bf16 v[48:51],a[12:15],a[160:163],v[48:51]
buffer_load_dwordx4 v4,s[8:11],s30 offen sc1 lds
s_add_u32 s37,s37,30720
v_mfma_f32_16x16x32_bf16 v[52:55],a[8:11],a[148:151],v[52:55]
ds_read_b64_tr_b16 a[2:3],v14 offset:896
v_mfma_f32_16x16x32_bf16 v[52:55],a[12:15],a[164:167],v[52:55]
s_cmp_eq_u32 s37,92160
s_cselect_b32 s43,s49,s48
s_cselect_b32 s37,0,s37
v_mfma_f32_16x16x32_bf16 v[56:59],a[8:11],a[152:155],v[56:59]
ds_read_b64_tr_b16 a[4:5],v14 offset:15360
v_mfma_f32_16x16x32_bf16 v[56:59],a[12:15],a[168:171],v[56:59]
buffer_load_dwordx4 v4,s[8:11],s30 offen offset:1024 sc1 lds
v_mfma_f32_16x16x32_bf16 v[60:63],a[8:11],a[156:159],v[60:63]
ds_read_b64_tr_b16 a[6:7],v14 offset:16256
v_mfma_f32_16x16x32_bf16 v[60:63],a[12:15],a[172:175],v[60:63]
s_cmp_eq_u32 s39,1
s_cbranch_scc1 Lco81
Lcb82:
v_mfma_f32_16x16x32_bf16 v[64:67],a[16:19],a[144:147],v[64:67]
ds_read_b64_tr_b16 a[8:9],v14 offset:32
v_mfma_f32_16x16x32_bf16 v[64:67],a[20:23],a[160:163],v[64:67]
v_mfma_f32_16x16x32_bf16 v[68:71],a[16:19],a[148:151],v[68:71]
ds_read_b64_tr_b16 a[10:11],v14 offset:928
v_mfma_f32_16x16x32_bf16 v[68:71],a[20:23],a[164:167],v[68:71]
buffer_load_dwordx4 v5,s[8:11],s30 offen offset:2048 sc1 lds
v_mfma_f32_16x16x32_bf16 v[72:75],a[16:19],a[152:155],v[72:75]
ds_read_b64_tr_b16 a[12:13],v14 offset:15392
v_mfma_f32_16x16x32_bf16 v[72:75],a[20:23],a[168:171],v[72:75]
v_mfma_f32_16x16x32_bf16 v[76:79],a[16:19],a[156:159],v[76:79]
ds_read_b64_tr_b16 a[14:15],v14 offset:16288
v_mfma_f32_16x16x32_bf16 v[76:79],a[20:23],a[172:175],v[76:79]
s_cmp_eq_u32 s39,2
s_cbranch_scc1 Lco83
Lcb84:
v_mfma_f32_16x16x32_bf16 v[80:83],a[24:27],a[144:147],v[80:83]
ds_read_b64_tr_b16 a[16:17],v14 offset:64
v_mfma_f32_16x16x32_bf16 v[80:83],a[28:31],a[160:163],v[80:83]
buffer_load_dwordx4 v5,s[8:11],s30 offen offset:3072 sc1 lds
s_add_u32 m0,s34,s52
v_mfma_f32_16x16x32_bf16 v[84:87],a[24:27],a[148:151],v[84:87]
ds_read_b64_tr_b16 a[18:19],v14 offset:960
v_mfma_f32_16x16x32_bf16 v[84:87],a[28:31],a[164:167],v[84:87]
v_mfma_f32_16x16x32_bf16 v[88:91],a[24:27],a[152:155],v[88:91]
ds_read_b64_tr_b16 a[20:21],v14 offset:15424
v_mfma_f32_16x16x32_bf16 v[88:91],a[28:31],a[168:171],v[88:91]
v_mfma_f32_16x16x32_bf16 v[92:95],a[24:27],a[156:159],v[92:95]
ds_read_b64_tr_b16 a[22:23],v14 offset:16320
v_mfma_f32_16x16x32_bf16 v[92:95],a[28:31],a[172:175],v[92:95]
buffer_load_dwordx4 v4,s[8:11],s31 offen sc1 lds
s_cmp_eq_u32 s39,3
s_cbranch_scc1 Lco85
Lcb86:
v_mfma_f32_16x16x32_bf16 v[96:99],a[32:35],a[144:147],v[96:99]
ds_read_b64_tr_b16 a[24:25],v14 offset:96
v_mfma_f32_16x16x32_bf16 v[96:99],a[36:39],a[160:163],v[96:99]
v_mfma_f32_16x16x32_bf16 v[100:103],a[32:35],a[148:151],v[100:103]
ds_read_b64_tr_b16 a[26:27],v14 offset:992
v_mfma_f32_16x16x32_bf16 v[100:103],a[36:39],a[164:167],v[100:103]
v_mfma_f32_16x16x32_bf16 v[104:107],a[32:35],a[152:155],v[104:107]
ds_read_b64_tr_b16 a[28:29],v14 offset:15456
v_mfma_f32_16x16x32_bf16 v[104:107],a[36:39],a[168:171],v[104:107]
buffer_load_dwordx4 v4,s[8:11],s31 offen offset:1024 sc1 lds
v_mfma_f32_16x16x32_bf16 v[108:111],a[32:35],a[156:159],v[108:111]
ds_read_b64_tr_b16 a[30:31],v14 offset:16352
v_mfma_f32_16x16x32_bf16 v[108:111],a[36:39],a[172:175],v[108:111]
s_cmp_eq_u32 s39,0
s_cbranch_scc1 Lco87
Lcb88:
v_mfma_f32_16x16x32_bf16 v[112:115],a[40:43],a[144:147],v[112:115]
ds_read_b64_tr_b16 a[32:33],v14 offset:128
v_mfma_f32_16x16x32_bf16 v[112:115],a[44:47],a[160:163],v[112:115]
v_mfma_f32_16x16x32_bf16 v[116:119],a[40:43],a[148:151],v[116:119]
ds_read_b64_tr_b16 a[34:35],v14 offset:1024
v_mfma_f32_16x16x32_bf16 v[116:119],a[44:47],a[164:167],v[116:119]
buffer_load_dwordx4 v5,s[8:11],s31 offen offset:2048 sc1 lds
v_mfma_f32_16x16x32_bf16 v[120:123],a[40:43],a[152:155],v[120:123]
ds_read_b64_tr_b16 a[36:37],v14 offset:15488
v_mfma_f32_16x16x32_bf16 v[120:123],a[44:47],a[168:171],v[120:123]
v_mfma_f32_16x16x32_bf16 v[124:127],a[40:43],a[156:159],v[124:127]
ds_read_b64_tr_b16 a[38:39],v14 offset:16384
v_mfma_f32_16x16x32_bf16 v[124:127],a[44:47],a[172:175],v[124:127]
s_cmp_eq_u32 s39,1
s_cbranch_scc1 Lco89
Lcb90:
v_mfma_f32_16x16x32_bf16 v[128:131],a[48:51],a[144:147],v[128:131]
ds_read_b64_tr_b16 a[40:41],v14 offset:160
v_mfma_f32_16x16x32_bf16 v[128:131],a[52:55],a[160:163],v[128:131]
buffer_load_dwordx4 v5,s[8:11],s31 offen offset:3072 sc1 lds
s_add_u32 s30,s30,2048
v_mfma_f32_16x16x32_bf16 v[132:135],a[48:51],a[148:151],v[132:135]
ds_read_b64_tr_b16 a[42:43],v14 offset:1056
s_and_b32 s30,s30,0x7fff
v_mfma_f32_16x16x32_bf16 v[132:135],a[52:55],a[164:167],v[132:135]
s_add_u32 s34,s34,32768
s_cmp_eq_u32 s34,65536
s_cselect_b32 s34,0,s34
v_mfma_f32_16x16x32_bf16 v[136:139],a[48:51],a[152:155],v[136:139]
ds_read_b64_tr_b16 a[44:45],v14 offset:15520
s_add_u32 s31,s30,65536
v_mfma_f32_16x16x32_bf16 v[136:139],a[52:55],a[168:171],v[136:139]
s_add_u32 m0,s35,s41
v_mfma_f32_16x16x32_bf16 v[140:143],a[48:51],a[156:159],v[140:143]
ds_read_b64_tr_b16 a[46:47],v14 offset:16416
v_mfma_f32_16x16x32_bf16 v[140:143],a[52:55],a[172:175],v[140:143]
buffer_load_dwordx4 v8,s[12:15],s32 offen lds
s_cmp_eq_u32 s39,2
s_cbranch_scc1 Lco91
Lcb92:
v_mfma_f32_16x16x32_bf16 v[144:147],a[56:59],a[144:147],v[144:147]
ds_read_b64_tr_b16 a[48:49],v14 offset:192
v_mfma_f32_16x16x32_bf16 v[144:147],a[60:63],a[160:163],v[144:147]
v_mfma_f32_16x16x32_bf16 v[148:151],a[56:59],a[148:151],v[148:151]
ds_read_b64_tr_b16 a[50:51],v14 offset:1088
v_mfma_f32_16x16x32_bf16 v[148:151],a[60:63],a[164:167],v[148:151]
v_mfma_f32_16x16x32_bf16 v[152:155],a[56:59],a[152:155],v[152:155]
ds_read_b64_tr_b16 a[52:53],v14 offset:15552
v_mfma_f32_16x16x32_bf16 v[152:155],a[60:63],a[168:171],v[152:155]
buffer_load_dwordx4 v9,s[12:15],s32 offen offset:896 lds
v_mfma_f32_16x16x32_bf16 v[156:159],a[56:59],a[156:159],v[156:159]
ds_read_b64_tr_b16 a[54:55],v14 offset:16448
v_mfma_f32_16x16x32_bf16 v[156:159],a[60:63],a[172:175],v[156:159]
s_cmp_eq_u32 s39,3
s_cbranch_scc1 Lco93
Lcb94:
v_mfma_f32_16x16x32_bf16 v[160:163],a[64:67],a[144:147],v[160:163]
ds_read_b64_tr_b16 a[56:57],v14 offset:7680
v_mfma_f32_16x16x32_bf16 v[160:163],a[68:71],a[160:163],v[160:163]
v_mfma_f32_16x16x32_bf16 v[164:167],a[64:67],a[148:151],v[164:167]
ds_read_b64_tr_b16 a[58:59],v14 offset:8576
v_mfma_f32_16x16x32_bf16 v[164:167],a[68:71],a[164:167],v[164:167]
buffer_load_dwordx4 v10,s[12:15],s32 offen offset:1920 lds
v_mfma_f32_16x16x32_bf16 v[168:171],a[64:67],a[152:155],v[168:171]
ds_read_b64_tr_b16 a[60:61],v14 offset:23040
v_mfma_f32_16x16x32_bf16 v[168:171],a[68:71],a[168:171],v[168:171]
v_mfma_f32_16x16x32_bf16 v[172:175],a[64:67],a[156:159],v[172:175]
ds_read_b64_tr_b16 a[62:63],v14 offset:23936
v_mfma_f32_16x16x32_bf16 v[172:175],a[68:71],a[172:175],v[172:175]
s_cmp_eq_u32 s39,0
s_cbranch_scc1 Lco95
Lcb96:
v_mfma_f32_16x16x32_bf16 v[176:179],a[72:75],a[144:147],v[176:179]
ds_read_b64_tr_b16 a[64:65],v14 offset:7712
v_mfma_f32_16x16x32_bf16 v[176:179],a[76:79],a[160:163],v[176:179]
buffer_load_dwordx4 v11,s[12:15],s32 offen offset:2816 lds
s_add_u32 s35,s35,15360
v_mfma_f32_16x16x32_bf16 v[180:183],a[72:75],a[148:151],v[180:183]
ds_read_b64_tr_b16 a[66:67],v14 offset:8608
v_mfma_f32_16x16x32_bf16 v[180:183],a[76:79],a[164:167],v[180:183]
s_cmp_eq_u32 s35,92160
s_cselect_b32 s35,0,s35
s_add_u32 s32,s32,229376
v_mfma_f32_16x16x32_bf16 v[184:187],a[72:75],a[152:155],v[184:187]
ds_read_b64_tr_b16 a[68:69],v14 offset:23072
s_waitcnt vmcnt(20)
v_mfma_f32_16x16x32_bf16 v[184:187],a[76:79],a[168:171],v[184:187]
s_cmp_eq_u32 s32,7340032
s_cselect_b32 s32,0,s32
s_add_u32 m0,s35,s41
ds_read_b128 a[112:115],v12 offset:0
v_mfma_f32_16x16x32_bf16 v[188:191],a[72:75],a[156:159],v[188:191]
ds_read_b64_tr_b16 a[70:71],v14 offset:23968
v_mfma_f32_16x16x32_bf16 v[188:191],a[76:79],a[172:175],v[188:191]
buffer_load_dwordx4 v8,s[12:15],s32 offen lds
s_cmp_eq_u32 s39,1
s_cbranch_scc1 Lco97
Lcb98:
v_mfma_f32_16x16x32_bf16 v[192:195],a[80:83],a[144:147],v[192:195]
ds_read_b64_tr_b16 a[72:73],v14 offset:7744
v_mfma_f32_16x16x32_bf16 v[192:195],a[84:87],a[160:163],v[192:195]
ds_read_b128 a[128:131],v12 offset:1024
v_mfma_f32_16x16x32_bf16 v[196:199],a[80:83],a[148:151],v[196:199]
ds_read_b64_tr_b16 a[74:75],v14 offset:8640
v_mfma_f32_16x16x32_bf16 v[196:199],a[84:87],a[164:167],v[196:199]
v_mfma_f32_16x16x32_bf16 v[200:203],a[80:83],a[152:155],v[200:203]
ds_read_b64_tr_b16 a[76:77],v14 offset:23104
v_mfma_f32_16x16x32_bf16 v[200:203],a[84:87],a[168:171],v[200:203]
ds_read_b128 a[116:119],v12 offset:2048
v_mfma_f32_16x16x32_bf16 v[204:207],a[80:83],a[156:159],v[204:207]
ds_read_b64_tr_b16 a[78:79],v14 offset:24000
v_mfma_f32_16x16x32_bf16 v[204:207],a[84:87],a[172:175],v[204:207]
buffer_load_dwordx4 v9,s[12:15],s32 offen offset:896 lds
s_cmp_eq_u32 s39,2
s_cbranch_scc1 Lco99
Lcb100:
v_mfma_f32_16x16x32_bf16 v[208:211],a[88:91],a[144:147],v[208:211]
ds_read_b64_tr_b16 a[80:81],v14 offset:7776
v_mfma_f32_16x16x32_bf16 v[208:211],a[92:95],a[160:163],v[208:211]
ds_read_b128 a[132:135],v12 offset:3072
v_mfma_f32_16x16x32_bf16 v[212:215],a[88:91],a[148:151],v[212:215]
ds_read_b64_tr_b16 a[82:83],v14 offset:8672
v_mfma_f32_16x16x32_bf16 v[212:215],a[92:95],a[164:167],v[212:215]
buffer_load_dwordx4 v10,s[12:15],s32 offen offset:1920 lds
v_mfma_f32_16x16x32_bf16 v[216:219],a[88:91],a[152:155],v[216:219]
ds_read_b64_tr_b16 a[84:85],v14 offset:23136
v_mfma_f32_16x16x32_bf16 v[216:219],a[92:95],a[168:171],v[216:219]
ds_read_b128 a[120:123],v12 offset:4096
v_mfma_f32_16x16x32_bf16 v[220:223],a[88:91],a[156:159],v[220:223]
ds_read_b64_tr_b16 a[86:87],v14 offset:24032
v_mfma_f32_16x16x32_bf16 v[220:223],a[92:95],a[172:175],v[220:223]
s_cmp_eq_u32 s39,3
s_cbranch_scc1 Lco101
Lcb102:
v_mfma_f32_16x16x32_bf16 v[224:227],a[96:99],a[144:147],v[224:227]
ds_read_b64_tr_b16 a[88:89],v14 offset:7808
v_mfma_f32_16x16x32_bf16 v[224:227],a[100:103],a[160:163],v[224:227]
ds_read_b128 a[136:139],v12 offset:5120
v_mfma_f32_16x16x32_bf16 v[228:231],a[96:99],a[148:151],v[228:231]
ds_read_b64_tr_b16 a[90:91],v14 offset:8704
v_mfma_f32_16x16x32_bf16 v[228:231],a[100:103],a[164:167],v[228:231]
buffer_load_dwordx4 v11,s[12:15],s32 offen offset:2816 lds
s_add_u32 s35,s35,15360
v_mfma_f32_16x16x32_bf16 v[232:235],a[96:99],a[152:155],v[232:235]
ds_read_b64_tr_b16 a[92:93],v14 offset:23168
v_mfma_f32_16x16x32_bf16 v[232:235],a[100:103],a[168:171],v[232:235]
s_cmp_eq_u32 s35,92160
s_cselect_b32 s35,0,s35
s_add_u32 s32,s32,229376
ds_read_b128 a[124:127],v12 offset:6144
v_mfma_f32_16x16x32_bf16 v[236:239],a[96:99],a[156:159],v[236:239]
ds_read_b64_tr_b16 a[94:95],v14 offset:24064
v_mfma_f32_16x16x32_bf16 v[236:239],a[100:103],a[172:175],v[236:239]
s_cmp_eq_u32 s32,7340032
s_cselect_b32 s32,0,s32
s_cmp_eq_u32 s39,0
s_cbranch_scc1 Lco103
Lcb104:
v_mfma_f32_16x16x32_bf16 v[240:243],a[104:107],a[144:147],v[240:243]
ds_read_b64_tr_b16 a[96:97],v14 offset:7840
v_mfma_f32_16x16x32_bf16 v[240:243],a[108:111],a[160:163],v[240:243]
ds_read_b128 a[140:143],v12 offset:7168
v_mfma_f32_16x16x32_bf16 v[244:247],a[104:107],a[148:151],v[244:247]
ds_read_b64_tr_b16 a[98:99],v14 offset:8736
v_mfma_f32_16x16x32_bf16 v[244:247],a[108:111],a[164:167],v[244:247]
buffer_load_dword a252,v26,s[4:7],s33 offen
s_add_u32 s33,s33,512
v_mfma_f32_16x16x32_bf16 v[248:251],a[104:107],a[152:155],v[248:251]
ds_read_b64_tr_b16 a[100:101],v14 offset:23200
v_mfma_f32_16x16x32_bf16 v[248:251],a[108:111],a[168:171],v[248:251]
v_mfma_f32_16x16x32_bf16 v[252:255],a[104:107],a[156:159],v[252:255]
ds_read_b64_tr_b16 a[102:103],v14 offset:24096
v_mfma_f32_16x16x32_bf16 v[252:255],a[108:111],a[172:175],v[252:255]
s_cmp_eq_u32 s39,1
s_cbranch_scc1 Lco105
Lcb106:
s_waitcnt lgkmcnt(4)
v_mfma_f32_16x16x32_bf16 v[32:35],a[0:3],a[112:115],v[32:35]
ds_read_b64_tr_b16 a[104:105],v14 offset:7872
s_cmp_eq_u32 s95,0
s_cselect_b32 s39,s20,9
v_mfma_f32_16x16x32_bf16 v[32:35],a[4:7],a[128:131],v[32:35]
ds_read_b64_tr_b16 a[106:107],v14 offset:8768
v_mfma_f32_16x16x32_bf16 v[36:39],a[0:3],a[116:119],v[36:39]
ds_read_b64_tr_b16 a[108:109],v14 offset:23232
v_mfma_f32_16x16x32_bf16 v[36:39],a[4:7],a[132:135],v[36:39]
ds_read_b64_tr_b16 a[110:111],v14 offset:24128
v_mfma_f32_16x16x32_bf16 v[40:43],a[0:3],a[120:123],v[40:43]
v_add_u32 v14,s43,v14
v_mfma_f32_16x16x32_bf16 v[40:43],a[4:7],a[136:139],v[40:43]
v_xor_b32 v12,32768,v12
v_mfma_f32_16x16x32_bf16 v[44:47],a[0:3],a[124:127],v[44:47]
v_mfma_f32_16x16x32_bf16 v[44:47],a[4:7],a[140:143],v[44:47]
s_waitcnt vmcnt(17) lgkmcnt(0)
s_barrier
s_cmp_eq_u32 s39,0
s_cbranch_scc1 Lco107
Lcb108:
v_mfma_f32_16x16x32_bf16 v[48:51],a[8:11],a[112:115],v[48:51]
ds_read_b64_tr_b16 a[0:1],v14 offset:0
s_add_u32 m0,s34,s40
v_mfma_f32_16x16x32_bf16 v[48:51],a[12:15],a[128:131],v[48:51]
buffer_load_dwordx4 v4,s[8:11],s30 offen sc1 lds
s_add_u32 s37,s37,30720
v_mfma_f32_16x16x32_bf16 v[52:55],a[8:11],a[116:119],v[52:55]
ds_read_b64_tr_b16 a[2:3],v14 offset:896
v_mfma_f32_16x16x32_bf16 v[52:55],a[12:15],a[132:135],v[52:55]
s_cmp_eq_u32 s37,92160
s_cselect_b32 s43,s49,s48
s_cselect_b32 s37,0,s37
v_mfma_f32_16x16x32_bf16 v[56:59],a[8:11],a[120:123],v[56:59]
ds_read_b64_tr_b16 a[4:5],v14 offset:15360
v_mfma_f32_16x16x32_bf16 v[56:59],a[12:15],a[136:139],v[56:59]
buffer_load_dwordx4 v4,s[8:11],s30 offen offset:1024 sc1 lds
v_mfma_f32_16x16x32_bf16 v[60:63],a[8:11],a[124:127],v[60:63]
ds_read_b64_tr_b16 a[6:7],v14 offset:16256
v_mfma_f32_16x16x32_bf16 v[60:63],a[12:15],a[140:143],v[60:63]
s_cmp_eq_u32 s39,1
s_cbranch_scc1 Lco109
Lcb110:
v_mfma_f32_16x16x32_bf16 v[64:67],a[16:19],a[112:115],v[64:67]
ds_read_b64_tr_b16 a[8:9],v14 offset:32
v_mfma_f32_16x16x32_bf16 v[64:67],a[20:23],a[128:131],v[64:67]
v_mfma_f32_16x16x32_bf16 v[68:71],a[16:19],a[116:119],v[68:71]
ds_read_b64_tr_b16 a[10:11],v14 offset:928
v_mfma_f32_16x16x32_bf16 v[68:71],a[20:23],a[132:135],v[68:71]
buffer_load_dwordx4 v5,s[8:11],s30 offen offset:2048 sc1 lds
v_mfma_f32_16x16x32_bf16 v[72:75],a[16:19],a[120:123],v[72:75]
ds_read_b64_tr_b16 a[12:13],v14 offset:15392
v_mfma_f32_16x16x32_bf16 v[72:75],a[20:23],a[136:139],v[72:75]
v_mfma_f32_16x16x32_bf16 v[76:79],a[16:19],a[124:127],v[76:79]
ds_read_b64_tr_b16 a[14:15],v14 offset:16288
v_mfma_f32_16x16x32_bf16 v[76:79],a[20:23],a[140:143],v[76:79]
s_cmp_eq_u32 s39,2
s_cbranch_scc1 Lco111
Lcb112:
v_mfma_f32_16x16x32_bf16 v[80:83],a[24:27],a[112:115],v[80:83]
ds_read_b64_tr_b16 a[16:17],v14 offset:64
v_mfma_f32_16x16x32_bf16 v[80:83],a[28:31],a[128:131],v[80:83]
buffer_load_dwordx4 v5,s[8:11],s30 offen offset:3072 sc1 lds
s_add_u32 m0,s34,s52
v_mfma_f32_16x16x32_bf16 v[84:87],a[24:27],a[116:119],v[84:87]
ds_read_b64_tr_b16 a[18:19],v14 offset:960
v_mfma_f32_16x16x32_bf16 v[84:87],a[28:31],a[132:135],v[84:87]
v_mfma_f32_16x16x32_bf16 v[88:91],a[24:27],a[120:123],v[88:91]
ds_read_b64_tr_b16 a[20:21],v14 offset:15424
v_mfma_f32_16x16x32_bf16 v[88:91],a[28:31],a[136:139],v[88:91]
v_mfma_f32_16x16x32_bf16 v[92:95],a[24:27],a[124:127],v[92:95]
ds_read_b64_tr_b16 a[22:23],v14 offset:16320
v_mfma_f32_16x16x32_bf16 v[92:95],a[28:31],a[140:143],v[92:95]
buffer_load_dwordx4 v4,s[8:11],s31 offen sc1 lds
s_cmp_eq_u32 s39,3
s_cbranch_scc1 Lco113
Lcb114:
v_mfma_f32_16x16x32_bf16 v[96:99],a[32:35],a[112:115],v[96:99]
ds_read_b64_tr_b16 a[24:25],v14 offset:96
v_mfma_f32_16x16x32_bf16 v[96:99],a[36:39],a[128:131],v[96:99]
v_mfma_f32_16x16x32_bf16 v[100:103],a[32:35],a[116:119],v[100:103]
ds_read_b64_tr_b16 a[26:27],v14 offset:992
v_mfma_f32_16x16x32_bf16 v[100:103],a[36:39],a[132:135],v[100:103]
v_mfma_f32_16x16x32_bf16 v[104:107],a[32:35],a[120:123],v[104:107]
ds_read_b64_tr_b16 a[28:29],v14 offset:15456
v_mfma_f32_16x16x32_bf16 v[104:107],a[36:39],a[136:139],v[104:107]
buffer_load_dwordx4 v4,s[8:11],s31 offen offset:1024 sc1 lds
v_mfma_f32_16x16x32_bf16 v[108:111],a[32:35],a[124:127],v[108:111]
ds_read_b64_tr_b16 a[30:31],v14 offset:16352
v_mfma_f32_16x16x32_bf16 v[108:111],a[36:39],a[140:143],v[108:111]
s_cmp_eq_u32 s39,0
s_cbranch_scc1 Lco115
Lcb116:
v_mfma_f32_16x16x32_bf16 v[112:115],a[40:43],a[112:115],v[112:115]
ds_read_b64_tr_b16 a[32:33],v14 offset:128
v_mfma_f32_16x16x32_bf16 v[112:115],a[44:47],a[128:131],v[112:115]
v_mfma_f32_16x16x32_bf16 v[116:119],a[40:43],a[116:119],v[116:119]
ds_read_b64_tr_b16 a[34:35],v14 offset:1024
v_mfma_f32_16x16x32_bf16 v[116:119],a[44:47],a[132:135],v[116:119]
buffer_load_dwordx4 v5,s[8:11],s31 offen offset:2048 sc1 lds
v_mfma_f32_16x16x32_bf16 v[120:123],a[40:43],a[120:123],v[120:123]
ds_read_b64_tr_b16 a[36:37],v14 offset:15488
v_mfma_f32_16x16x32_bf16 v[120:123],a[44:47],a[136:139],v[120:123]
v_mfma_f32_16x16x32_bf16 v[124:127],a[40:43],a[124:127],v[124:127]
ds_read_b64_tr_b16 a[38:39],v14 offset:16384
v_mfma_f32_16x16x32_bf16 v[124:127],a[44:47],a[140:143],v[124:127]
s_cmp_eq_u32 s39,1
s_cbranch_scc1 Lco117
Lcb118:
v_mfma_f32_16x16x32_bf16 v[128:131],a[48:51],a[112:115],v[128:131]
ds_read_b64_tr_b16 a[40:41],v14 offset:160
v_mfma_f32_16x16x32_bf16 v[128:131],a[52:55],a[128:131],v[128:131]
buffer_load_dwordx4 v5,s[8:11],s31 offen offset:3072 sc1 lds
s_add_u32 s30,s30,2048
v_mfma_f32_16x16x32_bf16 v[132:135],a[48:51],a[116:119],v[132:135]
ds_read_b64_tr_b16 a[42:43],v14 offset:1056
s_and_b32 s30,s30,0x7fff
v_mfma_f32_16x16x32_bf16 v[132:135],a[52:55],a[132:135],v[132:135]
s_add_u32 s34,s34,32768
s_cmp_eq_u32 s34,65536
s_cselect_b32 s34,0,s34
v_mfma_f32_16x16x32_bf16 v[136:139],a[48:51],a[120:123],v[136:139]
ds_read_b64_tr_b16 a[44:45],v14 offset:15520
s_add_u32 s31,s30,65536
v_mfma_f32_16x16x32_bf16 v[136:139],a[52:55],a[136:139],v[136:139]
s_add_u32 m0,s35,s41
v_mfma_f32_16x16x32_bf16 v[140:143],a[48:51],a[124:127],v[140:143]
ds_read_b64_tr_b16 a[46:47],v14 offset:16416
v_mfma_f32_16x16x32_bf16 v[140:143],a[52:55],a[140:143],v[140:143]
buffer_load_dwordx4 v8,s[12:15],s32 offen lds
s_cmp_eq_u32 s39,2
s_cbranch_scc1 Lco119
Lcb120:
v_mfma_f32_16x16x32_bf16 v[144:147],a[56:59],a[112:115],v[144:147]
ds_read_b64_tr_b16 a[48:49],v14 offset:192
v_mfma_f32_16x16x32_bf16 v[144:147],a[60:63],a[128:131],v[144:147]
v_mfma_f32_16x16x32_bf16 v[148:151],a[56:59],a[116:119],v[148:151]
ds_read_b64_tr_b16 a[50:51],v14 offset:1088
v_mfma_f32_16x16x32_bf16 v[148:151],a[60:63],a[132:135],v[148:151]
v_mfma_f32_16x16x32_bf16 v[152:155],a[56:59],a[120:123],v[152:155]
ds_read_b64_tr_b16 a[52:53],v14 offset:15552
v_mfma_f32_16x16x32_bf16 v[152:155],a[60:63],a[136:139],v[152:155]
buffer_load_dwordx4 v9,s[12:15],s32 offen offset:896 lds
v_mfma_f32_16x16x32_bf16 v[156:159],a[56:59],a[124:127],v[156:159]
ds_read_b64_tr_b16 a[54:55],v14 offset:16448
v_mfma_f32_16x16x32_bf16 v[156:159],a[60:63],a[140:143],v[156:159]
s_cmp_eq_u32 s39,3
s_cbranch_scc1 Lco121
Lcb122:
v_mfma_f32_16x16x32_bf16 v[160:163],a[64:67],a[112:115],v[160:163]
ds_read_b64_tr_b16 a[56:57],v14 offset:7680
v_mfma_f32_16x16x32_bf16 v[160:163],a[68:71],a[128:131],v[160:163]
v_mfma_f32_16x16x32_bf16 v[164:167],a[64:67],a[116:119],v[164:167]
ds_read_b64_tr_b16 a[58:59],v14 offset:8576
v_mfma_f32_16x16x32_bf16 v[164:167],a[68:71],a[132:135],v[164:167]
buffer_load_dwordx4 v10,s[12:15],s32 offen offset:1920 lds
v_mfma_f32_16x16x32_bf16 v[168:171],a[64:67],a[120:123],v[168:171]
ds_read_b64_tr_b16 a[60:61],v14 offset:23040
v_mfma_f32_16x16x32_bf16 v[168:171],a[68:71],a[136:139],v[168:171]
v_mfma_f32_16x16x32_bf16 v[172:175],a[64:67],a[124:127],v[172:175]
ds_read_b64_tr_b16 a[62:63],v14 offset:23936
v_mfma_f32_16x16x32_bf16 v[172:175],a[68:71],a[140:143],v[172:175]
s_cmp_eq_u32 s39,0
s_cbranch_scc1 Lco123
Lcb124:
v_mfma_f32_16x16x32_bf16 v[176:179],a[72:75],a[112:115],v[176:179]
ds_read_b64_tr_b16 a[64:65],v14 offset:7712
v_mfma_f32_16x16x32_bf16 v[176:179],a[76:79],a[128:131],v[176:179]
buffer_load_dwordx4 v11,s[12:15],s32 offen offset:2816 lds
s_add_u32 s35,s35,15360
v_mfma_f32_16x16x32_bf16 v[180:183],a[72:75],a[116:119],v[180:183]
ds_read_b64_tr_b16 a[66:67],v14 offset:8608
v_mfma_f32_16x16x32_bf16 v[180:183],a[76:79],a[132:135],v[180:183]
s_cmp_eq_u32 s35,92160
s_cselect_b32 s35,0,s35
s_add_u32 s32,s32,229376
v_mfma_f32_16x16x32_bf16 v[184:187],a[72:75],a[120:123],v[184:187]
ds_read_b64_tr_b16 a[68:69],v14 offset:23072
s_waitcnt vmcnt(21)
v_mfma_f32_16x16x32_bf16 v[184:187],a[76:79],a[136:139],v[184:187]
s_cmp_eq_u32 s32,7340032
s_cselect_b32 s32,0,s32
s_add_u32 m0,s35,s41
ds_read_b128 a[144:147],v12 offset:0
v_mfma_f32_16x16x32_bf16 v[188:191],a[72:75],a[124:127],v[188:191]
ds_read_b64_tr_b16 a[70:71],v14 offset:23968
v_mfma_f32_16x16x32_bf16 v[188:191],a[76:79],a[140:143],v[188:191]
buffer_load_dwordx4 v8,s[12:15],s32 offen lds
s_cmp_eq_u32 s39,1
s_cbranch_scc1 Lco125
Lcb126:
v_mfma_f32_16x16x32_bf16 v[192:195],a[80:83],a[112:115],v[192:195]
ds_read_b64_tr_b16 a[72:73],v14 offset:7744
v_mfma_f32_16x16x32_bf16 v[192:195],a[84:87],a[128:131],v[192:195]
ds_read_b128 a[160:163],v12 offset:1024
v_mfma_f32_16x16x32_bf16 v[196:199],a[80:83],a[116:119],v[196:199]
ds_read_b64_tr_b16 a[74:75],v14 offset:8640
v_mfma_f32_16x16x32_bf16 v[196:199],a[84:87],a[132:135],v[196:199]
v_mfma_f32_16x16x32_bf16 v[200:203],a[80:83],a[120:123],v[200:203]
ds_read_b64_tr_b16 a[76:77],v14 offset:23104
v_mfma_f32_16x16x32_bf16 v[200:203],a[84:87],a[136:139],v[200:203]
ds_read_b128 a[148:151],v12 offset:2048
v_mfma_f32_16x16x32_bf16 v[204:207],a[80:83],a[124:127],v[204:207]
ds_read_b64_tr_b16 a[78:79],v14 offset:24000
v_mfma_f32_16x16x32_bf16 v[204:207],a[84:87],a[140:143],v[204:207]
buffer_load_dwordx4 v9,s[12:15],s32 offen offset:896 lds
s_cmp_eq_u32 s39,2
s_cbranch_scc1 Lco127
Lcb128:
v_mfma_f32_16x16x32_bf16 v[208:211],a[88:91],a[112:115],v[208:211]
ds_read_b64_tr_b16 a[80:81],v14 offset:7776
v_mfma_f32_16x16x32_bf16 v[208:211],a[92:95],a[128:131],v[208:211]
ds_read_b128 a[164:167],v12 offset:3072
v_mfma_f32_16x16x32_bf16 v[212:215],a[88:91],a[116:119],v[212:215]
ds_read_b64_tr_b16 a[82:83],v14 offset:8672
v_mfma_f32_16x16x32_bf16 v[212:215],a[92:95],a[132:135],v[212:215]
buffer_load_dwordx4 v10,s[12:15],s32 offen offset:1920 lds
v_mfma_f32_16x16x32_bf16 v[216:219],a[88:91],a[120:123],v[216:219]
ds_read_b64_tr_b16 a[84:85],v14 offset:23136
v_mfma_f32_16x16x32_bf16 v[216:219],a[92:95],a[136:139],v[216:219]
ds_read_b128 a[152:155],v12 offset:4096
v_mfma_f32_16x16x32_bf16 v[220:223],a[88:91],a[124:127],v[220:223]
ds_read_b64_tr_b16 a[86:87],v14 offset:24032
v_mfma_f32_16x16x32_bf16 v[220:223],a[92:95],a[140:143],v[220:223]
s_cmp_eq_u32 s39,3
s_cbranch_scc1 Lco129
Lcb130:
v_mfma_f32_16x16x32_bf16 v[224:227],a[96:99],a[112:115],v[224:227]
ds_read_b64_tr_b16 a[88:89],v14 offset:7808
v_mfma_f32_16x16x32_bf16 v[224:227],a[100:103],a[128:131],v[224:227]
ds_read_b128 a[168:171],v12 offset:5120
v_mfma_f32_16x16x32_bf16 v[228:231],a[96:99],a[116:119],v[228:231]
ds_read_b64_tr_b16 a[90:91],v14 offset:8704
v_mfma_f32_16x16x32_bf16 v[228:231],a[100:103],a[132:135],v[228:231]
buffer_load_dwordx4 v11,s[12:15],s32 offen offset:2816 lds
s_add_u32 s35,s35,15360
v_mfma_f32_16x16x32_bf16 v[232:235],a[96:99],a[120:123],v[232:235]
ds_read_b64_tr_b16 a[92:93],v14 offset:23168
v_mfma_f32_16x16x32_bf16 v[232:235],a[100:103],a[136:139],v[232:235]
s_cmp_eq_u32 s35,92160
s_cselect_b32 s35,0,s35
s_add_u32 s32,s32,229376
ds_read_b128 a[156:159],v12 offset:6144
v_mfma_f32_16x16x32_bf16 v[236:239],a[96:99],a[124:127],v[236:239]
ds_read_b64_tr_b16 a[94:95],v14 offset:24064
v_mfma_f32_16x16x32_bf16 v[236:239],a[100:103],a[140:143],v[236:239]
s_cmp_eq_u32 s32,7340032
s_cselect_b32 s32,0,s32
s_cmp_eq_u32 s39,0
s_cbranch_scc1 Lco131
Lcb132:
v_mfma_f32_16x16x32_bf16 v[240:243],a[104:107],a[112:115],v[240:243]
ds_read_b64_tr_b16 a[96:97],v14 offset:7840
v_mfma_f32_16x16x32_bf16 v[240:243],a[108:111],a[128:131],v[240:243]
ds_read_b128 a[172:175],v12 offset:7168
v_mfma_f32_16x16x32_bf16 v[244:247],a[104:107],a[116:119],v[244:247]
ds_read_b64_tr_b16 a[98:99],v14 offset:8736
v_mfma_f32_16x16x32_bf16 v[244:247],a[108:111],a[132:135],v[244:247]
buffer_load_dword a252,v26,s[4:7],s33 offen
s_add_u32 s33,s33,512
v_mfma_f32_16x16x32_bf16 v[248:251],a[104:107],a[120:123],v[248:251]
ds_read_b64_tr_b16 a[100:101],v14 offset:23200
v_mfma_f32_16x16x32_bf16 v[248:251],a[108:111],a[136:139],v[248:251]
v_mfma_f32_16x16x32_bf16 v[252:255],a[104:107],a[124:127],v[252:255]
ds_read_b64_tr_b16 a[102:103],v14 offset:24096
v_mfma_f32_16x16x32_bf16 v[252:255],a[108:111],a[140:143],v[252:255]
s_cmp_eq_u32 s39,1
s_cbranch_scc1 Lco133
Lcb134:
s_waitcnt lgkmcnt(4)
v_mfma_f32_16x16x32_bf16 v[32:35],a[0:3],a[144:147],v[32:35]
ds_read_b64_tr_b16 a[104:105],v14 offset:7872
s_cmp_eq_u32 s95,1
s_cselect_b32 s39,s20,9
v_mfma_f32_16x16x32_bf16 v[32:35],a[4:7],a[160:163],v[32:35]
ds_read_b64_tr_b16 a[106:107],v14 offset:8768
v_mfma_f32_16x16x32_bf16 v[36:39],a[0:3],a[148:151],v[36:39]
ds_read_b64_tr_b16 a[108:109],v14 offset:23232
v_mfma_f32_16x16x32_bf16 v[36:39],a[4:7],a[164:167],v[36:39]
ds_read_b64_tr_b16 a[110:111],v14 offset:24128
v_mfma_f32_16x16x32_bf16 v[40:43],a[0:3],a[152:155],v[40:43]
v_add_u32 v14,s43,v14
v_mfma_f32_16x16x32_bf16 v[40:43],a[4:7],a[168:171],v[40:43]
v_xor_b32 v12,32768,v12
v_mfma_f32_16x16x32_bf16 v[44:47],a[0:3],a[156:159],v[44:47]
v_mfma_f32_16x16x32_bf16 v[44:47],a[4:7],a[172:175],v[44:47]
s_waitcnt vmcnt(18) lgkmcnt(0)
s_barrier
s_cmp_eq_u32 s39,0
s_cbranch_scc1 Lco135
Lcb136:
v_mfma_f32_16x16x32_bf16 v[48:51],a[8:11],a[144:147],v[48:51]
ds_read_b64_tr_b16 a[0:1],v14 offset:0
s_add_u32 m0,s34,s40
v_mfma_f32_16x16x32_bf16 v[48:51],a[12:15],a[160:163],v[48:51]
buffer_load_dwordx4 v4,s[8:11],s30 offen sc1 lds
s_add_u32 s37,s37,30720
v_mfma_f32_16x16x32_bf16 v[52:55],a[8:11],a[148:151],v[52:55]
ds_read_b64_tr_b16 a[2:3],v14 offset:896
v_mfma_f32_16x16x32_bf16 v[52:55],a[12:15],a[164:167],v[52:55]
s_cmp_eq_u32 s37,92160
s_cselect_b32 s43,s49,s48
s_cselect_b32 s37,0,s37
v_mfma_f32_16x16x32_bf16 v[56:59],a[8:11],a[152:155],v[56:59]
ds_read_b64_tr_b16 a[4:5],v14 offset:15360
v_mfma_f32_16x16x32_bf16 v[56:59],a[12:15],a[168:171],v[56:59]
buffer_load_dwordx4 v4,s[8:11],s30 offen offset:1024 sc1 lds
v_mfma_f32_16x16x32_bf16 v[60:63],a[8:11],a[156:159],v[60:63]
ds_read_b64_tr_b16 a[6:7],v14 offset:16256
v_mfma_f32_16x16x32_bf16 v[60:63],a[12:15],a[172:175],v[60:63]
s_cmp_eq_u32 s39,1
s_cbranch_scc1 Lco137
Lcb138:
v_mfma_f32_16x16x32_bf16 v[64:67],a[16:19],a[144:147],v[64:67]
ds_read_b64_tr_b16 a[8:9],v14 offset:32
v_mfma_f32_16x16x32_bf16 v[64:67],a[20:23],a[160:163],v[64:67]
v_mfma_f32_16x16x32_bf16 v[68:71],a[16:19],a[148:151],v[68:71]
ds_read_b64_tr_b16 a[10:11],v14 offset:928
v_mfma_f32_16x16x32_bf16 v[68:71],a[20:23],a[164:167],v[68:71]
buffer_load_dwordx4 v5,s[8:11],s30 offen offset:2048 sc1 lds
v_mfma_f32_16x16x32_bf16 v[72:75],a[16:19],a[152:155],v[72:75]
ds_read_b64_tr_b16 a[12:13],v14 offset:15392
v_mfma_f32_16x16x32_bf16 v[72:75],a[20:23],a[168:171],v[72:75]
v_mfma_f32_16x16x32_bf16 v[76:79],a[16:19],a[156:159],v[76:79]
ds_read_b64_tr_b16 a[14:15],v14 offset:16288
v_mfma_f32_16x16x32_bf16 v[76:79],a[20:23],a[172:175],v[76:79]
s_cmp_eq_u32 s39,2
s_cbranch_scc1 Lco139
Lcb140:
v_mfma_f32_16x16x32_bf16 v[80:83],a[24:27],a[144:147],v[80:83]
ds_read_b64_tr_b16 a[16:17],v14 offset:64
v_mfma_f32_16x16x32_bf16 v[80:83],a[28:31],a[160:163],v[80:83]
buffer_load_dwordx4 v5,s[8:11],s30 offen offset:3072 sc1 lds
s_add_u32 m0,s34,s52
v_mfma_f32_16x16x32_bf16 v[84:87],a[24:27],a[148:151],v[84:87]
ds_read_b64_tr_b16 a[18:19],v14 offset:960
v_mfma_f32_16x16x32_bf16 v[84:87],a[28:31],a[164:167],v[84:87]
v_mfma_f32_16x16x32_bf16 v[88:91],a[24:27],a[152:155],v[88:91]
ds_read_b64_tr_b16 a[20:21],v14 offset:15424
v_mfma_f32_16x16x32_bf16 v[88:91],a[28:31],a[168:171],v[88:91]
v_mfma_f32_16x16x32_bf16 v[92:95],a[24:27],a[156:159],v[92:95]
ds_read_b64_tr_b16 a[22:23],v14 offset:16320
v_mfma_f32_16x16x32_bf16 v[92:95],a[28:31],a[172:175],v[92:95]
buffer_load_dwordx4 v4,s[8:11],s31 offen sc1 lds
s_cmp_eq_u32 s39,3
s_cbranch_scc1 Lco141
Lcb142:
v_mfma_f32_16x16x32_bf16 v[96:99],a[32:35],a[144:147],v[96:99]
ds_read_b64_tr_b16 a[24:25],v14 offset:96
v_mfma_f32_16x16x32_bf16 v[96:99],a[36:39],a[160:163],v[96:99]
v_mfma_f32_16x16x32_bf16 v[100:103],a[32:35],a[148:151],v[100:103]
ds_read_b64_tr_b16 a[26:27],v14 offset:992
v_mfma_f32_16x16x32_bf16 v[100:103],a[36:39],a[164:167],v[100:103]
v_mfma_f32_16x16x32_bf16 v[104:107],a[32:35],a[152:155],v[104:107]
ds_read_b64_tr_b16 a[28:29],v14 offset:15456
v_mfma_f32_16x16x32_bf16 v[104:107],a[36:39],a[168:171],v[104:107]
buffer_load_dwordx4 v4,s[8:11],s31 offen offset:1024 sc1 lds
v_mfma_f32_16x16x32_bf16 v[108:111],a[32:35],a[156:159],v[108:111]
ds_read_b64_tr_b16 a[30:31],v14 offset:16352
v_mfma_f32_16x16x32_bf16 v[108:111],a[36:39],a[172:175],v[108:111]
s_cmp_eq_u32 s39,0
s_cbranch_scc1 Lco143
Lcb144:
v_mfma_f32_16x16x32_bf16 v[112:115],a[40:43],a[144:147],v[112:115]
ds_read_b64_tr_b16 a[32:33],v14 offset:128
v_mfma_f32_16x16x32_bf16 v[112:115],a[44:47],a[160:163],v[112:115]
v_mfma_f32_16x16x32_bf16 v[116:119],a[40:43],a[148:151],v[116:119]
ds_read_b64_tr_b16 a[34:35],v14 offset:1024
v_mfma_f32_16x16x32_bf16 v[116:119],a[44:47],a[164:167],v[116:119]
buffer_load_dwordx4 v5,s[8:11],s31 offen offset:2048 sc1 lds
v_mfma_f32_16x16x32_bf16 v[120:123],a[40:43],a[152:155],v[120:123]
ds_read_b64_tr_b16 a[36:37],v14 offset:15488
v_mfma_f32_16x16x32_bf16 v[120:123],a[44:47],a[168:171],v[120:123]
v_mfma_f32_16x16x32_bf16 v[124:127],a[40:43],a[156:159],v[124:127]
ds_read_b64_tr_b16 a[38:39],v14 offset:16384
v_mfma_f32_16x16x32_bf16 v[124:127],a[44:47],a[172:175],v[124:127]
s_cmp_eq_u32 s39,1
s_cbranch_scc1 Lco145
Lcb146:
v_mfma_f32_16x16x32_bf16 v[128:131],a[48:51],a[144:147],v[128:131]
ds_read_b64_tr_b16 a[40:41],v14 offset:160
v_mfma_f32_16x16x32_bf16 v[128:131],a[52:55],a[160:163],v[128:131]
buffer_load_dwordx4 v5,s[8:11],s31 offen offset:3072 sc1 lds
s_add_u32 s30,s30,2048
v_mfma_f32_16x16x32_bf16 v[132:135],a[48:51],a[148:151],v[132:135]
ds_read_b64_tr_b16 a[42:43],v14 offset:1056
s_and_b32 s30,s30,0x7fff
v_mfma_f32_16x16x32_bf16 v[132:135],a[52:55],a[164:167],v[132:135]
s_add_u32 s34,s34,32768
s_cmp_eq_u32 s34,65536
s_cselect_b32 s34,0,s34
v_mfma_f32_16x16x32_bf16 v[136:139],a[48:51],a[152:155],v[136:139]
ds_read_b64_tr_b16 a[44:45],v14 offset:15520
s_add_u32 s31,s30,65536
v_mfma_f32_16x16x32_bf16 v[136:139],a[52:55],a[168:171],v[136:139]
s_add_u32 m0,s35,s41
v_mfma_f32_16x16x32_bf16 v[140:143],a[48:51],a[156:159],v[140:143]
ds_read_b64_tr_b16 a[46:47],v14 offset:16416
v_mfma_f32_16x16x32_bf16 v[140:143],a[52:55],a[172:175],v[140:143]
buffer_load_dwordx4 v8,s[12:15],s32 offen lds
s_cmp_eq_u32 s39,2
s_cbranch_scc1 Lco147
Lcb148:
v_mfma_f32_16x16x32_bf16 v[144:147],a[56:59],a[144:147],v[144:147]
ds_read_b64_tr_b16 a[48:49],v14 offset:192
v_mfma_f32_16x16x32_bf16 v[144:147],a[60:63],a[160:163],v[144:147]
v_mfma_f32_16x16x32_bf16 v[148:151],a[56:59],a[148:151],v[148:151]
ds_read_b64_tr_b16 a[50:51],v14 offset:1088
v_mfma_f32_16x16x32_bf16 v[148:151],a[60:63],a[164:167],v[148:151]
v_mfma_f32_16x16x32_bf16 v[152:155],a[56:59],a[152:155],v[152:155]
ds_read_b64_tr_b16 a[52:53],v14 offset:15552
v_mfma_f32_16x16x32_bf16 v[152:155],a[60:63],a[168:171],v[152:155]
buffer_load_dwordx4 v9,s[12:15],s32 offen offset:896 lds
v_mfma_f32_16x16x32_bf16 v[156:159],a[56:59],a[156:159],v[156:159]
ds_read_b64_tr_b16 a[54:55],v14 offset:16448
v_mfma_f32_16x16x32_bf16 v[156:159],a[60:63],a[172:175],v[156:159]
s_cmp_eq_u32 s39,3
s_cbranch_scc1 Lco149
Lcb150:
v_mfma_f32_16x16x32_bf16 v[160:163],a[64:67],a[144:147],v[160:163]
ds_read_b64_tr_b16 a[56:57],v14 offset:7680
v_mfma_f32_16x16x32_bf16 v[160:163],a[68:71],a[160:163],v[160:163]
v_mfma_f32_16x16x32_bf16 v[164:167],a[64:67],a[148:151],v[164:167]
ds_read_b64_tr_b16 a[58:59],v14 offset:8576
v_mfma_f32_16x16x32_bf16 v[164:167],a[68:71],a[164:167],v[164:167]
buffer_load_dwordx4 v10,s[12:15],s32 offen offset:1920 lds
v_mfma_f32_16x16x32_bf16 v[168:171],a[64:67],a[152:155],v[168:171]
ds_read_b64_tr_b16 a[60:61],v14 offset:23040
v_mfma_f32_16x16x32_bf16 v[168:171],a[68:71],a[168:171],v[168:171]
v_mfma_f32_16x16x32_bf16 v[172:175],a[64:67],a[156:159],v[172:175]
ds_read_b64_tr_b16 a[62:63],v14 offset:23936
v_mfma_f32_16x16x32_bf16 v[172:175],a[68:71],a[172:175],v[172:175]
s_cmp_eq_u32 s39,0
s_cbranch_scc1 Lco151
Lcb152:
v_mfma_f32_16x16x32_bf16 v[176:179],a[72:75],a[144:147],v[176:179]
ds_read_b64_tr_b16 a[64:65],v14 offset:7712
v_mfma_f32_16x16x32_bf16 v[176:179],a[76:79],a[160:163],v[176:179]
buffer_load_dwordx4 v11,s[12:15],s32 offen offset:2816 lds
s_add_u32 s35,s35,15360
v_mfma_f32_16x16x32_bf16 v[180:183],a[72:75],a[148:151],v[180:183]
ds_read_b64_tr_b16 a[66:67],v14 offset:8608
v_mfma_f32_16x16x32_bf16 v[180:183],a[76:79],a[164:167],v[180:183]
s_cmp_eq_u32 s35,92160
s_cselect_b32 s35,0,s35
s_add_u32 s32,s32,229376
v_mfma_f32_16x16x32_bf16 v[184:187],a[72:75],a[152:155],v[184:187]
ds_read_b64_tr_b16 a[68:69],v14 offset:23072
s_waitcnt vmcnt(21)
v_mfma_f32_16x16x32_bf16 v[184:187],a[76:79],a[168:171],v[184:187]
s_cmp_eq_u32 s32,7340032
s_cselect_b32 s32,0,s32
s_add_u32 m0,s35,s41
ds_read_b128 a[112:115],v12 offset:0
v_mfma_f32_16x16x32_bf16 v[188:191],a[72:75],a[156:159],v[188:191]
ds_read_b64_tr_b16 a[70:71],v14 offset:23968
v_mfma_f32_16x16x32_bf16 v[188:191],a[76:79],a[172:175],v[188:191]
buffer_load_dwordx4 v8,s[12:15],s32 offen lds
s_cmp_eq_u32 s39,1
s_cbranch_scc1 Lco153
Lcb154:
v_mfma_f32_16x16x32_bf16 v[192:195],a[80:83],a[144:147],v[192:195]
ds_read_b64_tr_b16 a[72:73],v14 offset:7744
v_mfma_f32_16x16x32_bf16 v[192:195],a[84:87],a[160:163],v[192:195]
ds_read_b128 a[128:131],v12 offset:1024
v_mfma_f32_16x16x32_bf16 v[196:199],a[80:83],a[148:151],v[196:199]
ds_read_b64_tr_b16 a[74:75],v14 offset:8640
v_mfma_f32_16x16x32_bf16 v[196:199],a[84:87],a[164:167],v[196:199]
v_mfma_f32_16x16x32_bf16 v[200:203],a[80:83],a[152:155],v[200:203]
ds_read_b64_tr_b16 a[76:77],v14 offset:23104
v_mfma_f32_16x16x32_bf16 v[200:203],a[84:87],a[168:171],v[200:203]
ds_read_b128 a[116:119],v12 offset:2048
v_mfma_f32_16x16x32_bf16 v[204:207],a[80:83],a[156:159],v[204:207]
ds_read_b64_tr_b16 a[78:79],v14 offset:24000
v_mfma_f32_16x16x32_bf16 v[204:207],a[84:87],a[172:175],v[204:207]
buffer_load_dwordx4 v9,s[12:15],s32 offen offset:896 lds
s_cmp_eq_u32 s39,2
s_cbranch_scc1 Lco155
Lcb156:
v_mfma_f32_16x16x32_bf16 v[208:211],a[88:91],a[144:147],v[208:211]
ds_read_b64_tr_b16 a[80:81],v14 offset:7776
v_mfma_f32_16x16x32_bf16 v[208:211],a[92:95],a[160:163],v[208:211]
ds_read_b128 a[132:135],v12 offset:3072
v_mfma_f32_16x16x32_bf16 v[212:215],a[88:91],a[148:151],v[212:215]
ds_read_b64_tr_b16 a[82:83],v14 offset:8672
v_mfma_f32_16x16x32_bf16 v[212:215],a[92:95],a[164:167],v[212:215]
buffer_load_dwordx4 v10,s[12:15],s32 offen offset:1920 lds
v_mfma_f32_16x16x32_bf16 v[216:219],a[88:91],a[152:155],v[216:219]
ds_read_b64_tr_b16 a[84:85],v14 offset:23136
v_mfma_f32_16x16x32_bf16 v[216:219],a[92:95],a[168:171],v[216:219]
ds_read_b128 a[120:123],v12 offset:4096
v_mfma_f32_16x16x32_bf16 v[220:223],a[88:91],a[156:159],v[220:223]
ds_read_b64_tr_b16 a[86:87],v14 offset:24032
v_mfma_f32_16x16x32_bf16 v[220:223],a[92:95],a[172:175],v[220:223]
s_cmp_eq_u32 s39,3
s_cbranch_scc1 Lco157
Lcb158:
v_mfma_f32_16x16x32_bf16 v[224:227],a[96:99],a[144:147],v[224:227]
ds_read_b64_tr_b16 a[88:89],v14 offset:7808
v_mfma_f32_16x16x32_bf16 v[224:227],a[100:103],a[160:163],v[224:227]
ds_read_b128 a[136:139],v12 offset:5120
v_mfma_f32_16x16x32_bf16 v[228:231],a[96:99],a[148:151],v[228:231]
ds_read_b64_tr_b16 a[90:91],v14 offset:8704
v_mfma_f32_16x16x32_bf16 v[228:231],a[100:103],a[164:167],v[228:231]
buffer_load_dwordx4 v11,s[12:15],s32 offen offset:2816 lds
s_add_u32 s35,s35,15360
v_mfma_f32_16x16x32_bf16 v[232:235],a[96:99],a[152:155],v[232:235]
ds_read_b64_tr_b16 a[92:93],v14 offset:23168
v_mfma_f32_16x16x32_bf16 v[232:235],a[100:103],a[168:171],v[232:235]
s_cmp_eq_u32 s35,92160
s_cselect_b32 s35,0,s35
s_add_u32 s32,s32,229376
ds_read_b128 a[124:127],v12 offset:6144
v_mfma_f32_16x16x32_bf16 v[236:239],a[96:99],a[156:159],v[236:239]
ds_read_b64_tr_b16 a[94:95],v14 offset:24064
v_mfma_f32_16x16x32_bf16 v[236:239],a[100:103],a[172:175],v[236:239]
s_cmp_eq_u32 s32,7340032
s_cselect_b32 s32,0,s32
s_cmp_eq_u32 s39,0
s_cbranch_scc1 Lco159
Lcb160:
v_mfma_f32_16x16x32_bf16 v[240:243],a[104:107],a[144:147],v[240:243]
ds_read_b64_tr_b16 a[96:97],v14 offset:7840
v_mfma_f32_16x16x32_bf16 v[240:243],a[108:111],a[160:163],v[240:243]
ds_read_b128 a[140:143],v12 offset:7168
v_mfma_f32_16x16x32_bf16 v[244:247],a[104:107],a[148:151],v[244:247]
ds_read_b64_tr_b16 a[98:99],v14 offset:8736
v_mfma_f32_16x16x32_bf16 v[244:247],a[108:111],a[164:167],v[244:247]
buffer_load_dword a252,v26,s[4:7],s33 offen
s_add_u32 s33,s33,512
v_mfma_f32_16x16x32_bf16 v[248:251],a[104:107],a[152:155],v[248:251]
ds_read_b64_tr_b16 a[100:101],v14 offset:23200
v_mfma_f32_16x16x32_bf16 v[248:251],a[108:111],a[168:171],v[248:251]
v_mfma_f32_16x16x32_bf16 v[252:255],a[104:107],a[156:159],v[252:255]
ds_read_b64_tr_b16 a[102:103],v14 offset:24096
v_mfma_f32_16x16x32_bf16 v[252:255],a[108:111],a[172:175],v[252:255]
s_cmp_eq_u32 s39,1
s_cbranch_scc1 Lco161
Lcb162:
s_waitcnt lgkmcnt(4)
v_mfma_f32_16x16x32_bf16 v[32:35],a[0:3],a[112:115],v[32:35]
ds_read_b64_tr_b16 a[104:105],v14 offset:7872
v_mfma_f32_16x16x32_bf16 v[32:35],a[4:7],a[128:131],v[32:35]
ds_read_b64_tr_b16 a[106:107],v14 offset:8768
v_mfma_f32_16x16x32_bf16 v[36:39],a[0:3],a[116:119],v[36:39]
ds_read_b64_tr_b16 a[108:109],v14 offset:23232
v_mfma_f32_16x16x32_bf16 v[36:39],a[4:7],a[132:135],v[36:39]
ds_read_b64_tr_b16 a[110:111],v14 offset:24128
v_mfma_f32_16x16x32_bf16 v[40:43],a[0:3],a[120:123],v[40:43]
v_add_u32 v14,s43,v14
v_mfma_f32_16x16x32_bf16 v[40:43],a[4:7],a[136:139],v[40:43]
v_xor_b32 v12,32768,v12
v_mfma_f32_16x16x32_bf16 v[44:47],a[0:3],a[124:127],v[44:47]
v_mfma_f32_16x16x32_bf16 v[44:47],a[4:7],a[140:143],v[44:47]
s_waitcnt vmcnt(18) lgkmcnt(0)
s_barrier
v_accvgpr_read_b32 v16,a176
v_accvgpr_read_b32 v17,a180
v_accvgpr_read_b32 v18,a184
v_accvgpr_read_b32 v19,a188
v_cvt_pk_bf16_f32 v20,v16,v16
v_cvt_pk_bf16_f32 v21,v17,v17
v_cvt_pk_bf16_f32 v22,v18,v18
v_cvt_pk_bf16_f32 v23,v19,v19
v_and_b32 v20,0xffff0000,v20
v_and_b32 v21,0xffff0000,v21
v_and_b32 v22,0xffff0000,v22
v_and_b32 v23,0xffff0000,v23
v_sub_f32 v20,v16,v20
v_sub_f32 v21,v17,v21
v_sub_f32 v22,v18,v22
v_sub_f32 v23,v19,v23
v_cvt_pk_bf16_f32 v20,v16,v20
v_cvt_pk_bf16_f32 v21,v17,v21
v_cvt_pk_bf16_f32 v22,v18,v22
v_cvt_pk_bf16_f32 v23,v19,v23
s_mov_b64 exec,0xffff
s_cmp_lg_u32 s20,0
s_cbranch_scc1 Lcw164
buffer_store_dword v20,v27,s[24:27],s54 offen sc1
buffer_store_dword v21,v27,s[24:27],s54 offen offset:1024 sc1
buffer_store_dword v22,v27,s[24:27],s55 offen offset:256 sc1
buffer_store_dword v23,v27,s[24:27],s55 offen offset:1280 sc1
s_branch Lcwe167
Lcw164:
s_cmp_lg_u32 s20,1
s_cbranch_scc1 Lcw165
buffer_store_dword v20,v27,s[24:27],s54 offen offset:256 sc1
buffer_store_dword v21,v27,s[24:27],s54 offen offset:1280 sc1
buffer_store_dword v22,v27,s[24:27],s55 offen offset:512 sc1
buffer_store_dword v23,v27,s[24:27],s55 offen offset:1536 sc1
s_branch Lcwe167
Lcw165:
s_cmp_lg_u32 s20,2
s_cbranch_scc1 Lcw166
buffer_store_dword v20,v27,s[24:27],s54 offen offset:512 sc1
buffer_store_dword v21,v27,s[24:27],s54 offen offset:1536 sc1
buffer_store_dword v22,v27,s[24:27],s55 offen offset:768 sc1
buffer_store_dword v22,v27,s[24:27],s55 offen offset:768 sc1
s_branch Lcwe167
Lcw166:
buffer_store_dword v20,v27,s[24:27],s54 offen offset:768 sc1
buffer_store_dword v21,v27,s[24:27],s55 offen sc1
buffer_store_dword v22,v27,s[24:27],s55 offen offset:1024 sc1
buffer_store_dword v22,v27,s[24:27],s55 offen offset:1024 sc1
Lcwe167:
s_mov_b64 exec,-1
v_mfma_f32_16x16x32_bf16 v[48:51],a[8:11],a[112:115],v[48:51]
ds_read_b64_tr_b16 a[0:1],v14 offset:0
s_add_u32 m0,s34,s40
v_mfma_f32_16x16x32_bf16 v[48:51],a[12:15],a[128:131],v[48:51]
buffer_load_dwordx4 v4,s[8:11],s30 offen sc1 lds
s_add_u32 s37,s37,30720
v_mfma_f32_16x16x32_bf16 v[52:55],a[8:11],a[116:119],v[52:55]
ds_read_b64_tr_b16 a[2:3],v14 offset:896
v_mfma_f32_16x16x32_bf16 v[52:55],a[12:15],a[132:135],v[52:55]
s_cmp_eq_u32 s37,92160
s_cselect_b32 s43,s49,s48
s_cselect_b32 s37,0,s37
v_mfma_f32_16x16x32_bf16 v[56:59],a[8:11],a[120:123],v[56:59]
ds_read_b64_tr_b16 a[4:5],v14 offset:15360
v_mfma_f32_16x16x32_bf16 v[56:59],a[12:15],a[136:139],v[56:59]
buffer_load_dwordx4 v4,s[8:11],s30 offen offset:1024 sc1 lds
v_mfma_f32_16x16x32_bf16 v[60:63],a[8:11],a[124:127],v[60:63]
ds_read_b64_tr_b16 a[6:7],v14 offset:16256
v_mfma_f32_16x16x32_bf16 v[60:63],a[12:15],a[140:143],v[60:63]
v_mfma_f32_16x16x32_bf16 v[64:67],a[16:19],a[112:115],v[64:67]
ds_read_b64_tr_b16 a[8:9],v14 offset:32
v_mfma_f32_16x16x32_bf16 v[64:67],a[20:23],a[128:131],v[64:67]
v_mfma_f32_16x16x32_bf16 v[68:71],a[16:19],a[116:119],v[68:71]
ds_read_b64_tr_b16 a[10:11],v14 offset:928
v_mfma_f32_16x16x32_bf16 v[68:71],a[20:23],a[132:135],v[68:71]
buffer_load_dwordx4 v5,s[8:11],s30 offen offset:2048 sc1 lds
v_mfma_f32_16x16x32_bf16 v[72:75],a[16:19],a[120:123],v[72:75]
ds_read_b64_tr_b16 a[12:13],v14 offset:15392
v_mfma_f32_16x16x32_bf16 v[72:75],a[20:23],a[136:139],v[72:75]
v_mfma_f32_16x16x32_bf16 v[76:79],a[16:19],a[124:127],v[76:79]
ds_read_b64_tr_b16 a[14:15],v14 offset:16288
v_mfma_f32_16x16x32_bf16 v[76:79],a[20:23],a[140:143],v[76:79]
v_mfma_f32_16x16x32_bf16 v[80:83],a[24:27],a[112:115],v[80:83]
ds_read_b64_tr_b16 a[16:17],v14 offset:64
v_mfma_f32_16x16x32_bf16 v[80:83],a[28:31],a[128:131],v[80:83]
buffer_load_dwordx4 v5,s[8:11],s30 offen offset:3072 sc1 lds
s_add_u32 m0,s34,s52
v_mfma_f32_16x16x32_bf16 v[84:87],a[24:27],a[116:119],v[84:87]
ds_read_b64_tr_b16 a[18:19],v14 offset:960
v_mfma_f32_16x16x32_bf16 v[84:87],a[28:31],a[132:135],v[84:87]
v_mfma_f32_16x16x32_bf16 v[88:91],a[24:27],a[120:123],v[88:91]
ds_read_b64_tr_b16 a[20:21],v14 offset:15424
v_mfma_f32_16x16x32_bf16 v[88:91],a[28:31],a[136:139],v[88:91]
v_mfma_f32_16x16x32_bf16 v[92:95],a[24:27],a[124:127],v[92:95]
ds_read_b64_tr_b16 a[22:23],v14 offset:16320
v_mfma_f32_16x16x32_bf16 v[92:95],a[28:31],a[140:143],v[92:95]
buffer_load_dwordx4 v4,s[8:11],s31 offen sc1 lds
v_mfma_f32_16x16x32_bf16 v[96:99],a[32:35],a[112:115],v[96:99]
ds_read_b64_tr_b16 a[24:25],v14 offset:96
v_mfma_f32_16x16x32_bf16 v[96:99],a[36:39],a[128:131],v[96:99]
v_mfma_f32_16x16x32_bf16 v[100:103],a[32:35],a[116:119],v[100:103]
ds_read_b64_tr_b16 a[26:27],v14 offset:992
v_mfma_f32_16x16x32_bf16 v[100:103],a[36:39],a[132:135],v[100:103]
v_mfma_f32_16x16x32_bf16 v[104:107],a[32:35],a[120:123],v[104:107]
ds_read_b64_tr_b16 a[28:29],v14 offset:15456
v_mfma_f32_16x16x32_bf16 v[104:107],a[36:39],a[136:139],v[104:107]
buffer_load_dwordx4 v4,s[8:11],s31 offen offset:1024 sc1 lds
v_mfma_f32_16x16x32_bf16 v[108:111],a[32:35],a[124:127],v[108:111]
ds_read_b64_tr_b16 a[30:31],v14 offset:16352
v_mfma_f32_16x16x32_bf16 v[108:111],a[36:39],a[140:143],v[108:111]
v_mfma_f32_16x16x32_bf16 v[112:115],a[40:43],a[112:115],v[112:115]
ds_read_b64_tr_b16 a[32:33],v14 offset:128
v_mfma_f32_16x16x32_bf16 v[112:115],a[44:47],a[128:131],v[112:115]
v_mfma_f32_16x16x32_bf16 v[116:119],a[40:43],a[116:119],v[116:119]
ds_read_b64_tr_b16 a[34:35],v14 offset:1024
v_mfma_f32_16x16x32_bf16 v[116:119],a[44:47],a[132:135],v[116:119]
buffer_load_dwordx4 v5,s[8:11],s31 offen offset:2048 sc1 lds
v_mfma_f32_16x16x32_bf16 v[120:123],a[40:43],a[120:123],v[120:123]
ds_read_b64_tr_b16 a[36:37],v14 offset:15488
v_mfma_f32_16x16x32_bf16 v[120:123],a[44:47],a[136:139],v[120:123]
v_mfma_f32_16x16x32_bf16 v[124:127],a[40:43],a[124:127],v[124:127]
ds_read_b64_tr_b16 a[38:39],v14 offset:16384
v_mfma_f32_16x16x32_bf16 v[124:127],a[44:47],a[140:143],v[124:127]
v_mfma_f32_16x16x32_bf16 v[128:131],a[48:51],a[112:115],v[128:131]
ds_read_b64_tr_b16 a[40:41],v14 offset:160
v_mfma_f32_16x16x32_bf16 v[128:131],a[52:55],a[128:131],v[128:131]
buffer_load_dwordx4 v5,s[8:11],s31 offen offset:3072 sc1 lds
s_add_u32 s30,s30,2048
v_mfma_f32_16x16x32_bf16 v[132:135],a[48:51],a[116:119],v[132:135]
ds_read_b64_tr_b16 a[42:43],v14 offset:1056
s_and_b32 s30,s30,0x7fff
v_mfma_f32_16x16x32_bf16 v[132:135],a[52:55],a[132:135],v[132:135]
s_add_u32 s34,s34,32768
s_cmp_eq_u32 s34,65536
s_cselect_b32 s34,0,s34
v_mfma_f32_16x16x32_bf16 v[136:139],a[48:51],a[120:123],v[136:139]
ds_read_b64_tr_b16 a[44:45],v14 offset:15520
s_add_u32 s31,s30,65536
v_mfma_f32_16x16x32_bf16 v[136:139],a[52:55],a[136:139],v[136:139]
s_add_u32 m0,s35,s41
v_mfma_f32_16x16x32_bf16 v[140:143],a[48:51],a[124:127],v[140:143]
ds_read_b64_tr_b16 a[46:47],v14 offset:16416
v_mfma_f32_16x16x32_bf16 v[140:143],a[52:55],a[140:143],v[140:143]
buffer_load_dwordx4 v8,s[12:15],s32 offen lds
v_mfma_f32_16x16x32_bf16 v[144:147],a[56:59],a[112:115],v[144:147]
ds_read_b64_tr_b16 a[48:49],v14 offset:192
v_mfma_f32_16x16x32_bf16 v[144:147],a[60:63],a[128:131],v[144:147]
v_mfma_f32_16x16x32_bf16 v[148:151],a[56:59],a[116:119],v[148:151]
ds_read_b64_tr_b16 a[50:51],v14 offset:1088
v_mfma_f32_16x16x32_bf16 v[148:151],a[60:63],a[132:135],v[148:151]
v_mfma_f32_16x16x32_bf16 v[152:155],a[56:59],a[120:123],v[152:155]
ds_read_b64_tr_b16 a[52:53],v14 offset:15552
v_mfma_f32_16x16x32_bf16 v[152:155],a[60:63],a[136:139],v[152:155]
buffer_load_dwordx4 v9,s[12:15],s32 offen offset:896 lds
v_mfma_f32_16x16x32_bf16 v[156:159],a[56:59],a[124:127],v[156:159]
ds_read_b64_tr_b16 a[54:55],v14 offset:16448
v_mfma_f32_16x16x32_bf16 v[156:159],a[60:63],a[140:143],v[156:159]
v_mfma_f32_16x16x32_bf16 v[160:163],a[64:67],a[112:115],v[160:163]
ds_read_b64_tr_b16 a[56:57],v14 offset:7680
v_mfma_f32_16x16x32_bf16 v[160:163],a[68:71],a[128:131],v[160:163]
v_mfma_f32_16x16x32_bf16 v[164:167],a[64:67],a[116:119],v[164:167]
ds_read_b64_tr_b16 a[58:59],v14 offset:8576
v_mfma_f32_16x16x32_bf16 v[164:167],a[68:71],a[132:135],v[164:167]
buffer_load_dwordx4 v10,s[12:15],s32 offen offset:1920 lds
v_mfma_f32_16x16x32_bf16 v[168:171],a[64:67],a[120:123],v[168:171]
ds_read_b64_tr_b16 a[60:61],v14 offset:23040
v_mfma_f32_16x16x32_bf16 v[168:171],a[68:71],a[136:139],v[168:171]
v_mfma_f32_16x16x32_bf16 v[172:175],a[64:67],a[124:127],v[172:175]
ds_read_b64_tr_b16 a[62:63],v14 offset:23936
v_mfma_f32_16x16x32_bf16 v[172:175],a[68:71],a[140:143],v[172:175]
v_mfma_f32_16x16x32_bf16 v[176:179],a[72:75],a[112:115],v[176:179]
ds_read_b64_tr_b16 a[64:65],v14 offset:7712
v_mfma_f32_16x16x32_bf16 v[176:179],a[76:79],a[128:131],v[176:179]
buffer_load_dwordx4 v11,s[12:15],s32 offen offset:2816 lds
s_add_u32 s35,s35,15360
v_mfma_f32_16x16x32_bf16 v[180:183],a[72:75],a[116:119],v[180:183]
ds_read_b64_tr_b16 a[66:67],v14 offset:8608
v_mfma_f32_16x16x32_bf16 v[180:183],a[76:79],a[132:135],v[180:183]
s_cmp_eq_u32 s35,92160
s_cselect_b32 s35,0,s35
s_add_u32 s32,s32,229376
v_mfma_f32_16x16x32_bf16 v[184:187],a[72:75],a[120:123],v[184:187]
ds_read_b64_tr_b16 a[68:69],v14 offset:23072
s_waitcnt vmcnt(25)
v_mfma_f32_16x16x32_bf16 v[184:187],a[76:79],a[136:139],v[184:187]
s_cmp_eq_u32 s32,7340032
s_cselect_b32 s32,0,s32
s_add_u32 m0,s35,s41
ds_read_b128 a[144:147],v12 offset:0
v_mfma_f32_16x16x32_bf16 v[188:191],a[72:75],a[124:127],v[188:191]
ds_read_b64_tr_b16 a[70:71],v14 offset:23968
v_mfma_f32_16x16x32_bf16 v[188:191],a[76:79],a[140:143],v[188:191]
buffer_load_dwordx4 v8,s[12:15],s32 offen lds
v_mfma_f32_16x16x32_bf16 v[192:195],a[80:83],a[112:115],v[192:195]
ds_read_b64_tr_b16 a[72:73],v14 offset:7744
v_mfma_f32_16x16x32_bf16 v[192:195],a[84:87],a[128:131],v[192:195]
ds_read_b128 a[160:163],v12 offset:1024
v_mfma_f32_16x16x32_bf16 v[196:199],a[80:83],a[116:119],v[196:199]
ds_read_b64_tr_b16 a[74:75],v14 offset:8640
v_mfma_f32_16x16x32_bf16 v[196:199],a[84:87],a[132:135],v[196:199]
v_mfma_f32_16x16x32_bf16 v[200:203],a[80:83],a[120:123],v[200:203]
ds_read_b64_tr_b16 a[76:77],v14 offset:23104
v_mfma_f32_16x16x32_bf16 v[200:203],a[84:87],a[136:139],v[200:203]
ds_read_b128 a[148:151],v12 offset:2048
v_mfma_f32_16x16x32_bf16 v[204:207],a[80:83],a[124:127],v[204:207]
ds_read_b64_tr_b16 a[78:79],v14 offset:24000
v_mfma_f32_16x16x32_bf16 v[204:207],a[84:87],a[140:143],v[204:207]
buffer_load_dwordx4 v9,s[12:15],s32 offen offset:896 lds
v_mfma_f32_16x16x32_bf16 v[208:211],a[88:91],a[112:115],v[208:211]
ds_read_b64_tr_b16 a[80:81],v14 offset:7776
v_mfma_f32_16x16x32_bf16 v[208:211],a[92:95],a[128:131],v[208:211]
ds_read_b128 a[164:167],v12 offset:3072
v_mfma_f32_16x16x32_bf16 v[212:215],a[88:91],a[116:119],v[212:215]
ds_read_b64_tr_b16 a[82:83],v14 offset:8672
v_mfma_f32_16x16x32_bf16 v[212:215],a[92:95],a[132:135],v[212:215]
buffer_load_dwordx4 v10,s[12:15],s32 offen offset:1920 lds
v_mfma_f32_16x16x32_bf16 v[216:219],a[88:91],a[120:123],v[216:219]
ds_read_b64_tr_b16 a[84:85],v14 offset:23136
v_mfma_f32_16x16x32_bf16 v[216:219],a[92:95],a[136:139],v[216:219]
ds_read_b128 a[152:155],v12 offset:4096
v_mfma_f32_16x16x32_bf16 v[220:223],a[88:91],a[124:127],v[220:223]
ds_read_b64_tr_b16 a[86:87],v14 offset:24032
v_mfma_f32_16x16x32_bf16 v[220:223],a[92:95],a[140:143],v[220:223]
v_mfma_f32_16x16x32_bf16 v[224:227],a[96:99],a[112:115],v[224:227]
ds_read_b64_tr_b16 a[88:89],v14 offset:7808
v_mfma_f32_16x16x32_bf16 v[224:227],a[100:103],a[128:131],v[224:227]
ds_read_b128 a[168:171],v12 offset:5120
v_mfma_f32_16x16x32_bf16 v[228:231],a[96:99],a[116:119],v[228:231]
ds_read_b64_tr_b16 a[90:91],v14 offset:8704
v_mfma_f32_16x16x32_bf16 v[228:231],a[100:103],a[132:135],v[228:231]
buffer_load_dwordx4 v11,s[12:15],s32 offen offset:2816 lds
s_add_u32 s35,s35,15360
v_mfma_f32_16x16x32_bf16 v[232:235],a[96:99],a[120:123],v[232:235]
ds_read_b64_tr_b16 a[92:93],v14 offset:23168
v_mfma_f32_16x16x32_bf16 v[232:235],a[100:103],a[136:139],v[232:235]
s_cmp_eq_u32 s35,92160
s_cselect_b32 s35,0,s35
s_add_u32 s32,s32,229376
ds_read_b128 a[156:159],v12 offset:6144
v_mfma_f32_16x16x32_bf16 v[236:239],a[96:99],a[124:127],v[236:239]
ds_read_b64_tr_b16 a[94:95],v14 offset:24064
v_mfma_f32_16x16x32_bf16 v[236:239],a[100:103],a[140:143],v[236:239]
s_cmp_eq_u32 s32,7340032
s_cselect_b32 s32,0,s32
v_mfma_f32_16x16x32_bf16 v[240:243],a[104:107],a[112:115],v[240:243]
ds_read_b64_tr_b16 a[96:97],v14 offset:7840
v_mfma_f32_16x16x32_bf16 v[240:243],a[108:111],a[128:131],v[240:243]
ds_read_b128 a[172:175],v12 offset:7168
v_mfma_f32_16x16x32_bf16 v[244:247],a[104:107],a[116:119],v[244:247]
ds_read_b64_tr_b16 a[98:99],v14 offset:8736
v_mfma_f32_16x16x32_bf16 v[244:247],a[108:111],a[132:135],v[244:247]
buffer_load_dword a252,v26,s[4:7],s33 offen
s_add_u32 s33,s33,512
v_mfma_f32_16x16x32_bf16 v[248:251],a[104:107],a[120:123],v[248:251]
ds_read_b64_tr_b16 a[100:101],v14 offset:23200
v_mfma_f32_16x16x32_bf16 v[248:251],a[108:111],a[136:139],v[248:251]
v_mfma_f32_16x16x32_bf16 v[252:255],a[104:107],a[124:127],v[252:255]
ds_read_b64_tr_b16 a[102:103],v14 offset:24096
v_mfma_f32_16x16x32_bf16 v[252:255],a[108:111],a[140:143],v[252:255]
s_waitcnt lgkmcnt(4)
v_mfma_f32_16x16x32_bf16 v[32:35],a[0:3],a[144:147],v[32:35]
ds_read_b64_tr_b16 a[104:105],v14 offset:7872
v_mfma_f32_16x16x32_bf16 v[32:35],a[4:7],a[160:163],v[32:35]
ds_read_b64_tr_b16 a[106:107],v14 offset:8768
v_mfma_f32_16x16x32_bf16 v[36:39],a[0:3],a[148:151],v[36:39]
ds_read_b64_tr_b16 a[108:109],v14 offset:23232
v_mfma_f32_16x16x32_bf16 v[36:39],a[4:7],a[164:167],v[36:39]
ds_read_b64_tr_b16 a[110:111],v14 offset:24128
v_mfma_f32_16x16x32_bf16 v[40:43],a[0:3],a[152:155],v[40:43]
v_add_u32 v14,s43,v14
v_mfma_f32_16x16x32_bf16 v[40:43],a[4:7],a[168:171],v[40:43]
v_xor_b32 v12,32768,v12
v_mfma_f32_16x16x32_bf16 v[44:47],a[0:3],a[156:159],v[44:47]
v_mfma_f32_16x16x32_bf16 v[44:47],a[4:7],a[172:175],v[44:47]
s_waitcnt vmcnt(17) lgkmcnt(0)
s_barrier
s_cmp_lg_u32 s20,0
s_cbranch_scc1 Lpub168
s_mov_b32 s18,s87
s_mov_b32 s19,s86
s_lshl_b32 s18,s18,8
s_lshl_b32 s19,s19,2
s_add_u32 s18,s18,s19
s_add_u32 s18,s18,95518720
v_mov_b32 v1,0
v_mov_b32 v3,s94
s_mov_b64 exec,1
buffer_store_dword v3,v1,s[24:27],s18 offen sc1
s_mov_b64 exec,-1
Lpub168:
v_mfma_f32_16x16x32_bf16 v[48:51],a[8:11],a[144:147],v[48:51]
ds_read_b64_tr_b16 a[0:1],v14 offset:0
s_add_u32 m0,s34,s40
v_mfma_f32_16x16x32_bf16 v[48:51],a[12:15],a[160:163],v[48:51]
buffer_load_dwordx4 v4,s[8:11],s30 offen sc1 lds
s_add_u32 s37,s37,30720
v_mfma_f32_16x16x32_bf16 v[52:55],a[8:11],a[148:151],v[52:55]
ds_read_b64_tr_b16 a[2:3],v14 offset:896
v_mfma_f32_16x16x32_bf16 v[52:55],a[12:15],a[164:167],v[52:55]
s_cmp_eq_u32 s37,92160
s_cselect_b32 s43,s49,s48
s_cselect_b32 s37,0,s37
v_mfma_f32_16x16x32_bf16 v[56:59],a[8:11],a[152:155],v[56:59]
ds_read_b64_tr_b16 a[4:5],v14 offset:15360
v_mfma_f32_16x16x32_bf16 v[56:59],a[12:15],a[168:171],v[56:59]
buffer_load_dwordx4 v4,s[8:11],s30 offen offset:1024 sc1 lds
v_mfma_f32_16x16x32_bf16 v[60:63],a[8:11],a[156:159],v[60:63]
ds_read_b64_tr_b16 a[6:7],v14 offset:16256
v_mfma_f32_16x16x32_bf16 v[60:63],a[12:15],a[172:175],v[60:63]
v_mfma_f32_16x16x32_bf16 v[64:67],a[16:19],a[144:147],v[64:67]
ds_read_b64_tr_b16 a[8:9],v14 offset:32
v_mfma_f32_16x16x32_bf16 v[64:67],a[20:23],a[160:163],v[64:67]
v_mfma_f32_16x16x32_bf16 v[68:71],a[16:19],a[148:151],v[68:71]
ds_read_b64_tr_b16 a[10:11],v14 offset:928
v_mfma_f32_16x16x32_bf16 v[68:71],a[20:23],a[164:167],v[68:71]
buffer_load_dwordx4 v5,s[8:11],s30 offen offset:2048 sc1 lds
v_mfma_f32_16x16x32_bf16 v[72:75],a[16:19],a[152:155],v[72:75]
ds_read_b64_tr_b16 a[12:13],v14 offset:15392
v_mfma_f32_16x16x32_bf16 v[72:75],a[20:23],a[168:171],v[72:75]
v_mfma_f32_16x16x32_bf16 v[76:79],a[16:19],a[156:159],v[76:79]
ds_read_b64_tr_b16 a[14:15],v14 offset:16288
v_mfma_f32_16x16x32_bf16 v[76:79],a[20:23],a[172:175],v[76:79]
v_mfma_f32_16x16x32_bf16 v[80:83],a[24:27],a[144:147],v[80:83]
ds_read_b64_tr_b16 a[16:17],v14 offset:64
v_mfma_f32_16x16x32_bf16 v[80:83],a[28:31],a[160:163],v[80:83]
buffer_load_dwordx4 v5,s[8:11],s30 offen offset:3072 sc1 lds
s_add_u32 m0,s34,s52
v_mfma_f32_16x16x32_bf16 v[84:87],a[24:27],a[148:151],v[84:87]
ds_read_b64_tr_b16 a[18:19],v14 offset:960
v_mfma_f32_16x16x32_bf16 v[84:87],a[28:31],a[164:167],v[84:87]
v_mfma_f32_16x16x32_bf16 v[88:91],a[24:27],a[152:155],v[88:91]
ds_read_b64_tr_b16 a[20:21],v14 offset:15424
v_mfma_f32_16x16x32_bf16 v[88:91],a[28:31],a[168:171],v[88:91]
v_mfma_f32_16x16x32_bf16 v[92:95],a[24:27],a[156:159],v[92:95]
ds_read_b64_tr_b16 a[22:23],v14 offset:16320
v_mfma_f32_16x16x32_bf16 v[92:95],a[28:31],a[172:175],v[92:95]
buffer_load_dwordx4 v4,s[8:11],s31 offen sc1 lds
v_mfma_f32_16x16x32_bf16 v[96:99],a[32:35],a[144:147],v[96:99]
ds_read_b64_tr_b16 a[24:25],v14 offset:96
v_mfma_f32_16x16x32_bf16 v[96:99],a[36:39],a[160:163],v[96:99]
v_mfma_f32_16x16x32_bf16 v[100:103],a[32:35],a[148:151],v[100:103]
ds_read_b64_tr_b16 a[26:27],v14 offset:992
v_mfma_f32_16x16x32_bf16 v[100:103],a[36:39],a[164:167],v[100:103]
v_mfma_f32_16x16x32_bf16 v[104:107],a[32:35],a[152:155],v[104:107]
ds_read_b64_tr_b16 a[28:29],v14 offset:15456
v_mfma_f32_16x16x32_bf16 v[104:107],a[36:39],a[168:171],v[104:107]
buffer_load_dwordx4 v4,s[8:11],s31 offen offset:1024 sc1 lds
v_mfma_f32_16x16x32_bf16 v[108:111],a[32:35],a[156:159],v[108:111]
ds_read_b64_tr_b16 a[30:31],v14 offset:16352
v_mfma_f32_16x16x32_bf16 v[108:111],a[36:39],a[172:175],v[108:111]
v_mfma_f32_16x16x32_bf16 v[112:115],a[40:43],a[144:147],v[112:115]
ds_read_b64_tr_b16 a[32:33],v14 offset:128
v_mfma_f32_16x16x32_bf16 v[112:115],a[44:47],a[160:163],v[112:115]
v_mfma_f32_16x16x32_bf16 v[116:119],a[40:43],a[148:151],v[116:119]
ds_read_b64_tr_b16 a[34:35],v14 offset:1024
v_mfma_f32_16x16x32_bf16 v[116:119],a[44:47],a[164:167],v[116:119]
buffer_load_dwordx4 v5,s[8:11],s31 offen offset:2048 sc1 lds
v_mfma_f32_16x16x32_bf16 v[120:123],a[40:43],a[152:155],v[120:123]
ds_read_b64_tr_b16 a[36:37],v14 offset:15488
v_mfma_f32_16x16x32_bf16 v[120:123],a[44:47],a[168:171],v[120:123]
v_mfma_f32_16x16x32_bf16 v[124:127],a[40:43],a[156:159],v[124:127]
ds_read_b64_tr_b16 a[38:39],v14 offset:16384
v_mfma_f32_16x16x32_bf16 v[124:127],a[44:47],a[172:175],v[124:127]
v_mfma_f32_16x16x32_bf16 v[128:131],a[48:51],a[144:147],v[128:131]
ds_read_b64_tr_b16 a[40:41],v14 offset:160
v_mfma_f32_16x16x32_bf16 v[128:131],a[52:55],a[160:163],v[128:131]
buffer_load_dwordx4 v5,s[8:11],s31 offen offset:3072 sc1 lds
s_add_u32 s30,s30,2048
v_mfma_f32_16x16x32_bf16 v[132:135],a[48:51],a[148:151],v[132:135]
ds_read_b64_tr_b16 a[42:43],v14 offset:1056
s_and_b32 s30,s30,0x7fff
v_mfma_f32_16x16x32_bf16 v[132:135],a[52:55],a[164:167],v[132:135]
s_add_u32 s34,s34,32768
s_cmp_eq_u32 s34,65536
s_cselect_b32 s34,0,s34
v_mfma_f32_16x16x32_bf16 v[136:139],a[48:51],a[152:155],v[136:139]
ds_read_b64_tr_b16 a[44:45],v14 offset:15520
s_add_u32 s31,s30,65536
v_mfma_f32_16x16x32_bf16 v[136:139],a[52:55],a[168:171],v[136:139]
s_add_u32 m0,s35,s41
v_mfma_f32_16x16x32_bf16 v[140:143],a[48:51],a[156:159],v[140:143]
ds_read_b64_tr_b16 a[46:47],v14 offset:16416
v_mfma_f32_16x16x32_bf16 v[140:143],a[52:55],a[172:175],v[140:143]
buffer_load_dwordx4 v8,s[12:15],s32 offen lds
v_mfma_f32_16x16x32_bf16 v[144:147],a[56:59],a[144:147],v[144:147]
ds_read_b64_tr_b16 a[48:49],v14 offset:192
v_mfma_f32_16x16x32_bf16 v[144:147],a[60:63],a[160:163],v[144:147]
v_mfma_f32_16x16x32_bf16 v[148:151],a[56:59],a[148:151],v[148:151]
ds_read_b64_tr_b16 a[50:51],v14 offset:1088
v_mfma_f32_16x16x32_bf16 v[148:151],a[60:63],a[164:167],v[148:151]
v_mfma_f32_16x16x32_bf16 v[152:155],a[56:59],a[152:155],v[152:155]
ds_read_b64_tr_b16 a[52:53],v14 offset:15552
v_mfma_f32_16x16x32_bf16 v[152:155],a[60:63],a[168:171],v[152:155]
buffer_load_dwordx4 v9,s[12:15],s32 offen offset:896 lds
v_mfma_f32_16x16x32_bf16 v[156:159],a[56:59],a[156:159],v[156:159]
ds_read_b64_tr_b16 a[54:55],v14 offset:16448
v_mfma_f32_16x16x32_bf16 v[156:159],a[60:63],a[172:175],v[156:159]
v_mfma_f32_16x16x32_bf16 v[160:163],a[64:67],a[144:147],v[160:163]
ds_read_b64_tr_b16 a[56:57],v14 offset:7680
v_mfma_f32_16x16x32_bf16 v[160:163],a[68:71],a[160:163],v[160:163]
v_mfma_f32_16x16x32_bf16 v[164:167],a[64:67],a[148:151],v[164:167]
ds_read_b64_tr_b16 a[58:59],v14 offset:8576
v_mfma_f32_16x16x32_bf16 v[164:167],a[68:71],a[164:167],v[164:167]
buffer_load_dwordx4 v10,s[12:15],s32 offen offset:1920 lds
v_mfma_f32_16x16x32_bf16 v[168:171],a[64:67],a[152:155],v[168:171]
ds_read_b64_tr_b16 a[60:61],v14 offset:23040
v_mfma_f32_16x16x32_bf16 v[168:171],a[68:71],a[168:171],v[168:171]
v_mfma_f32_16x16x32_bf16 v[172:175],a[64:67],a[156:159],v[172:175]
ds_read_b64_tr_b16 a[62:63],v14 offset:23936
v_mfma_f32_16x16x32_bf16 v[172:175],a[68:71],a[172:175],v[172:175]
v_mfma_f32_16x16x32_bf16 v[176:179],a[72:75],a[144:147],v[176:179]
ds_read_b64_tr_b16 a[64:65],v14 offset:7712
v_mfma_f32_16x16x32_bf16 v[176:179],a[76:79],a[160:163],v[176:179]
buffer_load_dwordx4 v11,s[12:15],s32 offen offset:2816 lds
s_add_u32 s35,s35,15360
v_mfma_f32_16x16x32_bf16 v[180:183],a[72:75],a[148:151],v[180:183]
ds_read_b64_tr_b16 a[66:67],v14 offset:8608
v_mfma_f32_16x16x32_bf16 v[180:183],a[76:79],a[164:167],v[180:183]
s_cmp_eq_u32 s35,92160
s_cselect_b32 s35,0,s35
s_add_u32 s32,s32,229376
v_mfma_f32_16x16x32_bf16 v[184:187],a[72:75],a[152:155],v[184:187]
ds_read_b64_tr_b16 a[68:69],v14 offset:23072
s_waitcnt vmcnt(21)
v_mfma_f32_16x16x32_bf16 v[184:187],a[76:79],a[168:171],v[184:187]
s_cmp_eq_u32 s32,7340032
s_cselect_b32 s32,0,s32
s_add_u32 m0,s35,s41
ds_read_b128 a[112:115],v12 offset:0
v_mfma_f32_16x16x32_bf16 v[188:191],a[72:75],a[156:159],v[188:191]
ds_read_b64_tr_b16 a[70:71],v14 offset:23968
v_mfma_f32_16x16x32_bf16 v[188:191],a[76:79],a[172:175],v[188:191]
buffer_load_dwordx4 v8,s[12:15],s32 offen lds
v_mfma_f32_16x16x32_bf16 v[192:195],a[80:83],a[144:147],v[192:195]
ds_read_b64_tr_b16 a[72:73],v14 offset:7744
v_mfma_f32_16x16x32_bf16 v[192:195],a[84:87],a[160:163],v[192:195]
ds_read_b128 a[128:131],v12 offset:1024
v_mfma_f32_16x16x32_bf16 v[196:199],a[80:83],a[148:151],v[196:199]
ds_read_b64_tr_b16 a[74:75],v14 offset:8640
v_mfma_f32_16x16x32_bf16 v[196:199],a[84:87],a[164:167],v[196:199]
v_mfma_f32_16x16x32_bf16 v[200:203],a[80:83],a[152:155],v[200:203]
ds_read_b64_tr_b16 a[76:77],v14 offset:23104
v_mfma_f32_16x16x32_bf16 v[200:203],a[84:87],a[168:171],v[200:203]
ds_read_b128 a[116:119],v12 offset:2048
v_mfma_f32_16x16x32_bf16 v[204:207],a[80:83],a[156:159],v[204:207]
ds_read_b64_tr_b16 a[78:79],v14 offset:24000
v_mfma_f32_16x16x32_bf16 v[204:207],a[84:87],a[172:175],v[204:207]
buffer_load_dwordx4 v9,s[12:15],s32 offen offset:896 lds
v_mfma_f32_16x16x32_bf16 v[208:211],a[88:91],a[144:147],v[208:211]
ds_read_b64_tr_b16 a[80:81],v14 offset:7776
v_mfma_f32_16x16x32_bf16 v[208:211],a[92:95],a[160:163],v[208:211]
ds_read_b128 a[132:135],v12 offset:3072
v_mfma_f32_16x16x32_bf16 v[212:215],a[88:91],a[148:151],v[212:215]
ds_read_b64_tr_b16 a[82:83],v14 offset:8672
v_mfma_f32_16x16x32_bf16 v[212:215],a[92:95],a[164:167],v[212:215]
buffer_load_dwordx4 v10,s[12:15],s32 offen offset:1920 lds
v_mfma_f32_16x16x32_bf16 v[216:219],a[88:91],a[152:155],v[216:219]
ds_read_b64_tr_b16 a[84:85],v14 offset:23136
v_mfma_f32_16x16x32_bf16 v[216:219],a[92:95],a[168:171],v[216:219]
ds_read_b128 a[120:123],v12 offset:4096
v_mfma_f32_16x16x32_bf16 v[220:223],a[88:91],a[156:159],v[220:223]
ds_read_b64_tr_b16 a[86:87],v14 offset:24032
v_mfma_f32_16x16x32_bf16 v[220:223],a[92:95],a[172:175],v[220:223]
v_mfma_f32_16x16x32_bf16 v[224:227],a[96:99],a[144:147],v[224:227]
ds_read_b64_tr_b16 a[88:89],v14 offset:7808
v_mfma_f32_16x16x32_bf16 v[224:227],a[100:103],a[160:163],v[224:227]
ds_read_b128 a[136:139],v12 offset:5120
v_mfma_f32_16x16x32_bf16 v[228:231],a[96:99],a[148:151],v[228:231]
ds_read_b64_tr_b16 a[90:91],v14 offset:8704
v_mfma_f32_16x16x32_bf16 v[228:231],a[100:103],a[164:167],v[228:231]
buffer_load_dwordx4 v11,s[12:15],s32 offen offset:2816 lds
s_add_u32 s35,s35,15360
v_mfma_f32_16x16x32_bf16 v[232:235],a[96:99],a[152:155],v[232:235]
ds_read_b64_tr_b16 a[92:93],v14 offset:23168
v_mfma_f32_16x16x32_bf16 v[232:235],a[100:103],a[168:171],v[232:235]
s_cmp_eq_u32 s35,92160
s_cselect_b32 s35,0,s35
s_add_u32 s32,s32,229376
ds_read_b128 a[124:127],v12 offset:6144
v_mfma_f32_16x16x32_bf16 v[236:239],a[96:99],a[156:159],v[236:239]
ds_read_b64_tr_b16 a[94:95],v14 offset:24064
v_mfma_f32_16x16x32_bf16 v[236:239],a[100:103],a[172:175],v[236:239]
s_cmp_eq_u32 s32,7340032
s_cselect_b32 s32,0,s32
v_mfma_f32_16x16x32_bf16 v[240:243],a[104:107],a[144:147],v[240:243]
ds_read_b64_tr_b16 a[96:97],v14 offset:7840
v_mfma_f32_16x16x32_bf16 v[240:243],a[108:111],a[160:163],v[240:243]
ds_read_b128 a[140:143],v12 offset:7168
v_mfma_f32_16x16x32_bf16 v[244:247],a[104:107],a[148:151],v[244:247]
ds_read_b64_tr_b16 a[98:99],v14 offset:8736
v_mfma_f32_16x16x32_bf16 v[244:247],a[108:111],a[164:167],v[244:247]
buffer_load_dword a252,v26,s[4:7],s33 offen
s_add_u32 s33,s33,512
v_mfma_f32_16x16x32_bf16 v[248:251],a[104:107],a[152:155],v[248:251]
ds_read_b64_tr_b16 a[100:101],v14 offset:23200
v_mfma_f32_16x16x32_bf16 v[248:251],a[108:111],a[168:171],v[248:251]
v_mfma_f32_16x16x32_bf16 v[252:255],a[104:107],a[156:159],v[252:255]
ds_read_b64_tr_b16 a[102:103],v14 offset:24096
v_mfma_f32_16x16x32_bf16 v[252:255],a[108:111],a[172:175],v[252:255]
s_mov_b32 s38,3
Lp3L171_0:
s_waitcnt lgkmcnt(4)
v_mfma_f32_16x16x32_bf16 v[32:35],a[0:3],a[112:115],v[32:35]
ds_read_b64_tr_b16 a[104:105],v14 offset:7872
v_mfma_f32_16x16x32_bf16 v[32:35],a[4:7],a[128:131],v[32:35]
ds_read_b64_tr_b16 a[106:107],v14 offset:8768
v_mfma_f32_16x16x32_bf16 v[36:39],a[0:3],a[116:119],v[36:39]
ds_read_b64_tr_b16 a[108:109],v14 offset:23232
v_mfma_f32_16x16x32_bf16 v[36:39],a[4:7],a[132:135],v[36:39]
ds_read_b64_tr_b16 a[110:111],v14 offset:24128
v_mfma_f32_16x16x32_bf16 v[40:43],a[0:3],a[120:123],v[40:43]
v_add_u32 v14,s43,v14
v_mfma_f32_16x16x32_bf16 v[40:43],a[4:7],a[136:139],v[40:43]
v_xor_b32 v12,32768,v12
v_mfma_f32_16x16x32_bf16 v[44:47],a[0:3],a[124:127],v[44:47]
v_mfma_f32_16x16x32_bf16 v[44:47],a[4:7],a[140:143],v[44:47]
s_waitcnt vmcnt(18) lgkmcnt(0)
s_barrier
v_mfma_f32_16x16x32_bf16 v[48:51],a[8:11],a[112:115],v[48:51]
ds_read_b64_tr_b16 a[0:1],v14 offset:0
s_add_u32 m0,s34,s40
v_mfma_f32_16x16x32_bf16 v[48:51],a[12:15],a[128:131],v[48:51]
buffer_load_dwordx4 v4,s[8:11],s30 offen sc1 lds
s_add_u32 s37,s37,30720
v_mfma_f32_16x16x32_bf16 v[52:55],a[8:11],a[116:119],v[52:55]
ds_read_b64_tr_b16 a[2:3],v14 offset:896
v_mfma_f32_16x16x32_bf16 v[52:55],a[12:15],a[132:135],v[52:55]
s_cmp_eq_u32 s37,92160
s_cselect_b32 s43,s49,s48
s_cselect_b32 s37,0,s37
v_mfma_f32_16x16x32_bf16 v[56:59],a[8:11],a[120:123],v[56:59]
ds_read_b64_tr_b16 a[4:5],v14 offset:15360
v_mfma_f32_16x16x32_bf16 v[56:59],a[12:15],a[136:139],v[56:59]
buffer_load_dwordx4 v4,s[8:11],s30 offen offset:1024 sc1 lds
v_mfma_f32_16x16x32_bf16 v[60:63],a[8:11],a[124:127],v[60:63]
ds_read_b64_tr_b16 a[6:7],v14 offset:16256
v_mfma_f32_16x16x32_bf16 v[60:63],a[12:15],a[140:143],v[60:63]
v_mfma_f32_16x16x32_bf16 v[64:67],a[16:19],a[112:115],v[64:67]
ds_read_b64_tr_b16 a[8:9],v14 offset:32
v_mfma_f32_16x16x32_bf16 v[64:67],a[20:23],a[128:131],v[64:67]
v_mfma_f32_16x16x32_bf16 v[68:71],a[16:19],a[116:119],v[68:71]
ds_read_b64_tr_b16 a[10:11],v14 offset:928
v_mfma_f32_16x16x32_bf16 v[68:71],a[20:23],a[132:135],v[68:71]
buffer_load_dwordx4 v5,s[8:11],s30 offen offset:2048 sc1 lds
v_mfma_f32_16x16x32_bf16 v[72:75],a[16:19],a[120:123],v[72:75]
ds_read_b64_tr_b16 a[12:13],v14 offset:15392
v_mfma_f32_16x16x32_bf16 v[72:75],a[20:23],a[136:139],v[72:75]
v_mfma_f32_16x16x32_bf16 v[76:79],a[16:19],a[124:127],v[76:79]
ds_read_b64_tr_b16 a[14:15],v14 offset:16288
v_mfma_f32_16x16x32_bf16 v[76:79],a[20:23],a[140:143],v[76:79]
v_mfma_f32_16x16x32_bf16 v[80:83],a[24:27],a[112:115],v[80:83]
ds_read_b64_tr_b16 a[16:17],v14 offset:64
v_mfma_f32_16x16x32_bf16 v[80:83],a[28:31],a[128:131],v[80:83]
buffer_load_dwordx4 v5,s[8:11],s30 offen offset:3072 sc1 lds
s_add_u32 m0,s34,s52
v_mfma_f32_16x16x32_bf16 v[84:87],a[24:27],a[116:119],v[84:87]
ds_read_b64_tr_b16 a[18:19],v14 offset:960
v_mfma_f32_16x16x32_bf16 v[84:87],a[28:31],a[132:135],v[84:87]
v_mfma_f32_16x16x32_bf16 v[88:91],a[24:27],a[120:123],v[88:91]
ds_read_b64_tr_b16 a[20:21],v14 offset:15424
v_mfma_f32_16x16x32_bf16 v[88:91],a[28:31],a[136:139],v[88:91]
v_mfma_f32_16x16x32_bf16 v[92:95],a[24:27],a[124:127],v[92:95]
ds_read_b64_tr_b16 a[22:23],v14 offset:16320
v_mfma_f32_16x16x32_bf16 v[92:95],a[28:31],a[140:143],v[92:95]
buffer_load_dwordx4 v4,s[8:11],s31 offen sc1 lds
v_mfma_f32_16x16x32_bf16 v[96:99],a[32:35],a[112:115],v[96:99]
ds_read_b64_tr_b16 a[24:25],v14 offset:96
v_mfma_f32_16x16x32_bf16 v[96:99],a[36:39],a[128:131],v[96:99]
v_mfma_f32_16x16x32_bf16 v[100:103],a[32:35],a[116:119],v[100:103]
ds_read_b64_tr_b16 a[26:27],v14 offset:992
v_mfma_f32_16x16x32_bf16 v[100:103],a[36:39],a[132:135],v[100:103]
v_mfma_f32_16x16x32_bf16 v[104:107],a[32:35],a[120:123],v[104:107]
ds_read_b64_tr_b16 a[28:29],v14 offset:15456
v_mfma_f32_16x16x32_bf16 v[104:107],a[36:39],a[136:139],v[104:107]
buffer_load_dwordx4 v4,s[8:11],s31 offen offset:1024 sc1 lds
v_mfma_f32_16x16x32_bf16 v[108:111],a[32:35],a[124:127],v[108:111]
ds_read_b64_tr_b16 a[30:31],v14 offset:16352
v_mfma_f32_16x16x32_bf16 v[108:111],a[36:39],a[140:143],v[108:111]
v_mfma_f32_16x16x32_bf16 v[112:115],a[40:43],a[112:115],v[112:115]
ds_read_b64_tr_b16 a[32:33],v14 offset:128
v_mfma_f32_16x16x32_bf16 v[112:115],a[44:47],a[128:131],v[112:115]
v_mfma_f32_16x16x32_bf16 v[116:119],a[40:43],a[116:119],v[116:119]
ds_read_b64_tr_b16 a[34:35],v14 offset:1024
v_mfma_f32_16x16x32_bf16 v[116:119],a[44:47],a[132:135],v[116:119]
buffer_load_dwordx4 v5,s[8:11],s31 offen offset:2048 sc1 lds
v_mfma_f32_16x16x32_bf16 v[120:123],a[40:43],a[120:123],v[120:123]
ds_read_b64_tr_b16 a[36:37],v14 offset:15488
v_mfma_f32_16x16x32_bf16 v[120:123],a[44:47],a[136:139],v[120:123]
v_mfma_f32_16x16x32_bf16 v[124:127],a[40:43],a[124:127],v[124:127]
ds_read_b64_tr_b16 a[38:39],v14 offset:16384
v_mfma_f32_16x16x32_bf16 v[124:127],a[44:47],a[140:143],v[124:127]
v_mfma_f32_16x16x32_bf16 v[128:131],a[48:51],a[112:115],v[128:131]
ds_read_b64_tr_b16 a[40:41],v14 offset:160
v_mfma_f32_16x16x32_bf16 v[128:131],a[52:55],a[128:131],v[128:131]
buffer_load_dwordx4 v5,s[8:11],s31 offen offset:3072 sc1 lds
s_add_u32 s30,s30,2048
v_mfma_f32_16x16x32_bf16 v[132:135],a[48:51],a[116:119],v[132:135]
ds_read_b64_tr_b16 a[42:43],v14 offset:1056
s_and_b32 s30,s30,0x7fff
v_mfma_f32_16x16x32_bf16 v[132:135],a[52:55],a[132:135],v[132:135]
s_add_u32 s34,s34,32768
s_cmp_eq_u32 s34,65536
s_cselect_b32 s34,0,s34
v_mfma_f32_16x16x32_bf16 v[136:139],a[48:51],a[120:123],v[136:139]
ds_read_b64_tr_b16 a[44:45],v14 offset:15520
s_add_u32 s31,s30,65536
v_mfma_f32_16x16x32_bf16 v[136:139],a[52:55],a[136:139],v[136:139]
s_add_u32 m0,s35,s41
v_mfma_f32_16x16x32_bf16 v[140:143],a[48:51],a[124:127],v[140:143]
ds_read_b64_tr_b16 a[46:47],v14 offset:16416
v_mfma_f32_16x16x32_bf16 v[140:143],a[52:55],a[140:143],v[140:143]
buffer_load_dwordx4 v8,s[12:15],s32 offen lds
v_mfma_f32_16x16x32_bf16 v[144:147],a[56:59],a[112:115],v[144:147]
ds_read_b64_tr_b16 a[48:49],v14 offset:192
v_mfma_f32_16x16x32_bf16 v[144:147],a[60:63],a[128:131],v[144:147]
v_mfma_f32_16x16x32_bf16 v[148:151],a[56:59],a[116:119],v[148:151]
ds_read_b64_tr_b16 a[50:51],v14 offset:1088
v_mfma_f32_16x16x32_bf16 v[148:151],a[60:63],a[132:135],v[148:151]
v_mfma_f32_16x16x32_bf16 v[152:155],a[56:59],a[120:123],v[152:155]
ds_read_b64_tr_b16 a[52:53],v14 offset:15552
v_mfma_f32_16x16x32_bf16 v[152:155],a[60:63],a[136:139],v[152:155]
buffer_load_dwordx4 v9,s[12:15],s32 offen offset:896 lds
v_mfma_f32_16x16x32_bf16 v[156:159],a[56:59],a[124:127],v[156:159]
ds_read_b64_tr_b16 a[54:55],v14 offset:16448
v_mfma_f32_16x16x32_bf16 v[156:159],a[60:63],a[140:143],v[156:159]
v_mfma_f32_16x16x32_bf16 v[160:163],a[64:67],a[112:115],v[160:163]
ds_read_b64_tr_b16 a[56:57],v14 offset:7680
v_mfma_f32_16x16x32_bf16 v[160:163],a[68:71],a[128:131],v[160:163]
v_mfma_f32_16x16x32_bf16 v[164:167],a[64:67],a[116:119],v[164:167]
ds_read_b64_tr_b16 a[58:59],v14 offset:8576
v_mfma_f32_16x16x32_bf16 v[164:167],a[68:71],a[132:135],v[164:167]
buffer_load_dwordx4 v10,s[12:15],s32 offen offset:1920 lds
v_mfma_f32_16x16x32_bf16 v[168:171],a[64:67],a[120:123],v[168:171]
ds_read_b64_tr_b16 a[60:61],v14 offset:23040
v_mfma_f32_16x16x32_bf16 v[168:171],a[68:71],a[136:139],v[168:171]
v_mfma_f32_16x16x32_bf16 v[172:175],a[64:67],a[124:127],v[172:175]
ds_read_b64_tr_b16 a[62:63],v14 offset:23936
v_mfma_f32_16x16x32_bf16 v[172:175],a[68:71],a[140:143],v[172:175]
v_mfma_f32_16x16x32_bf16 v[176:179],a[72:75],a[112:115],v[176:179]
ds_read_b64_tr_b16 a[64:65],v14 offset:7712
v_mfma_f32_16x16x32_bf16 v[176:179],a[76:79],a[128:131],v[176:179]
buffer_load_dwordx4 v11,s[12:15],s32 offen offset:2816 lds
s_add_u32 s35,s35,15360
v_mfma_f32_16x16x32_bf16 v[180:183],a[72:75],a[116:119],v[180:183]
ds_read_b64_tr_b16 a[66:67],v14 offset:8608
v_mfma_f32_16x16x32_bf16 v[180:183],a[76:79],a[132:135],v[180:183]
s_cmp_eq_u32 s35,92160
s_cselect_b32 s35,0,s35
s_add_u32 s32,s32,229376
v_mfma_f32_16x16x32_bf16 v[184:187],a[72:75],a[120:123],v[184:187]
ds_read_b64_tr_b16 a[68:69],v14 offset:23072
s_waitcnt vmcnt(21)
v_mfma_f32_16x16x32_bf16 v[184:187],a[76:79],a[136:139],v[184:187]
s_cmp_eq_u32 s32,7340032
s_cselect_b32 s32,0,s32
s_add_u32 m0,s35,s41
ds_read_b128 a[144:147],v12 offset:0
v_mfma_f32_16x16x32_bf16 v[188:191],a[72:75],a[124:127],v[188:191]
ds_read_b64_tr_b16 a[70:71],v14 offset:23968
v_mfma_f32_16x16x32_bf16 v[188:191],a[76:79],a[140:143],v[188:191]
buffer_load_dwordx4 v8,s[12:15],s32 offen lds
v_mfma_f32_16x16x32_bf16 v[192:195],a[80:83],a[112:115],v[192:195]
ds_read_b64_tr_b16 a[72:73],v14 offset:7744
v_mfma_f32_16x16x32_bf16 v[192:195],a[84:87],a[128:131],v[192:195]
ds_read_b128 a[160:163],v12 offset:1024
v_mfma_f32_16x16x32_bf16 v[196:199],a[80:83],a[116:119],v[196:199]
ds_read_b64_tr_b16 a[74:75],v14 offset:8640
v_mfma_f32_16x16x32_bf16 v[196:199],a[84:87],a[132:135],v[196:199]
v_mfma_f32_16x16x32_bf16 v[200:203],a[80:83],a[120:123],v[200:203]
ds_read_b64_tr_b16 a[76:77],v14 offset:23104
v_mfma_f32_16x16x32_bf16 v[200:203],a[84:87],a[136:139],v[200:203]
ds_read_b128 a[148:151],v12 offset:2048
v_mfma_f32_16x16x32_bf16 v[204:207],a[80:83],a[124:127],v[204:207]
ds_read_b64_tr_b16 a[78:79],v14 offset:24000
v_mfma_f32_16x16x32_bf16 v[204:207],a[84:87],a[140:143],v[204:207]
buffer_load_dwordx4 v9,s[12:15],s32 offen offset:896 lds
v_mfma_f32_16x16x32_bf16 v[208:211],a[88:91],a[112:115],v[208:211]
ds_read_b64_tr_b16 a[80:81],v14 offset:7776
v_mfma_f32_16x16x32_bf16 v[208:211],a[92:95],a[128:131],v[208:211]
ds_read_b128 a[164:167],v12 offset:3072
v_mfma_f32_16x16x32_bf16 v[212:215],a[88:91],a[116:119],v[212:215]
ds_read_b64_tr_b16 a[82:83],v14 offset:8672
v_mfma_f32_16x16x32_bf16 v[212:215],a[92:95],a[132:135],v[212:215]
buffer_load_dwordx4 v10,s[12:15],s32 offen offset:1920 lds
v_mfma_f32_16x16x32_bf16 v[216:219],a[88:91],a[120:123],v[216:219]
ds_read_b64_tr_b16 a[84:85],v14 offset:23136
v_mfma_f32_16x16x32_bf16 v[216:219],a[92:95],a[136:139],v[216:219]
ds_read_b128 a[152:155],v12 offset:4096
v_mfma_f32_16x16x32_bf16 v[220:223],a[88:91],a[124:127],v[220:223]
ds_read_b64_tr_b16 a[86:87],v14 offset:24032
v_mfma_f32_16x16x32_bf16 v[220:223],a[92:95],a[140:143],v[220:223]
v_mfma_f32_16x16x32_bf16 v[224:227],a[96:99],a[112:115],v[224:227]
ds_read_b64_tr_b16 a[88:89],v14 offset:7808
v_mfma_f32_16x16x32_bf16 v[224:227],a[100:103],a[128:131],v[224:227]
ds_read_b128 a[168:171],v12 offset:5120
v_mfma_f32_16x16x32_bf16 v[228:231],a[96:99],a[116:119],v[228:231]
ds_read_b64_tr_b16 a[90:91],v14 offset:8704
v_mfma_f32_16x16x32_bf16 v[228:231],a[100:103],a[132:135],v[228:231]
buffer_load_dwordx4 v11,s[12:15],s32 offen offset:2816 lds
s_add_u32 s35,s35,15360
v_mfma_f32_16x16x32_bf16 v[232:235],a[96:99],a[120:123],v[232:235]
ds_read_b64_tr_b16 a[92:93],v14 offset:23168
v_mfma_f32_16x16x32_bf16 v[232:235],a[100:103],a[136:139],v[232:235]
s_cmp_eq_u32 s35,92160
s_cselect_b32 s35,0,s35
s_add_u32 s32,s32,229376
ds_read_b128 a[156:159],v12 offset:6144
v_mfma_f32_16x16x32_bf16 v[236:239],a[96:99],a[124:127],v[236:239]
ds_read_b64_tr_b16 a[94:95],v14 offset:24064
v_mfma_f32_16x16x32_bf16 v[236:239],a[100:103],a[140:143],v[236:239]
s_cmp_eq_u32 s32,7340032
s_cselect_b32 s32,0,s32
v_mfma_f32_16x16x32_bf16 v[240:243],a[104:107],a[112:115],v[240:243]
ds_read_b64_tr_b16 a[96:97],v14 offset:7840
v_mfma_f32_16x16x32_bf16 v[240:243],a[108:111],a[128:131],v[240:243]
ds_read_b128 a[172:175],v12 offset:7168
v_mfma_f32_16x16x32_bf16 v[244:247],a[104:107],a[116:119],v[244:247]
ds_read_b64_tr_b16 a[98:99],v14 offset:8736
v_mfma_f32_16x16x32_bf16 v[244:247],a[108:111],a[132:135],v[244:247]
buffer_load_dword a252,v26,s[4:7],s33 offen
s_add_u32 s33,s33,512
v_mfma_f32_16x16x32_bf16 v[248:251],a[104:107],a[120:123],v[248:251]
ds_read_b64_tr_b16 a[100:101],v14 offset:23200
v_mfma_f32_16x16x32_bf16 v[248:251],a[108:111],a[136:139],v[248:251]
v_mfma_f32_16x16x32_bf16 v[252:255],a[104:107],a[124:127],v[252:255]
ds_read_b64_tr_b16 a[102:103],v14 offset:24096
v_mfma_f32_16x16x32_bf16 v[252:255],a[108:111],a[140:143],v[252:255]
s_waitcnt lgkmcnt(4)
v_mfma_f32_16x16x32_bf16 v[32:35],a[0:3],a[144:147],v[32:35]
ds_read_b64_tr_b16 a[104:105],v14 offset:7872
v_mfma_f32_16x16x32_bf16 v[32:35],a[4:7],a[160:163],v[32:35]
ds_read_b64_tr_b16 a[106:107],v14 offset:8768
v_mfma_f32_16x16x32_bf16 v[36:39],a[0:3],a[148:151],v[36:39]
ds_read_b64_tr_b16 a[108:109],v14 offset:23232
v_mfma_f32_16x16x32_bf16 v[36:39],a[4:7],a[164:167],v[36:39]
ds_read_b64_tr_b16 a[110:111],v14 offset:24128
v_mfma_f32_16x16x32_bf16 v[40:43],a[0:3],a[152:155],v[40:43]
v_add_u32 v14,s43,v14
v_mfma_f32_16x16x32_bf16 v[40:43],a[4:7],a[168:171],v[40:43]
v_xor_b32 v12,32768,v12
v_mfma_f32_16x16x32_bf16 v[44:47],a[0:3],a[156:159],v[44:47]
v_mfma_f32_16x16x32_bf16 v[44:47],a[4:7],a[172:175],v[44:47]
s_waitcnt vmcnt(18) lgkmcnt(0)
s_barrier
v_mfma_f32_16x16x32_bf16 v[48:51],a[8:11],a[144:147],v[48:51]
ds_read_b64_tr_b16 a[0:1],v14 offset:0
s_add_u32 m0,s34,s40
v_mfma_f32_16x16x32_bf16 v[48:51],a[12:15],a[160:163],v[48:51]
buffer_load_dwordx4 v4,s[8:11],s30 offen sc1 lds
s_add_u32 s37,s37,30720
v_mfma_f32_16x16x32_bf16 v[52:55],a[8:11],a[148:151],v[52:55]
ds_read_b64_tr_b16 a[2:3],v14 offset:896
v_mfma_f32_16x16x32_bf16 v[52:55],a[12:15],a[164:167],v[52:55]
s_cmp_eq_u32 s37,92160
s_cselect_b32 s43,s49,s48
s_cselect_b32 s37,0,s37
v_mfma_f32_16x16x32_bf16 v[56:59],a[8:11],a[152:155],v[56:59]
ds_read_b64_tr_b16 a[4:5],v14 offset:15360
v_mfma_f32_16x16x32_bf16 v[56:59],a[12:15],a[168:171],v[56:59]
buffer_load_dwordx4 v4,s[8:11],s30 offen offset:1024 sc1 lds
v_mfma_f32_16x16x32_bf16 v[60:63],a[8:11],a[156:159],v[60:63]
ds_read_b64_tr_b16 a[6:7],v14 offset:16256
v_mfma_f32_16x16x32_bf16 v[60:63],a[12:15],a[172:175],v[60:63]
v_mfma_f32_16x16x32_bf16 v[64:67],a[16:19],a[144:147],v[64:67]
ds_read_b64_tr_b16 a[8:9],v14 offset:32
v_mfma_f32_16x16x32_bf16 v[64:67],a[20:23],a[160:163],v[64:67]
v_mfma_f32_16x16x32_bf16 v[68:71],a[16:19],a[148:151],v[68:71]
ds_read_b64_tr_b16 a[10:11],v14 offset:928
v_mfma_f32_16x16x32_bf16 v[68:71],a[20:23],a[164:167],v[68:71]
buffer_load_dwordx4 v5,s[8:11],s30 offen offset:2048 sc1 lds
v_mfma_f32_16x16x32_bf16 v[72:75],a[16:19],a[152:155],v[72:75]
ds_read_b64_tr_b16 a[12:13],v14 offset:15392
v_mfma_f32_16x16x32_bf16 v[72:75],a[20:23],a[168:171],v[72:75]
v_mfma_f32_16x16x32_bf16 v[76:79],a[16:19],a[156:159],v[76:79]
ds_read_b64_tr_b16 a[14:15],v14 offset:16288
v_mfma_f32_16x16x32_bf16 v[76:79],a[20:23],a[172:175],v[76:79]
v_mfma_f32_16x16x32_bf16 v[80:83],a[24:27],a[144:147],v[80:83]
ds_read_b64_tr_b16 a[16:17],v14 offset:64
v_mfma_f32_16x16x32_bf16 v[80:83],a[28:31],a[160:163],v[80:83]
buffer_load_dwordx4 v5,s[8:11],s30 offen offset:3072 sc1 lds
s_add_u32 m0,s34,s52
v_mfma_f32_16x16x32_bf16 v[84:87],a[24:27],a[148:151],v[84:87]
ds_read_b64_tr_b16 a[18:19],v14 offset:960
v_mfma_f32_16x16x32_bf16 v[84:87],a[28:31],a[164:167],v[84:87]
v_mfma_f32_16x16x32_bf16 v[88:91],a[24:27],a[152:155],v[88:91]
ds_read_b64_tr_b16 a[20:21],v14 offset:15424
v_mfma_f32_16x16x32_bf16 v[88:91],a[28:31],a[168:171],v[88:91]
v_mfma_f32_16x16x32_bf16 v[92:95],a[24:27],a[156:159],v[92:95]
ds_read_b64_tr_b16 a[22:23],v14 offset:16320
v_mfma_f32_16x16x32_bf16 v[92:95],a[28:31],a[172:175],v[92:95]
buffer_load_dwordx4 v4,s[8:11],s31 offen sc1 lds
v_mfma_f32_16x16x32_bf16 v[96:99],a[32:35],a[144:147],v[96:99]
ds_read_b64_tr_b16 a[24:25],v14 offset:96
v_mfma_f32_16x16x32_bf16 v[96:99],a[36:39],a[160:163],v[96:99]
v_mfma_f32_16x16x32_bf16 v[100:103],a[32:35],a[148:151],v[100:103]
ds_read_b64_tr_b16 a[26:27],v14 offset:992
v_mfma_f32_16x16x32_bf16 v[100:103],a[36:39],a[164:167],v[100:103]
v_mfma_f32_16x16x32_bf16 v[104:107],a[32:35],a[152:155],v[104:107]
ds_read_b64_tr_b16 a[28:29],v14 offset:15456
v_mfma_f32_16x16x32_bf16 v[104:107],a[36:39],a[168:171],v[104:107]
buffer_load_dwordx4 v4,s[8:11],s31 offen offset:1024 sc1 lds
v_mfma_f32_16x16x32_bf16 v[108:111],a[32:35],a[156:159],v[108:111]
ds_read_b64_tr_b16 a[30:31],v14 offset:16352
v_mfma_f32_16x16x32_bf16 v[108:111],a[36:39],a[172:175],v[108:111]
v_mfma_f32_16x16x32_bf16 v[112:115],a[40:43],a[144:147],v[112:115]
ds_read_b64_tr_b16 a[32:33],v14 offset:128
v_mfma_f32_16x16x32_bf16 v[112:115],a[44:47],a[160:163],v[112:115]
v_mfma_f32_16x16x32_bf16 v[116:119],a[40:43],a[148:151],v[116:119]
ds_read_b64_tr_b16 a[34:35],v14 offset:1024
v_mfma_f32_16x16x32_bf16 v[116:119],a[44:47],a[164:167],v[116:119]
buffer_load_dwordx4 v5,s[8:11],s31 offen offset:2048 sc1 lds
v_mfma_f32_16x16x32_bf16 v[120:123],a[40:43],a[152:155],v[120:123]
ds_read_b64_tr_b16 a[36:37],v14 offset:15488
v_mfma_f32_16x16x32_bf16 v[120:123],a[44:47],a[168:171],v[120:123]
v_mfma_f32_16x16x32_bf16 v[124:127],a[40:43],a[156:159],v[124:127]
ds_read_b64_tr_b16 a[38:39],v14 offset:16384
v_mfma_f32_16x16x32_bf16 v[124:127],a[44:47],a[172:175],v[124:127]
v_mfma_f32_16x16x32_bf16 v[128:131],a[48:51],a[144:147],v[128:131]
ds_read_b64_tr_b16 a[40:41],v14 offset:160
v_mfma_f32_16x16x32_bf16 v[128:131],a[52:55],a[160:163],v[128:131]
buffer_load_dwordx4 v5,s[8:11],s31 offen offset:3072 sc1 lds
s_add_u32 s30,s30,2048
v_mfma_f32_16x16x32_bf16 v[132:135],a[48:51],a[148:151],v[132:135]
ds_read_b64_tr_b16 a[42:43],v14 offset:1056
s_and_b32 s30,s30,0x7fff
v_mfma_f32_16x16x32_bf16 v[132:135],a[52:55],a[164:167],v[132:135]
s_add_u32 s34,s34,32768
s_cmp_eq_u32 s34,65536
s_cselect_b32 s34,0,s34
v_mfma_f32_16x16x32_bf16 v[136:139],a[48:51],a[152:155],v[136:139]
ds_read_b64_tr_b16 a[44:45],v14 offset:15520
s_add_u32 s31,s30,65536
v_mfma_f32_16x16x32_bf16 v[136:139],a[52:55],a[168:171],v[136:139]
s_add_u32 m0,s35,s41
v_mfma_f32_16x16x32_bf16 v[140:143],a[48:51],a[156:159],v[140:143]
ds_read_b64_tr_b16 a[46:47],v14 offset:16416
v_mfma_f32_16x16x32_bf16 v[140:143],a[52:55],a[172:175],v[140:143]
buffer_load_dwordx4 v8,s[12:15],s32 offen lds
v_mfma_f32_16x16x32_bf16 v[144:147],a[56:59],a[144:147],v[144:147]
ds_read_b64_tr_b16 a[48:49],v14 offset:192
v_mfma_f32_16x16x32_bf16 v[144:147],a[60:63],a[160:163],v[144:147]
v_mfma_f32_16x16x32_bf16 v[148:151],a[56:59],a[148:151],v[148:151]
ds_read_b64_tr_b16 a[50:51],v14 offset:1088
v_mfma_f32_16x16x32_bf16 v[148:151],a[60:63],a[164:167],v[148:151]
v_mfma_f32_16x16x32_bf16 v[152:155],a[56:59],a[152:155],v[152:155]
ds_read_b64_tr_b16 a[52:53],v14 offset:15552
v_mfma_f32_16x16x32_bf16 v[152:155],a[60:63],a[168:171],v[152:155]
buffer_load_dwordx4 v9,s[12:15],s32 offen offset:896 lds
v_mfma_f32_16x16x32_bf16 v[156:159],a[56:59],a[156:159],v[156:159]
ds_read_b64_tr_b16 a[54:55],v14 offset:16448
v_mfma_f32_16x16x32_bf16 v[156:159],a[60:63],a[172:175],v[156:159]
v_mfma_f32_16x16x32_bf16 v[160:163],a[64:67],a[144:147],v[160:163]
ds_read_b64_tr_b16 a[56:57],v14 offset:7680
v_mfma_f32_16x16x32_bf16 v[160:163],a[68:71],a[160:163],v[160:163]
v_mfma_f32_16x16x32_bf16 v[164:167],a[64:67],a[148:151],v[164:167]
ds_read_b64_tr_b16 a[58:59],v14 offset:8576
v_mfma_f32_16x16x32_bf16 v[164:167],a[68:71],a[164:167],v[164:167]
buffer_load_dwordx4 v10,s[12:15],s32 offen offset:1920 lds
v_mfma_f32_16x16x32_bf16 v[168:171],a[64:67],a[152:155],v[168:171]
ds_read_b64_tr_b16 a[60:61],v14 offset:23040
v_mfma_f32_16x16x32_bf16 v[168:171],a[68:71],a[168:171],v[168:171]
v_mfma_f32_16x16x32_bf16 v[172:175],a[64:67],a[156:159],v[172:175]
ds_read_b64_tr_b16 a[62:63],v14 offset:23936
v_mfma_f32_16x16x32_bf16 v[172:175],a[68:71],a[172:175],v[172:175]
v_mfma_f32_16x16x32_bf16 v[176:179],a[72:75],a[144:147],v[176:179]
ds_read_b64_tr_b16 a[64:65],v14 offset:7712
v_mfma_f32_16x16x32_bf16 v[176:179],a[76:79],a[160:163],v[176:179]
buffer_load_dwordx4 v11,s[12:15],s32 offen offset:2816 lds
s_add_u32 s35,s35,15360
v_mfma_f32_16x16x32_bf16 v[180:183],a[72:75],a[148:151],v[180:183]
ds_read_b64_tr_b16 a[66:67],v14 offset:8608
v_mfma_f32_16x16x32_bf16 v[180:183],a[76:79],a[164:167],v[180:183]
s_cmp_eq_u32 s35,92160
s_cselect_b32 s35,0,s35
s_add_u32 s32,s32,229376
v_mfma_f32_16x16x32_bf16 v[184:187],a[72:75],a[152:155],v[184:187]
ds_read_b64_tr_b16 a[68:69],v14 offset:23072
s_waitcnt vmcnt(21)
v_mfma_f32_16x16x32_bf16 v[184:187],a[76:79],a[168:171],v[184:187]
s_cmp_eq_u32 s32,7340032
s_cselect_b32 s32,0,s32
s_add_u32 m0,s35,s41
ds_read_b128 a[112:115],v12 offset:0
v_mfma_f32_16x16x32_bf16 v[188:191],a[72:75],a[156:159],v[188:191]
ds_read_b64_tr_b16 a[70:71],v14 offset:23968
v_mfma_f32_16x16x32_bf16 v[188:191],a[76:79],a[172:175],v[188:191]
buffer_load_dwordx4 v8,s[12:15],s32 offen lds
v_mfma_f32_16x16x32_bf16 v[192:195],a[80:83],a[144:147],v[192:195]
ds_read_b64_tr_b16 a[72:73],v14 offset:7744
v_mfma_f32_16x16x32_bf16 v[192:195],a[84:87],a[160:163],v[192:195]
ds_read_b128 a[128:131],v12 offset:1024
v_mfma_f32_16x16x32_bf16 v[196:199],a[80:83],a[148:151],v[196:199]
ds_read_b64_tr_b16 a[74:75],v14 offset:8640
v_mfma_f32_16x16x32_bf16 v[196:199],a[84:87],a[164:167],v[196:199]
v_mfma_f32_16x16x32_bf16 v[200:203],a[80:83],a[152:155],v[200:203]
ds_read_b64_tr_b16 a[76:77],v14 offset:23104
v_mfma_f32_16x16x32_bf16 v[200:203],a[84:87],a[168:171],v[200:203]
ds_read_b128 a[116:119],v12 offset:2048
v_mfma_f32_16x16x32_bf16 v[204:207],a[80:83],a[156:159],v[204:207]
ds_read_b64_tr_b16 a[78:79],v14 offset:24000
v_mfma_f32_16x16x32_bf16 v[204:207],a[84:87],a[172:175],v[204:207]
buffer_load_dwordx4 v9,s[12:15],s32 offen offset:896 lds
v_mfma_f32_16x16x32_bf16 v[208:211],a[88:91],a[144:147],v[208:211]
ds_read_b64_tr_b16 a[80:81],v14 offset:7776
v_mfma_f32_16x16x32_bf16 v[208:211],a[92:95],a[160:163],v[208:211]
ds_read_b128 a[132:135],v12 offset:3072
v_mfma_f32_16x16x32_bf16 v[212:215],a[88:91],a[148:151],v[212:215]
ds_read_b64_tr_b16 a[82:83],v14 offset:8672
v_mfma_f32_16x16x32_bf16 v[212:215],a[92:95],a[164:167],v[212:215]
buffer_load_dwordx4 v10,s[12:15],s32 offen offset:1920 lds
v_mfma_f32_16x16x32_bf16 v[216:219],a[88:91],a[152:155],v[216:219]
ds_read_b64_tr_b16 a[84:85],v14 offset:23136
v_mfma_f32_16x16x32_bf16 v[216:219],a[92:95],a[168:171],v[216:219]
ds_read_b128 a[120:123],v12 offset:4096
v_mfma_f32_16x16x32_bf16 v[220:223],a[88:91],a[156:159],v[220:223]
ds_read_b64_tr_b16 a[86:87],v14 offset:24032
v_mfma_f32_16x16x32_bf16 v[220:223],a[92:95],a[172:175],v[220:223]
v_mfma_f32_16x16x32_bf16 v[224:227],a[96:99],a[144:147],v[224:227]
ds_read_b64_tr_b16 a[88:89],v14 offset:7808
v_mfma_f32_16x16x32_bf16 v[224:227],a[100:103],a[160:163],v[224:227]
ds_read_b128 a[136:139],v12 offset:5120
v_mfma_f32_16x16x32_bf16 v[228:231],a[96:99],a[148:151],v[228:231]
ds_read_b64_tr_b16 a[90:91],v14 offset:8704
v_mfma_f32_16x16x32_bf16 v[228:231],a[100:103],a[164:167],v[228:231]
buffer_load_dwordx4 v11,s[12:15],s32 offen offset:2816 lds
s_add_u32 s35,s35,15360
v_mfma_f32_16x16x32_bf16 v[232:235],a[96:99],a[152:155],v[232:235]
ds_read_b64_tr_b16 a[92:93],v14 offset:23168
v_mfma_f32_16x16x32_bf16 v[232:235],a[100:103],a[168:171],v[232:235]
s_cmp_eq_u32 s35,92160
s_cselect_b32 s35,0,s35
s_add_u32 s32,s32,229376
ds_read_b128 a[124:127],v12 offset:6144
v_mfma_f32_16x16x32_bf16 v[236:239],a[96:99],a[156:159],v[236:239]
ds_read_b64_tr_b16 a[94:95],v14 offset:24064
v_mfma_f32_16x16x32_bf16 v[236:239],a[100:103],a[172:175],v[236:239]
s_cmp_eq_u32 s32,7340032
s_cselect_b32 s32,0,s32
v_mfma_f32_16x16x32_bf16 v[240:243],a[104:107],a[144:147],v[240:243]
ds_read_b64_tr_b16 a[96:97],v14 offset:7840
v_mfma_f32_16x16x32_bf16 v[240:243],a[108:111],a[160:163],v[240:243]
ds_read_b128 a[140:143],v12 offset:7168
v_mfma_f32_16x16x32_bf16 v[244:247],a[104:107],a[148:151],v[244:247]
ds_read_b64_tr_b16 a[98:99],v14 offset:8736
v_mfma_f32_16x16x32_bf16 v[244:247],a[108:111],a[164:167],v[244:247]
buffer_load_dword a252,v26,s[4:7],s33 offen
s_add_u32 s33,s33,512
v_mfma_f32_16x16x32_bf16 v[248:251],a[104:107],a[152:155],v[248:251]
ds_read_b64_tr_b16 a[100:101],v14 offset:23200
v_mfma_f32_16x16x32_bf16 v[248:251],a[108:111],a[168:171],v[248:251]
v_mfma_f32_16x16x32_bf16 v[252:255],a[104:107],a[156:159],v[252:255]
ds_read_b64_tr_b16 a[102:103],v14 offset:24096
v_mfma_f32_16x16x32_bf16 v[252:255],a[108:111],a[172:175],v[252:255]
s_sub_u32 s38,s38,1
s_cmp_lg_u32 s38,0
s_cbranch_scc1 Lp3L171_0
s_waitcnt lgkmcnt(4)
v_mfma_f32_16x16x32_bf16 v[32:35],a[0:3],a[112:115],v[32:35]
ds_read_b64_tr_b16 a[104:105],v14 offset:7872
v_mfma_f32_16x16x32_bf16 v[32:35],a[4:7],a[128:131],v[32:35]
ds_read_b64_tr_b16 a[106:107],v14 offset:8768
v_mfma_f32_16x16x32_bf16 v[36:39],a[0:3],a[116:119],v[36:39]
ds_read_b64_tr_b16 a[108:109],v14 offset:23232
v_mfma_f32_16x16x32_bf16 v[36:39],a[4:7],a[132:135],v[36:39]
ds_read_b64_tr_b16 a[110:111],v14 offset:24128
v_mfma_f32_16x16x32_bf16 v[40:43],a[0:3],a[120:123],v[40:43]
v_add_u32 v14,s43,v14
v_mfma_f32_16x16x32_bf16 v[40:43],a[4:7],a[136:139],v[40:43]
v_xor_b32 v12,32768,v12
v_mfma_f32_16x16x32_bf16 v[44:47],a[0:3],a[124:127],v[44:47]
v_mfma_f32_16x16x32_bf16 v[44:47],a[4:7],a[140:143],v[44:47]
s_waitcnt vmcnt(18) lgkmcnt(0)
s_barrier
v_mfma_f32_16x16x32_bf16 v[48:51],a[8:11],a[112:115],v[48:51]
ds_read_b64_tr_b16 a[0:1],v14 offset:0
s_add_u32 s37,s37,30720
v_mfma_f32_16x16x32_bf16 v[48:51],a[12:15],a[128:131],v[48:51]
buffer_load_dwordx4 a[176:179],v29,s[24:27],s60 offen sc1
v_mfma_f32_16x16x32_bf16 v[52:55],a[8:11],a[116:119],v[52:55]
ds_read_b64_tr_b16 a[2:3],v14 offset:896
v_mfma_f32_16x16x32_bf16 v[52:55],a[12:15],a[132:135],v[52:55]
buffer_load_dwordx4 a[180:183],v29,s[24:27],s60 offen offset:256 sc1
v_mfma_f32_16x16x32_bf16 v[56:59],a[8:11],a[120:123],v[56:59]
ds_read_b64_tr_b16 a[4:5],v14 offset:15360
v_mfma_f32_16x16x32_bf16 v[56:59],a[12:15],a[136:139],v[56:59]
s_cmp_eq_u32 s37,92160
s_cselect_b32 s43,s49,s48
s_cselect_b32 s37,0,s37
v_mfma_f32_16x16x32_bf16 v[60:63],a[8:11],a[124:127],v[60:63]
ds_read_b64_tr_b16 a[6:7],v14 offset:16256
v_mfma_f32_16x16x32_bf16 v[60:63],a[12:15],a[140:143],v[60:63]
buffer_load_dwordx4 a[184:187],v29,s[24:27],s60 offen offset:512 sc1
v_mfma_f32_16x16x32_bf16 v[64:67],a[16:19],a[112:115],v[64:67]
ds_read_b64_tr_b16 a[8:9],v14 offset:32
v_mfma_f32_16x16x32_bf16 v[64:67],a[20:23],a[128:131],v[64:67]
v_mfma_f32_16x16x32_bf16 v[68:71],a[16:19],a[116:119],v[68:71]
ds_read_b64_tr_b16 a[10:11],v14 offset:928
v_mfma_f32_16x16x32_bf16 v[68:71],a[20:23],a[132:135],v[68:71]
buffer_load_dwordx4 a[188:191],v29,s[24:27],s60 offen offset:768 sc1
v_mfma_f32_16x16x32_bf16 v[72:75],a[16:19],a[120:123],v[72:75]
ds_read_b64_tr_b16 a[12:13],v14 offset:15392
v_mfma_f32_16x16x32_bf16 v[72:75],a[20:23],a[136:139],v[72:75]
v_mfma_f32_16x16x32_bf16 v[76:79],a[16:19],a[124:127],v[76:79]
ds_read_b64_tr_b16 a[14:15],v14 offset:16288
v_mfma_f32_16x16x32_bf16 v[76:79],a[20:23],a[140:143],v[76:79]
buffer_load_dwordx4 a[192:195],v29,s[24:27],s60 offen offset:1024 sc1
v_mfma_f32_16x16x32_bf16 v[80:83],a[24:27],a[112:115],v[80:83]
ds_read_b64_tr_b16 a[16:17],v14 offset:64
v_mfma_f32_16x16x32_bf16 v[80:83],a[28:31],a[128:131],v[80:83]
v_mfma_f32_16x16x32_bf16 v[84:87],a[24:27],a[116:119],v[84:87]
ds_read_b64_tr_b16 a[18:19],v14 offset:960
v_mfma_f32_16x16x32_bf16 v[84:87],a[28:31],a[132:135],v[84:87]
buffer_load_dwordx4 a[196:199],v29,s[24:27],s60 offen offset:1280 sc1
v_mfma_f32_16x16x32_bf16 v[88:91],a[24:27],a[120:123],v[88:91]
ds_read_b64_tr_b16 a[20:21],v14 offset:15424
v_mfma_f32_16x16x32_bf16 v[88:91],a[28:31],a[136:139],v[88:91]
v_mfma_f32_16x16x32_bf16 v[92:95],a[24:27],a[124:127],v[92:95]
ds_read_b64_tr_b16 a[22:23],v14 offset:16320
v_mfma_f32_16x16x32_bf16 v[92:95],a[28:31],a[140:143],v[92:95]
buffer_load_dwordx4 a[200:203],v29,s[24:27],s60 offen offset:1536 sc1
v_mfma_f32_16x16x32_bf16 v[96:99],a[32:35],a[112:115],v[96:99]
ds_read_b64_tr_b16 a[24:25],v14 offset:96
v_mfma_f32_16x16x32_bf16 v[96:99],a[36:39],a[128:131],v[96:99]
v_mfma_f32_16x16x32_bf16 v[100:103],a[32:35],a[116:119],v[100:103]
ds_read_b64_tr_b16 a[26:27],v14 offset:992
v_mfma_f32_16x16x32_bf16 v[100:103],a[36:39],a[132:135],v[100:103]
buffer_load_dwordx4 a[204:207],v29,s[24:27],s60 offen offset:1792 sc1
s_add_u32 m0,s34,s40
v_mfma_f32_16x16x32_bf16 v[104:107],a[32:35],a[120:123],v[104:107]
ds_read_b64_tr_b16 a[28:29],v14 offset:15456
v_mfma_f32_16x16x32_bf16 v[104:107],a[36:39],a[136:139],v[104:107]
v_mfma_f32_16x16x32_bf16 v[108:111],a[32:35],a[124:127],v[108:111]
ds_read_b64_tr_b16 a[30:31],v14 offset:16352
v_mfma_f32_16x16x32_bf16 v[108:111],a[36:39],a[140:143],v[108:111]
buffer_load_dwordx4 v4,s[8:11],s30 offen sc1 lds
v_mfma_f32_16x16x32_bf16 v[112:115],a[40:43],a[112:115],v[112:115]
ds_read_b64_tr_b16 a[32:33],v14 offset:128
v_mfma_f32_16x16x32_bf16 v[112:115],a[44:47],a[128:131],v[112:115]
v_mfma_f32_16x16x32_bf16 v[116:119],a[40:43],a[116:119],v[116:119]
ds_read_b64_tr_b16 a[34:35],v14 offset:1024
v_mfma_f32_16x16x32_bf16 v[116:119],a[44:47],a[132:135],v[116:119]
buffer_load_dwordx4 v4,s[8:11],s30 offen offset:1024 sc1 lds
v_mfma_f32_16x16x32_bf16 v[120:123],a[40:43],a[120:123],v[120:123]
ds_read_b64_tr_b16 a[36:37],v14 offset:15488
v_mfma_f32_16x16x32_bf16 v[120:123],a[44:47],a[136:139],v[120:123]
v_mfma_f32_16x16x32_bf16 v[124:127],a[40:43],a[124:127],v[124:127]
ds_read_b64_tr_b16 a[38:39],v14 offset:16384
v_mfma_f32_16x16x32_bf16 v[124:127],a[44:47],a[140:143],v[124:127]
buffer_load_dwordx4 v5,s[8:11],s30 offen offset:2048 sc1 lds
v_mfma_f32_16x16x32_bf16 v[128:131],a[48:51],a[112:115],v[128:131]
ds_read_b64_tr_b16 a[40:41],v14 offset:160
v_mfma_f32_16x16x32_bf16 v[128:131],a[52:55],a[128:131],v[128:131]
v_mfma_f32_16x16x32_bf16 v[132:135],a[48:51],a[116:119],v[132:135]
ds_read_b64_tr_b16 a[42:43],v14 offset:1056
v_mfma_f32_16x16x32_bf16 v[132:135],a[52:55],a[132:135],v[132:135]
buffer_load_dwordx4 v5,s[8:11],s30 offen offset:3072 sc1 lds
s_add_u32 m0,s34,s52
v_mfma_f32_16x16x32_bf16 v[136:139],a[48:51],a[120:123],v[136:139]
ds_read_b64_tr_b16 a[44:45],v14 offset:15520
v_mfma_f32_16x16x32_bf16 v[136:139],a[52:55],a[136:139],v[136:139]
v_mfma_f32_16x16x32_bf16 v[140:143],a[48:51],a[124:127],v[140:143]
ds_read_b64_tr_b16 a[46:47],v14 offset:16416
v_mfma_f32_16x16x32_bf16 v[140:143],a[52:55],a[140:143],v[140:143]
buffer_load_dwordx4 v4,s[8:11],s31 offen sc1 lds
v_mfma_f32_16x16x32_bf16 v[144:147],a[56:59],a[112:115],v[144:147]
ds_read_b64_tr_b16 a[48:49],v14 offset:192
v_mfma_f32_16x16x32_bf16 v[144:147],a[60:63],a[128:131],v[144:147]
v_mfma_f32_16x16x32_bf16 v[148:151],a[56:59],a[116:119],v[148:151]
ds_read_b64_tr_b16 a[50:51],v14 offset:1088
v_mfma_f32_16x16x32_bf16 v[148:151],a[60:63],a[132:135],v[148:151]
buffer_load_dwordx4 v4,s[8:11],s31 offen offset:1024 sc1 lds
v_mfma_f32_16x16x32_bf16 v[152:155],a[56:59],a[120:123],v[152:155]
ds_read_b64_tr_b16 a[52:53],v14 offset:15552
v_mfma_f32_16x16x32_bf16 v[152:155],a[60:63],a[136:139],v[152:155]
buffer_load_dwordx4 v5,s[8:11],s31 offen offset:2048 sc1 lds
v_mfma_f32_16x16x32_bf16 v[156:159],a[56:59],a[124:127],v[156:159]
ds_read_b64_tr_b16 a[54:55],v14 offset:16448
v_mfma_f32_16x16x32_bf16 v[156:159],a[60:63],a[140:143],v[156:159]
v_mfma_f32_16x16x32_bf16 v[160:163],a[64:67],a[112:115],v[160:163]
ds_read_b64_tr_b16 a[56:57],v14 offset:7680
v_mfma_f32_16x16x32_bf16 v[160:163],a[68:71],a[128:131],v[160:163]
buffer_load_dwordx4 v5,s[8:11],s31 offen offset:3072 sc1 lds
s_add_u32 s30,s30,2048
v_mfma_f32_16x16x32_bf16 v[164:167],a[64:67],a[116:119],v[164:167]
ds_read_b64_tr_b16 a[58:59],v14 offset:8576
s_and_b32 s30,s30,0x7fff
v_mfma_f32_16x16x32_bf16 v[164:167],a[68:71],a[132:135],v[164:167]
s_add_u32 s34,s34,32768
s_cmp_eq_u32 s34,65536
s_cselect_b32 s34,0,s34
v_mfma_f32_16x16x32_bf16 v[168:171],a[64:67],a[120:123],v[168:171]
ds_read_b64_tr_b16 a[60:61],v14 offset:23040
s_add_u32 s31,s30,65536
v_mfma_f32_16x16x32_bf16 v[168:171],a[68:71],a[136:139],v[168:171]
s_add_u32 m0,s35,s41
s_nop 0
buffer_load_dwordx4 v8,s[12:15],s32 offen lds
v_mfma_f32_16x16x32_bf16 v[172:175],a[64:67],a[124:127],v[172:175]
ds_read_b64_tr_b16 a[62:63],v14 offset:23936
v_mfma_f32_16x16x32_bf16 v[172:175],a[68:71],a[140:143],v[172:175]
v_mfma_f32_16x16x32_bf16 v[176:179],a[72:75],a[112:115],v[176:179]
ds_read_b64_tr_b16 a[64:65],v14 offset:7712
v_mfma_f32_16x16x32_bf16 v[176:179],a[76:79],a[128:131],v[176:179]
buffer_load_dwordx4 v9,s[12:15],s32 offen offset:896 lds
v_mfma_f32_16x16x32_bf16 v[180:183],a[72:75],a[116:119],v[180:183]
ds_read_b64_tr_b16 a[66:67],v14 offset:8608
v_mfma_f32_16x16x32_bf16 v[180:183],a[76:79],a[132:135],v[180:183]
v_mfma_f32_16x16x32_bf16 v[184:187],a[72:75],a[120:123],v[184:187]
ds_read_b64_tr_b16 a[68:69],v14 offset:23072
s_waitcnt vmcnt(27)
v_mfma_f32_16x16x32_bf16 v[184:187],a[76:79],a[136:139],v[184:187]
ds_read_b128 a[144:147],v12 offset:0
v_mfma_f32_16x16x32_bf16 v[188:191],a[72:75],a[124:127],v[188:191]
ds_read_b64_tr_b16 a[70:71],v14 offset:23968
v_mfma_f32_16x16x32_bf16 v[188:191],a[76:79],a[140:143],v[188:191]
buffer_load_dwordx4 v10,s[12:15],s32 offen offset:1920 lds
v_mfma_f32_16x16x32_bf16 v[192:195],a[80:83],a[112:115],v[192:195]
ds_read_b64_tr_b16 a[72:73],v14 offset:7744
v_mfma_f32_16x16x32_bf16 v[192:195],a[84:87],a[128:131],v[192:195]
ds_read_b128 a[160:163],v12 offset:1024
v_mfma_f32_16x16x32_bf16 v[196:199],a[80:83],a[116:119],v[196:199]
ds_read_b64_tr_b16 a[74:75],v14 offset:8640
v_mfma_f32_16x16x32_bf16 v[196:199],a[84:87],a[132:135],v[196:199]
buffer_load_dwordx4 v11,s[12:15],s32 offen offset:2816 lds
s_add_u32 s35,s35,15360
v_mfma_f32_16x16x32_bf16 v[200:203],a[80:83],a[120:123],v[200:203]
ds_read_b64_tr_b16 a[76:77],v14 offset:23104
v_mfma_f32_16x16x32_bf16 v[200:203],a[84:87],a[136:139],v[200:203]
s_cmp_eq_u32 s35,92160
s_cselect_b32 s35,0,s35
s_add_u32 s32,s32,229376
ds_read_b128 a[148:151],v12 offset:2048
v_mfma_f32_16x16x32_bf16 v[204:207],a[80:83],a[124:127],v[204:207]
ds_read_b64_tr_b16 a[78:79],v14 offset:24000
v_mfma_f32_16x16x32_bf16 v[204:207],a[84:87],a[140:143],v[204:207]
s_cmp_eq_u32 s32,7340032
s_cselect_b32 s32,0,s32
s_add_u32 m0,s35,s41
v_mfma_f32_16x16x32_bf16 v[208:211],a[88:91],a[112:115],v[208:211]
ds_read_b64_tr_b16 a[80:81],v14 offset:7776
v_mfma_f32_16x16x32_bf16 v[208:211],a[92:95],a[128:131],v[208:211]
ds_read_b128 a[164:167],v12 offset:3072
v_mfma_f32_16x16x32_bf16 v[212:215],a[88:91],a[116:119],v[212:215]
ds_read_b64_tr_b16 a[82:83],v14 offset:8672
v_mfma_f32_16x16x32_bf16 v[212:215],a[92:95],a[132:135],v[212:215]
buffer_load_dwordx4 v8,s[12:15],s32 offen lds
v_mfma_f32_16x16x32_bf16 v[216:219],a[88:91],a[120:123],v[216:219]
ds_read_b64_tr_b16 a[84:85],v14 offset:23136
v_mfma_f32_16x16x32_bf16 v[216:219],a[92:95],a[136:139],v[216:219]
ds_read_b128 a[152:155],v12 offset:4096
v_mfma_f32_16x16x32_bf16 v[220:223],a[88:91],a[124:127],v[220:223]
ds_read_b64_tr_b16 a[86:87],v14 offset:24032
v_mfma_f32_16x16x32_bf16 v[220:223],a[92:95],a[140:143],v[220:223]
buffer_load_dwordx4 v9,s[12:15],s32 offen offset:896 lds
v_mfma_f32_16x16x32_bf16 v[224:227],a[96:99],a[112:115],v[224:227]
ds_read_b64_tr_b16 a[88:89],v14 offset:7808
v_mfma_f32_16x16x32_bf16 v[224:227],a[100:103],a[128:131],v[224:227]
ds_read_b128 a[168:171],v12 offset:5120
v_mfma_f32_16x16x32_bf16 v[228:231],a[96:99],a[116:119],v[228:231]
ds_read_b64_tr_b16 a[90:91],v14 offset:8704
v_mfma_f32_16x16x32_bf16 v[228:231],a[100:103],a[132:135],v[228:231]
buffer_load_dwordx4 v10,s[12:15],s32 offen offset:1920 lds
v_mfma_f32_16x16x32_bf16 v[232:235],a[96:99],a[120:123],v[232:235]
ds_read_b64_tr_b16 a[92:93],v14 offset:23168
v_mfma_f32_16x16x32_bf16 v[232:235],a[100:103],a[136:139],v[232:235]
ds_read_b128 a[156:159],v12 offset:6144
v_mfma_f32_16x16x32_bf16 v[236:239],a[96:99],a[124:127],v[236:239]
ds_read_b64_tr_b16 a[94:95],v14 offset:24064
v_mfma_f32_16x16x32_bf16 v[236:239],a[100:103],a[140:143],v[236:239]
buffer_load_dwordx4 v11,s[12:15],s32 offen offset:2816 lds
s_add_u32 s35,s35,15360
v_mfma_f32_16x16x32_bf16 v[240:243],a[104:107],a[112:115],v[240:243]
ds_read_b64_tr_b16 a[96:97],v14 offset:7840
v_mfma_f32_16x16x32_bf16 v[240:243],a[108:111],a[128:131],v[240:243]
s_cmp_eq_u32 s35,92160
s_cselect_b32 s35,0,s35
s_add_u32 s32,s32,229376
ds_read_b128 a[172:175],v12 offset:7168
v_mfma_f32_16x16x32_bf16 v[244:247],a[104:107],a[116:119],v[244:247]
ds_read_b64_tr_b16 a[98:99],v14 offset:8736
v_mfma_f32_16x16x32_bf16 v[244:247],a[108:111],a[132:135],v[244:247]
s_cmp_eq_u32 s32,7340032
s_cselect_b32 s32,0,s32
v_mfma_f32_16x16x32_bf16 v[248:251],a[104:107],a[120:123],v[248:251]
ds_read_b64_tr_b16 a[100:101],v14 offset:23200
v_mfma_f32_16x16x32_bf16 v[248:251],a[108:111],a[136:139],v[248:251]
buffer_load_dword a252,v26,s[4:7],s33 offen
s_add_u32 s33,s33,512
v_mfma_f32_16x16x32_bf16 v[252:255],a[104:107],a[124:127],v[252:255]
ds_read_b64_tr_b16 a[102:103],v14 offset:24096
s_lshl_b32 s53,s87,8
v_mfma_f32_16x16x32_bf16 v[252:255],a[108:111],a[140:143],v[252:255]
s_add_u32 s53,s53,95518720
v_and_b32 v24,7,v2
v_lshlrev_b32 v24,2,v24
buffer_load_dword v25,v24,s[24:27],s53 offen sc1
s_waitcnt lgkmcnt(4)
v_mfma_f32_16x16x32_bf16 v[32:35],a[0:3],a[144:147],v[32:35]
ds_read_b64_tr_b16 a[104:105],v14 offset:7872
v_mfma_f32_16x16x32_bf16 v[32:35],a[4:7],a[160:163],v[32:35]
ds_read_b64_tr_b16 a[106:107],v14 offset:8768
v_mfma_f32_16x16x32_bf16 v[36:39],a[0:3],a[148:151],v[36:39]
ds_read_b64_tr_b16 a[108:109],v14 offset:23232
v_mfma_f32_16x16x32_bf16 v[36:39],a[4:7],a[164:167],v[36:39]
ds_read_b64_tr_b16 a[110:111],v14 offset:24128
v_mfma_f32_16x16x32_bf16 v[40:43],a[0:3],a[152:155],v[40:43]
v_add_u32 v14,s43,v14
v_mfma_f32_16x16x32_bf16 v[40:43],a[4:7],a[168:171],v[40:43]
v_xor_b32 v12,32768,v12
v_mfma_f32_16x16x32_bf16 v[44:47],a[0:3],a[156:159],v[44:47]
v_mfma_f32_16x16x32_bf16 v[44:47],a[4:7],a[172:175],v[44:47]
s_waitcnt vmcnt(18) lgkmcnt(0)
s_barrier
v_mfma_f32_16x16x32_bf16 v[48:51],a[8:11],a[144:147],v[48:51]
ds_read_b64_tr_b16 a[0:1],v14 offset:0
s_add_u32 m0,s34,s40
v_mfma_f32_16x16x32_bf16 v[48:51],a[12:15],a[160:163],v[48:51]
buffer_load_dwordx4 v4,s[8:11],s30 offen sc1 lds
s_add_u32 s37,s37,30720
v_mfma_f32_16x16x32_bf16 v[52:55],a[8:11],a[148:151],v[52:55]
ds_read_b64_tr_b16 a[2:3],v14 offset:896
v_mfma_f32_16x16x32_bf16 v[52:55],a[12:15],a[164:167],v[52:55]
s_cmp_eq_u32 s37,92160
s_cselect_b32 s43,s49,s48
s_cselect_b32 s37,0,s37
v_mfma_f32_16x16x32_bf16 v[56:59],a[8:11],a[152:155],v[56:59]
ds_read_b64_tr_b16 a[4:5],v14 offset:15360
v_accvgpr_read_b32 v16,a176
v_mfma_f32_16x16x32_bf16 v[56:59],a[12:15],a[168:171],v[56:59]
v_accvgpr_read_b32 v17,a177
v_accvgpr_read_b32 v18,a178
v_mfma_f32_16x16x32_bf16 v[60:63],a[8:11],a[156:159],v[60:63]
ds_read_b64_tr_b16 a[6:7],v14 offset:16256
v_accvgpr_read_b32 v19,a179
v_mfma_f32_16x16x32_bf16 v[60:63],a[12:15],a[172:175],v[60:63]
v_accvgpr_read_b32 v20,a180
v_accvgpr_read_b32 v21,a181
v_mfma_f32_16x16x32_bf16 v[64:67],a[16:19],a[144:147],v[64:67]
ds_read_b64_tr_b16 a[8:9],v14 offset:32
v_accvgpr_read_b32 v22,a182
v_mfma_f32_16x16x32_bf16 v[64:67],a[20:23],a[160:163],v[64:67]
v_accvgpr_read_b32 v23,a183
v_add_f32 v16,v16,v20
v_mfma_f32_16x16x32_bf16 v[68:71],a[16:19],a[148:151],v[68:71]
ds_read_b64_tr_b16 a[10:11],v14 offset:928
v_add_f32 v17,v17,v21
v_mfma_f32_16x16x32_bf16 v[68:71],a[20:23],a[164:167],v[68:71]
buffer_load_dwordx4 v4,s[8:11],s30 offen offset:1024 sc1 lds
v_add_f32 v18,v18,v22
v_mfma_f32_16x16x32_bf16 v[72:75],a[16:19],a[152:155],v[72:75]
ds_read_b64_tr_b16 a[12:13],v14 offset:15392
v_add_f32 v19,v19,v23
v_mfma_f32_16x16x32_bf16 v[72:75],a[20:23],a[168:171],v[72:75]
v_accvgpr_read_b32 v20,a184
v_accvgpr_read_b32 v21,a185
v_mfma_f32_16x16x32_bf16 v[76:79],a[16:19],a[156:159],v[76:79]
ds_read_b64_tr_b16 a[14:15],v14 offset:16288
v_accvgpr_read_b32 v22,a186
v_mfma_f32_16x16x32_bf16 v[76:79],a[20:23],a[172:175],v[76:79]
v_accvgpr_read_b32 v23,a187
v_add_f32 v16,v16,v20
v_mfma_f32_16x16x32_bf16 v[80:83],a[24:27],a[144:147],v[80:83]
ds_read_b64_tr_b16 a[16:17],v14 offset:64
v_add_f32 v17,v17,v21
v_mfma_f32_16x16x32_bf16 v[80:83],a[28:31],a[160:163],v[80:83]
v_add_f32 v18,v18,v22
v_add_f32 v19,v19,v23
v_mfma_f32_16x16x32_bf16 v[84:87],a[24:27],a[148:151],v[84:87]
ds_read_b64_tr_b16 a[18:19],v14 offset:960
v_accvgpr_read_b32 v20,a188
v_mfma_f32_16x16x32_bf16 v[84:87],a[28:31],a[164:167],v[84:87]
v_accvgpr_read_b32 v21,a189
v_accvgpr_read_b32 v22,a190
v_mfma_f32_16x16x32_bf16 v[88:91],a[24:27],a[152:155],v[88:91]
ds_read_b64_tr_b16 a[20:21],v14 offset:15424
v_accvgpr_read_b32 v23,a191
v_mfma_f32_16x16x32_bf16 v[88:91],a[28:31],a[168:171],v[88:91]
v_add_f32 v16,v16,v20
v_add_f32 v17,v17,v21
v_mfma_f32_16x16x32_bf16 v[92:95],a[24:27],a[156:159],v[92:95]
ds_read_b64_tr_b16 a[22:23],v14 offset:16320
v_add_f32 v18,v18,v22
v_mfma_f32_16x16x32_bf16 v[92:95],a[28:31],a[172:175],v[92:95]
buffer_load_dwordx4 v5,s[8:11],s30 offen offset:2048 sc1 lds
v_add_f32 v19,v19,v23
v_mfma_f32_16x16x32_bf16 v[96:99],a[32:35],a[144:147],v[96:99]
ds_read_b64_tr_b16 a[24:25],v14 offset:96
v_accvgpr_read_b32 v20,a192
v_mfma_f32_16x16x32_bf16 v[96:99],a[36:39],a[160:163],v[96:99]
v_accvgpr_read_b32 v21,a193
v_accvgpr_read_b32 v22,a194
v_mfma_f32_16x16x32_bf16 v[100:103],a[32:35],a[148:151],v[100:103]
ds_read_b64_tr_b16 a[26:27],v14 offset:992
v_accvgpr_read_b32 v23,a195
v_mfma_f32_16x16x32_bf16 v[100:103],a[36:39],a[164:167],v[100:103]
v_add_f32 v16,v16,v20
v_add_f32 v17,v17,v21
v_mfma_f32_16x16x32_bf16 v[104:107],a[32:35],a[152:155],v[104:107]
ds_read_b64_tr_b16 a[28:29],v14 offset:15456
v_add_f32 v18,v18,v22
v_mfma_f32_16x16x32_bf16 v[104:107],a[36:39],a[168:171],v[104:107]
v_add_f32 v19,v19,v23
v_accvgpr_read_b32 v20,a196
v_mfma_f32_16x16x32_bf16 v[108:111],a[32:35],a[156:159],v[108:111]
ds_read_b64_tr_b16 a[30:31],v14 offset:16352
v_accvgpr_read_b32 v21,a197
v_mfma_f32_16x16x32_bf16 v[108:111],a[36:39],a[172:175],v[108:111]
v_accvgpr_read_b32 v22,a198
v_accvgpr_read_b32 v23,a199
v_mfma_f32_16x16x32_bf16 v[112:115],a[40:43],a[144:147],v[112:115]
ds_read_b64_tr_b16 a[32:33],v14 offset:128
v_add_f32 v16,v16,v20
v_mfma_f32_16x16x32_bf16 v[112:115],a[44:47],a[160:163],v[112:115]
buffer_load_dwordx4 v5,s[8:11],s30 offen offset:3072 sc1 lds
s_add_u32 m0,s34,s52
v_mfma_f32_16x16x32_bf16 v[116:119],a[40:43],a[148:151],v[116:119]
ds_read_b64_tr_b16 a[34:35],v14 offset:1024
v_add_f32 v17,v17,v21
v_mfma_f32_16x16x32_bf16 v[116:119],a[44:47],a[164:167],v[116:119]
v_add_f32 v18,v18,v22
v_add_f32 v19,v19,v23
v_mfma_f32_16x16x32_bf16 v[120:123],a[40:43],a[152:155],v[120:123]
ds_read_b64_tr_b16 a[36:37],v14 offset:15488
v_accvgpr_read_b32 v20,a200
v_mfma_f32_16x16x32_bf16 v[120:123],a[44:47],a[168:171],v[120:123]
v_accvgpr_read_b32 v21,a201
v_accvgpr_read_b32 v22,a202
v_mfma_f32_16x16x32_bf16 v[124:127],a[40:43],a[156:159],v[124:127]
ds_read_b64_tr_b16 a[38:39],v14 offset:16384
v_accvgpr_read_b32 v23,a203
v_mfma_f32_16x16x32_bf16 v[124:127],a[44:47],a[172:175],v[124:127]
v_add_f32 v16,v16,v20
v_add_f32 v17,v17,v21
v_mfma_f32_16x16x32_bf16 v[128:131],a[48:51],a[144:147],v[128:131]
ds_read_b64_tr_b16 a[40:41],v14 offset:160
v_add_f32 v18,v18,v22
v_mfma_f32_16x16x32_bf16 v[128:131],a[52:55],a[160:163],v[128:131]
v_add_f32 v19,v19,v23
v_accvgpr_read_b32 v20,a204
v_mfma_f32_16x16x32_bf16 v[132:135],a[48:51],a[148:151],v[132:135]
ds_read_b64_tr_b16 a[42:43],v14 offset:1056
v_accvgpr_read_b32 v21,a205
v_mfma_f32_16x16x32_bf16 v[132:135],a[52:55],a[164:167],v[132:135]
v_accvgpr_read_b32 v22,a206
v_accvgpr_read_b32 v23,a207
v_mfma_f32_16x16x32_bf16 v[136:139],a[48:51],a[152:155],v[136:139]
ds_read_b64_tr_b16 a[44:45],v14 offset:15520
v_add_f32 v16,v16,v20
v_mfma_f32_16x16x32_bf16 v[136:139],a[52:55],a[168:171],v[136:139]
buffer_load_dwordx4 v4,s[8:11],s31 offen sc1 lds
v_add_f32 v17,v17,v21
v_mfma_f32_16x16x32_bf16 v[140:143],a[48:51],a[156:159],v[140:143]
ds_read_b64_tr_b16 a[46:47],v14 offset:16416
v_add_f32 v18,v18,v22
v_mfma_f32_16x16x32_bf16 v[140:143],a[52:55],a[172:175],v[140:143]
v_add_f32 v19,v19,v23
v_add_f32 v16,v16,v18
v_mfma_f32_16x16x32_bf16 v[144:147],a[56:59],a[144:147],v[144:147]
ds_read_b64_tr_b16 a[48:49],v14 offset:192
v_add_f32 v17,v17,v19
v_mfma_f32_16x16x32_bf16 v[144:147],a[60:63],a[160:163],v[144:147]
v_mfma_f32_16x16x32_bf16 v[148:151],a[56:59],a[148:151],v[148:151]
ds_read_b64_tr_b16 a[50:51],v14 offset:1088
v_mfma_f32_16x16x32_bf16 v[148:151],a[60:63],a[164:167],v[148:151]
v_mfma_f32_16x16x32_bf16 v[152:155],a[56:59],a[152:155],v[152:155]
ds_read_b64_tr_b16 a[52:53],v14 offset:15552
v_mfma_f32_16x16x32_bf16 v[152:155],a[60:63],a[168:171],v[152:155]
v_mfma_f32_16x16x32_bf16 v[156:159],a[56:59],a[156:159],v[156:159]
ds_read_b64_tr_b16 a[54:55],v14 offset:16448
v_mfma_f32_16x16x32_bf16 v[156:159],a[60:63],a[172:175],v[156:159]
buffer_load_dwordx4 v4,s[8:11],s31 offen offset:1024 sc1 lds
v_mfma_f32_16x16x32_bf16 v[160:163],a[64:67],a[144:147],v[160:163]
ds_read_b64_tr_b16 a[56:57],v14 offset:7680
v_mfma_f32_16x16x32_bf16 v[160:163],a[68:71],a[160:163],v[160:163]
v_mfma_f32_16x16x32_bf16 v[164:167],a[64:67],a[148:151],v[164:167]
ds_read_b64_tr_b16 a[58:59],v14 offset:8576
v_mfma_f32_16x16x32_bf16 v[164:167],a[68:71],a[164:167],v[164:167]
v_mfma_f32_16x16x32_bf16 v[168:171],a[64:67],a[152:155],v[168:171]
ds_read_b64_tr_b16 a[60:61],v14 offset:23040
v_mfma_f32_16x16x32_bf16 v[168:171],a[68:71],a[168:171],v[168:171]
v_mfma_f32_16x16x32_bf16 v[172:175],a[64:67],a[156:159],v[172:175]
ds_read_b64_tr_b16 a[62:63],v14 offset:23936
v_mfma_f32_16x16x32_bf16 v[172:175],a[68:71],a[172:175],v[172:175]
v_mfma_f32_16x16x32_bf16 v[176:179],a[72:75],a[144:147],v[176:179]
ds_read_b64_tr_b16 a[64:65],v14 offset:7712
v_mfma_f32_16x16x32_bf16 v[176:179],a[76:79],a[160:163],v[176:179]
v_mfma_f32_16x16x32_bf16 v[180:183],a[72:75],a[148:151],v[180:183]
ds_read_b64_tr_b16 a[66:67],v14 offset:8608
v_mfma_f32_16x16x32_bf16 v[180:183],a[76:79],a[164:167],v[180:183]
buffer_load_dwordx4 v5,s[8:11],s31 offen offset:2048 sc1 lds
v_mfma_f32_16x16x32_bf16 v[184:187],a[72:75],a[152:155],v[184:187]
ds_read_b64_tr_b16 a[68:69],v14 offset:23072
s_waitcnt vmcnt(17)
v_mfma_f32_16x16x32_bf16 v[184:187],a[76:79],a[168:171],v[184:187]
ds_read_b128 a[112:115],v12 offset:0
v_mfma_f32_16x16x32_bf16 v[188:191],a[72:75],a[156:159],v[188:191]
ds_read_b64_tr_b16 a[70:71],v14 offset:23968
v_mfma_f32_16x16x32_bf16 v[188:191],a[76:79],a[172:175],v[188:191]
v_mfma_f32_16x16x32_bf16 v[192:195],a[80:83],a[144:147],v[192:195]
ds_read_b64_tr_b16 a[72:73],v14 offset:7744
v_mfma_f32_16x16x32_bf16 v[192:195],a[84:87],a[160:163],v[192:195]
ds_read_b128 a[128:131],v12 offset:1024
v_mfma_f32_16x16x32_bf16 v[196:199],a[80:83],a[148:151],v[196:199]
ds_read_b64_tr_b16 a[74:75],v14 offset:8640
v_mfma_f32_16x16x32_bf16 v[196:199],a[84:87],a[164:167],v[196:199]
v_mfma_f32_16x16x32_bf16 v[200:203],a[80:83],a[152:155],v[200:203]
ds_read_b64_tr_b16 a[76:77],v14 offset:23104
v_mfma_f32_16x16x32_bf16 v[200:203],a[84:87],a[168:171],v[200:203]
ds_read_b128 a[116:119],v12 offset:2048
v_mfma_f32_16x16x32_bf16 v[204:207],a[80:83],a[156:159],v[204:207]
ds_read_b64_tr_b16 a[78:79],v14 offset:24000
v_mfma_f32_16x16x32_bf16 v[204:207],a[84:87],a[172:175],v[204:207]
buffer_load_dwordx4 v5,s[8:11],s31 offen offset:3072 sc1 lds
s_add_u32 s30,s30,2048
v_mfma_f32_16x16x32_bf16 v[208:211],a[88:91],a[144:147],v[208:211]
ds_read_b64_tr_b16 a[80:81],v14 offset:7776
s_and_b32 s30,s30,0x7fff
v_mfma_f32_16x16x32_bf16 v[208:211],a[92:95],a[160:163],v[208:211]
s_add_u32 s34,s34,32768
s_cmp_eq_u32 s34,65536
s_cselect_b32 s34,0,s34
ds_read_b128 a[132:135],v12 offset:3072
v_mfma_f32_16x16x32_bf16 v[212:215],a[88:91],a[148:151],v[212:215]
ds_read_b64_tr_b16 a[82:83],v14 offset:8672
s_add_u32 s31,s30,65536
v_mfma_f32_16x16x32_bf16 v[212:215],a[92:95],a[164:167],v[212:215]
v_mfma_f32_16x16x32_bf16 v[216:219],a[88:91],a[152:155],v[216:219]
ds_read_b64_tr_b16 a[84:85],v14 offset:23136
v_mfma_f32_16x16x32_bf16 v[216:219],a[92:95],a[168:171],v[216:219]
ds_read_b128 a[120:123],v12 offset:4096
v_mfma_f32_16x16x32_bf16 v[220:223],a[88:91],a[156:159],v[220:223]
ds_read_b64_tr_b16 a[86:87],v14 offset:24032
v_mfma_f32_16x16x32_bf16 v[220:223],a[92:95],a[172:175],v[220:223]
v_mfma_f32_16x16x32_bf16 v[224:227],a[96:99],a[144:147],v[224:227]
ds_read_b64_tr_b16 a[88:89],v14 offset:7808
v_mfma_f32_16x16x32_bf16 v[224:227],a[100:103],a[160:163],v[224:227]
ds_read_b128 a[136:139],v12 offset:5120
v_mfma_f32_16x16x32_bf16 v[228:231],a[96:99],a[148:151],v[228:231]
ds_read_b64_tr_b16 a[90:91],v14 offset:8704
v_mfma_f32_16x16x32_bf16 v[228:231],a[100:103],a[164:167],v[228:231]
buffer_load_dword a252,v26,s[4:7],s33 offen
s_add_u32 s33,s33,512
v_mfma_f32_16x16x32_bf16 v[232:235],a[96:99],a[152:155],v[232:235]
ds_read_b64_tr_b16 a[92:93],v14 offset:23168
v_mfma_f32_16x16x32_bf16 v[232:235],a[100:103],a[168:171],v[232:235]
ds_read_b128 a[124:127],v12 offset:6144
v_mfma_f32_16x16x32_bf16 v[236:239],a[96:99],a[156:159],v[236:239]
ds_read_b64_tr_b16 a[94:95],v14 offset:24064
v_mfma_f32_16x16x32_bf16 v[236:239],a[100:103],a[172:175],v[236:239]
v_mfma_f32_16x16x32_bf16 v[240:243],a[104:107],a[144:147],v[240:243]
ds_read_b64_tr_b16 a[96:97],v14 offset:7840
v_mfma_f32_16x16x32_bf16 v[240:243],a[108:111],a[160:163],v[240:243]
ds_read_b128 a[140:143],v12 offset:7168
v_mfma_f32_16x16x32_bf16 v[244:247],a[104:107],a[148:151],v[244:247]
ds_read_b64_tr_b16 a[98:99],v14 offset:8736
v_mfma_f32_16x16x32_bf16 v[244:247],a[108:111],a[164:167],v[244:247]
v_mfma_f32_16x16x32_bf16 v[248:251],a[104:107],a[152:155],v[248:251]
ds_read_b64_tr_b16 a[100:101],v14 offset:23200
v_mfma_f32_16x16x32_bf16 v[248:251],a[108:111],a[168:171],v[248:251]
v_mfma_f32_16x16x32_bf16 v[252:255],a[104:107],a[156:159],v[252:255]
ds_read_b64_tr_b16 a[102:103],v14 offset:24096
v_mfma_f32_16x16x32_bf16 v[252:255],a[108:111],a[172:175],v[252:255]
s_waitcnt lgkmcnt(4)
v_mfma_f32_16x16x32_bf16 v[32:35],a[0:3],a[112:115],v[32:35]
ds_read_b64_tr_b16 a[104:105],v14 offset:7872
v_mfma_f32_16x16x32_bf16 v[32:35],a[4:7],a[128:131],v[32:35]
ds_read_b64_tr_b16 a[106:107],v14 offset:8768
v_mfma_f32_16x16x32_bf16 v[36:39],a[0:3],a[116:119],v[36:39]
ds_read_b64_tr_b16 a[108:109],v14 offset:23232
v_mfma_f32_16x16x32_bf16 v[36:39],a[4:7],a[132:135],v[36:39]
ds_read_b64_tr_b16 a[110:111],v14 offset:24128
v_mfma_f32_16x16x32_bf16 v[40:43],a[0:3],a[120:123],v[40:43]
v_add_u32 v14,s43,v14
v_mfma_f32_16x16x32_bf16 v[40:43],a[4:7],a[136:139],v[40:43]
v_xor_b32 v12,32768,v12
v_mfma_f32_16x16x32_bf16 v[44:47],a[0:3],a[124:127],v[44:47]
v_mfma_f32_16x16x32_bf16 v[44:47],a[4:7],a[140:143],v[44:47]
s_waitcnt vmcnt(9) lgkmcnt(0)
s_barrier
s_mov_b32 s39,131072
Lspl170:
v_cmp_ne_u32 s[90:91],s94,v25
s_nop 1
s_cmp_eq_u64 s[90:91],0
s_cbranch_scc1 Lsok169
s_sleep 1
buffer_load_dword v25,v24,s[24:27],s53 offen sc1
s_waitcnt vmcnt(0)
s_sub_u32 s39,s39,1
s_cmp_lg_u32 s39,0
s_cbranch_scc1 Lspl170
Lsok169:
v_mfma_f32_16x16x32_bf16 v[48:51],a[8:11],a[112:115],v[48:51]
ds_read_b64_tr_b16 a[0:1],v14 offset:0
s_add_u32 s37,s37,30720
v_mfma_f32_16x16x32_bf16 v[48:51],a[12:15],a[128:131],v[48:51]
buffer_load_dword a252,v26,s[4:7],s33 offen
s_add_u32 s33,s33,512
v_mfma_f32_16x16x32_bf16 v[52:55],a[8:11],a[116:119],v[52:55]
ds_read_b64_tr_b16 a[2:3],v14 offset:896
v_mfma_f32_16x16x32_bf16 v[52:55],a[12:15],a[132:135],v[52:55]
s_cmp_eq_u32 s37,92160
s_cselect_b32 s43,s49,s48
s_cselect_b32 s37,0,s37
v_mfma_f32_16x16x32_bf16 v[56:59],a[8:11],a[120:123],v[56:59]
ds_read_b64_tr_b16 a[4:5],v14 offset:15360
v_mfma_f32_16x16x32_bf16 v[56:59],a[12:15],a[136:139],v[56:59]
v_mfma_f32_16x16x32_bf16 v[60:63],a[8:11],a[124:127],v[60:63]
ds_read_b64_tr_b16 a[6:7],v14 offset:16256
v_mfma_f32_16x16x32_bf16 v[60:63],a[12:15],a[140:143],v[60:63]
buffer_load_dwordx4 a[176:179],v28,s[24:27],s62 offen sc1
v_mfma_f32_16x16x32_bf16 v[64:67],a[16:19],a[112:115],v[64:67]
ds_read_b64_tr_b16 a[8:9],v14 offset:32
v_mfma_f32_16x16x32_bf16 v[64:67],a[20:23],a[128:131],v[64:67]
v_mfma_f32_16x16x32_bf16 v[68:71],a[16:19],a[116:119],v[68:71]
ds_read_b64_tr_b16 a[10:11],v14 offset:928
v_mfma_f32_16x16x32_bf16 v[68:71],a[20:23],a[132:135],v[68:71]
v_mfma_f32_16x16x32_bf16 v[72:75],a[16:19],a[120:123],v[72:75]
ds_read_b64_tr_b16 a[12:13],v14 offset:15392
v_mfma_f32_16x16x32_bf16 v[72:75],a[20:23],a[136:139],v[72:75]
buffer_load_dwordx4 a[180:183],v28,s[24:27],s62 offen offset:256 sc1
v_mfma_f32_16x16x32_bf16 v[76:79],a[16:19],a[124:127],v[76:79]
ds_read_b64_tr_b16 a[14:15],v14 offset:16288
v_mfma_f32_16x16x32_bf16 v[76:79],a[20:23],a[140:143],v[76:79]
v_mfma_f32_16x16x32_bf16 v[80:83],a[24:27],a[112:115],v[80:83]
ds_read_b64_tr_b16 a[16:17],v14 offset:64
v_mfma_f32_16x16x32_bf16 v[80:83],a[28:31],a[128:131],v[80:83]
v_mfma_f32_16x16x32_bf16 v[84:87],a[24:27],a[116:119],v[84:87]
ds_read_b64_tr_b16 a[18:19],v14 offset:960
v_mfma_f32_16x16x32_bf16 v[84:87],a[28:31],a[132:135],v[84:87]
v_mfma_f32_16x16x32_bf16 v[88:91],a[24:27],a[120:123],v[88:91]
ds_read_b64_tr_b16 a[20:21],v14 offset:15424
v_mfma_f32_16x16x32_bf16 v[88:91],a[28:31],a[136:139],v[88:91]
buffer_load_dwordx4 a[184:187],v28,s[24:27],s62 offen offset:512 sc1
v_mfma_f32_16x16x32_bf16 v[92:95],a[24:27],a[124:127],v[92:95]
ds_read_b64_tr_b16 a[22:23],v14 offset:16320
v_mfma_f32_16x16x32_bf16 v[92:95],a[28:31],a[140:143],v[92:95]
v_mfma_f32_16x16x32_bf16 v[96:99],a[32:35],a[112:115],v[96:99]
ds_read_b64_tr_b16 a[24:25],v14 offset:96
v_mfma_f32_16x16x32_bf16 v[96:99],a[36:39],a[128:131],v[96:99]
v_mfma_f32_16x16x32_bf16 v[100:103],a[32:35],a[116:119],v[100:103]
ds_read_b64_tr_b16 a[26:27],v14 offset:992
v_mfma_f32_16x16x32_bf16 v[100:103],a[36:39],a[132:135],v[100:103]
buffer_load_dwordx4 a[188:191],v28,s[24:27],s62 offen offset:768 sc1
v_mfma_f32_16x16x32_bf16 v[104:107],a[32:35],a[120:123],v[104:107]
ds_read_b64_tr_b16 a[28:29],v14 offset:15456
v_mfma_f32_16x16x32_bf16 v[104:107],a[36:39],a[136:139],v[104:107]
v_mfma_f32_16x16x32_bf16 v[108:111],a[32:35],a[124:127],v[108:111]
ds_read_b64_tr_b16 a[30:31],v14 offset:16352
v_mfma_f32_16x16x32_bf16 v[108:111],a[36:39],a[140:143],v[108:111]
v_mfma_f32_16x16x32_bf16 v[112:115],a[40:43],a[112:115],v[112:115]
ds_read_b64_tr_b16 a[32:33],v14 offset:128
v_mfma_f32_16x16x32_bf16 v[112:115],a[44:47],a[128:131],v[112:115]
buffer_load_dwordx4 a[192:195],v28,s[24:27],s62 offen offset:1024 sc1
v_mfma_f32_16x16x32_bf16 v[116:119],a[40:43],a[116:119],v[116:119]
ds_read_b64_tr_b16 a[34:35],v14 offset:1024
v_mfma_f32_16x16x32_bf16 v[116:119],a[44:47],a[132:135],v[116:119]
v_mfma_f32_16x16x32_bf16 v[120:123],a[40:43],a[120:123],v[120:123]
ds_read_b64_tr_b16 a[36:37],v14 offset:15488
v_mfma_f32_16x16x32_bf16 v[120:123],a[44:47],a[136:139],v[120:123]
v_mfma_f32_16x16x32_bf16 v[124:127],a[40:43],a[124:127],v[124:127]
ds_read_b64_tr_b16 a[38:39],v14 offset:16384
v_mfma_f32_16x16x32_bf16 v[124:127],a[44:47],a[140:143],v[124:127]
v_mfma_f32_16x16x32_bf16 v[128:131],a[48:51],a[112:115],v[128:131]
ds_read_b64_tr_b16 a[40:41],v14 offset:160
v_mfma_f32_16x16x32_bf16 v[128:131],a[52:55],a[128:131],v[128:131]
buffer_load_dwordx4 a[196:199],v28,s[24:27],s62 offen offset:1280 sc1
v_mfma_f32_16x16x32_bf16 v[132:135],a[48:51],a[116:119],v[132:135]
ds_read_b64_tr_b16 a[42:43],v14 offset:1056
v_mfma_f32_16x16x32_bf16 v[132:135],a[52:55],a[132:135],v[132:135]
v_mfma_f32_16x16x32_bf16 v[136:139],a[48:51],a[120:123],v[136:139]
ds_read_b64_tr_b16 a[44:45],v14 offset:15520
v_mfma_f32_16x16x32_bf16 v[136:139],a[52:55],a[136:139],v[136:139]
v_mfma_f32_16x16x32_bf16 v[140:143],a[48:51],a[124:127],v[140:143]
ds_read_b64_tr_b16 a[46:47],v14 offset:16416
v_mfma_f32_16x16x32_bf16 v[140:143],a[52:55],a[140:143],v[140:143]
buffer_load_dwordx4 a[200:203],v28,s[24:27],s62 offen offset:1536 sc1
v_mfma_f32_16x16x32_bf16 v[144:147],a[56:59],a[112:115],v[144:147]
ds_read_b64_tr_b16 a[48:49],v14 offset:192
v_mfma_f32_16x16x32_bf16 v[144:147],a[60:63],a[128:131],v[144:147]
v_mfma_f32_16x16x32_bf16 v[148:151],a[56:59],a[116:119],v[148:151]
ds_read_b64_tr_b16 a[50:51],v14 offset:1088
v_mfma_f32_16x16x32_bf16 v[148:151],a[60:63],a[132:135],v[148:151]
v_mfma_f32_16x16x32_bf16 v[152:155],a[56:59],a[120:123],v[152:155]
ds_read_b64_tr_b16 a[52:53],v14 offset:15552
v_mfma_f32_16x16x32_bf16 v[152:155],a[60:63],a[136:139],v[152:155]
buffer_load_dwordx4 a[204:207],v28,s[24:27],s63 offen sc1
v_mfma_f32_16x16x32_bf16 v[156:159],a[56:59],a[124:127],v[156:159]
ds_read_b64_tr_b16 a[54:55],v14 offset:16448
v_mfma_f32_16x16x32_bf16 v[156:159],a[60:63],a[140:143],v[156:159]
v_mfma_f32_16x16x32_bf16 v[160:163],a[64:67],a[112:115],v[160:163]
ds_read_b64_tr_b16 a[56:57],v14 offset:7680
v_mfma_f32_16x16x32_bf16 v[160:163],a[68:71],a[128:131],v[160:163]
v_mfma_f32_16x16x32_bf16 v[164:167],a[64:67],a[116:119],v[164:167]
ds_read_b64_tr_b16 a[58:59],v14 offset:8576
v_mfma_f32_16x16x32_bf16 v[164:167],a[68:71],a[132:135],v[164:167]
v_mfma_f32_16x16x32_bf16 v[168:171],a[64:67],a[120:123],v[168:171]
ds_read_b64_tr_b16 a[60:61],v14 offset:23040
v_mfma_f32_16x16x32_bf16 v[168:171],a[68:71],a[136:139],v[168:171]
buffer_load_dwordx4 a[208:211],v28,s[24:27],s63 offen offset:256 sc1
v_mfma_f32_16x16x32_bf16 v[172:175],a[64:67],a[124:127],v[172:175]
ds_read_b64_tr_b16 a[62:63],v14 offset:23936
v_mfma_f32_16x16x32_bf16 v[172:175],a[68:71],a[140:143],v[172:175]
v_mfma_f32_16x16x32_bf16 v[176:179],a[72:75],a[112:115],v[176:179]
ds_read_b64_tr_b16 a[64:65],v14 offset:7712
v_mfma_f32_16x16x32_bf16 v[176:179],a[76:79],a[128:131],v[176:179]
v_mfma_f32_16x16x32_bf16 v[180:183],a[72:75],a[116:119],v[180:183]
ds_read_b64_tr_b16 a[66:67],v14 offset:8608
v_mfma_f32_16x16x32_bf16 v[180:183],a[76:79],a[132:135],v[180:183]
buffer_load_dwordx4 a[212:215],v28,s[24:27],s63 offen offset:512 sc1
v_mfma_f32_16x16x32_bf16 v[184:187],a[72:75],a[120:123],v[184:187]
ds_read_b64_tr_b16 a[68:69],v14 offset:23072
s_waitcnt vmcnt(12)
v_mfma_f32_16x16x32_bf16 v[184:187],a[76:79],a[136:139],v[184:187]
ds_read_b128 a[144:147],v12 offset:0
v_mfma_f32_16x16x32_bf16 v[188:191],a[72:75],a[124:127],v[188:191]
ds_read_b64_tr_b16 a[70:71],v14 offset:23968
v_mfma_f32_16x16x32_bf16 v[188:191],a[76:79],a[140:143],v[188:191]
v_mfma_f32_16x16x32_bf16 v[192:195],a[80:83],a[112:115],v[192:195]
ds_read_b64_tr_b16 a[72:73],v14 offset:7744
v_mfma_f32_16x16x32_bf16 v[192:195],a[84:87],a[128:131],v[192:195]
ds_read_b128 a[160:163],v12 offset:1024
v_mfma_f32_16x16x32_bf16 v[196:199],a[80:83],a[116:119],v[196:199]
ds_read_b64_tr_b16 a[74:75],v14 offset:8640
v_mfma_f32_16x16x32_bf16 v[196:199],a[84:87],a[132:135],v[196:199]
buffer_load_dwordx4 a[216:219],v28,s[24:27],s63 offen offset:768 sc1
v_mfma_f32_16x16x32_bf16 v[200:203],a[80:83],a[120:123],v[200:203]
ds_read_b64_tr_b16 a[76:77],v14 offset:23104
v_mfma_f32_16x16x32_bf16 v[200:203],a[84:87],a[136:139],v[200:203]
ds_read_b128 a[148:151],v12 offset:2048
v_mfma_f32_16x16x32_bf16 v[204:207],a[80:83],a[124:127],v[204:207]
ds_read_b64_tr_b16 a[78:79],v14 offset:24000
v_mfma_f32_16x16x32_bf16 v[204:207],a[84:87],a[140:143],v[204:207]
v_mfma_f32_16x16x32_bf16 v[208:211],a[88:91],a[112:115],v[208:211]
ds_read_b64_tr_b16 a[80:81],v14 offset:7776
v_mfma_f32_16x16x32_bf16 v[208:211],a[92:95],a[128:131],v[208:211]
ds_read_b128 a[164:167],v12 offset:3072
v_mfma_f32_16x16x32_bf16 v[212:215],a[88:91],a[116:119],v[212:215]
ds_read_b64_tr_b16 a[82:83],v14 offset:8672
v_mfma_f32_16x16x32_bf16 v[212:215],a[92:95],a[132:135],v[212:215]
buffer_load_dwordx4 a[220:223],v28,s[24:27],s63 offen offset:1024 sc1
v_mfma_f32_16x16x32_bf16 v[216:219],a[88:91],a[120:123],v[216:219]
ds_read_b64_tr_b16 a[84:85],v14 offset:23136
v_mfma_f32_16x16x32_bf16 v[216:219],a[92:95],a[136:139],v[216:219]
ds_read_b128 a[152:155],v12 offset:4096
v_mfma_f32_16x16x32_bf16 v[220:223],a[88:91],a[124:127],v[220:223]
ds_read_b64_tr_b16 a[86:87],v14 offset:24032
v_mfma_f32_16x16x32_bf16 v[220:223],a[92:95],a[140:143],v[220:223]
buffer_load_dwordx4 a[224:227],v28,s[24:27],s63 offen offset:1280 sc1
v_mfma_f32_16x16x32_bf16 v[224:227],a[96:99],a[112:115],v[224:227]
ds_read_b64_tr_b16 a[88:89],v14 offset:7808
v_mfma_f32_16x16x32_bf16 v[224:227],a[100:103],a[128:131],v[224:227]
ds_read_b128 a[168:171],v12 offset:5120
v_mfma_f32_16x16x32_bf16 v[228:231],a[96:99],a[116:119],v[228:231]
ds_read_b64_tr_b16 a[90:91],v14 offset:8704
v_mfma_f32_16x16x32_bf16 v[228:231],a[100:103],a[132:135],v[228:231]
v_mfma_f32_16x16x32_bf16 v[232:235],a[96:99],a[120:123],v[232:235]
ds_read_b64_tr_b16 a[92:93],v14 offset:23168
v_mfma_f32_16x16x32_bf16 v[232:235],a[100:103],a[136:139],v[232:235]
ds_read_b128 a[156:159],v12 offset:6144
v_mfma_f32_16x16x32_bf16 v[236:239],a[96:99],a[124:127],v[236:239]
ds_read_b64_tr_b16 a[94:95],v14 offset:24064
v_mfma_f32_16x16x32_bf16 v[236:239],a[100:103],a[140:143],v[236:239]
buffer_load_dwordx4 a[228:231],v28,s[24:27],s63 offen offset:1536 sc1
v_mfma_f32_16x16x32_bf16 v[240:243],a[104:107],a[112:115],v[240:243]
ds_read_b64_tr_b16 a[96:97],v14 offset:7840
v_mfma_f32_16x16x32_bf16 v[240:243],a[108:111],a[128:131],v[240:243]
ds_read_b128 a[172:175],v12 offset:7168
v_mfma_f32_16x16x32_bf16 v[244:247],a[104:107],a[116:119],v[244:247]
ds_read_b64_tr_b16 a[98:99],v14 offset:8736
v_mfma_f32_16x16x32_bf16 v[244:247],a[108:111],a[132:135],v[244:247]
v_mfma_f32_16x16x32_bf16 v[248:251],a[104:107],a[120:123],v[248:251]
ds_read_b64_tr_b16 a[100:101],v14 offset:23200
v_mfma_f32_16x16x32_bf16 v[248:251],a[108:111],a[136:139],v[248:251]
v_mfma_f32_16x16x32_bf16 v[252:255],a[104:107],a[124:127],v[252:255]
ds_read_b64_tr_b16 a[102:103],v14 offset:24096
v_mfma_f32_16x16x32_bf16 v[252:255],a[108:111],a[140:143],v[252:255]
s_waitcnt lgkmcnt(4)
v_mfma_f32_16x16x32_bf16 v[32:35],a[0:3],a[144:147],v[32:35]
ds_read_b64_tr_b16 a[104:105],v14 offset:7872
v_mfma_f32_16x16x32_bf16 v[32:35],a[4:7],a[160:163],v[32:35]
ds_read_b64_tr_b16 a[106:107],v14 offset:8768
v_mfma_f32_16x16x32_bf16 v[36:39],a[0:3],a[148:151],v[36:39]
ds_read_b64_tr_b16 a[108:109],v14 offset:23232
v_mfma_f32_16x16x32_bf16 v[36:39],a[4:7],a[164:167],v[36:39]
ds_read_b64_tr_b16 a[110:111],v14 offset:24128
v_mfma_f32_16x16x32_bf16 v[40:43],a[0:3],a[152:155],v[40:43]
v_mfma_f32_16x16x32_bf16 v[40:43],a[4:7],a[168:171],v[40:43]
v_mfma_f32_16x16x32_bf16 v[44:47],a[0:3],a[156:159],v[44:47]
v_mfma_f32_16x16x32_bf16 v[44:47],a[4:7],a[172:175],v[44:47]
s_waitcnt lgkmcnt(0)
v_mfma_f32_16x16x32_bf16 v[48:51],a[8:11],a[144:147],v[48:51]
v_mul_f32 v16,s46,v16
v_mul_f32 v17,s46,v17
v_mfma_f32_16x16x32_bf16 v[48:51],a[12:15],a[160:163],v[48:51]
v_fma_f32 v17,-v16,v16,v17
v_max_f32 v17,0,v17
v_mfma_f32_16x16x32_bf16 v[52:55],a[8:11],a[148:151],v[52:55]
v_cvt_pk_bf16_f32 v18,v17,v17
v_cvt_pk_bf16_f32 v8,-v16,-v16
v_mfma_f32_16x16x32_bf16 v[52:55],a[12:15],a[164:167],v[52:55]
v_and_b32 v18,0xffff0000,v18
v_add_f32 v18,s47,v18
v_mfma_f32_16x16x32_bf16 v[56:59],a[8:11],a[152:155],v[56:59]
v_cvt_pk_bf16_f32 v18,v18,v18
v_mov_b32 v9,v8
v_mfma_f32_16x16x32_bf16 v[56:59],a[12:15],a[168:171],v[56:59]
v_and_b32 v18,0xffff0000,v18
v_mfma_f32_16x16x32_bf16 v[60:63],a[8:11],a[156:159],v[60:63]
v_sqrt_f32 v18,v18
v_mfma_f32_16x16x32_bf16 v[60:63],a[12:15],a[172:175],v[60:63]
v_permlane16_swap_b32 v8,v9
v_mfma_f32_16x16x32_bf16 v[64:67],a[16:19],a[144:147],v[64:67]
v_cvt_pk_bf16_f32 v18,v18,v18
v_and_b32 v24,0xffff0000,v18
v_mfma_f32_16x16x32_bf16 v[64:67],a[20:23],a[160:163],v[64:67]
v_mov_b32 v10,v8
v_mov_b32 v11,v9
v_mfma_f32_16x16x32_bf16 v[68:71],a[16:19],a[148:151],v[68:71]
v_mov_b32 v25,v24
v_mfma_f32_16x16x32_bf16 v[68:71],a[20:23],a[164:167],v[68:71]
v_permlane32_swap_b32 v8,v10
v_mfma_f32_16x16x32_bf16 v[72:75],a[16:19],a[152:155],v[72:75]
v_permlane32_swap_b32 v9,v11
v_mfma_f32_16x16x32_bf16 v[72:75],a[20:23],a[168:171],v[72:75]
v_permlane16_swap_b32 v24,v25
v_mfma_f32_16x16x32_bf16 v[76:79],a[16:19],a[156:159],v[76:79]
v_mov_b32 v26,v24
v_mov_b32 v27,v25
v_mfma_f32_16x16x32_bf16 v[76:79],a[20:23],a[172:175],v[76:79]
s_nop 0
v_mfma_f32_16x16x32_bf16 v[80:83],a[24:27],a[144:147],v[80:83]
v_permlane32_swap_b32 v24,v26
v_mfma_f32_16x16x32_bf16 v[80:83],a[28:31],a[160:163],v[80:83]
v_permlane32_swap_b32 v25,v27
v_mfma_f32_16x16x32_bf16 v[84:87],a[24:27],a[148:151],v[84:87]
v_rcp_f32 v16,v24
v_mfma_f32_16x16x32_bf16 v[84:87],a[28:31],a[164:167],v[84:87]
v_rcp_f32 v17,v25
v_mfma_f32_16x16x32_bf16 v[88:91],a[24:27],a[152:155],v[88:91]
v_rcp_f32 v18,v26
v_mfma_f32_16x16x32_bf16 v[88:91],a[28:31],a[168:171],v[88:91]
v_rcp_f32 v19,v27
v_mfma_f32_16x16x32_bf16 v[92:95],a[24:27],a[156:159],v[92:95]
v_cndmask_b32 v8,0,v8,vcc
v_cndmask_b32 v9,0,v9,vcc
v_mfma_f32_16x16x32_bf16 v[92:95],a[28:31],a[172:175],v[92:95]
v_cndmask_b32 v10,0,v10,vcc
v_cndmask_b32 v11,0,v11,vcc
v_mfma_f32_16x16x32_bf16 v[96:99],a[32:35],a[144:147],v[96:99]
v_mul_f32 v20,v16,v16
v_mul_f32 v21,v17,v17
v_mfma_f32_16x16x32_bf16 v[96:99],a[36:39],a[160:163],v[96:99]
v_mul_f32 v22,v18,v18
v_mul_f32 v23,v19,v19
v_mfma_f32_16x16x32_bf16 v[100:103],a[32:35],a[148:151],v[100:103]
v_mul_f32 v24,v24,v24
v_mul_f32 v25,v25,v25
v_mfma_f32_16x16x32_bf16 v[100:103],a[36:39],a[164:167],v[100:103]
v_mul_f32 v26,v26,v26
v_mul_f32 v27,v27,v27
v_mfma_f32_16x16x32_bf16 v[104:107],a[32:35],a[152:155],v[104:107]
v_mul_f32 v20,v20,v16
v_mul_f32 v21,v21,v17
v_mfma_f32_16x16x32_bf16 v[104:107],a[36:39],a[168:171],v[104:107]
v_mul_f32 v22,v22,v18
v_mul_f32 v23,v23,v19
v_mfma_f32_16x16x32_bf16 v[108:111],a[32:35],a[156:159],v[108:111]
v_mul_f32 v16,s44,v16
v_mul_f32 v17,s44,v17
v_mfma_f32_16x16x32_bf16 v[108:111],a[36:39],a[172:175],v[108:111]
v_mul_f32 v18,s44,v18
v_mul_f32 v19,s44,v19
v_mfma_f32_16x16x32_bf16 v[112:115],a[40:43],a[144:147],v[112:115]
v_mul_f32 v20,s45,v20
v_mul_f32 v21,s45,v21
v_mfma_f32_16x16x32_bf16 v[112:115],a[44:47],a[160:163],v[112:115]
v_mul_f32 v22,s45,v22
v_mul_f32 v23,s45,v23
v_mfma_f32_16x16x32_bf16 v[116:119],a[40:43],a[148:151],v[116:119]
v_accvgpr_write_b32 a232,v8
v_accvgpr_write_b32 a233,v8
v_mfma_f32_16x16x32_bf16 v[116:119],a[44:47],a[164:167],v[116:119]
v_accvgpr_write_b32 a234,v8
v_accvgpr_write_b32 a235,v8
v_mfma_f32_16x16x32_bf16 v[120:123],a[40:43],a[152:155],v[120:123]
v_accvgpr_write_b32 a236,v9
v_accvgpr_write_b32 a237,v9
v_mfma_f32_16x16x32_bf16 v[120:123],a[44:47],a[168:171],v[120:123]
v_accvgpr_write_b32 a238,v9
v_accvgpr_write_b32 a239,v9
v_mfma_f32_16x16x32_bf16 v[124:127],a[40:43],a[156:159],v[124:127]
v_accvgpr_write_b32 a240,v10
v_accvgpr_write_b32 a241,v10
v_mfma_f32_16x16x32_bf16 v[124:127],a[44:47],a[172:175],v[124:127]
v_accvgpr_write_b32 a242,v10
v_accvgpr_write_b32 a243,v10
v_mfma_f32_16x16x32_bf16 v[128:131],a[48:51],a[144:147],v[128:131]
v_accvgpr_write_b32 a244,v11
v_accvgpr_write_b32 a245,v11
v_mfma_f32_16x16x32_bf16 v[128:131],a[52:55],a[160:163],v[128:131]
v_accvgpr_write_b32 a246,v11
v_accvgpr_write_b32 a247,v11
v_mfma_f32_16x16x32_bf16 v[132:135],a[48:51],a[148:151],v[132:135]
v_mfma_f32_16x16x32_bf16 v[132:135],a[52:55],a[164:167],v[132:135]
v_mfma_f32_16x16x32_bf16 v[136:139],a[48:51],a[152:155],v[136:139]
v_mfma_f32_16x16x32_bf16 v[136:139],a[52:55],a[168:171],v[136:139]
v_mfma_f32_16x16x32_bf16 v[140:143],a[48:51],a[156:159],v[140:143]
v_mfma_f32_16x16x32_bf16 v[140:143],a[52:55],a[172:175],v[140:143]
v_mfma_f32_16x16x32_bf16 v[144:147],a[56:59],a[144:147],v[144:147]
v_mfma_f32_16x16x32_bf16 v[144:147],a[60:63],a[160:163],v[144:147]
v_mfma_f32_16x16x32_bf16 v[148:151],a[56:59],a[148:151],v[148:151]
v_mfma_f32_16x16x32_bf16 v[148:151],a[60:63],a[164:167],v[148:151]
v_mfma_f32_16x16x32_bf16 v[152:155],a[56:59],a[152:155],v[152:155]
v_mfma_f32_16x16x32_bf16 v[152:155],a[60:63],a[168:171],v[152:155]
v_mfma_f32_16x16x32_bf16 v[156:159],a[56:59],a[156:159],v[156:159]
v_mfma_f32_16x16x32_bf16 v[156:159],a[60:63],a[172:175],v[156:159]
v_mfma_f32_16x16x32_bf16 v[160:163],a[64:67],a[144:147],v[160:163]
v_mfma_f32_16x16x32_bf16 v[160:163],a[68:71],a[160:163],v[160:163]
v_mfma_f32_16x16x32_bf16 v[164:167],a[64:67],a[148:151],v[164:167]
v_mfma_f32_16x16x32_bf16 v[164:167],a[68:71],a[164:167],v[164:167]
v_mfma_f32_16x16x32_bf16 v[168:171],a[64:67],a[152:155],v[168:171]
v_mfma_f32_16x16x32_bf16 v[168:171],a[68:71],a[168:171],v[168:171]
v_mfma_f32_16x16x32_bf16 v[172:175],a[64:67],a[156:159],v[172:175]
v_mfma_f32_16x16x32_bf16 v[172:175],a[68:71],a[172:175],v[172:175]
v_mfma_f32_16x16x32_bf16 v[176:179],a[72:75],a[144:147],v[176:179]
v_mfma_f32_16x16x32_bf16 v[176:179],a[76:79],a[160:163],v[176:179]
v_mfma_f32_16x16x32_bf16 v[180:183],a[72:75],a[148:151],v[180:183]
v_mfma_f32_16x16x32_bf16 v[180:183],a[76:79],a[164:167],v[180:183]
v_mfma_f32_16x16x32_bf16 v[184:187],a[72:75],a[152:155],v[184:187]
v_mfma_f32_16x16x32_bf16 v[184:187],a[76:79],a[168:171],v[184:187]
v_mfma_f32_16x16x32_bf16 v[188:191],a[72:75],a[156:159],v[188:191]
v_mfma_f32_16x16x32_bf16 v[188:191],a[76:79],a[172:175],v[188:191]
v_mfma_f32_16x16x32_bf16 v[192:195],a[80:83],a[144:147],v[192:195]
v_mfma_f32_16x16x32_bf16 v[192:195],a[84:87],a[160:163],v[192:195]
v_mfma_f32_16x16x32_bf16 v[196:199],a[80:83],a[148:151],v[196:199]
v_mfma_f32_16x16x32_bf16 v[196:199],a[84:87],a[164:167],v[196:199]
v_mfma_f32_16x16x32_bf16 v[200:203],a[80:83],a[152:155],v[200:203]
v_mfma_f32_16x16x32_bf16 v[200:203],a[84:87],a[168:171],v[200:203]
v_mfma_f32_16x16x32_bf16 v[204:207],a[80:83],a[156:159],v[204:207]
v_mfma_f32_16x16x32_bf16 v[204:207],a[84:87],a[172:175],v[204:207]
v_mfma_f32_16x16x32_bf16 v[208:211],a[88:91],a[144:147],v[208:211]
v_mfma_f32_16x16x32_bf16 v[208:211],a[92:95],a[160:163],v[208:211]
v_mfma_f32_16x16x32_bf16 v[212:215],a[88:91],a[148:151],v[212:215]
v_mfma_f32_16x16x32_bf16 v[212:215],a[92:95],a[164:167],v[212:215]
v_mfma_f32_16x16x32_bf16 v[216:219],a[88:91],a[152:155],v[216:219]
v_mfma_f32_16x16x32_bf16 v[216:219],a[92:95],a[168:171],v[216:219]
v_mfma_f32_16x16x32_bf16 v[220:223],a[88:91],a[156:159],v[220:223]
v_mfma_f32_16x16x32_bf16 v[220:223],a[92:95],a[172:175],v[220:223]
v_mfma_f32_16x16x32_bf16 v[224:227],a[96:99],a[144:147],v[224:227]
v_mfma_f32_16x16x32_bf16 v[224:227],a[100:103],a[160:163],v[224:227]
v_mfma_f32_16x16x32_bf16 v[228:231],a[96:99],a[148:151],v[228:231]
v_mfma_f32_16x16x32_bf16 v[228:231],a[100:103],a[164:167],v[228:231]
v_mfma_f32_16x16x32_bf16 v[232:235],a[96:99],a[152:155],v[232:235]
v_mfma_f32_16x16x32_bf16 v[232:235],a[100:103],a[168:171],v[232:235]
v_mfma_f32_16x16x32_bf16 v[236:239],a[96:99],a[156:159],v[236:239]
v_mfma_f32_16x16x32_bf16 v[236:239],a[100:103],a[172:175],v[236:239]
v_mfma_f32_16x16x32_bf16 v[240:243],a[104:107],a[144:147],v[240:243]
v_mfma_f32_16x16x32_bf16 v[240:243],a[108:111],a[160:163],v[240:243]
v_mfma_f32_16x16x32_bf16 v[244:247],a[104:107],a[148:151],v[244:247]
v_mfma_f32_16x16x32_bf16 v[244:247],a[108:111],a[164:167],v[244:247]
v_mfma_f32_16x16x32_bf16 v[248:251],a[104:107],a[152:155],v[248:251]
v_mfma_f32_16x16x32_bf16 v[248:251],a[108:111],a[168:171],v[248:251]
v_mfma_f32_16x16x32_bf16 v[252:255],a[104:107],a[156:159],v[252:255]
v_mfma_f32_16x16x32_bf16 v[252:255],a[108:111],a[172:175],v[252:255]
s_branch Lcosk172
Lco51:
v_mfma_f32_16x16x32_bf16 a[176:179],a[248:251],a[0:3],0
v_mfma_f32_16x16x32_bf16 a[176:179],a[248:251],a[4:7],a[176:179]
s_branch Lcb52
Lco53:
s_nop 6
v_mfma_f32_16x16x32_bf16 a[176:179],a[248:251],a[8:11],0
v_mfma_f32_16x16x32_bf16 a[176:179],a[248:251],a[12:15],a[176:179]
s_branch Lcb54
Lco55:
s_nop 6
v_mfma_f32_16x16x32_bf16 a[176:179],a[248:251],a[16:19],0
v_mfma_f32_16x16x32_bf16 a[176:179],a[248:251],a[20:23],a[176:179]
s_branch Lcb56
Lco57:
s_nop 6
v_mfma_f32_16x16x32_bf16 a[176:179],a[248:251],a[24:27],0
v_mfma_f32_16x16x32_bf16 a[176:179],a[248:251],a[28:31],a[176:179]
s_branch Lcb58
Lco59:
v_mfma_f32_16x16x32_bf16 a[180:183],a[248:251],a[32:35],0
v_mfma_f32_16x16x32_bf16 a[180:183],a[248:251],a[36:39],a[180:183]
s_branch Lcb60
Lco61:
s_nop 6
v_mfma_f32_16x16x32_bf16 a[180:183],a[248:251],a[40:43],0
v_mfma_f32_16x16x32_bf16 a[180:183],a[248:251],a[44:47],a[180:183]
s_branch Lcb62
Lco63:
s_nop 6
v_mfma_f32_16x16x32_bf16 a[180:183],a[248:251],a[48:51],0
v_mfma_f32_16x16x32_bf16 a[180:183],a[248:251],a[52:55],a[180:183]
s_branch Lcb64
Lco65:
s_nop 6
v_mfma_f32_16x16x32_bf16 a[180:183],a[248:251],a[56:59],0
v_mfma_f32_16x16x32_bf16 a[180:183],a[248:251],a[60:63],a[180:183]
s_branch Lcb66
Lco67:
v_mfma_f32_16x16x32_bf16 a[184:187],a[248:251],a[64:67],0
v_mfma_f32_16x16x32_bf16 a[184:187],a[248:251],a[68:71],a[184:187]
s_branch Lcb68
Lco69:
s_nop 6
v_mfma_f32_16x16x32_bf16 a[184:187],a[248:251],a[72:75],0
v_mfma_f32_16x16x32_bf16 a[184:187],a[248:251],a[76:79],a[184:187]
s_branch Lcb70
Lco71:
s_nop 6
v_mfma_f32_16x16x32_bf16 a[184:187],a[248:251],a[80:83],0
v_mfma_f32_16x16x32_bf16 a[184:187],a[248:251],a[84:87],a[184:187]
s_branch Lcb72
Lco73:
s_nop 6
v_mfma_f32_16x16x32_bf16 a[184:187],a[248:251],a[88:91],0
v_mfma_f32_16x16x32_bf16 a[184:187],a[248:251],a[92:95],a[184:187]
s_branch Lcb74
Lco75:
v_mfma_f32_16x16x32_bf16 a[188:191],a[248:251],a[96:99],0
v_mfma_f32_16x16x32_bf16 a[188:191],a[248:251],a[100:103],a[188:191]
s_branch Lcb76
Lco77:
s_nop 6
v_mfma_f32_16x16x32_bf16 a[188:191],a[248:251],a[104:107],0
v_mfma_f32_16x16x32_bf16 a[188:191],a[248:251],a[108:111],a[188:191]
s_branch Lcb78
Lco79:
v_mfma_f32_16x16x32_bf16 a[176:179],a[248:251],a[0:3],0
v_mfma_f32_16x16x32_bf16 a[176:179],a[248:251],a[4:7],a[176:179]
s_branch Lcb80
Lco81:
s_nop 6
v_mfma_f32_16x16x32_bf16 a[176:179],a[248:251],a[8:11],0
v_mfma_f32_16x16x32_bf16 a[176:179],a[248:251],a[12:15],a[176:179]
s_branch Lcb82
Lco83:
s_nop 6
v_mfma_f32_16x16x32_bf16 a[176:179],a[248:251],a[16:19],0
v_mfma_f32_16x16x32_bf16 a[176:179],a[248:251],a[20:23],a[176:179]
s_branch Lcb84
Lco85:
s_nop 6
v_mfma_f32_16x16x32_bf16 a[176:179],a[248:251],a[24:27],0
v_mfma_f32_16x16x32_bf16 a[176:179],a[248:251],a[28:31],a[176:179]
s_branch Lcb86
Lco87:
v_mfma_f32_16x16x32_bf16 a[180:183],a[248:251],a[32:35],0
v_mfma_f32_16x16x32_bf16 a[180:183],a[248:251],a[36:39],a[180:183]
s_branch Lcb88
Lco89:
s_nop 6
v_mfma_f32_16x16x32_bf16 a[180:183],a[248:251],a[40:43],0
v_mfma_f32_16x16x32_bf16 a[180:183],a[248:251],a[44:47],a[180:183]
s_branch Lcb90
Lco91:
s_nop 6
v_mfma_f32_16x16x32_bf16 a[180:183],a[248:251],a[48:51],0
v_mfma_f32_16x16x32_bf16 a[180:183],a[248:251],a[52:55],a[180:183]
s_branch Lcb92
Lco93:
s_nop 6
v_mfma_f32_16x16x32_bf16 a[180:183],a[248:251],a[56:59],0
v_mfma_f32_16x16x32_bf16 a[180:183],a[248:251],a[60:63],a[180:183]
s_branch Lcb94
Lco95:
v_mfma_f32_16x16x32_bf16 a[184:187],a[248:251],a[64:67],0
v_mfma_f32_16x16x32_bf16 a[184:187],a[248:251],a[68:71],a[184:187]
s_branch Lcb96
Lco97:
s_nop 6
v_mfma_f32_16x16x32_bf16 a[184:187],a[248:251],a[72:75],0
v_mfma_f32_16x16x32_bf16 a[184:187],a[248:251],a[76:79],a[184:187]
s_branch Lcb98
Lco99:
s_nop 6
v_mfma_f32_16x16x32_bf16 a[184:187],a[248:251],a[80:83],0
v_mfma_f32_16x16x32_bf16 a[184:187],a[248:251],a[84:87],a[184:187]
s_branch Lcb100
Lco101:
s_nop 6
v_mfma_f32_16x16x32_bf16 a[184:187],a[248:251],a[88:91],0
v_mfma_f32_16x16x32_bf16 a[184:187],a[248:251],a[92:95],a[184:187]
s_branch Lcb102
Lco103:
v_mfma_f32_16x16x32_bf16 a[188:191],a[248:251],a[96:99],0
v_mfma_f32_16x16x32_bf16 a[188:191],a[248:251],a[100:103],a[188:191]
s_branch Lcb104
Lco105:
s_nop 6
v_mfma_f32_16x16x32_bf16 a[188:191],a[248:251],a[104:107],0
v_mfma_f32_16x16x32_bf16 a[188:191],a[248:251],a[108:111],a[188:191]
s_branch Lcb106
Lco107:
v_mfma_f32_16x16x32_bf16 a[176:179],a[248:251],a[0:3],a[176:179]
v_mfma_f32_16x16x32_bf16 a[176:179],a[248:251],a[4:7],a[176:179]
s_branch Lcb108
Lco109:
v_mfma_f32_16x16x32_bf16 a[176:179],a[248:251],a[8:11],a[176:179]
v_mfma_f32_16x16x32_bf16 a[176:179],a[248:251],a[12:15],a[176:179]
s_branch Lcb110
Lco111:
v_mfma_f32_16x16x32_bf16 a[176:179],a[248:251],a[16:19],a[176:179]
v_mfma_f32_16x16x32_bf16 a[176:179],a[248:251],a[20:23],a[176:179]
s_branch Lcb112
Lco113:
v_mfma_f32_16x16x32_bf16 a[176:179],a[248:251],a[24:27],a[176:179]
v_mfma_f32_16x16x32_bf16 a[176:179],a[248:251],a[28:31],a[176:179]
s_branch Lcb114
Lco115:
v_mfma_f32_16x16x32_bf16 a[180:183],a[248:251],a[32:35],a[180:183]
v_mfma_f32_16x16x32_bf16 a[180:183],a[248:251],a[36:39],a[180:183]
s_branch Lcb116
Lco117:
v_mfma_f32_16x16x32_bf16 a[180:183],a[248:251],a[40:43],a[180:183]
v_mfma_f32_16x16x32_bf16 a[180:183],a[248:251],a[44:47],a[180:183]
s_branch Lcb118
Lco119:
v_mfma_f32_16x16x32_bf16 a[180:183],a[248:251],a[48:51],a[180:183]
v_mfma_f32_16x16x32_bf16 a[180:183],a[248:251],a[52:55],a[180:183]
s_branch Lcb120
Lco121:
v_mfma_f32_16x16x32_bf16 a[180:183],a[248:251],a[56:59],a[180:183]
v_mfma_f32_16x16x32_bf16 a[180:183],a[248:251],a[60:63],a[180:183]
s_branch Lcb122
Lco123:
v_mfma_f32_16x16x32_bf16 a[184:187],a[248:251],a[64:67],a[184:187]
v_mfma_f32_16x16x32_bf16 a[184:187],a[248:251],a[68:71],a[184:187]
s_branch Lcb124
Lco125:
v_mfma_f32_16x16x32_bf16 a[184:187],a[248:251],a[72:75],a[184:187]
v_mfma_f32_16x16x32_bf16 a[184:187],a[248:251],a[76:79],a[184:187]
s_branch Lcb126
Lco127:
v_mfma_f32_16x16x32_bf16 a[184:187],a[248:251],a[80:83],a[184:187]
v_mfma_f32_16x16x32_bf16 a[184:187],a[248:251],a[84:87],a[184:187]
s_branch Lcb128
Lco129:
v_mfma_f32_16x16x32_bf16 a[184:187],a[248:251],a[88:91],a[184:187]
v_mfma_f32_16x16x32_bf16 a[184:187],a[248:251],a[92:95],a[184:187]
s_branch Lcb130
Lco131:
v_mfma_f32_16x16x32_bf16 a[188:191],a[248:251],a[96:99],a[188:191]
v_mfma_f32_16x16x32_bf16 a[188:191],a[248:251],a[100:103],a[188:191]
s_branch Lcb132
Lco133:
v_mfma_f32_16x16x32_bf16 a[188:191],a[248:251],a[104:107],a[188:191]
v_mfma_f32_16x16x32_bf16 a[188:191],a[248:251],a[108:111],a[188:191]
s_branch Lcb134
Lco135:
v_mfma_f32_16x16x32_bf16 a[176:179],a[248:251],a[0:3],a[176:179]
v_mfma_f32_16x16x32_bf16 a[176:179],a[248:251],a[4:7],a[176:179]
s_branch Lcb136
Lco137:
v_mfma_f32_16x16x32_bf16 a[176:179],a[248:251],a[8:11],a[176:179]
v_mfma_f32_16x16x32_bf16 a[176:179],a[248:251],a[12:15],a[176:179]
s_branch Lcb138
Lco139:
v_mfma_f32_16x16x32_bf16 a[176:179],a[248:251],a[16:19],a[176:179]
v_mfma_f32_16x16x32_bf16 a[176:179],a[248:251],a[20:23],a[176:179]
s_branch Lcb140
Lco141:
v_mfma_f32_16x16x32_bf16 a[176:179],a[248:251],a[24:27],a[176:179]
v_mfma_f32_16x16x32_bf16 a[176:179],a[248:251],a[28:31],a[176:179]
s_branch Lcb142
Lco143:
v_mfma_f32_16x16x32_bf16 a[180:183],a[248:251],a[32:35],a[180:183]
v_mfma_f32_16x16x32_bf16 a[180:183],a[248:251],a[36:39],a[180:183]
s_branch Lcb144
Lco145:
v_mfma_f32_16x16x32_bf16 a[180:183],a[248:251],a[40:43],a[180:183]
v_mfma_f32_16x16x32_bf16 a[180:183],a[248:251],a[44:47],a[180:183]
s_branch Lcb146
Lco147:
v_mfma_f32_16x16x32_bf16 a[180:183],a[248:251],a[48:51],a[180:183]
v_mfma_f32_16x16x32_bf16 a[180:183],a[248:251],a[52:55],a[180:183]
s_branch Lcb148
Lco149:
v_mfma_f32_16x16x32_bf16 a[180:183],a[248:251],a[56:59],a[180:183]
v_mfma_f32_16x16x32_bf16 a[180:183],a[248:251],a[60:63],a[180:183]
s_branch Lcb150
Lco151:
v_mfma_f32_16x16x32_bf16 a[184:187],a[248:251],a[64:67],a[184:187]
v_mfma_f32_16x16x32_bf16 a[184:187],a[248:251],a[68:71],a[184:187]
s_branch Lcb152
Lco153:
v_mfma_f32_16x16x32_bf16 a[184:187],a[248:251],a[72:75],a[184:187]
v_mfma_f32_16x16x32_bf16 a[184:187],a[248:251],a[76:79],a[184:187]
s_branch Lcb154
Lco155:
v_mfma_f32_16x16x32_bf16 a[184:187],a[248:251],a[80:83],a[184:187]
v_mfma_f32_16x16x32_bf16 a[184:187],a[248:251],a[84:87],a[184:187]
s_branch Lcb156
Lco157:
v_mfma_f32_16x16x32_bf16 a[184:187],a[248:251],a[88:91],a[184:187]
v_mfma_f32_16x16x32_bf16 a[184:187],a[248:251],a[92:95],a[184:187]
s_branch Lcb158
Lco159:
v_mfma_f32_16x16x32_bf16 a[188:191],a[248:251],a[96:99],a[188:191]
v_mfma_f32_16x16x32_bf16 a[188:191],a[248:251],a[100:103],a[188:191]
s_branch Lcb160
Lco161:
v_mfma_f32_16x16x32_bf16 a[188:191],a[248:251],a[104:107],a[188:191]
v_mfma_f32_16x16x32_bf16 a[188:191],a[248:251],a[108:111],a[188:191]
s_branch Lcb162
Lcosk172:
s_waitcnt vmcnt(0)
s_barrier
s_call_b64 s[98:99],Lsub_p3e
s_waitcnt vmcnt(0)
s_barrier
s_cmp_lg_u32 s20,0
s_cbranch_scc1 Lpub173
s_lshl_b32 s18,s86,1
s_lshr_b32 s19,s87,4
s_add_u32 s18,s18,s19
s_and_b32 s19,s87,15
s_lshl_b32 s18,s18,8
s_lshl_b32 s19,s19,2
s_add_u32 s18,s18,s19
s_add_u32 s18,s18,95485952
v_mov_b32 v1,0
v_mov_b32 v3,s94
s_mov_b64 exec,1
buffer_store_dword v3,v1,s[24:27],s18 offen sc1
s_mov_b64 exec,-1
Lpub173:
s_add_u32 s8,s16,12648448
s_addc_u32 s9,s17,0
s_mov_b32 s10,14680064
s_add_u32 s56,s16,4259840
s_addc_u32 s57,s17,0
s_mov_b32 s58,4194304
s_lshl_b32 s23,s84,7
s_lshr_b32 s28,s20,1
s_and_b32 s29,s20,1
s_lshl_b32 s18,s20,5
s_add_u32 s33,s23,s18
s_mul_i32 s19,s33,7168
v_lshlrev_b32 v4,4,v2
v_add_u32 v4,s19,v4
v_add_u32 v5,112640,v4
s_mul_i32 s30,s88,57344
s_mov_b32 s34,0
s_lshl_b32 s40,s20,12
s_and_b32 s54,s85,7
s_lshl_b32 s54,s54,1
s_add_u32 s54,s54,s29
s_lshl_b32 s18,s28,6
s_add_u32 s18,s18,s23
s_lshl_b32 s19,s88,5
s_add_u32 s18,s18,s19
s_mov_b32 s60,32768
s_lshl_b32 s61,s18,11
s_lshl_b32 s19,s54,11
s_add_u32 s19,s19,s61
v_lshlrev_b32 v22,4,v30
v_and_b32 v1,1,v31
v_lshl_add_u32 v22,v1,3,v22
v_lshrrev_b32 v1,1,v31
v_lshl_add_u32 v22,v1,8,v22
v_add_u32 v22,s19,v22
s_lshl_b32 s19,s54,11
s_add_u32 s19,s19,s61
v_lshlrev_b32 v18,4,v30
v_and_b32 v1,1,v31
v_lshl_add_u32 v18,v1,9,v18
v_lshrrev_b32 v1,1,v31
v_lshl_add_u32 v18,v1,8,v18
v_add_u32 v18,s19,v18
s_lshl_b32 s18,s18,7
s_lshr_b32 s19,s54,1
s_lshl_b32 s19,s19,8
s_add_u32 s18,s18,s19
s_and_b32 s19,s54,1
s_lshl_b32 s19,s19,3
s_add_u32 s18,s18,s19
v_lshlrev_b32 v19,4,v30
v_add_u32 v19,s18,v19
s_lshl_b32 s18,s28,13
s_lshl_b32 s19,s88,12
v_lshlrev_b32 v1,4,v2
v_add_u32 v1,s18,v1
v_add_u32 v13,s19,v1
s_sub_u32 s19,4096,s19
v_add_u32 v12,s19,v1
s_lshl_b32 s18,s29,13
s_add_u32 s18,s18,16384
v_bfe_u32 v1,v2,2,2
v_lshl_add_u32 v3,v31,3,v1
v_lshlrev_b32 v3,7,v3
v_add_u32 v3,s18,v3
v_and_b32 v0,1,v2
v_lshl_add_u32 v3,v0,3,v3
v_and_b32 v1,2,v1
v_and_b32 v0,1,v31
v_lshl_add_u32 v1,v0,2,v1
v_bfe_u32 v0,v2,1,1
v_or_b32 v1,v1,v0
v_xor_b32 v0,0,v1
v_lshl_add_u32 v14,v0,4,v3
v_xor_b32 v0,2,v1
v_lshl_add_u32 v15,v0,4,v3
v_xor_b32 v0,4,v1
v_lshl_add_u32 v16,v0,4,v3
v_xor_b32 v0,6,v1
v_lshl_add_u32 v17,v0,4,v3
s_lshl_b32 s18,s2,2
s_add_u32 s18,s18,s20
s_xor_b32 s19,s18,4
s_lshl_b32 s18,s18,12
s_add_u32 s18,s18,35717120
s_lshl_b32 s19,s19,12
s_add_u32 s19,s19,35717120
v_lshlrev_b32 v1,4,v2
v_add_u32 v20,s18,v1
v_add_u32 v21,s19,v1
s_mov_b32 s55,4096
s_mov_b32 s36,0
s_mov_b32 s42,0
s_mov_b32 s50,32768
s_mov_b32 s51,0xfffe0000
s_cmp_lg_u32 s20,0
s_cbranch_scc1 Lwbar174
s_and_b32 s18,s84,14
s_add_u32 s18,s18,s88
s_lshl_b32 s18,s18,8
s_add_u32 s18,s18,95485952
v_lshlrev_b32 v1,2,v30
v_lshl_add_u32 v1,v31,8,v1
s_mov_b32 exec_lo,0xffff
s_mov_b32 exec_hi,0
s_mov_b32 s39,131072
Lpoll175:
buffer_load_dword v3,v1,s[24:27],s18 offen sc1
s_waitcnt vmcnt(0)
v_cmp_ne_u32 vcc,s94,v3
s_nop 1
s_cmp_eq_u64 vcc,0
s_cbranch_scc1 Lgot176
s_sleep 1
s_sub_u32 s39,s39,1
s_cmp_lg_u32 s39,0
s_cbranch_scc1 Lpoll175
Lgot176:
s_mov_b64 exec,-1
Lwbar174:
s_barrier
s_add_u32 m0,s34,s40
s_nop 0
buffer_load_dwordx4 v4,s[8:11],s30 offen sc1 lds
buffer_load_dwordx4 v4,s[8:11],s30 offen offset:1024 sc1 lds
buffer_load_dwordx4 v5,s[8:11],s30 offen offset:2048 sc1 lds
buffer_load_dwordx4 v5,s[8:11],s30 offen offset:3072 sc1 lds
s_add_u32 s34,s34,32768
s_cmp_eq_u32 s34,163840
s_cselect_b32 s34,0,s34
s_add_u32 s30,s30,2048
s_add_u32 m0,s34,s40
s_nop 0
buffer_load_dwordx4 v4,s[8:11],s30 offen sc1 lds
buffer_load_dwordx4 v4,s[8:11],s30 offen offset:1024 sc1 lds
buffer_load_dwordx4 v5,s[8:11],s30 offen offset:2048 sc1 lds
buffer_load_dwordx4 v5,s[8:11],s30 offen offset:3072 sc1 lds
s_add_u32 s34,s34,32768
s_cmp_eq_u32 s34,163840
s_cselect_b32 s34,0,s34
s_add_u32 s30,s30,2048
s_add_u32 m0,s34,s40
s_nop 0
buffer_load_dwordx4 v4,s[8:11],s30 offen sc1 lds
buffer_load_dwordx4 v4,s[8:11],s30 offen offset:1024 sc1 lds
buffer_load_dwordx4 v5,s[8:11],s30 offen offset:2048 sc1 lds
buffer_load_dwordx4 v5,s[8:11],s30 offen offset:3072 sc1 lds
s_add_u32 s34,s34,32768
s_cmp_eq_u32 s34,163840
s_cselect_b32 s34,0,s34
s_add_u32 s30,s30,2048
s_waitcnt vmcnt(8)
s_barrier
ds_read_b128 v[96:99],v12 offset:0
ds_read_b64_tr_b16 v[112:113],v14 offset:0
ds_read_b64_tr_b16 v[114:115],v14 offset:512
ds_read_b128 v[128:131],v12 offset:1024
ds_read_b64_tr_b16 v[144:145],v14 offset:4096
ds_read_b64_tr_b16 v[146:147],v14 offset:4608
ds_read_b128 v[100:103],v12 offset:2048
ds_read_b128 v[132:135],v12 offset:3072
ds_read_b128 v[104:107],v13 offset:0
ds_read_b128 v[136:139],v13 offset:1024
ds_read_b128 v[108:111],v13 offset:2048
ds_read_b128 v[140:143],v13 offset:3072
ds_read_b64_tr_b16 v[116:117],v15 offset:0
ds_read_b64_tr_b16 v[118:119],v15 offset:512
ds_read_b64_tr_b16 v[148:149],v15 offset:4096
ds_read_b64_tr_b16 v[150:151],v15 offset:4608
ds_read_b64_tr_b16 v[120:121],v16 offset:0
ds_read_b64_tr_b16 v[122:123],v16 offset:512
ds_read_b64_tr_b16 v[152:153],v16 offset:4096
ds_read_b64_tr_b16 v[154:155],v16 offset:4608
ds_read_b64_tr_b16 v[124:125],v17 offset:0
ds_read_b64_tr_b16 v[126:127],v17 offset:512
ds_read_b64_tr_b16 v[156:157],v17 offset:4096
ds_read_b64_tr_b16 v[158:159],v17 offset:4608
s_add_u32 s36,s36,32768
s_cmp_eq_u32 s36,163840
s_cselect_b32 s42,s51,s50
s_cselect_b32 s36,0,s36
s_waitcnt lgkmcnt(12)
v_mfma_f32_16x16x32_bf16 v[32:35],v[112:115],v[96:99],0
v_add_u32 v12,s42,v12
v_add_u32 v13,s42,v13
v_mfma_f32_16x16x32_bf16 v[32:35],v[144:147],v[128:131],v[32:35]
v_add_u32 v14,s42,v14
v_add_u32 v15,s42,v15
v_mfma_f32_16x16x32_bf16 v[36:39],v[112:115],v[100:103],0
v_add_u32 v16,s42,v16
v_add_u32 v17,s42,v17
v_mfma_f32_16x16x32_bf16 v[36:39],v[144:147],v[132:135],v[36:39]
s_waitcnt vmcnt(4)
s_waitcnt lgkmcnt(0)
s_barrier
ds_read_b128 v[208:211],v12 offset:0
v_mfma_f32_16x16x32_bf16 v[40:43],v[112:115],v[104:107],0
ds_read_b64_tr_b16 v[224:225],v14 offset:0
s_add_u32 m0,s34,s40
v_mfma_f32_16x16x32_bf16 v[40:43],v[144:147],v[136:139],v[40:43]
ds_read_b64_tr_b16 v[226:227],v14 offset:512
buffer_load_dwordx4 v4,s[8:11],s30 offen sc1 lds
v_mfma_f32_16x16x32_bf16 v[44:47],v[112:115],v[108:111],0
ds_read_b128 v[240:243],v12 offset:1024
s_add_u32 s36,s36,32768
v_mfma_f32_16x16x32_bf16 v[44:47],v[144:147],v[140:143],v[44:47]
ds_read_b64_tr_b16 a[0:1],v14 offset:4096
buffer_load_dwordx4 v4,s[8:11],s30 offen offset:1024 sc1 lds
v_mfma_f32_16x16x32_bf16 v[48:51],v[116:119],v[96:99],0
ds_read_b64_tr_b16 a[2:3],v14 offset:4608
v_mfma_f32_16x16x32_bf16 v[48:51],v[148:151],v[128:131],v[48:51]
ds_read_b128 v[212:215],v12 offset:2048
buffer_load_dwordx4 v5,s[8:11],s30 offen offset:2048 sc1 lds
v_mfma_f32_16x16x32_bf16 v[52:55],v[116:119],v[100:103],0
ds_read_b128 v[244:247],v12 offset:3072
v_mfma_f32_16x16x32_bf16 v[52:55],v[148:151],v[132:135],v[52:55]
buffer_load_dwordx4 v5,s[8:11],s30 offen offset:3072 sc1 lds
s_add_u32 s34,s34,32768
v_mfma_f32_16x16x32_bf16 v[56:59],v[116:119],v[104:107],0
ds_read_b128 v[216:219],v13 offset:0
v_mfma_f32_16x16x32_bf16 v[56:59],v[148:151],v[136:139],v[56:59]
ds_read_b128 v[248:251],v13 offset:1024
v_mfma_f32_16x16x32_bf16 v[60:63],v[116:119],v[108:111],0
s_cmp_eq_u32 s34,163840
s_cselect_b32 s34,0,s34
v_mfma_f32_16x16x32_bf16 v[60:63],v[148:151],v[140:143],v[60:63]
ds_read_b128 v[220:223],v13 offset:2048
s_add_u32 s30,s30,2048
v_mfma_f32_16x16x32_bf16 v[64:67],v[120:123],v[96:99],0
s_add_u32 m0,s34,s40
s_nop 0
buffer_load_dwordx4 v4,s[8:11],s30 offen sc1 lds
v_mfma_f32_16x16x32_bf16 v[64:67],v[152:155],v[128:131],v[64:67]
ds_read_b128 v[252:255],v13 offset:3072
buffer_load_dwordx4 v4,s[8:11],s30 offen offset:1024 sc1 lds
v_mfma_f32_16x16x32_bf16 v[68:71],v[120:123],v[100:103],0
ds_read_b64_tr_b16 v[228:229],v15 offset:0
buffer_load_dwordx4 v5,s[8:11],s30 offen offset:2048 sc1 lds
v_mfma_f32_16x16x32_bf16 v[68:71],v[152:155],v[132:135],v[68:71]
ds_read_b64_tr_b16 v[230:231],v15 offset:512
v_mfma_f32_16x16x32_bf16 v[72:75],v[120:123],v[104:107],0
ds_read_b64_tr_b16 a[4:5],v15 offset:4096
ds_read_b64_tr_b16 a[6:7],v15 offset:4608
v_mfma_f32_16x16x32_bf16 v[72:75],v[152:155],v[136:139],v[72:75]
ds_read_b64_tr_b16 v[232:233],v16 offset:0
buffer_load_dwordx4 v5,s[8:11],s30 offen offset:3072 sc1 lds
v_mfma_f32_16x16x32_bf16 v[76:79],v[120:123],v[108:111],0
ds_read_b64_tr_b16 v[234:235],v16 offset:512
s_add_u32 s34,s34,32768
v_mfma_f32_16x16x32_bf16 v[76:79],v[152:155],v[140:143],v[76:79]
ds_read_b64_tr_b16 a[8:9],v16 offset:4096
v_mfma_f32_16x16x32_bf16 v[80:83],v[124:127],v[96:99],0
ds_read_b64_tr_b16 a[10:11],v16 offset:4608
ds_read_b64_tr_b16 v[236:237],v17 offset:0
v_mfma_f32_16x16x32_bf16 v[80:83],v[156:159],v[128:131],v[80:83]
ds_read_b64_tr_b16 v[238:239],v17 offset:512
v_mfma_f32_16x16x32_bf16 v[84:87],v[124:127],v[100:103],0
ds_read_b64_tr_b16 a[12:13],v17 offset:4096
v_mfma_f32_16x16x32_bf16 v[84:87],v[156:159],v[132:135],v[84:87]
ds_read_b64_tr_b16 a[14:15],v17 offset:4608
v_mfma_f32_16x16x32_bf16 v[88:91],v[124:127],v[104:107],0
s_cmp_eq_u32 s34,163840
s_cselect_b32 s34,0,s34
v_mfma_f32_16x16x32_bf16 v[88:91],v[156:159],v[136:139],v[88:91]
s_add_u32 s30,s30,2048
s_add_u32 m0,s34,s40
v_mfma_f32_16x16x32_bf16 v[92:95],v[124:127],v[108:111],0
buffer_load_dwordx4 v4,s[8:11],s30 offen sc1 lds
buffer_load_dwordx4 v4,s[8:11],s30 offen offset:1024 sc1 lds
v_mfma_f32_16x16x32_bf16 v[92:95],v[156:159],v[140:143],v[92:95]
buffer_load_dwordx4 v5,s[8:11],s30 offen offset:2048 sc1 lds
buffer_load_dwordx4 v5,s[8:11],s30 offen offset:3072 sc1 lds
s_add_u32 s34,s34,32768
s_cmp_eq_u32 s34,163840
s_cselect_b32 s34,0,s34
s_add_u32 s30,s30,2048
s_cmp_eq_u32 s36,163840
s_cselect_b32 s42,s51,s50
s_cselect_b32 s36,0,s36
s_waitcnt lgkmcnt(12)
v_mfma_f32_16x16x32_bf16 v[32:35],v[224:227],v[208:211],v[32:35]
v_add_u32 v12,s42,v12
v_add_u32 v13,s42,v13
v_mfma_f32_16x16x32_bf16 v[32:35],a[0:3],v[240:243],v[32:35]
v_add_u32 v14,s42,v14
v_add_u32 v15,s42,v15
v_mfma_f32_16x16x32_bf16 v[36:39],v[224:227],v[212:215],v[36:39]
v_add_u32 v16,s42,v16
v_add_u32 v17,s42,v17
v_mfma_f32_16x16x32_bf16 v[36:39],a[0:3],v[244:247],v[36:39]
s_waitcnt vmcnt(12)
s_waitcnt lgkmcnt(0)
s_barrier
ds_read_b128 v[96:99],v12 offset:0
v_mfma_f32_16x16x32_bf16 v[40:43],v[224:227],v[216:219],v[40:43]
ds_read_b64_tr_b16 v[112:113],v14 offset:0
s_add_u32 m0,s35,s41
v_mfma_f32_16x16x32_bf16 v[40:43],a[0:3],v[248:251],v[40:43]
ds_read_b64_tr_b16 v[114:115],v14 offset:512
buffer_load_dwordx4 v8,s[12:15],s32 offen lds
v_mfma_f32_16x16x32_bf16 v[44:47],v[224:227],v[220:223],v[44:47]
ds_read_b128 v[128:131],v12 offset:1024
s_add_u32 s36,s36,32768
v_mfma_f32_16x16x32_bf16 v[44:47],a[0:3],v[252:255],v[44:47]
ds_read_b64_tr_b16 v[144:145],v14 offset:4096
buffer_load_dwordx4 v9,s[12:15],s32 offen offset:1024 lds
v_mfma_f32_16x16x32_bf16 v[48:51],v[228:231],v[208:211],v[48:51]
ds_read_b64_tr_b16 v[146:147],v14 offset:4608
v_mfma_f32_16x16x32_bf16 v[48:51],a[4:7],v[240:243],v[48:51]
ds_read_b128 v[100:103],v12 offset:2048
buffer_load_dwordx4 v10,s[12:15],s32 offen offset:2048 lds
v_mfma_f32_16x16x32_bf16 v[52:55],v[228:231],v[212:215],v[52:55]
ds_read_b128 v[132:135],v12 offset:3072
v_mfma_f32_16x16x32_bf16 v[52:55],a[4:7],v[244:247],v[52:55]
buffer_load_dwordx4 v11,s[12:15],s32 offen offset:3072 lds
s_add_u32 s35,s35,32768
v_mfma_f32_16x16x32_bf16 v[56:59],v[228:231],v[216:219],v[56:59]
ds_read_b128 v[104:107],v13 offset:0
v_mfma_f32_16x16x32_bf16 v[56:59],a[4:7],v[248:251],v[56:59]
ds_read_b128 v[136:139],v13 offset:1024
v_mfma_f32_16x16x32_bf16 v[60:63],v[228:231],v[220:223],v[60:63]
s_cmp_eq_u32 s35,163840
s_cselect_b32 s35,0,s35
v_mfma_f32_16x16x32_bf16 v[60:63],a[4:7],v[252:255],v[60:63]
ds_read_b128 v[108:111],v13 offset:2048
s_add_u32 s32,s32,131072
v_mfma_f32_16x16x32_bf16 v[64:67],v[232:235],v[208:211],v[64:67]
s_add_u32 m0,s34,s40
s_nop 0
buffer_load_dwordx4 v4,s[8:11],s30 offen sc1 lds
v_mfma_f32_16x16x32_bf16 v[64:67],a[8:11],v[240:243],v[64:67]
ds_read_b128 v[140:143],v13 offset:3072
buffer_load_dwordx4 v4,s[8:11],s30 offen offset:1024 sc1 lds
v_mfma_f32_16x16x32_bf16 v[68:71],v[232:235],v[212:215],v[68:71]
ds_read_b64_tr_b16 v[116:117],v15 offset:0
buffer_load_dwordx4 v5,s[8:11],s30 offen offset:2048 sc1 lds
v_mfma_f32_16x16x32_bf16 v[68:71],a[8:11],v[244:247],v[68:71]
ds_read_b64_tr_b16 v[118:119],v15 offset:512
v_mfma_f32_16x16x32_bf16 v[72:75],v[232:235],v[216:219],v[72:75]
ds_read_b64_tr_b16 v[148:149],v15 offset:4096
ds_read_b64_tr_b16 v[150:151],v15 offset:4608
v_mfma_f32_16x16x32_bf16 v[72:75],a[8:11],v[248:251],v[72:75]
ds_read_b64_tr_b16 v[120:121],v16 offset:0
buffer_load_dwordx4 v5,s[8:11],s30 offen offset:3072 sc1 lds
v_mfma_f32_16x16x32_bf16 v[76:79],v[232:235],v[220:223],v[76:79]
ds_read_b64_tr_b16 v[122:123],v16 offset:512
s_add_u32 s34,s34,32768
v_mfma_f32_16x16x32_bf16 v[76:79],a[8:11],v[252:255],v[76:79]
ds_read_b64_tr_b16 v[152:153],v16 offset:4096
v_mfma_f32_16x16x32_bf16 v[80:83],v[236:239],v[208:211],v[80:83]
ds_read_b64_tr_b16 v[154:155],v16 offset:4608
ds_read_b64_tr_b16 v[124:125],v17 offset:0
v_mfma_f32_16x16x32_bf16 v[80:83],a[12:15],v[240:243],v[80:83]
ds_read_b64_tr_b16 v[126:127],v17 offset:512
v_mfma_f32_16x16x32_bf16 v[84:87],v[236:239],v[212:215],v[84:87]
ds_read_b64_tr_b16 v[156:157],v17 offset:4096
v_mfma_f32_16x16x32_bf16 v[84:87],a[12:15],v[244:247],v[84:87]
ds_read_b64_tr_b16 v[158:159],v17 offset:4608
v_mfma_f32_16x16x32_bf16 v[88:91],v[236:239],v[216:219],v[88:91]
s_cmp_eq_u32 s34,163840
s_cselect_b32 s34,0,s34
v_mfma_f32_16x16x32_bf16 v[88:91],a[12:15],v[248:251],v[88:91]
s_add_u32 s30,s30,2048
s_add_u32 m0,s35,s41
v_mfma_f32_16x16x32_bf16 v[92:95],v[236:239],v[220:223],v[92:95]
buffer_load_dwordx4 v8,s[12:15],s32 offen lds
buffer_load_dwordx4 v9,s[12:15],s32 offen offset:1024 lds
v_mfma_f32_16x16x32_bf16 v[92:95],a[12:15],v[252:255],v[92:95]
buffer_load_dwordx4 v10,s[12:15],s32 offen offset:2048 lds
buffer_load_dwordx4 v11,s[12:15],s32 offen offset:3072 lds
s_add_u32 s35,s35,32768
s_cmp_eq_u32 s35,163840
s_cselect_b32 s35,0,s35
s_add_u32 s32,s32,131072
s_cmp_eq_u32 s36,163840
s_cselect_b32 s42,s51,s50
s_cselect_b32 s36,0,s36
s_waitcnt lgkmcnt(12)
v_mfma_f32_16x16x32_bf16 v[32:35],v[112:115],v[96:99],v[32:35]
v_add_u32 v12,s42,v12
v_add_u32 v13,s42,v13
v_mfma_f32_16x16x32_bf16 v[32:35],v[144:147],v[128:131],v[32:35]
v_add_u32 v14,s42,v14
v_add_u32 v15,s42,v15
v_mfma_f32_16x16x32_bf16 v[36:39],v[112:115],v[100:103],v[36:39]
v_add_u32 v16,s42,v16
v_add_u32 v17,s42,v17
v_mfma_f32_16x16x32_bf16 v[36:39],v[144:147],v[132:135],v[36:39]
s_waitcnt vmcnt(20)
s_waitcnt lgkmcnt(0)
s_barrier
ds_read_b128 v[208:211],v12 offset:0
v_mfma_f32_16x16x32_bf16 v[40:43],v[112:115],v[104:107],v[40:43]
ds_read_b64_tr_b16 v[224:225],v14 offset:0
s_add_u32 m0,s34,s40
v_mfma_f32_16x16x32_bf16 v[40:43],v[144:147],v[136:139],v[40:43]
ds_read_b64_tr_b16 v[226:227],v14 offset:512
buffer_load_dwordx4 v4,s[8:11],s30 offen sc1 lds
v_mfma_f32_16x16x32_bf16 v[44:47],v[112:115],v[108:111],v[44:47]
ds_read_b128 v[240:243],v12 offset:1024
s_add_u32 s36,s36,32768
v_mfma_f32_16x16x32_bf16 v[44:47],v[144:147],v[140:143],v[44:47]
ds_read_b64_tr_b16 a[0:1],v14 offset:4096
v_mfma_f32_16x16x32_bf16 v[48:51],v[116:119],v[96:99],v[48:51]
ds_read_b64_tr_b16 a[2:3],v14 offset:4608
buffer_load_dwordx4 v4,s[8:11],s30 offen offset:1024 sc1 lds
v_mfma_f32_16x16x32_bf16 v[48:51],v[148:151],v[128:131],v[48:51]
ds_read_b128 v[212:215],v12 offset:2048
v_mfma_f32_16x16x32_bf16 v[52:55],v[116:119],v[100:103],v[52:55]
ds_read_b128 v[244:247],v12 offset:3072
v_mfma_f32_16x16x32_bf16 v[52:55],v[148:151],v[132:135],v[52:55]
buffer_load_dwordx4 v5,s[8:11],s30 offen offset:2048 sc1 lds
v_mfma_f32_16x16x32_bf16 v[56:59],v[116:119],v[104:107],v[56:59]
ds_read_b128 v[216:219],v13 offset:0
v_mfma_f32_16x16x32_bf16 v[56:59],v[148:151],v[136:139],v[56:59]
ds_read_b128 v[248:251],v13 offset:1024
v_mfma_f32_16x16x32_bf16 v[60:63],v[116:119],v[108:111],v[60:63]
buffer_load_dwordx4 v5,s[8:11],s30 offen offset:3072 sc1 lds
s_add_u32 s34,s34,32768
v_mfma_f32_16x16x32_bf16 v[60:63],v[148:151],v[140:143],v[60:63]
ds_read_b128 v[220:223],v13 offset:2048
v_mfma_f32_16x16x32_bf16 v[64:67],v[120:123],v[96:99],v[64:67]
s_cmp_eq_u32 s34,163840
s_cselect_b32 s34,0,s34
v_mfma_f32_16x16x32_bf16 v[64:67],v[152:155],v[128:131],v[64:67]
ds_read_b128 v[252:255],v13 offset:3072
s_add_u32 s30,s30,2048
v_mfma_f32_16x16x32_bf16 v[68:71],v[120:123],v[100:103],v[68:71]
ds_read_b64_tr_b16 v[228:229],v15 offset:0
s_add_u32 m0,s35,s41
v_mfma_f32_16x16x32_bf16 v[68:71],v[152:155],v[132:135],v[68:71]
ds_read_b64_tr_b16 v[230:231],v15 offset:512
buffer_load_dwordx4 v8,s[12:15],s32 offen lds
v_mfma_f32_16x16x32_bf16 v[72:75],v[120:123],v[104:107],v[72:75]
ds_read_b64_tr_b16 a[4:5],v15 offset:4096
ds_read_b64_tr_b16 a[6:7],v15 offset:4608
v_mfma_f32_16x16x32_bf16 v[72:75],v[152:155],v[136:139],v[72:75]
ds_read_b64_tr_b16 v[232:233],v16 offset:0
buffer_load_dwordx4 v9,s[12:15],s32 offen offset:1024 lds
v_mfma_f32_16x16x32_bf16 v[76:79],v[120:123],v[108:111],v[76:79]
ds_read_b64_tr_b16 v[234:235],v16 offset:512
v_mfma_f32_16x16x32_bf16 v[76:79],v[152:155],v[140:143],v[76:79]
ds_read_b64_tr_b16 a[8:9],v16 offset:4096
v_mfma_f32_16x16x32_bf16 v[80:83],v[124:127],v[96:99],v[80:83]
ds_read_b64_tr_b16 a[10:11],v16 offset:4608
ds_read_b64_tr_b16 v[236:237],v17 offset:0
v_mfma_f32_16x16x32_bf16 v[80:83],v[156:159],v[128:131],v[80:83]
ds_read_b64_tr_b16 v[238:239],v17 offset:512
buffer_load_dwordx4 v10,s[12:15],s32 offen offset:2048 lds
v_mfma_f32_16x16x32_bf16 v[84:87],v[124:127],v[100:103],v[84:87]
ds_read_b64_tr_b16 a[12:13],v17 offset:4096
v_mfma_f32_16x16x32_bf16 v[84:87],v[156:159],v[132:135],v[84:87]
ds_read_b64_tr_b16 a[14:15],v17 offset:4608
buffer_load_dwordx4 v11,s[12:15],s32 offen offset:3072 lds
v_mfma_f32_16x16x32_bf16 v[88:91],v[124:127],v[104:107],v[88:91]
s_add_u32 s35,s35,32768
v_mfma_f32_16x16x32_bf16 v[88:91],v[156:159],v[136:139],v[88:91]
s_cmp_eq_u32 s35,163840
s_cselect_b32 s35,0,s35
v_mfma_f32_16x16x32_bf16 v[92:95],v[124:127],v[108:111],v[92:95]
s_add_u32 s32,s32,131072
v_mfma_f32_16x16x32_bf16 v[92:95],v[156:159],v[140:143],v[92:95]
s_cmp_eq_u32 s36,163840
s_cselect_b32 s42,s51,s50
s_cselect_b32 s36,0,s36
s_waitcnt lgkmcnt(12)
v_mfma_f32_16x16x32_bf16 v[32:35],v[224:227],v[208:211],v[32:35]
v_add_u32 v12,s42,v12
v_add_u32 v13,s42,v13
v_mfma_f32_16x16x32_bf16 v[32:35],a[0:3],v[240:243],v[32:35]
v_add_u32 v14,s42,v14
v_add_u32 v15,s42,v15
v_mfma_f32_16x16x32_bf16 v[36:39],v[224:227],v[212:215],v[36:39]
v_add_u32 v16,s42,v16
v_add_u32 v17,s42,v17
v_mfma_f32_16x16x32_bf16 v[36:39],a[0:3],v[244:247],v[36:39]
s_waitcnt vmcnt(24)
s_waitcnt lgkmcnt(0)
s_barrier
ds_read_b128 v[96:99],v12 offset:0
v_mfma_f32_16x16x32_bf16 v[40:43],v[224:227],v[216:219],v[40:43]
ds_read_b64_tr_b16 v[112:113],v14 offset:0
s_add_u32 m0,s34,s40
v_mfma_f32_16x16x32_bf16 v[40:43],a[0:3],v[248:251],v[40:43]
ds_read_b64_tr_b16 v[114:115],v14 offset:512
buffer_load_dwordx4 v4,s[8:11],s30 offen sc1 lds
v_mfma_f32_16x16x32_bf16 v[44:47],v[224:227],v[220:223],v[44:47]
ds_read_b128 v[128:131],v12 offset:1024
s_add_u32 s36,s36,32768
v_mfma_f32_16x16x32_bf16 v[44:47],a[0:3],v[252:255],v[44:47]
ds_read_b64_tr_b16 v[144:145],v14 offset:4096
v_mfma_f32_16x16x32_bf16 v[48:51],v[228:231],v[208:211],v[48:51]
ds_read_b64_tr_b16 v[146:147],v14 offset:4608
buffer_load_dwordx4 v4,s[8:11],s30 offen offset:1024 sc1 lds
v_mfma_f32_16x16x32_bf16 v[48:51],a[4:7],v[240:243],v[48:51]
ds_read_b128 v[100:103],v12 offset:2048
v_mfma_f32_16x16x32_bf16 v[52:55],v[228:231],v[212:215],v[52:55]
ds_read_b128 v[132:135],v12 offset:3072
v_mfma_f32_16x16x32_bf16 v[52:55],a[4:7],v[244:247],v[52:55]
buffer_load_dwordx4 v5,s[8:11],s30 offen offset:2048 sc1 lds
v_mfma_f32_16x16x32_bf16 v[56:59],v[228:231],v[216:219],v[56:59]
ds_read_b128 v[104:107],v13 offset:0
v_mfma_f32_16x16x32_bf16 v[56:59],a[4:7],v[248:251],v[56:59]
ds_read_b128 v[136:139],v13 offset:1024
v_mfma_f32_16x16x32_bf16 v[60:63],v[228:231],v[220:223],v[60:63]
buffer_load_dwordx4 v5,s[8:11],s30 offen offset:3072 sc1 lds
s_add_u32 s34,s34,32768
v_mfma_f32_16x16x32_bf16 v[60:63],a[4:7],v[252:255],v[60:63]
ds_read_b128 v[108:111],v13 offset:2048
v_mfma_f32_16x16x32_bf16 v[64:67],v[232:235],v[208:211],v[64:67]
s_cmp_eq_u32 s34,163840
s_cselect_b32 s34,0,s34
v_mfma_f32_16x16x32_bf16 v[64:67],a[8:11],v[240:243],v[64:67]
ds_read_b128 v[140:143],v13 offset:3072
s_add_u32 s30,s30,2048
v_mfma_f32_16x16x32_bf16 v[68:71],v[232:235],v[212:215],v[68:71]
ds_read_b64_tr_b16 v[116:117],v15 offset:0
s_add_u32 m0,s35,s41
v_mfma_f32_16x16x32_bf16 v[68:71],a[8:11],v[244:247],v[68:71]
ds_read_b64_tr_b16 v[118:119],v15 offset:512
buffer_load_dwordx4 v8,s[12:15],s32 offen lds
v_mfma_f32_16x16x32_bf16 v[72:75],v[232:235],v[216:219],v[72:75]
ds_read_b64_tr_b16 v[148:149],v15 offset:4096
ds_read_b64_tr_b16 v[150:151],v15 offset:4608
v_mfma_f32_16x16x32_bf16 v[72:75],a[8:11],v[248:251],v[72:75]
ds_read_b64_tr_b16 v[120:121],v16 offset:0
buffer_load_dwordx4 v9,s[12:15],s32 offen offset:1024 lds
v_mfma_f32_16x16x32_bf16 v[76:79],v[232:235],v[220:223],v[76:79]
ds_read_b64_tr_b16 v[122:123],v16 offset:512
v_mfma_f32_16x16x32_bf16 v[76:79],a[8:11],v[252:255],v[76:79]
ds_read_b64_tr_b16 v[152:153],v16 offset:4096
v_mfma_f32_16x16x32_bf16 v[80:83],v[236:239],v[208:211],v[80:83]
ds_read_b64_tr_b16 v[154:155],v16 offset:4608
ds_read_b64_tr_b16 v[124:125],v17 offset:0
v_mfma_f32_16x16x32_bf16 v[80:83],a[12:15],v[240:243],v[80:83]
ds_read_b64_tr_b16 v[126:127],v17 offset:512
buffer_load_dwordx4 v10,s[12:15],s32 offen offset:2048 lds
v_mfma_f32_16x16x32_bf16 v[84:87],v[236:239],v[212:215],v[84:87]
ds_read_b64_tr_b16 v[156:157],v17 offset:4096
v_mfma_f32_16x16x32_bf16 v[84:87],a[12:15],v[244:247],v[84:87]
ds_read_b64_tr_b16 v[158:159],v17 offset:4608
buffer_load_dwordx4 v11,s[12:15],s32 offen offset:3072 lds
v_mfma_f32_16x16x32_bf16 v[88:91],v[236:239],v[216:219],v[88:91]
s_add_u32 s35,s35,32768
v_mfma_f32_16x16x32_bf16 v[88:91],a[12:15],v[248:251],v[88:91]
s_cmp_eq_u32 s35,163840
s_cselect_b32 s35,0,s35
v_mfma_f32_16x16x32_bf16 v[92:95],v[236:239],v[220:223],v[92:95]
s_add_u32 s32,s32,131072
v_mfma_f32_16x16x32_bf16 v[92:95],a[12:15],v[252:255],v[92:95]
s_cmp_eq_u32 s36,163840
s_cselect_b32 s42,s51,s50
s_cselect_b32 s36,0,s36
s_mov_b32 s38,9
Lp4L177_0:
s_waitcnt lgkmcnt(12)
v_mfma_f32_16x16x32_bf16 v[32:35],v[112:115],v[96:99],v[32:35]
v_add_u32 v12,s42,v12
v_add_u32 v13,s42,v13
v_mfma_f32_16x16x32_bf16 v[32:35],v[144:147],v[128:131],v[32:35]
v_add_u32 v14,s42,v14
v_add_u32 v15,s42,v15
v_mfma_f32_16x16x32_bf16 v[36:39],v[112:115],v[100:103],v[36:39]
v_add_u32 v16,s42,v16
v_add_u32 v17,s42,v17
v_mfma_f32_16x16x32_bf16 v[36:39],v[144:147],v[132:135],v[36:39]
s_waitcnt vmcnt(24)
s_waitcnt lgkmcnt(0)
s_barrier
ds_read_b128 v[208:211],v12 offset:0
v_mfma_f32_16x16x32_bf16 v[40:43],v[112:115],v[104:107],v[40:43]
ds_read_b64_tr_b16 v[224:225],v14 offset:0
s_add_u32 m0,s34,s40
v_mfma_f32_16x16x32_bf16 v[40:43],v[144:147],v[136:139],v[40:43]
ds_read_b64_tr_b16 v[226:227],v14 offset:512
buffer_load_dwordx4 v4,s[8:11],s30 offen sc1 lds
v_mfma_f32_16x16x32_bf16 v[44:47],v[112:115],v[108:111],v[44:47]
ds_read_b128 v[240:243],v12 offset:1024
s_add_u32 s36,s36,32768
v_mfma_f32_16x16x32_bf16 v[44:47],v[144:147],v[140:143],v[44:47]
ds_read_b64_tr_b16 a[0:1],v14 offset:4096
v_mfma_f32_16x16x32_bf16 v[48:51],v[116:119],v[96:99],v[48:51]
ds_read_b64_tr_b16 a[2:3],v14 offset:4608
buffer_load_dwordx4 v4,s[8:11],s30 offen offset:1024 sc1 lds
v_mfma_f32_16x16x32_bf16 v[48:51],v[148:151],v[128:131],v[48:51]
ds_read_b128 v[212:215],v12 offset:2048
v_mfma_f32_16x16x32_bf16 v[52:55],v[116:119],v[100:103],v[52:55]
ds_read_b128 v[244:247],v12 offset:3072
v_mfma_f32_16x16x32_bf16 v[52:55],v[148:151],v[132:135],v[52:55]
buffer_load_dwordx4 v5,s[8:11],s30 offen offset:2048 sc1 lds
v_mfma_f32_16x16x32_bf16 v[56:59],v[116:119],v[104:107],v[56:59]
ds_read_b128 v[216:219],v13 offset:0
v_mfma_f32_16x16x32_bf16 v[56:59],v[148:151],v[136:139],v[56:59]
ds_read_b128 v[248:251],v13 offset:1024
v_mfma_f32_16x16x32_bf16 v[60:63],v[116:119],v[108:111],v[60:63]
buffer_load_dwordx4 v5,s[8:11],s30 offen offset:3072 sc1 lds
s_add_u32 s34,s34,32768
v_mfma_f32_16x16x32_bf16 v[60:63],v[148:151],v[140:143],v[60:63]
ds_read_b128 v[220:223],v13 offset:2048
v_mfma_f32_16x16x32_bf16 v[64:67],v[120:123],v[96:99],v[64:67]
s_cmp_eq_u32 s34,163840
s_cselect_b32 s34,0,s34
v_mfma_f32_16x16x32_bf16 v[64:67],v[152:155],v[128:131],v[64:67]
ds_read_b128 v[252:255],v13 offset:3072
s_add_u32 s30,s30,2048
v_mfma_f32_16x16x32_bf16 v[68:71],v[120:123],v[100:103],v[68:71]
ds_read_b64_tr_b16 v[228:229],v15 offset:0
s_add_u32 m0,s35,s41
v_mfma_f32_16x16x32_bf16 v[68:71],v[152:155],v[132:135],v[68:71]
ds_read_b64_tr_b16 v[230:231],v15 offset:512
buffer_load_dwordx4 v8,s[12:15],s32 offen lds
v_mfma_f32_16x16x32_bf16 v[72:75],v[120:123],v[104:107],v[72:75]
ds_read_b64_tr_b16 a[4:5],v15 offset:4096
ds_read_b64_tr_b16 a[6:7],v15 offset:4608
v_mfma_f32_16x16x32_bf16 v[72:75],v[152:155],v[136:139],v[72:75]
ds_read_b64_tr_b16 v[232:233],v16 offset:0
buffer_load_dwordx4 v9,s[12:15],s32 offen offset:1024 lds
v_mfma_f32_16x16x32_bf16 v[76:79],v[120:123],v[108:111],v[76:79]
ds_read_b64_tr_b16 v[234:235],v16 offset:512
v_mfma_f32_16x16x32_bf16 v[76:79],v[152:155],v[140:143],v[76:79]
ds_read_b64_tr_b16 a[8:9],v16 offset:4096
v_mfma_f32_16x16x32_bf16 v[80:83],v[124:127],v[96:99],v[80:83]
ds_read_b64_tr_b16 a[10:11],v16 offset:4608
ds_read_b64_tr_b16 v[236:237],v17 offset:0
v_mfma_f32_16x16x32_bf16 v[80:83],v[156:159],v[128:131],v[80:83]
ds_read_b64_tr_b16 v[238:239],v17 offset:512
buffer_load_dwordx4 v10,s[12:15],s32 offen offset:2048 lds
v_mfma_f32_16x16x32_bf16 v[84:87],v[124:127],v[100:103],v[84:87]
ds_read_b64_tr_b16 a[12:13],v17 offset:4096
v_mfma_f32_16x16x32_bf16 v[84:87],v[156:159],v[132:135],v[84:87]
ds_read_b64_tr_b16 a[14:15],v17 offset:4608
buffer_load_dwordx4 v11,s[12:15],s32 offen offset:3072 lds
v_mfma_f32_16x16x32_bf16 v[88:91],v[124:127],v[104:107],v[88:91]
s_add_u32 s35,s35,32768
v_mfma_f32_16x16x32_bf16 v[88:91],v[156:159],v[136:139],v[88:91]
s_cmp_eq_u32 s35,163840
s_cselect_b32 s35,0,s35
v_mfma_f32_16x16x32_bf16 v[92:95],v[124:127],v[108:111],v[92:95]
s_add_u32 s32,s32,131072
v_mfma_f32_16x16x32_bf16 v[92:95],v[156:159],v[140:143],v[92:95]
s_cmp_eq_u32 s36,163840
s_cselect_b32 s42,s51,s50
s_cselect_b32 s36,0,s36
s_waitcnt lgkmcnt(12)
v_mfma_f32_16x16x32_bf16 v[32:35],v[224:227],v[208:211],v[32:35]
v_add_u32 v12,s42,v12
v_add_u32 v13,s42,v13
v_mfma_f32_16x16x32_bf16 v[32:35],a[0:3],v[240:243],v[32:35]
v_add_u32 v14,s42,v14
v_add_u32 v15,s42,v15
v_mfma_f32_16x16x32_bf16 v[36:39],v[224:227],v[212:215],v[36:39]
v_add_u32 v16,s42,v16
v_add_u32 v17,s42,v17
v_mfma_f32_16x16x32_bf16 v[36:39],a[0:3],v[244:247],v[36:39]
s_waitcnt vmcnt(24)
s_waitcnt lgkmcnt(0)
s_barrier
ds_read_b128 v[96:99],v12 offset:0
v_mfma_f32_16x16x32_bf16 v[40:43],v[224:227],v[216:219],v[40:43]
ds_read_b64_tr_b16 v[112:113],v14 offset:0
s_add_u32 m0,s34,s40
v_mfma_f32_16x16x32_bf16 v[40:43],a[0:3],v[248:251],v[40:43]
ds_read_b64_tr_b16 v[114:115],v14 offset:512
buffer_load_dwordx4 v4,s[8:11],s30 offen sc1 lds
v_mfma_f32_16x16x32_bf16 v[44:47],v[224:227],v[220:223],v[44:47]
ds_read_b128 v[128:131],v12 offset:1024
s_add_u32 s36,s36,32768
v_mfma_f32_16x16x32_bf16 v[44:47],a[0:3],v[252:255],v[44:47]
ds_read_b64_tr_b16 v[144:145],v14 offset:4096
v_mfma_f32_16x16x32_bf16 v[48:51],v[228:231],v[208:211],v[48:51]
ds_read_b64_tr_b16 v[146:147],v14 offset:4608
buffer_load_dwordx4 v4,s[8:11],s30 offen offset:1024 sc1 lds
v_mfma_f32_16x16x32_bf16 v[48:51],a[4:7],v[240:243],v[48:51]
ds_read_b128 v[100:103],v12 offset:2048
v_mfma_f32_16x16x32_bf16 v[52:55],v[228:231],v[212:215],v[52:55]
ds_read_b128 v[132:135],v12 offset:3072
v_mfma_f32_16x16x32_bf16 v[52:55],a[4:7],v[244:247],v[52:55]
buffer_load_dwordx4 v5,s[8:11],s30 offen offset:2048 sc1 lds
v_mfma_f32_16x16x32_bf16 v[56:59],v[228:231],v[216:219],v[56:59]
ds_read_b128 v[104:107],v13 offset:0
v_mfma_f32_16x16x32_bf16 v[56:59],a[4:7],v[248:251],v[56:59]
ds_read_b128 v[136:139],v13 offset:1024
v_mfma_f32_16x16x32_bf16 v[60:63],v[228:231],v[220:223],v[60:63]
buffer_load_dwordx4 v5,s[8:11],s30 offen offset:3072 sc1 lds
s_add_u32 s34,s34,32768
v_mfma_f32_16x16x32_bf16 v[60:63],a[4:7],v[252:255],v[60:63]
ds_read_b128 v[108:111],v13 offset:2048
v_mfma_f32_16x16x32_bf16 v[64:67],v[232:235],v[208:211],v[64:67]
s_cmp_eq_u32 s34,163840
s_cselect_b32 s34,0,s34
v_mfma_f32_16x16x32_bf16 v[64:67],a[8:11],v[240:243],v[64:67]
ds_read_b128 v[140:143],v13 offset:3072
s_add_u32 s30,s30,2048
v_mfma_f32_16x16x32_bf16 v[68:71],v[232:235],v[212:215],v[68:71]
ds_read_b64_tr_b16 v[116:117],v15 offset:0
s_add_u32 m0,s35,s41
v_mfma_f32_16x16x32_bf16 v[68:71],a[8:11],v[244:247],v[68:71]
ds_read_b64_tr_b16 v[118:119],v15 offset:512
buffer_load_dwordx4 v8,s[12:15],s32 offen lds
v_mfma_f32_16x16x32_bf16 v[72:75],v[232:235],v[216:219],v[72:75]
ds_read_b64_tr_b16 v[148:149],v15 offset:4096
ds_read_b64_tr_b16 v[150:151],v15 offset:4608
v_mfma_f32_16x16x32_bf16 v[72:75],a[8:11],v[248:251],v[72:75]
ds_read_b64_tr_b16 v[120:121],v16 offset:0
buffer_load_dwordx4 v9,s[12:15],s32 offen offset:1024 lds
v_mfma_f32_16x16x32_bf16 v[76:79],v[232:235],v[220:223],v[76:79]
ds_read_b64_tr_b16 v[122:123],v16 offset:512
v_mfma_f32_16x16x32_bf16 v[76:79],a[8:11],v[252:255],v[76:79]
ds_read_b64_tr_b16 v[152:153],v16 offset:4096
v_mfma_f32_16x16x32_bf16 v[80:83],v[236:239],v[208:211],v[80:83]
ds_read_b64_tr_b16 v[154:155],v16 offset:4608
ds_read_b64_tr_b16 v[124:125],v17 offset:0
v_mfma_f32_16x16x32_bf16 v[80:83],a[12:15],v[240:243],v[80:83]
ds_read_b64_tr_b16 v[126:127],v17 offset:512
buffer_load_dwordx4 v10,s[12:15],s32 offen offset:2048 lds
v_mfma_f32_16x16x32_bf16 v[84:87],v[236:239],v[212:215],v[84:87]
ds_read_b64_tr_b16 v[156:157],v17 offset:4096
v_mfma_f32_16x16x32_bf16 v[84:87],a[12:15],v[244:247],v[84:87]
ds_read_b64_tr_b16 v[158:159],v17 offset:4608
buffer_load_dwordx4 v11,s[12:15],s32 offen offset:3072 lds
v_mfma_f32_16x16x32_bf16 v[88:91],v[236:239],v[216:219],v[88:91]
s_add_u32 s35,s35,32768
v_mfma_f32_16x16x32_bf16 v[88:91],a[12:15],v[248:251],v[88:91]
s_cmp_eq_u32 s35,163840
s_cselect_b32 s35,0,s35
v_mfma_f32_16x16x32_bf16 v[92:95],v[236:239],v[220:223],v[92:95]
s_add_u32 s32,s32,131072
v_mfma_f32_16x16x32_bf16 v[92:95],a[12:15],v[252:255],v[92:95]
s_cmp_eq_u32 s36,163840
s_cselect_b32 s42,s51,s50
s_cselect_b32 s36,0,s36
s_sub_u32 s38,s38,1
s_cmp_lg_u32 s38,0
s_cbranch_scc1 Lp4L177_0
s_waitcnt lgkmcnt(12)
v_mfma_f32_16x16x32_bf16 v[32:35],v[112:115],v[96:99],v[32:35]
v_add_u32 v12,s42,v12
v_add_u32 v13,s42,v13
v_mfma_f32_16x16x32_bf16 v[32:35],v[144:147],v[128:131],v[32:35]
v_add_u32 v14,s42,v14
v_add_u32 v15,s42,v15
v_mfma_f32_16x16x32_bf16 v[36:39],v[112:115],v[100:103],v[36:39]
v_add_u32 v16,s42,v16
v_add_u32 v17,s42,v17
v_mfma_f32_16x16x32_bf16 v[36:39],v[144:147],v[132:135],v[36:39]
s_waitcnt vmcnt(24)
s_waitcnt lgkmcnt(0)
s_barrier
ds_read_b128 v[208:211],v12 offset:0
v_mfma_f32_16x16x32_bf16 v[40:43],v[112:115],v[104:107],v[40:43]
ds_read_b64_tr_b16 a[24:25],v14 offset:0
s_add_u32 m0,s34,s40
v_mfma_f32_16x16x32_bf16 v[40:43],v[144:147],v[136:139],v[40:43]
ds_read_b64_tr_b16 a[26:27],v14 offset:512
buffer_load_dwordx4 v4,s[8:11],s30 offen sc1 lds
v_mfma_f32_16x16x32_bf16 v[44:47],v[112:115],v[108:111],v[44:47]
ds_read_b128 v[240:243],v12 offset:1024
s_add_u32 s36,s36,32768
v_mfma_f32_16x16x32_bf16 v[44:47],v[144:147],v[140:143],v[44:47]
ds_read_b64_tr_b16 a[48:49],v14 offset:4096
v_mfma_f32_16x16x32_bf16 v[48:51],v[116:119],v[96:99],v[48:51]
ds_read_b64_tr_b16 a[50:51],v14 offset:4608
buffer_load_dwordx4 v4,s[8:11],s30 offen offset:1024 sc1 lds
v_mfma_f32_16x16x32_bf16 v[48:51],v[148:151],v[128:131],v[48:51]
ds_read_b128 v[212:215],v12 offset:2048
v_mfma_f32_16x16x32_bf16 v[52:55],v[116:119],v[100:103],v[52:55]
ds_read_b128 v[244:247],v12 offset:3072
v_mfma_f32_16x16x32_bf16 v[52:55],v[148:151],v[132:135],v[52:55]
buffer_load_dwordx4 v5,s[8:11],s30 offen offset:2048 sc1 lds
v_mfma_f32_16x16x32_bf16 v[56:59],v[116:119],v[104:107],v[56:59]
ds_read_b64_tr_b16 a[28:29],v15 offset:0
v_mfma_f32_16x16x32_bf16 v[56:59],v[148:151],v[136:139],v[56:59]
ds_read_b64_tr_b16 a[30:31],v15 offset:512
ds_read_b64_tr_b16 a[52:53],v15 offset:4096
v_mfma_f32_16x16x32_bf16 v[60:63],v[116:119],v[108:111],v[60:63]
ds_read_b64_tr_b16 a[54:55],v15 offset:4608
buffer_load_dwordx4 v5,s[8:11],s30 offen offset:3072 sc1 lds
v_mfma_f32_16x16x32_bf16 v[60:63],v[148:151],v[140:143],v[60:63]
ds_read_b64_tr_b16 a[32:33],v16 offset:0
s_add_u32 s34,s34,32768
v_mfma_f32_16x16x32_bf16 v[64:67],v[120:123],v[96:99],v[64:67]
ds_read_b64_tr_b16 a[34:35],v16 offset:512
v_mfma_f32_16x16x32_bf16 v[64:67],v[152:155],v[128:131],v[64:67]
ds_read_b64_tr_b16 a[56:57],v16 offset:4096
ds_read_b64_tr_b16 a[58:59],v16 offset:4608
v_mfma_f32_16x16x32_bf16 v[68:71],v[120:123],v[100:103],v[68:71]
ds_read_b64_tr_b16 a[36:37],v17 offset:0
v_mfma_f32_16x16x32_bf16 v[68:71],v[152:155],v[132:135],v[68:71]
ds_read_b64_tr_b16 a[38:39],v17 offset:512
v_mfma_f32_16x16x32_bf16 v[72:75],v[120:123],v[104:107],v[72:75]
ds_read_b64_tr_b16 a[60:61],v17 offset:4096
ds_read_b64_tr_b16 a[62:63],v17 offset:4608
v_mfma_f32_16x16x32_bf16 v[72:75],v[152:155],v[136:139],v[72:75]
ds_read_b128 a[16:19],v13 offset:0
v_mfma_f32_16x16x32_bf16 v[76:79],v[120:123],v[108:111],v[76:79]
s_cmp_eq_u32 s34,163840
s_cselect_b32 s34,0,s34
v_mfma_f32_16x16x32_bf16 v[76:79],v[152:155],v[140:143],v[76:79]
ds_read_b128 a[40:43],v13 offset:1024
s_add_u32 s30,s30,2048
v_mfma_f32_16x16x32_bf16 v[80:83],v[124:127],v[96:99],v[80:83]
ds_read_b128 a[20:23],v13 offset:2048
s_add_u32 m0,s35,s41
v_mfma_f32_16x16x32_bf16 v[80:83],v[156:159],v[128:131],v[80:83]
buffer_load_dwordx4 v8,s[12:15],s32 offen lds
buffer_load_dwordx4 v9,s[12:15],s32 offen offset:1024 lds
v_mfma_f32_16x16x32_bf16 v[84:87],v[124:127],v[100:103],v[84:87]
ds_read_b128 a[44:47],v13 offset:3072
buffer_load_dwordx4 v10,s[12:15],s32 offen offset:2048 lds
v_mfma_f32_16x16x32_bf16 v[84:87],v[156:159],v[132:135],v[84:87]
buffer_load_dwordx4 v11,s[12:15],s32 offen offset:3072 lds
s_add_u32 s35,s35,32768
v_mfma_f32_16x16x32_bf16 v[88:91],v[124:127],v[104:107],v[88:91]
s_cmp_eq_u32 s35,163840
s_cselect_b32 s35,0,s35
v_mfma_f32_16x16x32_bf16 v[88:91],v[156:159],v[136:139],v[88:91]
s_add_u32 s32,s32,131072
v_mfma_f32_16x16x32_bf16 v[92:95],v[124:127],v[108:111],v[92:95]
v_mfma_f32_16x16x32_bf16 v[92:95],v[156:159],v[140:143],v[92:95]
s_cmp_eq_u32 s36,163840
s_cselect_b32 s42,s51,s50
s_cselect_b32 s36,0,s36
s_waitcnt lgkmcnt(12)
v_mfma_f32_16x16x32_bf16 v[32:35],a[24:27],v[208:211],v[32:35]
v_add_u32 v12,s42,v12
v_add_u32 v13,s42,v13
v_mfma_f32_16x16x32_bf16 v[32:35],a[48:51],v[240:243],v[32:35]
v_add_u32 v14,s42,v14
v_add_u32 v15,s42,v15
v_mfma_f32_16x16x32_bf16 v[36:39],a[24:27],v[212:215],v[36:39]
v_add_u32 v16,s42,v16
v_add_u32 v17,s42,v17
v_mfma_f32_16x16x32_bf16 v[36:39],a[48:51],v[244:247],v[36:39]
s_waitcnt vmcnt(24)
s_waitcnt lgkmcnt(0)
s_barrier
ds_read_b128 v[96:99],v12 offset:0
v_mfma_f32_16x16x32_bf16 v[48:51],a[28:31],v[208:211],v[48:51]
ds_read_b64_tr_b16 a[72:73],v14 offset:0
ds_read_b64_tr_b16 a[74:75],v14 offset:512
s_add_u32 s36,s36,32768
v_mfma_f32_16x16x32_bf16 v[48:51],a[52:55],v[240:243],v[48:51]
ds_read_b128 v[128:131],v12 offset:1024
buffer_load_dwordx2 v[160:161],v22,s[56:59],0 offen sc1
v_mfma_f32_16x16x32_bf16 v[52:55],a[28:31],v[212:215],v[52:55]
ds_read_b64_tr_b16 a[96:97],v14 offset:4096
ds_read_b64_tr_b16 a[98:99],v14 offset:4608
v_mfma_f32_16x16x32_bf16 v[52:55],a[52:55],v[244:247],v[52:55]
ds_read_b128 v[100:103],v12 offset:2048
buffer_load_dwordx2 v[162:163],v22,s[56:59],0 offen offset:512 sc1
v_mfma_f32_16x16x32_bf16 v[64:67],a[32:35],v[208:211],v[64:67]
ds_read_b128 v[132:135],v12 offset:3072
buffer_load_dwordx2 v[164:165],v22,s[56:59],0 offen offset:1024 sc1
v_mfma_f32_16x16x32_bf16 v[64:67],a[56:59],v[240:243],v[64:67]
ds_read_b64_tr_b16 a[76:77],v15 offset:0
ds_read_b64_tr_b16 a[78:79],v15 offset:512
v_mfma_f32_16x16x32_bf16 v[68:71],a[32:35],v[212:215],v[68:71]
ds_read_b64_tr_b16 a[100:101],v15 offset:4096
ds_read_b64_tr_b16 a[102:103],v15 offset:4608
v_mfma_f32_16x16x32_bf16 v[68:71],a[56:59],v[244:247],v[68:71]
ds_read_b64_tr_b16 a[80:81],v16 offset:0
ds_read_b64_tr_b16 a[82:83],v16 offset:512
v_mfma_f32_16x16x32_bf16 v[80:83],a[36:39],v[208:211],v[80:83]
ds_read_b64_tr_b16 a[104:105],v16 offset:4096
ds_read_b64_tr_b16 a[106:107],v16 offset:4608
v_mfma_f32_16x16x32_bf16 v[80:83],a[60:63],v[240:243],v[80:83]
ds_read_b64_tr_b16 a[84:85],v17 offset:0
ds_read_b64_tr_b16 a[86:87],v17 offset:512
v_mfma_f32_16x16x32_bf16 v[84:87],a[36:39],v[212:215],v[84:87]
ds_read_b64_tr_b16 a[108:109],v17 offset:4096
ds_read_b64_tr_b16 a[110:111],v17 offset:4608
v_mfma_f32_16x16x32_bf16 v[84:87],a[60:63],v[244:247],v[84:87]
ds_read_b128 a[64:67],v13 offset:0
ds_read_b128 a[88:91],v13 offset:1024
ds_read_b128 a[68:71],v13 offset:2048
ds_read_b128 a[92:95],v13 offset:3072
buffer_load_dwordx2 v[166:167],v22,s[56:59],0 offen offset:1536 sc1
buffer_load_dwordx2 v[168:169],v22,s[56:59],s60 offen sc1
buffer_load_dwordx2 v[170:171],v22,s[56:59],s60 offen offset:512 sc1
buffer_load_dwordx2 v[172:173],v22,s[56:59],s60 offen offset:1024 sc1
buffer_load_dwordx2 v[174:175],v22,s[56:59],s60 offen offset:1536 sc1
s_cmp_eq_u32 s36,163840
s_cselect_b32 s42,s51,s50
s_cselect_b32 s36,0,s36
s_waitcnt lgkmcnt(12)
v_mfma_f32_16x16x32_bf16 v[32:35],a[72:75],v[96:99],v[32:35]
v_add_u32 v12,s42,v12
v_add_u32 v13,s42,v13
v_mfma_f32_16x16x32_bf16 v[32:35],a[96:99],v[128:131],v[32:35]
v_add_u32 v14,s42,v14
v_add_u32 v15,s42,v15
v_mfma_f32_16x16x32_bf16 v[36:39],a[72:75],v[100:103],v[36:39]
v_add_u32 v16,s42,v16
v_add_u32 v17,s42,v17
v_mfma_f32_16x16x32_bf16 v[36:39],a[96:99],v[132:135],v[36:39]
s_waitcnt vmcnt(24)
s_waitcnt lgkmcnt(0)
s_barrier
ds_read_b128 v[208:211],v12 offset:0
v_mfma_f32_16x16x32_bf16 v[48:51],a[76:79],v[96:99],v[48:51]
ds_read_b64_tr_b16 a[120:121],v14 offset:0
ds_read_b64_tr_b16 a[122:123],v14 offset:512
v_mfma_f32_16x16x32_bf16 v[48:51],a[100:103],v[128:131],v[48:51]
ds_read_b128 v[240:243],v12 offset:1024
s_add_u32 s36,s36,32768
v_mfma_f32_16x16x32_bf16 v[52:55],a[76:79],v[100:103],v[52:55]
ds_read_b64_tr_b16 a[144:145],v14 offset:4096
ds_read_b64_tr_b16 a[146:147],v14 offset:4608
v_mfma_f32_16x16x32_bf16 v[52:55],a[100:103],v[132:135],v[52:55]
ds_read_b128 v[212:215],v12 offset:2048
v_mfma_f32_16x16x32_bf16 v[64:67],a[80:83],v[96:99],v[64:67]
ds_read_b128 v[244:247],v12 offset:3072
v_mfma_f32_16x16x32_bf16 v[64:67],a[104:107],v[128:131],v[64:67]
ds_read_b64_tr_b16 a[124:125],v15 offset:0
ds_read_b64_tr_b16 a[126:127],v15 offset:512
v_mfma_f32_16x16x32_bf16 v[68:71],a[80:83],v[100:103],v[68:71]
ds_read_b64_tr_b16 a[148:149],v15 offset:4096
ds_read_b64_tr_b16 a[150:151],v15 offset:4608
v_mfma_f32_16x16x32_bf16 v[68:71],a[104:107],v[132:135],v[68:71]
ds_read_b64_tr_b16 a[128:129],v16 offset:0
ds_read_b64_tr_b16 a[130:131],v16 offset:512
v_mfma_f32_16x16x32_bf16 v[80:83],a[84:87],v[96:99],v[80:83]
ds_read_b64_tr_b16 a[152:153],v16 offset:4096
ds_read_b64_tr_b16 a[154:155],v16 offset:4608
v_mfma_f32_16x16x32_bf16 v[80:83],a[108:111],v[128:131],v[80:83]
ds_read_b64_tr_b16 a[132:133],v17 offset:0
ds_read_b64_tr_b16 a[134:135],v17 offset:512
v_mfma_f32_16x16x32_bf16 v[84:87],a[84:87],v[100:103],v[84:87]
ds_read_b64_tr_b16 a[156:157],v17 offset:4096
ds_read_b64_tr_b16 a[158:159],v17 offset:4608
v_mfma_f32_16x16x32_bf16 v[84:87],a[108:111],v[132:135],v[84:87]
ds_read_b128 a[112:115],v13 offset:0
ds_read_b128 a[136:139],v13 offset:1024
ds_read_b128 a[116:119],v13 offset:2048
ds_read_b128 a[140:143],v13 offset:3072
s_cmp_eq_u32 s36,163840
s_cselect_b32 s42,s51,s50
s_cselect_b32 s36,0,s36
s_waitcnt lgkmcnt(12)
v_mfma_f32_16x16x32_bf16 v[32:35],a[120:123],v[208:211],v[32:35]
v_add_u32 v12,s42,v12
v_add_u32 v13,s42,v13
v_mfma_f32_16x16x32_bf16 v[32:35],a[144:147],v[240:243],v[32:35]
v_add_u32 v14,s42,v14
v_add_u32 v15,s42,v15
v_mfma_f32_16x16x32_bf16 v[36:39],a[120:123],v[212:215],v[36:39]
v_add_u32 v16,s42,v16
v_add_u32 v17,s42,v17
v_mfma_f32_16x16x32_bf16 v[36:39],a[144:147],v[244:247],v[36:39]
s_waitcnt vmcnt(16)
s_waitcnt lgkmcnt(0)
s_barrier
ds_read_b128 v[96:99],v12 offset:0
v_mfma_f32_16x16x32_bf16 v[48:51],a[124:127],v[208:211],v[48:51]
ds_read_b64_tr_b16 a[168:169],v14 offset:0
ds_read_b64_tr_b16 a[170:171],v14 offset:512
v_mfma_f32_16x16x32_bf16 v[48:51],a[148:151],v[240:243],v[48:51]
ds_read_b128 v[128:131],v12 offset:1024
s_add_u32 s36,s36,32768
v_mfma_f32_16x16x32_bf16 v[52:55],a[124:127],v[212:215],v[52:55]
ds_read_b64_tr_b16 a[192:193],v14 offset:4096
ds_read_b64_tr_b16 a[194:195],v14 offset:4608
v_mfma_f32_16x16x32_bf16 v[52:55],a[148:151],v[244:247],v[52:55]
ds_read_b128 v[100:103],v12 offset:2048
v_mfma_f32_16x16x32_bf16 v[64:67],a[128:131],v[208:211],v[64:67]
ds_read_b128 v[132:135],v12 offset:3072
v_mfma_f32_16x16x32_bf16 v[64:67],a[152:155],v[240:243],v[64:67]
ds_read_b64_tr_b16 a[172:173],v15 offset:0
ds_read_b64_tr_b16 a[174:175],v15 offset:512
v_mfma_f32_16x16x32_bf16 v[68:71],a[128:131],v[212:215],v[68:71]
ds_read_b64_tr_b16 a[196:197],v15 offset:4096
ds_read_b64_tr_b16 a[198:199],v15 offset:4608
v_mfma_f32_16x16x32_bf16 v[68:71],a[152:155],v[244:247],v[68:71]
ds_read_b64_tr_b16 a[176:177],v16 offset:0
ds_read_b64_tr_b16 a[178:179],v16 offset:512
v_mfma_f32_16x16x32_bf16 v[80:83],a[132:135],v[208:211],v[80:83]
ds_read_b64_tr_b16 a[200:201],v16 offset:4096
ds_read_b64_tr_b16 a[202:203],v16 offset:4608
v_mfma_f32_16x16x32_bf16 v[80:83],a[156:159],v[240:243],v[80:83]
ds_read_b64_tr_b16 a[180:181],v17 offset:0
ds_read_b64_tr_b16 a[182:183],v17 offset:512
v_mfma_f32_16x16x32_bf16 v[84:87],a[132:135],v[212:215],v[84:87]
ds_read_b64_tr_b16 a[204:205],v17 offset:4096
ds_read_b64_tr_b16 a[206:207],v17 offset:4608
v_mfma_f32_16x16x32_bf16 v[84:87],a[156:159],v[244:247],v[84:87]
ds_read_b128 a[160:163],v13 offset:0
ds_read_b128 a[184:187],v13 offset:1024
ds_read_b128 a[164:167],v13 offset:2048
ds_read_b128 a[188:191],v13 offset:3072
s_cmp_eq_u32 s36,163840
s_cselect_b32 s42,s51,s50
s_cselect_b32 s36,0,s36
s_waitcnt lgkmcnt(12)
v_mfma_f32_16x16x32_bf16 v[32:35],a[168:171],v[96:99],v[32:35]
v_add_u32 v12,s42,v12
v_add_u32 v13,s42,v13
v_mfma_f32_16x16x32_bf16 v[32:35],a[192:195],v[128:131],v[32:35]
v_add_u32 v14,s42,v14
v_add_u32 v15,s42,v15
v_mfma_f32_16x16x32_bf16 v[36:39],a[168:171],v[100:103],v[36:39]
v_add_u32 v16,s42,v16
v_add_u32 v17,s42,v17
v_mfma_f32_16x16x32_bf16 v[36:39],a[192:195],v[132:135],v[36:39]
s_waitcnt vmcnt(0)
s_waitcnt lgkmcnt(0)
s_barrier
ds_read_b128 v[208:211],v12 offset:0
v_mfma_f32_16x16x32_bf16 v[48:51],a[172:175],v[96:99],v[48:51]
ds_read_b64_tr_b16 a[216:217],v14 offset:0
ds_read_b64_tr_b16 a[218:219],v14 offset:512
v_mfma_f32_16x16x32_bf16 v[48:51],a[196:199],v[128:131],v[48:51]
ds_read_b128 v[240:243],v12 offset:1024
s_add_u32 s36,s36,32768
v_mfma_f32_16x16x32_bf16 v[52:55],a[172:175],v[100:103],v[52:55]
ds_read_b64_tr_b16 a[240:241],v14 offset:4096
ds_read_b64_tr_b16 a[242:243],v14 offset:4608
v_mfma_f32_16x16x32_bf16 v[52:55],a[196:199],v[132:135],v[52:55]
ds_read_b128 v[212:215],v12 offset:2048
v_mfma_f32_16x16x32_bf16 v[64:67],a[176:179],v[96:99],v[64:67]
ds_read_b128 v[244:247],v12 offset:3072
v_mfma_f32_16x16x32_bf16 v[64:67],a[200:203],v[128:131],v[64:67]
ds_read_b64_tr_b16 a[220:221],v15 offset:0
ds_read_b64_tr_b16 a[222:223],v15 offset:512
v_mfma_f32_16x16x32_bf16 v[68:71],a[176:179],v[100:103],v[68:71]
ds_read_b64_tr_b16 a[244:245],v15 offset:4096
ds_read_b64_tr_b16 a[246:247],v15 offset:4608
v_mfma_f32_16x16x32_bf16 v[68:71],a[200:203],v[132:135],v[68:71]
ds_read_b64_tr_b16 a[224:225],v16 offset:0
ds_read_b64_tr_b16 a[226:227],v16 offset:512
v_mfma_f32_16x16x32_bf16 v[80:83],a[180:183],v[96:99],v[80:83]
ds_read_b64_tr_b16 a[248:249],v16 offset:4096
ds_read_b64_tr_b16 a[250:251],v16 offset:4608
v_mfma_f32_16x16x32_bf16 v[80:83],a[204:207],v[128:131],v[80:83]
ds_read_b64_tr_b16 a[228:229],v17 offset:0
ds_read_b64_tr_b16 a[230:231],v17 offset:512
v_mfma_f32_16x16x32_bf16 v[84:87],a[180:183],v[100:103],v[84:87]
ds_read_b64_tr_b16 a[252:253],v17 offset:4096
ds_read_b64_tr_b16 a[254:255],v17 offset:4608
v_mfma_f32_16x16x32_bf16 v[84:87],a[204:207],v[132:135],v[84:87]
ds_read_b128 a[208:211],v13 offset:0
ds_read_b128 a[232:235],v13 offset:1024
ds_read_b128 a[212:215],v13 offset:2048
ds_read_b128 a[236:239],v13 offset:3072
s_cmp_eq_u32 s36,163840
s_cselect_b32 s42,s51,s50
s_cselect_b32 s36,0,s36
s_waitcnt lgkmcnt(12)
v_mfma_f32_16x16x32_bf16 v[32:35],a[216:219],v[208:211],v[32:35]
v_mfma_f32_16x16x32_bf16 v[32:35],a[240:243],v[240:243],v[32:35]
v_mfma_f32_16x16x32_bf16 v[36:39],a[216:219],v[212:215],v[36:39]
v_mfma_f32_16x16x32_bf16 v[36:39],a[240:243],v[244:247],v[36:39]
v_mfma_f32_16x16x32_bf16 v[48:51],a[220:223],v[208:211],v[48:51]
v_mfma_f32_16x16x32_bf16 v[48:51],a[244:247],v[240:243],v[48:51]
v_mfma_f32_16x16x32_bf16 v[52:55],a[220:223],v[212:215],v[52:55]
v_mfma_f32_16x16x32_bf16 v[52:55],a[244:247],v[244:247],v[52:55]
s_waitcnt lgkmcnt(4)
v_mfma_f32_16x16x32_bf16 v[64:67],a[224:227],v[208:211],v[64:67]
v_mfma_f32_16x16x32_bf16 v[64:67],a[248:251],v[240:243],v[64:67]
v_mfma_f32_16x16x32_bf16 v[68:71],a[224:227],v[212:215],v[68:71]
v_mfma_f32_16x16x32_bf16 v[68:71],a[248:251],v[244:247],v[68:71]
v_mfma_f32_16x16x32_bf16 v[80:83],a[228:231],v[208:211],v[80:83]
v_mfma_f32_16x16x32_bf16 v[80:83],a[252:255],v[240:243],v[80:83]
v_mfma_f32_16x16x32_bf16 v[84:87],a[228:231],v[212:215],v[84:87]
v_mfma_f32_16x16x32_bf16 v[84:87],a[252:255],v[244:247],v[84:87]
v_cvt_pk_bf16_f32 v96,v32,v33
v_cvt_pk_bf16_f32 v97,v34,v35
v_cvt_pk_bf16_f32 v98,v48,v49
v_cvt_pk_bf16_f32 v99,v50,v51
v_cvt_pk_bf16_f32 v100,v64,v65
v_cvt_pk_bf16_f32 v101,v66,v67
v_cvt_pk_bf16_f32 v102,v80,v81
v_cvt_pk_bf16_f32 v103,v82,v83
v_cvt_pk_bf16_f32 v104,v36,v37
v_cvt_pk_bf16_f32 v105,v38,v39
v_cvt_pk_bf16_f32 v106,v52,v53
v_cvt_pk_bf16_f32 v107,v54,v55
v_cvt_pk_bf16_f32 v108,v68,v69
v_cvt_pk_bf16_f32 v109,v70,v71
v_cvt_pk_bf16_f32 v110,v84,v85
v_cvt_pk_bf16_f32 v111,v86,v87
buffer_store_dwordx4 v[96:99],v20,s[24:27],0 offen sc1
buffer_store_dwordx4 v[100:103],v20,s[24:27],0 offen offset:1024 sc1
buffer_store_dwordx4 v[104:107],v20,s[24:27],0 offen offset:2048 sc1
buffer_store_dwordx4 v[108:111],v20,s[24:27],0 offen offset:3072 sc1
s_waitcnt lgkmcnt(0)
v_mfma_f32_16x16x32_bf16 v[40:43],a[24:27],a[16:19],v[40:43]
v_lshlrev_b32 v176,16,v160
v_mfma_f32_16x16x32_bf16 v[40:43],a[48:51],a[40:43],v[40:43]
v_and_b32 v177,0xffff0000,v160
v_mfma_f32_16x16x32_bf16 v[40:43],a[72:75],a[64:67],v[40:43]
v_lshlrev_b32 v178,16,v161
v_mfma_f32_16x16x32_bf16 v[40:43],a[96:99],a[88:91],v[40:43]
v_and_b32 v179,0xffff0000,v161
v_mfma_f32_16x16x32_bf16 v[40:43],a[120:123],a[112:115],v[40:43]
v_lshlrev_b32 v180,16,v162
v_mfma_f32_16x16x32_bf16 v[40:43],a[144:147],a[136:139],v[40:43]
v_and_b32 v181,0xffff0000,v162
v_mfma_f32_16x16x32_bf16 v[40:43],a[168:171],a[160:163],v[40:43]
v_lshlrev_b32 v182,16,v163
v_mfma_f32_16x16x32_bf16 v[40:43],a[192:195],a[184:187],v[40:43]
v_and_b32 v183,0xffff0000,v163
v_mfma_f32_16x16x32_bf16 v[40:43],a[216:219],a[208:211],v[40:43]
v_lshlrev_b32 v184,16,v164
v_mfma_f32_16x16x32_bf16 v[40:43],a[240:243],a[232:235],v[40:43]
v_and_b32 v185,0xffff0000,v164
v_mfma_f32_16x16x32_bf16 v[44:47],a[24:27],a[20:23],v[44:47]
v_lshlrev_b32 v186,16,v165
v_mfma_f32_16x16x32_bf16 v[44:47],a[48:51],a[44:47],v[44:47]
v_and_b32 v187,0xffff0000,v165
v_mfma_f32_16x16x32_bf16 v[44:47],a[72:75],a[68:71],v[44:47]
v_lshlrev_b32 v188,16,v166
v_mfma_f32_16x16x32_bf16 v[44:47],a[96:99],a[92:95],v[44:47]
v_and_b32 v189,0xffff0000,v166
v_mfma_f32_16x16x32_bf16 v[44:47],a[120:123],a[116:119],v[44:47]
v_lshlrev_b32 v190,16,v167
v_mfma_f32_16x16x32_bf16 v[44:47],a[144:147],a[140:143],v[44:47]
v_and_b32 v191,0xffff0000,v167
v_mfma_f32_16x16x32_bf16 v[44:47],a[168:171],a[164:167],v[44:47]
v_lshlrev_b32 v192,16,v168
v_mfma_f32_16x16x32_bf16 v[44:47],a[192:195],a[188:191],v[44:47]
v_and_b32 v193,0xffff0000,v168
v_mfma_f32_16x16x32_bf16 v[44:47],a[216:219],a[212:215],v[44:47]
v_lshlrev_b32 v194,16,v169
v_mfma_f32_16x16x32_bf16 v[44:47],a[240:243],a[236:239],v[44:47]
v_and_b32 v195,0xffff0000,v169
v_mfma_f32_16x16x32_bf16 v[56:59],a[28:31],a[16:19],v[56:59]
v_lshlrev_b32 v196,16,v170
v_mfma_f32_16x16x32_bf16 v[56:59],a[52:55],a[40:43],v[56:59]
v_and_b32 v197,0xffff0000,v170
v_mfma_f32_16x16x32_bf16 v[56:59],a[76:79],a[64:67],v[56:59]
v_lshlrev_b32 v198,16,v171
v_mfma_f32_16x16x32_bf16 v[56:59],a[100:103],a[88:91],v[56:59]
v_and_b32 v199,0xffff0000,v171
v_mfma_f32_16x16x32_bf16 v[56:59],a[124:127],a[112:115],v[56:59]
v_lshlrev_b32 v200,16,v172
v_mfma_f32_16x16x32_bf16 v[56:59],a[148:151],a[136:139],v[56:59]
v_and_b32 v201,0xffff0000,v172
v_mfma_f32_16x16x32_bf16 v[56:59],a[172:175],a[160:163],v[56:59]
v_lshlrev_b32 v202,16,v173
v_mfma_f32_16x16x32_bf16 v[56:59],a[196:199],a[184:187],v[56:59]
v_and_b32 v203,0xffff0000,v173
v_mfma_f32_16x16x32_bf16 v[56:59],a[220:223],a[208:211],v[56:59]
v_lshlrev_b32 v204,16,v174
v_mfma_f32_16x16x32_bf16 v[56:59],a[244:247],a[232:235],v[56:59]
v_and_b32 v205,0xffff0000,v174
v_mfma_f32_16x16x32_bf16 v[60:63],a[28:31],a[20:23],v[60:63]
v_lshlrev_b32 v206,16,v175
v_mfma_f32_16x16x32_bf16 v[60:63],a[52:55],a[44:47],v[60:63]
v_and_b32 v207,0xffff0000,v175
v_mfma_f32_16x16x32_bf16 v[60:63],a[76:79],a[68:71],v[60:63]
v_mfma_f32_16x16x32_bf16 v[60:63],a[100:103],a[92:95],v[60:63]
v_mfma_f32_16x16x32_bf16 v[60:63],a[124:127],a[116:119],v[60:63]
v_mfma_f32_16x16x32_bf16 v[60:63],a[148:151],a[140:143],v[60:63]
v_mfma_f32_16x16x32_bf16 v[60:63],a[172:175],a[164:167],v[60:63]
v_mfma_f32_16x16x32_bf16 v[60:63],a[196:199],a[188:191],v[60:63]
v_mfma_f32_16x16x32_bf16 v[60:63],a[220:223],a[212:215],v[60:63]
v_mfma_f32_16x16x32_bf16 v[60:63],a[244:247],a[236:239],v[60:63]
v_mfma_f32_16x16x32_bf16 v[72:75],a[32:35],a[16:19],v[72:75]
v_mfma_f32_16x16x32_bf16 v[72:75],a[56:59],a[40:43],v[72:75]
v_mfma_f32_16x16x32_bf16 v[72:75],a[80:83],a[64:67],v[72:75]
v_mfma_f32_16x16x32_bf16 v[72:75],a[104:107],a[88:91],v[72:75]
v_mfma_f32_16x16x32_bf16 v[72:75],a[128:131],a[112:115],v[72:75]
v_mfma_f32_16x16x32_bf16 v[72:75],a[152:155],a[136:139],v[72:75]
v_mfma_f32_16x16x32_bf16 v[72:75],a[176:179],a[160:163],v[72:75]
v_mfma_f32_16x16x32_bf16 v[72:75],a[200:203],a[184:187],v[72:75]
v_mfma_f32_16x16x32_bf16 v[72:75],a[224:227],a[208:211],v[72:75]
v_mfma_f32_16x16x32_bf16 v[72:75],a[248:251],a[232:235],v[72:75]
v_mfma_f32_16x16x32_bf16 v[76:79],a[32:35],a[20:23],v[76:79]
v_mfma_f32_16x16x32_bf16 v[76:79],a[56:59],a[44:47],v[76:79]
buffer_load_dwordx4 v[128:131],v21,s[24:27],0 offen sc1
v_mfma_f32_16x16x32_bf16 v[76:79],a[80:83],a[68:71],v[76:79]
buffer_load_dwordx4 v[132:135],v21,s[24:27],0 offen offset:1024 sc1
v_mfma_f32_16x16x32_bf16 v[76:79],a[104:107],a[92:95],v[76:79]
buffer_load_dwordx4 v[136:139],v21,s[24:27],0 offen offset:2048 sc1
v_mfma_f32_16x16x32_bf16 v[76:79],a[128:131],a[116:119],v[76:79]
buffer_load_dwordx4 v[140:143],v21,s[24:27],0 offen offset:3072 sc1
v_mfma_f32_16x16x32_bf16 v[76:79],a[152:155],a[140:143],v[76:79]
v_mfma_f32_16x16x32_bf16 v[76:79],a[176:179],a[164:167],v[76:79]
v_mfma_f32_16x16x32_bf16 v[76:79],a[200:203],a[188:191],v[76:79]
v_mfma_f32_16x16x32_bf16 v[76:79],a[224:227],a[212:215],v[76:79]
v_mfma_f32_16x16x32_bf16 v[76:79],a[248:251],a[236:239],v[76:79]
v_mfma_f32_16x16x32_bf16 v[88:91],a[36:39],a[16:19],v[88:91]
v_mfma_f32_16x16x32_bf16 v[88:91],a[60:63],a[40:43],v[88:91]
v_mfma_f32_16x16x32_bf16 v[88:91],a[84:87],a[64:67],v[88:91]
v_mfma_f32_16x16x32_bf16 v[88:91],a[108:111],a[88:91],v[88:91]
v_mfma_f32_16x16x32_bf16 v[88:91],a[132:135],a[112:115],v[88:91]
v_mfma_f32_16x16x32_bf16 v[88:91],a[156:159],a[136:139],v[88:91]
v_mfma_f32_16x16x32_bf16 v[88:91],a[180:183],a[160:163],v[88:91]
v_mfma_f32_16x16x32_bf16 v[88:91],a[204:207],a[184:187],v[88:91]
v_mfma_f32_16x16x32_bf16 v[88:91],a[228:231],a[208:211],v[88:91]
v_mfma_f32_16x16x32_bf16 v[88:91],a[252:255],a[232:235],v[88:91]
v_mfma_f32_16x16x32_bf16 v[92:95],a[36:39],a[20:23],v[92:95]
v_mfma_f32_16x16x32_bf16 v[92:95],a[60:63],a[44:47],v[92:95]
v_mfma_f32_16x16x32_bf16 v[92:95],a[84:87],a[68:71],v[92:95]
v_mfma_f32_16x16x32_bf16 v[92:95],a[108:111],a[92:95],v[92:95]
v_mfma_f32_16x16x32_bf16 v[92:95],a[132:135],a[116:119],v[92:95]
v_mfma_f32_16x16x32_bf16 v[92:95],a[156:159],a[140:143],v[92:95]
v_mfma_f32_16x16x32_bf16 v[92:95],a[180:183],a[164:167],v[92:95]
v_mfma_f32_16x16x32_bf16 v[92:95],a[204:207],a[188:191],v[92:95]
v_mfma_f32_16x16x32_bf16 v[92:95],a[228:231],a[212:215],v[92:95]
v_mfma_f32_16x16x32_bf16 v[92:95],a[252:255],a[236:239],v[92:95]
v_pk_add_f32 v[176:177],v[176:177],v[40:41]
v_pk_add_f32 v[178:179],v[178:179],v[42:43]
v_pk_add_f32 v[180:181],v[180:181],v[56:57]
v_pk_add_f32 v[182:183],v[182:183],v[58:59]
v_pk_add_f32 v[184:185],v[184:185],v[72:73]
v_pk_add_f32 v[186:187],v[186:187],v[74:75]
v_pk_add_f32 v[188:189],v[188:189],v[88:89]
v_pk_add_f32 v[190:191],v[190:191],v[90:91]
v_pk_add_f32 v[192:193],v[192:193],v[44:45]
v_pk_add_f32 v[194:195],v[194:195],v[46:47]
v_pk_add_f32 v[196:197],v[196:197],v[60:61]
v_pk_add_f32 v[198:199],v[198:199],v[62:63]
v_pk_add_f32 v[200:201],v[200:201],v[76:77]
v_pk_add_f32 v[202:203],v[202:203],v[78:79]
v_pk_add_f32 v[204:205],v[204:205],v[92:93]
v_pk_add_f32 v[206:207],v[206:207],v[94:95]
s_mov_b32 s39,65536
Lxpl178:
s_waitcnt vmcnt(0)
v_max3_u32 v1,v128,v129,v130
v_max3_u32 v1,v1,v131,v132
v_max3_u32 v1,v1,v133,v134
v_max3_u32 v1,v1,v135,v136
v_max3_u32 v1,v1,v137,v138
v_max3_u32 v1,v1,v139,v140
v_max3_u32 v1,v1,v141,v142
v_max_u32 v1,v1,v143
v_cmp_eq_u32 vcc,-1,v1
s_nop 1
s_cmp_eq_u64 vcc,0
s_cbranch_scc1 Lxok179
buffer_load_dwordx4 v[128:131],v21,s[24:27],0 offen sc1
buffer_load_dwordx4 v[132:135],v21,s[24:27],0 offen offset:1024 sc1
buffer_load_dwordx4 v[136:139],v21,s[24:27],0 offen offset:2048 sc1
buffer_load_dwordx4 v[140:143],v21,s[24:27],0 offen offset:3072 sc1
s_sub_u32 s39,s39,1
s_cmp_lg_u32 s39,0
s_cbranch_scc1 Lxpl178
s_waitcnt vmcnt(0)
Lxok179:
v_lshlrev_b32 v96,16,v128
v_and_b32 v97,0xffff0000,v128
v_lshlrev_b32 v98,16,v129
v_and_b32 v99,0xffff0000,v129
v_lshlrev_b32 v100,16,v130
v_and_b32 v101,0xffff0000,v130
v_lshlrev_b32 v102,16,v131
v_and_b32 v103,0xffff0000,v131
v_lshlrev_b32 v104,16,v132
v_and_b32 v105,0xffff0000,v132
v_lshlrev_b32 v106,16,v133
v_and_b32 v107,0xffff0000,v133
v_lshlrev_b32 v108,16,v134
v_and_b32 v109,0xffff0000,v134
v_lshlrev_b32 v110,16,v135
v_and_b32 v111,0xffff0000,v135
v_lshlrev_b32 v112,16,v136
v_and_b32 v113,0xffff0000,v136
v_lshlrev_b32 v114,16,v137
v_and_b32 v115,0xffff0000,v137
v_lshlrev_b32 v116,16,v138
v_and_b32 v117,0xffff0000,v138
v_lshlrev_b32 v118,16,v139
v_and_b32 v119,0xffff0000,v139
v_lshlrev_b32 v120,16,v140
v_and_b32 v121,0xffff0000,v140
v_lshlrev_b32 v122,16,v141
v_and_b32 v123,0xffff0000,v141
v_lshlrev_b32 v124,16,v142
v_and_b32 v125,0xffff0000,v142
v_lshlrev_b32 v126,16,v143
v_and_b32 v127,0xffff0000,v143
s_add_u32 s56,s16,8454144
s_addc_u32 s57,s17,0
s_mov_b32 s58,4194304
v_pk_add_f32 v[176:177],v[176:177],v[96:97]
v_pk_add_f32 v[178:179],v[178:179],v[98:99]
v_pk_add_f32 v[180:181],v[180:181],v[100:101]
v_pk_add_f32 v[182:183],v[182:183],v[102:103]
v_pk_add_f32 v[184:185],v[184:185],v[104:105]
v_pk_add_f32 v[186:187],v[186:187],v[106:107]
v_pk_add_f32 v[188:189],v[188:189],v[108:109]
v_pk_add_f32 v[190:191],v[190:191],v[110:111]
v_pk_add_f32 v[192:193],v[192:193],v[112:113]
v_pk_add_f32 v[194:195],v[194:195],v[114:115]
v_pk_add_f32 v[196:197],v[196:197],v[116:117]
v_pk_add_f32 v[198:199],v[198:199],v[118:119]
v_pk_add_f32 v[200:201],v[200:201],v[120:121]
v_pk_add_f32 v[202:203],v[202:203],v[122:123]
v_pk_add_f32 v[204:205],v[204:205],v[124:125]
v_pk_add_f32 v[206:207],v[206:207],v[126:127]
v_cvt_pk_bf16_f32 v32,v176,v177
v_cvt_pk_bf16_f32 v33,v178,v179
v_cvt_pk_bf16_f32 v34,v180,v181
v_cvt_pk_bf16_f32 v35,v182,v183
v_cvt_pk_bf16_f32 v36,v184,v185
v_cvt_pk_bf16_f32 v37,v186,v187
v_cvt_pk_bf16_f32 v38,v188,v189
v_cvt_pk_bf16_f32 v39,v190,v191
v_cvt_pk_bf16_f32 v40,v192,v193
v_cvt_pk_bf16_f32 v41,v194,v195
v_cvt_pk_bf16_f32 v42,v196,v197
v_cvt_pk_bf16_f32 v43,v198,v199
v_cvt_pk_bf16_f32 v44,v200,v201
v_cvt_pk_bf16_f32 v45,v202,v203
v_cvt_pk_bf16_f32 v46,v204,v205
v_cvt_pk_bf16_f32 v47,v206,v207
v_mov_b32 v64,v32
v_mov_b32 v65,v33
v_mov_b32 v66,v34
v_mov_b32 v67,v35
v_mov_b32 v68,v36
v_mov_b32 v69,v37
v_mov_b32 v70,v38
v_mov_b32 v71,v39
v_mov_b32 v72,v40
v_mov_b32 v73,v41
v_mov_b32 v74,v42
v_mov_b32 v75,v43
v_mov_b32 v76,v44
v_mov_b32 v77,v45
v_mov_b32 v78,v46
v_mov_b32 v79,v47
v_permlane16_swap_b32 v32,v34
v_permlane16_swap_b32 v33,v35
buffer_store_dwordx4 v[32:35],v18,s[56:59],0 offen sc1
v_permlane16_swap_b32 v36,v38
v_permlane16_swap_b32 v37,v39
buffer_store_dwordx4 v[36:39],v18,s[56:59],0 offen offset:1024 sc1
v_permlane16_swap_b32 v40,v42
v_permlane16_swap_b32 v41,v43
buffer_store_dwordx4 v[40:43],v18,s[56:59],s60 offen sc1
v_permlane16_swap_b32 v44,v46
v_permlane16_swap_b32 v45,v47
buffer_store_dwordx4 v[44:47],v18,s[56:59],s60 offen offset:1024 sc1
s_mov_b32 s18,0x3f803f80
v_mov_b32 v48,0
v_mov_b32 v49,0
v_mov_b32 v50,0
v_mov_b32 v51,0
v_dot2_f32_bf16 v48,v64,s18,v48
v_dot2_f32_bf16 v49,v64,v64,v49
v_dot2_f32_bf16 v50,v72,s18,v50
v_dot2_f32_bf16 v51,v72,v72,v51
v_dot2_f32_bf16 v48,v65,s18,v48
v_dot2_f32_bf16 v49,v65,v65,v49
v_dot2_f32_bf16 v50,v73,s18,v50
v_dot2_f32_bf16 v51,v73,v73,v51
v_dot2_f32_bf16 v48,v66,s18,v48
v_dot2_f32_bf16 v49,v66,v66,v49
v_dot2_f32_bf16 v50,v74,s18,v50
v_dot2_f32_bf16 v51,v74,v74,v51
v_dot2_f32_bf16 v48,v67,s18,v48
v_dot2_f32_bf16 v49,v67,v67,v49
v_dot2_f32_bf16 v50,v75,s18,v50
v_dot2_f32_bf16 v51,v75,v75,v51
v_dot2_f32_bf16 v48,v68,s18,v48
v_dot2_f32_bf16 v49,v68,v68,v49
v_dot2_f32_bf16 v50,v76,s18,v50
v_dot2_f32_bf16 v51,v76,v76,v51
v_dot2_f32_bf16 v48,v69,s18,v48
v_dot2_f32_bf16 v49,v69,v69,v49
v_dot2_f32_bf16 v50,v77,s18,v50
v_dot2_f32_bf16 v51,v77,v77,v51
v_dot2_f32_bf16 v48,v70,s18,v48
v_dot2_f32_bf16 v49,v70,v70,v49
v_dot2_f32_bf16 v50,v78,s18,v50
v_dot2_f32_bf16 v51,v78,v78,v51
v_dot2_f32_bf16 v48,v71,s18,v48
v_dot2_f32_bf16 v49,v71,v71,v49
v_dot2_f32_bf16 v50,v79,s18,v50
v_dot2_f32_bf16 v51,v79,v79,v51
s_nop 2
v_mov_b32 v52,v48
v_mov_b32 v53,v49
v_mov_b32 v54,v50
v_mov_b32 v55,v51
v_permlane32_swap_b32 v48,v52
v_permlane32_swap_b32 v49,v53
v_permlane32_swap_b32 v50,v54
v_permlane32_swap_b32 v51,v55
v_pk_add_f32 v[48:49],v[48:49],v[52:53]
v_pk_add_f32 v[50:51],v[50:51],v[54:55]
v_mov_b32 v52,v48
v_mov_b32 v53,v49
v_mov_b32 v54,v50
v_mov_b32 v55,v51
v_permlane16_swap_b32 v48,v52
v_permlane16_swap_b32 v49,v53
v_permlane16_swap_b32 v50,v54
v_permlane16_swap_b32 v51,v55
v_pk_add_f32 v[48:49],v[48:49],v[52:53]
v_pk_add_f32 v[50:51],v[50:51],v[54:55]
s_mov_b32 s18,80805888
s_mov_b64 exec,0xffff
buffer_store_dwordx2 v[48:49],v19,s[24:27],s18 offen sc1
buffer_store_dwordx2 v[50:51],v19,s[24:27],s18 offen offset:2048 sc1
s_mov_b64 exec,-1
s_mov_b32 s12,s66
s_mov_b32 s13,s67
s_mov_b32 s14,6291456
s_lshl_b32 s18,s20,4
s_lshl_b32 s19,s85,7
v_lshrrev_b32 v3,3,v2
v_add_u32 v3,s18,v3
v_mul_u32_u24 v3,6144,v3
v_add_u32 v3,s19,v3
v_and_b32 v1,1,v31
v_lshlrev_b32 v1,1,v1
v_and_b32 v0,7,v2
v_xor_b32 v1,v1,v0
v_lshl_add_u32 v8,v1,4,v3
v_xor_b32 v1,4,v1
v_lshl_add_u32 v9,v1,4,v3
v_add_u32 v9,48128,v9
s_andn2_b32 s95,s84,1
s_mul_i32 s32,s95,0
s_add_u32 s32,s32,2048
s_add_u32 s33,s32,2048
s_mov_b32 s35,0
s_lshl_b32 s41,s20,11
s_add_u32 s41,s41,16384
s_add_u32 s43,s41,8192
s_waitcnt vmcnt(0)
s_barrier
s_cmp_lg_u32 s20,0
s_cbranch_scc1 Lpub180
s_mov_b32 s18,s84
s_mov_b32 s19,s85
s_lshl_b32 s18,s18,8
s_lshl_b32 s19,s19,2
s_add_u32 s18,s18,s19
s_add_u32 s18,s18,95502336
v_mov_b32 v1,0
v_mov_b32 v3,s94
s_mov_b64 exec,1
buffer_store_dword v3,v1,s[24:27],s18 offen sc1
s_mov_b64 exec,-1
Lpub180:
s_add_u32 m0,s35,s41
s_nop 0
buffer_load_dwordx4 v8,s[12:15],s32 offen lds
buffer_load_dwordx4 v9,s[12:15],s32 offen offset:1024 lds
s_add_u32 m0,s35,s43
s_nop 0
buffer_load_dwordx4 v8,s[12:15],s33 offen lds
buffer_load_dwordx4 v9,s[12:15],s33 offen offset:1024 lds
s_add_u32 s35,s35,32768
s_cmp_eq_u32 s35,163840
s_cselect_b32 s35,0,s35
s_add_u32 s32,s32,393216
s_add_u32 s33,s32,2048
s_add_u32 m0,s35,s41
s_nop 0
buffer_load_dwordx4 v8,s[12:15],s32 offen lds
buffer_load_dwordx4 v9,s[12:15],s32 offen offset:1024 lds
s_add_u32 m0,s35,s43
s_nop 0
buffer_load_dwordx4 v8,s[12:15],s33 offen lds
buffer_load_dwordx4 v9,s[12:15],s33 offen offset:1024 lds
s_add_u32 s35,s35,32768
s_cmp_eq_u32 s35,163840
s_cselect_b32 s35,0,s35
s_add_u32 s32,s32,393216
s_add_u32 s33,s32,2048
s_add_u32 m0,s35,s41
s_nop 0
buffer_load_dwordx4 v8,s[12:15],s32 offen lds
buffer_load_dwordx4 v9,s[12:15],s32 offen offset:1024 lds
s_add_u32 m0,s35,s43
s_nop 0
buffer_load_dwordx4 v8,s[12:15],s33 offen lds
buffer_load_dwordx4 v9,s[12:15],s33 offen offset:1024 lds
s_add_u32 s35,s35,32768
s_cmp_eq_u32 s35,163840
s_cselect_b32 s35,0,s35
s_add_u32 s32,s32,393216
s_add_u32 s33,s32,2048
s_add_u32 m0,s35,s41
s_nop 0
buffer_load_dwordx4 v8,s[12:15],s32 offen lds
buffer_load_dwordx4 v9,s[12:15],s32 offen offset:1024 lds
s_add_u32 m0,s35,s43
s_nop 0
buffer_load_dwordx4 v8,s[12:15],s33 offen lds
buffer_load_dwordx4 v9,s[12:15],s33 offen offset:1024 lds
s_add_u32 s35,s35,32768
s_cmp_eq_u32 s35,163840
s_cselect_b32 s35,0,s35
s_add_u32 s32,s32,393216
s_add_u32 s33,s32,2048
s_add_u32 s8,s16,8454144
s_addc_u32 s9,s17,0
s_mov_b32 s10,4194304
s_lshl_b32 s23,s84,7
s_lshr_b32 s28,s20,1
s_and_b32 s29,s20,1
s_lshl_b32 s18,s20,5
s_add_u32 s18,s18,s23
s_mul_i32 s19,s18,2048
v_lshlrev_b32 v4,4,v2
v_add_u32 v4,s19,v4
v_add_u32 v5,30720,v4
s_mul_i32 s30,s95,0
s_and_b32 s31,s84,1
s_mov_b32 s34,0
s_lshl_b32 s40,s20,12
s_lshl_b32 s18,s28,13
v_lshlrev_b32 v12,4,v2
v_add_u32 v12,s18,v12
v_add_u32 v13,1024,v12
s_mov_b32 s18,16384
s_lshl_b32 s19,s29,2
v_bfe_u32 v1,v2,2,2
v_lshl_add_u32 v3,v31,3,v1
v_lshlrev_b32 v3,7,v3
v_add_u32 v3,s18,v3
v_and_b32 v0,1,v2
v_lshl_add_u32 v3,v0,3,v3
v_and_b32 v1,2,v1
v_and_b32 v0,1,v31
v_lshl_add_u32 v1,v0,2,v1
v_bfe_u32 v0,v2,1,1
v_or_b32 v1,v1,v0
v_xor_b32 v1,s19,v1
v_xor_b32 v0,0,v1
v_lshl_add_u32 v14,v0,4,v3
v_xor_b32 v0,2,v1
v_lshl_add_u32 v15,v0,4,v3
s_lshl_b32 s18,s85,1
s_add_u32 s54,s18,s29
s_lshl_b32 s18,s84,3
s_lshl_b32 s19,s28,2
s_add_u32 s18,s18,s19
s_lshl_b32 s18,s18,11
s_add_u32 s60,s18,80805888
v_lshlrev_b32 v23,11,v31
v_lshl_add_u32 v23,v30,4,v23
s_lshl_b32 s18,s54,5
v_add_u32 v1,s18,v30
v_lshlrev_b32 v24,4,v1
v_mov_b32 v16,v24
v_mul_u32_u24 v1,163840,v31
v_add_u32 v24,v24,v1
s_mov_b32 s62,94371840
s_mov_b32 s63,94388224
s_mov_b32 s55,94404608
v_lshlrev_b32 v25,8,v31
v_lshl_add_u32 v25,v30,1,v25
s_lshl_b32 s45,s54,11
s_lshl_b32 s18,s28,6
v_add_u32 v1,s18,v30
v_mul_u32_u24 v1,352,v1
v_lshrrev_b32 v3,2,v30
v_xor_b32 v3,v3,v31
v_lshl_add_u32 v1,v3,3,v1
s_mul_i32 s18,s29,45056
v_add_u32 v18,s18,v1
v_bfe_u32 v1,v2,2,2
v_lshl_add_u32 v1,v31,2,v1
v_mul_u32_u24 v1,352,v1
v_and_b32 v3,3,v2
v_xor_b32 v3,v3,v31
v_lshl_add_u32 v1,v3,3,v1
v_add_u32 v19,s18,v1
s_lshl_b32 s18,s84,5
s_add_u32 s18,s18,s54
s_mul_i32 s18,s18,8448
s_add_u32 s18,s18,28377088
s_lshl_b32 s19,s28,7
s_add_u32 s19,s19,s18
s_add_u32 s19,s19,8192
v_lshlrev_b32 v1,4,v31
v_add_u32 v22,s19,v1
s_lshl_b32 s19,s28,12
s_add_u32 s18,s18,s19
v_lshlrev_b32 v1,4,v2
v_add_u32 v20,s18,v1
s_lshl_b32 s18,s28,6
s_add_u32 s18,s18,s23
s_lshl_b32 s18,s18,11
s_lshl_b32 s19,s54,10
s_add_u32 s18,s18,s19
s_add_u32 s18,s18,65536
v_lshlrev_b32 v21,4,v30
v_and_b32 v1,1,v31
v_lshl_add_u32 v21,v1,9,v21
v_lshrrev_b32 v1,1,v31
v_lshl_add_u32 v21,v1,8,v21
v_add_u32 v21,s18,v21
s_mov_b32 s36,0
s_mov_b32 s42,0
s_mov_b32 s50,32768
s_mov_b32 s51,0xfffe0000
s_mov_b32 s56,s68
s_mov_b32 s57,s69
s_mov_b32 s58,65536
s_lshr_b32 s18,s84,3
s_lshl_b32 s19,s85,1
s_add_u32 s18,s18,s19
s_mul_i32 s44,s18,6144
s_bfe_u32 s18,s84,0x10002
s_mul_i32 s18,s18,3072
s_add_u32 s44,s44,s18
s_and_b32 s18,s84,1
s_lshl_b32 s18,s18,10
s_add_u32 s44,s44,s18
s_and_b32 s18,s84,2
s_lshl_b32 s18,s18,2
s_add_u32 s44,s44,s18
s_lshr_b32 s18,s84,2
s_add_u32 s18,s18,s19
s_mul_i32 s39,s18,6144
s_bfe_u32 s18,s84,0x10001
s_mul_i32 s18,s18,3072
s_add_u32 s39,s39,s18
s_and_b32 s18,s84,1
s_lshl_b32 s18,s18,3
s_add_u32 s39,s39,s18
s_add_u32 s39,s39,2048
s_lshr_b32 s18,s84,3
s_lshl_b32 s18,s18,2
s_add_u32 s18,s18,s20
s_add_u32 s92,s44,79757312
s_add_u32 s93,s39,79757312
s_cmp_eq_u32 s18,1
s_cselect_b32 s44,s93,s92
buffer_load_dwordx4 a[0:3],v24,s[24:27],s62 offen sc1
buffer_load_dwordx4 a[4:7],v24,s[24:27],s62 offen offset:256 sc1
buffer_load_dwordx4 a[8:11],v24,s[24:27],s63 offen sc1
buffer_load_dwordx4 a[12:15],v24,s[24:27],s63 offen offset:256 sc1
buffer_load_dwordx4 a[16:19],v24,s[24:27],s55 offen sc1
buffer_load_dwordx4 a[20:23],v24,s[24:27],s55 offen offset:256 sc1
buffer_load_ushort v240,v25,s[56:59],s45 offen offset:0
buffer_load_ushort a40,v25,s[56:59],s45 offen offset:64
buffer_load_ushort v241,v25,s[56:59],s45 offen offset:128
buffer_load_ushort a41,v25,s[56:59],s45 offen offset:192
buffer_load_ushort v242,v25,s[56:59],s45 offen offset:1024
buffer_load_ushort a42,v25,s[56:59],s45 offen offset:1088
buffer_load_ushort v243,v25,s[56:59],s45 offen offset:1152
buffer_load_ushort a43,v25,s[56:59],s45 offen offset:1216
buffer_load_ushort v244,v25,s[56:59],s45 offen offset:32
buffer_load_ushort a44,v25,s[56:59],s45 offen offset:96
buffer_load_ushort v245,v25,s[56:59],s45 offen offset:160
buffer_load_ushort a45,v25,s[56:59],s45 offen offset:224
buffer_load_ushort v246,v25,s[56:59],s45 offen offset:1056
buffer_load_ushort a46,v25,s[56:59],s45 offen offset:1120
buffer_load_ushort v247,v25,s[56:59],s45 offen offset:1184
buffer_load_ushort a47,v25,s[56:59],s45 offen offset:1248
s_cmp_lg_u32 s20,0
s_cbranch_scc1 Lwbar181
s_mov_b32 s18,s84
s_lshl_b32 s18,s18,8
s_add_u32 s18,s18,95502336
v_lshlrev_b32 v1,2,v30
v_lshl_add_u32 v1,v31,8,v1
s_mov_b32 exec_lo,0xffff
s_mov_b32 exec_hi,0
s_mov_b32 s39,131072
Lpoll182:
buffer_load_dword v3,v1,s[24:27],s18 offen sc1
s_waitcnt vmcnt(0)
v_cmp_ne_u32 vcc,s94,v3
s_nop 1
s_cmp_eq_u64 vcc,0
s_cbranch_scc1 Lgot183
s_sleep 1
s_sub_u32 s39,s39,1
s_cmp_lg_u32 s39,0
s_cbranch_scc1 Lpoll182
Lgot183:
s_mov_b64 exec,-1
Lwbar181:
s_barrier
s_add_u32 m0,s34,s40
s_nop 0
buffer_load_dwordx4 v4,s[8:11],s30 offen sc1 lds
buffer_load_dwordx4 v4,s[8:11],s30 offen offset:1024 sc1 lds
buffer_load_dwordx4 v5,s[8:11],s30 offen offset:2048 sc1 lds
buffer_load_dwordx4 v5,s[8:11],s30 offen offset:3072 sc1 lds
s_add_u32 s34,s34,32768
s_cmp_eq_u32 s34,163840
s_cselect_b32 s34,0,s34
s_add_u32 s30,s30,2048
s_add_u32 m0,s34,s40
s_nop 0
buffer_load_dwordx4 v4,s[8:11],s30 offen sc1 lds
buffer_load_dwordx4 v4,s[8:11],s30 offen offset:1024 sc1 lds
buffer_load_dwordx4 v5,s[8:11],s30 offen offset:2048 sc1 lds
buffer_load_dwordx4 v5,s[8:11],s30 offen offset:3072 sc1 lds
s_add_u32 s34,s34,32768
s_cmp_eq_u32 s34,163840
s_cselect_b32 s34,0,s34
s_add_u32 s30,s30,2048
s_add_u32 m0,s34,s40
s_nop 0
buffer_load_dwordx4 v4,s[8:11],s30 offen sc1 lds
buffer_load_dwordx4 v4,s[8:11],s30 offen offset:1024 sc1 lds
buffer_load_dwordx4 v5,s[8:11],s30 offen offset:2048 sc1 lds
buffer_load_dwordx4 v5,s[8:11],s30 offen offset:3072 sc1 lds
s_add_u32 s34,s34,32768
s_cmp_eq_u32 s34,163840
s_cselect_b32 s34,0,s34
s_add_u32 s30,s30,2048
s_add_u32 m0,s34,s40
s_nop 0
buffer_load_dwordx4 v4,s[8:11],s30 offen sc1 lds
buffer_load_dwordx4 v4,s[8:11],s30 offen offset:1024 sc1 lds
buffer_load_dwordx4 v5,s[8:11],s30 offen offset:2048 sc1 lds
buffer_load_dwordx4 v5,s[8:11],s30 offen offset:3072 sc1 lds
s_add_u32 s34,s34,32768
s_cmp_eq_u32 s34,163840
s_cselect_b32 s34,0,s34
s_add_u32 s30,s30,2048
s_waitcnt vmcnt(12)
s_barrier
ds_read_b128 v[128:131],v12 offset:0
ds_read_b64_tr_b16 v[144:145],v14 offset:0
ds_read_b64_tr_b16 v[146:147],v14 offset:512
ds_read_b128 v[132:135],v12 offset:2048
ds_read_b128 v[136:139],v12 offset:4096
ds_read_b128 v[140:143],v12 offset:6144
ds_read_b64_tr_b16 v[148:149],v15 offset:0
ds_read_b64_tr_b16 v[150:151],v15 offset:512
ds_read_b64_tr_b16 v[152:153],v14 offset:8192
ds_read_b64_tr_b16 v[154:155],v14 offset:8704
ds_read_b64_tr_b16 v[156:157],v15 offset:8192
ds_read_b64_tr_b16 v[158:159],v15 offset:8704
s_waitcnt lgkmcnt(4)
v_mfma_f32_16x16x32_bf16 v[64:67],v[144:147],v[128:131],0
v_add_u32 v13,s42,v13
ds_read_b128 v[160:163],v13 offset:0
v_mfma_f32_16x16x32_bf16 v[68:71],v[144:147],v[132:135],0
ds_read_b64_tr_b16 v[176:177],v14 offset:4096
s_add_u32 m0,s34,s40
v_mfma_f32_16x16x32_bf16 v[72:75],v[144:147],v[136:139],0
ds_read_b64_tr_b16 v[178:179],v14 offset:4608
buffer_load_dwordx4 v4,s[8:11],s30 offen sc1 lds
v_mfma_f32_16x16x32_bf16 v[76:79],v[144:147],v[140:143],0
ds_read_b128 v[164:167],v13 offset:2048
v_mfma_f32_16x16x32_bf16 v[80:83],v[148:151],v[128:131],0
ds_read_b128 v[168:171],v13 offset:4096
buffer_load_dwordx4 v4,s[8:11],s30 offen offset:1024 sc1 lds
v_mfma_f32_16x16x32_bf16 v[84:87],v[148:151],v[132:135],0
v_mfma_f32_16x16x32_bf16 v[88:91],v[148:151],v[136:139],0
ds_read_b128 v[172:175],v13 offset:6144
buffer_load_dwordx4 v5,s[8:11],s30 offen offset:2048 sc1 lds
v_mfma_f32_16x16x32_bf16 v[92:95],v[148:151],v[140:143],0
ds_read_b64_tr_b16 v[180:181],v15 offset:4096
s_waitcnt lgkmcnt(7)
v_mfma_f32_16x16x32_bf16 v[96:99],v[152:155],v[128:131],0
ds_read_b64_tr_b16 v[182:183],v15 offset:4608
buffer_load_dwordx4 v5,s[8:11],s30 offen offset:3072 sc1 lds
v_mfma_f32_16x16x32_bf16 v[100:103],v[152:155],v[132:135],0
ds_read_b64_tr_b16 v[184:185],v14 offset:12288
ds_read_b64_tr_b16 v[186:187],v14 offset:12800
v_mfma_f32_16x16x32_bf16 v[104:107],v[152:155],v[136:139],0
ds_read_b64_tr_b16 v[188:189],v15 offset:12288
s_add_u32 s34,s34,32768
v_mfma_f32_16x16x32_bf16 v[108:111],v[152:155],v[140:143],0
ds_read_b64_tr_b16 v[190:191],v15 offset:12800
v_mfma_f32_16x16x32_bf16 v[112:115],v[156:159],v[128:131],0
s_cmp_eq_u32 s34,163840
s_cselect_b32 s34,0,s34
v_mfma_f32_16x16x32_bf16 v[116:119],v[156:159],v[132:135],0
s_add_u32 s30,s30,2048
s_add_u32 m0,s35,s41
v_mfma_f32_16x16x32_bf16 v[120:123],v[156:159],v[136:139],0
buffer_load_dwordx4 v8,s[12:15],s32 offen lds
buffer_load_dwordx4 v9,s[12:15],s32 offen offset:1024 lds
v_mfma_f32_16x16x32_bf16 v[124:127],v[156:159],v[140:143],0
s_waitcnt lgkmcnt(4)
v_mfma_f32_16x16x32_bf16 v[64:67],v[176:179],v[160:163],v[64:67]
s_add_u32 s36,s36,32768
v_mfma_f32_16x16x32_bf16 v[68:71],v[176:179],v[164:167],v[68:71]
v_mfma_f32_16x16x32_bf16 v[72:75],v[176:179],v[168:171],v[72:75]
s_cmp_eq_u32 s36,163840
s_cselect_b32 s42,s51,s50
s_cselect_b32 s36,0,s36
v_add_u32 v12,s42,v12
v_add_u32 v14,s42,v14
v_add_u32 v15,s42,v15
s_waitcnt vmcnt(14)
s_waitcnt lgkmcnt(0)
s_barrier
ds_read_b128 v[128:131],v12 offset:0
v_mfma_f32_16x16x32_bf16 v[76:79],v[176:179],v[172:175],v[76:79]
ds_read_b64_tr_b16 v[144:145],v14 offset:0
ds_read_b64_tr_b16 v[146:147],v14 offset:512
v_mfma_f32_16x16x32_bf16 v[80:83],v[180:183],v[160:163],v[80:83]
ds_read_b128 v[132:135],v12 offset:2048
s_add_u32 m0,s35,s43
v_mfma_f32_16x16x32_bf16 v[84:87],v[180:183],v[164:167],v[84:87]
ds_read_b128 v[136:139],v12 offset:4096
buffer_load_dwordx4 v8,s[12:15],s33 offen lds
v_mfma_f32_16x16x32_bf16 v[88:91],v[180:183],v[168:171],v[88:91]
buffer_load_dwordx4 v9,s[12:15],s33 offen offset:1024 lds
s_add_u32 s35,s35,32768
v_mfma_f32_16x16x32_bf16 v[92:95],v[180:183],v[172:175],v[92:95]
ds_read_b128 v[140:143],v12 offset:6144
v_mfma_f32_16x16x32_bf16 v[96:99],v[184:187],v[160:163],v[96:99]
ds_read_b64_tr_b16 v[148:149],v15 offset:0
ds_read_b64_tr_b16 v[150:151],v15 offset:512
v_mfma_f32_16x16x32_bf16 v[100:103],v[184:187],v[164:167],v[100:103]
ds_read_b64_tr_b16 v[152:153],v14 offset:8192
v_mfma_f32_16x16x32_bf16 v[104:107],v[184:187],v[168:171],v[104:107]
ds_read_b64_tr_b16 v[154:155],v14 offset:8704
ds_read_b64_tr_b16 v[156:157],v15 offset:8192
v_mfma_f32_16x16x32_bf16 v[108:111],v[184:187],v[172:175],v[108:111]
ds_read_b64_tr_b16 v[158:159],v15 offset:8704
v_mfma_f32_16x16x32_bf16 v[112:115],v[188:191],v[160:163],v[112:115]
s_cmp_eq_u32 s35,163840
s_cselect_b32 s35,0,s35
v_mfma_f32_16x16x32_bf16 v[116:119],v[188:191],v[164:167],v[116:119]
s_add_u32 s32,s32,393216
s_add_u32 s33,s32,2048
v_mfma_f32_16x16x32_bf16 v[120:123],v[188:191],v[168:171],v[120:123]
s_add_u32 m0,s34,s40
s_nop 0
buffer_load_dwordx4 v4,s[8:11],s30 offen sc1 lds
v_mfma_f32_16x16x32_bf16 v[124:127],v[188:191],v[172:175],v[124:127]
buffer_load_dwordx4 v4,s[8:11],s30 offen offset:1024 sc1 lds
buffer_load_dwordx4 v5,s[8:11],s30 offen offset:2048 sc1 lds
buffer_load_dwordx4 v5,s[8:11],s30 offen offset:3072 sc1 lds
s_add_u32 s34,s34,32768
s_cmp_eq_u32 s34,163840
s_cselect_b32 s34,0,s34
s_add_u32 s30,s30,2048
s_waitcnt lgkmcnt(4)
v_mfma_f32_16x16x32_bf16 v[64:67],v[144:147],v[128:131],v[64:67]
v_add_u32 v13,s42,v13
ds_read_b128 v[160:163],v13 offset:0
v_mfma_f32_16x16x32_bf16 v[68:71],v[144:147],v[132:135],v[68:71]
ds_read_b64_tr_b16 v[176:177],v14 offset:4096
s_add_u32 m0,s35,s41
v_mfma_f32_16x16x32_bf16 v[72:75],v[144:147],v[136:139],v[72:75]
ds_read_b64_tr_b16 v[178:179],v14 offset:4608
buffer_load_dwordx4 v8,s[12:15],s32 offen lds
v_mfma_f32_16x16x32_bf16 v[76:79],v[144:147],v[140:143],v[76:79]
ds_read_b128 v[164:167],v13 offset:2048
v_mfma_f32_16x16x32_bf16 v[80:83],v[148:151],v[128:131],v[80:83]
ds_read_b128 v[168:171],v13 offset:4096
v_mfma_f32_16x16x32_bf16 v[84:87],v[148:151],v[132:135],v[84:87]
buffer_load_dwordx4 v9,s[12:15],s32 offen offset:1024 lds
s_add_u32 m0,s35,s43
v_mfma_f32_16x16x32_bf16 v[88:91],v[148:151],v[136:139],v[88:91]
ds_read_b128 v[172:175],v13 offset:6144
v_mfma_f32_16x16x32_bf16 v[92:95],v[148:151],v[140:143],v[92:95]
ds_read_b64_tr_b16 v[180:181],v15 offset:4096
s_waitcnt lgkmcnt(7)
v_mfma_f32_16x16x32_bf16 v[96:99],v[152:155],v[128:131],v[96:99]
ds_read_b64_tr_b16 v[182:183],v15 offset:4608
buffer_load_dwordx4 v8,s[12:15],s33 offen lds
v_mfma_f32_16x16x32_bf16 v[100:103],v[152:155],v[132:135],v[100:103]
ds_read_b64_tr_b16 v[184:185],v14 offset:12288
ds_read_b64_tr_b16 v[186:187],v14 offset:12800
v_mfma_f32_16x16x32_bf16 v[104:107],v[152:155],v[136:139],v[104:107]
ds_read_b64_tr_b16 v[188:189],v15 offset:12288
v_mfma_f32_16x16x32_bf16 v[108:111],v[152:155],v[140:143],v[108:111]
ds_read_b64_tr_b16 v[190:191],v15 offset:12800
buffer_load_dwordx4 v9,s[12:15],s33 offen offset:1024 lds
v_mfma_f32_16x16x32_bf16 v[112:115],v[156:159],v[128:131],v[112:115]
s_add_u32 s35,s35,32768
v_mfma_f32_16x16x32_bf16 v[116:119],v[156:159],v[132:135],v[116:119]
s_cmp_eq_u32 s35,163840
s_cselect_b32 s35,0,s35
v_mfma_f32_16x16x32_bf16 v[120:123],v[156:159],v[136:139],v[120:123]
s_add_u32 s32,s32,393216
s_add_u32 s33,s32,2048
v_mfma_f32_16x16x32_bf16 v[124:127],v[156:159],v[140:143],v[124:127]
s_waitcnt lgkmcnt(4)
v_mfma_f32_16x16x32_bf16 v[64:67],v[176:179],v[160:163],v[64:67]
s_add_u32 s36,s36,32768
v_mfma_f32_16x16x32_bf16 v[68:71],v[176:179],v[164:167],v[68:71]
v_mfma_f32_16x16x32_bf16 v[72:75],v[176:179],v[168:171],v[72:75]
s_cmp_eq_u32 s36,163840
s_cselect_b32 s42,s51,s50
s_cselect_b32 s36,0,s36
v_add_u32 v12,s42,v12
v_add_u32 v14,s42,v14
v_add_u32 v15,s42,v15
s_waitcnt vmcnt(20)
s_waitcnt lgkmcnt(0)
s_barrier
ds_read_b128 v[128:131],v12 offset:0
v_mfma_f32_16x16x32_bf16 v[76:79],v[176:179],v[172:175],v[76:79]
ds_read_b64_tr_b16 v[144:145],v14 offset:0
ds_read_b64_tr_b16 v[146:147],v14 offset:512
v_mfma_f32_16x16x32_bf16 v[80:83],v[180:183],v[160:163],v[80:83]
ds_read_b128 v[132:135],v12 offset:2048
s_add_u32 m0,s34,s40
v_mfma_f32_16x16x32_bf16 v[84:87],v[180:183],v[164:167],v[84:87]
ds_read_b128 v[136:139],v12 offset:4096
buffer_load_dwordx4 v4,s[8:11],s30 offen sc1 lds
v_mfma_f32_16x16x32_bf16 v[88:91],v[180:183],v[168:171],v[88:91]
buffer_load_dwordx4 v4,s[8:11],s30 offen offset:1024 sc1 lds
v_mfma_f32_16x16x32_bf16 v[92:95],v[180:183],v[172:175],v[92:95]
ds_read_b128 v[140:143],v12 offset:6144
buffer_load_dwordx4 v5,s[8:11],s30 offen offset:2048 sc1 lds
v_mfma_f32_16x16x32_bf16 v[96:99],v[184:187],v[160:163],v[96:99]
ds_read_b64_tr_b16 v[148:149],v15 offset:0
ds_read_b64_tr_b16 v[150:151],v15 offset:512
v_mfma_f32_16x16x32_bf16 v[100:103],v[184:187],v[164:167],v[100:103]
ds_read_b64_tr_b16 v[152:153],v14 offset:8192
buffer_load_dwordx4 v5,s[8:11],s30 offen offset:3072 sc1 lds
v_mfma_f32_16x16x32_bf16 v[104:107],v[184:187],v[168:171],v[104:107]
ds_read_b64_tr_b16 v[154:155],v14 offset:8704
ds_read_b64_tr_b16 v[156:157],v15 offset:8192
v_mfma_f32_16x16x32_bf16 v[108:111],v[184:187],v[172:175],v[108:111]
ds_read_b64_tr_b16 v[158:159],v15 offset:8704
s_add_u32 s34,s34,32768
v_mfma_f32_16x16x32_bf16 v[112:115],v[188:191],v[160:163],v[112:115]
s_cmp_eq_u32 s34,163840
s_cselect_b32 s34,0,s34
v_mfma_f32_16x16x32_bf16 v[116:119],v[188:191],v[164:167],v[116:119]
s_add_u32 s30,s30,2048
s_add_u32 m0,s35,s41
v_mfma_f32_16x16x32_bf16 v[120:123],v[188:191],v[168:171],v[120:123]
buffer_load_dwordx4 v8,s[12:15],s32 offen lds
buffer_load_dwordx4 v9,s[12:15],s32 offen offset:1024 lds
v_mfma_f32_16x16x32_bf16 v[124:127],v[188:191],v[172:175],v[124:127]
s_mov_b32 s38,3
Lp1L184_0:
s_waitcnt lgkmcnt(4)
v_mfma_f32_16x16x32_bf16 v[64:67],v[144:147],v[128:131],v[64:67]
v_add_u32 v13,s42,v13
ds_read_b128 v[160:163],v13 offset:0
v_mfma_f32_16x16x32_bf16 v[68:71],v[144:147],v[132:135],v[68:71]
ds_read_b64_tr_b16 v[176:177],v14 offset:4096
s_add_u32 m0,s35,s43
v_mfma_f32_16x16x32_bf16 v[72:75],v[144:147],v[136:139],v[72:75]
ds_read_b64_tr_b16 v[178:179],v14 offset:4608
buffer_load_dwordx4 v8,s[12:15],s33 offen lds
v_mfma_f32_16x16x32_bf16 v[76:79],v[144:147],v[140:143],v[76:79]
ds_read_b128 v[164:167],v13 offset:2048
v_mfma_f32_16x16x32_bf16 v[80:83],v[148:151],v[128:131],v[80:83]
ds_read_b128 v[168:171],v13 offset:4096
v_mfma_f32_16x16x32_bf16 v[84:87],v[148:151],v[132:135],v[84:87]
v_mfma_f32_16x16x32_bf16 v[88:91],v[148:151],v[136:139],v[88:91]
ds_read_b128 v[172:175],v13 offset:6144
v_mfma_f32_16x16x32_bf16 v[92:95],v[148:151],v[140:143],v[92:95]
ds_read_b64_tr_b16 v[180:181],v15 offset:4096
s_waitcnt lgkmcnt(7)
v_mfma_f32_16x16x32_bf16 v[96:99],v[152:155],v[128:131],v[96:99]
ds_read_b64_tr_b16 v[182:183],v15 offset:4608
buffer_load_dwordx4 v9,s[12:15],s33 offen offset:1024 lds
v_mfma_f32_16x16x32_bf16 v[100:103],v[152:155],v[132:135],v[100:103]
ds_read_b64_tr_b16 v[184:185],v14 offset:12288
ds_read_b64_tr_b16 v[186:187],v14 offset:12800
v_mfma_f32_16x16x32_bf16 v[104:107],v[152:155],v[136:139],v[104:107]
ds_read_b64_tr_b16 v[188:189],v15 offset:12288
s_add_u32 s35,s35,32768
v_mfma_f32_16x16x32_bf16 v[108:111],v[152:155],v[140:143],v[108:111]
ds_read_b64_tr_b16 v[190:191],v15 offset:12800
v_mfma_f32_16x16x32_bf16 v[112:115],v[156:159],v[128:131],v[112:115]
s_cmp_eq_u32 s35,163840
s_cselect_b32 s35,0,s35
v_mfma_f32_16x16x32_bf16 v[116:119],v[156:159],v[132:135],v[116:119]
s_add_u32 s32,s32,393216
s_add_u32 s33,s32,2048
v_mfma_f32_16x16x32_bf16 v[120:123],v[156:159],v[136:139],v[120:123]
v_mfma_f32_16x16x32_bf16 v[124:127],v[156:159],v[140:143],v[124:127]
s_waitcnt lgkmcnt(4)
v_mfma_f32_16x16x32_bf16 v[64:67],v[176:179],v[160:163],v[64:67]
s_add_u32 s36,s36,32768
v_mfma_f32_16x16x32_bf16 v[68:71],v[176:179],v[164:167],v[68:71]
v_mfma_f32_16x16x32_bf16 v[72:75],v[176:179],v[168:171],v[72:75]
s_cmp_eq_u32 s36,163840
s_cselect_b32 s42,s51,s50
s_cselect_b32 s36,0,s36
v_add_u32 v12,s42,v12
v_add_u32 v14,s42,v14
v_add_u32 v15,s42,v15
s_waitcnt vmcnt(24)
s_waitcnt lgkmcnt(0)
s_barrier
ds_read_b128 v[128:131],v12 offset:0
v_mfma_f32_16x16x32_bf16 v[76:79],v[176:179],v[172:175],v[76:79]
ds_read_b64_tr_b16 v[144:145],v14 offset:0
ds_read_b64_tr_b16 v[146:147],v14 offset:512
v_mfma_f32_16x16x32_bf16 v[80:83],v[180:183],v[160:163],v[80:83]
ds_read_b128 v[132:135],v12 offset:2048
s_add_u32 m0,s34,s40
v_mfma_f32_16x16x32_bf16 v[84:87],v[180:183],v[164:167],v[84:87]
ds_read_b128 v[136:139],v12 offset:4096
buffer_load_dwordx4 v4,s[8:11],s30 offen sc1 lds
v_mfma_f32_16x16x32_bf16 v[88:91],v[180:183],v[168:171],v[88:91]
buffer_load_dwordx4 v4,s[8:11],s30 offen offset:1024 sc1 lds
v_mfma_f32_16x16x32_bf16 v[92:95],v[180:183],v[172:175],v[92:95]
ds_read_b128 v[140:143],v12 offset:6144
buffer_load_dwordx4 v5,s[8:11],s30 offen offset:2048 sc1 lds
v_mfma_f32_16x16x32_bf16 v[96:99],v[184:187],v[160:163],v[96:99]
ds_read_b64_tr_b16 v[148:149],v15 offset:0
ds_read_b64_tr_b16 v[150:151],v15 offset:512
v_mfma_f32_16x16x32_bf16 v[100:103],v[184:187],v[164:167],v[100:103]
ds_read_b64_tr_b16 v[152:153],v14 offset:8192
buffer_load_dwordx4 v5,s[8:11],s30 offen offset:3072 sc1 lds
v_mfma_f32_16x16x32_bf16 v[104:107],v[184:187],v[168:171],v[104:107]
ds_read_b64_tr_b16 v[154:155],v14 offset:8704
ds_read_b64_tr_b16 v[156:157],v15 offset:8192
v_mfma_f32_16x16x32_bf16 v[108:111],v[184:187],v[172:175],v[108:111]
ds_read_b64_tr_b16 v[158:159],v15 offset:8704
s_add_u32 s34,s34,32768
v_mfma_f32_16x16x32_bf16 v[112:115],v[188:191],v[160:163],v[112:115]
s_cmp_eq_u32 s34,163840
s_cselect_b32 s34,0,s34
v_mfma_f32_16x16x32_bf16 v[116:119],v[188:191],v[164:167],v[116:119]
s_add_u32 s30,s30,2048
s_add_u32 m0,s35,s41
v_mfma_f32_16x16x32_bf16 v[120:123],v[188:191],v[168:171],v[120:123]
buffer_load_dwordx4 v8,s[12:15],s32 offen lds
buffer_load_dwordx4 v9,s[12:15],s32 offen offset:1024 lds
v_mfma_f32_16x16x32_bf16 v[124:127],v[188:191],v[172:175],v[124:127]
s_sub_u32 s38,s38,1
s_cmp_lg_u32 s38,0
s_cbranch_scc1 Lp1L184_0
s_waitcnt lgkmcnt(4)
v_mfma_f32_16x16x32_bf16 v[64:67],v[144:147],v[128:131],v[64:67]
v_add_u32 v13,s42,v13
ds_read_b128 v[160:163],v13 offset:0
v_mfma_f32_16x16x32_bf16 v[68:71],v[144:147],v[132:135],v[68:71]
ds_read_b64_tr_b16 v[176:177],v14 offset:4096
s_add_u32 m0,s35,s43
v_mfma_f32_16x16x32_bf16 v[72:75],v[144:147],v[136:139],v[72:75]
ds_read_b64_tr_b16 v[178:179],v14 offset:4608
buffer_load_dwordx4 v8,s[12:15],s33 offen lds
v_mfma_f32_16x16x32_bf16 v[76:79],v[144:147],v[140:143],v[76:79]
ds_read_b128 v[164:167],v13 offset:2048
v_mfma_f32_16x16x32_bf16 v[80:83],v[148:151],v[128:131],v[80:83]
ds_read_b128 v[168:171],v13 offset:4096
v_mfma_f32_16x16x32_bf16 v[84:87],v[148:151],v[132:135],v[84:87]
v_mfma_f32_16x16x32_bf16 v[88:91],v[148:151],v[136:139],v[88:91]
ds_read_b128 v[172:175],v13 offset:6144
v_mfma_f32_16x16x32_bf16 v[92:95],v[148:151],v[140:143],v[92:95]
ds_read_b64_tr_b16 v[180:181],v15 offset:4096
s_waitcnt lgkmcnt(7)
v_mfma_f32_16x16x32_bf16 v[96:99],v[152:155],v[128:131],v[96:99]
ds_read_b64_tr_b16 v[182:183],v15 offset:4608
buffer_load_dwordx4 v9,s[12:15],s33 offen offset:1024 lds
v_mfma_f32_16x16x32_bf16 v[100:103],v[152:155],v[132:135],v[100:103]
ds_read_b64_tr_b16 v[184:185],v14 offset:12288
ds_read_b64_tr_b16 v[186:187],v14 offset:12800
v_mfma_f32_16x16x32_bf16 v[104:107],v[152:155],v[136:139],v[104:107]
ds_read_b64_tr_b16 v[188:189],v15 offset:12288
s_add_u32 s35,s35,32768
v_mfma_f32_16x16x32_bf16 v[108:111],v[152:155],v[140:143],v[108:111]
ds_read_b64_tr_b16 v[190:191],v15 offset:12800
v_mfma_f32_16x16x32_bf16 v[112:115],v[156:159],v[128:131],v[112:115]
s_cmp_eq_u32 s35,163840
s_cselect_b32 s35,0,s35
v_mfma_f32_16x16x32_bf16 v[116:119],v[156:159],v[132:135],v[116:119]
s_add_u32 s32,s32,393216
s_add_u32 s33,s32,2048
v_mfma_f32_16x16x32_bf16 v[120:123],v[156:159],v[136:139],v[120:123]
v_mfma_f32_16x16x32_bf16 v[124:127],v[156:159],v[140:143],v[124:127]
s_waitcnt lgkmcnt(4)
v_mfma_f32_16x16x32_bf16 v[64:67],v[176:179],v[160:163],v[64:67]
s_add_u32 s36,s36,32768
v_mfma_f32_16x16x32_bf16 v[68:71],v[176:179],v[164:167],v[68:71]
v_mfma_f32_16x16x32_bf16 v[72:75],v[176:179],v[168:171],v[72:75]
s_cmp_eq_u32 s36,163840
s_cselect_b32 s42,s51,s50
s_cselect_b32 s36,0,s36
v_add_u32 v12,s42,v12
v_add_u32 v14,s42,v14
v_add_u32 v15,s42,v15
s_waitcnt vmcnt(24)
s_waitcnt lgkmcnt(0)
s_barrier
ds_read_b128 v[128:131],v12 offset:0
v_mfma_f32_16x16x32_bf16 v[76:79],v[176:179],v[172:175],v[76:79]
ds_read_b64_tr_b16 v[144:145],v14 offset:0
ds_read_b64_tr_b16 v[146:147],v14 offset:512
v_mfma_f32_16x16x32_bf16 v[80:83],v[180:183],v[160:163],v[80:83]
ds_read_b128 v[132:135],v12 offset:2048
s_add_u32 m0,s34,s40
v_mfma_f32_16x16x32_bf16 v[84:87],v[180:183],v[164:167],v[84:87]
ds_read_b128 v[136:139],v12 offset:4096
buffer_load_dwordx4 v4,s[8:11],s30 offen sc1 lds
v_mfma_f32_16x16x32_bf16 v[88:91],v[180:183],v[168:171],v[88:91]
buffer_load_dwordx4 v4,s[8:11],s30 offen offset:1024 sc1 lds
v_mfma_f32_16x16x32_bf16 v[92:95],v[180:183],v[172:175],v[92:95]
ds_read_b128 v[140:143],v12 offset:6144
v_mfma_f32_16x16x32_bf16 v[96:99],v[184:187],v[160:163],v[96:99]
ds_read_b64_tr_b16 v[148:149],v15 offset:0
ds_read_b64_tr_b16 v[150:151],v15 offset:512
v_mfma_f32_16x16x32_bf16 v[100:103],v[184:187],v[164:167],v[100:103]
ds_read_b64_tr_b16 v[152:153],v14 offset:8192
buffer_load_dwordx4 v5,s[8:11],s30 offen offset:2048 sc1 lds
v_mfma_f32_16x16x32_bf16 v[104:107],v[184:187],v[168:171],v[104:107]
ds_read_b64_tr_b16 v[154:155],v14 offset:8704
ds_read_b64_tr_b16 v[156:157],v15 offset:8192
v_mfma_f32_16x16x32_bf16 v[108:111],v[184:187],v[172:175],v[108:111]
ds_read_b64_tr_b16 v[158:159],v15 offset:8704
v_mfma_f32_16x16x32_bf16 v[112:115],v[188:191],v[160:163],v[112:115]
buffer_load_dwordx4 v5,s[8:11],s30 offen offset:3072 sc1 lds
s_add_u32 s34,s34,32768
v_mfma_f32_16x16x32_bf16 v[116:119],v[188:191],v[164:167],v[116:119]
s_cmp_eq_u32 s34,163840
s_cselect_b32 s34,0,s34
v_mfma_f32_16x16x32_bf16 v[120:123],v[188:191],v[168:171],v[120:123]
s_add_u32 s30,s30,2048
v_mfma_f32_16x16x32_bf16 v[124:127],v[188:191],v[172:175],v[124:127]
s_mov_b32 s38,4
Lp1L184_1:
s_waitcnt lgkmcnt(4)
v_mfma_f32_16x16x32_bf16 v[64:67],v[144:147],v[128:131],v[64:67]
v_add_u32 v13,s42,v13
ds_read_b128 v[160:163],v13 offset:0
v_mfma_f32_16x16x32_bf16 v[68:71],v[144:147],v[132:135],v[68:71]
ds_read_b64_tr_b16 v[176:177],v14 offset:4096
s_add_u32 m0,s35,s41
v_mfma_f32_16x16x32_bf16 v[72:75],v[144:147],v[136:139],v[72:75]
ds_read_b64_tr_b16 v[178:179],v14 offset:4608
buffer_load_dwordx4 v8,s[12:15],s32 offen lds
v_mfma_f32_16x16x32_bf16 v[76:79],v[144:147],v[140:143],v[76:79]
ds_read_b128 v[164:167],v13 offset:2048
v_mfma_f32_16x16x32_bf16 v[80:83],v[148:151],v[128:131],v[80:83]
ds_read_b128 v[168:171],v13 offset:4096
v_mfma_f32_16x16x32_bf16 v[84:87],v[148:151],v[132:135],v[84:87]
buffer_load_dwordx4 v9,s[12:15],s32 offen offset:1024 lds
s_add_u32 m0,s35,s43
v_mfma_f32_16x16x32_bf16 v[88:91],v[148:151],v[136:139],v[88:91]
ds_read_b128 v[172:175],v13 offset:6144
v_mfma_f32_16x16x32_bf16 v[92:95],v[148:151],v[140:143],v[92:95]
ds_read_b64_tr_b16 v[180:181],v15 offset:4096
s_waitcnt lgkmcnt(7)
v_mfma_f32_16x16x32_bf16 v[96:99],v[152:155],v[128:131],v[96:99]
ds_read_b64_tr_b16 v[182:183],v15 offset:4608
buffer_load_dwordx4 v8,s[12:15],s33 offen lds
v_mfma_f32_16x16x32_bf16 v[100:103],v[152:155],v[132:135],v[100:103]
ds_read_b64_tr_b16 v[184:185],v14 offset:12288
ds_read_b64_tr_b16 v[186:187],v14 offset:12800
v_mfma_f32_16x16x32_bf16 v[104:107],v[152:155],v[136:139],v[104:107]
ds_read_b64_tr_b16 v[188:189],v15 offset:12288
v_mfma_f32_16x16x32_bf16 v[108:111],v[152:155],v[140:143],v[108:111]
ds_read_b64_tr_b16 v[190:191],v15 offset:12800
buffer_load_dwordx4 v9,s[12:15],s33 offen offset:1024 lds
v_mfma_f32_16x16x32_bf16 v[112:115],v[156:159],v[128:131],v[112:115]
s_add_u32 s35,s35,32768
v_mfma_f32_16x16x32_bf16 v[116:119],v[156:159],v[132:135],v[116:119]
s_cmp_eq_u32 s35,163840
s_cselect_b32 s35,0,s35
v_mfma_f32_16x16x32_bf16 v[120:123],v[156:159],v[136:139],v[120:123]
s_add_u32 s32,s32,393216
s_add_u32 s33,s32,2048
v_mfma_f32_16x16x32_bf16 v[124:127],v[156:159],v[140:143],v[124:127]
s_waitcnt lgkmcnt(4)
v_mfma_f32_16x16x32_bf16 v[64:67],v[176:179],v[160:163],v[64:67]
s_add_u32 s36,s36,32768
v_mfma_f32_16x16x32_bf16 v[68:71],v[176:179],v[164:167],v[68:71]
v_mfma_f32_16x16x32_bf16 v[72:75],v[176:179],v[168:171],v[72:75]
s_cmp_eq_u32 s36,163840
s_cselect_b32 s42,s51,s50
s_cselect_b32 s36,0,s36
v_add_u32 v12,s42,v12
v_add_u32 v14,s42,v14
v_add_u32 v15,s42,v15
s_waitcnt vmcnt(24)
s_waitcnt lgkmcnt(0)
s_barrier
ds_read_b128 v[128:131],v12 offset:0
v_mfma_f32_16x16x32_bf16 v[76:79],v[176:179],v[172:175],v[76:79]
ds_read_b64_tr_b16 v[144:145],v14 offset:0
ds_read_b64_tr_b16 v[146:147],v14 offset:512
v_mfma_f32_16x16x32_bf16 v[80:83],v[180:183],v[160:163],v[80:83]
ds_read_b128 v[132:135],v12 offset:2048
s_add_u32 m0,s34,s40
v_mfma_f32_16x16x32_bf16 v[84:87],v[180:183],v[164:167],v[84:87]
ds_read_b128 v[136:139],v12 offset:4096
buffer_load_dwordx4 v4,s[8:11],s30 offen sc1 lds
v_mfma_f32_16x16x32_bf16 v[88:91],v[180:183],v[168:171],v[88:91]
buffer_load_dwordx4 v4,s[8:11],s30 offen offset:1024 sc1 lds
v_mfma_f32_16x16x32_bf16 v[92:95],v[180:183],v[172:175],v[92:95]
ds_read_b128 v[140:143],v12 offset:6144
v_mfma_f32_16x16x32_bf16 v[96:99],v[184:187],v[160:163],v[96:99]
ds_read_b64_tr_b16 v[148:149],v15 offset:0
ds_read_b64_tr_b16 v[150:151],v15 offset:512
v_mfma_f32_16x16x32_bf16 v[100:103],v[184:187],v[164:167],v[100:103]
ds_read_b64_tr_b16 v[152:153],v14 offset:8192
buffer_load_dwordx4 v5,s[8:11],s30 offen offset:2048 sc1 lds
v_mfma_f32_16x16x32_bf16 v[104:107],v[184:187],v[168:171],v[104:107]
ds_read_b64_tr_b16 v[154:155],v14 offset:8704
ds_read_b64_tr_b16 v[156:157],v15 offset:8192
v_mfma_f32_16x16x32_bf16 v[108:111],v[184:187],v[172:175],v[108:111]
ds_read_b64_tr_b16 v[158:159],v15 offset:8704
v_mfma_f32_16x16x32_bf16 v[112:115],v[188:191],v[160:163],v[112:115]
buffer_load_dwordx4 v5,s[8:11],s30 offen offset:3072 sc1 lds
s_add_u32 s34,s34,32768
v_mfma_f32_16x16x32_bf16 v[116:119],v[188:191],v[164:167],v[116:119]
s_cmp_eq_u32 s34,163840
s_cselect_b32 s34,0,s34
v_mfma_f32_16x16x32_bf16 v[120:123],v[188:191],v[168:171],v[120:123]
s_add_u32 s30,s30,2048
v_mfma_f32_16x16x32_bf16 v[124:127],v[188:191],v[172:175],v[124:127]
s_sub_u32 s38,s38,1
s_cmp_lg_u32 s38,0
s_cbranch_scc1 Lp1L184_1
s_waitcnt lgkmcnt(4)
v_mfma_f32_16x16x32_bf16 v[64:67],v[144:147],v[128:131],v[64:67]
v_add_u32 v13,s42,v13
ds_read_b128 v[160:163],v13 offset:0
v_mfma_f32_16x16x32_bf16 v[68:71],v[144:147],v[132:135],v[68:71]
ds_read_b64_tr_b16 v[176:177],v14 offset:4096
s_add_u32 m0,s35,s41
v_mfma_f32_16x16x32_bf16 v[72:75],v[144:147],v[136:139],v[72:75]
ds_read_b64_tr_b16 v[178:179],v14 offset:4608
buffer_load_dwordx4 v8,s[12:15],s32 offen lds
v_mfma_f32_16x16x32_bf16 v[76:79],v[144:147],v[140:143],v[76:79]
ds_read_b128 v[164:167],v13 offset:2048
v_mfma_f32_16x16x32_bf16 v[80:83],v[148:151],v[128:131],v[80:83]
ds_read_b128 v[168:171],v13 offset:4096
v_mfma_f32_16x16x32_bf16 v[84:87],v[148:151],v[132:135],v[84:87]
buffer_load_dwordx4 v9,s[12:15],s32 offen offset:1024 lds
s_add_u32 m0,s35,s43
v_mfma_f32_16x16x32_bf16 v[88:91],v[148:151],v[136:139],v[88:91]
ds_read_b128 v[172:175],v13 offset:6144
v_mfma_f32_16x16x32_bf16 v[92:95],v[148:151],v[140:143],v[92:95]
ds_read_b64_tr_b16 v[180:181],v15 offset:4096
s_waitcnt lgkmcnt(7)
v_mfma_f32_16x16x32_bf16 v[96:99],v[152:155],v[128:131],v[96:99]
ds_read_b64_tr_b16 v[182:183],v15 offset:4608
buffer_load_dwordx4 v8,s[12:15],s33 offen lds
v_mfma_f32_16x16x32_bf16 v[100:103],v[152:155],v[132:135],v[100:103]
ds_read_b64_tr_b16 v[184:185],v14 offset:12288
ds_read_b64_tr_b16 v[186:187],v14 offset:12800
v_mfma_f32_16x16x32_bf16 v[104:107],v[152:155],v[136:139],v[104:107]
ds_read_b64_tr_b16 v[188:189],v15 offset:12288
v_mfma_f32_16x16x32_bf16 v[108:111],v[152:155],v[140:143],v[108:111]
ds_read_b64_tr_b16 v[190:191],v15 offset:12800
buffer_load_dwordx4 v9,s[12:15],s33 offen offset:1024 lds
v_mfma_f32_16x16x32_bf16 v[112:115],v[156:159],v[128:131],v[112:115]
s_add_u32 s35,s35,32768
v_mfma_f32_16x16x32_bf16 v[116:119],v[156:159],v[132:135],v[116:119]
s_cmp_eq_u32 s35,163840
s_cselect_b32 s35,0,s35
v_mfma_f32_16x16x32_bf16 v[120:123],v[156:159],v[136:139],v[120:123]
s_add_u32 s32,s32,393216
s_add_u32 s33,s32,2048
v_mfma_f32_16x16x32_bf16 v[124:127],v[156:159],v[140:143],v[124:127]
s_waitcnt lgkmcnt(4)
v_mfma_f32_16x16x32_bf16 v[64:67],v[176:179],v[160:163],v[64:67]
s_add_u32 s36,s36,32768
v_mfma_f32_16x16x32_bf16 v[68:71],v[176:179],v[164:167],v[68:71]
v_mfma_f32_16x16x32_bf16 v[72:75],v[176:179],v[168:171],v[72:75]
s_cmp_eq_u32 s36,163840
s_cselect_b32 s42,s51,s50
s_cselect_b32 s36,0,s36
v_add_u32 v12,s42,v12
v_add_u32 v14,s42,v14
v_add_u32 v15,s42,v15
s_waitcnt vmcnt(24)
s_waitcnt lgkmcnt(0)
s_barrier
ds_read_b128 a[68:71],v12 offset:0
v_mfma_f32_16x16x32_bf16 v[76:79],v[176:179],v[172:175],v[76:79]
ds_read_b64_tr_b16 v[144:145],v14 offset:0
ds_read_b64_tr_b16 v[146:147],v14 offset:512
v_mfma_f32_16x16x32_bf16 v[80:83],v[180:183],v[160:163],v[80:83]
ds_read_b128 a[72:75],v12 offset:2048
s_add_u32 m0,s34,s40
v_mfma_f32_16x16x32_bf16 v[84:87],v[180:183],v[164:167],v[84:87]
ds_read_b128 a[76:79],v12 offset:4096
buffer_load_dwordx4 v4,s[8:11],s30 offen sc1 lds
v_mfma_f32_16x16x32_bf16 v[88:91],v[180:183],v[168:171],v[88:91]
buffer_load_dwordx4 v4,s[8:11],s30 offen offset:1024 sc1 lds
v_mfma_f32_16x16x32_bf16 v[92:95],v[180:183],v[172:175],v[92:95]
ds_read_b128 a[80:83],v12 offset:6144
v_mfma_f32_16x16x32_bf16 v[96:99],v[184:187],v[160:163],v[96:99]
ds_read_b64_tr_b16 v[148:149],v15 offset:0
ds_read_b64_tr_b16 v[150:151],v15 offset:512
v_mfma_f32_16x16x32_bf16 v[100:103],v[184:187],v[164:167],v[100:103]
ds_read_b64_tr_b16 v[152:153],v14 offset:8192
buffer_load_dwordx4 v5,s[8:11],s30 offen offset:2048 sc1 lds
v_mfma_f32_16x16x32_bf16 v[104:107],v[184:187],v[168:171],v[104:107]
ds_read_b64_tr_b16 v[154:155],v14 offset:8704
ds_read_b64_tr_b16 v[156:157],v15 offset:8192
v_mfma_f32_16x16x32_bf16 v[108:111],v[184:187],v[172:175],v[108:111]
ds_read_b64_tr_b16 v[158:159],v15 offset:8704
v_mfma_f32_16x16x32_bf16 v[112:115],v[188:191],v[160:163],v[112:115]
buffer_load_dwordx4 v5,s[8:11],s30 offen offset:3072 sc1 lds
s_add_u32 s34,s34,32768
v_mfma_f32_16x16x32_bf16 v[116:119],v[188:191],v[164:167],v[116:119]
s_cmp_eq_u32 s34,163840
s_cselect_b32 s34,0,s34
v_mfma_f32_16x16x32_bf16 v[120:123],v[188:191],v[168:171],v[120:123]
s_add_u32 s30,s30,2048
v_mfma_f32_16x16x32_bf16 v[124:127],v[188:191],v[172:175],v[124:127]
s_waitcnt lgkmcnt(4)
v_mfma_f32_16x16x32_bf16 v[64:67],v[144:147],a[68:71],v[64:67]
v_add_u32 v13,s42,v13
ds_read_b128 a[84:87],v13 offset:0
v_mfma_f32_16x16x32_bf16 v[68:71],v[144:147],a[72:75],v[68:71]
ds_read_b64_tr_b16 v[176:177],v14 offset:4096
s_add_u32 m0,s35,s41
v_mfma_f32_16x16x32_bf16 v[72:75],v[144:147],a[76:79],v[72:75]
ds_read_b64_tr_b16 v[178:179],v14 offset:4608
buffer_load_dwordx4 v8,s[12:15],s32 offen lds
v_mfma_f32_16x16x32_bf16 v[76:79],v[144:147],a[80:83],v[76:79]
ds_read_b128 a[88:91],v13 offset:2048
v_mfma_f32_16x16x32_bf16 v[80:83],v[148:151],a[68:71],v[80:83]
ds_read_b128 a[92:95],v13 offset:4096
v_mfma_f32_16x16x32_bf16 v[84:87],v[148:151],a[72:75],v[84:87]
buffer_load_dwordx4 v9,s[12:15],s32 offen offset:1024 lds
s_add_u32 m0,s35,s43
v_mfma_f32_16x16x32_bf16 v[88:91],v[148:151],a[76:79],v[88:91]
ds_read_b128 a[96:99],v13 offset:6144
v_mfma_f32_16x16x32_bf16 v[92:95],v[148:151],a[80:83],v[92:95]
ds_read_b64_tr_b16 v[180:181],v15 offset:4096
s_waitcnt lgkmcnt(7)
v_mfma_f32_16x16x32_bf16 v[96:99],v[152:155],a[68:71],v[96:99]
ds_read_b64_tr_b16 v[182:183],v15 offset:4608
buffer_load_dwordx4 v8,s[12:15],s33 offen lds
v_mfma_f32_16x16x32_bf16 v[100:103],v[152:155],a[72:75],v[100:103]
ds_read_b64_tr_b16 v[184:185],v14 offset:12288
ds_read_b64_tr_b16 v[186:187],v14 offset:12800
v_mfma_f32_16x16x32_bf16 v[104:107],v[152:155],a[76:79],v[104:107]
ds_read_b64_tr_b16 v[188:189],v15 offset:12288
v_mfma_f32_16x16x32_bf16 v[108:111],v[152:155],a[80:83],v[108:111]
ds_read_b64_tr_b16 v[190:191],v15 offset:12800
buffer_load_dwordx4 v9,s[12:15],s33 offen offset:1024 lds
v_mfma_f32_16x16x32_bf16 v[112:115],v[156:159],a[68:71],v[112:115]
s_add_u32 s35,s35,32768
v_mfma_f32_16x16x32_bf16 v[116:119],v[156:159],a[72:75],v[116:119]
s_cmp_eq_u32 s35,163840
s_cselect_b32 s35,0,s35
v_mfma_f32_16x16x32_bf16 v[120:123],v[156:159],a[76:79],v[120:123]
s_add_u32 s32,s32,393216
s_add_u32 s33,s32,2048
v_mfma_f32_16x16x32_bf16 v[124:127],v[156:159],a[80:83],v[124:127]
s_waitcnt lgkmcnt(4)
v_mfma_f32_16x16x32_bf16 v[64:67],v[176:179],a[84:87],v[64:67]
s_add_u32 s36,s36,32768
v_mfma_f32_16x16x32_bf16 v[68:71],v[176:179],a[88:91],v[68:71]
v_mfma_f32_16x16x32_bf16 v[72:75],v[176:179],a[92:95],v[72:75]
s_cmp_eq_u32 s36,163840
s_cselect_b32 s42,s51,s50
s_cselect_b32 s36,0,s36
v_add_u32 v12,s42,v12
v_add_u32 v14,s42,v14
v_add_u32 v15,s42,v15
s_waitcnt vmcnt(24)
s_waitcnt lgkmcnt(0)
s_barrier
ds_read_b128 a[100:103],v12 offset:0
v_mfma_f32_16x16x32_bf16 v[76:79],v[176:179],a[96:99],v[76:79]
ds_read_b64_tr_b16 v[144:145],v14 offset:0
ds_read_b64_tr_b16 v[146:147],v14 offset:512
v_mfma_f32_16x16x32_bf16 v[80:83],v[180:183],a[84:87],v[80:83]
ds_read_b128 a[104:107],v12 offset:2048
buffer_load_dwordx4 v[208:211],v23,s[24:27],s60 offen sc1
v_mfma_f32_16x16x32_bf16 v[84:87],v[180:183],a[88:91],v[84:87]
ds_read_b128 a[108:111],v12 offset:4096
v_mfma_f32_16x16x32_bf16 v[88:91],v[180:183],a[92:95],v[88:91]
v_mfma_f32_16x16x32_bf16 v[92:95],v[180:183],a[96:99],v[92:95]
ds_read_b128 a[112:115],v12 offset:6144
buffer_load_dwordx4 v[212:215],v23,s[24:27],s60 offen offset:256 sc1
v_mfma_f32_16x16x32_bf16 v[96:99],v[184:187],a[84:87],v[96:99]
ds_read_b64_tr_b16 v[148:149],v15 offset:0
ds_read_b64_tr_b16 v[150:151],v15 offset:512
v_mfma_f32_16x16x32_bf16 v[100:103],v[184:187],a[88:91],v[100:103]
ds_read_b64_tr_b16 v[152:153],v14 offset:8192
v_mfma_f32_16x16x32_bf16 v[104:107],v[184:187],a[92:95],v[104:107]
ds_read_b64_tr_b16 v[154:155],v14 offset:8704
ds_read_b64_tr_b16 v[156:157],v15 offset:8192
v_mfma_f32_16x16x32_bf16 v[108:111],v[184:187],a[96:99],v[108:111]
ds_read_b64_tr_b16 v[158:159],v15 offset:8704
buffer_load_dwordx4 v[216:219],v23,s[24:27],s60 offen offset:512 sc1
v_mfma_f32_16x16x32_bf16 v[112:115],v[188:191],a[84:87],v[112:115]
v_mfma_f32_16x16x32_bf16 v[116:119],v[188:191],a[88:91],v[116:119]
v_mfma_f32_16x16x32_bf16 v[120:123],v[188:191],a[92:95],v[120:123]
v_mfma_f32_16x16x32_bf16 v[124:127],v[188:191],a[96:99],v[124:127]
s_waitcnt lgkmcnt(4)
v_mfma_f32_16x16x32_bf16 v[64:67],v[144:147],a[100:103],v[64:67]
v_add_u32 v13,s42,v13
ds_read_b128 a[116:119],v13 offset:0
v_mfma_f32_16x16x32_bf16 v[68:71],v[144:147],a[104:107],v[68:71]
ds_read_b64_tr_b16 v[176:177],v14 offset:4096
v_mfma_f32_16x16x32_bf16 v[72:75],v[144:147],a[108:111],v[72:75]
ds_read_b64_tr_b16 v[178:179],v14 offset:4608
buffer_load_dwordx4 v[220:223],v23,s[24:27],s60 offen offset:768 sc1
v_mfma_f32_16x16x32_bf16 v[76:79],v[144:147],a[112:115],v[76:79]
ds_read_b128 a[120:123],v13 offset:2048
v_mfma_f32_16x16x32_bf16 v[80:83],v[148:151],a[100:103],v[80:83]
ds_read_b128 a[124:127],v13 offset:4096
v_mfma_f32_16x16x32_bf16 v[84:87],v[148:151],a[104:107],v[84:87]
v_mfma_f32_16x16x32_bf16 v[88:91],v[148:151],a[108:111],v[88:91]
ds_read_b128 a[128:131],v13 offset:6144
buffer_load_dwordx4 v[224:227],v23,s[24:27],s60 offen offset:1024 sc1
v_mfma_f32_16x16x32_bf16 v[92:95],v[148:151],a[112:115],v[92:95]
ds_read_b64_tr_b16 v[180:181],v15 offset:4096
s_waitcnt lgkmcnt(7)
v_mfma_f32_16x16x32_bf16 v[96:99],v[152:155],a[100:103],v[96:99]
ds_read_b64_tr_b16 v[182:183],v15 offset:4608
v_mfma_f32_16x16x32_bf16 v[100:103],v[152:155],a[104:107],v[100:103]
ds_read_b64_tr_b16 v[184:185],v14 offset:12288
ds_read_b64_tr_b16 v[186:187],v14 offset:12800
v_mfma_f32_16x16x32_bf16 v[104:107],v[152:155],a[108:111],v[104:107]
ds_read_b64_tr_b16 v[188:189],v15 offset:12288
buffer_load_dwordx4 v[228:231],v23,s[24:27],s60 offen offset:1280 sc1
v_mfma_f32_16x16x32_bf16 v[108:111],v[152:155],a[112:115],v[108:111]
ds_read_b64_tr_b16 v[190:191],v15 offset:12800
v_mfma_f32_16x16x32_bf16 v[112:115],v[156:159],a[100:103],v[112:115]
v_mfma_f32_16x16x32_bf16 v[116:119],v[156:159],a[104:107],v[116:119]
v_mfma_f32_16x16x32_bf16 v[120:123],v[156:159],a[108:111],v[120:123]
v_mfma_f32_16x16x32_bf16 v[124:127],v[156:159],a[112:115],v[124:127]
s_waitcnt lgkmcnt(4)
v_mfma_f32_16x16x32_bf16 v[64:67],v[176:179],a[116:119],v[64:67]
s_add_u32 s36,s36,32768
v_mfma_f32_16x16x32_bf16 v[68:71],v[176:179],a[120:123],v[68:71]
v_mfma_f32_16x16x32_bf16 v[72:75],v[176:179],a[124:127],v[72:75]
s_cmp_eq_u32 s36,163840
s_cselect_b32 s42,s51,s50
s_cselect_b32 s36,0,s36
v_add_u32 v12,s42,v12
v_add_u32 v14,s42,v14
v_add_u32 v15,s42,v15
s_waitcnt vmcnt(22)
s_waitcnt lgkmcnt(0)
s_barrier
ds_read_b128 a[132:135],v12 offset:0
v_mfma_f32_16x16x32_bf16 v[76:79],v[176:179],a[128:131],v[76:79]
ds_read_b64_tr_b16 v[144:145],v14 offset:0
ds_read_b64_tr_b16 v[146:147],v14 offset:512
v_mfma_f32_16x16x32_bf16 v[80:83],v[180:183],a[116:119],v[80:83]
ds_read_b128 a[136:139],v12 offset:2048
buffer_load_dwordx4 v[232:235],v23,s[24:27],s60 offen offset:1536 sc1
v_mfma_f32_16x16x32_bf16 v[84:87],v[180:183],a[120:123],v[84:87]
ds_read_b128 a[140:143],v12 offset:4096
v_mfma_f32_16x16x32_bf16 v[88:91],v[180:183],a[124:127],v[88:91]
v_mfma_f32_16x16x32_bf16 v[92:95],v[180:183],a[128:131],v[92:95]
ds_read_b128 a[144:147],v12 offset:6144
v_mfma_f32_16x16x32_bf16 v[96:99],v[184:187],a[116:119],v[96:99]
ds_read_b64_tr_b16 v[148:149],v15 offset:0
ds_read_b64_tr_b16 v[150:151],v15 offset:512
v_mfma_f32_16x16x32_bf16 v[100:103],v[184:187],a[120:123],v[100:103]
ds_read_b64_tr_b16 v[152:153],v14 offset:8192
buffer_load_dwordx4 v[236:239],v23,s[24:27],s60 offen offset:1792 sc1
v_mfma_f32_16x16x32_bf16 v[104:107],v[184:187],a[124:127],v[104:107]
ds_read_b64_tr_b16 v[154:155],v14 offset:8704
ds_read_b64_tr_b16 v[156:157],v15 offset:8192
v_mfma_f32_16x16x32_bf16 v[108:111],v[184:187],a[128:131],v[108:111]
ds_read_b64_tr_b16 v[158:159],v15 offset:8704
v_mfma_f32_16x16x32_bf16 v[112:115],v[188:191],a[116:119],v[112:115]
v_mfma_f32_16x16x32_bf16 v[116:119],v[188:191],a[120:123],v[116:119]
v_mfma_f32_16x16x32_bf16 v[120:123],v[188:191],a[124:127],v[120:123]
v_mfma_f32_16x16x32_bf16 v[124:127],v[188:191],a[128:131],v[124:127]
s_waitcnt lgkmcnt(4)
v_mfma_f32_16x16x32_bf16 v[64:67],v[144:147],a[132:135],v[64:67]
v_add_u32 v13,s42,v13
ds_read_b128 a[148:151],v13 offset:0
v_mfma_f32_16x16x32_bf16 v[68:71],v[144:147],a[136:139],v[68:71]
ds_read_b64_tr_b16 v[176:177],v14 offset:4096
v_mfma_f32_16x16x32_bf16 v[72:75],v[144:147],a[140:143],v[72:75]
ds_read_b64_tr_b16 v[178:179],v14 offset:4608
v_mfma_f32_16x16x32_bf16 v[76:79],v[144:147],a[144:147],v[76:79]
ds_read_b128 a[152:155],v13 offset:2048
v_mfma_f32_16x16x32_bf16 v[80:83],v[148:151],a[132:135],v[80:83]
ds_read_b128 a[156:159],v13 offset:4096
v_mfma_f32_16x16x32_bf16 v[84:87],v[148:151],a[136:139],v[84:87]
v_mfma_f32_16x16x32_bf16 v[88:91],v[148:151],a[140:143],v[88:91]
ds_read_b128 a[160:163],v13 offset:6144
v_mfma_f32_16x16x32_bf16 v[92:95],v[148:151],a[144:147],v[92:95]
ds_read_b64_tr_b16 v[180:181],v15 offset:4096
s_waitcnt lgkmcnt(7)
v_mfma_f32_16x16x32_bf16 v[96:99],v[152:155],a[132:135],v[96:99]
ds_read_b64_tr_b16 v[182:183],v15 offset:4608
v_mfma_f32_16x16x32_bf16 v[100:103],v[152:155],a[136:139],v[100:103]
ds_read_b64_tr_b16 v[184:185],v14 offset:12288
ds_read_b64_tr_b16 v[186:187],v14 offset:12800
v_mfma_f32_16x16x32_bf16 v[104:107],v[152:155],a[140:143],v[104:107]
ds_read_b64_tr_b16 v[188:189],v15 offset:12288
v_mfma_f32_16x16x32_bf16 v[108:111],v[152:155],a[144:147],v[108:111]
ds_read_b64_tr_b16 v[190:191],v15 offset:12800
v_mfma_f32_16x16x32_bf16 v[112:115],v[156:159],a[132:135],v[112:115]
v_mfma_f32_16x16x32_bf16 v[116:119],v[156:159],a[136:139],v[116:119]
v_mfma_f32_16x16x32_bf16 v[120:123],v[156:159],a[140:143],v[120:123]
v_mfma_f32_16x16x32_bf16 v[124:127],v[156:159],a[144:147],v[124:127]
s_waitcnt lgkmcnt(4)
v_mfma_f32_16x16x32_bf16 v[64:67],v[176:179],a[148:151],v[64:67]
s_add_u32 s36,s36,32768
v_mfma_f32_16x16x32_bf16 v[68:71],v[176:179],a[152:155],v[68:71]
v_mfma_f32_16x16x32_bf16 v[72:75],v[176:179],a[156:159],v[72:75]
s_cmp_eq_u32 s36,163840
s_cselect_b32 s42,s51,s50
s_cselect_b32 s36,0,s36
v_add_u32 v12,s42,v12
v_add_u32 v14,s42,v14
v_add_u32 v15,s42,v15
s_waitcnt vmcnt(0)
s_waitcnt lgkmcnt(0)
s_barrier
ds_read_b128 a[164:167],v12 offset:0
v_mfma_f32_16x16x32_bf16 v[76:79],v[176:179],a[160:163],v[76:79]
ds_read_b64_tr_b16 v[144:145],v14 offset:0
ds_read_b64_tr_b16 v[146:147],v14 offset:512
v_accvgpr_read_b32 v26,a40
v_mfma_f32_16x16x32_bf16 v[80:83],v[180:183],a[148:151],v[80:83]
ds_read_b128 a[168:171],v12 offset:2048
s_add_u32 s31,s95,11
v_lshl_or_b32 v240,v26,16,v240
v_mfma_f32_16x16x32_bf16 v[84:87],v[180:183],a[152:155],v[84:87]
ds_read_b128 a[172:175],v12 offset:4096
s_and_b32 s31,s31,15
v_accvgpr_read_b32 v26,a41
v_mfma_f32_16x16x32_bf16 v[88:91],v[180:183],a[156:159],v[88:91]
s_mov_b32 s31,11
s_mul_i32 s31,s31,393216
v_lshl_or_b32 v241,v26,16,v241
v_accvgpr_read_b32 v26,a42
v_mfma_f32_16x16x32_bf16 v[92:95],v[180:183],a[160:163],v[92:95]
ds_read_b128 a[176:179],v12 offset:6144
s_lshl_b32 s53,s20,11
v_lshl_or_b32 v242,v26,16,v242
v_mfma_f32_16x16x32_bf16 v[96:99],v[184:187],a[148:151],v[96:99]
ds_read_b64_tr_b16 v[148:149],v15 offset:0
ds_read_b64_tr_b16 v[150:151],v15 offset:512
v_accvgpr_read_b32 v26,a43
v_mfma_f32_16x16x32_bf16 v[100:103],v[184:187],a[152:155],v[100:103]
ds_read_b64_tr_b16 v[152:153],v14 offset:8192
s_add_u32 s53,s53,32768
v_lshl_or_b32 v243,v26,16,v243
v_mfma_f32_16x16x32_bf16 v[104:107],v[184:187],a[156:159],v[104:107]
ds_read_b64_tr_b16 v[154:155],v14 offset:8704
ds_read_b64_tr_b16 v[156:157],v15 offset:8192
v_accvgpr_read_b32 v26,a44
v_mfma_f32_16x16x32_bf16 v[108:111],v[184:187],a[160:163],v[108:111]
ds_read_b64_tr_b16 v[158:159],v15 offset:8704
s_add_u32 m0,s53,0
v_lshl_or_b32 v244,v26,16,v244
v_mfma_f32_16x16x32_bf16 v[112:115],v[188:191],a[148:151],v[112:115]
buffer_load_dwordx4 v8,s[12:15],s31 offen lds
buffer_load_dwordx4 v9,s[12:15],s31 offen offset:1024 lds
v_accvgpr_read_b32 v26,a45
v_mfma_f32_16x16x32_bf16 v[116:119],v[188:191],a[152:155],v[116:119]
s_add_u32 s31,s31,393216
v_lshl_or_b32 v245,v26,16,v245
v_accvgpr_read_b32 v26,a46
v_mfma_f32_16x16x32_bf16 v[120:123],v[188:191],a[156:159],v[120:123]
s_cmp_eq_u32 s31,6291456
s_cselect_b32 s31,0,s31
v_lshl_or_b32 v246,v26,16,v246
v_accvgpr_read_b32 v26,a47
v_mfma_f32_16x16x32_bf16 v[124:127],v[188:191],a[160:163],v[124:127]
s_add_u32 m0,s53,8192
s_nop 0
buffer_load_dwordx4 v8,s[12:15],s31 offen lds
buffer_load_dwordx4 v9,s[12:15],s31 offen offset:1024 lds
s_add_u32 s31,s31,393216
s_cmp_eq_u32 s31,6291456
s_cselect_b32 s31,0,s31
v_mov_b32 v252,-1
v_mov_b32 v253,-1
v_mov_b32 v254,-1
v_mov_b32 v255,-1
v_lshlrev_b32 v29,4,v2
buffer_store_dwordx2 v[252:253],v29,s[24:27],s44 offen sc1
v_lshl_or_b32 v247,v26,16,v247
v_add_f32 v208,v208,v224
v_add_f32 v209,v209,v225
v_add_f32 v210,v210,v226
s_waitcnt lgkmcnt(4)
v_mfma_f32_16x16x32_bf16 v[64:67],v[144:147],a[164:167],v[64:67]
v_add_u32 v13,s42,v13
ds_read_b128 a[180:183],v13 offset:0
v_mfma_f32_16x16x32_bf16 v[68:71],v[144:147],a[168:171],v[68:71]
ds_read_b64_tr_b16 v[176:177],v14 offset:4096
s_add_u32 m0,s53,16384
v_add_f32 v211,v211,v227
v_mfma_f32_16x16x32_bf16 v[72:75],v[144:147],a[172:175],v[72:75]
ds_read_b64_tr_b16 v[178:179],v14 offset:4608
buffer_load_dwordx4 v8,s[12:15],s31 offen lds
v_add_f32 v212,v212,v228
v_mfma_f32_16x16x32_bf16 v[76:79],v[144:147],a[176:179],v[76:79]
ds_read_b128 a[184:187],v13 offset:2048
v_add_f32 v213,v213,v229
v_add_f32 v214,v214,v230
v_mfma_f32_16x16x32_bf16 v[80:83],v[148:151],a[164:167],v[80:83]
ds_read_b128 a[188:191],v13 offset:4096
v_add_f32 v215,v215,v231
v_add_f32 v216,v216,v232
v_mfma_f32_16x16x32_bf16 v[84:87],v[148:151],a[168:171],v[84:87]
buffer_load_dwordx4 v9,s[12:15],s31 offen offset:1024 lds
s_add_u32 s31,s31,393216
v_add_f32 v217,v217,v233
v_mfma_f32_16x16x32_bf16 v[88:91],v[148:151],a[172:175],v[88:91]
ds_read_b128 a[192:195],v13 offset:6144
v_add_f32 v218,v218,v234
v_add_f32 v219,v219,v235
v_mfma_f32_16x16x32_bf16 v[92:95],v[148:151],a[176:179],v[92:95]
ds_read_b64_tr_b16 v[180:181],v15 offset:4096
v_add_f32 v220,v220,v236
v_add_f32 v221,v221,v237
s_waitcnt lgkmcnt(7)
v_mfma_f32_16x16x32_bf16 v[96:99],v[152:155],a[164:167],v[96:99]
ds_read_b64_tr_b16 v[182:183],v15 offset:4608
v_add_f32 v222,v222,v238
v_add_f32 v223,v223,v239
v_mfma_f32_16x16x32_bf16 v[100:103],v[152:155],a[168:171],v[100:103]
ds_read_b64_tr_b16 v[184:185],v14 offset:12288
ds_read_b64_tr_b16 v[186:187],v14 offset:12800
v_add_f32 v208,v208,v216
v_mfma_f32_16x16x32_bf16 v[104:107],v[152:155],a[172:175],v[104:107]
ds_read_b64_tr_b16 v[188:189],v15 offset:12288
v_add_f32 v209,v209,v217
v_add_f32 v210,v210,v218
v_mfma_f32_16x16x32_bf16 v[108:111],v[152:155],a[176:179],v[108:111]
ds_read_b64_tr_b16 v[190:191],v15 offset:12800
v_add_f32 v211,v211,v219
v_add_f32 v212,v212,v220
v_mfma_f32_16x16x32_bf16 v[112:115],v[156:159],a[164:167],v[112:115]
s_cmp_eq_u32 s31,6291456
s_cselect_b32 s31,0,s31
v_add_f32 v213,v213,v221
v_mfma_f32_16x16x32_bf16 v[116:119],v[156:159],a[168:171],v[116:119]
s_add_u32 m0,s53,24576
s_nop 0
buffer_load_dwordx4 v8,s[12:15],s31 offen lds
v_mfma_f32_16x16x32_bf16 v[120:123],v[156:159],a[172:175],v[120:123]
buffer_load_dwordx4 v9,s[12:15],s31 offen offset:1024 lds
s_add_u32 s31,s31,393216
v_mfma_f32_16x16x32_bf16 v[124:127],v[156:159],a[176:179],v[124:127]
s_cmp_eq_u32 s31,6291456
s_cselect_b32 s31,0,s31
s_waitcnt lgkmcnt(4)
v_mfma_f32_16x16x32_bf16 v[64:67],v[176:179],a[180:183],v[64:67]
s_add_u32 s36,s36,32768
v_mfma_f32_16x16x32_bf16 v[68:71],v[176:179],a[184:187],v[68:71]
v_mfma_f32_16x16x32_bf16 v[72:75],v[176:179],a[188:191],v[72:75]
s_cmp_eq_u32 s36,163840
s_cselect_b32 s42,s51,s50
s_cselect_b32 s36,0,s36
v_add_u32 v12,s42,v12
v_add_u32 v14,s42,v14
v_add_u32 v15,s42,v15
s_waitcnt vmcnt(9)
s_waitcnt lgkmcnt(0)
s_barrier
ds_read_b128 a[196:199],v12 offset:0
v_mfma_f32_16x16x32_bf16 v[76:79],v[176:179],a[192:195],v[76:79]
ds_read_b64_tr_b16 v[144:145],v14 offset:0
ds_read_b64_tr_b16 v[146:147],v14 offset:512
v_add_f32 v214,v214,v222
v_mfma_f32_16x16x32_bf16 v[80:83],v[180:183],a[180:183],v[80:83]
ds_read_b128 a[200:203],v12 offset:2048
s_add_u32 m0,s53,32768
v_add_f32 v215,v215,v223
v_mfma_f32_16x16x32_bf16 v[84:87],v[180:183],a[184:187],v[84:87]
ds_read_b128 a[204:207],v12 offset:4096
buffer_load_dwordx4 v8,s[12:15],s31 offen lds
v_add_f32 v208,v208,v212
v_mfma_f32_16x16x32_bf16 v[88:91],v[180:183],a[188:191],v[88:91]
v_add_f32 v209,v209,v213
v_add_f32 v210,v210,v214
v_add_f32 v211,v211,v215
v_mfma_f32_16x16x32_bf16 v[92:95],v[180:183],a[192:195],v[92:95]
ds_read_b128 a[208:211],v12 offset:6144
v_add_f32 v208,v208,v210
v_add_f32 v209,v209,v211
v_mfma_f32_16x16x32_bf16 v[96:99],v[184:187],a[180:183],v[96:99]
ds_read_b64_tr_b16 v[148:149],v15 offset:0
ds_read_b64_tr_b16 v[150:151],v15 offset:512
v_mul_f32 v208,s46,v208
v_mfma_f32_16x16x32_bf16 v[100:103],v[184:187],a[184:187],v[100:103]
ds_read_b64_tr_b16 v[152:153],v14 offset:8192
buffer_load_dwordx4 v9,s[12:15],s31 offen offset:1024 lds
v_mul_f32 v209,s46,v209
v_mfma_f32_16x16x32_bf16 v[104:107],v[184:187],a[188:191],v[104:107]
ds_read_b64_tr_b16 v[154:155],v14 offset:8704
ds_read_b64_tr_b16 v[156:157],v15 offset:8192
v_fma_f32 v209,-v208,v208,v209
v_mfma_f32_16x16x32_bf16 v[108:111],v[184:187],a[192:195],v[108:111]
ds_read_b64_tr_b16 v[158:159],v15 offset:8704
s_add_u32 s31,s31,393216
v_max_f32 v209,0,v209
v_mfma_f32_16x16x32_bf16 v[112:115],v[188:191],a[180:183],v[112:115]
s_cmp_eq_u32 s31,6291456
s_cselect_b32 s31,0,s31
v_cvt_pk_bf16_f32 v210,v209,v209
v_mfma_f32_16x16x32_bf16 v[116:119],v[188:191],a[184:187],v[116:119]
v_cvt_pk_bf16_f32 v216,-v208,-v208
v_and_b32 v210,0xffff0000,v210
v_add_f32 v210,s47,v210
v_mfma_f32_16x16x32_bf16 v[120:123],v[188:191],a[188:191],v[120:123]
v_cvt_pk_bf16_f32 v210,v210,v210
v_mov_b32 v217,v216
v_mfma_f32_16x16x32_bf16 v[124:127],v[188:191],a[192:195],v[124:127]
s_waitcnt lgkmcnt(4)
v_mfma_f32_16x16x32_bf16 v[64:67],v[144:147],a[196:199],v[64:67]
v_add_u32 v13,s42,v13
ds_read_b128 a[212:215],v13 offset:0
v_mfma_f32_16x16x32_bf16 v[68:71],v[144:147],a[200:203],v[68:71]
ds_read_b64_tr_b16 v[176:177],v14 offset:4096
v_and_b32 v210,0xffff0000,v210
v_mfma_f32_16x16x32_bf16 v[72:75],v[144:147],a[204:207],v[72:75]
ds_read_b64_tr_b16 v[178:179],v14 offset:4608
v_sqrt_f32 v210,v210
v_mfma_f32_16x16x32_bf16 v[76:79],v[144:147],a[208:211],v[76:79]
ds_read_b128 a[216:219],v13 offset:2048
v_permlane16_swap_b32 v216,v217
v_mfma_f32_16x16x32_bf16 v[80:83],v[148:151],a[196:199],v[80:83]
ds_read_b128 a[220:223],v13 offset:4096
v_cvt_pk_bf16_f32 v210,v210,v210
v_and_b32 v248,0xffff0000,v210
v_mfma_f32_16x16x32_bf16 v[84:87],v[148:151],a[200:203],v[84:87]
v_mov_b32 v218,v216
v_mov_b32 v219,v217
v_mov_b32 v249,v248
v_mfma_f32_16x16x32_bf16 v[88:91],v[148:151],a[204:207],v[88:91]
ds_read_b128 a[224:227],v13 offset:6144
v_permlane32_swap_b32 v216,v218
v_mfma_f32_16x16x32_bf16 v[92:95],v[148:151],a[208:211],v[92:95]
ds_read_b64_tr_b16 v[180:181],v15 offset:4096
v_permlane32_swap_b32 v217,v219
s_waitcnt lgkmcnt(7)
v_mfma_f32_16x16x32_bf16 v[96:99],v[152:155],a[196:199],v[96:99]
ds_read_b64_tr_b16 v[182:183],v15 offset:4608
v_permlane16_swap_b32 v248,v249
v_mfma_f32_16x16x32_bf16 v[100:103],v[152:155],a[200:203],v[100:103]
ds_read_b64_tr_b16 v[184:185],v14 offset:12288
ds_read_b64_tr_b16 v[186:187],v14 offset:12800
v_mov_b32 v250,v248
v_mfma_f32_16x16x32_bf16 v[104:107],v[152:155],a[204:207],v[104:107]
ds_read_b64_tr_b16 v[188:189],v15 offset:12288
v_mov_b32 v251,v249
s_nop 0
v_mfma_f32_16x16x32_bf16 v[108:111],v[152:155],a[208:211],v[108:111]
ds_read_b64_tr_b16 v[190:191],v15 offset:12800
v_permlane32_swap_b32 v248,v250
v_mfma_f32_16x16x32_bf16 v[112:115],v[156:159],a[196:199],v[112:115]
v_permlane32_swap_b32 v249,v251
v_mfma_f32_16x16x32_bf16 v[116:119],v[156:159],a[200:203],v[116:119]
v_rcp_f32 v248,v248
v_mfma_f32_16x16x32_bf16 v[120:123],v[156:159],a[204:207],v[120:123]
v_rcp_f32 v249,v249
v_mfma_f32_16x16x32_bf16 v[124:127],v[156:159],a[208:211],v[124:127]
s_waitcnt lgkmcnt(4)
v_mfma_f32_16x16x32_bf16 v[64:67],v[176:179],a[212:215],v[64:67]
v_mfma_f32_16x16x32_bf16 v[68:71],v[176:179],a[216:219],v[68:71]
v_mfma_f32_16x16x32_bf16 v[72:75],v[176:179],a[220:223],v[72:75]
v_mfma_f32_16x16x32_bf16 v[76:79],v[176:179],a[224:227],v[76:79]
v_rcp_f32 v250,v250
v_mfma_f32_16x16x32_bf16 v[80:83],v[180:183],a[212:215],v[80:83]
v_rcp_f32 v251,v251
v_mfma_f32_16x16x32_bf16 v[84:87],v[180:183],a[216:219],v[84:87]
v_accvgpr_write_b32 a24,v216
v_accvgpr_write_b32 a25,v216
v_mfma_f32_16x16x32_bf16 v[88:91],v[180:183],a[220:223],v[88:91]
v_accvgpr_write_b32 a26,v216
v_accvgpr_write_b32 a27,v216
v_mfma_f32_16x16x32_bf16 v[92:95],v[180:183],a[224:227],v[92:95]
v_accvgpr_write_b32 a28,v217
v_accvgpr_write_b32 a29,v217
s_waitcnt lgkmcnt(0)
v_mfma_f32_16x16x32_bf16 v[96:99],v[184:187],a[212:215],v[96:99]
v_accvgpr_write_b32 a30,v217
v_accvgpr_write_b32 a31,v217
v_mfma_f32_16x16x32_bf16 v[100:103],v[184:187],a[216:219],v[100:103]
v_accvgpr_write_b32 a32,v218
v_accvgpr_write_b32 a33,v218
v_mfma_f32_16x16x32_bf16 v[104:107],v[184:187],a[220:223],v[104:107]
v_accvgpr_write_b32 a34,v218
v_accvgpr_write_b32 a35,v218
v_mfma_f32_16x16x32_bf16 v[108:111],v[184:187],a[224:227],v[108:111]
v_accvgpr_write_b32 a36,v219
v_accvgpr_write_b32 a37,v219
v_mfma_f32_16x16x32_bf16 v[112:115],v[188:191],a[212:215],v[112:115]
v_accvgpr_write_b32 a38,v219
v_accvgpr_write_b32 a39,v219
v_mfma_f32_16x16x32_bf16 v[116:119],v[188:191],a[216:219],v[116:119]
v_mfma_f32_16x16x32_bf16 v[120:123],v[188:191],a[220:223],v[120:123]
v_mfma_f32_16x16x32_bf16 v[124:127],v[188:191],a[224:227],v[124:127]
v_mfma_f32_16x16x32_bf16 v[64:67],a[8:11],a[24:27],v[64:67]
v_mfma_f32_16x16x32_bf16 v[68:71],a[8:11],a[28:31],v[68:71]
v_mfma_f32_16x16x32_bf16 v[72:75],a[8:11],a[32:35],v[72:75]
v_mfma_f32_16x16x32_bf16 v[76:79],a[8:11],a[36:39],v[76:79]
v_mfma_f32_16x16x32_bf16 v[80:83],a[12:15],a[24:27],v[80:83]
v_mfma_f32_16x16x32_bf16 v[84:87],a[12:15],a[28:31],v[84:87]
v_mfma_f32_16x16x32_bf16 v[88:91],a[12:15],a[32:35],v[88:91]
v_mfma_f32_16x16x32_bf16 v[92:95],a[12:15],a[36:39],v[92:95]
v_mfma_f32_16x16x32_bf16 v[96:99],a[16:19],a[24:27],v[96:99]
v_mfma_f32_16x16x32_bf16 v[100:103],a[16:19],a[28:31],v[100:103]
v_mfma_f32_16x16x32_bf16 v[104:107],a[16:19],a[32:35],v[104:107]
v_mfma_f32_16x16x32_bf16 v[108:111],a[16:19],a[36:39],v[108:111]
v_mfma_f32_16x16x32_bf16 v[112:115],a[20:23],a[24:27],v[112:115]
v_mfma_f32_16x16x32_bf16 v[116:119],a[20:23],a[28:31],v[116:119]
v_mfma_f32_16x16x32_bf16 v[120:123],a[20:23],a[32:35],v[120:123]
v_mfma_f32_16x16x32_bf16 v[124:127],a[20:23],a[36:39],v[124:127]
s_waitcnt vmcnt(0)
s_barrier
s_mul_i32 s30,s95,0
s_mul_i32 s32,s95,0
v_mov_b32 v23,v24
s_and_b32 s31,s84,1
s_mov_b32 s34,90112
s_mov_b32 s35,90112
s_mov_b32 s36,90112
s_mov_b32 s42,0
s_mov_b32 s50,24576
s_mov_b32 s51,0xfffe2000
s_lshl_b32 s18,s28,13
s_add_u32 s18,s18,90112
v_lshlrev_b32 v12,4,v2
v_add_u32 v12,s18,v12
v_add_u32 v13,1024,v12
s_mov_b32 s18,106496
s_lshl_b32 s19,s29,2
v_bfe_u32 v1,v2,2,2
v_lshl_add_u32 v3,v31,3,v1
v_lshlrev_b32 v3,7,v3
v_add_u32 v3,s18,v3
v_and_b32 v0,1,v2
v_lshl_add_u32 v3,v0,3,v3
v_and_b32 v1,2,v1
v_and_b32 v0,1,v31
v_lshl_add_u32 v1,v0,2,v1
v_bfe_u32 v0,v2,1,1
v_or_b32 v1,v1,v0
v_xor_b32 v1,s19,v1
v_xor_b32 v0,0,v1
v_lshl_add_u32 v14,v0,4,v3
v_xor_b32 v0,2,v1
v_lshl_add_u32 v15,v0,4,v3
s_mov_b32 s44,0x3fb8aa3b
s_mov_b32 s45,0x3fb8aa3b
v_mov_b32 v24,0x3f803f80
v_mov_b32 v25,0x3f803f80
v_mov_b32 v26,0x3f803f80
v_mov_b32 v27,0x3f803f80
v_pk_mul_f32 v[64:65],v[64:65],v[248:249] op_sel:[0,0] op_sel_hi:[1,0]
v_pk_mul_f32 v[66:67],v[66:67],v[248:249] op_sel:[0,0] op_sel_hi:[1,0]
v_pk_mul_f32 v[80:81],v[80:81],v[248:249] op_sel:[0,0] op_sel_hi:[1,0]
v_pk_mul_f32 v[82:83],v[82:83],v[248:249] op_sel:[0,0] op_sel_hi:[1,0]
v_pk_mul_f32 v[68:69],v[68:69],v[248:249] op_sel:[0,1] op_sel_hi:[1,1]
v_pk_mul_f32 v[70:71],v[70:71],v[248:249] op_sel:[0,1] op_sel_hi:[1,1]
v_pk_mul_f32 v[84:85],v[84:85],v[248:249] op_sel:[0,1] op_sel_hi:[1,1]
v_pk_mul_f32 v[86:87],v[86:87],v[248:249] op_sel:[0,1] op_sel_hi:[1,1]
s_add_u32 m0,s34,s40
s_nop 0
buffer_load_dwordx4 v4,s[8:11],s30 offen sc1 lds
v_pk_mul_f32 v[72:73],v[72:73],v[250:251] op_sel:[0,0] op_sel_hi:[1,0]
v_pk_mul_f32 v[74:75],v[74:75],v[250:251] op_sel:[0,0] op_sel_hi:[1,0]
v_pk_mul_f32 v[88:89],v[88:89],v[250:251] op_sel:[0,0] op_sel_hi:[1,0]
v_pk_mul_f32 v[90:91],v[90:91],v[250:251] op_sel:[0,0] op_sel_hi:[1,0]
v_pk_mul_f32 v[76:77],v[76:77],v[250:251] op_sel:[0,1] op_sel_hi:[1,1]
v_pk_mul_f32 v[78:79],v[78:79],v[250:251] op_sel:[0,1] op_sel_hi:[1,1]
v_pk_mul_f32 v[92:93],v[92:93],v[250:251] op_sel:[0,1] op_sel_hi:[1,1]
v_pk_mul_f32 v[94:95],v[94:95],v[250:251] op_sel:[0,1] op_sel_hi:[1,1]
buffer_load_dwordx4 v4,s[8:11],s30 offen offset:1024 sc1 lds
v_cvt_pk_bf16_f32 v128,v64,v65
v_cvt_pk_bf16_f32 v129,v66,v67
v_cvt_pk_bf16_f32 v130,v80,v81
v_cvt_pk_bf16_f32 v131,v82,v83
v_cvt_pk_bf16_f32 v132,v68,v69
v_cvt_pk_bf16_f32 v133,v70,v71
v_cvt_pk_bf16_f32 v134,v84,v85
v_cvt_pk_bf16_f32 v135,v86,v87
buffer_load_dwordx4 v5,s[8:11],s30 offen offset:2048 sc1 lds
v_cvt_pk_bf16_f32 v136,v72,v73
v_cvt_pk_bf16_f32 v137,v74,v75
v_cvt_pk_bf16_f32 v138,v88,v89
v_cvt_pk_bf16_f32 v139,v90,v91
v_cvt_pk_bf16_f32 v140,v76,v77
v_cvt_pk_bf16_f32 v141,v78,v79
v_cvt_pk_bf16_f32 v142,v92,v93
v_cvt_pk_bf16_f32 v143,v94,v95
buffer_load_dwordx4 v5,s[8:11],s30 offen offset:3072 sc1 lds
s_add_u32 s34,s34,24576
s_cmp_eq_u32 s34,163840
s_cselect_b32 s34,16384,s34
s_add_u32 s30,s30,2048
v_mfma_f32_16x16x32_bf16 v[144:147],v[240:243],v[128:131],0
v_mfma_f32_16x16x32_bf16 v[148:151],v[244:247],v[128:131],0
v_mfma_f32_16x16x32_bf16 v[152:155],v[240:243],v[132:135],0
v_mfma_f32_16x16x32_bf16 v[156:159],v[244:247],v[132:135],0
v_mfma_f32_16x16x32_bf16 v[160:163],v[240:243],v[136:139],0
v_mfma_f32_16x16x32_bf16 v[164:167],v[244:247],v[136:139],0
v_mfma_f32_16x16x32_bf16 v[168:171],v[240:243],v[140:143],0
v_mfma_f32_16x16x32_bf16 v[172:175],v[244:247],v[140:143],0
s_add_u32 m0,s35,s41
s_nop 0
buffer_load_dwordx4 v8,s[12:15],s32 offen lds
v_max3_f32 v176,v144,v145,v146
v_max3_f32 v177,-v144,-v145,-v146
v_max3_f32 v178,v152,v153,v154
v_max3_f32 v179,-v152,-v153,-v154
v_max3_f32 v180,v160,v161,v162
v_max3_f32 v181,-v160,-v161,-v162
v_max3_f32 v182,v168,v169,v170
v_max3_f32 v183,-v168,-v169,-v170
buffer_load_dwordx4 v9,s[12:15],s32 offen offset:1024 lds
s_add_u32 s35,s35,24576
s_cmp_eq_u32 s35,163840
s_cselect_b32 s35,16384,s35
s_add_u32 s32,s32,393216
v_max3_f32 v176,v176,v147,v148
v_max3_f32 v177,v177,-v147,-v148
v_max3_f32 v178,v178,v155,v156
v_max3_f32 v179,v179,-v155,-v156
v_max3_f32 v180,v180,v163,v164
v_max3_f32 v181,v181,-v163,-v164
v_max3_f32 v182,v182,v171,v172
v_max3_f32 v183,v183,-v171,-v172
s_add_u32 m0,s34,s40
s_nop 0
buffer_load_dwordx4 v4,s[8:11],s30 offen sc1 lds
v_max3_f32 v176,v176,v149,v150
v_max3_f32 v177,v177,-v149,-v150
v_max3_f32 v178,v178,v157,v158
v_max3_f32 v179,v179,-v157,-v158
v_max3_f32 v180,v180,v165,v166
v_max3_f32 v181,v181,-v165,-v166
v_max3_f32 v182,v182,v173,v174
v_max3_f32 v183,v183,-v173,-v174
buffer_load_dwordx4 v4,s[8:11],s30 offen offset:1024 sc1 lds
v_max_f32 v176,v176,v151
v_max_f32_e64 v177,v177,-v151
v_max_f32 v178,v178,v159
v_max_f32_e64 v179,v179,-v159
v_max_f32 v180,v180,v167
v_max_f32_e64 v181,v181,-v167
v_max_f32 v182,v182,v175
v_max_f32_e64 v183,v183,-v175
buffer_load_dwordx4 v5,s[8:11],s30 offen offset:2048 sc1 lds
v_permlane32_swap_b32 v176,v177
v_permlane32_swap_b32 v178,v179
v_permlane32_swap_b32 v180,v181
v_permlane32_swap_b32 v182,v183
v_max_f32 v176,v176,v177
v_max_f32 v178,v178,v179
v_max_f32 v180,v180,v181
v_max_f32 v182,v182,v183
buffer_load_dwordx4 v5,s[8:11],s30 offen offset:3072 sc1 lds
s_add_u32 s34,s34,24576
s_cmp_eq_u32 s34,163840
s_cselect_b32 s34,16384,s34
s_add_u32 s30,s30,2048
v_permlane16_swap_b32 v176,v178
v_permlane16_swap_b32 v180,v182
v_max_f32 v176,v176,v178
v_max_f32 v180,v180,v182
v_mul_f32 v176,s44,v176
v_mul_f32 v180,s44,v180
v_mov_b32 v178,v176
v_mov_b32 v182,v180
s_add_u32 m0,s35,s41
s_nop 0
buffer_load_dwordx4 v8,s[12:15],s32 offen lds
v_permlane16_swap_b32 v176,v178
v_permlane16_swap_b32 v180,v182
v_mov_b32 v177,v176
v_mov_b32 v179,v178
v_mov_b32 v181,v180
v_mov_b32 v183,v182
v_permlane32_swap_b32 v176,v177
v_permlane32_swap_b32 v178,v179
buffer_load_dwordx4 v9,s[12:15],s32 offen offset:1024 lds
s_add_u32 s35,s35,24576
s_cmp_eq_u32 s35,163840
s_cselect_b32 s35,16384,s35
s_add_u32 s32,s32,393216
v_permlane32_swap_b32 v180,v181
v_permlane32_swap_b32 v182,v183
v_subrev_u32 v0,73728,v14
v_subrev_u32 v1,73728,v15
ds_read_b64_tr_b16 a[228:229],v0 offset:0
ds_read_b64_tr_b16 a[230:231],v0 offset:512
ds_read_b64_tr_b16 a[232:233],v1 offset:0
ds_read_b64_tr_b16 a[234:235],v1 offset:512
v_pk_fma_f32 v[192:193],v[144:145],s[44:45],v[176:177] op_sel:[0,0,0] op_sel_hi:[1,1,0] neg_lo:[0,0,1] neg_hi:[0,0,1]
v_pk_fma_f32 v[194:195],v[146:147],s[44:45],v[176:177] op_sel:[0,0,0] op_sel_hi:[1,1,0] neg_lo:[0,0,1] neg_hi:[0,0,1]
v_pk_fma_f32 v[196:197],v[148:149],s[44:45],v[176:177] op_sel:[0,0,0] op_sel_hi:[1,1,0] neg_lo:[0,0,1] neg_hi:[0,0,1]
v_pk_fma_f32 v[198:199],v[150:151],s[44:45],v[176:177] op_sel:[0,0,0] op_sel_hi:[1,1,0] neg_lo:[0,0,1] neg_hi:[0,0,1]
v_pk_fma_f32 v[200:201],v[144:145],s[44:45],v[176:177] op_sel:[0,0,1] op_sel_hi:[1,1,1] neg_lo:[1,0,1] neg_hi:[1,0,1]
v_pk_fma_f32 v[202:203],v[146:147],s[44:45],v[176:177] op_sel:[0,0,1] op_sel_hi:[1,1,1] neg_lo:[1,0,1] neg_hi:[1,0,1]
v_pk_fma_f32 v[204:205],v[148:149],s[44:45],v[176:177] op_sel:[0,0,1] op_sel_hi:[1,1,1] neg_lo:[1,0,1] neg_hi:[1,0,1]
v_pk_fma_f32 v[206:207],v[150:151],s[44:45],v[176:177] op_sel:[0,0,1] op_sel_hi:[1,1,1] neg_lo:[1,0,1] neg_hi:[1,0,1]
s_waitcnt lgkmcnt(0)
v_mfma_f32_16x16x32_bf16 v[32:35],a[228:231],a[68:71],0
ds_read_b64_tr_b16 a[236:237],v0 offset:4096
v_exp_f32 v192,v192
v_mfma_f32_16x16x32_bf16 v[36:39],a[228:231],a[72:75],0
ds_read_b64_tr_b16 a[238:239],v0 offset:4608
v_exp_f32 v193,v193
v_mfma_f32_16x16x32_bf16 v[40:43],a[228:231],a[76:79],0
ds_read_b64_tr_b16 a[240:241],v1 offset:4096
v_exp_f32 v194,v194
v_mfma_f32_16x16x32_bf16 v[44:47],a[228:231],a[80:83],0
ds_read_b64_tr_b16 a[242:243],v1 offset:4608
v_exp_f32 v195,v195
v_mfma_f32_16x16x32_bf16 v[48:51],a[232:235],a[68:71],0
v_exp_f32 v196,v196
v_mfma_f32_16x16x32_bf16 v[52:55],a[232:235],a[72:75],0
v_exp_f32 v197,v197
v_mfma_f32_16x16x32_bf16 v[56:59],a[232:235],a[76:79],0
v_exp_f32 v198,v198
v_mfma_f32_16x16x32_bf16 v[60:63],a[232:235],a[80:83],0
v_exp_f32 v199,v199
s_waitcnt lgkmcnt(0)
v_mfma_f32_16x16x32_bf16 v[32:35],a[236:239],a[84:87],v[32:35]
ds_read_b64_tr_b16 a[228:229],v0 offset:8192
v_exp_f32 v200,v200
v_mfma_f32_16x16x32_bf16 v[36:39],a[236:239],a[88:91],v[36:39]
ds_read_b64_tr_b16 a[230:231],v0 offset:8704
v_exp_f32 v201,v201
v_mfma_f32_16x16x32_bf16 v[40:43],a[236:239],a[92:95],v[40:43]
ds_read_b64_tr_b16 a[232:233],v1 offset:8192
v_exp_f32 v202,v202
v_mfma_f32_16x16x32_bf16 v[44:47],a[236:239],a[96:99],v[44:47]
ds_read_b64_tr_b16 a[234:235],v1 offset:8704
v_exp_f32 v203,v203
v_mfma_f32_16x16x32_bf16 v[48:51],a[240:243],a[84:87],v[48:51]
v_exp_f32 v204,v204
v_mfma_f32_16x16x32_bf16 v[52:55],a[240:243],a[88:91],v[52:55]
v_exp_f32 v205,v205
v_mfma_f32_16x16x32_bf16 v[56:59],a[240:243],a[92:95],v[56:59]
v_exp_f32 v206,v206
v_mfma_f32_16x16x32_bf16 v[60:63],a[240:243],a[96:99],v[60:63]
v_exp_f32 v207,v207
s_waitcnt lgkmcnt(0)
v_mfma_f32_16x16x32_bf16 v[32:35],a[228:231],a[100:103],v[32:35]
ds_read_b64_tr_b16 a[236:237],v0 offset:12288
v_cvt_pk_bf16_f32 v208,v192,v193
v_cvt_pk_bf16_f32 v209,v194,v195
v_mfma_f32_16x16x32_bf16 v[36:39],a[228:231],a[104:107],v[36:39]
ds_read_b64_tr_b16 a[238:239],v0 offset:12800
v_cvt_pk_bf16_f32 v210,v196,v197
v_cvt_pk_bf16_f32 v211,v198,v199
v_mfma_f32_16x16x32_bf16 v[40:43],a[228:231],a[108:111],v[40:43]
ds_read_b64_tr_b16 a[240:241],v1 offset:12288
v_cvt_pk_bf16_f32 v212,v200,v201
v_cvt_pk_bf16_f32 v213,v202,v203
v_mfma_f32_16x16x32_bf16 v[44:47],a[228:231],a[112:115],v[44:47]
ds_read_b64_tr_b16 a[242:243],v1 offset:12800
v_cvt_pk_bf16_f32 v214,v204,v205
v_cvt_pk_bf16_f32 v215,v206,v207
v_pk_fma_f32 v[192:193],v[152:153],s[44:45],v[178:179] op_sel:[0,0,0] op_sel_hi:[1,1,0] neg_lo:[0,0,1] neg_hi:[0,0,1]
v_pk_fma_f32 v[194:195],v[154:155],s[44:45],v[178:179] op_sel:[0,0,0] op_sel_hi:[1,1,0] neg_lo:[0,0,1] neg_hi:[0,0,1]
v_pk_fma_f32 v[196:197],v[156:157],s[44:45],v[178:179] op_sel:[0,0,0] op_sel_hi:[1,1,0] neg_lo:[0,0,1] neg_hi:[0,0,1]
v_pk_fma_f32 v[198:199],v[158:159],s[44:45],v[178:179] op_sel:[0,0,0] op_sel_hi:[1,1,0] neg_lo:[0,0,1] neg_hi:[0,0,1]
v_pk_fma_f32 v[200:201],v[152:153],s[44:45],v[178:179] op_sel:[0,0,1] op_sel_hi:[1,1,1] neg_lo:[1,0,1] neg_hi:[1,0,1]
v_pk_fma_f32 v[202:203],v[154:155],s[44:45],v[178:179] op_sel:[0,0,1] op_sel_hi:[1,1,1] neg_lo:[1,0,1] neg_hi:[1,0,1]
v_pk_fma_f32 v[204:205],v[156:157],s[44:45],v[178:179] op_sel:[0,0,1] op_sel_hi:[1,1,1] neg_lo:[1,0,1] neg_hi:[1,0,1]
v_pk_fma_f32 v[206:207],v[158:159],s[44:45],v[178:179] op_sel:[0,0,1] op_sel_hi:[1,1,1] neg_lo:[1,0,1] neg_hi:[1,0,1]
v_mfma_f32_16x16x32_bf16 v[48:51],a[232:235],a[100:103],v[48:51]
v_exp_f32 v192,v192
v_mfma_f32_16x16x32_bf16 v[52:55],a[232:235],a[104:107],v[52:55]
v_exp_f32 v193,v193
v_mfma_f32_16x16x32_bf16 v[56:59],a[232:235],a[108:111],v[56:59]
v_exp_f32 v194,v194
v_mfma_f32_16x16x32_bf16 v[60:63],a[232:235],a[112:115],v[60:63]
v_exp_f32 v195,v195
s_waitcnt lgkmcnt(0)
v_mfma_f32_16x16x32_bf16 v[32:35],a[236:239],a[116:119],v[32:35]
ds_read_b64_tr_b16 a[228:229],v0 offset:16384
v_exp_f32 v196,v196
v_mfma_f32_16x16x32_bf16 v[36:39],a[236:239],a[120:123],v[36:39]
ds_read_b64_tr_b16 a[230:231],v0 offset:16896
v_exp_f32 v197,v197
v_mfma_f32_16x16x32_bf16 v[40:43],a[236:239],a[124:127],v[40:43]
ds_read_b64_tr_b16 a[232:233],v1 offset:16384
v_exp_f32 v198,v198
v_mfma_f32_16x16x32_bf16 v[44:47],a[236:239],a[128:131],v[44:47]
ds_read_b64_tr_b16 a[234:235],v1 offset:16896
v_exp_f32 v199,v199
v_mfma_f32_16x16x32_bf16 v[48:51],a[240:243],a[116:119],v[48:51]
v_exp_f32 v200,v200
v_mfma_f32_16x16x32_bf16 v[52:55],a[240:243],a[120:123],v[52:55]
v_exp_f32 v201,v201
v_mfma_f32_16x16x32_bf16 v[56:59],a[240:243],a[124:127],v[56:59]
v_exp_f32 v202,v202
v_mfma_f32_16x16x32_bf16 v[60:63],a[240:243],a[128:131],v[60:63]
v_exp_f32 v203,v203
s_waitcnt lgkmcnt(0)
v_mfma_f32_16x16x32_bf16 v[32:35],a[228:231],a[132:135],v[32:35]
ds_read_b64_tr_b16 a[236:237],v0 offset:20480
v_exp_f32 v204,v204
v_mfma_f32_16x16x32_bf16 v[36:39],a[228:231],a[136:139],v[36:39]
ds_read_b64_tr_b16 a[238:239],v0 offset:20992
v_exp_f32 v205,v205
v_mfma_f32_16x16x32_bf16 v[40:43],a[228:231],a[140:143],v[40:43]
ds_read_b64_tr_b16 a[240:241],v1 offset:20480
v_exp_f32 v206,v206
v_mfma_f32_16x16x32_bf16 v[44:47],a[228:231],a[144:147],v[44:47]
ds_read_b64_tr_b16 a[242:243],v1 offset:20992
v_exp_f32 v207,v207
v_mfma_f32_16x16x32_bf16 v[48:51],a[232:235],a[132:135],v[48:51]
v_cvt_pk_bf16_f32 v216,v192,v193
v_cvt_pk_bf16_f32 v217,v194,v195
v_mfma_f32_16x16x32_bf16 v[52:55],a[232:235],a[136:139],v[52:55]
v_cvt_pk_bf16_f32 v218,v196,v197
v_cvt_pk_bf16_f32 v219,v198,v199
v_mfma_f32_16x16x32_bf16 v[56:59],a[232:235],a[140:143],v[56:59]
v_cvt_pk_bf16_f32 v220,v200,v201
v_cvt_pk_bf16_f32 v221,v202,v203
v_mfma_f32_16x16x32_bf16 v[60:63],a[232:235],a[144:147],v[60:63]
v_cvt_pk_bf16_f32 v222,v204,v205
v_cvt_pk_bf16_f32 v223,v206,v207
v_pk_fma_f32 v[192:193],v[160:161],s[44:45],v[180:181] op_sel:[0,0,0] op_sel_hi:[1,1,0] neg_lo:[0,0,1] neg_hi:[0,0,1]
v_pk_fma_f32 v[194:195],v[162:163],s[44:45],v[180:181] op_sel:[0,0,0] op_sel_hi:[1,1,0] neg_lo:[0,0,1] neg_hi:[0,0,1]
v_pk_fma_f32 v[196:197],v[164:165],s[44:45],v[180:181] op_sel:[0,0,0] op_sel_hi:[1,1,0] neg_lo:[0,0,1] neg_hi:[0,0,1]
v_pk_fma_f32 v[198:199],v[166:167],s[44:45],v[180:181] op_sel:[0,0,0] op_sel_hi:[1,1,0] neg_lo:[0,0,1] neg_hi:[0,0,1]
v_pk_fma_f32 v[200:201],v[160:161],s[44:45],v[180:181] op_sel:[0,0,1] op_sel_hi:[1,1,1] neg_lo:[1,0,1] neg_hi:[1,0,1]
v_pk_fma_f32 v[202:203],v[162:163],s[44:45],v[180:181] op_sel:[0,0,1] op_sel_hi:[1,1,1] neg_lo:[1,0,1] neg_hi:[1,0,1]
v_pk_fma_f32 v[204:205],v[164:165],s[44:45],v[180:181] op_sel:[0,0,1] op_sel_hi:[1,1,1] neg_lo:[1,0,1] neg_hi:[1,0,1]
v_pk_fma_f32 v[206:207],v[166:167],s[44:45],v[180:181] op_sel:[0,0,1] op_sel_hi:[1,1,1] neg_lo:[1,0,1] neg_hi:[1,0,1]
s_waitcnt lgkmcnt(0)
v_mfma_f32_16x16x32_bf16 v[32:35],a[236:239],a[148:151],v[32:35]
ds_read_b64_tr_b16 a[228:229],v0 offset:24576
v_exp_f32 v192,v192
v_mfma_f32_16x16x32_bf16 v[36:39],a[236:239],a[152:155],v[36:39]
ds_read_b64_tr_b16 a[230:231],v0 offset:25088
v_exp_f32 v193,v193
v_mfma_f32_16x16x32_bf16 v[40:43],a[236:239],a[156:159],v[40:43]
ds_read_b64_tr_b16 a[232:233],v1 offset:24576
v_exp_f32 v194,v194
v_mfma_f32_16x16x32_bf16 v[44:47],a[236:239],a[160:163],v[44:47]
ds_read_b64_tr_b16 a[234:235],v1 offset:25088
v_exp_f32 v195,v195
v_mfma_f32_16x16x32_bf16 v[48:51],a[240:243],a[148:151],v[48:51]
v_exp_f32 v196,v196
v_mfma_f32_16x16x32_bf16 v[52:55],a[240:243],a[152:155],v[52:55]
v_exp_f32 v197,v197
v_mfma_f32_16x16x32_bf16 v[56:59],a[240:243],a[156:159],v[56:59]
v_exp_f32 v198,v198
v_mfma_f32_16x16x32_bf16 v[60:63],a[240:243],a[160:163],v[60:63]
v_exp_f32 v199,v199
s_waitcnt lgkmcnt(0)
v_mfma_f32_16x16x32_bf16 v[32:35],a[228:231],a[164:167],v[32:35]
ds_read_b64_tr_b16 a[236:237],v0 offset:28672
v_exp_f32 v200,v200
v_mfma_f32_16x16x32_bf16 v[36:39],a[228:231],a[168:171],v[36:39]
ds_read_b64_tr_b16 a[238:239],v0 offset:29184
v_exp_f32 v201,v201
v_mfma_f32_16x16x32_bf16 v[40:43],a[228:231],a[172:175],v[40:43]
ds_read_b64_tr_b16 a[240:241],v1 offset:28672
v_exp_f32 v202,v202
v_mfma_f32_16x16x32_bf16 v[44:47],a[228:231],a[176:179],v[44:47]
ds_read_b64_tr_b16 a[242:243],v1 offset:29184
v_exp_f32 v203,v203
v_mfma_f32_16x16x32_bf16 v[48:51],a[232:235],a[164:167],v[48:51]
v_exp_f32 v204,v204
v_mfma_f32_16x16x32_bf16 v[52:55],a[232:235],a[168:171],v[52:55]
v_exp_f32 v205,v205
v_mfma_f32_16x16x32_bf16 v[56:59],a[232:235],a[172:175],v[56:59]
v_exp_f32 v206,v206
v_mfma_f32_16x16x32_bf16 v[60:63],a[232:235],a[176:179],v[60:63]
v_exp_f32 v207,v207
s_waitcnt lgkmcnt(0)
v_mfma_f32_16x16x32_bf16 v[32:35],a[236:239],a[180:183],v[32:35]
ds_read_b64_tr_b16 a[228:229],v0 offset:32768
v_cvt_pk_bf16_f32 v224,v192,v193
v_cvt_pk_bf16_f32 v225,v194,v195
v_mfma_f32_16x16x32_bf16 v[36:39],a[236:239],a[184:187],v[36:39]
ds_read_b64_tr_b16 a[230:231],v0 offset:33280
v_cvt_pk_bf16_f32 v226,v196,v197
v_cvt_pk_bf16_f32 v227,v198,v199
v_mfma_f32_16x16x32_bf16 v[40:43],a[236:239],a[188:191],v[40:43]
ds_read_b64_tr_b16 a[232:233],v1 offset:32768
v_cvt_pk_bf16_f32 v228,v200,v201
v_cvt_pk_bf16_f32 v229,v202,v203
v_mfma_f32_16x16x32_bf16 v[44:47],a[236:239],a[192:195],v[44:47]
ds_read_b64_tr_b16 a[234:235],v1 offset:33280
v_cvt_pk_bf16_f32 v230,v204,v205
v_cvt_pk_bf16_f32 v231,v206,v207
v_pk_fma_f32 v[192:193],v[168:169],s[44:45],v[182:183] op_sel:[0,0,0] op_sel_hi:[1,1,0] neg_lo:[0,0,1] neg_hi:[0,0,1]
v_pk_fma_f32 v[194:195],v[170:171],s[44:45],v[182:183] op_sel:[0,0,0] op_sel_hi:[1,1,0] neg_lo:[0,0,1] neg_hi:[0,0,1]
v_pk_fma_f32 v[196:197],v[172:173],s[44:45],v[182:183] op_sel:[0,0,0] op_sel_hi:[1,1,0] neg_lo:[0,0,1] neg_hi:[0,0,1]
v_pk_fma_f32 v[198:199],v[174:175],s[44:45],v[182:183] op_sel:[0,0,0] op_sel_hi:[1,1,0] neg_lo:[0,0,1] neg_hi:[0,0,1]
v_pk_fma_f32 v[200:201],v[168:169],s[44:45],v[182:183] op_sel:[0,0,1] op_sel_hi:[1,1,1] neg_lo:[1,0,1] neg_hi:[1,0,1]
v_pk_fma_f32 v[202:203],v[170:171],s[44:45],v[182:183] op_sel:[0,0,1] op_sel_hi:[1,1,1] neg_lo:[1,0,1] neg_hi:[1,0,1]
v_pk_fma_f32 v[204:205],v[172:173],s[44:45],v[182:183] op_sel:[0,0,1] op_sel_hi:[1,1,1] neg_lo:[1,0,1] neg_hi:[1,0,1]
v_pk_fma_f32 v[206:207],v[174:175],s[44:45],v[182:183] op_sel:[0,0,1] op_sel_hi:[1,1,1] neg_lo:[1,0,1] neg_hi:[1,0,1]
v_mfma_f32_16x16x32_bf16 v[48:51],a[240:243],a[180:183],v[48:51]
v_exp_f32 v192,v192
v_mfma_f32_16x16x32_bf16 v[52:55],a[240:243],a[184:187],v[52:55]
v_exp_f32 v193,v193
v_mfma_f32_16x16x32_bf16 v[56:59],a[240:243],a[188:191],v[56:59]
v_exp_f32 v194,v194
v_mfma_f32_16x16x32_bf16 v[60:63],a[240:243],a[192:195],v[60:63]
v_exp_f32 v195,v195
s_waitcnt lgkmcnt(0)
v_mfma_f32_16x16x32_bf16 v[32:35],a[228:231],a[196:199],v[32:35]
ds_read_b64_tr_b16 a[236:237],v0 offset:36864
v_exp_f32 v196,v196
v_mfma_f32_16x16x32_bf16 v[36:39],a[228:231],a[200:203],v[36:39]
ds_read_b64_tr_b16 a[238:239],v0 offset:37376
v_exp_f32 v197,v197
v_mfma_f32_16x16x32_bf16 v[40:43],a[228:231],a[204:207],v[40:43]
ds_read_b64_tr_b16 a[240:241],v1 offset:36864
v_exp_f32 v198,v198
v_mfma_f32_16x16x32_bf16 v[44:47],a[228:231],a[208:211],v[44:47]
ds_read_b64_tr_b16 a[242:243],v1 offset:37376
v_exp_f32 v199,v199
v_mfma_f32_16x16x32_bf16 v[48:51],a[232:235],a[196:199],v[48:51]
v_exp_f32 v200,v200
v_mfma_f32_16x16x32_bf16 v[52:55],a[232:235],a[200:203],v[52:55]
v_exp_f32 v201,v201
v_mfma_f32_16x16x32_bf16 v[56:59],a[232:235],a[204:207],v[56:59]
v_exp_f32 v202,v202
v_mfma_f32_16x16x32_bf16 v[60:63],a[232:235],a[208:211],v[60:63]
v_exp_f32 v203,v203
s_waitcnt lgkmcnt(0)
v_mfma_f32_16x16x32_bf16 v[32:35],a[236:239],a[212:215],v[32:35]
v_exp_f32 v204,v204
v_mfma_f32_16x16x32_bf16 v[36:39],a[236:239],a[216:219],v[36:39]
v_exp_f32 v205,v205
v_mfma_f32_16x16x32_bf16 v[40:43],a[236:239],a[220:223],v[40:43]
v_exp_f32 v206,v206
v_mfma_f32_16x16x32_bf16 v[44:47],a[236:239],a[224:227],v[44:47]
v_exp_f32 v207,v207
v_mfma_f32_16x16x32_bf16 v[48:51],a[240:243],a[212:215],v[48:51]
v_cvt_pk_bf16_f32 v232,v192,v193
v_cvt_pk_bf16_f32 v233,v194,v195
v_mfma_f32_16x16x32_bf16 v[52:55],a[240:243],a[216:219],v[52:55]
v_cvt_pk_bf16_f32 v234,v196,v197
v_cvt_pk_bf16_f32 v235,v198,v199
v_mfma_f32_16x16x32_bf16 v[56:59],a[240:243],a[220:223],v[56:59]
v_cvt_pk_bf16_f32 v236,v200,v201
v_cvt_pk_bf16_f32 v237,v202,v203
v_mfma_f32_16x16x32_bf16 v[60:63],a[240:243],a[224:227],v[60:63]
v_cvt_pk_bf16_f32 v238,v204,v205
v_cvt_pk_bf16_f32 v239,v206,v207
s_barrier
s_add_u32 m0,s34,s40
s_nop 0
buffer_load_dwordx4 v4,s[8:11],s30 offen sc1 lds
buffer_load_dwordx4 v4,s[8:11],s30 offen offset:1024 sc1 lds
buffer_load_dwordx4 v5,s[8:11],s30 offen offset:2048 sc1 lds
buffer_load_dwordx4 v5,s[8:11],s30 offen offset:3072 sc1 lds
s_add_u32 s34,s34,24576
s_cmp_eq_u32 s34,163840
s_cselect_b32 s34,16384,s34
s_add_u32 s30,s30,2048
s_add_u32 m0,s35,s41
s_nop 0
buffer_load_dwordx4 v8,s[12:15],s32 offen lds
buffer_load_dwordx4 v9,s[12:15],s32 offen offset:1024 lds
s_add_u32 s35,s35,24576
s_cmp_eq_u32 s35,163840
s_cselect_b32 s35,16384,s35
s_add_u32 s32,s32,393216
v_mfma_f32_16x16x32_bf16 v[144:147],v[24:27],v[208:211],0
v_mfma_f32_16x16x32_bf16 v[148:151],v[24:27],v[212:215],0
v_mfma_f32_16x16x32_bf16 v[152:155],v[24:27],v[216:219],0
v_mfma_f32_16x16x32_bf16 v[156:159],v[24:27],v[220:223],0
v_mfma_f32_16x16x32_bf16 v[160:163],v[24:27],v[224:227],0
v_mfma_f32_16x16x32_bf16 v[164:167],v[24:27],v[228:231],0
v_mfma_f32_16x16x32_bf16 v[168:171],v[24:27],v[232:235],0
v_mfma_f32_16x16x32_bf16 v[172:175],v[24:27],v[236:239],0
ds_write_b64 v18,v[208:209] offset:0
ds_write_b64 v18,v[210:211] offset:32
ds_write_b64 v18,v[212:213] offset:64
ds_write_b64 v18,v[214:215] offset:96
ds_write_b64 v18,v[216:217] offset:5632
ds_write_b64 v18,v[218:219] offset:5664
ds_write_b64 v18,v[220:221] offset:5696
ds_write_b64 v18,v[222:223] offset:5728
ds_write_b64 v18,v[224:225] offset:11264
ds_write_b64 v18,v[226:227] offset:11296
ds_write_b64 v18,v[228:229] offset:11328
ds_write_b64 v18,v[230:231] offset:11360
ds_write_b64 v18,v[232:233] offset:16896
ds_write_b64 v18,v[234:235] offset:16928
ds_write_b64 v18,v[236:237] offset:16960
ds_write_b64 v18,v[238:239] offset:16992
v_rcp_f32 v144,v144
v_rcp_f32 v148,v148
v_rcp_f32 v152,v152
v_rcp_f32 v156,v156
v_rcp_f32 v160,v160
v_rcp_f32 v164,v164
v_rcp_f32 v168,v168
v_rcp_f32 v172,v172
v_mul_f32 v146,v144,v248
v_cvt_pk_bf16_f32 v144,v144,0
v_mov_b32 v145,0
v_mul_f32 v150,v148,v248
v_cvt_pk_bf16_f32 v148,v148,0
v_mov_b32 v149,0
v_mul_f32 v154,v152,v249
v_cvt_pk_bf16_f32 v152,v152,0
v_mov_b32 v153,0
v_mul_f32 v158,v156,v249
v_cvt_pk_bf16_f32 v156,v156,0
v_mov_b32 v157,0
v_mul_f32 v162,v160,v250
v_cvt_pk_bf16_f32 v160,v160,0
v_mov_b32 v161,0
v_mul_f32 v166,v164,v250
v_cvt_pk_bf16_f32 v164,v164,0
v_mov_b32 v165,0
v_mul_f32 v170,v168,v251
v_cvt_pk_bf16_f32 v168,v168,0
v_mov_b32 v169,0
v_mul_f32 v174,v172,v251
v_cvt_pk_bf16_f32 v172,v172,0
v_mov_b32 v173,0
v_pk_mul_f32 v[176:177],v[96:97],v[146:147] op_sel:[0,0] op_sel_hi:[1,0]
v_pk_mul_f32 v[178:179],v[98:99],v[146:147] op_sel:[0,0] op_sel_hi:[1,0]
v_pk_mul_f32 v[180:181],v[112:113],v[146:147] op_sel:[0,0] op_sel_hi:[1,0]
v_pk_mul_f32 v[182:183],v[114:115],v[146:147] op_sel:[0,0] op_sel_hi:[1,0]
v_cvt_pk_bf16_f32 v192,v176,v177
v_cvt_pk_bf16_f32 v193,v178,v179
v_cvt_pk_bf16_f32 v194,v180,v181
v_cvt_pk_bf16_f32 v195,v182,v183
ds_write_b64 v18,v[192:193] offset:128
ds_write_b64 v18,v[194:195] offset:160
ds_write_b64 v18,v[144:145] offset:256
v_pk_mul_f32 v[184:185],v[96:97],v[150:151] op_sel:[0,0] op_sel_hi:[1,0]
v_pk_mul_f32 v[186:187],v[98:99],v[150:151] op_sel:[0,0] op_sel_hi:[1,0]
v_pk_mul_f32 v[188:189],v[112:113],v[150:151] op_sel:[0,0] op_sel_hi:[1,0]
v_pk_mul_f32 v[190:191],v[114:115],v[150:151] op_sel:[0,0] op_sel_hi:[1,0]
v_cvt_pk_bf16_f32 v196,v184,v185
v_cvt_pk_bf16_f32 v197,v186,v187
v_cvt_pk_bf16_f32 v198,v188,v189
v_cvt_pk_bf16_f32 v199,v190,v191
ds_write_b64 v18,v[196:197] offset:192
ds_write_b64 v18,v[198:199] offset:224
ds_write_b64 v18,v[148:149] offset:288
v_pk_mul_f32 v[176:177],v[100:101],v[154:155] op_sel:[0,0] op_sel_hi:[1,0]
v_pk_mul_f32 v[178:179],v[102:103],v[154:155] op_sel:[0,0] op_sel_hi:[1,0]
v_pk_mul_f32 v[180:181],v[116:117],v[154:155] op_sel:[0,0] op_sel_hi:[1,0]
v_pk_mul_f32 v[182:183],v[118:119],v[154:155] op_sel:[0,0] op_sel_hi:[1,0]
v_cvt_pk_bf16_f32 v200,v176,v177
v_cvt_pk_bf16_f32 v201,v178,v179
v_cvt_pk_bf16_f32 v202,v180,v181
v_cvt_pk_bf16_f32 v203,v182,v183
ds_write_b64 v18,v[200:201] offset:5760
ds_write_b64 v18,v[202:203] offset:5792
ds_write_b64 v18,v[152:153] offset:5888
v_pk_mul_f32 v[184:185],v[100:101],v[158:159] op_sel:[0,0] op_sel_hi:[1,0]
v_pk_mul_f32 v[186:187],v[102:103],v[158:159] op_sel:[0,0] op_sel_hi:[1,0]
v_pk_mul_f32 v[188:189],v[116:117],v[158:159] op_sel:[0,0] op_sel_hi:[1,0]
v_pk_mul_f32 v[190:191],v[118:119],v[158:159] op_sel:[0,0] op_sel_hi:[1,0]
v_cvt_pk_bf16_f32 v204,v184,v185
v_cvt_pk_bf16_f32 v205,v186,v187
v_cvt_pk_bf16_f32 v206,v188,v189
v_cvt_pk_bf16_f32 v207,v190,v191
ds_write_b64 v18,v[204:205] offset:5824
ds_write_b64 v18,v[206:207] offset:5856
ds_write_b64 v18,v[156:157] offset:5920
v_pk_mul_f32 v[176:177],v[104:105],v[162:163] op_sel:[0,0] op_sel_hi:[1,0]
v_pk_mul_f32 v[178:179],v[106:107],v[162:163] op_sel:[0,0] op_sel_hi:[1,0]
v_pk_mul_f32 v[180:181],v[120:121],v[162:163] op_sel:[0,0] op_sel_hi:[1,0]
v_pk_mul_f32 v[182:183],v[122:123],v[162:163] op_sel:[0,0] op_sel_hi:[1,0]
v_cvt_pk_bf16_f32 v192,v176,v177
v_cvt_pk_bf16_f32 v193,v178,v179
v_cvt_pk_bf16_f32 v194,v180,v181
v_cvt_pk_bf16_f32 v195,v182,v183
ds_write_b64 v18,v[192:193] offset:11392
ds_write_b64 v18,v[194:195] offset:11424
ds_write_b64 v18,v[160:161] offset:11520
v_pk_mul_f32 v[184:185],v[104:105],v[166:167] op_sel:[0,0] op_sel_hi:[1,0]
v_pk_mul_f32 v[186:187],v[106:107],v[166:167] op_sel:[0,0] op_sel_hi:[1,0]
v_pk_mul_f32 v[188:189],v[120:121],v[166:167] op_sel:[0,0] op_sel_hi:[1,0]
v_pk_mul_f32 v[190:191],v[122:123],v[166:167] op_sel:[0,0] op_sel_hi:[1,0]
v_cvt_pk_bf16_f32 v196,v184,v185
v_cvt_pk_bf16_f32 v197,v186,v187
v_cvt_pk_bf16_f32 v198,v188,v189
v_cvt_pk_bf16_f32 v199,v190,v191
ds_write_b64 v18,v[196:197] offset:11456
ds_write_b64 v18,v[198:199] offset:11488
ds_write_b64 v18,v[164:165] offset:11552
v_pk_mul_f32 v[176:177],v[108:109],v[170:171] op_sel:[0,0] op_sel_hi:[1,0]
v_pk_mul_f32 v[178:179],v[110:111],v[170:171] op_sel:[0,0] op_sel_hi:[1,0]
v_pk_mul_f32 v[180:181],v[124:125],v[170:171] op_sel:[0,0] op_sel_hi:[1,0]
v_pk_mul_f32 v[182:183],v[126:127],v[170:171] op_sel:[0,0] op_sel_hi:[1,0]
v_cvt_pk_bf16_f32 v200,v176,v177
v_cvt_pk_bf16_f32 v201,v178,v179
v_cvt_pk_bf16_f32 v202,v180,v181
v_cvt_pk_bf16_f32 v203,v182,v183
ds_write_b64 v18,v[200:201] offset:17024
ds_write_b64 v18,v[202:203] offset:17056
ds_write_b64 v18,v[168:169] offset:17152
v_pk_mul_f32 v[184:185],v[108:109],v[174:175] op_sel:[0,0] op_sel_hi:[1,0]
v_pk_mul_f32 v[186:187],v[110:111],v[174:175] op_sel:[0,0] op_sel_hi:[1,0]
v_pk_mul_f32 v[188:189],v[124:125],v[174:175] op_sel:[0,0] op_sel_hi:[1,0]
v_pk_mul_f32 v[190:191],v[126:127],v[174:175] op_sel:[0,0] op_sel_hi:[1,0]
v_cvt_pk_bf16_f32 v204,v184,v185
v_cvt_pk_bf16_f32 v205,v186,v187
v_cvt_pk_bf16_f32 v206,v188,v189
v_cvt_pk_bf16_f32 v207,v190,v191
ds_write_b64 v18,v[204:205] offset:17088
ds_write_b64 v18,v[206:207] offset:17120
ds_write_b64 v18,v[172:173] offset:17184
s_waitcnt lgkmcnt(0)
s_barrier
s_lshl_b32 s18,s28,6
v_add_u32 v28,s18,v19
s_lshl_b32 s18,s28,5
v_add_u32 v29,s18,v19
ds_read_b64_tr_b16 v[128:129],v28 offset:0
ds_read_b64_tr_b16 v[132:133],v28 offset:32
ds_read_b64_tr_b16 v[136:137],v28 offset:128
ds_read_b64_tr_b16 v[140:141],v28 offset:160
ds_read_b64_tr_b16 v[144:145],v29 offset:256
ds_read_b64_tr_b16 v[130:131],v28 offset:5632
ds_read_b64_tr_b16 v[134:135],v28 offset:5664
ds_read_b64_tr_b16 v[138:139],v28 offset:5760
ds_read_b64_tr_b16 v[142:143],v28 offset:5792
ds_read_b64_tr_b16 v[146:147],v29 offset:5888
ds_read_b64_tr_b16 v[148:149],v28 offset:11264
ds_read_b64_tr_b16 v[152:153],v28 offset:11296
ds_read_b64_tr_b16 v[156:157],v28 offset:11392
ds_read_b64_tr_b16 v[160:161],v28 offset:11424
ds_read_b64_tr_b16 v[164:165],v29 offset:11520
ds_read_b64_tr_b16 v[150:151],v28 offset:16896
ds_read_b64_tr_b16 v[154:155],v28 offset:16928
ds_read_b64_tr_b16 v[158:159],v28 offset:17024
ds_read_b64_tr_b16 v[162:163],v28 offset:17056
ds_read_b64_tr_b16 v[166:167],v29 offset:17152
ds_read_b64_tr_b16 v[168:169],v28 offset:22528
ds_read_b64_tr_b16 v[172:173],v28 offset:22560
ds_read_b64_tr_b16 v[176:177],v28 offset:22656
ds_read_b64_tr_b16 v[180:181],v28 offset:22688
ds_read_b64_tr_b16 v[184:185],v29 offset:22784
ds_read_b64_tr_b16 v[170:171],v28 offset:28160
ds_read_b64_tr_b16 v[174:175],v28 offset:28192
ds_read_b64_tr_b16 v[178:179],v28 offset:28288
ds_read_b64_tr_b16 v[182:183],v28 offset:28320
ds_read_b64_tr_b16 v[186:187],v29 offset:28416
ds_read_b64_tr_b16 v[188:189],v28 offset:33792
ds_read_b64_tr_b16 v[192:193],v28 offset:33824
ds_read_b64_tr_b16 v[196:197],v28 offset:33920
ds_read_b64_tr_b16 v[200:201],v28 offset:33952
ds_read_b64_tr_b16 v[204:205],v29 offset:34048
ds_read_b64_tr_b16 v[190:191],v28 offset:39424
ds_read_b64_tr_b16 v[194:195],v28 offset:39456
ds_read_b64_tr_b16 v[198:199],v28 offset:39552
ds_read_b64_tr_b16 v[202:203],v28 offset:39584
ds_read_b64_tr_b16 v[206:207],v29 offset:39680
s_waitcnt lgkmcnt(15)
v_mfma_f32_16x16x32_bf16 v[64:67],v[128:131],v[136:139],0
v_mfma_f32_16x16x32_bf16 v[68:71],v[128:131],v[140:143],0
v_mfma_f32_16x16x32_bf16 v[72:75],v[128:131],v[144:147],0
v_mfma_f32_16x16x32_bf16 v[76:79],v[132:135],v[136:139],0
v_mfma_f32_16x16x32_bf16 v[80:83],v[132:135],v[140:143],0
v_mfma_f32_16x16x32_bf16 v[84:87],v[132:135],v[144:147],0
s_waitcnt lgkmcnt(10)
v_mfma_f32_16x16x32_bf16 v[64:67],v[148:151],v[156:159],v[64:67]
v_mfma_f32_16x16x32_bf16 v[68:71],v[148:151],v[160:163],v[68:71]
v_mfma_f32_16x16x32_bf16 v[72:75],v[148:151],v[164:167],v[72:75]
v_mfma_f32_16x16x32_bf16 v[76:79],v[152:155],v[156:159],v[76:79]
v_mfma_f32_16x16x32_bf16 v[80:83],v[152:155],v[160:163],v[80:83]
v_mfma_f32_16x16x32_bf16 v[84:87],v[152:155],v[164:167],v[84:87]
s_waitcnt vmcnt(12) lgkmcnt(0)
s_barrier
v_mfma_f32_16x16x32_bf16 v[64:67],v[168:171],v[176:179],v[64:67]
ds_read_b128 v[128:131],v12 offset:0
s_add_u32 m0,s34,s40
s_nop 0
buffer_load_dwordx4 v4,s[8:11],s30 offen sc1 lds
v_mfma_f32_16x16x32_bf16 v[68:71],v[168:171],v[180:183],v[68:71]
ds_read_b64_tr_b16 v[144:145],v14 offset:0
buffer_load_dwordx4 v4,s[8:11],s30 offen offset:1024 sc1 lds
v_mfma_f32_16x16x32_bf16 v[72:75],v[168:171],v[184:187],v[72:75]
ds_read_b64_tr_b16 v[146:147],v14 offset:512
buffer_load_dwordx4 v5,s[8:11],s30 offen offset:2048 sc1 lds
v_mfma_f32_16x16x32_bf16 v[76:79],v[172:175],v[176:179],v[76:79]
ds_read_b128 v[132:135],v12 offset:2048
buffer_load_dwordx4 v5,s[8:11],s30 offen offset:3072 sc1 lds
s_add_u32 s34,s34,24576
s_cmp_eq_u32 s34,163840
s_cselect_b32 s34,16384,s34
s_add_u32 s30,s30,2048
v_mfma_f32_16x16x32_bf16 v[80:83],v[172:175],v[180:183],v[80:83]
ds_read_b128 v[136:139],v12 offset:4096
s_add_u32 m0,s35,s41
s_nop 0
buffer_load_dwordx4 v8,s[12:15],s32 offen lds
v_mfma_f32_16x16x32_bf16 v[84:87],v[172:175],v[184:187],v[84:87]
ds_read_b128 v[140:143],v12 offset:6144
buffer_load_dwordx4 v9,s[12:15],s32 offen offset:1024 lds
s_add_u32 s35,s35,24576
s_cmp_eq_u32 s35,163840
s_cselect_b32 s35,16384,s35
s_add_u32 s32,s32,393216
v_mfma_f32_16x16x32_bf16 v[64:67],v[188:191],v[196:199],v[64:67]
ds_read_b64_tr_b16 v[148:149],v15 offset:0
v_mfma_f32_16x16x32_bf16 v[68:71],v[188:191],v[200:203],v[68:71]
ds_read_b64_tr_b16 v[150:151],v15 offset:512
v_mfma_f32_16x16x32_bf16 v[72:75],v[188:191],v[204:207],v[72:75]
v_mfma_f32_16x16x32_bf16 v[76:79],v[192:195],v[196:199],v[76:79]
v_mfma_f32_16x16x32_bf16 v[80:83],v[192:195],v[200:203],v[80:83]
v_mfma_f32_16x16x32_bf16 v[84:87],v[192:195],v[204:207],v[84:87]
s_nop 0
buffer_store_dwordx4 v[64:67],v20,s[24:27],0 offen sc1
s_nop 0
buffer_store_dwordx4 v[68:71],v20,s[24:27],0 offen offset:1024 sc1
s_nop 1
buffer_store_dwordx4 v[76:79],v20,s[24:27],0 offen offset:2048 sc1
buffer_store_dwordx4 v[80:83],v20,s[24:27],0 offen offset:3072 sc1
s_mov_b32 exec_lo,0x00010001
s_mov_b32 exec_hi,0x00010001
buffer_store_dwordx4 v[72:75],v22,s[24:27],0 offen sc1
buffer_store_dwordx4 v[84:87],v22,s[24:27],0 offen offset:64 sc1
s_mov_b64 exec,-1
s_lshr_b32 s18,s84,3
s_lshl_b32 s19,s85,1
s_add_u32 s18,s18,s19
s_mul_i32 s60,s18,8448
s_and_b32 s18,s84,7
s_lshl_b32 s18,s18,10
s_add_u32 s60,s60,s18
s_lshl_b32 s18,s20,8
s_add_u32 s60,s60,s18
s_add_u32 s60,s60,28377088
s_bfe_u32 s18,s84,0x10002
s_add_u32 s18,s18,s19
s_mul_i32 s61,s18,8448
s_and_b32 s18,s84,3
s_lshl_b32 s18,s18,6
s_add_u32 s61,s61,s18
s_add_u32 s61,s61,28385280
s_mov_b32 s18,270336
v_mul_lo_u32 v25,v31,s18
v_lshl_add_u32 v25,v30,4,v25
v_mul_lo_u32 v29,v30,s18
v_lshl_add_u32 v29,v31,4,v29
s_lshl_b32 s49,s85,8
s_add_u32 s49,s49,95682560
s_lshl_b32 s52,s85,8
s_add_u32 s52,s52,95436800
v_lshlrev_b32 v28,2,v30
s_waitcnt lgkmcnt(0)
v_mfma_f32_16x16x32_bf16 v[32:35],v[144:147],v[128:131],v[32:35]
v_add_u32 v13,s42,v13
ds_read_b128 v[160:163],v13 offset:0
v_mfma_f32_16x16x32_bf16 v[36:39],v[144:147],v[132:135],v[36:39]
ds_read_b64_tr_b16 v[176:177],v14 offset:4096
ds_read_b64_tr_b16 v[178:179],v14 offset:4608
s_add_u32 s36,s36,24576
v_mfma_f32_16x16x32_bf16 v[40:43],v[144:147],v[136:139],v[40:43]
ds_read_b128 v[164:167],v13 offset:2048
s_add_u32 m0,s34,s40
v_mfma_f32_16x16x32_bf16 v[44:47],v[144:147],v[140:143],v[44:47]
ds_read_b128 v[168:171],v13 offset:4096
buffer_load_dwordx4 v4,s[8:11],s30 offen sc1 lds
v_mfma_f32_16x16x32_bf16 v[48:51],v[148:151],v[128:131],v[48:51]
ds_read_b128 v[172:175],v13 offset:6144
buffer_load_dwordx4 v4,s[8:11],s30 offen offset:1024 sc1 lds
v_mfma_f32_16x16x32_bf16 v[52:55],v[148:151],v[132:135],v[52:55]
ds_read_b64_tr_b16 v[180:181],v15 offset:4096
ds_read_b64_tr_b16 v[182:183],v15 offset:4608
v_mfma_f32_16x16x32_bf16 v[56:59],v[148:151],v[136:139],v[56:59]
buffer_load_dwordx4 v5,s[8:11],s30 offen offset:2048 sc1 lds
buffer_load_dwordx4 v5,s[8:11],s30 offen offset:3072 sc1 lds
v_mfma_f32_16x16x32_bf16 v[60:63],v[148:151],v[140:143],v[60:63]
s_add_u32 s34,s34,24576
s_cmp_eq_u32 s34,163840
s_cselect_b32 s34,16384,s34
s_add_u32 s30,s30,2048
s_add_u32 m0,s35,s41
s_nop 0
buffer_load_dwordx4 v8,s[12:15],s32 offen lds
buffer_load_dwordx4 v9,s[12:15],s32 offen offset:1024 lds
s_add_u32 s35,s35,24576
s_cmp_eq_u32 s35,163840
s_cselect_b32 s35,16384,s35
s_add_u32 s32,s32,393216
s_cmp_eq_u32 s36,163840
s_cselect_b32 s42,s51,s50
s_cselect_b32 s36,16384,s36
s_waitcnt lgkmcnt(0)
v_mfma_f32_16x16x32_bf16 v[32:35],v[176:179],v[160:163],v[32:35]
v_add_u32 v12,s42,v12
v_add_u32 v14,s42,v14
v_mfma_f32_16x16x32_bf16 v[36:39],v[176:179],v[164:167],v[36:39]
v_add_u32 v15,s42,v15
s_waitcnt vmcnt(24)
s_barrier
ds_read_b128 v[128:131],v12 offset:0
v_mfma_f32_16x16x32_bf16 v[40:43],v[176:179],v[168:171],v[40:43]
ds_read_b64_tr_b16 v[144:145],v14 offset:0
ds_read_b64_tr_b16 v[146:147],v14 offset:512
v_mfma_f32_16x16x32_bf16 v[44:47],v[176:179],v[172:175],v[44:47]
ds_read_b128 v[132:135],v12 offset:2048
s_add_u32 m0,s34,s40
v_mfma_f32_16x16x32_bf16 v[48:51],v[180:183],v[160:163],v[48:51]
ds_read_b128 v[136:139],v12 offset:4096
buffer_load_dwordx4 v4,s[8:11],s30 offen sc1 lds
v_mfma_f32_16x16x32_bf16 v[52:55],v[180:183],v[164:167],v[52:55]
ds_read_b128 v[140:143],v12 offset:6144
buffer_load_dwordx4 v4,s[8:11],s30 offen offset:1024 sc1 lds
v_mfma_f32_16x16x32_bf16 v[56:59],v[180:183],v[168:171],v[56:59]
ds_read_b64_tr_b16 v[148:149],v15 offset:0
ds_read_b64_tr_b16 v[150:151],v15 offset:512
v_mfma_f32_16x16x32_bf16 v[60:63],v[180:183],v[172:175],v[60:63]
buffer_load_dwordx4 v5,s[8:11],s30 offen offset:2048 sc1 lds
buffer_load_dwordx4 v5,s[8:11],s30 offen offset:3072 sc1 lds
s_add_u32 s34,s34,24576
s_cmp_eq_u32 s34,163840
s_cselect_b32 s34,16384,s34
s_add_u32 s30,s30,2048
s_add_u32 m0,s35,s41
s_nop 0
buffer_load_dwordx4 v8,s[12:15],s32 offen lds
buffer_load_dwordx4 v9,s[12:15],s32 offen offset:1024 lds
s_add_u32 s35,s35,24576
s_cmp_eq_u32 s35,163840
s_cselect_b32 s35,16384,s35
s_add_u32 s32,s32,393216
s_waitcnt lgkmcnt(0)
v_mfma_f32_16x16x32_bf16 v[32:35],v[144:147],v[128:131],v[32:35]
v_add_u32 v13,s42,v13
ds_read_b128 v[160:163],v13 offset:0
v_mfma_f32_16x16x32_bf16 v[36:39],v[144:147],v[132:135],v[36:39]
ds_read_b64_tr_b16 v[176:177],v14 offset:4096
ds_read_b64_tr_b16 v[178:179],v14 offset:4608
v_mfma_f32_16x16x32_bf16 v[40:43],v[144:147],v[136:139],v[40:43]
ds_read_b128 v[164:167],v13 offset:2048
s_add_u32 m0,s34,s40
s_add_u32 s36,s36,24576
v_mfma_f32_16x16x32_bf16 v[44:47],v[144:147],v[140:143],v[44:47]
ds_read_b128 v[168:171],v13 offset:4096
buffer_load_dwordx4 v4,s[8:11],s30 offen sc1 lds
v_mfma_f32_16x16x32_bf16 v[48:51],v[148:151],v[128:131],v[48:51]
ds_read_b128 v[172:175],v13 offset:6144
buffer_load_dwordx4 v4,s[8:11],s30 offen offset:1024 sc1 lds
v_mfma_f32_16x16x32_bf16 v[52:55],v[148:151],v[132:135],v[52:55]
ds_read_b64_tr_b16 v[180:181],v15 offset:4096
ds_read_b64_tr_b16 v[182:183],v15 offset:4608
v_mfma_f32_16x16x32_bf16 v[56:59],v[148:151],v[136:139],v[56:59]
buffer_load_dwordx4 v5,s[8:11],s30 offen offset:2048 sc1 lds
v_mfma_f32_16x16x32_bf16 v[60:63],v[148:151],v[140:143],v[60:63]
s_cmp_eq_u32 s36,163840
s_cselect_b32 s42,s51,s50
s_cselect_b32 s36,16384,s36
s_waitcnt lgkmcnt(0)
v_mfma_f32_16x16x32_bf16 v[32:35],v[176:179],v[160:163],v[32:35]
v_add_u32 v12,s42,v12
v_add_u32 v14,s42,v14
v_mfma_f32_16x16x32_bf16 v[36:39],v[176:179],v[164:167],v[36:39]
v_add_u32 v15,s42,v15
s_waitcnt vmcnt(27)
s_barrier
ds_read_b128 v[128:131],v12 offset:0
v_mfma_f32_16x16x32_bf16 v[40:43],v[176:179],v[168:171],v[40:43]
ds_read_b64_tr_b16 v[144:145],v14 offset:0
ds_read_b64_tr_b16 v[146:147],v14 offset:512
v_mfma_f32_16x16x32_bf16 v[44:47],v[176:179],v[172:175],v[44:47]
ds_read_b128 v[132:135],v12 offset:2048
buffer_load_dwordx4 v5,s[8:11],s30 offen offset:3072 sc1 lds
v_mfma_f32_16x16x32_bf16 v[48:51],v[180:183],v[160:163],v[48:51]
ds_read_b128 v[136:139],v12 offset:4096
s_add_u32 s34,s34,24576
v_mfma_f32_16x16x32_bf16 v[52:55],v[180:183],v[164:167],v[52:55]
ds_read_b128 v[140:143],v12 offset:6144
v_mfma_f32_16x16x32_bf16 v[56:59],v[180:183],v[168:171],v[56:59]
ds_read_b64_tr_b16 v[148:149],v15 offset:0
ds_read_b64_tr_b16 v[150:151],v15 offset:512
v_mfma_f32_16x16x32_bf16 v[60:63],v[180:183],v[172:175],v[60:63]
s_cmp_eq_u32 s34,163840
s_cselect_b32 s34,16384,s34
s_add_u32 s30,s30,2048
s_add_u32 m0,s35,s41
s_nop 0
buffer_load_dwordx4 v8,s[12:15],s32 offen lds
buffer_load_dwordx4 v9,s[12:15],s32 offen offset:1024 lds
s_add_u32 s35,s35,24576
s_cmp_eq_u32 s35,163840
s_cselect_b32 s35,16384,s35
s_add_u32 s32,s32,393216
s_waitcnt lgkmcnt(0)
v_mfma_f32_16x16x32_bf16 v[32:35],v[144:147],v[128:131],v[32:35]
v_add_u32 v13,s42,v13
ds_read_b128 v[160:163],v13 offset:0
v_mfma_f32_16x16x32_bf16 v[36:39],v[144:147],v[132:135],v[36:39]
ds_read_b64_tr_b16 v[176:177],v14 offset:4096
ds_read_b64_tr_b16 v[178:179],v14 offset:4608
v_mfma_f32_16x16x32_bf16 v[40:43],v[144:147],v[136:139],v[40:43]
ds_read_b128 v[164:167],v13 offset:2048
s_add_u32 m0,s34,s40
s_add_u32 s36,s36,24576
v_mfma_f32_16x16x32_bf16 v[44:47],v[144:147],v[140:143],v[44:47]
ds_read_b128 v[168:171],v13 offset:4096
buffer_load_dwordx4 v4,s[8:11],s30 offen sc1 lds
v_mfma_f32_16x16x32_bf16 v[48:51],v[148:151],v[128:131],v[48:51]
ds_read_b128 v[172:175],v13 offset:6144
buffer_load_dwordx4 v4,s[8:11],s30 offen offset:1024 sc1 lds
v_mfma_f32_16x16x32_bf16 v[52:55],v[148:151],v[132:135],v[52:55]
ds_read_b64_tr_b16 v[180:181],v15 offset:4096
ds_read_b64_tr_b16 v[182:183],v15 offset:4608
v_mfma_f32_16x16x32_bf16 v[56:59],v[148:151],v[136:139],v[56:59]
buffer_load_dwordx4 v5,s[8:11],s30 offen offset:2048 sc1 lds
v_mfma_f32_16x16x32_bf16 v[60:63],v[148:151],v[140:143],v[60:63]
s_cmp_eq_u32 s36,163840
s_cselect_b32 s42,s51,s50
s_cselect_b32 s36,16384,s36
s_waitcnt lgkmcnt(0)
v_mfma_f32_16x16x32_bf16 v[32:35],v[176:179],v[160:163],v[32:35]
v_add_u32 v12,s42,v12
v_add_u32 v14,s42,v14
v_mfma_f32_16x16x32_bf16 v[36:39],v[176:179],v[164:167],v[36:39]
v_add_u32 v15,s42,v15
s_waitcnt vmcnt(21)
s_barrier
s_cmp_lg_u32 s20,0
s_cbranch_scc1 Lpub186
s_mov_b32 s18,s85
s_mov_b32 s19,s84
s_lshl_b32 s18,s18,8
s_lshl_b32 s19,s19,2
s_add_u32 s18,s18,s19
s_add_u32 s18,s18,95682560
v_mov_b32 v1,0
v_mov_b32 v3,s94
s_mov_b64 exec,1
buffer_store_dword v3,v1,s[24:27],s18 offen sc1
s_mov_b64 exec,-1
Lpub186:
ds_read_b128 v[128:131],v12 offset:0
v_mfma_f32_16x16x32_bf16 v[40:43],v[176:179],v[168:171],v[40:43]
ds_read_b64_tr_b16 v[144:145],v14 offset:0
ds_read_b64_tr_b16 v[146:147],v14 offset:512
v_mfma_f32_16x16x32_bf16 v[44:47],v[176:179],v[172:175],v[44:47]
ds_read_b128 v[132:135],v12 offset:2048
buffer_load_dwordx4 v5,s[8:11],s30 offen offset:3072 sc1 lds
v_mfma_f32_16x16x32_bf16 v[48:51],v[180:183],v[160:163],v[48:51]
ds_read_b128 v[136:139],v12 offset:4096
s_add_u32 s34,s34,24576
v_mfma_f32_16x16x32_bf16 v[52:55],v[180:183],v[164:167],v[52:55]
ds_read_b128 v[140:143],v12 offset:6144
v_mfma_f32_16x16x32_bf16 v[56:59],v[180:183],v[168:171],v[56:59]
ds_read_b64_tr_b16 v[148:149],v15 offset:0
ds_read_b64_tr_b16 v[150:151],v15 offset:512
v_mfma_f32_16x16x32_bf16 v[60:63],v[180:183],v[172:175],v[60:63]
s_cmp_eq_u32 s34,163840
s_cselect_b32 s34,16384,s34
s_add_u32 s30,s30,2048
s_add_u32 m0,s35,s41
s_nop 0
buffer_load_dwordx4 v8,s[12:15],s32 offen lds
buffer_load_dwordx4 v9,s[12:15],s32 offen offset:1024 lds
s_add_u32 s35,s35,24576
s_cmp_eq_u32 s35,163840
s_cselect_b32 s35,16384,s35
s_add_u32 s32,s32,393216
s_waitcnt lgkmcnt(0)
v_mfma_f32_16x16x32_bf16 v[32:35],v[144:147],v[128:131],v[32:35]
v_add_u32 v13,s42,v13
ds_read_b128 v[160:163],v13 offset:0
v_mfma_f32_16x16x32_bf16 v[36:39],v[144:147],v[132:135],v[36:39]
ds_read_b64_tr_b16 v[176:177],v14 offset:4096
ds_read_b64_tr_b16 v[178:179],v14 offset:4608
v_mfma_f32_16x16x32_bf16 v[40:43],v[144:147],v[136:139],v[40:43]
ds_read_b128 v[164:167],v13 offset:2048
s_add_u32 m0,s34,s40
s_add_u32 s36,s36,24576
v_mfma_f32_16x16x32_bf16 v[44:47],v[144:147],v[140:143],v[44:47]
ds_read_b128 v[168:171],v13 offset:4096
buffer_load_dwordx4 v4,s[8:11],s30 offen sc1 lds
v_mfma_f32_16x16x32_bf16 v[48:51],v[148:151],v[128:131],v[48:51]
ds_read_b128 v[172:175],v13 offset:6144
buffer_load_dwordx4 v4,s[8:11],s30 offen offset:1024 sc1 lds
v_mfma_f32_16x16x32_bf16 v[52:55],v[148:151],v[132:135],v[52:55]
ds_read_b64_tr_b16 v[180:181],v15 offset:4096
ds_read_b64_tr_b16 v[182:183],v15 offset:4608
v_mfma_f32_16x16x32_bf16 v[56:59],v[148:151],v[136:139],v[56:59]
buffer_load_dwordx4 v5,s[8:11],s30 offen offset:2048 sc1 lds
v_mfma_f32_16x16x32_bf16 v[60:63],v[148:151],v[140:143],v[60:63]
s_cmp_eq_u32 s36,163840
s_cselect_b32 s42,s51,s50
s_cselect_b32 s36,16384,s36
s_waitcnt lgkmcnt(0)
v_mfma_f32_16x16x32_bf16 v[32:35],v[176:179],v[160:163],v[32:35]
v_add_u32 v12,s42,v12
v_add_u32 v14,s42,v14
v_mfma_f32_16x16x32_bf16 v[36:39],v[176:179],v[164:167],v[36:39]
v_add_u32 v15,s42,v15
s_waitcnt vmcnt(21)
s_barrier
ds_read_b128 v[128:131],v12 offset:0
v_mfma_f32_16x16x32_bf16 v[40:43],v[176:179],v[168:171],v[40:43]
ds_read_b64_tr_b16 v[144:145],v14 offset:0
ds_read_b64_tr_b16 v[146:147],v14 offset:512
v_mfma_f32_16x16x32_bf16 v[44:47],v[176:179],v[172:175],v[44:47]
ds_read_b128 v[132:135],v12 offset:2048
buffer_load_dwordx4 v5,s[8:11],s30 offen offset:3072 sc1 lds
v_mfma_f32_16x16x32_bf16 v[48:51],v[180:183],v[160:163],v[48:51]
ds_read_b128 v[136:139],v12 offset:4096
s_add_u32 s34,s34,24576
v_mfma_f32_16x16x32_bf16 v[52:55],v[180:183],v[164:167],v[52:55]
ds_read_b128 v[140:143],v12 offset:6144
v_mfma_f32_16x16x32_bf16 v[56:59],v[180:183],v[168:171],v[56:59]
ds_read_b64_tr_b16 v[148:149],v15 offset:0
ds_read_b64_tr_b16 v[150:151],v15 offset:512
v_mfma_f32_16x16x32_bf16 v[60:63],v[180:183],v[172:175],v[60:63]
s_cmp_eq_u32 s34,163840
s_cselect_b32 s34,16384,s34
s_add_u32 s30,s30,2048
s_add_u32 m0,s35,s41
s_nop 0
buffer_load_dwordx4 v8,s[12:15],s32 offen lds
buffer_load_dwordx4 v9,s[12:15],s32 offen offset:1024 lds
s_add_u32 s35,s35,24576
s_cmp_eq_u32 s35,163840
s_cselect_b32 s35,16384,s35
s_add_u32 s32,s32,393216
s_waitcnt lgkmcnt(0)
v_mfma_f32_16x16x32_bf16 v[32:35],v[144:147],v[128:131],v[32:35]
v_add_u32 v13,s42,v13
ds_read_b128 v[160:163],v13 offset:0
v_mfma_f32_16x16x32_bf16 v[36:39],v[144:147],v[132:135],v[36:39]
ds_read_b64_tr_b16 v[176:177],v14 offset:4096
ds_read_b64_tr_b16 v[178:179],v14 offset:4608
v_mfma_f32_16x16x32_bf16 v[40:43],v[144:147],v[136:139],v[40:43]
ds_read_b128 v[164:167],v13 offset:2048
s_add_u32 m0,s34,s40
s_add_u32 s36,s36,24576
v_mfma_f32_16x16x32_bf16 v[44:47],v[144:147],v[140:143],v[44:47]
ds_read_b128 v[168:171],v13 offset:4096
buffer_load_dwordx4 v4,s[8:11],s30 offen sc1 lds
v_mfma_f32_16x16x32_bf16 v[48:51],v[148:151],v[128:131],v[48:51]
ds_read_b128 v[172:175],v13 offset:6144
buffer_load_dwordx4 v4,s[8:11],s30 offen offset:1024 sc1 lds
v_mfma_f32_16x16x32_bf16 v[52:55],v[148:151],v[132:135],v[52:55]
ds_read_b64_tr_b16 v[180:181],v15 offset:4096
ds_read_b64_tr_b16 v[182:183],v15 offset:4608
v_mfma_f32_16x16x32_bf16 v[56:59],v[148:151],v[136:139],v[56:59]
buffer_load_dwordx4 v5,s[8:11],s30 offen offset:2048 sc1 lds
v_mfma_f32_16x16x32_bf16 v[60:63],v[148:151],v[140:143],v[60:63]
s_cmp_eq_u32 s36,163840
s_cselect_b32 s42,s51,s50
s_cselect_b32 s36,16384,s36
s_waitcnt lgkmcnt(0)
v_mfma_f32_16x16x32_bf16 v[32:35],v[176:179],v[160:163],v[32:35]
v_add_u32 v12,s42,v12
v_add_u32 v14,s42,v14
v_mfma_f32_16x16x32_bf16 v[36:39],v[176:179],v[164:167],v[36:39]
v_add_u32 v15,s42,v15
s_waitcnt vmcnt(21)
s_barrier
ds_read_b128 v[128:131],v12 offset:0
v_mfma_f32_16x16x32_bf16 v[40:43],v[176:179],v[168:171],v[40:43]
ds_read_b64_tr_b16 v[144:145],v14 offset:0
ds_read_b64_tr_b16 v[146:147],v14 offset:512
v_mfma_f32_16x16x32_bf16 v[44:47],v[176:179],v[172:175],v[44:47]
ds_read_b128 v[132:135],v12 offset:2048
buffer_load_dwordx4 v5,s[8:11],s30 offen offset:3072 sc1 lds
v_mfma_f32_16x16x32_bf16 v[48:51],v[180:183],v[160:163],v[48:51]
ds_read_b128 v[136:139],v12 offset:4096
s_add_u32 s34,s34,24576
v_mfma_f32_16x16x32_bf16 v[52:55],v[180:183],v[164:167],v[52:55]
ds_read_b128 v[140:143],v12 offset:6144
v_mfma_f32_16x16x32_bf16 v[56:59],v[180:183],v[168:171],v[56:59]
ds_read_b64_tr_b16 v[148:149],v15 offset:0
ds_read_b64_tr_b16 v[150:151],v15 offset:512
v_mfma_f32_16x16x32_bf16 v[60:63],v[180:183],v[172:175],v[60:63]
s_cmp_eq_u32 s34,163840
s_cselect_b32 s34,16384,s34
s_add_u32 s30,s30,2048
s_add_u32 m0,s35,s41
s_nop 0
buffer_load_dwordx4 v8,s[12:15],s32 offen lds
buffer_load_dwordx4 v9,s[12:15],s32 offen offset:1024 lds
s_add_u32 s35,s35,24576
s_cmp_eq_u32 s35,163840
s_cselect_b32 s35,16384,s35
s_add_u32 s32,s32,393216
buffer_load_dword v26,v28,s[24:27],s49 offen sc1
s_waitcnt lgkmcnt(0)
v_mfma_f32_16x16x32_bf16 v[32:35],v[144:147],v[128:131],v[32:35]
v_add_u32 v13,s42,v13
ds_read_b128 v[160:163],v13 offset:0
v_mfma_f32_16x16x32_bf16 v[36:39],v[144:147],v[132:135],v[36:39]
ds_read_b64_tr_b16 v[176:177],v14 offset:4096
ds_read_b64_tr_b16 v[178:179],v14 offset:4608
v_mfma_f32_16x16x32_bf16 v[40:43],v[144:147],v[136:139],v[40:43]
ds_read_b128 v[164:167],v13 offset:2048
s_add_u32 m0,s34,s40
s_add_u32 s36,s36,24576
v_mfma_f32_16x16x32_bf16 v[44:47],v[144:147],v[140:143],v[44:47]
ds_read_b128 v[168:171],v13 offset:4096
buffer_load_dwordx4 v4,s[8:11],s30 offen sc1 lds
v_mfma_f32_16x16x32_bf16 v[48:51],v[148:151],v[128:131],v[48:51]
ds_read_b128 v[172:175],v13 offset:6144
buffer_load_dwordx4 v4,s[8:11],s30 offen offset:1024 sc1 lds
v_mfma_f32_16x16x32_bf16 v[52:55],v[148:151],v[132:135],v[52:55]
ds_read_b64_tr_b16 v[180:181],v15 offset:4096
ds_read_b64_tr_b16 v[182:183],v15 offset:4608
v_mfma_f32_16x16x32_bf16 v[56:59],v[148:151],v[136:139],v[56:59]
buffer_load_dwordx4 v5,s[8:11],s30 offen offset:2048 sc1 lds
v_mfma_f32_16x16x32_bf16 v[60:63],v[148:151],v[140:143],v[60:63]
s_cmp_eq_u32 s36,163840
s_cselect_b32 s42,s51,s50
s_cselect_b32 s36,16384,s36
s_waitcnt lgkmcnt(0)
v_mfma_f32_16x16x32_bf16 v[32:35],v[176:179],v[160:163],v[32:35]
v_add_u32 v12,s42,v12
v_add_u32 v14,s42,v14
v_mfma_f32_16x16x32_bf16 v[36:39],v[176:179],v[164:167],v[36:39]
v_add_u32 v15,s42,v15
s_waitcnt vmcnt(22)
s_barrier
ds_read_b128 v[128:131],v12 offset:0
v_mfma_f32_16x16x32_bf16 v[40:43],v[176:179],v[168:171],v[40:43]
ds_read_b64_tr_b16 v[144:145],v14 offset:0
ds_read_b64_tr_b16 v[146:147],v14 offset:512
v_mfma_f32_16x16x32_bf16 v[44:47],v[176:179],v[172:175],v[44:47]
ds_read_b128 v[132:135],v12 offset:2048
buffer_load_dwordx4 v5,s[8:11],s30 offen offset:3072 sc1 lds
v_mfma_f32_16x16x32_bf16 v[48:51],v[180:183],v[160:163],v[48:51]
ds_read_b128 v[136:139],v12 offset:4096
s_add_u32 s34,s34,24576
v_mfma_f32_16x16x32_bf16 v[52:55],v[180:183],v[164:167],v[52:55]
ds_read_b128 v[140:143],v12 offset:6144
v_mfma_f32_16x16x32_bf16 v[56:59],v[180:183],v[168:171],v[56:59]
ds_read_b64_tr_b16 v[148:149],v15 offset:0
ds_read_b64_tr_b16 v[150:151],v15 offset:512
v_mfma_f32_16x16x32_bf16 v[60:63],v[180:183],v[172:175],v[60:63]
s_cmp_eq_u32 s34,163840
s_cselect_b32 s34,16384,s34
s_add_u32 s30,s30,2048
s_add_u32 m0,s35,s41
s_nop 0
buffer_load_dwordx4 v8,s[12:15],s32 offen lds
buffer_load_dwordx4 v9,s[12:15],s32 offen offset:1024 lds
s_add_u32 s35,s35,24576
s_cmp_eq_u32 s35,163840
s_cselect_b32 s35,16384,s35
s_add_u32 s32,s32,393216
s_waitcnt lgkmcnt(0)
v_mfma_f32_16x16x32_bf16 v[32:35],v[144:147],v[128:131],v[32:35]
v_add_u32 v13,s42,v13
ds_read_b128 v[160:163],v13 offset:0
v_mfma_f32_16x16x32_bf16 v[36:39],v[144:147],v[132:135],v[36:39]
ds_read_b64_tr_b16 v[176:177],v14 offset:4096
ds_read_b64_tr_b16 v[178:179],v14 offset:4608
v_mfma_f32_16x16x32_bf16 v[40:43],v[144:147],v[136:139],v[40:43]
ds_read_b128 v[164:167],v13 offset:2048
s_add_u32 s36,s36,24576
v_mfma_f32_16x16x32_bf16 v[44:47],v[144:147],v[140:143],v[44:47]
ds_read_b128 v[168:171],v13 offset:4096
v_mfma_f32_16x16x32_bf16 v[48:51],v[148:151],v[128:131],v[48:51]
ds_read_b128 v[172:175],v13 offset:6144
v_mfma_f32_16x16x32_bf16 v[52:55],v[148:151],v[132:135],v[52:55]
ds_read_b64_tr_b16 v[180:181],v15 offset:4096
ds_read_b64_tr_b16 v[182:183],v15 offset:4608
v_mfma_f32_16x16x32_bf16 v[56:59],v[148:151],v[136:139],v[56:59]
v_mfma_f32_16x16x32_bf16 v[60:63],v[148:151],v[140:143],v[60:63]
s_cmp_eq_u32 s36,163840
s_cselect_b32 s42,s51,s50
s_cselect_b32 s36,16384,s36
s_waitcnt lgkmcnt(0)
v_mfma_f32_16x16x32_bf16 v[32:35],v[176:179],v[160:163],v[32:35]
v_add_u32 v12,s42,v12
v_add_u32 v14,s42,v14
v_mfma_f32_16x16x32_bf16 v[36:39],v[176:179],v[164:167],v[36:39]
v_add_u32 v15,s42,v15
s_waitcnt vmcnt(6)
s_barrier
s_mov_b32 s39,131072
Lspl188:
v_cmp_ne_u32 s[90:91],s94,v26
s_nop 1
s_cmp_eq_u64 s[90:91],0
s_cbranch_scc1 Lsok187
s_sleep 1
buffer_load_dword v26,v28,s[24:27],s49 offen sc1
s_waitcnt vmcnt(0)
s_sub_u32 s39,s39,1
s_cmp_lg_u32 s39,0
s_cbranch_scc1 Lspl188
Lsok187:
ds_read_b128 v[128:131],v12 offset:0
v_mfma_f32_16x16x32_bf16 v[40:43],v[176:179],v[168:171],v[40:43]
ds_read_b64_tr_b16 v[144:145],v14 offset:0
ds_read_b64_tr_b16 v[146:147],v14 offset:512
v_mfma_f32_16x16x32_bf16 v[44:47],v[176:179],v[172:175],v[44:47]
ds_read_b128 v[132:135],v12 offset:2048
buffer_load_dwordx4 v[64:67],v25,s[24:27],s60 offen sc1
v_mfma_f32_16x16x32_bf16 v[48:51],v[180:183],v[160:163],v[48:51]
ds_read_b128 v[136:139],v12 offset:4096
s_add_u32 s60,s60,1081344
v_mfma_f32_16x16x32_bf16 v[52:55],v[180:183],v[164:167],v[52:55]
ds_read_b128 v[140:143],v12 offset:6144
buffer_load_dwordx4 v[68:71],v25,s[24:27],s60 offen sc1
v_mfma_f32_16x16x32_bf16 v[56:59],v[180:183],v[168:171],v[56:59]
ds_read_b64_tr_b16 v[148:149],v15 offset:0
ds_read_b64_tr_b16 v[150:151],v15 offset:512
v_mfma_f32_16x16x32_bf16 v[60:63],v[180:183],v[172:175],v[60:63]
s_add_u32 s60,s60,1081344
buffer_load_dwordx4 v[72:75],v25,s[24:27],s60 offen sc1
s_add_u32 s60,s60,1081344
buffer_load_dwordx4 v[76:79],v25,s[24:27],s60 offen sc1
buffer_load_dwordx4 v[80:83],v29,s[24:27],s61 offen sc1
s_waitcnt lgkmcnt(0)
v_mfma_f32_16x16x32_bf16 v[32:35],v[144:147],v[128:131],v[32:35]
v_add_u32 v13,s42,v13
ds_read_b128 v[160:163],v13 offset:0
v_mfma_f32_16x16x32_bf16 v[36:39],v[144:147],v[132:135],v[36:39]
ds_read_b64_tr_b16 v[176:177],v14 offset:4096
ds_read_b64_tr_b16 v[178:179],v14 offset:4608
v_mfma_f32_16x16x32_bf16 v[40:43],v[144:147],v[136:139],v[40:43]
ds_read_b128 v[164:167],v13 offset:2048
s_add_u32 s36,s36,24576
v_mfma_f32_16x16x32_bf16 v[44:47],v[144:147],v[140:143],v[44:47]
ds_read_b128 v[168:171],v13 offset:4096
v_mfma_f32_16x16x32_bf16 v[48:51],v[148:151],v[128:131],v[48:51]
ds_read_b128 v[172:175],v13 offset:6144
v_mfma_f32_16x16x32_bf16 v[52:55],v[148:151],v[132:135],v[52:55]
ds_read_b64_tr_b16 v[180:181],v15 offset:4096
ds_read_b64_tr_b16 v[182:183],v15 offset:4608
v_mfma_f32_16x16x32_bf16 v[56:59],v[148:151],v[136:139],v[56:59]
v_mfma_f32_16x16x32_bf16 v[60:63],v[148:151],v[140:143],v[60:63]
s_cmp_eq_u32 s36,163840
s_cselect_b32 s42,s51,s50
s_cselect_b32 s36,16384,s36
s_waitcnt lgkmcnt(0)
v_mfma_f32_16x16x32_bf16 v[32:35],v[176:179],v[160:163],v[32:35]
v_add_u32 v12,s42,v12
v_add_u32 v14,s42,v14
v_mfma_f32_16x16x32_bf16 v[36:39],v[176:179],v[164:167],v[36:39]
v_add_u32 v15,s42,v15
s_waitcnt vmcnt(11)
s_barrier
ds_read_b128 v[128:131],v12 offset:0
v_mfma_f32_16x16x32_bf16 v[40:43],v[176:179],v[168:171],v[40:43]
ds_read_b64_tr_b16 v[144:145],v14 offset:0
ds_read_b64_tr_b16 v[146:147],v14 offset:512
v_mfma_f32_16x16x32_bf16 v[44:47],v[176:179],v[172:175],v[44:47]
ds_read_b128 v[132:135],v12 offset:2048
v_mfma_f32_16x16x32_bf16 v[48:51],v[180:183],v[160:163],v[48:51]
ds_read_b128 v[136:139],v12 offset:4096
v_mfma_f32_16x16x32_bf16 v[52:55],v[180:183],v[164:167],v[52:55]
ds_read_b128 v[140:143],v12 offset:6144
v_mfma_f32_16x16x32_bf16 v[56:59],v[180:183],v[168:171],v[56:59]
ds_read_b64_tr_b16 v[148:149],v15 offset:0
ds_read_b64_tr_b16 v[150:151],v15 offset:512
v_mfma_f32_16x16x32_bf16 v[60:63],v[180:183],v[172:175],v[60:63]
s_waitcnt lgkmcnt(0)
v_mfma_f32_16x16x32_bf16 v[32:35],v[144:147],v[128:131],v[32:35]
v_add_u32 v13,s42,v13
ds_read_b128 v[160:163],v13 offset:0
v_mfma_f32_16x16x32_bf16 v[36:39],v[144:147],v[132:135],v[36:39]
ds_read_b64_tr_b16 v[176:177],v14 offset:4096
ds_read_b64_tr_b16 v[178:179],v14 offset:4608
v_mfma_f32_16x16x32_bf16 v[40:43],v[144:147],v[136:139],v[40:43]
ds_read_b128 v[164:167],v13 offset:2048
s_add_u32 s36,s36,24576
v_mfma_f32_16x16x32_bf16 v[44:47],v[144:147],v[140:143],v[44:47]
ds_read_b128 v[168:171],v13 offset:4096
v_mfma_f32_16x16x32_bf16 v[48:51],v[148:151],v[128:131],v[48:51]
ds_read_b128 v[172:175],v13 offset:6144
v_mfma_f32_16x16x32_bf16 v[52:55],v[148:151],v[132:135],v[52:55]
ds_read_b64_tr_b16 v[180:181],v15 offset:4096
ds_read_b64_tr_b16 v[182:183],v15 offset:4608
v_mfma_f32_16x16x32_bf16 v[56:59],v[148:151],v[136:139],v[56:59]
v_mfma_f32_16x16x32_bf16 v[60:63],v[148:151],v[140:143],v[60:63]
s_cmp_eq_u32 s36,163840
s_cselect_b32 s42,s51,s50
s_cselect_b32 s36,16384,s36
s_waitcnt vmcnt(0)
s_waitcnt lgkmcnt(0)
v_mfma_f32_16x16x32_bf16 v[32:35],v[176:179],v[160:163],v[32:35]
v_add_u32 v12,s42,v12
v_add_u32 v14,s42,v14
v_mfma_f32_16x16x32_bf16 v[36:39],v[176:179],v[164:167],v[36:39]
v_add_u32 v15,s42,v15
s_waitcnt vmcnt(11)
s_barrier
ds_read_b128 v[128:131],v12 offset:0
v_mfma_f32_16x16x32_bf16 v[40:43],v[176:179],v[168:171],v[40:43]
ds_read_b64_tr_b16 v[144:145],v14 offset:0
ds_read_b64_tr_b16 v[146:147],v14 offset:512
v_add_f32 v64,v64,v68
v_add_f32 v65,v65,v69
v_add_f32 v66,v66,v70
v_add_f32 v67,v67,v71
v_add_f32 v72,v72,v76
v_mfma_f32_16x16x32_bf16 v[44:47],v[176:179],v[172:175],v[44:47]
ds_read_b128 v[132:135],v12 offset:2048
v_add_f32 v73,v73,v77
v_add_f32 v74,v74,v78
v_add_f32 v75,v75,v79
v_add_f32 v64,v64,v72
v_add_f32 v65,v65,v73
v_add_f32 v66,v66,v74
v_mfma_f32_16x16x32_bf16 v[48:51],v[180:183],v[160:163],v[48:51]
ds_read_b128 v[136:139],v12 offset:4096
v_add_f32 v67,v67,v75
v_add_f32_dpp v80,v80,v80 row_ror:8 row_mask:0xf bank_mask:0xf
v_add_f32_dpp v81,v81,v81 row_ror:8 row_mask:0xf bank_mask:0xf
v_add_f32_dpp v82,v82,v82 row_ror:8 row_mask:0xf bank_mask:0xf
v_add_f32_dpp v83,v83,v83 row_ror:8 row_mask:0xf bank_mask:0xf
v_add_f32_dpp v80,v80,v80 row_ror:4 row_mask:0xf bank_mask:0xf
v_mfma_f32_16x16x32_bf16 v[52:55],v[180:183],v[164:167],v[52:55]
ds_read_b128 v[140:143],v12 offset:6144
v_add_f32_dpp v81,v81,v81 row_ror:4 row_mask:0xf bank_mask:0xf
v_add_f32_dpp v82,v82,v82 row_ror:4 row_mask:0xf bank_mask:0xf
v_add_f32_dpp v83,v83,v83 row_ror:4 row_mask:0xf bank_mask:0xf
v_add_f32_dpp v80,v80,v80 row_ror:2 row_mask:0xf bank_mask:0xf
v_add_f32_dpp v81,v81,v81 row_ror:2 row_mask:0xf bank_mask:0xf
v_add_f32_dpp v82,v82,v82 row_ror:2 row_mask:0xf bank_mask:0xf
v_mfma_f32_16x16x32_bf16 v[56:59],v[180:183],v[168:171],v[56:59]
ds_read_b64_tr_b16 v[148:149],v15 offset:0
ds_read_b64_tr_b16 v[150:151],v15 offset:512
v_add_f32_dpp v83,v83,v83 row_ror:2 row_mask:0xf bank_mask:0xf
v_add_f32_dpp v80,v80,v80 row_ror:1 row_mask:0xf bank_mask:0xf
v_add_f32_dpp v81,v81,v81 row_ror:1 row_mask:0xf bank_mask:0xf
v_add_f32_dpp v82,v82,v82 row_ror:1 row_mask:0xf bank_mask:0xf
v_add_f32_dpp v83,v83,v83 row_ror:1 row_mask:0xf bank_mask:0xf
v_mfma_f32_16x16x32_bf16 v[60:63],v[180:183],v[172:175],v[60:63]
v_mov_b32 v84,v64
v_mov_b32 v85,v65
v_mov_b32 v86,v66
v_mov_b32 v87,v67
s_waitcnt lgkmcnt(0)
v_mfma_f32_16x16x32_bf16 v[32:35],v[144:147],v[128:131],v[32:35]
v_add_u32 v13,s42,v13
ds_read_b128 v[160:163],v13 offset:0
v_mfma_f32_16x16x32_bf16 v[36:39],v[144:147],v[132:135],v[36:39]
ds_read_b64_tr_b16 v[176:177],v14 offset:4096
ds_read_b64_tr_b16 v[178:179],v14 offset:4608
s_add_u32 s36,s36,24576
s_cmp_eq_u32 s36,163840
s_cselect_b32 s42,s51,s50
s_cselect_b32 s36,16384,s36
v_permlane32_swap_b32 v64,v84
v_mfma_f32_16x16x32_bf16 v[40:43],v[144:147],v[136:139],v[40:43]
ds_read_b128 v[164:167],v13 offset:2048
v_permlane32_swap_b32 v65,v85
v_permlane32_swap_b32 v66,v86
v_permlane32_swap_b32 v67,v87
v_add_f32 v64,v64,v84
v_mfma_f32_16x16x32_bf16 v[44:47],v[144:147],v[140:143],v[44:47]
ds_read_b128 v[168:171],v13 offset:4096
v_add_f32 v65,v65,v85
v_add_f32 v66,v66,v86
v_add_f32 v67,v67,v87
v_mov_b32 v84,v64
v_mov_b32 v85,v65
v_mov_b32 v86,v66
v_mov_b32 v87,v67
v_mfma_f32_16x16x32_bf16 v[48:51],v[148:151],v[128:131],v[48:51]
ds_read_b128 v[172:175],v13 offset:6144
v_permlane16_swap_b32 v64,v84
v_permlane16_swap_b32 v65,v85
v_permlane16_swap_b32 v66,v86
v_mfma_f32_16x16x32_bf16 v[52:55],v[148:151],v[132:135],v[52:55]
ds_read_b64_tr_b16 v[180:181],v15 offset:4096
ds_read_b64_tr_b16 v[182:183],v15 offset:4608
v_permlane16_swap_b32 v67,v87
v_add_f32 v64,v64,v84
v_add_f32 v65,v65,v85
v_add_f32 v66,v66,v86
v_add_f32 v67,v67,v87
v_mfma_f32_16x16x32_bf16 v[56:59],v[148:151],v[136:139],v[56:59]
v_cvt_pk_bf16_f32 v68,v64,v65
v_cvt_pk_bf16_f32 v69,v66,v67
v_cvt_pk_bf16_f32 v70,v80,v81
v_cvt_pk_bf16_f32 v71,v82,v83
v_and_b32 v3,3,v2
v_cmp_eq_u32 vcc,0,v3
v_cmp_eq_u32 s[90:91],1,v3
v_lshlrev_b32 v1,4,v2
v_mfma_f32_16x16x32_bf16 v[60:63],v[148:151],v[140:143],v[60:63]
v_cndmask_b32 v3,0,v24,s[90:91]
v_cndmask_b32 v70,v3,v70,vcc
v_cndmask_b32 v71,v3,v71,vcc
s_lshl_b32 s18,s20,8
s_add_u32 s18,s18,s92
s_mov_b64 exec,0xffff
buffer_store_dwordx2 v[68:69],v1,s[24:27],s18 offen sc1
s_mov_b64 exec,-1
s_lshr_b32 s18,s84,3
s_lshl_b32 s18,s18,2
s_add_u32 s18,s18,s20
s_cmp_lg_u32 s18,1
s_cbranch_scc1 Lhz185
buffer_store_dwordx2 v[70:71],v1,s[24:27],s93 offen sc1
Lhz185:
s_waitcnt lgkmcnt(0)
v_mfma_f32_16x16x32_bf16 v[32:35],v[176:179],v[160:163],v[32:35]
v_add_u32 v12,s42,v12
v_add_u32 v14,s42,v14
v_mfma_f32_16x16x32_bf16 v[36:39],v[176:179],v[164:167],v[36:39]
v_add_u32 v15,s42,v15
s_waitcnt vmcnt(1)
s_barrier
ds_read_b128 v[128:131],v12 offset:0
v_mfma_f32_16x16x32_bf16 v[40:43],v[176:179],v[168:171],v[40:43]
ds_read_b64_tr_b16 v[144:145],v14 offset:0
ds_read_b64_tr_b16 v[146:147],v14 offset:512
v_mfma_f32_16x16x32_bf16 v[44:47],v[176:179],v[172:175],v[44:47]
ds_read_b128 v[132:135],v12 offset:2048
v_mfma_f32_16x16x32_bf16 v[48:51],v[180:183],v[160:163],v[48:51]
ds_read_b128 v[136:139],v12 offset:4096
v_mfma_f32_16x16x32_bf16 v[52:55],v[180:183],v[164:167],v[52:55]
ds_read_b128 v[140:143],v12 offset:6144
v_mfma_f32_16x16x32_bf16 v[56:59],v[180:183],v[168:171],v[56:59]
ds_read_b64_tr_b16 v[148:149],v15 offset:0
ds_read_b64_tr_b16 v[150:151],v15 offset:512
v_mfma_f32_16x16x32_bf16 v[60:63],v[180:183],v[172:175],v[60:63]
s_waitcnt lgkmcnt(0)
v_mfma_f32_16x16x32_bf16 v[32:35],v[144:147],v[128:131],v[32:35]
v_add_u32 v13,s42,v13
ds_read_b128 v[160:163],v13 offset:0
v_mfma_f32_16x16x32_bf16 v[36:39],v[144:147],v[132:135],v[36:39]
ds_read_b64_tr_b16 v[176:177],v14 offset:4096
ds_read_b64_tr_b16 v[178:179],v14 offset:4608
v_mfma_f32_16x16x32_bf16 v[40:43],v[144:147],v[136:139],v[40:43]
ds_read_b128 v[164:167],v13 offset:2048
s_add_u32 s36,s36,24576
v_mfma_f32_16x16x32_bf16 v[44:47],v[144:147],v[140:143],v[44:47]
ds_read_b128 v[168:171],v13 offset:4096
v_mfma_f32_16x16x32_bf16 v[48:51],v[148:151],v[128:131],v[48:51]
ds_read_b128 v[172:175],v13 offset:6144
v_mfma_f32_16x16x32_bf16 v[52:55],v[148:151],v[132:135],v[52:55]
ds_read_b64_tr_b16 v[180:181],v15 offset:4096
ds_read_b64_tr_b16 v[182:183],v15 offset:4608
v_mfma_f32_16x16x32_bf16 v[56:59],v[148:151],v[136:139],v[56:59]
v_mfma_f32_16x16x32_bf16 v[60:63],v[148:151],v[140:143],v[60:63]
s_cmp_eq_u32 s36,163840
s_cselect_b32 s42,s51,s50
s_cselect_b32 s36,16384,s36
s_waitcnt lgkmcnt(0)
v_mfma_f32_16x16x32_bf16 v[32:35],v[176:179],v[160:163],v[32:35]
v_mfma_f32_16x16x32_bf16 v[36:39],v[176:179],v[164:167],v[36:39]
v_mfma_f32_16x16x32_bf16 v[40:43],v[176:179],v[168:171],v[40:43]
v_mfma_f32_16x16x32_bf16 v[44:47],v[176:179],v[172:175],v[44:47]
v_mfma_f32_16x16x32_bf16 v[48:51],v[180:183],v[160:163],v[48:51]
v_mfma_f32_16x16x32_bf16 v[52:55],v[180:183],v[164:167],v[52:55]
v_mfma_f32_16x16x32_bf16 v[56:59],v[180:183],v[168:171],v[56:59]
v_mfma_f32_16x16x32_bf16 v[60:63],v[180:183],v[172:175],v[60:63]
v_mfma_f32_16x16x32_bf16 v[32:35],a[0:3],a[24:27],v[32:35]
v_mfma_f32_16x16x32_bf16 v[36:39],a[0:3],a[28:31],v[36:39]
v_mfma_f32_16x16x32_bf16 v[40:43],a[0:3],a[32:35],v[40:43]
v_mfma_f32_16x16x32_bf16 v[44:47],a[0:3],a[36:39],v[44:47]
v_mfma_f32_16x16x32_bf16 v[48:51],a[4:7],a[24:27],v[48:51]
v_mfma_f32_16x16x32_bf16 v[52:55],a[4:7],a[28:31],v[52:55]
v_mfma_f32_16x16x32_bf16 v[56:59],a[4:7],a[32:35],v[56:59]
v_mfma_f32_16x16x32_bf16 v[60:63],a[4:7],a[36:39],v[60:63]
s_barrier
s_mov_b32 s12,s70
s_mov_b32 s13,s71
s_mov_b32 s14,2097152
s_lshl_b32 s18,s20,5
s_lshl_b32 s19,s85,7
v_lshrrev_b32 v3,3,v2
v_add_u32 v3,s18,v3
v_mul_u32_u24 v3,2048,v3
v_add_u32 v3,s19,v3
v_and_b32 v1,1,v31
v_lshlrev_b32 v1,1,v1
v_and_b32 v0,7,v2
v_xor_b32 v1,v1,v0
v_lshl_add_u32 v8,v1,4,v3
v_xor_b32 v1,4,v1
v_lshl_add_u32 v9,v1,4,v3
v_add_u32 v9,15360,v9
v_add_u32 v10,30720,v8
v_add_u32 v11,30720,v9
s_mov_b32 s32,0
s_mov_b32 s35,0
s_lshl_b32 s41,s20,12
s_add_u32 s41,s41,32768
s_lshl_b32 s18,s2,2
s_add_u32 s18,s18,s20
s_lshl_b32 s18,s18,12
s_add_u32 s18,s18,81854464
v_lshlrev_b32 v29,4,v2
buffer_store_dwordx4 v[252:255],v29,s[24:27],s18 offen sc1
buffer_store_dwordx4 v[252:255],v29,s[24:27],s18 offen offset:1024 sc1
buffer_store_dwordx4 v[252:255],v29,s[24:27],s18 offen offset:2048 sc1
buffer_store_dwordx4 v[252:255],v29,s[24:27],s18 offen offset:3072 sc1
s_mul_i32 s48,s54,6144
s_add_u32 s48,s48,79757312
s_add_u32 s49,s48,4096
v_pk_mul_f32 v[32:33],v[32:33],v[248:249] op_sel:[0,0] op_sel_hi:[1,0]
v_pk_mul_f32 v[34:35],v[34:35],v[248:249] op_sel:[0,0] op_sel_hi:[1,0]
v_pk_mul_f32 v[48:49],v[48:49],v[248:249] op_sel:[0,0] op_sel_hi:[1,0]
v_pk_mul_f32 v[50:51],v[50:51],v[248:249] op_sel:[0,0] op_sel_hi:[1,0]
v_pk_mul_f32 v[36:37],v[36:37],v[248:249] op_sel:[0,1] op_sel_hi:[1,1]
v_pk_mul_f32 v[38:39],v[38:39],v[248:249] op_sel:[0,1] op_sel_hi:[1,1]
v_pk_mul_f32 v[52:53],v[52:53],v[248:249] op_sel:[0,1] op_sel_hi:[1,1]
v_pk_mul_f32 v[54:55],v[54:55],v[248:249] op_sel:[0,1] op_sel_hi:[1,1]
v_pk_mul_f32 v[40:41],v[40:41],v[250:251] op_sel:[0,0] op_sel_hi:[1,0]
v_pk_mul_f32 v[42:43],v[42:43],v[250:251] op_sel:[0,0] op_sel_hi:[1,0]
s_add_u32 m0,s35,s41
s_nop 0
buffer_load_dwordx4 v8,s[12:15],s32 offen lds
v_pk_mul_f32 v[56:57],v[56:57],v[250:251] op_sel:[0,0] op_sel_hi:[1,0]
v_pk_mul_f32 v[58:59],v[58:59],v[250:251] op_sel:[0,0] op_sel_hi:[1,0]
v_pk_mul_f32 v[44:45],v[44:45],v[250:251] op_sel:[0,1] op_sel_hi:[1,1]
v_pk_mul_f32 v[46:47],v[46:47],v[250:251] op_sel:[0,1] op_sel_hi:[1,1]
v_pk_mul_f32 v[60:61],v[60:61],v[250:251] op_sel:[0,1] op_sel_hi:[1,1]
v_pk_mul_f32 v[62:63],v[62:63],v[250:251] op_sel:[0,1] op_sel_hi:[1,1]
v_cvt_pk_bf16_f32 v128,v32,v33
v_cvt_pk_bf16_f32 v129,v34,v35
v_cvt_pk_bf16_f32 v130,v48,v49
v_cvt_pk_bf16_f32 v131,v50,v51
buffer_load_dwordx4 v9,s[12:15],s32 offen offset:1024 lds
v_cvt_pk_bf16_f32 v132,v36,v37
v_cvt_pk_bf16_f32 v133,v38,v39
v_cvt_pk_bf16_f32 v134,v52,v53
v_cvt_pk_bf16_f32 v135,v54,v55
v_cvt_pk_bf16_f32 v136,v40,v41
v_cvt_pk_bf16_f32 v137,v42,v43
v_cvt_pk_bf16_f32 v138,v56,v57
v_cvt_pk_bf16_f32 v139,v58,v59
v_cvt_pk_bf16_f32 v140,v44,v45
v_cvt_pk_bf16_f32 v141,v46,v47
buffer_load_dwordx4 v10,s[12:15],s32 offen offset:2048 lds
v_cvt_pk_bf16_f32 v142,v60,v61
v_cvt_pk_bf16_f32 v143,v62,v63
v_mfma_f32_16x16x32_bf16 v[144:147],v[240:243],v[128:131],0
v_mfma_f32_16x16x32_bf16 v[148:151],v[244:247],v[128:131],0
v_mfma_f32_16x16x32_bf16 v[152:155],v[240:243],v[132:135],0
v_mfma_f32_16x16x32_bf16 v[156:159],v[244:247],v[132:135],0
v_mfma_f32_16x16x32_bf16 v[160:163],v[240:243],v[136:139],0
v_mfma_f32_16x16x32_bf16 v[164:167],v[244:247],v[136:139],0
v_mfma_f32_16x16x32_bf16 v[168:171],v[240:243],v[140:143],0
v_mfma_f32_16x16x32_bf16 v[172:175],v[244:247],v[140:143],0
buffer_load_dwordx4 v11,s[12:15],s32 offen offset:3072 lds
s_add_u32 s35,s35,49152
s_cmp_eq_u32 s35,147456
s_cselect_b32 s35,0,s35
s_add_u32 s32,s32,262144
v_max3_f32 v176,v144,v145,v146
v_max3_f32 v177,-v144,-v145,-v146
v_max3_f32 v178,v152,v153,v154
v_max3_f32 v179,-v152,-v153,-v154
v_max3_f32 v180,v160,v161,v162
v_max3_f32 v181,-v160,-v161,-v162
v_max3_f32 v182,v168,v169,v170
v_max3_f32 v183,-v168,-v169,-v170
v_max3_f32 v176,v176,v147,v148
v_max3_f32 v177,v177,-v147,-v148
s_add_u32 m0,s35,s41
s_nop 0
buffer_load_dwordx4 v8,s[12:15],s32 offen lds
v_max3_f32 v178,v178,v155,v156
v_max3_f32 v179,v179,-v155,-v156
v_max3_f32 v180,v180,v163,v164
v_max3_f32 v181,v181,-v163,-v164
v_max3_f32 v182,v182,v171,v172
v_max3_f32 v183,v183,-v171,-v172
v_max3_f32 v176,v176,v149,v150
v_max3_f32 v177,v177,-v149,-v150
v_max3_f32 v178,v178,v157,v158
v_max3_f32 v179,v179,-v157,-v158
buffer_load_dwordx4 v9,s[12:15],s32 offen offset:1024 lds
v_max3_f32 v180,v180,v165,v166
v_max3_f32 v181,v181,-v165,-v166
v_max3_f32 v182,v182,v173,v174
v_max3_f32 v183,v183,-v173,-v174
v_max_f32 v176,v176,v151
v_max_f32_e64 v177,v177,-v151
v_max_f32 v178,v178,v159
v_max_f32_e64 v179,v179,-v159
v_max_f32 v180,v180,v167
v_max_f32_e64 v181,v181,-v167
buffer_load_dwordx4 v10,s[12:15],s32 offen offset:2048 lds
v_max_f32 v182,v182,v175
v_max_f32_e64 v183,v183,-v175
v_permlane32_swap_b32 v176,v177
v_permlane32_swap_b32 v178,v179
v_permlane32_swap_b32 v180,v181
v_permlane32_swap_b32 v182,v183
v_max_f32 v176,v176,v177
v_max_f32 v178,v178,v179
v_max_f32 v180,v180,v181
v_max_f32 v182,v182,v183
buffer_load_dwordx4 v11,s[12:15],s32 offen offset:3072 lds
s_add_u32 s35,s35,49152
s_cmp_eq_u32 s35,147456
s_cselect_b32 s35,0,s35
s_add_u32 s32,s32,262144
v_permlane16_swap_b32 v176,v178
v_permlane16_swap_b32 v180,v182
v_max_f32 v176,v176,v178
v_max_f32 v180,v180,v182
v_mul_f32 v176,s44,v176
v_mul_f32 v180,s44,v180
v_mov_b32 v178,v176
v_mov_b32 v182,v180
s_nop 0
v_permlane16_swap_b32 v176,v178
v_permlane16_swap_b32 v180,v182
s_add_u32 m0,s35,s41
s_nop 0
buffer_load_dwordx4 v8,s[12:15],s32 offen lds
v_mov_b32 v177,v176
v_mov_b32 v179,v178
v_mov_b32 v181,v180
v_mov_b32 v183,v182
v_permlane32_swap_b32 v176,v177
v_permlane32_swap_b32 v178,v179
v_permlane32_swap_b32 v180,v181
v_permlane32_swap_b32 v182,v183
v_pk_fma_f32 v[192:193],v[144:145],s[44:45],v[176:177] op_sel:[0,0,0] op_sel_hi:[1,1,0] neg_lo:[0,0,1] neg_hi:[0,0,1]
v_pk_fma_f32 v[194:195],v[146:147],s[44:45],v[176:177] op_sel:[0,0,0] op_sel_hi:[1,1,0] neg_lo:[0,0,1] neg_hi:[0,0,1]
buffer_load_dwordx4 v9,s[12:15],s32 offen offset:1024 lds
v_pk_fma_f32 v[196:197],v[148:149],s[44:45],v[176:177] op_sel:[0,0,0] op_sel_hi:[1,1,0] neg_lo:[0,0,1] neg_hi:[0,0,1]
v_pk_fma_f32 v[198:199],v[150:151],s[44:45],v[176:177] op_sel:[0,0,0] op_sel_hi:[1,1,0] neg_lo:[0,0,1] neg_hi:[0,0,1]
v_pk_fma_f32 v[200:201],v[144:145],s[44:45],v[176:177] op_sel:[0,0,1] op_sel_hi:[1,1,1] neg_lo:[1,0,1] neg_hi:[1,0,1]
v_pk_fma_f32 v[202:203],v[146:147],s[44:45],v[176:177] op_sel:[0,0,1] op_sel_hi:[1,1,1] neg_lo:[1,0,1] neg_hi:[1,0,1]
v_pk_fma_f32 v[204:205],v[148:149],s[44:45],v[176:177] op_sel:[0,0,1] op_sel_hi:[1,1,1] neg_lo:[1,0,1] neg_hi:[1,0,1]
v_pk_fma_f32 v[206:207],v[150:151],s[44:45],v[176:177] op_sel:[0,0,1] op_sel_hi:[1,1,1] neg_lo:[1,0,1] neg_hi:[1,0,1]
v_exp_f32 v192,v192
v_exp_f32 v193,v193
v_exp_f32 v194,v194
v_exp_f32 v195,v195
buffer_load_dwordx4 v10,s[12:15],s32 offen offset:2048 lds
v_exp_f32 v196,v196
v_exp_f32 v197,v197
v_exp_f32 v198,v198
v_exp_f32 v199,v199
v_exp_f32 v200,v200
v_exp_f32 v201,v201
v_exp_f32 v202,v202
v_exp_f32 v203,v203
v_exp_f32 v204,v204
v_exp_f32 v205,v205
buffer_load_dwordx4 v11,s[12:15],s32 offen offset:3072 lds
s_add_u32 s35,s35,49152
s_cmp_eq_u32 s35,147456
s_cselect_b32 s35,0,s35
s_add_u32 s32,s32,262144
v_exp_f32 v206,v206
v_exp_f32 v207,v207
v_cvt_pk_bf16_f32 v208,v192,v193
v_cvt_pk_bf16_f32 v209,v194,v195
v_cvt_pk_bf16_f32 v210,v196,v197
v_cvt_pk_bf16_f32 v211,v198,v199
v_cvt_pk_bf16_f32 v212,v200,v201
v_cvt_pk_bf16_f32 v213,v202,v203
v_cvt_pk_bf16_f32 v214,v204,v205
v_cvt_pk_bf16_f32 v215,v206,v207
v_pk_fma_f32 v[192:193],v[152:153],s[44:45],v[178:179] op_sel:[0,0,0] op_sel_hi:[1,1,0] neg_lo:[0,0,1] neg_hi:[0,0,1]
v_pk_fma_f32 v[194:195],v[154:155],s[44:45],v[178:179] op_sel:[0,0,0] op_sel_hi:[1,1,0] neg_lo:[0,0,1] neg_hi:[0,0,1]
v_pk_fma_f32 v[196:197],v[156:157],s[44:45],v[178:179] op_sel:[0,0,0] op_sel_hi:[1,1,0] neg_lo:[0,0,1] neg_hi:[0,0,1]
v_pk_fma_f32 v[198:199],v[158:159],s[44:45],v[178:179] op_sel:[0,0,0] op_sel_hi:[1,1,0] neg_lo:[0,0,1] neg_hi:[0,0,1]
v_pk_fma_f32 v[200:201],v[152:153],s[44:45],v[178:179] op_sel:[0,0,1] op_sel_hi:[1,1,1] neg_lo:[1,0,1] neg_hi:[1,0,1]
v_pk_fma_f32 v[202:203],v[154:155],s[44:45],v[178:179] op_sel:[0,0,1] op_sel_hi:[1,1,1] neg_lo:[1,0,1] neg_hi:[1,0,1]
v_pk_fma_f32 v[204:205],v[156:157],s[44:45],v[178:179] op_sel:[0,0,1] op_sel_hi:[1,1,1] neg_lo:[1,0,1] neg_hi:[1,0,1]
v_pk_fma_f32 v[206:207],v[158:159],s[44:45],v[178:179] op_sel:[0,0,1] op_sel_hi:[1,1,1] neg_lo:[1,0,1] neg_hi:[1,0,1]
v_exp_f32 v192,v192
v_exp_f32 v193,v193
v_exp_f32 v194,v194
v_exp_f32 v195,v195
v_exp_f32 v196,v196
v_exp_f32 v197,v197
v_exp_f32 v198,v198
v_exp_f32 v199,v199
v_exp_f32 v200,v200
v_exp_f32 v201,v201
v_exp_f32 v202,v202
v_exp_f32 v203,v203
v_exp_f32 v204,v204
v_exp_f32 v205,v205
v_exp_f32 v206,v206
v_exp_f32 v207,v207
v_cvt_pk_bf16_f32 v216,v192,v193
v_cvt_pk_bf16_f32 v217,v194,v195
buffer_load_dwordx4 v[100:103],v29,s[24:27],s48 offen sc1
buffer_load_dwordx4 v[104:107],v29,s[24:27],s48 offen offset:1024 sc1
buffer_load_dwordx4 v[108:111],v29,s[24:27],s48 offen offset:2048 sc1
buffer_load_dwordx4 v[112:115],v29,s[24:27],s48 offen offset:3072 sc1
buffer_load_dwordx4 v[116:119],v29,s[24:27],s49 offen sc1
buffer_load_dwordx4 v[120:123],v29,s[24:27],s49 offen offset:1024 sc1
v_cvt_pk_bf16_f32 v218,v196,v197
v_cvt_pk_bf16_f32 v219,v198,v199
v_cvt_pk_bf16_f32 v220,v200,v201
v_cvt_pk_bf16_f32 v221,v202,v203
v_cvt_pk_bf16_f32 v222,v204,v205
v_cvt_pk_bf16_f32 v223,v206,v207
v_pk_fma_f32 v[192:193],v[160:161],s[44:45],v[180:181] op_sel:[0,0,0] op_sel_hi:[1,1,0] neg_lo:[0,0,1] neg_hi:[0,0,1]
v_pk_fma_f32 v[194:195],v[162:163],s[44:45],v[180:181] op_sel:[0,0,0] op_sel_hi:[1,1,0] neg_lo:[0,0,1] neg_hi:[0,0,1]
v_pk_fma_f32 v[196:197],v[164:165],s[44:45],v[180:181] op_sel:[0,0,0] op_sel_hi:[1,1,0] neg_lo:[0,0,1] neg_hi:[0,0,1]
v_pk_fma_f32 v[198:199],v[166:167],s[44:45],v[180:181] op_sel:[0,0,0] op_sel_hi:[1,1,0] neg_lo:[0,0,1] neg_hi:[0,0,1]
v_pk_fma_f32 v[200:201],v[160:161],s[44:45],v[180:181] op_sel:[0,0,1] op_sel_hi:[1,1,1] neg_lo:[1,0,1] neg_hi:[1,0,1]
v_pk_fma_f32 v[202:203],v[162:163],s[44:45],v[180:181] op_sel:[0,0,1] op_sel_hi:[1,1,1] neg_lo:[1,0,1] neg_hi:[1,0,1]
v_pk_fma_f32 v[204:205],v[164:165],s[44:45],v[180:181] op_sel:[0,0,1] op_sel_hi:[1,1,1] neg_lo:[1,0,1] neg_hi:[1,0,1]
v_pk_fma_f32 v[206:207],v[166:167],s[44:45],v[180:181] op_sel:[0,0,1] op_sel_hi:[1,1,1] neg_lo:[1,0,1] neg_hi:[1,0,1]
v_exp_f32 v192,v192
v_exp_f32 v193,v193
v_exp_f32 v194,v194
v_exp_f32 v195,v195
v_exp_f32 v196,v196
v_exp_f32 v197,v197
v_exp_f32 v198,v198
v_exp_f32 v199,v199
v_exp_f32 v200,v200
v_exp_f32 v201,v201
v_exp_f32 v202,v202
v_exp_f32 v203,v203
v_exp_f32 v204,v204
v_exp_f32 v205,v205
v_exp_f32 v206,v206
v_exp_f32 v207,v207
v_cvt_pk_bf16_f32 v224,v192,v193
v_cvt_pk_bf16_f32 v225,v194,v195
v_cvt_pk_bf16_f32 v226,v196,v197
v_cvt_pk_bf16_f32 v227,v198,v199
v_cvt_pk_bf16_f32 v228,v200,v201
v_cvt_pk_bf16_f32 v229,v202,v203
v_cvt_pk_bf16_f32 v230,v204,v205
v_cvt_pk_bf16_f32 v231,v206,v207
v_pk_fma_f32 v[192:193],v[168:169],s[44:45],v[182:183] op_sel:[0,0,0] op_sel_hi:[1,1,0] neg_lo:[0,0,1] neg_hi:[0,0,1]
v_pk_fma_f32 v[194:195],v[170:171],s[44:45],v[182:183] op_sel:[0,0,0] op_sel_hi:[1,1,0] neg_lo:[0,0,1] neg_hi:[0,0,1]
v_pk_fma_f32 v[196:197],v[172:173],s[44:45],v[182:183] op_sel:[0,0,0] op_sel_hi:[1,1,0] neg_lo:[0,0,1] neg_hi:[0,0,1]
v_pk_fma_f32 v[198:199],v[174:175],s[44:45],v[182:183] op_sel:[0,0,0] op_sel_hi:[1,1,0] neg_lo:[0,0,1] neg_hi:[0,0,1]
v_pk_fma_f32 v[200:201],v[168:169],s[44:45],v[182:183] op_sel:[0,0,1] op_sel_hi:[1,1,1] neg_lo:[1,0,1] neg_hi:[1,0,1]
v_pk_fma_f32 v[202:203],v[170:171],s[44:45],v[182:183] op_sel:[0,0,1] op_sel_hi:[1,1,1] neg_lo:[1,0,1] neg_hi:[1,0,1]
v_pk_fma_f32 v[204:205],v[172:173],s[44:45],v[182:183] op_sel:[0,0,1] op_sel_hi:[1,1,1] neg_lo:[1,0,1] neg_hi:[1,0,1]
v_pk_fma_f32 v[206:207],v[174:175],s[44:45],v[182:183] op_sel:[0,0,1] op_sel_hi:[1,1,1] neg_lo:[1,0,1] neg_hi:[1,0,1]
v_exp_f32 v192,v192
v_exp_f32 v193,v193
v_exp_f32 v194,v194
v_exp_f32 v195,v195
v_exp_f32 v196,v196
v_exp_f32 v197,v197
v_exp_f32 v198,v198
v_exp_f32 v199,v199
v_exp_f32 v200,v200
v_exp_f32 v201,v201
v_exp_f32 v202,v202
v_exp_f32 v203,v203
v_exp_f32 v204,v204
v_exp_f32 v205,v205
v_exp_f32 v206,v206
v_exp_f32 v207,v207
v_cvt_pk_bf16_f32 v232,v192,v193
v_cvt_pk_bf16_f32 v233,v194,v195
v_cvt_pk_bf16_f32 v234,v196,v197
v_cvt_pk_bf16_f32 v235,v198,v199
v_cvt_pk_bf16_f32 v236,v200,v201
v_cvt_pk_bf16_f32 v237,v202,v203
v_cvt_pk_bf16_f32 v238,v204,v205
v_cvt_pk_bf16_f32 v239,v206,v207
s_mov_b32 s44,0x358637bd
s_mov_b32 s39,65536
s_mov_b32 s60,0
s_mov_b32 s61,32768
s_mov_b32 s62,65536
s_mov_b32 s63,98304
Lkpl190:
s_waitcnt vmcnt(0)
v_max3_u32 v3,v100,v101,v102
v_max3_u32 v3,v3,v103,v104
v_max3_u32 v3,v3,v105,v106
v_max3_u32 v3,v3,v107,v108
v_max3_u32 v3,v3,v109,v110
v_max3_u32 v3,v3,v111,v112
v_max3_u32 v3,v3,v113,v114
v_max3_u32 v3,v3,v115,v116
v_max3_u32 v3,v3,v117,v118
v_max3_u32 v3,v3,v119,v120
v_max3_u32 v3,v3,v121,v122
v_max_u32 v3,v3,v123
v_cmp_eq_u32 vcc,-1,v3
s_nop 1
s_cmp_eq_u64 vcc,0
s_cbranch_scc1 Lkok191
buffer_load_dwordx4 v[100:103],v29,s[24:27],s48 offen sc1
buffer_load_dwordx4 v[104:107],v29,s[24:27],s48 offen offset:1024 sc1
buffer_load_dwordx4 v[108:111],v29,s[24:27],s48 offen offset:2048 sc1
buffer_load_dwordx4 v[112:115],v29,s[24:27],s48 offen offset:3072 sc1
buffer_load_dwordx4 v[116:119],v29,s[24:27],s49 offen sc1
buffer_load_dwordx4 v[120:123],v29,s[24:27],s49 offen offset:1024 sc1
s_sub_u32 s39,s39,1
s_cmp_lg_u32 s39,0
s_cbranch_scc1 Lkpl190
s_waitcnt vmcnt(0)
Lkok191:
v_mfma_f32_16x16x32_bf16 v[32:35],v[100:103],v[208:211],0
v_mfma_f32_16x16x32_bf16 v[36:39],v[104:107],v[208:211],0
v_mfma_f32_16x16x32_bf16 v[40:43],v[108:111],v[208:211],0
v_mfma_f32_16x16x32_bf16 v[44:47],v[112:115],v[212:215],0
v_mfma_f32_16x16x32_bf16 v[48:51],v[116:119],v[212:215],0
v_mfma_f32_16x16x32_bf16 v[52:55],v[120:123],v[212:215],0
v_mfma_f32_16x16x32_bf16 v[56:59],v[100:103],v[216:219],0
v_mfma_f32_16x16x32_bf16 v[60:63],v[104:107],v[216:219],0
v_mfma_f32_16x16x32_bf16 v[64:67],v[108:111],v[216:219],0
v_mfma_f32_16x16x32_bf16 v[68:71],v[112:115],v[220:223],0
v_mfma_f32_16x16x32_bf16 v[72:75],v[116:119],v[220:223],0
v_mfma_f32_16x16x32_bf16 v[76:79],v[120:123],v[220:223],0
v_mfma_f32_16x16x32_bf16 v[128:131],v[100:103],v[224:227],0
v_mfma_f32_16x16x32_bf16 v[132:135],v[104:107],v[224:227],0
v_mfma_f32_16x16x32_bf16 v[136:139],v[108:111],v[224:227],0
v_mfma_f32_16x16x32_bf16 v[140:143],v[112:115],v[228:231],0
v_mfma_f32_16x16x32_bf16 v[144:147],v[116:119],v[228:231],0
v_mfma_f32_16x16x32_bf16 v[148:151],v[120:123],v[228:231],0
v_mfma_f32_16x16x32_bf16 v[176:179],v[100:103],v[232:235],0
v_mfma_f32_16x16x32_bf16 v[180:183],v[104:107],v[232:235],0
v_mfma_f32_16x16x32_bf16 v[184:187],v[108:111],v[232:235],0
v_mfma_f32_16x16x32_bf16 v[188:191],v[112:115],v[236:239],0
v_mfma_f32_16x16x32_bf16 v[192:195],v[116:119],v[236:239],0
v_mfma_f32_16x16x32_bf16 v[196:199],v[120:123],v[236:239],0
v_rcp_f32 v41,v41
v_rcp_f32 v53,v53
v_rcp_f32 v65,v65
v_rcp_f32 v77,v77
v_rcp_f32 v137,v137
v_rcp_f32 v149,v149
v_rcp_f32 v185,v185
s_nop 0
v_rcp_f32 v197,v197
v_fma_f32 v42,v40,v41,s44
v_fma_f32 v42,v52,v53,v42
v_fma_f32 v66,v64,v65,s44
v_fma_f32 v66,v76,v77,v66
v_fma_f32 v138,v136,v137,s44
v_fma_f32 v138,v148,v149,v138
v_fma_f32 v186,v184,v185,s44
v_fma_f32 v186,v196,v197,v186
v_rcp_f32 v42,v42
v_rcp_f32 v66,v66
v_rcp_f32 v138,v138
v_rcp_f32 v186,v186
v_mul_f32 v40,v41,v42
v_mul_f32 v52,v53,v42
v_mul_f32 v64,v65,v66
v_mul_f32 v76,v77,v66
v_mul_f32 v136,v137,v138
v_mul_f32 v148,v149,v138
v_mul_f32 v184,v185,v186
v_mul_f32 v196,v197,v186
v_pk_mul_f32 v[32:33],v[32:33],v[40:41] op_sel:[0,0] op_sel_hi:[1,0]
v_pk_mul_f32 v[34:35],v[34:35],v[40:41] op_sel:[0,0] op_sel_hi:[1,0]
v_pk_mul_f32 v[36:37],v[36:37],v[40:41] op_sel:[0,0] op_sel_hi:[1,0]
v_pk_mul_f32 v[38:39],v[38:39],v[40:41] op_sel:[0,0] op_sel_hi:[1,0]
v_pk_fma_f32 v[32:33],v[44:45],v[52:53],v[32:33] op_sel:[0,0,0] op_sel_hi:[1,0,1]
v_pk_fma_f32 v[34:35],v[46:47],v[52:53],v[34:35] op_sel:[0,0,0] op_sel_hi:[1,0,1]
v_pk_fma_f32 v[36:37],v[48:49],v[52:53],v[36:37] op_sel:[0,0,0] op_sel_hi:[1,0,1]
v_pk_fma_f32 v[38:39],v[50:51],v[52:53],v[38:39] op_sel:[0,0,0] op_sel_hi:[1,0,1]
v_pk_mul_f32 v[56:57],v[56:57],v[64:65] op_sel:[0,0] op_sel_hi:[1,0]
v_pk_mul_f32 v[58:59],v[58:59],v[64:65] op_sel:[0,0] op_sel_hi:[1,0]
v_pk_mul_f32 v[60:61],v[60:61],v[64:65] op_sel:[0,0] op_sel_hi:[1,0]
v_pk_mul_f32 v[62:63],v[62:63],v[64:65] op_sel:[0,0] op_sel_hi:[1,0]
v_pk_fma_f32 v[56:57],v[68:69],v[76:77],v[56:57] op_sel:[0,0,0] op_sel_hi:[1,0,1]
v_pk_fma_f32 v[58:59],v[70:71],v[76:77],v[58:59] op_sel:[0,0,0] op_sel_hi:[1,0,1]
v_pk_fma_f32 v[60:61],v[72:73],v[76:77],v[60:61] op_sel:[0,0,0] op_sel_hi:[1,0,1]
v_pk_fma_f32 v[62:63],v[74:75],v[76:77],v[62:63] op_sel:[0,0,0] op_sel_hi:[1,0,1]
v_pk_mul_f32 v[128:129],v[128:129],v[136:137] op_sel:[0,0] op_sel_hi:[1,0]
v_pk_mul_f32 v[130:131],v[130:131],v[136:137] op_sel:[0,0] op_sel_hi:[1,0]
v_pk_mul_f32 v[132:133],v[132:133],v[136:137] op_sel:[0,0] op_sel_hi:[1,0]
v_pk_mul_f32 v[134:135],v[134:135],v[136:137] op_sel:[0,0] op_sel_hi:[1,0]
v_pk_fma_f32 v[128:129],v[140:141],v[148:149],v[128:129] op_sel:[0,0,0] op_sel_hi:[1,0,1]
v_pk_fma_f32 v[130:131],v[142:143],v[148:149],v[130:131] op_sel:[0,0,0] op_sel_hi:[1,0,1]
v_pk_fma_f32 v[132:133],v[144:145],v[148:149],v[132:133] op_sel:[0,0,0] op_sel_hi:[1,0,1]
v_pk_fma_f32 v[134:135],v[146:147],v[148:149],v[134:135] op_sel:[0,0,0] op_sel_hi:[1,0,1]
v_pk_mul_f32 v[176:177],v[176:177],v[184:185] op_sel:[0,0] op_sel_hi:[1,0]
v_pk_mul_f32 v[178:179],v[178:179],v[184:185] op_sel:[0,0] op_sel_hi:[1,0]
v_pk_mul_f32 v[180:181],v[180:181],v[184:185] op_sel:[0,0] op_sel_hi:[1,0]
v_pk_mul_f32 v[182:183],v[182:183],v[184:185] op_sel:[0,0] op_sel_hi:[1,0]
v_pk_fma_f32 v[176:177],v[188:189],v[196:197],v[176:177] op_sel:[0,0,0] op_sel_hi:[1,0,1]
v_pk_fma_f32 v[178:179],v[190:191],v[196:197],v[178:179] op_sel:[0,0,0] op_sel_hi:[1,0,1]
v_pk_fma_f32 v[180:181],v[192:193],v[196:197],v[180:181] op_sel:[0,0,0] op_sel_hi:[1,0,1]
v_pk_fma_f32 v[182:183],v[194:195],v[196:197],v[182:183] op_sel:[0,0,0] op_sel_hi:[1,0,1]
v_cvt_pk_bf16_f32 v160,v32,v33
v_cvt_pk_bf16_f32 v161,v34,v35
v_cvt_pk_bf16_f32 v162,v36,v37
v_cvt_pk_bf16_f32 v163,v38,v39
v_cvt_pk_bf16_f32 v164,v56,v57
v_cvt_pk_bf16_f32 v165,v58,v59
v_cvt_pk_bf16_f32 v166,v60,v61
v_cvt_pk_bf16_f32 v167,v62,v63
v_cvt_pk_bf16_f32 v168,v128,v129
v_cvt_pk_bf16_f32 v169,v130,v131
v_cvt_pk_bf16_f32 v170,v132,v133
v_cvt_pk_bf16_f32 v171,v134,v135
v_cvt_pk_bf16_f32 v172,v176,v177
v_cvt_pk_bf16_f32 v173,v178,v179
v_cvt_pk_bf16_f32 v174,v180,v181
v_cvt_pk_bf16_f32 v175,v182,v183
v_permlane16_swap_b32 v160,v162
v_permlane16_swap_b32 v161,v163
v_permlane16_swap_b32 v164,v166
v_permlane16_swap_b32 v165,v167
v_permlane16_swap_b32 v168,v170
v_permlane16_swap_b32 v169,v171
v_permlane16_swap_b32 v172,v174
v_permlane16_swap_b32 v173,v175
buffer_store_dwordx4 v[160:163],v21,s[24:27],s60 offen sc1
buffer_store_dwordx4 v[164:167],v21,s[24:27],s61 offen sc1
buffer_store_dwordx4 v[168:171],v21,s[24:27],s62 offen sc1
buffer_store_dwordx4 v[172:175],v21,s[24:27],s63 offen sc1
s_waitcnt vmcnt(0)
s_barrier
s_cmp_lg_u32 s20,0
s_cbranch_scc1 Lpub192
s_mov_b32 s18,s84
s_mov_b32 s19,s85
s_lshl_b32 s18,s18,8
s_lshl_b32 s19,s19,2
s_add_u32 s18,s18,s19
s_add_u32 s18,s18,95715328
v_mov_b32 v1,0
v_mov_b32 v3,s94
s_mov_b64 exec,1
buffer_store_dword v3,v1,s[24:27],s18 offen sc1
s_mov_b64 exec,-1
Lpub192:
s_add_u32 s8,s16,65536
s_addc_u32 s9,s17,0
s_mov_b32 s10,4194304
s_add_u32 s56,s16,8454144
s_addc_u32 s57,s17,0
s_mov_b32 s58,4194304
s_lshl_b32 s23,s84,7
s_and_b32 s28,s20,1
s_lshr_b32 s29,s20,1
s_lshl_b32 s18,s28,6
s_add_u32 s33,s23,s18
s_lshl_b32 s18,s29,11
s_mul_i32 s19,s33,2048
v_lshlrev_b32 v4,4,v2
v_add_u32 v4,s19,v4
v_add_u32 v4,s18,v4
v_add_u32 v5,30720,v4
s_mov_b32 s30,0
s_mov_b32 s31,65536
s_mov_b32 s34,0
s_lshl_b32 s40,s20,13
s_add_u32 s52,s40,4096
s_lshl_b32 s18,s29,5
s_add_u32 s18,s18,s33
s_mov_b32 s60,32768
s_lshl_b32 s61,s18,11
s_lshl_b32 s19,s85,11
s_add_u32 s19,s19,s61
v_lshlrev_b32 v22,4,v30
v_and_b32 v1,1,v31
v_lshl_add_u32 v22,v1,3,v22
v_lshrrev_b32 v1,1,v31
v_lshl_add_u32 v22,v1,8,v22
v_add_u32 v22,s19,v22
s_lshl_b32 s19,s85,11
s_add_u32 s19,s19,s61
v_lshlrev_b32 v18,4,v30
v_and_b32 v1,1,v31
v_lshl_add_u32 v18,v1,9,v18
v_lshrrev_b32 v1,1,v31
v_lshl_add_u32 v18,v1,8,v18
v_add_u32 v18,s19,v18
s_lshl_b32 s18,s18,7
s_lshr_b32 s19,s85,1
s_lshl_b32 s19,s19,8
s_add_u32 s18,s18,s19
s_and_b32 s19,s85,1
s_lshl_b32 s19,s19,3
s_add_u32 s18,s18,s19
v_lshlrev_b32 v19,4,v30
v_add_u32 v19,s18,v19
v_lshlrev_b32 v12,4,v2
v_add_u32 v12,s40,v12
v_add_u32 v13,1024,v12
s_lshl_b32 s18,s29,13
s_add_u32 s18,s18,32768
v_bfe_u32 v1,v2,2,2
v_lshl_add_u32 v3,v31,3,v1
v_lshlrev_b32 v3,7,v3
v_add_u32 v3,s18,v3
v_and_b32 v0,1,v2
v_lshl_add_u32 v3,v0,3,v3
v_and_b32 v1,2,v1
v_and_b32 v0,1,v31
v_lshl_add_u32 v1,v0,2,v1
v_bfe_u32 v0,v2,1,1
v_or_b32 v1,v1,v0
v_xor_b32 v0,0,v1
v_lshl_add_u32 v14,v0,4,v3
v_xor_b32 v0,2,v1
v_lshl_add_u32 v15,v0,4,v3
v_xor_b32 v0,4,v1
v_lshl_add_u32 v16,v0,4,v3
v_xor_b32 v0,6,v1
v_lshl_add_u32 v17,v0,4,v3
v_lshlrev_b32 v20,4,v2
v_add_u32 v20,s40,v20
v_xor_b32 v21,16384,v20
s_mov_b32 s36,0
s_mov_b32 s42,0
s_mov_b32 s50,49152
s_mov_b32 s51,0xfffe8000
s_cmp_lg_u32 s20,0
s_cbranch_scc1 Lwbar193
s_mov_b32 s18,s84
s_lshl_b32 s18,s18,8
s_add_u32 s18,s18,95715328
v_lshlrev_b32 v1,2,v30
v_lshl_add_u32 v1,v31,8,v1
s_mov_b32 exec_lo,0xffff
s_mov_b32 exec_hi,0
s_mov_b32 s39,131072
Lpoll194:
buffer_load_dword v3,v1,s[24:27],s18 offen sc1
s_waitcnt vmcnt(0)
v_cmp_ne_u32 vcc,s94,v3
s_nop 1
s_cmp_eq_u64 vcc,0
s_cbranch_scc1 Lgot195
s_sleep 1
s_sub_u32 s39,s39,1
s_cmp_lg_u32 s39,0
s_cbranch_scc1 Lpoll194
Lgot195:
s_mov_b64 exec,-1
Lwbar193:
s_barrier
s_add_u32 m0,s34,s40
s_nop 0
buffer_load_dwordx4 v4,s[8:11],s30 offen sc1 lds
buffer_load_dwordx4 v4,s[8:11],s30 offen offset:1024 sc1 lds
buffer_load_dwordx4 v5,s[8:11],s30 offen offset:2048 sc1 lds
buffer_load_dwordx4 v5,s[8:11],s30 offen offset:3072 sc1 lds
s_add_u32 s30,s30,4096
s_add_u32 m0,s34,s52
s_nop 0
buffer_load_dwordx4 v4,s[8:11],s31 offen sc1 lds
buffer_load_dwordx4 v4,s[8:11],s31 offen offset:1024 sc1 lds
buffer_load_dwordx4 v5,s[8:11],s31 offen offset:2048 sc1 lds
buffer_load_dwordx4 v5,s[8:11],s31 offen offset:3072 sc1 lds
s_add_u32 s34,s34,49152
s_cmp_eq_u32 s34,147456
s_cselect_b32 s34,0,s34
s_add_u32 s31,s31,4096
s_add_u32 m0,s34,s40
s_nop 0
buffer_load_dwordx4 v4,s[8:11],s30 offen sc1 lds
buffer_load_dwordx4 v4,s[8:11],s30 offen offset:1024 sc1 lds
buffer_load_dwordx4 v5,s[8:11],s30 offen offset:2048 sc1 lds
buffer_load_dwordx4 v5,s[8:11],s30 offen offset:3072 sc1 lds
s_add_u32 s30,s30,4096
s_add_u32 m0,s34,s52
s_nop 0
buffer_load_dwordx4 v4,s[8:11],s31 offen sc1 lds
buffer_load_dwordx4 v4,s[8:11],s31 offen offset:1024 sc1 lds
buffer_load_dwordx4 v5,s[8:11],s31 offen offset:2048 sc1 lds
buffer_load_dwordx4 v5,s[8:11],s31 offen offset:3072 sc1 lds
s_add_u32 s34,s34,49152
s_cmp_eq_u32 s34,147456
s_cselect_b32 s34,0,s34
s_add_u32 s31,s31,4096
s_waitcnt vmcnt(8)
s_barrier
ds_read_b128 v[96:99],v12 offset:0
ds_read_b64_tr_b16 v[112:113],v14 offset:0
ds_read_b64_tr_b16 v[114:115],v14 offset:512
ds_read_b128 v[100:103],v12 offset:2048
ds_read_b128 v[104:107],v12 offset:4096
ds_read_b128 v[108:111],v12 offset:6144
ds_read_b64_tr_b16 v[116:117],v15 offset:0
ds_read_b64_tr_b16 v[118:119],v15 offset:512
ds_read_b64_tr_b16 v[120:121],v16 offset:0
ds_read_b64_tr_b16 v[122:123],v16 offset:512
ds_read_b64_tr_b16 v[124:125],v17 offset:0
ds_read_b64_tr_b16 v[126:127],v17 offset:512
s_waitcnt lgkmcnt(4)
v_mfma_f32_16x16x32_bf16 v[32:35],v[112:115],v[96:99],0
v_add_u32 v13,s42,v13
ds_read_b128 v[128:131],v13 offset:0
v_mfma_f32_16x16x32_bf16 v[36:39],v[112:115],v[100:103],0
ds_read_b64_tr_b16 v[144:145],v14 offset:4096
s_add_u32 m0,s34,s40
v_mfma_f32_16x16x32_bf16 v[40:43],v[112:115],v[104:107],0
ds_read_b64_tr_b16 v[146:147],v14 offset:4608
buffer_load_dwordx4 v4,s[8:11],s30 offen sc1 lds
v_mfma_f32_16x16x32_bf16 v[44:47],v[112:115],v[108:111],0
ds_read_b128 v[132:135],v13 offset:2048
buffer_load_dwordx4 v4,s[8:11],s30 offen offset:1024 sc1 lds
v_mfma_f32_16x16x32_bf16 v[48:51],v[116:119],v[96:99],0
ds_read_b128 v[136:139],v13 offset:4096
v_mfma_f32_16x16x32_bf16 v[52:55],v[116:119],v[100:103],0
buffer_load_dwordx4 v5,s[8:11],s30 offen offset:2048 sc1 lds
v_mfma_f32_16x16x32_bf16 v[56:59],v[116:119],v[104:107],0
ds_read_b128 v[140:143],v13 offset:6144
buffer_load_dwordx4 v5,s[8:11],s30 offen offset:3072 sc1 lds
v_mfma_f32_16x16x32_bf16 v[60:63],v[116:119],v[108:111],0
ds_read_b64_tr_b16 v[148:149],v15 offset:4096
s_add_u32 s30,s30,4096
s_waitcnt lgkmcnt(7)
v_mfma_f32_16x16x32_bf16 v[64:67],v[120:123],v[96:99],0
ds_read_b64_tr_b16 v[150:151],v15 offset:4608
s_add_u32 m0,s34,s52
v_mfma_f32_16x16x32_bf16 v[68:71],v[120:123],v[100:103],0
ds_read_b64_tr_b16 v[152:153],v16 offset:4096
ds_read_b64_tr_b16 v[154:155],v16 offset:4608
v_mfma_f32_16x16x32_bf16 v[72:75],v[120:123],v[104:107],0
ds_read_b64_tr_b16 v[156:157],v17 offset:4096
buffer_load_dwordx4 v4,s[8:11],s31 offen sc1 lds
v_mfma_f32_16x16x32_bf16 v[76:79],v[120:123],v[108:111],0
ds_read_b64_tr_b16 v[158:159],v17 offset:4608
buffer_load_dwordx4 v4,s[8:11],s31 offen offset:1024 sc1 lds
v_mfma_f32_16x16x32_bf16 v[80:83],v[124:127],v[96:99],0
buffer_load_dwordx4 v5,s[8:11],s31 offen offset:2048 sc1 lds
v_mfma_f32_16x16x32_bf16 v[84:87],v[124:127],v[100:103],0
buffer_load_dwordx4 v5,s[8:11],s31 offen offset:3072 sc1 lds
s_add_u32 s34,s34,49152
v_mfma_f32_16x16x32_bf16 v[88:91],v[124:127],v[104:107],0
s_cmp_eq_u32 s34,147456
s_cselect_b32 s34,0,s34
v_mfma_f32_16x16x32_bf16 v[92:95],v[124:127],v[108:111],0
s_add_u32 s31,s31,4096
s_waitcnt lgkmcnt(4)
v_mfma_f32_16x16x32_bf16 v[32:35],v[144:147],v[128:131],v[32:35]
s_add_u32 s36,s36,49152
v_mfma_f32_16x16x32_bf16 v[36:39],v[144:147],v[132:135],v[36:39]
v_mfma_f32_16x16x32_bf16 v[40:43],v[144:147],v[136:139],v[40:43]
s_cmp_eq_u32 s36,147456
s_cselect_b32 s42,s51,s50
s_cselect_b32 s36,0,s36
v_add_u32 v12,s42,v12
v_add_u32 v14,s42,v14
v_add_u32 v15,s42,v15
v_add_u32 v16,s42,v16
v_add_u32 v17,s42,v17
s_waitcnt vmcnt(8)
s_waitcnt lgkmcnt(0)
s_barrier
ds_read_b128 v[96:99],v12 offset:0
v_mfma_f32_16x16x32_bf16 v[44:47],v[144:147],v[140:143],v[44:47]
ds_read_b64_tr_b16 v[112:113],v14 offset:0
ds_read_b64_tr_b16 v[114:115],v14 offset:512
v_mfma_f32_16x16x32_bf16 v[48:51],v[148:151],v[128:131],v[48:51]
ds_read_b128 v[100:103],v12 offset:2048
s_add_u32 m0,s34,s40
v_mfma_f32_16x16x32_bf16 v[52:55],v[148:151],v[132:135],v[52:55]
ds_read_b128 v[104:107],v12 offset:4096
buffer_load_dwordx4 v4,s[8:11],s30 offen sc1 lds
v_mfma_f32_16x16x32_bf16 v[56:59],v[148:151],v[136:139],v[56:59]
buffer_load_dwordx4 v4,s[8:11],s30 offen offset:1024 sc1 lds
buffer_load_dwordx4 v5,s[8:11],s30 offen offset:2048 sc1 lds
v_mfma_f32_16x16x32_bf16 v[60:63],v[148:151],v[140:143],v[60:63]
ds_read_b128 v[108:111],v12 offset:6144
v_mfma_f32_16x16x32_bf16 v[64:67],v[152:155],v[128:131],v[64:67]
ds_read_b64_tr_b16 v[116:117],v15 offset:0
ds_read_b64_tr_b16 v[118:119],v15 offset:512
v_mfma_f32_16x16x32_bf16 v[68:71],v[152:155],v[132:135],v[68:71]
ds_read_b64_tr_b16 v[120:121],v16 offset:0
buffer_load_dwordx4 v5,s[8:11],s30 offen offset:3072 sc1 lds
v_mfma_f32_16x16x32_bf16 v[72:75],v[152:155],v[136:139],v[72:75]
ds_read_b64_tr_b16 v[122:123],v16 offset:512
ds_read_b64_tr_b16 v[124:125],v17 offset:0
v_mfma_f32_16x16x32_bf16 v[76:79],v[152:155],v[140:143],v[76:79]
ds_read_b64_tr_b16 v[126:127],v17 offset:512
s_add_u32 s30,s30,4096
v_mfma_f32_16x16x32_bf16 v[80:83],v[156:159],v[128:131],v[80:83]
s_add_u32 m0,s34,s52
s_nop 0
buffer_load_dwordx4 v4,s[8:11],s31 offen sc1 lds
v_mfma_f32_16x16x32_bf16 v[84:87],v[156:159],v[132:135],v[84:87]
buffer_load_dwordx4 v4,s[8:11],s31 offen offset:1024 sc1 lds
buffer_load_dwordx4 v5,s[8:11],s31 offen offset:2048 sc1 lds
v_mfma_f32_16x16x32_bf16 v[88:91],v[156:159],v[136:139],v[88:91]
buffer_load_dwordx4 v5,s[8:11],s31 offen offset:3072 sc1 lds
s_add_u32 s34,s34,49152
v_mfma_f32_16x16x32_bf16 v[92:95],v[156:159],v[140:143],v[92:95]
s_cmp_eq_u32 s34,147456
s_cselect_b32 s34,0,s34
s_add_u32 s31,s31,4096
s_mov_b32 s38,4
Lp2L196_0:
s_waitcnt lgkmcnt(4)
v_mfma_f32_16x16x32_bf16 v[32:35],v[112:115],v[96:99],v[32:35]
v_add_u32 v13,s42,v13
ds_read_b128 v[128:131],v13 offset:0
v_mfma_f32_16x16x32_bf16 v[36:39],v[112:115],v[100:103],v[36:39]
ds_read_b64_tr_b16 v[144:145],v14 offset:4096
s_add_u32 m0,s35,s41
v_mfma_f32_16x16x32_bf16 v[40:43],v[112:115],v[104:107],v[40:43]
ds_read_b64_tr_b16 v[146:147],v14 offset:4608
buffer_load_dwordx4 v8,s[12:15],s32 offen lds
v_mfma_f32_16x16x32_bf16 v[44:47],v[112:115],v[108:111],v[44:47]
ds_read_b128 v[132:135],v13 offset:2048
v_mfma_f32_16x16x32_bf16 v[48:51],v[116:119],v[96:99],v[48:51]
ds_read_b128 v[136:139],v13 offset:4096
v_mfma_f32_16x16x32_bf16 v[52:55],v[116:119],v[100:103],v[52:55]
buffer_load_dwordx4 v9,s[12:15],s32 offen offset:1024 lds
v_mfma_f32_16x16x32_bf16 v[56:59],v[116:119],v[104:107],v[56:59]
ds_read_b128 v[140:143],v13 offset:6144
v_mfma_f32_16x16x32_bf16 v[60:63],v[116:119],v[108:111],v[60:63]
ds_read_b64_tr_b16 v[148:149],v15 offset:4096
s_waitcnt lgkmcnt(7)
v_mfma_f32_16x16x32_bf16 v[64:67],v[120:123],v[96:99],v[64:67]
ds_read_b64_tr_b16 v[150:151],v15 offset:4608
buffer_load_dwordx4 v10,s[12:15],s32 offen offset:2048 lds
v_mfma_f32_16x16x32_bf16 v[68:71],v[120:123],v[100:103],v[68:71]
ds_read_b64_tr_b16 v[152:153],v16 offset:4096
ds_read_b64_tr_b16 v[154:155],v16 offset:4608
v_mfma_f32_16x16x32_bf16 v[72:75],v[120:123],v[104:107],v[72:75]
ds_read_b64_tr_b16 v[156:157],v17 offset:4096
v_mfma_f32_16x16x32_bf16 v[76:79],v[120:123],v[108:111],v[76:79]
ds_read_b64_tr_b16 v[158:159],v17 offset:4608
buffer_load_dwordx4 v11,s[12:15],s32 offen offset:3072 lds
v_mfma_f32_16x16x32_bf16 v[80:83],v[124:127],v[96:99],v[80:83]
s_add_u32 s35,s35,49152
v_mfma_f32_16x16x32_bf16 v[84:87],v[124:127],v[100:103],v[84:87]
s_cmp_eq_u32 s35,147456
s_cselect_b32 s35,0,s35
v_mfma_f32_16x16x32_bf16 v[88:91],v[124:127],v[104:107],v[88:91]
s_add_u32 s32,s32,262144
v_mfma_f32_16x16x32_bf16 v[92:95],v[124:127],v[108:111],v[92:95]
s_waitcnt lgkmcnt(4)
v_mfma_f32_16x16x32_bf16 v[32:35],v[144:147],v[128:131],v[32:35]
s_add_u32 s36,s36,49152
v_mfma_f32_16x16x32_bf16 v[36:39],v[144:147],v[132:135],v[36:39]
v_mfma_f32_16x16x32_bf16 v[40:43],v[144:147],v[136:139],v[40:43]
s_cmp_eq_u32 s36,147456
s_cselect_b32 s42,s51,s50
s_cselect_b32 s36,0,s36
v_add_u32 v12,s42,v12
v_add_u32 v14,s42,v14
v_add_u32 v15,s42,v15
v_add_u32 v16,s42,v16
v_add_u32 v17,s42,v17
s_waitcnt vmcnt(12)
s_waitcnt lgkmcnt(0)
s_barrier
ds_read_b128 v[96:99],v12 offset:0
v_mfma_f32_16x16x32_bf16 v[44:47],v[144:147],v[140:143],v[44:47]
ds_read_b64_tr_b16 v[112:113],v14 offset:0
ds_read_b64_tr_b16 v[114:115],v14 offset:512
v_mfma_f32_16x16x32_bf16 v[48:51],v[148:151],v[128:131],v[48:51]
ds_read_b128 v[100:103],v12 offset:2048
s_add_u32 m0,s34,s40
v_mfma_f32_16x16x32_bf16 v[52:55],v[148:151],v[132:135],v[52:55]
ds_read_b128 v[104:107],v12 offset:4096
buffer_load_dwordx4 v4,s[8:11],s30 offen sc1 lds
v_mfma_f32_16x16x32_bf16 v[56:59],v[148:151],v[136:139],v[56:59]
buffer_load_dwordx4 v4,s[8:11],s30 offen offset:1024 sc1 lds
buffer_load_dwordx4 v5,s[8:11],s30 offen offset:2048 sc1 lds
v_mfma_f32_16x16x32_bf16 v[60:63],v[148:151],v[140:143],v[60:63]
ds_read_b128 v[108:111],v12 offset:6144
v_mfma_f32_16x16x32_bf16 v[64:67],v[152:155],v[128:131],v[64:67]
ds_read_b64_tr_b16 v[116:117],v15 offset:0
ds_read_b64_tr_b16 v[118:119],v15 offset:512
v_mfma_f32_16x16x32_bf16 v[68:71],v[152:155],v[132:135],v[68:71]
ds_read_b64_tr_b16 v[120:121],v16 offset:0
buffer_load_dwordx4 v5,s[8:11],s30 offen offset:3072 sc1 lds
v_mfma_f32_16x16x32_bf16 v[72:75],v[152:155],v[136:139],v[72:75]
ds_read_b64_tr_b16 v[122:123],v16 offset:512
ds_read_b64_tr_b16 v[124:125],v17 offset:0
v_mfma_f32_16x16x32_bf16 v[76:79],v[152:155],v[140:143],v[76:79]
ds_read_b64_tr_b16 v[126:127],v17 offset:512
s_add_u32 s30,s30,4096
v_mfma_f32_16x16x32_bf16 v[80:83],v[156:159],v[128:131],v[80:83]
s_add_u32 m0,s34,s52
s_nop 0
buffer_load_dwordx4 v4,s[8:11],s31 offen sc1 lds
v_mfma_f32_16x16x32_bf16 v[84:87],v[156:159],v[132:135],v[84:87]
buffer_load_dwordx4 v4,s[8:11],s31 offen offset:1024 sc1 lds
buffer_load_dwordx4 v5,s[8:11],s31 offen offset:2048 sc1 lds
v_mfma_f32_16x16x32_bf16 v[88:91],v[156:159],v[136:139],v[88:91]
buffer_load_dwordx4 v5,s[8:11],s31 offen offset:3072 sc1 lds
s_add_u32 s34,s34,49152
v_mfma_f32_16x16x32_bf16 v[92:95],v[156:159],v[140:143],v[92:95]
s_cmp_eq_u32 s34,147456
s_cselect_b32 s34,0,s34
s_add_u32 s31,s31,4096
s_sub_u32 s38,s38,1
s_cmp_lg_u32 s38,0
s_cbranch_scc1 Lp2L196_0
s_waitcnt lgkmcnt(4)
v_mfma_f32_16x16x32_bf16 v[32:35],v[112:115],v[96:99],v[32:35]
v_add_u32 v13,s42,v13
ds_read_b128 v[128:131],v13 offset:0
v_mfma_f32_16x16x32_bf16 v[36:39],v[112:115],v[100:103],v[36:39]
ds_read_b64_tr_b16 v[144:145],v14 offset:4096
s_add_u32 m0,s35,s41
v_mfma_f32_16x16x32_bf16 v[40:43],v[112:115],v[104:107],v[40:43]
ds_read_b64_tr_b16 v[146:147],v14 offset:4608
buffer_load_dwordx4 v8,s[12:15],s32 offen lds
v_mfma_f32_16x16x32_bf16 v[44:47],v[112:115],v[108:111],v[44:47]
ds_read_b128 v[132:135],v13 offset:2048
v_mfma_f32_16x16x32_bf16 v[48:51],v[116:119],v[96:99],v[48:51]
ds_read_b128 v[136:139],v13 offset:4096
v_mfma_f32_16x16x32_bf16 v[52:55],v[116:119],v[100:103],v[52:55]
buffer_load_dwordx4 v9,s[12:15],s32 offen offset:1024 lds
v_mfma_f32_16x16x32_bf16 v[56:59],v[116:119],v[104:107],v[56:59]
ds_read_b128 v[140:143],v13 offset:6144
v_mfma_f32_16x16x32_bf16 v[60:63],v[116:119],v[108:111],v[60:63]
ds_read_b64_tr_b16 v[148:149],v15 offset:4096
s_waitcnt lgkmcnt(7)
v_mfma_f32_16x16x32_bf16 v[64:67],v[120:123],v[96:99],v[64:67]
ds_read_b64_tr_b16 v[150:151],v15 offset:4608
buffer_load_dwordx4 v10,s[12:15],s32 offen offset:2048 lds
v_mfma_f32_16x16x32_bf16 v[68:71],v[120:123],v[100:103],v[68:71]
ds_read_b64_tr_b16 v[152:153],v16 offset:4096
ds_read_b64_tr_b16 v[154:155],v16 offset:4608
v_mfma_f32_16x16x32_bf16 v[72:75],v[120:123],v[104:107],v[72:75]
ds_read_b64_tr_b16 v[156:157],v17 offset:4096
v_mfma_f32_16x16x32_bf16 v[76:79],v[120:123],v[108:111],v[76:79]
ds_read_b64_tr_b16 v[158:159],v17 offset:4608
buffer_load_dwordx4 v11,s[12:15],s32 offen offset:3072 lds
v_mfma_f32_16x16x32_bf16 v[80:83],v[124:127],v[96:99],v[80:83]
s_add_u32 s35,s35,49152
v_mfma_f32_16x16x32_bf16 v[84:87],v[124:127],v[100:103],v[84:87]
s_cmp_eq_u32 s35,147456
s_cselect_b32 s35,0,s35
v_mfma_f32_16x16x32_bf16 v[88:91],v[124:127],v[104:107],v[88:91]
s_add_u32 s32,s32,262144
v_mfma_f32_16x16x32_bf16 v[92:95],v[124:127],v[108:111],v[92:95]
s_waitcnt lgkmcnt(4)
v_mfma_f32_16x16x32_bf16 v[32:35],v[144:147],v[128:131],v[32:35]
s_add_u32 s36,s36,49152
v_mfma_f32_16x16x32_bf16 v[36:39],v[144:147],v[132:135],v[36:39]
v_mfma_f32_16x16x32_bf16 v[40:43],v[144:147],v[136:139],v[40:43]
s_cmp_eq_u32 s36,147456
s_cselect_b32 s42,s51,s50
s_cselect_b32 s36,0,s36
v_add_u32 v12,s42,v12
v_add_u32 v14,s42,v14
v_add_u32 v15,s42,v15
v_add_u32 v16,s42,v16
v_add_u32 v17,s42,v17
s_waitcnt vmcnt(12)
s_waitcnt lgkmcnt(0)
s_barrier
ds_read_b128 v[96:99],v12 offset:0
v_mfma_f32_16x16x32_bf16 v[44:47],v[144:147],v[140:143],v[44:47]
ds_read_b64_tr_b16 v[112:113],v14 offset:0
ds_read_b64_tr_b16 v[114:115],v14 offset:512
v_mfma_f32_16x16x32_bf16 v[48:51],v[148:151],v[128:131],v[48:51]
ds_read_b128 v[100:103],v12 offset:2048
buffer_load_dwordx2 v[160:161],v22,s[56:59],0 offen sc1
v_mfma_f32_16x16x32_bf16 v[52:55],v[148:151],v[132:135],v[52:55]
ds_read_b128 v[104:107],v12 offset:4096
v_mfma_f32_16x16x32_bf16 v[56:59],v[148:151],v[136:139],v[56:59]
buffer_load_dwordx2 v[162:163],v22,s[56:59],0 offen offset:512 sc1
v_mfma_f32_16x16x32_bf16 v[60:63],v[148:151],v[140:143],v[60:63]
ds_read_b128 v[108:111],v12 offset:6144
v_mfma_f32_16x16x32_bf16 v[64:67],v[152:155],v[128:131],v[64:67]
ds_read_b64_tr_b16 v[116:117],v15 offset:0
ds_read_b64_tr_b16 v[118:119],v15 offset:512
v_mfma_f32_16x16x32_bf16 v[68:71],v[152:155],v[132:135],v[68:71]
ds_read_b64_tr_b16 v[120:121],v16 offset:0
buffer_load_dwordx2 v[164:165],v22,s[56:59],0 offen offset:1024 sc1
v_mfma_f32_16x16x32_bf16 v[72:75],v[152:155],v[136:139],v[72:75]
ds_read_b64_tr_b16 v[122:123],v16 offset:512
ds_read_b64_tr_b16 v[124:125],v17 offset:0
v_mfma_f32_16x16x32_bf16 v[76:79],v[152:155],v[140:143],v[76:79]
ds_read_b64_tr_b16 v[126:127],v17 offset:512
v_mfma_f32_16x16x32_bf16 v[80:83],v[156:159],v[128:131],v[80:83]
buffer_load_dwordx2 v[166:167],v22,s[56:59],0 offen offset:1536 sc1
v_mfma_f32_16x16x32_bf16 v[84:87],v[156:159],v[132:135],v[84:87]
v_mfma_f32_16x16x32_bf16 v[88:91],v[156:159],v[136:139],v[88:91]
v_mfma_f32_16x16x32_bf16 v[92:95],v[156:159],v[140:143],v[92:95]
s_waitcnt lgkmcnt(4)
v_mfma_f32_16x16x32_bf16 v[32:35],v[112:115],v[96:99],v[32:35]
v_add_u32 v13,s42,v13
ds_read_b128 v[128:131],v13 offset:0
v_mfma_f32_16x16x32_bf16 v[36:39],v[112:115],v[100:103],v[36:39]
ds_read_b64_tr_b16 v[144:145],v14 offset:4096
v_mfma_f32_16x16x32_bf16 v[40:43],v[112:115],v[104:107],v[40:43]
ds_read_b64_tr_b16 v[146:147],v14 offset:4608
buffer_load_dwordx2 v[168:169],v22,s[56:59],s60 offen sc1
v_mfma_f32_16x16x32_bf16 v[44:47],v[112:115],v[108:111],v[44:47]
ds_read_b128 v[132:135],v13 offset:2048
v_mfma_f32_16x16x32_bf16 v[48:51],v[116:119],v[96:99],v[48:51]
ds_read_b128 v[136:139],v13 offset:4096
v_mfma_f32_16x16x32_bf16 v[52:55],v[116:119],v[100:103],v[52:55]
buffer_load_dwordx2 v[170:171],v22,s[56:59],s60 offen offset:512 sc1
v_mfma_f32_16x16x32_bf16 v[56:59],v[116:119],v[104:107],v[56:59]
ds_read_b128 v[140:143],v13 offset:6144
v_mfma_f32_16x16x32_bf16 v[60:63],v[116:119],v[108:111],v[60:63]
ds_read_b64_tr_b16 v[148:149],v15 offset:4096
s_waitcnt lgkmcnt(7)
v_mfma_f32_16x16x32_bf16 v[64:67],v[120:123],v[96:99],v[64:67]
ds_read_b64_tr_b16 v[150:151],v15 offset:4608
buffer_load_dwordx2 v[172:173],v22,s[56:59],s60 offen offset:1024 sc1
v_mfma_f32_16x16x32_bf16 v[68:71],v[120:123],v[100:103],v[68:71]
ds_read_b64_tr_b16 v[152:153],v16 offset:4096
ds_read_b64_tr_b16 v[154:155],v16 offset:4608
v_mfma_f32_16x16x32_bf16 v[72:75],v[120:123],v[104:107],v[72:75]
ds_read_b64_tr_b16 v[156:157],v17 offset:4096
v_mfma_f32_16x16x32_bf16 v[76:79],v[120:123],v[108:111],v[76:79]
ds_read_b64_tr_b16 v[158:159],v17 offset:4608
buffer_load_dwordx2 v[174:175],v22,s[56:59],s60 offen offset:1536 sc1
v_mfma_f32_16x16x32_bf16 v[80:83],v[124:127],v[96:99],v[80:83]
v_mfma_f32_16x16x32_bf16 v[84:87],v[124:127],v[100:103],v[84:87]
v_mfma_f32_16x16x32_bf16 v[88:91],v[124:127],v[104:107],v[88:91]
v_mfma_f32_16x16x32_bf16 v[92:95],v[124:127],v[108:111],v[92:95]
s_waitcnt lgkmcnt(4)
v_mfma_f32_16x16x32_bf16 v[32:35],v[144:147],v[128:131],v[32:35]
s_add_u32 s36,s36,49152
v_mfma_f32_16x16x32_bf16 v[36:39],v[144:147],v[132:135],v[36:39]
v_mfma_f32_16x16x32_bf16 v[40:43],v[144:147],v[136:139],v[40:43]
s_cmp_eq_u32 s36,147456
s_cselect_b32 s42,s51,s50
s_cselect_b32 s36,0,s36
v_add_u32 v12,s42,v12
v_add_u32 v14,s42,v14
v_add_u32 v15,s42,v15
v_add_u32 v16,s42,v16
v_add_u32 v17,s42,v17
s_waitcnt vmcnt(8)
s_waitcnt lgkmcnt(0)
s_barrier
ds_read_b128 v[96:99],v12 offset:0
v_mfma_f32_16x16x32_bf16 v[44:47],v[144:147],v[140:143],v[44:47]
ds_read_b64_tr_b16 v[112:113],v14 offset:0
ds_read_b64_tr_b16 v[114:115],v14 offset:512
v_mfma_f32_16x16x32_bf16 v[48:51],v[148:151],v[128:131],v[48:51]
ds_read_b128 v[100:103],v12 offset:2048
v_mfma_f32_16x16x32_bf16 v[52:55],v[148:151],v[132:135],v[52:55]
ds_read_b128 v[104:107],v12 offset:4096
v_mfma_f32_16x16x32_bf16 v[56:59],v[148:151],v[136:139],v[56:59]
v_mfma_f32_16x16x32_bf16 v[60:63],v[148:151],v[140:143],v[60:63]
ds_read_b128 v[108:111],v12 offset:6144
v_mfma_f32_16x16x32_bf16 v[64:67],v[152:155],v[128:131],v[64:67]
ds_read_b64_tr_b16 v[116:117],v15 offset:0
ds_read_b64_tr_b16 v[118:119],v15 offset:512
v_mfma_f32_16x16x32_bf16 v[68:71],v[152:155],v[132:135],v[68:71]
ds_read_b64_tr_b16 v[120:121],v16 offset:0
v_mfma_f32_16x16x32_bf16 v[72:75],v[152:155],v[136:139],v[72:75]
ds_read_b64_tr_b16 v[122:123],v16 offset:512
ds_read_b64_tr_b16 v[124:125],v17 offset:0
v_mfma_f32_16x16x32_bf16 v[76:79],v[152:155],v[140:143],v[76:79]
ds_read_b64_tr_b16 v[126:127],v17 offset:512
v_mfma_f32_16x16x32_bf16 v[80:83],v[156:159],v[128:131],v[80:83]
v_mfma_f32_16x16x32_bf16 v[84:87],v[156:159],v[132:135],v[84:87]
v_mfma_f32_16x16x32_bf16 v[88:91],v[156:159],v[136:139],v[88:91]
v_mfma_f32_16x16x32_bf16 v[92:95],v[156:159],v[140:143],v[92:95]
s_waitcnt lgkmcnt(4)
v_mfma_f32_16x16x32_bf16 v[32:35],v[112:115],v[96:99],v[32:35]
v_add_u32 v13,s42,v13
ds_read_b128 v[128:131],v13 offset:0
v_mfma_f32_16x16x32_bf16 v[36:39],v[112:115],v[100:103],v[36:39]
ds_read_b64_tr_b16 v[144:145],v14 offset:4096
v_mfma_f32_16x16x32_bf16 v[40:43],v[112:115],v[104:107],v[40:43]
ds_read_b64_tr_b16 v[146:147],v14 offset:4608
v_mfma_f32_16x16x32_bf16 v[44:47],v[112:115],v[108:111],v[44:47]
ds_read_b128 v[132:135],v13 offset:2048
v_mfma_f32_16x16x32_bf16 v[48:51],v[116:119],v[96:99],v[48:51]
ds_read_b128 v[136:139],v13 offset:4096
v_mfma_f32_16x16x32_bf16 v[52:55],v[116:119],v[100:103],v[52:55]
v_mfma_f32_16x16x32_bf16 v[56:59],v[116:119],v[104:107],v[56:59]
ds_read_b128 v[140:143],v13 offset:6144
v_mfma_f32_16x16x32_bf16 v[60:63],v[116:119],v[108:111],v[60:63]
ds_read_b64_tr_b16 v[148:149],v15 offset:4096
s_waitcnt lgkmcnt(7)
v_mfma_f32_16x16x32_bf16 v[64:67],v[120:123],v[96:99],v[64:67]
ds_read_b64_tr_b16 v[150:151],v15 offset:4608
v_mfma_f32_16x16x32_bf16 v[68:71],v[120:123],v[100:103],v[68:71]
ds_read_b64_tr_b16 v[152:153],v16 offset:4096
ds_read_b64_tr_b16 v[154:155],v16 offset:4608
v_mfma_f32_16x16x32_bf16 v[72:75],v[120:123],v[104:107],v[72:75]
ds_read_b64_tr_b16 v[156:157],v17 offset:4096
v_mfma_f32_16x16x32_bf16 v[76:79],v[120:123],v[108:111],v[76:79]
ds_read_b64_tr_b16 v[158:159],v17 offset:4608
v_mfma_f32_16x16x32_bf16 v[80:83],v[124:127],v[96:99],v[80:83]
v_mfma_f32_16x16x32_bf16 v[84:87],v[124:127],v[100:103],v[84:87]
v_mfma_f32_16x16x32_bf16 v[88:91],v[124:127],v[104:107],v[88:91]
v_mfma_f32_16x16x32_bf16 v[92:95],v[124:127],v[108:111],v[92:95]
s_waitcnt lgkmcnt(4)
v_mfma_f32_16x16x32_bf16 v[32:35],v[144:147],v[128:131],v[32:35]
v_mfma_f32_16x16x32_bf16 v[36:39],v[144:147],v[132:135],v[36:39]
v_mfma_f32_16x16x32_bf16 v[40:43],v[144:147],v[136:139],v[40:43]
v_mfma_f32_16x16x32_bf16 v[44:47],v[144:147],v[140:143],v[44:47]
v_mfma_f32_16x16x32_bf16 v[48:51],v[148:151],v[128:131],v[48:51]
v_mfma_f32_16x16x32_bf16 v[52:55],v[148:151],v[132:135],v[52:55]
v_mfma_f32_16x16x32_bf16 v[56:59],v[148:151],v[136:139],v[56:59]
v_mfma_f32_16x16x32_bf16 v[60:63],v[148:151],v[140:143],v[60:63]
s_waitcnt lgkmcnt(0)
v_mfma_f32_16x16x32_bf16 v[64:67],v[152:155],v[128:131],v[64:67]
v_mfma_f32_16x16x32_bf16 v[68:71],v[152:155],v[132:135],v[68:71]
v_mfma_f32_16x16x32_bf16 v[72:75],v[152:155],v[136:139],v[72:75]
v_mfma_f32_16x16x32_bf16 v[76:79],v[152:155],v[140:143],v[76:79]
v_mfma_f32_16x16x32_bf16 v[80:83],v[156:159],v[128:131],v[80:83]
v_mfma_f32_16x16x32_bf16 v[84:87],v[156:159],v[132:135],v[84:87]
v_mfma_f32_16x16x32_bf16 v[88:91],v[156:159],v[136:139],v[88:91]
v_mfma_f32_16x16x32_bf16 v[92:95],v[156:159],v[140:143],v[92:95]
s_barrier
s_nop 7
s_cmp_eq_u32 s29,0
s_cbranch_scc1 Lwk0197
ds_write_b128 v20,v[32:35] offset:0
ds_write_b128 v20,v[48:51] offset:1024
ds_write_b128 v20,v[64:67] offset:2048
ds_write_b128 v20,v[80:83] offset:3072
ds_write_b128 v20,v[36:39] offset:4096
ds_write_b128 v20,v[52:55] offset:5120
ds_write_b128 v20,v[68:71] offset:6144
ds_write_b128 v20,v[84:87] offset:7168
s_waitcnt vmcnt(0)
v_lshlrev_b32 v176,16,v160
v_and_b32 v177,0xffff0000,v160
v_lshlrev_b32 v178,16,v161
v_and_b32 v179,0xffff0000,v161
v_lshlrev_b32 v180,16,v162
v_and_b32 v181,0xffff0000,v162
v_lshlrev_b32 v182,16,v163
v_and_b32 v183,0xffff0000,v163
v_lshlrev_b32 v184,16,v164
v_and_b32 v185,0xffff0000,v164
v_lshlrev_b32 v186,16,v165
v_and_b32 v187,0xffff0000,v165
v_lshlrev_b32 v188,16,v166
v_and_b32 v189,0xffff0000,v166
v_lshlrev_b32 v190,16,v167
v_and_b32 v191,0xffff0000,v167
v_lshlrev_b32 v192,16,v168
v_and_b32 v193,0xffff0000,v168
v_lshlrev_b32 v194,16,v169
v_and_b32 v195,0xffff0000,v169
v_lshlrev_b32 v196,16,v170
v_and_b32 v197,0xffff0000,v170
v_lshlrev_b32 v198,16,v171
v_and_b32 v199,0xffff0000,v171
v_lshlrev_b32 v200,16,v172
v_and_b32 v201,0xffff0000,v172
v_lshlrev_b32 v202,16,v173
v_and_b32 v203,0xffff0000,v173
v_lshlrev_b32 v204,16,v174
v_and_b32 v205,0xffff0000,v174
v_lshlrev_b32 v206,16,v175
v_and_b32 v207,0xffff0000,v175
s_waitcnt lgkmcnt(0)
s_barrier
ds_read_b128 v[96:99],v21 offset:0
ds_read_b128 v[100:103],v21 offset:1024
ds_read_b128 v[104:107],v21 offset:2048
ds_read_b128 v[108:111],v21 offset:3072
ds_read_b128 v[112:115],v21 offset:4096
ds_read_b128 v[116:119],v21 offset:5120
ds_read_b128 v[120:123],v21 offset:6144
ds_read_b128 v[124:127],v21 offset:7168
v_pk_add_f32 v[176:177],v[176:177],v[40:41]
v_pk_add_f32 v[178:179],v[178:179],v[42:43]
v_pk_add_f32 v[180:181],v[180:181],v[56:57]
v_pk_add_f32 v[182:183],v[182:183],v[58:59]
v_pk_add_f32 v[184:185],v[184:185],v[72:73]
v_pk_add_f32 v[186:187],v[186:187],v[74:75]
v_pk_add_f32 v[188:189],v[188:189],v[88:89]
v_pk_add_f32 v[190:191],v[190:191],v[90:91]
v_pk_add_f32 v[192:193],v[192:193],v[44:45]
v_pk_add_f32 v[194:195],v[194:195],v[46:47]
v_pk_add_f32 v[196:197],v[196:197],v[60:61]
v_pk_add_f32 v[198:199],v[198:199],v[62:63]
v_pk_add_f32 v[200:201],v[200:201],v[76:77]
v_pk_add_f32 v[202:203],v[202:203],v[78:79]
v_pk_add_f32 v[204:205],v[204:205],v[92:93]
v_pk_add_f32 v[206:207],v[206:207],v[94:95]
s_branch Lex198
Lwk0197:
ds_write_b128 v20,v[40:43] offset:0
ds_write_b128 v20,v[56:59] offset:1024
ds_write_b128 v20,v[72:75] offset:2048
ds_write_b128 v20,v[88:91] offset:3072
ds_write_b128 v20,v[44:47] offset:4096
ds_write_b128 v20,v[60:63] offset:5120
ds_write_b128 v20,v[76:79] offset:6144
ds_write_b128 v20,v[92:95] offset:7168
s_waitcnt vmcnt(0)
v_lshlrev_b32 v176,16,v160
v_and_b32 v177,0xffff0000,v160
v_lshlrev_b32 v178,16,v161
v_and_b32 v179,0xffff0000,v161
v_lshlrev_b32 v180,16,v162
v_and_b32 v181,0xffff0000,v162
v_lshlrev_b32 v182,16,v163
v_and_b32 v183,0xffff0000,v163
v_lshlrev_b32 v184,16,v164
v_and_b32 v185,0xffff0000,v164
v_lshlrev_b32 v186,16,v165
v_and_b32 v187,0xffff0000,v165
v_lshlrev_b32 v188,16,v166
v_and_b32 v189,0xffff0000,v166
v_lshlrev_b32 v190,16,v167
v_and_b32 v191,0xffff0000,v167
v_lshlrev_b32 v192,16,v168
v_and_b32 v193,0xffff0000,v168
v_lshlrev_b32 v194,16,v169
v_and_b32 v195,0xffff0000,v169
v_lshlrev_b32 v196,16,v170
v_and_b32 v197,0xffff0000,v170
v_lshlrev_b32 v198,16,v171
v_and_b32 v199,0xffff0000,v171
v_lshlrev_b32 v200,16,v172
v_and_b32 v201,0xffff0000,v172
v_lshlrev_b32 v202,16,v173
v_and_b32 v203,0xffff0000,v173
v_lshlrev_b32 v204,16,v174
v_and_b32 v205,0xffff0000,v174
v_lshlrev_b32 v206,16,v175
v_and_b32 v207,0xffff0000,v175
s_waitcnt lgkmcnt(0)
s_barrier
ds_read_b128 v[96:99],v21 offset:0
ds_read_b128 v[100:103],v21 offset:1024
ds_read_b128 v[104:107],v21 offset:2048
ds_read_b128 v[108:111],v21 offset:3072
ds_read_b128 v[112:115],v21 offset:4096
ds_read_b128 v[116:119],v21 offset:5120
ds_read_b128 v[120:123],v21 offset:6144
ds_read_b128 v[124:127],v21 offset:7168
v_pk_add_f32 v[176:177],v[176:177],v[32:33]
v_pk_add_f32 v[178:179],v[178:179],v[34:35]
v_pk_add_f32 v[180:181],v[180:181],v[48:49]
v_pk_add_f32 v[182:183],v[182:183],v[50:51]
v_pk_add_f32 v[184:185],v[184:185],v[64:65]
v_pk_add_f32 v[186:187],v[186:187],v[66:67]
v_pk_add_f32 v[188:189],v[188:189],v[80:81]
v_pk_add_f32 v[190:191],v[190:191],v[82:83]
v_pk_add_f32 v[192:193],v[192:193],v[36:37]
v_pk_add_f32 v[194:195],v[194:195],v[38:39]
v_pk_add_f32 v[196:197],v[196:197],v[52:53]
v_pk_add_f32 v[198:199],v[198:199],v[54:55]
v_pk_add_f32 v[200:201],v[200:201],v[68:69]
v_pk_add_f32 v[202:203],v[202:203],v[70:71]
v_pk_add_f32 v[204:205],v[204:205],v[84:85]
v_pk_add_f32 v[206:207],v[206:207],v[86:87]
Lex198:
s_waitcnt lgkmcnt(0)
s_add_u32 s56,s16,4259840
s_addc_u32 s57,s17,0
s_mov_b32 s58,4194304
v_pk_add_f32 v[176:177],v[176:177],v[96:97]
v_pk_add_f32 v[178:179],v[178:179],v[98:99]
v_pk_add_f32 v[180:181],v[180:181],v[100:101]
v_pk_add_f32 v[182:183],v[182:183],v[102:103]
v_pk_add_f32 v[184:185],v[184:185],v[104:105]
v_pk_add_f32 v[186:187],v[186:187],v[106:107]
v_pk_add_f32 v[188:189],v[188:189],v[108:109]
v_pk_add_f32 v[190:191],v[190:191],v[110:111]
v_pk_add_f32 v[192:193],v[192:193],v[112:113]
v_pk_add_f32 v[194:195],v[194:195],v[114:115]
v_pk_add_f32 v[196:197],v[196:197],v[116:117]
v_pk_add_f32 v[198:199],v[198:199],v[118:119]
v_pk_add_f32 v[200:201],v[200:201],v[120:121]
v_pk_add_f32 v[202:203],v[202:203],v[122:123]
v_pk_add_f32 v[204:205],v[204:205],v[124:125]
v_pk_add_f32 v[206:207],v[206:207],v[126:127]
v_cvt_pk_bf16_f32 v32,v176,v177
v_cvt_pk_bf16_f32 v33,v178,v179
v_cvt_pk_bf16_f32 v34,v180,v181
v_cvt_pk_bf16_f32 v35,v182,v183
v_cvt_pk_bf16_f32 v36,v184,v185
v_cvt_pk_bf16_f32 v37,v186,v187
v_cvt_pk_bf16_f32 v38,v188,v189
v_cvt_pk_bf16_f32 v39,v190,v191
v_cvt_pk_bf16_f32 v40,v192,v193
v_cvt_pk_bf16_f32 v41,v194,v195
v_cvt_pk_bf16_f32 v42,v196,v197
v_cvt_pk_bf16_f32 v43,v198,v199
v_cvt_pk_bf16_f32 v44,v200,v201
v_cvt_pk_bf16_f32 v45,v202,v203
v_cvt_pk_bf16_f32 v46,v204,v205
v_cvt_pk_bf16_f32 v47,v206,v207
v_mov_b32 v64,v32
v_mov_b32 v65,v33
v_mov_b32 v66,v34
v_mov_b32 v67,v35
v_mov_b32 v68,v36
v_mov_b32 v69,v37
v_mov_b32 v70,v38
v_mov_b32 v71,v39
v_mov_b32 v72,v40
v_mov_b32 v73,v41
v_mov_b32 v74,v42
v_mov_b32 v75,v43
v_mov_b32 v76,v44
v_mov_b32 v77,v45
v_mov_b32 v78,v46
v_mov_b32 v79,v47
v_permlane16_swap_b32 v32,v34
v_permlane16_swap_b32 v33,v35
buffer_store_dwordx4 v[32:35],v18,s[56:59],0 offen sc1
v_permlane16_swap_b32 v36,v38
v_permlane16_swap_b32 v37,v39
buffer_store_dwordx4 v[36:39],v18,s[56:59],0 offen offset:1024 sc1
v_permlane16_swap_b32 v40,v42
v_permlane16_swap_b32 v41,v43
buffer_store_dwordx4 v[40:43],v18,s[56:59],s60 offen sc1
v_permlane16_swap_b32 v44,v46
v_permlane16_swap_b32 v45,v47
buffer_store_dwordx4 v[44:47],v18,s[56:59],s60 offen offset:1024 sc1
s_mov_b32 s18,0x3f803f80
v_mov_b32 v48,0
v_mov_b32 v49,0
v_mov_b32 v50,0
v_mov_b32 v51,0
v_dot2_f32_bf16 v48,v64,s18,v48
v_dot2_f32_bf16 v49,v64,v64,v49
v_dot2_f32_bf16 v50,v72,s18,v50
v_dot2_f32_bf16 v51,v72,v72,v51
v_dot2_f32_bf16 v48,v65,s18,v48
v_dot2_f32_bf16 v49,v65,v65,v49
v_dot2_f32_bf16 v50,v73,s18,v50
v_dot2_f32_bf16 v51,v73,v73,v51
v_dot2_f32_bf16 v48,v66,s18,v48
v_dot2_f32_bf16 v49,v66,v66,v49
v_dot2_f32_bf16 v50,v74,s18,v50
v_dot2_f32_bf16 v51,v74,v74,v51
v_dot2_f32_bf16 v48,v67,s18,v48
v_dot2_f32_bf16 v49,v67,v67,v49
v_dot2_f32_bf16 v50,v75,s18,v50
v_dot2_f32_bf16 v51,v75,v75,v51
v_dot2_f32_bf16 v48,v68,s18,v48
v_dot2_f32_bf16 v49,v68,v68,v49
v_dot2_f32_bf16 v50,v76,s18,v50
v_dot2_f32_bf16 v51,v76,v76,v51
v_dot2_f32_bf16 v48,v69,s18,v48
v_dot2_f32_bf16 v49,v69,v69,v49
v_dot2_f32_bf16 v50,v77,s18,v50
v_dot2_f32_bf16 v51,v77,v77,v51
v_dot2_f32_bf16 v48,v70,s18,v48
v_dot2_f32_bf16 v49,v70,v70,v49
v_dot2_f32_bf16 v50,v78,s18,v50
v_dot2_f32_bf16 v51,v78,v78,v51
v_dot2_f32_bf16 v48,v71,s18,v48
v_dot2_f32_bf16 v49,v71,v71,v49
v_dot2_f32_bf16 v50,v79,s18,v50
v_dot2_f32_bf16 v51,v79,v79,v51
s_nop 2
v_mov_b32 v52,v48
v_mov_b32 v53,v49
v_mov_b32 v54,v50
v_mov_b32 v55,v51
v_permlane32_swap_b32 v48,v52
v_permlane32_swap_b32 v49,v53
v_permlane32_swap_b32 v50,v54
v_permlane32_swap_b32 v51,v55
v_pk_add_f32 v[48:49],v[48:49],v[52:53]
v_pk_add_f32 v[50:51],v[50:51],v[54:55]
v_mov_b32 v52,v48
v_mov_b32 v53,v49
v_mov_b32 v54,v50
v_mov_b32 v55,v51
v_permlane16_swap_b32 v48,v52
v_permlane16_swap_b32 v49,v53
v_permlane16_swap_b32 v50,v54
v_permlane16_swap_b32 v51,v55
v_pk_add_f32 v[48:49],v[48:49],v[52:53]
v_pk_add_f32 v[50:51],v[50:51],v[54:55]
s_mov_b32 s18,35192832
s_mov_b64 exec,0xffff
buffer_store_dwordx2 v[48:49],v19,s[24:27],s18 offen sc1
buffer_store_dwordx2 v[50:51],v19,s[24:27],s18 offen offset:2048 sc1
s_mov_b64 exec,-1
s_cmp_lt_u32 s20,2
s_cselect_b32 s12,s74,s76
s_cselect_b32 s13,s75,s77
s_mov_b32 s14,7340032
v_mul_u32_u24 v1,4682,v2
v_lshrrev_b32 v1,16,v1
v_mul_u32_u24 v3,14,v1
v_sub_u32 v3,v2,v3
v_lshlrev_b32 v3,4,v3
s_and_b32 s18,s20,1
s_lshl_b32 s18,s18,4
v_add_u32 v1,s18,v1
v_mul_u32_u24 v1,7168,v1
v_add_u32 v1,v1,v3
s_mul_i32 s19,s87,224
v_add_u32 v8,s19,v1
v_add_u32 v9,27776,v8
v_add_u32 v10,55424,v8
v_add_u32 v11,83200,v8
s_lshr_b32 s32,s86,1
s_mul_i32 s32,s32,0
s_mov_b32 s35,0
s_lshr_b32 s18,s20,1
s_mul_i32 s41,s18,7680
s_and_b32 s18,s20,1
s_mul_i32 s18,s18,3840
s_add_u32 s41,s41,s18
s_add_u32 s41,s41,65536
s_waitcnt vmcnt(0)
s_barrier
s_cmp_lg_u32 s20,0
s_cbranch_scc1 Lpub199
s_and_b32 s18,s84,14
s_add_u32 s18,s18,s88
s_and_b32 s19,s84,1
s_lshl_b32 s19,s19,3
s_and_b32 s39,s85,7
s_add_u32 s19,s19,s39
s_lshl_b32 s18,s18,8
s_lshl_b32 s19,s19,2
s_add_u32 s18,s18,s19
s_add_u32 s18,s18,95731712
v_mov_b32 v1,0
v_mov_b32 v3,s94
s_mov_b64 exec,1
buffer_store_dword v3,v1,s[24:27],s18 offen sc1
s_mov_b64 exec,-1
Lpub199:
s_add_u32 m0,s35,s41
s_nop 0
buffer_load_dwordx4 v8,s[12:15],s32 offen lds
buffer_load_dwordx4 v9,s[12:15],s32 offen offset:896 lds
buffer_load_dwordx4 v10,s[12:15],s32 offen offset:1920 lds
buffer_load_dwordx4 v11,s[12:15],s32 offen offset:2816 lds
s_add_u32 s35,s35,15360
s_cmp_eq_u32 s35,92160
s_cselect_b32 s35,0,s35
s_add_u32 s32,s32,229376
s_cmp_eq_u32 s32,7340032
s_cselect_b32 s32,0,s32
s_add_u32 m0,s35,s41
s_nop 0
buffer_load_dwordx4 v8,s[12:15],s32 offen lds
buffer_load_dwordx4 v9,s[12:15],s32 offen offset:896 lds
buffer_load_dwordx4 v10,s[12:15],s32 offen offset:1920 lds
buffer_load_dwordx4 v11,s[12:15],s32 offen offset:2816 lds
s_add_u32 s35,s35,15360
s_cmp_eq_u32 s35,92160
s_cselect_b32 s35,0,s35
s_add_u32 s32,s32,229376
s_cmp_eq_u32 s32,7340032
s_cselect_b32 s32,0,s32
s_add_u32 m0,s35,s41
s_nop 0
buffer_load_dwordx4 v8,s[12:15],s32 offen lds
buffer_load_dwordx4 v9,s[12:15],s32 offen offset:896 lds
buffer_load_dwordx4 v10,s[12:15],s32 offen offset:1920 lds
buffer_load_dwordx4 v11,s[12:15],s32 offen offset:2816 lds
s_add_u32 s35,s35,15360
s_cmp_eq_u32 s35,92160
s_cselect_b32 s35,0,s35
s_add_u32 s32,s32,229376
s_cmp_eq_u32 s32,7340032
s_cselect_b32 s32,0,s32
s_add_u32 m0,s35,s41
s_nop 0
buffer_load_dwordx4 v8,s[12:15],s32 offen lds
buffer_load_dwordx4 v9,s[12:15],s32 offen offset:896 lds
buffer_load_dwordx4 v10,s[12:15],s32 offen offset:1920 lds
buffer_load_dwordx4 v11,s[12:15],s32 offen offset:2816 lds
s_add_u32 s35,s35,15360
s_cmp_eq_u32 s35,92160
s_cselect_b32 s35,0,s35
s_add_u32 s32,s32,229376
s_cmp_eq_u32 s32,7340032
s_cselect_b32 s32,0,s32
s_add_u32 s8,s16,4259840
s_addc_u32 s9,s17,0
s_mov_b32 s10,4194304
s_lshl_b32 s23,s86,8
s_lshl_b32 s18,s20,6
s_add_u32 s23,s23,s18
s_mul_i32 s22,s87,112
s_mul_i32 s19,s23,2048
v_lshlrev_b32 v4,4,v2
v_add_u32 v4,s19,v4
v_add_u32 v5,30720,v4
s_lshr_b32 s30,s86,1
s_mul_i32 s30,s30,0
s_and_b32 s95,s86,1
s_add_u32 s31,s30,65536
s_mov_b32 s34,0
s_lshl_b32 s40,s20,13
s_add_u32 s52,s40,4096
s_mul_i32 s18,s23,7168
s_mul_i32 s19,s87,3584
s_add_u32 s18,s18,s19
v_lshlrev_b32 v15,4,v30
v_and_b32 v1,1,v31
v_lshl_add_u32 v15,v1,9,v15
v_lshrrev_b32 v1,1,v31
v_lshl_add_u32 v15,v1,8,v15
v_add_u32 v15,s18,v15
s_lshl_b32 s18,s23,7
s_add_u32 s60,s18,35192832
v_lshlrev_b32 v29,11,v31
v_lshl_add_u32 v29,v30,4,v29
v_add_u32 v1,s22,v30
v_lshlrev_b32 v28,4,v1
v_and_b32 v1,1,v31
v_mul_u32_u24 v1,163840,v1
v_add_u32 v28,v28,v1
s_mov_b32 s62,94420992
s_mov_b32 s63,94478336
v_lshlrev_b32 v12,4,v2
v_add_u32 v12,s40,v12
v_add_u32 v13,1024,v12
v_mul_u32_u24 v1,1920,v31
v_bfe_u32 v3,v2,2,2
v_mul_u32_u24 v3,224,v3
v_add_u32 v1,v1,v3
v_and_b32 v3,3,v2
v_lshl_add_u32 v1,v3,3,v1
v_add_u32 v14,65536,v1
s_mov_b32 s36,0
s_mov_b32 s37,0
s_mov_b32 s42,0
s_mov_b32 s48,30720
s_mov_b32 s49,0xffff1000
s_mov_b32 s50,32768
s_mov_b32 s51,0xffff8000
s_mov_b32 s44,0xc0135761
s_mov_b32 s45,0xbdd2d3e8
s_cmp_lg_u32 s20,0
s_cbranch_scc1 Lwbar200
s_lshl_b32 s18,s86,1
s_lshl_b32 s18,s18,8
s_add_u32 s18,s18,95731712
v_lshlrev_b32 v1,2,v30
v_lshl_add_u32 v1,v31,8,v1
s_mov_b32 exec_lo,0xffffffff
s_mov_b32 exec_hi,0
s_mov_b32 s39,131072
Lpoll201:
buffer_load_dword v3,v1,s[24:27],s18 offen sc1
s_waitcnt vmcnt(0)
v_cmp_ne_u32 vcc,s94,v3
s_nop 1
s_cmp_eq_u64 vcc,0
s_cbranch_scc1 Lgot202
s_sleep 1
s_sub_u32 s39,s39,1
s_cmp_lg_u32 s39,0
s_cbranch_scc1 Lpoll201
Lgot202:
s_mov_b64 exec,-1
Lwbar200:
s_barrier
s_add_u32 m0,s34,s40
s_nop 0
buffer_load_dwordx4 v4,s[8:11],s30 offen sc1 lds
buffer_load_dwordx4 v4,s[8:11],s30 offen offset:1024 sc1 lds
buffer_load_dwordx4 v5,s[8:11],s30 offen offset:2048 sc1 lds
buffer_load_dwordx4 v5,s[8:11],s30 offen offset:3072 sc1 lds
s_add_u32 m0,s34,s52
s_nop 0
buffer_load_dwordx4 v4,s[8:11],s31 offen sc1 lds
buffer_load_dwordx4 v4,s[8:11],s31 offen offset:1024 sc1 lds
buffer_load_dwordx4 v5,s[8:11],s31 offen offset:2048 sc1 lds
buffer_load_dwordx4 v5,s[8:11],s31 offen offset:3072 sc1 lds
s_add_u32 s30,s30,2048
s_and_b32 s30,s30,0x7fff
s_add_u32 s34,s34,32768
s_cmp_eq_u32 s34,65536
s_cselect_b32 s34,0,s34
s_add_u32 s31,s30,65536
s_add_u32 m0,s34,s40
s_nop 0
buffer_load_dwordx4 v4,s[8:11],s30 offen sc1 lds
buffer_load_dwordx4 v4,s[8:11],s30 offen offset:1024 sc1 lds
buffer_load_dwordx4 v5,s[8:11],s30 offen offset:2048 sc1 lds
buffer_load_dwordx4 v5,s[8:11],s30 offen offset:3072 sc1 lds
s_add_u32 m0,s34,s52
s_nop 0
buffer_load_dwordx4 v4,s[8:11],s31 offen sc1 lds
buffer_load_dwordx4 v4,s[8:11],s31 offen offset:1024 sc1 lds
buffer_load_dwordx4 v5,s[8:11],s31 offen offset:2048 sc1 lds
buffer_load_dwordx4 v5,s[8:11],s31 offen offset:3072 sc1 lds
s_add_u32 s30,s30,2048
s_and_b32 s30,s30,0x7fff
s_add_u32 s34,s34,32768
s_cmp_eq_u32 s34,65536
s_cselect_b32 s34,0,s34
s_add_u32 s31,s30,65536
s_waitcnt vmcnt(8)
s_barrier
v_cmp_gt_u32 vcc,32,v2
ds_read_b128 a[112:115],v12 offset:0
ds_read_b128 a[128:131],v12 offset:1024
ds_read_b128 a[116:119],v12 offset:2048
ds_read_b128 a[132:135],v12 offset:3072
ds_read_b128 a[120:123],v12 offset:4096
ds_read_b128 a[136:139],v12 offset:5120
ds_read_b128 a[124:127],v12 offset:6144
ds_read_b128 a[140:143],v12 offset:7168
ds_read_b64_tr_b16 a[0:1],v14 offset:0
ds_read_b64_tr_b16 a[2:3],v14 offset:896
ds_read_b64_tr_b16 a[4:5],v14 offset:15360
ds_read_b64_tr_b16 a[6:7],v14 offset:16256
ds_read_b64_tr_b16 a[8:9],v14 offset:32
ds_read_b64_tr_b16 a[10:11],v14 offset:928
ds_read_b64_tr_b16 a[12:13],v14 offset:15392
ds_read_b64_tr_b16 a[14:15],v14 offset:16288
ds_read_b64_tr_b16 a[16:17],v14 offset:64
ds_read_b64_tr_b16 a[18:19],v14 offset:960
ds_read_b64_tr_b16 a[20:21],v14 offset:15424
ds_read_b64_tr_b16 a[22:23],v14 offset:16320
ds_read_b64_tr_b16 a[24:25],v14 offset:96
ds_read_b64_tr_b16 a[26:27],v14 offset:992
ds_read_b64_tr_b16 a[28:29],v14 offset:15456
ds_read_b64_tr_b16 a[30:31],v14 offset:16352
ds_read_b64_tr_b16 a[32:33],v14 offset:128
ds_read_b64_tr_b16 a[34:35],v14 offset:1024
ds_read_b64_tr_b16 a[36:37],v14 offset:15488
ds_read_b64_tr_b16 a[38:39],v14 offset:16384
ds_read_b64_tr_b16 a[40:41],v14 offset:160
ds_read_b64_tr_b16 a[42:43],v14 offset:1056
ds_read_b64_tr_b16 a[44:45],v14 offset:15520
ds_read_b64_tr_b16 a[46:47],v14 offset:16416
ds_read_b64_tr_b16 a[48:49],v14 offset:192
ds_read_b64_tr_b16 a[50:51],v14 offset:1088
ds_read_b64_tr_b16 a[52:53],v14 offset:15552
ds_read_b64_tr_b16 a[54:55],v14 offset:16448
ds_read_b64_tr_b16 a[56:57],v14 offset:7680
ds_read_b64_tr_b16 a[58:59],v14 offset:8576
ds_read_b64_tr_b16 a[60:61],v14 offset:23040
ds_read_b64_tr_b16 a[62:63],v14 offset:23936
ds_read_b64_tr_b16 a[64:65],v14 offset:7712
ds_read_b64_tr_b16 a[66:67],v14 offset:8608
ds_read_b64_tr_b16 a[68:69],v14 offset:23072
ds_read_b64_tr_b16 a[70:71],v14 offset:23968
ds_read_b64_tr_b16 a[72:73],v14 offset:7744
ds_read_b64_tr_b16 a[74:75],v14 offset:8640
ds_read_b64_tr_b16 a[76:77],v14 offset:23104
ds_read_b64_tr_b16 a[78:79],v14 offset:24000
ds_read_b64_tr_b16 a[80:81],v14 offset:7776
ds_read_b64_tr_b16 a[82:83],v14 offset:8672
ds_read_b64_tr_b16 a[84:85],v14 offset:23136
ds_read_b64_tr_b16 a[86:87],v14 offset:24032
ds_read_b64_tr_b16 a[88:89],v14 offset:7808
ds_read_b64_tr_b16 a[90:91],v14 offset:8704
ds_read_b64_tr_b16 a[92:93],v14 offset:23168
ds_read_b64_tr_b16 a[94:95],v14 offset:24064
ds_read_b64_tr_b16 a[96:97],v14 offset:7840
ds_read_b64_tr_b16 a[98:99],v14 offset:8736
ds_read_b64_tr_b16 a[100:101],v14 offset:23200
ds_read_b64_tr_b16 a[102:103],v14 offset:24096
s_add_u32 s37,s37,30720
s_cmp_eq_u32 s37,92160
s_cselect_b32 s43,s49,s48
s_cselect_b32 s37,0,s37
s_waitcnt lgkmcnt(0)
v_mfma_f32_16x16x32_bf16 v[32:35],a[0:3],a[112:115],0
ds_read_b64_tr_b16 a[104:105],v14 offset:7872
v_mfma_f32_16x16x32_bf16 v[32:35],a[4:7],a[128:131],v[32:35]
ds_read_b64_tr_b16 a[106:107],v14 offset:8768
v_mfma_f32_16x16x32_bf16 v[36:39],a[0:3],a[116:119],0
ds_read_b64_tr_b16 a[108:109],v14 offset:23232
v_mfma_f32_16x16x32_bf16 v[36:39],a[4:7],a[132:135],v[36:39]
ds_read_b64_tr_b16 a[110:111],v14 offset:24128
v_mfma_f32_16x16x32_bf16 v[40:43],a[0:3],a[120:123],0
v_add_u32 v14,s43,v14
v_mfma_f32_16x16x32_bf16 v[40:43],a[4:7],a[136:139],v[40:43]
v_xor_b32 v12,32768,v12
v_mfma_f32_16x16x32_bf16 v[44:47],a[0:3],a[124:127],0
v_mfma_f32_16x16x32_bf16 v[44:47],a[4:7],a[140:143],v[44:47]
s_waitcnt vmcnt(8) lgkmcnt(0)
s_barrier
v_mfma_f32_16x16x32_bf16 v[48:51],a[8:11],a[112:115],0
ds_read_b64_tr_b16 a[0:1],v14 offset:0
s_add_u32 m0,s34,s40
v_mfma_f32_16x16x32_bf16 v[48:51],a[12:15],a[128:131],v[48:51]
buffer_load_dwordx4 v4,s[8:11],s30 offen sc1 lds
s_add_u32 s37,s37,30720
v_mfma_f32_16x16x32_bf16 v[52:55],a[8:11],a[116:119],0
ds_read_b64_tr_b16 a[2:3],v14 offset:896
v_mfma_f32_16x16x32_bf16 v[52:55],a[12:15],a[132:135],v[52:55]
s_cmp_eq_u32 s37,92160
s_cselect_b32 s43,s49,s48
s_cselect_b32 s37,0,s37
v_mfma_f32_16x16x32_bf16 v[56:59],a[8:11],a[120:123],0
ds_read_b64_tr_b16 a[4:5],v14 offset:15360
v_mfma_f32_16x16x32_bf16 v[56:59],a[12:15],a[136:139],v[56:59]
buffer_load_dwordx4 v4,s[8:11],s30 offen offset:1024 sc1 lds
v_mfma_f32_16x16x32_bf16 v[60:63],a[8:11],a[124:127],0
ds_read_b64_tr_b16 a[6:7],v14 offset:16256
v_mfma_f32_16x16x32_bf16 v[60:63],a[12:15],a[140:143],v[60:63]
v_mfma_f32_16x16x32_bf16 v[64:67],a[16:19],a[112:115],0
ds_read_b64_tr_b16 a[8:9],v14 offset:32
v_mfma_f32_16x16x32_bf16 v[64:67],a[20:23],a[128:131],v[64:67]
buffer_load_dwordx4 v5,s[8:11],s30 offen offset:2048 sc1 lds
v_mfma_f32_16x16x32_bf16 v[68:71],a[16:19],a[116:119],0
ds_read_b64_tr_b16 a[10:11],v14 offset:928
v_mfma_f32_16x16x32_bf16 v[68:71],a[20:23],a[132:135],v[68:71]
v_mfma_f32_16x16x32_bf16 v[72:75],a[16:19],a[120:123],0
ds_read_b64_tr_b16 a[12:13],v14 offset:15392
v_mfma_f32_16x16x32_bf16 v[72:75],a[20:23],a[136:139],v[72:75]
buffer_load_dwordx4 v5,s[8:11],s30 offen offset:3072 sc1 lds
s_add_u32 m0,s34,s52
v_mfma_f32_16x16x32_bf16 v[76:79],a[16:19],a[124:127],0
ds_read_b64_tr_b16 a[14:15],v14 offset:16288
v_mfma_f32_16x16x32_bf16 v[76:79],a[20:23],a[140:143],v[76:79]
v_mfma_f32_16x16x32_bf16 v[80:83],a[24:27],a[112:115],0
ds_read_b64_tr_b16 a[16:17],v14 offset:64
v_mfma_f32_16x16x32_bf16 v[80:83],a[28:31],a[128:131],v[80:83]
buffer_load_dwordx4 v4,s[8:11],s31 offen sc1 lds
v_mfma_f32_16x16x32_bf16 v[84:87],a[24:27],a[116:119],0
ds_read_b64_tr_b16 a[18:19],v14 offset:960
v_mfma_f32_16x16x32_bf16 v[84:87],a[28:31],a[132:135],v[84:87]
v_mfma_f32_16x16x32_bf16 v[88:91],a[24:27],a[120:123],0
ds_read_b64_tr_b16 a[20:21],v14 offset:15424
v_mfma_f32_16x16x32_bf16 v[88:91],a[28:31],a[136:139],v[88:91]
buffer_load_dwordx4 v4,s[8:11],s31 offen offset:1024 sc1 lds
v_mfma_f32_16x16x32_bf16 v[92:95],a[24:27],a[124:127],0
ds_read_b64_tr_b16 a[22:23],v14 offset:16320
v_mfma_f32_16x16x32_bf16 v[92:95],a[28:31],a[140:143],v[92:95]
v_mfma_f32_16x16x32_bf16 v[96:99],a[32:35],a[112:115],0
ds_read_b64_tr_b16 a[24:25],v14 offset:96
v_mfma_f32_16x16x32_bf16 v[96:99],a[36:39],a[128:131],v[96:99]
buffer_load_dwordx4 v5,s[8:11],s31 offen offset:2048 sc1 lds
v_mfma_f32_16x16x32_bf16 v[100:103],a[32:35],a[116:119],0
ds_read_b64_tr_b16 a[26:27],v14 offset:992
v_mfma_f32_16x16x32_bf16 v[100:103],a[36:39],a[132:135],v[100:103]
v_mfma_f32_16x16x32_bf16 v[104:107],a[32:35],a[120:123],0
ds_read_b64_tr_b16 a[28:29],v14 offset:15456
v_mfma_f32_16x16x32_bf16 v[104:107],a[36:39],a[136:139],v[104:107]
buffer_load_dwordx4 v5,s[8:11],s31 offen offset:3072 sc1 lds
s_add_u32 s30,s30,2048
v_mfma_f32_16x16x32_bf16 v[108:111],a[32:35],a[124:127],0
ds_read_b64_tr_b16 a[30:31],v14 offset:16352
s_and_b32 s30,s30,0x7fff
v_mfma_f32_16x16x32_bf16 v[108:111],a[36:39],a[140:143],v[108:111]
s_add_u32 s34,s34,32768
s_cmp_eq_u32 s34,65536
s_cselect_b32 s34,0,s34
v_mfma_f32_16x16x32_bf16 v[112:115],a[40:43],a[112:115],0
ds_read_b64_tr_b16 a[32:33],v14 offset:128
s_add_u32 s31,s30,65536
v_mfma_f32_16x16x32_bf16 v[112:115],a[44:47],a[128:131],v[112:115]
s_add_u32 m0,s35,s41
s_nop 0
buffer_load_dwordx4 v8,s[12:15],s32 offen lds
v_mfma_f32_16x16x32_bf16 v[116:119],a[40:43],a[116:119],0
ds_read_b64_tr_b16 a[34:35],v14 offset:1024
v_mfma_f32_16x16x32_bf16 v[116:119],a[44:47],a[132:135],v[116:119]
v_mfma_f32_16x16x32_bf16 v[120:123],a[40:43],a[120:123],0
ds_read_b64_tr_b16 a[36:37],v14 offset:15488
v_mfma_f32_16x16x32_bf16 v[120:123],a[44:47],a[136:139],v[120:123]
buffer_load_dwordx4 v9,s[12:15],s32 offen offset:896 lds
v_mfma_f32_16x16x32_bf16 v[124:127],a[40:43],a[124:127],0
ds_read_b64_tr_b16 a[38:39],v14 offset:16384
v_mfma_f32_16x16x32_bf16 v[124:127],a[44:47],a[140:143],v[124:127]
v_mfma_f32_16x16x32_bf16 v[128:131],a[48:51],a[112:115],0
ds_read_b64_tr_b16 a[40:41],v14 offset:160
v_mfma_f32_16x16x32_bf16 v[128:131],a[52:55],a[128:131],v[128:131]
buffer_load_dwordx4 v10,s[12:15],s32 offen offset:1920 lds
v_mfma_f32_16x16x32_bf16 v[132:135],a[48:51],a[116:119],0
ds_read_b64_tr_b16 a[42:43],v14 offset:1056
v_mfma_f32_16x16x32_bf16 v[132:135],a[52:55],a[132:135],v[132:135]
v_mfma_f32_16x16x32_bf16 v[136:139],a[48:51],a[120:123],0
ds_read_b64_tr_b16 a[44:45],v14 offset:15520
v_mfma_f32_16x16x32_bf16 v[136:139],a[52:55],a[136:139],v[136:139]
buffer_load_dwordx4 v11,s[12:15],s32 offen offset:2816 lds
s_add_u32 s35,s35,15360
v_mfma_f32_16x16x32_bf16 v[140:143],a[48:51],a[124:127],0
ds_read_b64_tr_b16 a[46:47],v14 offset:16416
v_mfma_f32_16x16x32_bf16 v[140:143],a[52:55],a[140:143],v[140:143]
s_cmp_eq_u32 s35,92160
s_cselect_b32 s35,0,s35
s_add_u32 s32,s32,229376
v_mfma_f32_16x16x32_bf16 v[144:147],a[56:59],a[112:115],0
ds_read_b64_tr_b16 a[48:49],v14 offset:192
v_mfma_f32_16x16x32_bf16 v[144:147],a[60:63],a[128:131],v[144:147]
s_cmp_eq_u32 s32,7340032
s_cselect_b32 s32,0,s32
s_add_u32 m0,s35,s41
v_mfma_f32_16x16x32_bf16 v[148:151],a[56:59],a[116:119],0
ds_read_b64_tr_b16 a[50:51],v14 offset:1088
v_mfma_f32_16x16x32_bf16 v[148:151],a[60:63],a[132:135],v[148:151]
buffer_load_dwordx4 v8,s[12:15],s32 offen lds
v_mfma_f32_16x16x32_bf16 v[152:155],a[56:59],a[120:123],0
ds_read_b64_tr_b16 a[52:53],v14 offset:15552
v_mfma_f32_16x16x32_bf16 v[152:155],a[60:63],a[136:139],v[152:155]
v_mfma_f32_16x16x32_bf16 v[156:159],a[56:59],a[124:127],0
ds_read_b64_tr_b16 a[54:55],v14 offset:16448
v_mfma_f32_16x16x32_bf16 v[156:159],a[60:63],a[140:143],v[156:159]
buffer_load_dwordx4 v9,s[12:15],s32 offen offset:896 lds
v_mfma_f32_16x16x32_bf16 v[160:163],a[64:67],a[112:115],0
ds_read_b64_tr_b16 a[56:57],v14 offset:7680
v_mfma_f32_16x16x32_bf16 v[160:163],a[68:71],a[128:131],v[160:163]
v_mfma_f32_16x16x32_bf16 v[164:167],a[64:67],a[116:119],0
ds_read_b64_tr_b16 a[58:59],v14 offset:8576
v_mfma_f32_16x16x32_bf16 v[164:167],a[68:71],a[132:135],v[164:167]
buffer_load_dwordx4 v10,s[12:15],s32 offen offset:1920 lds
v_mfma_f32_16x16x32_bf16 v[168:171],a[64:67],a[120:123],0
ds_read_b64_tr_b16 a[60:61],v14 offset:23040
v_mfma_f32_16x16x32_bf16 v[168:171],a[68:71],a[136:139],v[168:171]
v_mfma_f32_16x16x32_bf16 v[172:175],a[64:67],a[124:127],0
ds_read_b64_tr_b16 a[62:63],v14 offset:23936
v_mfma_f32_16x16x32_bf16 v[172:175],a[68:71],a[140:143],v[172:175]
buffer_load_dwordx4 v11,s[12:15],s32 offen offset:2816 lds
s_add_u32 s35,s35,15360
v_mfma_f32_16x16x32_bf16 v[176:179],a[72:75],a[112:115],0
ds_read_b64_tr_b16 a[64:65],v14 offset:7712
v_mfma_f32_16x16x32_bf16 v[176:179],a[76:79],a[128:131],v[176:179]
s_cmp_eq_u32 s35,92160
s_cselect_b32 s35,0,s35
s_add_u32 s32,s32,229376
v_mfma_f32_16x16x32_bf16 v[180:183],a[72:75],a[116:119],0
ds_read_b64_tr_b16 a[66:67],v14 offset:8608
v_mfma_f32_16x16x32_bf16 v[180:183],a[76:79],a[132:135],v[180:183]
s_cmp_eq_u32 s32,7340032
s_cselect_b32 s32,0,s32
s_add_u32 m0,s35,s41
v_mfma_f32_16x16x32_bf16 v[184:187],a[72:75],a[120:123],0
ds_read_b64_tr_b16 a[68:69],v14 offset:23072
s_waitcnt vmcnt(16)
v_mfma_f32_16x16x32_bf16 v[184:187],a[76:79],a[136:139],v[184:187]
ds_read_b128 a[144:147],v12 offset:0
v_mfma_f32_16x16x32_bf16 v[188:191],a[72:75],a[124:127],0
ds_read_b64_tr_b16 a[70:71],v14 offset:23968
v_mfma_f32_16x16x32_bf16 v[188:191],a[76:79],a[140:143],v[188:191]
buffer_load_dwordx4 v8,s[12:15],s32 offen lds
v_mfma_f32_16x16x32_bf16 v[192:195],a[80:83],a[112:115],0
ds_read_b64_tr_b16 a[72:73],v14 offset:7744
v_mfma_f32_16x16x32_bf16 v[192:195],a[84:87],a[128:131],v[192:195]
ds_read_b128 a[160:163],v12 offset:1024
v_mfma_f32_16x16x32_bf16 v[196:199],a[80:83],a[116:119],0
ds_read_b64_tr_b16 a[74:75],v14 offset:8640
v_mfma_f32_16x16x32_bf16 v[196:199],a[84:87],a[132:135],v[196:199]
buffer_load_dwordx4 v9,s[12:15],s32 offen offset:896 lds
v_mfma_f32_16x16x32_bf16 v[200:203],a[80:83],a[120:123],0
ds_read_b64_tr_b16 a[76:77],v14 offset:23104
v_mfma_f32_16x16x32_bf16 v[200:203],a[84:87],a[136:139],v[200:203]
ds_read_b128 a[148:151],v12 offset:2048
v_mfma_f32_16x16x32_bf16 v[204:207],a[80:83],a[124:127],0
ds_read_b64_tr_b16 a[78:79],v14 offset:24000
v_mfma_f32_16x16x32_bf16 v[204:207],a[84:87],a[140:143],v[204:207]
buffer_load_dwordx4 v10,s[12:15],s32 offen offset:1920 lds
v_mfma_f32_16x16x32_bf16 v[208:211],a[88:91],a[112:115],0
ds_read_b64_tr_b16 a[80:81],v14 offset:7776
v_mfma_f32_16x16x32_bf16 v[208:211],a[92:95],a[128:131],v[208:211]
ds_read_b128 a[164:167],v12 offset:3072
v_mfma_f32_16x16x32_bf16 v[212:215],a[88:91],a[116:119],0
ds_read_b64_tr_b16 a[82:83],v14 offset:8672
v_mfma_f32_16x16x32_bf16 v[212:215],a[92:95],a[132:135],v[212:215]
buffer_load_dwordx4 v11,s[12:15],s32 offen offset:2816 lds
s_add_u32 s35,s35,15360
v_mfma_f32_16x16x32_bf16 v[216:219],a[88:91],a[120:123],0
ds_read_b64_tr_b16 a[84:85],v14 offset:23136
v_mfma_f32_16x16x32_bf16 v[216:219],a[92:95],a[136:139],v[216:219]
s_cmp_eq_u32 s35,92160
s_cselect_b32 s35,0,s35
s_add_u32 s32,s32,229376
ds_read_b128 a[152:155],v12 offset:4096
v_mfma_f32_16x16x32_bf16 v[220:223],a[88:91],a[124:127],0
ds_read_b64_tr_b16 a[86:87],v14 offset:24032
v_mfma_f32_16x16x32_bf16 v[220:223],a[92:95],a[140:143],v[220:223]
s_cmp_eq_u32 s32,7340032
s_cselect_b32 s32,0,s32
s_add_u32 m0,s35,s41
v_mfma_f32_16x16x32_bf16 v[224:227],a[96:99],a[112:115],0
ds_read_b64_tr_b16 a[88:89],v14 offset:7808
v_mfma_f32_16x16x32_bf16 v[224:227],a[100:103],a[128:131],v[224:227]
ds_read_b128 a[168:171],v12 offset:5120
v_mfma_f32_16x16x32_bf16 v[228:231],a[96:99],a[116:119],0
ds_read_b64_tr_b16 a[90:91],v14 offset:8704
v_mfma_f32_16x16x32_bf16 v[228:231],a[100:103],a[132:135],v[228:231]
buffer_load_dwordx4 v8,s[12:15],s32 offen lds
v_mfma_f32_16x16x32_bf16 v[232:235],a[96:99],a[120:123],0
ds_read_b64_tr_b16 a[92:93],v14 offset:23168
v_mfma_f32_16x16x32_bf16 v[232:235],a[100:103],a[136:139],v[232:235]
ds_read_b128 a[156:159],v12 offset:6144
v_mfma_f32_16x16x32_bf16 v[236:239],a[96:99],a[124:127],0
ds_read_b64_tr_b16 a[94:95],v14 offset:24064
v_mfma_f32_16x16x32_bf16 v[236:239],a[100:103],a[140:143],v[236:239]
buffer_load_dwordx4 v9,s[12:15],s32 offen offset:896 lds
v_mfma_f32_16x16x32_bf16 v[240:243],a[104:107],a[112:115],0
ds_read_b64_tr_b16 a[96:97],v14 offset:7840
v_mfma_f32_16x16x32_bf16 v[240:243],a[108:111],a[128:131],v[240:243]
ds_read_b128 a[172:175],v12 offset:7168
v_mfma_f32_16x16x32_bf16 v[244:247],a[104:107],a[116:119],0
ds_read_b64_tr_b16 a[98:99],v14 offset:8736
v_mfma_f32_16x16x32_bf16 v[244:247],a[108:111],a[132:135],v[244:247]
buffer_load_dwordx4 v10,s[12:15],s32 offen offset:1920 lds
v_mfma_f32_16x16x32_bf16 v[248:251],a[104:107],a[120:123],0
ds_read_b64_tr_b16 a[100:101],v14 offset:23200
v_mfma_f32_16x16x32_bf16 v[248:251],a[108:111],a[136:139],v[248:251]
buffer_load_dwordx4 v11,s[12:15],s32 offen offset:2816 lds
s_add_u32 s35,s35,15360
v_mfma_f32_16x16x32_bf16 v[252:255],a[104:107],a[124:127],0
ds_read_b64_tr_b16 a[102:103],v14 offset:24096
v_mfma_f32_16x16x32_bf16 v[252:255],a[108:111],a[140:143],v[252:255]
s_cmp_eq_u32 s35,92160
s_cselect_b32 s35,0,s35
s_add_u32 s32,s32,229376
s_cmp_eq_u32 s32,7340032
s_cselect_b32 s32,0,s32
s_waitcnt lgkmcnt(4)
v_mfma_f32_16x16x32_bf16 v[32:35],a[0:3],a[144:147],v[32:35]
ds_read_b64_tr_b16 a[104:105],v14 offset:7872
v_mfma_f32_16x16x32_bf16 v[32:35],a[4:7],a[160:163],v[32:35]
ds_read_b64_tr_b16 a[106:107],v14 offset:8768
v_mfma_f32_16x16x32_bf16 v[36:39],a[0:3],a[148:151],v[36:39]
ds_read_b64_tr_b16 a[108:109],v14 offset:23232
v_mfma_f32_16x16x32_bf16 v[36:39],a[4:7],a[164:167],v[36:39]
ds_read_b64_tr_b16 a[110:111],v14 offset:24128
v_mfma_f32_16x16x32_bf16 v[40:43],a[0:3],a[152:155],v[40:43]
v_add_u32 v14,s43,v14
v_mfma_f32_16x16x32_bf16 v[40:43],a[4:7],a[168:171],v[40:43]
v_xor_b32 v12,32768,v12
v_mfma_f32_16x16x32_bf16 v[44:47],a[0:3],a[156:159],v[44:47]
v_mfma_f32_16x16x32_bf16 v[44:47],a[4:7],a[172:175],v[44:47]
s_waitcnt vmcnt(8) lgkmcnt(0)
s_barrier
v_mfma_f32_16x16x32_bf16 v[48:51],a[8:11],a[144:147],v[48:51]
ds_read_b64_tr_b16 a[0:1],v14 offset:0
s_add_u32 m0,s34,s40
v_mfma_f32_16x16x32_bf16 v[48:51],a[12:15],a[160:163],v[48:51]
buffer_load_dwordx4 v4,s[8:11],s30 offen sc1 lds
s_add_u32 s37,s37,30720
v_mfma_f32_16x16x32_bf16 v[52:55],a[8:11],a[148:151],v[52:55]
ds_read_b64_tr_b16 a[2:3],v14 offset:896
v_mfma_f32_16x16x32_bf16 v[52:55],a[12:15],a[164:167],v[52:55]
s_cmp_eq_u32 s37,92160
s_cselect_b32 s43,s49,s48
s_cselect_b32 s37,0,s37
v_mfma_f32_16x16x32_bf16 v[56:59],a[8:11],a[152:155],v[56:59]
ds_read_b64_tr_b16 a[4:5],v14 offset:15360
v_mfma_f32_16x16x32_bf16 v[56:59],a[12:15],a[168:171],v[56:59]
v_mfma_f32_16x16x32_bf16 v[60:63],a[8:11],a[156:159],v[60:63]
ds_read_b64_tr_b16 a[6:7],v14 offset:16256
v_mfma_f32_16x16x32_bf16 v[60:63],a[12:15],a[172:175],v[60:63]
buffer_load_dwordx4 v4,s[8:11],s30 offen offset:1024 sc1 lds
v_mfma_f32_16x16x32_bf16 v[64:67],a[16:19],a[144:147],v[64:67]
ds_read_b64_tr_b16 a[8:9],v14 offset:32
v_mfma_f32_16x16x32_bf16 v[64:67],a[20:23],a[160:163],v[64:67]
v_mfma_f32_16x16x32_bf16 v[68:71],a[16:19],a[148:151],v[68:71]
ds_read_b64_tr_b16 a[10:11],v14 offset:928
v_mfma_f32_16x16x32_bf16 v[68:71],a[20:23],a[164:167],v[68:71]
v_mfma_f32_16x16x32_bf16 v[72:75],a[16:19],a[152:155],v[72:75]
ds_read_b64_tr_b16 a[12:13],v14 offset:15392
v_mfma_f32_16x16x32_bf16 v[72:75],a[20:23],a[168:171],v[72:75]
buffer_load_dwordx4 v5,s[8:11],s30 offen offset:2048 sc1 lds
v_mfma_f32_16x16x32_bf16 v[76:79],a[16:19],a[156:159],v[76:79]
ds_read_b64_tr_b16 a[14:15],v14 offset:16288
v_mfma_f32_16x16x32_bf16 v[76:79],a[20:23],a[172:175],v[76:79]
v_mfma_f32_16x16x32_bf16 v[80:83],a[24:27],a[144:147],v[80:83]
ds_read_b64_tr_b16 a[16:17],v14 offset:64
v_mfma_f32_16x16x32_bf16 v[80:83],a[28:31],a[160:163],v[80:83]
v_mfma_f32_16x16x32_bf16 v[84:87],a[24:27],a[148:151],v[84:87]
ds_read_b64_tr_b16 a[18:19],v14 offset:960
v_mfma_f32_16x16x32_bf16 v[84:87],a[28:31],a[164:167],v[84:87]
buffer_load_dwordx4 v5,s[8:11],s30 offen offset:3072 sc1 lds
s_add_u32 m0,s34,s52
v_mfma_f32_16x16x32_bf16 v[88:91],a[24:27],a[152:155],v[88:91]
ds_read_b64_tr_b16 a[20:21],v14 offset:15424
v_mfma_f32_16x16x32_bf16 v[88:91],a[28:31],a[168:171],v[88:91]
v_mfma_f32_16x16x32_bf16 v[92:95],a[24:27],a[156:159],v[92:95]
ds_read_b64_tr_b16 a[22:23],v14 offset:16320
v_mfma_f32_16x16x32_bf16 v[92:95],a[28:31],a[172:175],v[92:95]
v_mfma_f32_16x16x32_bf16 v[96:99],a[32:35],a[144:147],v[96:99]
ds_read_b64_tr_b16 a[24:25],v14 offset:96
v_mfma_f32_16x16x32_bf16 v[96:99],a[36:39],a[160:163],v[96:99]
buffer_load_dwordx4 v4,s[8:11],s31 offen sc1 lds
v_mfma_f32_16x16x32_bf16 v[100:103],a[32:35],a[148:151],v[100:103]
ds_read_b64_tr_b16 a[26:27],v14 offset:992
v_mfma_f32_16x16x32_bf16 v[100:103],a[36:39],a[164:167],v[100:103]
v_mfma_f32_16x16x32_bf16 v[104:107],a[32:35],a[152:155],v[104:107]
ds_read_b64_tr_b16 a[28:29],v14 offset:15456
v_mfma_f32_16x16x32_bf16 v[104:107],a[36:39],a[168:171],v[104:107]
v_mfma_f32_16x16x32_bf16 v[108:111],a[32:35],a[156:159],v[108:111]
ds_read_b64_tr_b16 a[30:31],v14 offset:16352
v_mfma_f32_16x16x32_bf16 v[108:111],a[36:39],a[172:175],v[108:111]
buffer_load_dwordx4 v4,s[8:11],s31 offen offset:1024 sc1 lds
v_mfma_f32_16x16x32_bf16 v[112:115],a[40:43],a[144:147],v[112:115]
ds_read_b64_tr_b16 a[32:33],v14 offset:128
v_mfma_f32_16x16x32_bf16 v[112:115],a[44:47],a[160:163],v[112:115]
v_mfma_f32_16x16x32_bf16 v[116:119],a[40:43],a[148:151],v[116:119]
ds_read_b64_tr_b16 a[34:35],v14 offset:1024
v_mfma_f32_16x16x32_bf16 v[116:119],a[44:47],a[164:167],v[116:119]
v_mfma_f32_16x16x32_bf16 v[120:123],a[40:43],a[152:155],v[120:123]
ds_read_b64_tr_b16 a[36:37],v14 offset:15488
v_mfma_f32_16x16x32_bf16 v[120:123],a[44:47],a[168:171],v[120:123]
buffer_load_dwordx4 v5,s[8:11],s31 offen offset:2048 sc1 lds
v_mfma_f32_16x16x32_bf16 v[124:127],a[40:43],a[156:159],v[124:127]
ds_read_b64_tr_b16 a[38:39],v14 offset:16384
v_mfma_f32_16x16x32_bf16 v[124:127],a[44:47],a[172:175],v[124:127]
v_mfma_f32_16x16x32_bf16 v[128:131],a[48:51],a[144:147],v[128:131]
ds_read_b64_tr_b16 a[40:41],v14 offset:160
v_mfma_f32_16x16x32_bf16 v[128:131],a[52:55],a[160:163],v[128:131]
v_mfma_f32_16x16x32_bf16 v[132:135],a[48:51],a[148:151],v[132:135]
ds_read_b64_tr_b16 a[42:43],v14 offset:1056
v_mfma_f32_16x16x32_bf16 v[132:135],a[52:55],a[164:167],v[132:135]
buffer_load_dwordx4 v5,s[8:11],s31 offen offset:3072 sc1 lds
s_add_u32 s30,s30,2048
v_mfma_f32_16x16x32_bf16 v[136:139],a[48:51],a[152:155],v[136:139]
ds_read_b64_tr_b16 a[44:45],v14 offset:15520
s_and_b32 s30,s30,0x7fff
v_mfma_f32_16x16x32_bf16 v[136:139],a[52:55],a[168:171],v[136:139]
s_add_u32 s34,s34,32768
s_cmp_eq_u32 s34,65536
s_cselect_b32 s34,0,s34
v_mfma_f32_16x16x32_bf16 v[140:143],a[48:51],a[156:159],v[140:143]
ds_read_b64_tr_b16 a[46:47],v14 offset:16416
s_add_u32 s31,s30,65536
v_mfma_f32_16x16x32_bf16 v[140:143],a[52:55],a[172:175],v[140:143]
s_add_u32 m0,s35,s41
v_mfma_f32_16x16x32_bf16 v[144:147],a[56:59],a[144:147],v[144:147]
ds_read_b64_tr_b16 a[48:49],v14 offset:192
v_mfma_f32_16x16x32_bf16 v[144:147],a[60:63],a[160:163],v[144:147]
v_mfma_f32_16x16x32_bf16 v[148:151],a[56:59],a[148:151],v[148:151]
ds_read_b64_tr_b16 a[50:51],v14 offset:1088
v_mfma_f32_16x16x32_bf16 v[148:151],a[60:63],a[164:167],v[148:151]
buffer_load_dwordx4 v8,s[12:15],s32 offen lds
v_mfma_f32_16x16x32_bf16 v[152:155],a[56:59],a[152:155],v[152:155]
ds_read_b64_tr_b16 a[52:53],v14 offset:15552
v_mfma_f32_16x16x32_bf16 v[152:155],a[60:63],a[168:171],v[152:155]
v_mfma_f32_16x16x32_bf16 v[156:159],a[56:59],a[156:159],v[156:159]
ds_read_b64_tr_b16 a[54:55],v14 offset:16448
v_mfma_f32_16x16x32_bf16 v[156:159],a[60:63],a[172:175],v[156:159]
v_mfma_f32_16x16x32_bf16 v[160:163],a[64:67],a[144:147],v[160:163]
ds_read_b64_tr_b16 a[56:57],v14 offset:7680
v_mfma_f32_16x16x32_bf16 v[160:163],a[68:71],a[160:163],v[160:163]
buffer_load_dwordx4 v9,s[12:15],s32 offen offset:896 lds
v_mfma_f32_16x16x32_bf16 v[164:167],a[64:67],a[148:151],v[164:167]
ds_read_b64_tr_b16 a[58:59],v14 offset:8576
v_mfma_f32_16x16x32_bf16 v[164:167],a[68:71],a[164:167],v[164:167]
v_mfma_f32_16x16x32_bf16 v[168:171],a[64:67],a[152:155],v[168:171]
ds_read_b64_tr_b16 a[60:61],v14 offset:23040
v_mfma_f32_16x16x32_bf16 v[168:171],a[68:71],a[168:171],v[168:171]
v_mfma_f32_16x16x32_bf16 v[172:175],a[64:67],a[156:159],v[172:175]
ds_read_b64_tr_b16 a[62:63],v14 offset:23936
v_mfma_f32_16x16x32_bf16 v[172:175],a[68:71],a[172:175],v[172:175]
buffer_load_dwordx4 v10,s[12:15],s32 offen offset:1920 lds
v_mfma_f32_16x16x32_bf16 v[176:179],a[72:75],a[144:147],v[176:179]
ds_read_b64_tr_b16 a[64:65],v14 offset:7712
v_mfma_f32_16x16x32_bf16 v[176:179],a[76:79],a[160:163],v[176:179]
v_mfma_f32_16x16x32_bf16 v[180:183],a[72:75],a[148:151],v[180:183]
ds_read_b64_tr_b16 a[66:67],v14 offset:8608
v_mfma_f32_16x16x32_bf16 v[180:183],a[76:79],a[164:167],v[180:183]
v_mfma_f32_16x16x32_bf16 v[184:187],a[72:75],a[152:155],v[184:187]
ds_read_b64_tr_b16 a[68:69],v14 offset:23072
s_waitcnt vmcnt(19)
v_mfma_f32_16x16x32_bf16 v[184:187],a[76:79],a[168:171],v[184:187]
ds_read_b128 a[112:115],v12 offset:0
v_mfma_f32_16x16x32_bf16 v[188:191],a[72:75],a[156:159],v[188:191]
ds_read_b64_tr_b16 a[70:71],v14 offset:23968
v_mfma_f32_16x16x32_bf16 v[188:191],a[76:79],a[172:175],v[188:191]
buffer_load_dwordx4 v11,s[12:15],s32 offen offset:2816 lds
s_add_u32 s35,s35,15360
v_mfma_f32_16x16x32_bf16 v[192:195],a[80:83],a[144:147],v[192:195]
ds_read_b64_tr_b16 a[72:73],v14 offset:7744
v_mfma_f32_16x16x32_bf16 v[192:195],a[84:87],a[160:163],v[192:195]
s_cmp_eq_u32 s35,92160
s_cselect_b32 s35,0,s35
s_add_u32 s32,s32,229376
ds_read_b128 a[128:131],v12 offset:1024
v_mfma_f32_16x16x32_bf16 v[196:199],a[80:83],a[148:151],v[196:199]
ds_read_b64_tr_b16 a[74:75],v14 offset:8640
v_mfma_f32_16x16x32_bf16 v[196:199],a[84:87],a[164:167],v[196:199]
s_cmp_eq_u32 s32,7340032
s_cselect_b32 s32,0,s32
s_add_u32 m0,s35,s41
v_mfma_f32_16x16x32_bf16 v[200:203],a[80:83],a[152:155],v[200:203]
ds_read_b64_tr_b16 a[76:77],v14 offset:23104
v_mfma_f32_16x16x32_bf16 v[200:203],a[84:87],a[168:171],v[200:203]
ds_read_b128 a[116:119],v12 offset:2048
v_mfma_f32_16x16x32_bf16 v[204:207],a[80:83],a[156:159],v[204:207]
ds_read_b64_tr_b16 a[78:79],v14 offset:24000
v_mfma_f32_16x16x32_bf16 v[204:207],a[84:87],a[172:175],v[204:207]
buffer_load_dwordx4 v8,s[12:15],s32 offen lds
v_mfma_f32_16x16x32_bf16 v[208:211],a[88:91],a[144:147],v[208:211]
ds_read_b64_tr_b16 a[80:81],v14 offset:7776
v_mfma_f32_16x16x32_bf16 v[208:211],a[92:95],a[160:163],v[208:211]
ds_read_b128 a[132:135],v12 offset:3072
v_mfma_f32_16x16x32_bf16 v[212:215],a[88:91],a[148:151],v[212:215]
ds_read_b64_tr_b16 a[82:83],v14 offset:8672
v_mfma_f32_16x16x32_bf16 v[212:215],a[92:95],a[164:167],v[212:215]
buffer_load_dwordx4 v9,s[12:15],s32 offen offset:896 lds
v_mfma_f32_16x16x32_bf16 v[216:219],a[88:91],a[152:155],v[216:219]
ds_read_b64_tr_b16 a[84:85],v14 offset:23136
v_mfma_f32_16x16x32_bf16 v[216:219],a[92:95],a[168:171],v[216:219]
ds_read_b128 a[120:123],v12 offset:4096
v_mfma_f32_16x16x32_bf16 v[220:223],a[88:91],a[156:159],v[220:223]
ds_read_b64_tr_b16 a[86:87],v14 offset:24032
v_mfma_f32_16x16x32_bf16 v[220:223],a[92:95],a[172:175],v[220:223]
buffer_load_dwordx4 v10,s[12:15],s32 offen offset:1920 lds
v_mfma_f32_16x16x32_bf16 v[224:227],a[96:99],a[144:147],v[224:227]
ds_read_b64_tr_b16 a[88:89],v14 offset:7808
v_mfma_f32_16x16x32_bf16 v[224:227],a[100:103],a[160:163],v[224:227]
ds_read_b128 a[136:139],v12 offset:5120
v_mfma_f32_16x16x32_bf16 v[228:231],a[96:99],a[148:151],v[228:231]
ds_read_b64_tr_b16 a[90:91],v14 offset:8704
v_mfma_f32_16x16x32_bf16 v[228:231],a[100:103],a[164:167],v[228:231]
v_mfma_f32_16x16x32_bf16 v[232:235],a[96:99],a[152:155],v[232:235]
ds_read_b64_tr_b16 a[92:93],v14 offset:23168
v_mfma_f32_16x16x32_bf16 v[232:235],a[100:103],a[168:171],v[232:235]
ds_read_b128 a[124:127],v12 offset:6144
v_mfma_f32_16x16x32_bf16 v[236:239],a[96:99],a[156:159],v[236:239]
ds_read_b64_tr_b16 a[94:95],v14 offset:24064
v_mfma_f32_16x16x32_bf16 v[236:239],a[100:103],a[172:175],v[236:239]
buffer_load_dwordx4 v11,s[12:15],s32 offen offset:2816 lds
s_add_u32 s35,s35,15360
v_mfma_f32_16x16x32_bf16 v[240:243],a[104:107],a[144:147],v[240:243]
ds_read_b64_tr_b16 a[96:97],v14 offset:7840
v_mfma_f32_16x16x32_bf16 v[240:243],a[108:111],a[160:163],v[240:243]
s_cmp_eq_u32 s35,92160
s_cselect_b32 s35,0,s35
s_add_u32 s32,s32,229376
ds_read_b128 a[140:143],v12 offset:7168
v_mfma_f32_16x16x32_bf16 v[244:247],a[104:107],a[148:151],v[244:247]
ds_read_b64_tr_b16 a[98:99],v14 offset:8736
v_mfma_f32_16x16x32_bf16 v[244:247],a[108:111],a[164:167],v[244:247]
s_cmp_eq_u32 s32,7340032
s_cselect_b32 s32,0,s32
v_mfma_f32_16x16x32_bf16 v[248:251],a[104:107],a[152:155],v[248:251]
ds_read_b64_tr_b16 a[100:101],v14 offset:23200
v_mfma_f32_16x16x32_bf16 v[248:251],a[108:111],a[168:171],v[248:251]
v_mfma_f32_16x16x32_bf16 v[252:255],a[104:107],a[156:159],v[252:255]
ds_read_b64_tr_b16 a[102:103],v14 offset:24096
v_mfma_f32_16x16x32_bf16 v[252:255],a[108:111],a[172:175],v[252:255]
s_mov_b32 s38,5
Lp3L203_0:
s_waitcnt lgkmcnt(4)
v_mfma_f32_16x16x32_bf16 v[32:35],a[0:3],a[112:115],v[32:35]
ds_read_b64_tr_b16 a[104:105],v14 offset:7872
v_mfma_f32_16x16x32_bf16 v[32:35],a[4:7],a[128:131],v[32:35]
ds_read_b64_tr_b16 a[106:107],v14 offset:8768
v_mfma_f32_16x16x32_bf16 v[36:39],a[0:3],a[116:119],v[36:39]
ds_read_b64_tr_b16 a[108:109],v14 offset:23232
v_mfma_f32_16x16x32_bf16 v[36:39],a[4:7],a[132:135],v[36:39]
ds_read_b64_tr_b16 a[110:111],v14 offset:24128
v_mfma_f32_16x16x32_bf16 v[40:43],a[0:3],a[120:123],v[40:43]
v_add_u32 v14,s43,v14
v_mfma_f32_16x16x32_bf16 v[40:43],a[4:7],a[136:139],v[40:43]
v_xor_b32 v12,32768,v12
v_mfma_f32_16x16x32_bf16 v[44:47],a[0:3],a[124:127],v[44:47]
v_mfma_f32_16x16x32_bf16 v[44:47],a[4:7],a[140:143],v[44:47]
s_waitcnt vmcnt(16) lgkmcnt(0)
s_barrier
v_mfma_f32_16x16x32_bf16 v[48:51],a[8:11],a[112:115],v[48:51]
ds_read_b64_tr_b16 a[0:1],v14 offset:0
s_add_u32 m0,s34,s40
v_mfma_f32_16x16x32_bf16 v[48:51],a[12:15],a[128:131],v[48:51]
buffer_load_dwordx4 v4,s[8:11],s30 offen sc1 lds
s_add_u32 s37,s37,30720
v_mfma_f32_16x16x32_bf16 v[52:55],a[8:11],a[116:119],v[52:55]
ds_read_b64_tr_b16 a[2:3],v14 offset:896
v_mfma_f32_16x16x32_bf16 v[52:55],a[12:15],a[132:135],v[52:55]
s_cmp_eq_u32 s37,92160
s_cselect_b32 s43,s49,s48
s_cselect_b32 s37,0,s37
v_mfma_f32_16x16x32_bf16 v[56:59],a[8:11],a[120:123],v[56:59]
ds_read_b64_tr_b16 a[4:5],v14 offset:15360
v_mfma_f32_16x16x32_bf16 v[56:59],a[12:15],a[136:139],v[56:59]
v_mfma_f32_16x16x32_bf16 v[60:63],a[8:11],a[124:127],v[60:63]
ds_read_b64_tr_b16 a[6:7],v14 offset:16256
v_mfma_f32_16x16x32_bf16 v[60:63],a[12:15],a[140:143],v[60:63]
buffer_load_dwordx4 v4,s[8:11],s30 offen offset:1024 sc1 lds
v_mfma_f32_16x16x32_bf16 v[64:67],a[16:19],a[112:115],v[64:67]
ds_read_b64_tr_b16 a[8:9],v14 offset:32
v_mfma_f32_16x16x32_bf16 v[64:67],a[20:23],a[128:131],v[64:67]
v_mfma_f32_16x16x32_bf16 v[68:71],a[16:19],a[116:119],v[68:71]
ds_read_b64_tr_b16 a[10:11],v14 offset:928
v_mfma_f32_16x16x32_bf16 v[68:71],a[20:23],a[132:135],v[68:71]
v_mfma_f32_16x16x32_bf16 v[72:75],a[16:19],a[120:123],v[72:75]
ds_read_b64_tr_b16 a[12:13],v14 offset:15392
v_mfma_f32_16x16x32_bf16 v[72:75],a[20:23],a[136:139],v[72:75]
buffer_load_dwordx4 v5,s[8:11],s30 offen offset:2048 sc1 lds
v_mfma_f32_16x16x32_bf16 v[76:79],a[16:19],a[124:127],v[76:79]
ds_read_b64_tr_b16 a[14:15],v14 offset:16288
v_mfma_f32_16x16x32_bf16 v[76:79],a[20:23],a[140:143],v[76:79]
v_mfma_f32_16x16x32_bf16 v[80:83],a[24:27],a[112:115],v[80:83]
ds_read_b64_tr_b16 a[16:17],v14 offset:64
v_mfma_f32_16x16x32_bf16 v[80:83],a[28:31],a[128:131],v[80:83]
v_mfma_f32_16x16x32_bf16 v[84:87],a[24:27],a[116:119],v[84:87]
ds_read_b64_tr_b16 a[18:19],v14 offset:960
v_mfma_f32_16x16x32_bf16 v[84:87],a[28:31],a[132:135],v[84:87]
buffer_load_dwordx4 v5,s[8:11],s30 offen offset:3072 sc1 lds
s_add_u32 m0,s34,s52
v_mfma_f32_16x16x32_bf16 v[88:91],a[24:27],a[120:123],v[88:91]
ds_read_b64_tr_b16 a[20:21],v14 offset:15424
v_mfma_f32_16x16x32_bf16 v[88:91],a[28:31],a[136:139],v[88:91]
v_mfma_f32_16x16x32_bf16 v[92:95],a[24:27],a[124:127],v[92:95]
ds_read_b64_tr_b16 a[22:23],v14 offset:16320
v_mfma_f32_16x16x32_bf16 v[92:95],a[28:31],a[140:143],v[92:95]
v_mfma_f32_16x16x32_bf16 v[96:99],a[32:35],a[112:115],v[96:99]
ds_read_b64_tr_b16 a[24:25],v14 offset:96
v_mfma_f32_16x16x32_bf16 v[96:99],a[36:39],a[128:131],v[96:99]
buffer_load_dwordx4 v4,s[8:11],s31 offen sc1 lds
v_mfma_f32_16x16x32_bf16 v[100:103],a[32:35],a[116:119],v[100:103]
ds_read_b64_tr_b16 a[26:27],v14 offset:992
v_mfma_f32_16x16x32_bf16 v[100:103],a[36:39],a[132:135],v[100:103]
v_mfma_f32_16x16x32_bf16 v[104:107],a[32:35],a[120:123],v[104:107]
ds_read_b64_tr_b16 a[28:29],v14 offset:15456
v_mfma_f32_16x16x32_bf16 v[104:107],a[36:39],a[136:139],v[104:107]
v_mfma_f32_16x16x32_bf16 v[108:111],a[32:35],a[124:127],v[108:111]
ds_read_b64_tr_b16 a[30:31],v14 offset:16352
v_mfma_f32_16x16x32_bf16 v[108:111],a[36:39],a[140:143],v[108:111]
buffer_load_dwordx4 v4,s[8:11],s31 offen offset:1024 sc1 lds
v_mfma_f32_16x16x32_bf16 v[112:115],a[40:43],a[112:115],v[112:115]
ds_read_b64_tr_b16 a[32:33],v14 offset:128
v_mfma_f32_16x16x32_bf16 v[112:115],a[44:47],a[128:131],v[112:115]
v_mfma_f32_16x16x32_bf16 v[116:119],a[40:43],a[116:119],v[116:119]
ds_read_b64_tr_b16 a[34:35],v14 offset:1024
v_mfma_f32_16x16x32_bf16 v[116:119],a[44:47],a[132:135],v[116:119]
v_mfma_f32_16x16x32_bf16 v[120:123],a[40:43],a[120:123],v[120:123]
ds_read_b64_tr_b16 a[36:37],v14 offset:15488
v_mfma_f32_16x16x32_bf16 v[120:123],a[44:47],a[136:139],v[120:123]
buffer_load_dwordx4 v5,s[8:11],s31 offen offset:2048 sc1 lds
v_mfma_f32_16x16x32_bf16 v[124:127],a[40:43],a[124:127],v[124:127]
ds_read_b64_tr_b16 a[38:39],v14 offset:16384
v_mfma_f32_16x16x32_bf16 v[124:127],a[44:47],a[140:143],v[124:127]
v_mfma_f32_16x16x32_bf16 v[128:131],a[48:51],a[112:115],v[128:131]
ds_read_b64_tr_b16 a[40:41],v14 offset:160
v_mfma_f32_16x16x32_bf16 v[128:131],a[52:55],a[128:131],v[128:131]
v_mfma_f32_16x16x32_bf16 v[132:135],a[48:51],a[116:119],v[132:135]
ds_read_b64_tr_b16 a[42:43],v14 offset:1056
v_mfma_f32_16x16x32_bf16 v[132:135],a[52:55],a[132:135],v[132:135]
buffer_load_dwordx4 v5,s[8:11],s31 offen offset:3072 sc1 lds
s_add_u32 s30,s30,2048
v_mfma_f32_16x16x32_bf16 v[136:139],a[48:51],a[120:123],v[136:139]
ds_read_b64_tr_b16 a[44:45],v14 offset:15520
s_and_b32 s30,s30,0x7fff
v_mfma_f32_16x16x32_bf16 v[136:139],a[52:55],a[136:139],v[136:139]
s_add_u32 s34,s34,32768
s_cmp_eq_u32 s34,65536
s_cselect_b32 s34,0,s34
v_mfma_f32_16x16x32_bf16 v[140:143],a[48:51],a[124:127],v[140:143]
ds_read_b64_tr_b16 a[46:47],v14 offset:16416
s_add_u32 s31,s30,65536
v_mfma_f32_16x16x32_bf16 v[140:143],a[52:55],a[140:143],v[140:143]
s_add_u32 m0,s35,s41
v_mfma_f32_16x16x32_bf16 v[144:147],a[56:59],a[112:115],v[144:147]
ds_read_b64_tr_b16 a[48:49],v14 offset:192
v_mfma_f32_16x16x32_bf16 v[144:147],a[60:63],a[128:131],v[144:147]
v_mfma_f32_16x16x32_bf16 v[148:151],a[56:59],a[116:119],v[148:151]
ds_read_b64_tr_b16 a[50:51],v14 offset:1088
v_mfma_f32_16x16x32_bf16 v[148:151],a[60:63],a[132:135],v[148:151]
buffer_load_dwordx4 v8,s[12:15],s32 offen lds
v_mfma_f32_16x16x32_bf16 v[152:155],a[56:59],a[120:123],v[152:155]
ds_read_b64_tr_b16 a[52:53],v14 offset:15552
v_mfma_f32_16x16x32_bf16 v[152:155],a[60:63],a[136:139],v[152:155]
v_mfma_f32_16x16x32_bf16 v[156:159],a[56:59],a[124:127],v[156:159]
ds_read_b64_tr_b16 a[54:55],v14 offset:16448
v_mfma_f32_16x16x32_bf16 v[156:159],a[60:63],a[140:143],v[156:159]
v_mfma_f32_16x16x32_bf16 v[160:163],a[64:67],a[112:115],v[160:163]
ds_read_b64_tr_b16 a[56:57],v14 offset:7680
v_mfma_f32_16x16x32_bf16 v[160:163],a[68:71],a[128:131],v[160:163]
buffer_load_dwordx4 v9,s[12:15],s32 offen offset:896 lds
v_mfma_f32_16x16x32_bf16 v[164:167],a[64:67],a[116:119],v[164:167]
ds_read_b64_tr_b16 a[58:59],v14 offset:8576
v_mfma_f32_16x16x32_bf16 v[164:167],a[68:71],a[132:135],v[164:167]
v_mfma_f32_16x16x32_bf16 v[168:171],a[64:67],a[120:123],v[168:171]
ds_read_b64_tr_b16 a[60:61],v14 offset:23040
v_mfma_f32_16x16x32_bf16 v[168:171],a[68:71],a[136:139],v[168:171]
v_mfma_f32_16x16x32_bf16 v[172:175],a[64:67],a[124:127],v[172:175]
ds_read_b64_tr_b16 a[62:63],v14 offset:23936
v_mfma_f32_16x16x32_bf16 v[172:175],a[68:71],a[140:143],v[172:175]
buffer_load_dwordx4 v10,s[12:15],s32 offen offset:1920 lds
v_mfma_f32_16x16x32_bf16 v[176:179],a[72:75],a[112:115],v[176:179]
ds_read_b64_tr_b16 a[64:65],v14 offset:7712
v_mfma_f32_16x16x32_bf16 v[176:179],a[76:79],a[128:131],v[176:179]
v_mfma_f32_16x16x32_bf16 v[180:183],a[72:75],a[116:119],v[180:183]
ds_read_b64_tr_b16 a[66:67],v14 offset:8608
v_mfma_f32_16x16x32_bf16 v[180:183],a[76:79],a[132:135],v[180:183]
v_mfma_f32_16x16x32_bf16 v[184:187],a[72:75],a[120:123],v[184:187]
ds_read_b64_tr_b16 a[68:69],v14 offset:23072
s_waitcnt vmcnt(19)
v_mfma_f32_16x16x32_bf16 v[184:187],a[76:79],a[136:139],v[184:187]
ds_read_b128 a[144:147],v12 offset:0
v_mfma_f32_16x16x32_bf16 v[188:191],a[72:75],a[124:127],v[188:191]
ds_read_b64_tr_b16 a[70:71],v14 offset:23968
v_mfma_f32_16x16x32_bf16 v[188:191],a[76:79],a[140:143],v[188:191]
buffer_load_dwordx4 v11,s[12:15],s32 offen offset:2816 lds
s_add_u32 s35,s35,15360
v_mfma_f32_16x16x32_bf16 v[192:195],a[80:83],a[112:115],v[192:195]
ds_read_b64_tr_b16 a[72:73],v14 offset:7744
v_mfma_f32_16x16x32_bf16 v[192:195],a[84:87],a[128:131],v[192:195]
s_cmp_eq_u32 s35,92160
s_cselect_b32 s35,0,s35
s_add_u32 s32,s32,229376
ds_read_b128 a[160:163],v12 offset:1024
v_mfma_f32_16x16x32_bf16 v[196:199],a[80:83],a[116:119],v[196:199]
ds_read_b64_tr_b16 a[74:75],v14 offset:8640
v_mfma_f32_16x16x32_bf16 v[196:199],a[84:87],a[132:135],v[196:199]
s_cmp_eq_u32 s32,7340032
s_cselect_b32 s32,0,s32
s_add_u32 m0,s35,s41
v_mfma_f32_16x16x32_bf16 v[200:203],a[80:83],a[120:123],v[200:203]
ds_read_b64_tr_b16 a[76:77],v14 offset:23104
v_mfma_f32_16x16x32_bf16 v[200:203],a[84:87],a[136:139],v[200:203]
ds_read_b128 a[148:151],v12 offset:2048
v_mfma_f32_16x16x32_bf16 v[204:207],a[80:83],a[124:127],v[204:207]
ds_read_b64_tr_b16 a[78:79],v14 offset:24000
v_mfma_f32_16x16x32_bf16 v[204:207],a[84:87],a[140:143],v[204:207]
buffer_load_dwordx4 v8,s[12:15],s32 offen lds
v_mfma_f32_16x16x32_bf16 v[208:211],a[88:91],a[112:115],v[208:211]
ds_read_b64_tr_b16 a[80:81],v14 offset:7776
v_mfma_f32_16x16x32_bf16 v[208:211],a[92:95],a[128:131],v[208:211]
ds_read_b128 a[164:167],v12 offset:3072
v_mfma_f32_16x16x32_bf16 v[212:215],a[88:91],a[116:119],v[212:215]
ds_read_b64_tr_b16 a[82:83],v14 offset:8672
v_mfma_f32_16x16x32_bf16 v[212:215],a[92:95],a[132:135],v[212:215]
buffer_load_dwordx4 v9,s[12:15],s32 offen offset:896 lds
v_mfma_f32_16x16x32_bf16 v[216:219],a[88:91],a[120:123],v[216:219]
ds_read_b64_tr_b16 a[84:85],v14 offset:23136
v_mfma_f32_16x16x32_bf16 v[216:219],a[92:95],a[136:139],v[216:219]
ds_read_b128 a[152:155],v12 offset:4096
v_mfma_f32_16x16x32_bf16 v[220:223],a[88:91],a[124:127],v[220:223]
ds_read_b64_tr_b16 a[86:87],v14 offset:24032
v_mfma_f32_16x16x32_bf16 v[220:223],a[92:95],a[140:143],v[220:223]
buffer_load_dwordx4 v10,s[12:15],s32 offen offset:1920 lds
v_mfma_f32_16x16x32_bf16 v[224:227],a[96:99],a[112:115],v[224:227]
ds_read_b64_tr_b16 a[88:89],v14 offset:7808
v_mfma_f32_16x16x32_bf16 v[224:227],a[100:103],a[128:131],v[224:227]
ds_read_b128 a[168:171],v12 offset:5120
v_mfma_f32_16x16x32_bf16 v[228:231],a[96:99],a[116:119],v[228:231]
ds_read_b64_tr_b16 a[90:91],v14 offset:8704
v_mfma_f32_16x16x32_bf16 v[228:231],a[100:103],a[132:135],v[228:231]
v_mfma_f32_16x16x32_bf16 v[232:235],a[96:99],a[120:123],v[232:235]
ds_read_b64_tr_b16 a[92:93],v14 offset:23168
v_mfma_f32_16x16x32_bf16 v[232:235],a[100:103],a[136:139],v[232:235]
ds_read_b128 a[156:159],v12 offset:6144
v_mfma_f32_16x16x32_bf16 v[236:239],a[96:99],a[124:127],v[236:239]
ds_read_b64_tr_b16 a[94:95],v14 offset:24064
v_mfma_f32_16x16x32_bf16 v[236:239],a[100:103],a[140:143],v[236:239]
buffer_load_dwordx4 v11,s[12:15],s32 offen offset:2816 lds
s_add_u32 s35,s35,15360
v_mfma_f32_16x16x32_bf16 v[240:243],a[104:107],a[112:115],v[240:243]
ds_read_b64_tr_b16 a[96:97],v14 offset:7840
v_mfma_f32_16x16x32_bf16 v[240:243],a[108:111],a[128:131],v[240:243]
s_cmp_eq_u32 s35,92160
s_cselect_b32 s35,0,s35
s_add_u32 s32,s32,229376
ds_read_b128 a[172:175],v12 offset:7168
v_mfma_f32_16x16x32_bf16 v[244:247],a[104:107],a[116:119],v[244:247]
ds_read_b64_tr_b16 a[98:99],v14 offset:8736
v_mfma_f32_16x16x32_bf16 v[244:247],a[108:111],a[132:135],v[244:247]
s_cmp_eq_u32 s32,7340032
s_cselect_b32 s32,0,s32
v_mfma_f32_16x16x32_bf16 v[248:251],a[104:107],a[120:123],v[248:251]
ds_read_b64_tr_b16 a[100:101],v14 offset:23200
v_mfma_f32_16x16x32_bf16 v[248:251],a[108:111],a[136:139],v[248:251]
v_mfma_f32_16x16x32_bf16 v[252:255],a[104:107],a[124:127],v[252:255]
ds_read_b64_tr_b16 a[102:103],v14 offset:24096
v_mfma_f32_16x16x32_bf16 v[252:255],a[108:111],a[140:143],v[252:255]
s_waitcnt lgkmcnt(4)
v_mfma_f32_16x16x32_bf16 v[32:35],a[0:3],a[144:147],v[32:35]
ds_read_b64_tr_b16 a[104:105],v14 offset:7872
v_mfma_f32_16x16x32_bf16 v[32:35],a[4:7],a[160:163],v[32:35]
ds_read_b64_tr_b16 a[106:107],v14 offset:8768
v_mfma_f32_16x16x32_bf16 v[36:39],a[0:3],a[148:151],v[36:39]
ds_read_b64_tr_b16 a[108:109],v14 offset:23232
v_mfma_f32_16x16x32_bf16 v[36:39],a[4:7],a[164:167],v[36:39]
ds_read_b64_tr_b16 a[110:111],v14 offset:24128
v_mfma_f32_16x16x32_bf16 v[40:43],a[0:3],a[152:155],v[40:43]
v_add_u32 v14,s43,v14
v_mfma_f32_16x16x32_bf16 v[40:43],a[4:7],a[168:171],v[40:43]
v_xor_b32 v12,32768,v12
v_mfma_f32_16x16x32_bf16 v[44:47],a[0:3],a[156:159],v[44:47]
v_mfma_f32_16x16x32_bf16 v[44:47],a[4:7],a[172:175],v[44:47]
s_waitcnt vmcnt(16) lgkmcnt(0)
s_barrier
v_mfma_f32_16x16x32_bf16 v[48:51],a[8:11],a[144:147],v[48:51]
ds_read_b64_tr_b16 a[0:1],v14 offset:0
s_add_u32 m0,s34,s40
v_mfma_f32_16x16x32_bf16 v[48:51],a[12:15],a[160:163],v[48:51]
buffer_load_dwordx4 v4,s[8:11],s30 offen sc1 lds
s_add_u32 s37,s37,30720
v_mfma_f32_16x16x32_bf16 v[52:55],a[8:11],a[148:151],v[52:55]
ds_read_b64_tr_b16 a[2:3],v14 offset:896
v_mfma_f32_16x16x32_bf16 v[52:55],a[12:15],a[164:167],v[52:55]
s_cmp_eq_u32 s37,92160
s_cselect_b32 s43,s49,s48
s_cselect_b32 s37,0,s37
v_mfma_f32_16x16x32_bf16 v[56:59],a[8:11],a[152:155],v[56:59]
ds_read_b64_tr_b16 a[4:5],v14 offset:15360
v_mfma_f32_16x16x32_bf16 v[56:59],a[12:15],a[168:171],v[56:59]
v_mfma_f32_16x16x32_bf16 v[60:63],a[8:11],a[156:159],v[60:63]
ds_read_b64_tr_b16 a[6:7],v14 offset:16256
v_mfma_f32_16x16x32_bf16 v[60:63],a[12:15],a[172:175],v[60:63]
buffer_load_dwordx4 v4,s[8:11],s30 offen offset:1024 sc1 lds
v_mfma_f32_16x16x32_bf16 v[64:67],a[16:19],a[144:147],v[64:67]
ds_read_b64_tr_b16 a[8:9],v14 offset:32
v_mfma_f32_16x16x32_bf16 v[64:67],a[20:23],a[160:163],v[64:67]
v_mfma_f32_16x16x32_bf16 v[68:71],a[16:19],a[148:151],v[68:71]
ds_read_b64_tr_b16 a[10:11],v14 offset:928
v_mfma_f32_16x16x32_bf16 v[68:71],a[20:23],a[164:167],v[68:71]
v_mfma_f32_16x16x32_bf16 v[72:75],a[16:19],a[152:155],v[72:75]
ds_read_b64_tr_b16 a[12:13],v14 offset:15392
v_mfma_f32_16x16x32_bf16 v[72:75],a[20:23],a[168:171],v[72:75]
buffer_load_dwordx4 v5,s[8:11],s30 offen offset:2048 sc1 lds
v_mfma_f32_16x16x32_bf16 v[76:79],a[16:19],a[156:159],v[76:79]
ds_read_b64_tr_b16 a[14:15],v14 offset:16288
v_mfma_f32_16x16x32_bf16 v[76:79],a[20:23],a[172:175],v[76:79]
v_mfma_f32_16x16x32_bf16 v[80:83],a[24:27],a[144:147],v[80:83]
ds_read_b64_tr_b16 a[16:17],v14 offset:64
v_mfma_f32_16x16x32_bf16 v[80:83],a[28:31],a[160:163],v[80:83]
v_mfma_f32_16x16x32_bf16 v[84:87],a[24:27],a[148:151],v[84:87]
ds_read_b64_tr_b16 a[18:19],v14 offset:960
v_mfma_f32_16x16x32_bf16 v[84:87],a[28:31],a[164:167],v[84:87]
buffer_load_dwordx4 v5,s[8:11],s30 offen offset:3072 sc1 lds
s_add_u32 m0,s34,s52
v_mfma_f32_16x16x32_bf16 v[88:91],a[24:27],a[152:155],v[88:91]
ds_read_b64_tr_b16 a[20:21],v14 offset:15424
v_mfma_f32_16x16x32_bf16 v[88:91],a[28:31],a[168:171],v[88:91]
v_mfma_f32_16x16x32_bf16 v[92:95],a[24:27],a[156:159],v[92:95]
ds_read_b64_tr_b16 a[22:23],v14 offset:16320
v_mfma_f32_16x16x32_bf16 v[92:95],a[28:31],a[172:175],v[92:95]
v_mfma_f32_16x16x32_bf16 v[96:99],a[32:35],a[144:147],v[96:99]
ds_read_b64_tr_b16 a[24:25],v14 offset:96
v_mfma_f32_16x16x32_bf16 v[96:99],a[36:39],a[160:163],v[96:99]
buffer_load_dwordx4 v4,s[8:11],s31 offen sc1 lds
v_mfma_f32_16x16x32_bf16 v[100:103],a[32:35],a[148:151],v[100:103]
ds_read_b64_tr_b16 a[26:27],v14 offset:992
v_mfma_f32_16x16x32_bf16 v[100:103],a[36:39],a[164:167],v[100:103]
v_mfma_f32_16x16x32_bf16 v[104:107],a[32:35],a[152:155],v[104:107]
ds_read_b64_tr_b16 a[28:29],v14 offset:15456
v_mfma_f32_16x16x32_bf16 v[104:107],a[36:39],a[168:171],v[104:107]
v_mfma_f32_16x16x32_bf16 v[108:111],a[32:35],a[156:159],v[108:111]
ds_read_b64_tr_b16 a[30:31],v14 offset:16352
v_mfma_f32_16x16x32_bf16 v[108:111],a[36:39],a[172:175],v[108:111]
buffer_load_dwordx4 v4,s[8:11],s31 offen offset:1024 sc1 lds
v_mfma_f32_16x16x32_bf16 v[112:115],a[40:43],a[144:147],v[112:115]
ds_read_b64_tr_b16 a[32:33],v14 offset:128
v_mfma_f32_16x16x32_bf16 v[112:115],a[44:47],a[160:163],v[112:115]
v_mfma_f32_16x16x32_bf16 v[116:119],a[40:43],a[148:151],v[116:119]
ds_read_b64_tr_b16 a[34:35],v14 offset:1024
v_mfma_f32_16x16x32_bf16 v[116:119],a[44:47],a[164:167],v[116:119]
v_mfma_f32_16x16x32_bf16 v[120:123],a[40:43],a[152:155],v[120:123]
ds_read_b64_tr_b16 a[36:37],v14 offset:15488
v_mfma_f32_16x16x32_bf16 v[120:123],a[44:47],a[168:171],v[120:123]
buffer_load_dwordx4 v5,s[8:11],s31 offen offset:2048 sc1 lds
v_mfma_f32_16x16x32_bf16 v[124:127],a[40:43],a[156:159],v[124:127]
ds_read_b64_tr_b16 a[38:39],v14 offset:16384
v_mfma_f32_16x16x32_bf16 v[124:127],a[44:47],a[172:175],v[124:127]
v_mfma_f32_16x16x32_bf16 v[128:131],a[48:51],a[144:147],v[128:131]
ds_read_b64_tr_b16 a[40:41],v14 offset:160
v_mfma_f32_16x16x32_bf16 v[128:131],a[52:55],a[160:163],v[128:131]
v_mfma_f32_16x16x32_bf16 v[132:135],a[48:51],a[148:151],v[132:135]
ds_read_b64_tr_b16 a[42:43],v14 offset:1056
v_mfma_f32_16x16x32_bf16 v[132:135],a[52:55],a[164:167],v[132:135]
buffer_load_dwordx4 v5,s[8:11],s31 offen offset:3072 sc1 lds
s_add_u32 s30,s30,2048
v_mfma_f32_16x16x32_bf16 v[136:139],a[48:51],a[152:155],v[136:139]
ds_read_b64_tr_b16 a[44:45],v14 offset:15520
s_and_b32 s30,s30,0x7fff
v_mfma_f32_16x16x32_bf16 v[136:139],a[52:55],a[168:171],v[136:139]
s_add_u32 s34,s34,32768
s_cmp_eq_u32 s34,65536
s_cselect_b32 s34,0,s34
v_mfma_f32_16x16x32_bf16 v[140:143],a[48:51],a[156:159],v[140:143]
ds_read_b64_tr_b16 a[46:47],v14 offset:16416
s_add_u32 s31,s30,65536
v_mfma_f32_16x16x32_bf16 v[140:143],a[52:55],a[172:175],v[140:143]
s_add_u32 m0,s35,s41
v_mfma_f32_16x16x32_bf16 v[144:147],a[56:59],a[144:147],v[144:147]
ds_read_b64_tr_b16 a[48:49],v14 offset:192
v_mfma_f32_16x16x32_bf16 v[144:147],a[60:63],a[160:163],v[144:147]
v_mfma_f32_16x16x32_bf16 v[148:151],a[56:59],a[148:151],v[148:151]
ds_read_b64_tr_b16 a[50:51],v14 offset:1088
v_mfma_f32_16x16x32_bf16 v[148:151],a[60:63],a[164:167],v[148:151]
buffer_load_dwordx4 v8,s[12:15],s32 offen lds
v_mfma_f32_16x16x32_bf16 v[152:155],a[56:59],a[152:155],v[152:155]
ds_read_b64_tr_b16 a[52:53],v14 offset:15552
v_mfma_f32_16x16x32_bf16 v[152:155],a[60:63],a[168:171],v[152:155]
v_mfma_f32_16x16x32_bf16 v[156:159],a[56:59],a[156:159],v[156:159]
ds_read_b64_tr_b16 a[54:55],v14 offset:16448
v_mfma_f32_16x16x32_bf16 v[156:159],a[60:63],a[172:175],v[156:159]
v_mfma_f32_16x16x32_bf16 v[160:163],a[64:67],a[144:147],v[160:163]
ds_read_b64_tr_b16 a[56:57],v14 offset:7680
v_mfma_f32_16x16x32_bf16 v[160:163],a[68:71],a[160:163],v[160:163]
buffer_load_dwordx4 v9,s[12:15],s32 offen offset:896 lds
v_mfma_f32_16x16x32_bf16 v[164:167],a[64:67],a[148:151],v[164:167]
ds_read_b64_tr_b16 a[58:59],v14 offset:8576
v_mfma_f32_16x16x32_bf16 v[164:167],a[68:71],a[164:167],v[164:167]
v_mfma_f32_16x16x32_bf16 v[168:171],a[64:67],a[152:155],v[168:171]
ds_read_b64_tr_b16 a[60:61],v14 offset:23040
v_mfma_f32_16x16x32_bf16 v[168:171],a[68:71],a[168:171],v[168:171]
v_mfma_f32_16x16x32_bf16 v[172:175],a[64:67],a[156:159],v[172:175]
ds_read_b64_tr_b16 a[62:63],v14 offset:23936
v_mfma_f32_16x16x32_bf16 v[172:175],a[68:71],a[172:175],v[172:175]
buffer_load_dwordx4 v10,s[12:15],s32 offen offset:1920 lds
v_mfma_f32_16x16x32_bf16 v[176:179],a[72:75],a[144:147],v[176:179]
ds_read_b64_tr_b16 a[64:65],v14 offset:7712
v_mfma_f32_16x16x32_bf16 v[176:179],a[76:79],a[160:163],v[176:179]
v_mfma_f32_16x16x32_bf16 v[180:183],a[72:75],a[148:151],v[180:183]
ds_read_b64_tr_b16 a[66:67],v14 offset:8608
v_mfma_f32_16x16x32_bf16 v[180:183],a[76:79],a[164:167],v[180:183]
v_mfma_f32_16x16x32_bf16 v[184:187],a[72:75],a[152:155],v[184:187]
ds_read_b64_tr_b16 a[68:69],v14 offset:23072
s_waitcnt vmcnt(19)
v_mfma_f32_16x16x32_bf16 v[184:187],a[76:79],a[168:171],v[184:187]
ds_read_b128 a[112:115],v12 offset:0
v_mfma_f32_16x16x32_bf16 v[188:191],a[72:75],a[156:159],v[188:191]
ds_read_b64_tr_b16 a[70:71],v14 offset:23968
v_mfma_f32_16x16x32_bf16 v[188:191],a[76:79],a[172:175],v[188:191]
buffer_load_dwordx4 v11,s[12:15],s32 offen offset:2816 lds
s_add_u32 s35,s35,15360
v_mfma_f32_16x16x32_bf16 v[192:195],a[80:83],a[144:147],v[192:195]
ds_read_b64_tr_b16 a[72:73],v14 offset:7744
v_mfma_f32_16x16x32_bf16 v[192:195],a[84:87],a[160:163],v[192:195]
s_cmp_eq_u32 s35,92160
s_cselect_b32 s35,0,s35
s_add_u32 s32,s32,229376
ds_read_b128 a[128:131],v12 offset:1024
v_mfma_f32_16x16x32_bf16 v[196:199],a[80:83],a[148:151],v[196:199]
ds_read_b64_tr_b16 a[74:75],v14 offset:8640
v_mfma_f32_16x16x32_bf16 v[196:199],a[84:87],a[164:167],v[196:199]
s_cmp_eq_u32 s32,7340032
s_cselect_b32 s32,0,s32
s_add_u32 m0,s35,s41
v_mfma_f32_16x16x32_bf16 v[200:203],a[80:83],a[152:155],v[200:203]
ds_read_b64_tr_b16 a[76:77],v14 offset:23104
v_mfma_f32_16x16x32_bf16 v[200:203],a[84:87],a[168:171],v[200:203]
ds_read_b128 a[116:119],v12 offset:2048
v_mfma_f32_16x16x32_bf16 v[204:207],a[80:83],a[156:159],v[204:207]
ds_read_b64_tr_b16 a[78:79],v14 offset:24000
v_mfma_f32_16x16x32_bf16 v[204:207],a[84:87],a[172:175],v[204:207]
buffer_load_dwordx4 v8,s[12:15],s32 offen lds
v_mfma_f32_16x16x32_bf16 v[208:211],a[88:91],a[144:147],v[208:211]
ds_read_b64_tr_b16 a[80:81],v14 offset:7776
v_mfma_f32_16x16x32_bf16 v[208:211],a[92:95],a[160:163],v[208:211]
ds_read_b128 a[132:135],v12 offset:3072
v_mfma_f32_16x16x32_bf16 v[212:215],a[88:91],a[148:151],v[212:215]
ds_read_b64_tr_b16 a[82:83],v14 offset:8672
v_mfma_f32_16x16x32_bf16 v[212:215],a[92:95],a[164:167],v[212:215]
buffer_load_dwordx4 v9,s[12:15],s32 offen offset:896 lds
v_mfma_f32_16x16x32_bf16 v[216:219],a[88:91],a[152:155],v[216:219]
ds_read_b64_tr_b16 a[84:85],v14 offset:23136
v_mfma_f32_16x16x32_bf16 v[216:219],a[92:95],a[168:171],v[216:219]
ds_read_b128 a[120:123],v12 offset:4096
v_mfma_f32_16x16x32_bf16 v[220:223],a[88:91],a[156:159],v[220:223]
ds_read_b64_tr_b16 a[86:87],v14 offset:24032
v_mfma_f32_16x16x32_bf16 v[220:223],a[92:95],a[172:175],v[220:223]
buffer_load_dwordx4 v10,s[12:15],s32 offen offset:1920 lds
v_mfma_f32_16x16x32_bf16 v[224:227],a[96:99],a[144:147],v[224:227]
ds_read_b64_tr_b16 a[88:89],v14 offset:7808
v_mfma_f32_16x16x32_bf16 v[224:227],a[100:103],a[160:163],v[224:227]
ds_read_b128 a[136:139],v12 offset:5120
v_mfma_f32_16x16x32_bf16 v[228:231],a[96:99],a[148:151],v[228:231]
ds_read_b64_tr_b16 a[90:91],v14 offset:8704
v_mfma_f32_16x16x32_bf16 v[228:231],a[100:103],a[164:167],v[228:231]
v_mfma_f32_16x16x32_bf16 v[232:235],a[96:99],a[152:155],v[232:235]
ds_read_b64_tr_b16 a[92:93],v14 offset:23168
v_mfma_f32_16x16x32_bf16 v[232:235],a[100:103],a[168:171],v[232:235]
ds_read_b128 a[124:127],v12 offset:6144
v_mfma_f32_16x16x32_bf16 v[236:239],a[96:99],a[156:159],v[236:239]
ds_read_b64_tr_b16 a[94:95],v14 offset:24064
v_mfma_f32_16x16x32_bf16 v[236:239],a[100:103],a[172:175],v[236:239]
buffer_load_dwordx4 v11,s[12:15],s32 offen offset:2816 lds
s_add_u32 s35,s35,15360
v_mfma_f32_16x16x32_bf16 v[240:243],a[104:107],a[144:147],v[240:243]
ds_read_b64_tr_b16 a[96:97],v14 offset:7840
v_mfma_f32_16x16x32_bf16 v[240:243],a[108:111],a[160:163],v[240:243]
s_cmp_eq_u32 s35,92160
s_cselect_b32 s35,0,s35
s_add_u32 s32,s32,229376
ds_read_b128 a[140:143],v12 offset:7168
v_mfma_f32_16x16x32_bf16 v[244:247],a[104:107],a[148:151],v[244:247]
ds_read_b64_tr_b16 a[98:99],v14 offset:8736
v_mfma_f32_16x16x32_bf16 v[244:247],a[108:111],a[164:167],v[244:247]
s_cmp_eq_u32 s32,7340032
s_cselect_b32 s32,0,s32
v_mfma_f32_16x16x32_bf16 v[248:251],a[104:107],a[152:155],v[248:251]
ds_read_b64_tr_b16 a[100:101],v14 offset:23200
v_mfma_f32_16x16x32_bf16 v[248:251],a[108:111],a[168:171],v[248:251]
v_mfma_f32_16x16x32_bf16 v[252:255],a[104:107],a[156:159],v[252:255]
ds_read_b64_tr_b16 a[102:103],v14 offset:24096
v_mfma_f32_16x16x32_bf16 v[252:255],a[108:111],a[172:175],v[252:255]
s_sub_u32 s38,s38,1
s_cmp_lg_u32 s38,0
s_cbranch_scc1 Lp3L203_0
s_waitcnt lgkmcnt(4)
v_mfma_f32_16x16x32_bf16 v[32:35],a[0:3],a[112:115],v[32:35]
ds_read_b64_tr_b16 a[104:105],v14 offset:7872
v_mfma_f32_16x16x32_bf16 v[32:35],a[4:7],a[128:131],v[32:35]
ds_read_b64_tr_b16 a[106:107],v14 offset:8768
v_mfma_f32_16x16x32_bf16 v[36:39],a[0:3],a[116:119],v[36:39]
ds_read_b64_tr_b16 a[108:109],v14 offset:23232
v_mfma_f32_16x16x32_bf16 v[36:39],a[4:7],a[132:135],v[36:39]
ds_read_b64_tr_b16 a[110:111],v14 offset:24128
v_mfma_f32_16x16x32_bf16 v[40:43],a[0:3],a[120:123],v[40:43]
v_add_u32 v14,s43,v14
v_mfma_f32_16x16x32_bf16 v[40:43],a[4:7],a[136:139],v[40:43]
v_xor_b32 v12,32768,v12
v_mfma_f32_16x16x32_bf16 v[44:47],a[0:3],a[124:127],v[44:47]
v_mfma_f32_16x16x32_bf16 v[44:47],a[4:7],a[140:143],v[44:47]
s_waitcnt vmcnt(16) lgkmcnt(0)
s_barrier
v_mfma_f32_16x16x32_bf16 v[48:51],a[8:11],a[112:115],v[48:51]
ds_read_b64_tr_b16 a[0:1],v14 offset:0
s_add_u32 s37,s37,30720
v_mfma_f32_16x16x32_bf16 v[48:51],a[12:15],a[128:131],v[48:51]
buffer_load_dwordx4 a[176:179],v29,s[24:27],s60 offen sc1
v_mfma_f32_16x16x32_bf16 v[52:55],a[8:11],a[116:119],v[52:55]
ds_read_b64_tr_b16 a[2:3],v14 offset:896
v_mfma_f32_16x16x32_bf16 v[52:55],a[12:15],a[132:135],v[52:55]
s_cmp_eq_u32 s37,92160
s_cselect_b32 s43,s49,s48
s_cselect_b32 s37,0,s37
v_mfma_f32_16x16x32_bf16 v[56:59],a[8:11],a[120:123],v[56:59]
ds_read_b64_tr_b16 a[4:5],v14 offset:15360
v_mfma_f32_16x16x32_bf16 v[56:59],a[12:15],a[136:139],v[56:59]
buffer_load_dwordx4 a[180:183],v29,s[24:27],s60 offen offset:256 sc1
v_mfma_f32_16x16x32_bf16 v[60:63],a[8:11],a[124:127],v[60:63]
ds_read_b64_tr_b16 a[6:7],v14 offset:16256
v_mfma_f32_16x16x32_bf16 v[60:63],a[12:15],a[140:143],v[60:63]
v_mfma_f32_16x16x32_bf16 v[64:67],a[16:19],a[112:115],v[64:67]
ds_read_b64_tr_b16 a[8:9],v14 offset:32
v_mfma_f32_16x16x32_bf16 v[64:67],a[20:23],a[128:131],v[64:67]
buffer_load_dwordx4 a[184:187],v29,s[24:27],s60 offen offset:512 sc1
v_mfma_f32_16x16x32_bf16 v[68:71],a[16:19],a[116:119],v[68:71]
ds_read_b64_tr_b16 a[10:11],v14 offset:928
v_mfma_f32_16x16x32_bf16 v[68:71],a[20:23],a[132:135],v[68:71]
v_mfma_f32_16x16x32_bf16 v[72:75],a[16:19],a[120:123],v[72:75]
ds_read_b64_tr_b16 a[12:13],v14 offset:15392
v_mfma_f32_16x16x32_bf16 v[72:75],a[20:23],a[136:139],v[72:75]
buffer_load_dwordx4 a[188:191],v29,s[24:27],s60 offen offset:768 sc1
v_mfma_f32_16x16x32_bf16 v[76:79],a[16:19],a[124:127],v[76:79]
ds_read_b64_tr_b16 a[14:15],v14 offset:16288
v_mfma_f32_16x16x32_bf16 v[76:79],a[20:23],a[140:143],v[76:79]
v_mfma_f32_16x16x32_bf16 v[80:83],a[24:27],a[112:115],v[80:83]
ds_read_b64_tr_b16 a[16:17],v14 offset:64
v_mfma_f32_16x16x32_bf16 v[80:83],a[28:31],a[128:131],v[80:83]
buffer_load_dwordx4 a[192:195],v29,s[24:27],s60 offen offset:1024 sc1
v_mfma_f32_16x16x32_bf16 v[84:87],a[24:27],a[116:119],v[84:87]
ds_read_b64_tr_b16 a[18:19],v14 offset:960
v_mfma_f32_16x16x32_bf16 v[84:87],a[28:31],a[132:135],v[84:87]
v_mfma_f32_16x16x32_bf16 v[88:91],a[24:27],a[120:123],v[88:91]
ds_read_b64_tr_b16 a[20:21],v14 offset:15424
v_mfma_f32_16x16x32_bf16 v[88:91],a[28:31],a[136:139],v[88:91]
buffer_load_dwordx4 a[196:199],v29,s[24:27],s60 offen offset:1280 sc1
v_mfma_f32_16x16x32_bf16 v[92:95],a[24:27],a[124:127],v[92:95]
ds_read_b64_tr_b16 a[22:23],v14 offset:16320
v_mfma_f32_16x16x32_bf16 v[92:95],a[28:31],a[140:143],v[92:95]
v_mfma_f32_16x16x32_bf16 v[96:99],a[32:35],a[112:115],v[96:99]
ds_read_b64_tr_b16 a[24:25],v14 offset:96
v_mfma_f32_16x16x32_bf16 v[96:99],a[36:39],a[128:131],v[96:99]
buffer_load_dwordx4 a[200:203],v29,s[24:27],s60 offen offset:1536 sc1
v_mfma_f32_16x16x32_bf16 v[100:103],a[32:35],a[116:119],v[100:103]
ds_read_b64_tr_b16 a[26:27],v14 offset:992
v_mfma_f32_16x16x32_bf16 v[100:103],a[36:39],a[132:135],v[100:103]
v_mfma_f32_16x16x32_bf16 v[104:107],a[32:35],a[120:123],v[104:107]
ds_read_b64_tr_b16 a[28:29],v14 offset:15456
v_mfma_f32_16x16x32_bf16 v[104:107],a[36:39],a[136:139],v[104:107]
buffer_load_dwordx4 a[204:207],v29,s[24:27],s60 offen offset:1792 sc1
s_add_u32 m0,s34,s40
v_mfma_f32_16x16x32_bf16 v[108:111],a[32:35],a[124:127],v[108:111]
ds_read_b64_tr_b16 a[30:31],v14 offset:16352
v_mfma_f32_16x16x32_bf16 v[108:111],a[36:39],a[140:143],v[108:111]
v_mfma_f32_16x16x32_bf16 v[112:115],a[40:43],a[112:115],v[112:115]
ds_read_b64_tr_b16 a[32:33],v14 offset:128
v_mfma_f32_16x16x32_bf16 v[112:115],a[44:47],a[128:131],v[112:115]
buffer_load_dwordx4 v4,s[8:11],s30 offen sc1 lds
v_mfma_f32_16x16x32_bf16 v[116:119],a[40:43],a[116:119],v[116:119]
ds_read_b64_tr_b16 a[34:35],v14 offset:1024
v_mfma_f32_16x16x32_bf16 v[116:119],a[44:47],a[132:135],v[116:119]
v_mfma_f32_16x16x32_bf16 v[120:123],a[40:43],a[120:123],v[120:123]
ds_read_b64_tr_b16 a[36:37],v14 offset:15488
v_mfma_f32_16x16x32_bf16 v[120:123],a[44:47],a[136:139],v[120:123]
buffer_load_dwordx4 v4,s[8:11],s30 offen offset:1024 sc1 lds
v_mfma_f32_16x16x32_bf16 v[124:127],a[40:43],a[124:127],v[124:127]
ds_read_b64_tr_b16 a[38:39],v14 offset:16384
v_mfma_f32_16x16x32_bf16 v[124:127],a[44:47],a[140:143],v[124:127]
v_mfma_f32_16x16x32_bf16 v[128:131],a[48:51],a[112:115],v[128:131]
ds_read_b64_tr_b16 a[40:41],v14 offset:160
v_mfma_f32_16x16x32_bf16 v[128:131],a[52:55],a[128:131],v[128:131]
buffer_load_dwordx4 v5,s[8:11],s30 offen offset:2048 sc1 lds
v_mfma_f32_16x16x32_bf16 v[132:135],a[48:51],a[116:119],v[132:135]
ds_read_b64_tr_b16 a[42:43],v14 offset:1056
v_mfma_f32_16x16x32_bf16 v[132:135],a[52:55],a[132:135],v[132:135]
v_mfma_f32_16x16x32_bf16 v[136:139],a[48:51],a[120:123],v[136:139]
ds_read_b64_tr_b16 a[44:45],v14 offset:15520
v_mfma_f32_16x16x32_bf16 v[136:139],a[52:55],a[136:139],v[136:139]
buffer_load_dwordx4 v5,s[8:11],s30 offen offset:3072 sc1 lds
s_add_u32 m0,s34,s52
v_mfma_f32_16x16x32_bf16 v[140:143],a[48:51],a[124:127],v[140:143]
ds_read_b64_tr_b16 a[46:47],v14 offset:16416
v_mfma_f32_16x16x32_bf16 v[140:143],a[52:55],a[140:143],v[140:143]
v_mfma_f32_16x16x32_bf16 v[144:147],a[56:59],a[112:115],v[144:147]
ds_read_b64_tr_b16 a[48:49],v14 offset:192
v_mfma_f32_16x16x32_bf16 v[144:147],a[60:63],a[128:131],v[144:147]
v_mfma_f32_16x16x32_bf16 v[148:151],a[56:59],a[116:119],v[148:151]
ds_read_b64_tr_b16 a[50:51],v14 offset:1088
v_mfma_f32_16x16x32_bf16 v[148:151],a[60:63],a[132:135],v[148:151]
buffer_load_dwordx4 v4,s[8:11],s31 offen sc1 lds
v_mfma_f32_16x16x32_bf16 v[152:155],a[56:59],a[120:123],v[152:155]
ds_read_b64_tr_b16 a[52:53],v14 offset:15552
v_mfma_f32_16x16x32_bf16 v[152:155],a[60:63],a[136:139],v[152:155]
v_mfma_f32_16x16x32_bf16 v[156:159],a[56:59],a[124:127],v[156:159]
ds_read_b64_tr_b16 a[54:55],v14 offset:16448
v_mfma_f32_16x16x32_bf16 v[156:159],a[60:63],a[140:143],v[156:159]
buffer_load_dwordx4 v4,s[8:11],s31 offen offset:1024 sc1 lds
v_mfma_f32_16x16x32_bf16 v[160:163],a[64:67],a[112:115],v[160:163]
ds_read_b64_tr_b16 a[56:57],v14 offset:7680
v_mfma_f32_16x16x32_bf16 v[160:163],a[68:71],a[128:131],v[160:163]
v_mfma_f32_16x16x32_bf16 v[164:167],a[64:67],a[116:119],v[164:167]
ds_read_b64_tr_b16 a[58:59],v14 offset:8576
v_mfma_f32_16x16x32_bf16 v[164:167],a[68:71],a[132:135],v[164:167]
buffer_load_dwordx4 v5,s[8:11],s31 offen offset:2048 sc1 lds
v_mfma_f32_16x16x32_bf16 v[168:171],a[64:67],a[120:123],v[168:171]
ds_read_b64_tr_b16 a[60:61],v14 offset:23040
v_mfma_f32_16x16x32_bf16 v[168:171],a[68:71],a[136:139],v[168:171]
v_mfma_f32_16x16x32_bf16 v[172:175],a[64:67],a[124:127],v[172:175]
ds_read_b64_tr_b16 a[62:63],v14 offset:23936
v_mfma_f32_16x16x32_bf16 v[172:175],a[68:71],a[140:143],v[172:175]
buffer_load_dwordx4 v5,s[8:11],s31 offen offset:3072 sc1 lds
s_add_u32 s30,s30,2048
v_mfma_f32_16x16x32_bf16 v[176:179],a[72:75],a[112:115],v[176:179]
ds_read_b64_tr_b16 a[64:65],v14 offset:7712
s_and_b32 s30,s30,0x7fff
v_mfma_f32_16x16x32_bf16 v[176:179],a[76:79],a[128:131],v[176:179]
s_add_u32 s34,s34,32768
s_cmp_eq_u32 s34,65536
s_cselect_b32 s34,0,s34
v_mfma_f32_16x16x32_bf16 v[180:183],a[72:75],a[116:119],v[180:183]
ds_read_b64_tr_b16 a[66:67],v14 offset:8608
s_add_u32 s31,s30,65536
v_mfma_f32_16x16x32_bf16 v[180:183],a[76:79],a[132:135],v[180:183]
s_add_u32 m0,s35,s41
s_nop 0
buffer_load_dwordx4 v8,s[12:15],s32 offen lds
v_mfma_f32_16x16x32_bf16 v[184:187],a[72:75],a[120:123],v[184:187]
ds_read_b64_tr_b16 a[68:69],v14 offset:23072
s_waitcnt vmcnt(25)
v_mfma_f32_16x16x32_bf16 v[184:187],a[76:79],a[136:139],v[184:187]
ds_read_b128 a[144:147],v12 offset:0
v_mfma_f32_16x16x32_bf16 v[188:191],a[72:75],a[124:127],v[188:191]
ds_read_b64_tr_b16 a[70:71],v14 offset:23968
v_mfma_f32_16x16x32_bf16 v[188:191],a[76:79],a[140:143],v[188:191]
buffer_load_dwordx4 v9,s[12:15],s32 offen offset:896 lds
v_mfma_f32_16x16x32_bf16 v[192:195],a[80:83],a[112:115],v[192:195]
ds_read_b64_tr_b16 a[72:73],v14 offset:7744
v_mfma_f32_16x16x32_bf16 v[192:195],a[84:87],a[128:131],v[192:195]
ds_read_b128 a[160:163],v12 offset:1024
v_mfma_f32_16x16x32_bf16 v[196:199],a[80:83],a[116:119],v[196:199]
ds_read_b64_tr_b16 a[74:75],v14 offset:8640
v_mfma_f32_16x16x32_bf16 v[196:199],a[84:87],a[132:135],v[196:199]
buffer_load_dwordx4 v10,s[12:15],s32 offen offset:1920 lds
v_mfma_f32_16x16x32_bf16 v[200:203],a[80:83],a[120:123],v[200:203]
ds_read_b64_tr_b16 a[76:77],v14 offset:23104
v_mfma_f32_16x16x32_bf16 v[200:203],a[84:87],a[136:139],v[200:203]
ds_read_b128 a[148:151],v12 offset:2048
v_mfma_f32_16x16x32_bf16 v[204:207],a[80:83],a[124:127],v[204:207]
ds_read_b64_tr_b16 a[78:79],v14 offset:24000
v_mfma_f32_16x16x32_bf16 v[204:207],a[84:87],a[140:143],v[204:207]
buffer_load_dwordx4 v11,s[12:15],s32 offen offset:2816 lds
s_add_u32 s35,s35,15360
v_mfma_f32_16x16x32_bf16 v[208:211],a[88:91],a[112:115],v[208:211]
ds_read_b64_tr_b16 a[80:81],v14 offset:7776
v_mfma_f32_16x16x32_bf16 v[208:211],a[92:95],a[128:131],v[208:211]
s_cmp_eq_u32 s35,92160
s_cselect_b32 s35,0,s35
s_add_u32 s32,s32,229376
ds_read_b128 a[164:167],v12 offset:3072
v_mfma_f32_16x16x32_bf16 v[212:215],a[88:91],a[116:119],v[212:215]
ds_read_b64_tr_b16 a[82:83],v14 offset:8672
v_mfma_f32_16x16x32_bf16 v[212:215],a[92:95],a[132:135],v[212:215]
s_cmp_eq_u32 s32,7340032
s_cselect_b32 s32,0,s32
s_add_u32 m0,s35,s41
v_mfma_f32_16x16x32_bf16 v[216:219],a[88:91],a[120:123],v[216:219]
ds_read_b64_tr_b16 a[84:85],v14 offset:23136
v_mfma_f32_16x16x32_bf16 v[216:219],a[92:95],a[136:139],v[216:219]
ds_read_b128 a[152:155],v12 offset:4096
v_mfma_f32_16x16x32_bf16 v[220:223],a[88:91],a[124:127],v[220:223]
ds_read_b64_tr_b16 a[86:87],v14 offset:24032
v_mfma_f32_16x16x32_bf16 v[220:223],a[92:95],a[140:143],v[220:223]
buffer_load_dwordx4 v8,s[12:15],s32 offen lds
v_mfma_f32_16x16x32_bf16 v[224:227],a[96:99],a[112:115],v[224:227]
ds_read_b64_tr_b16 a[88:89],v14 offset:7808
v_mfma_f32_16x16x32_bf16 v[224:227],a[100:103],a[128:131],v[224:227]
ds_read_b128 a[168:171],v12 offset:5120
v_mfma_f32_16x16x32_bf16 v[228:231],a[96:99],a[116:119],v[228:231]
ds_read_b64_tr_b16 a[90:91],v14 offset:8704
v_mfma_f32_16x16x32_bf16 v[228:231],a[100:103],a[132:135],v[228:231]
buffer_load_dwordx4 v9,s[12:15],s32 offen offset:896 lds
v_mfma_f32_16x16x32_bf16 v[232:235],a[96:99],a[120:123],v[232:235]
ds_read_b64_tr_b16 a[92:93],v14 offset:23168
v_mfma_f32_16x16x32_bf16 v[232:235],a[100:103],a[136:139],v[232:235]
ds_read_b128 a[156:159],v12 offset:6144
v_mfma_f32_16x16x32_bf16 v[236:239],a[96:99],a[124:127],v[236:239]
ds_read_b64_tr_b16 a[94:95],v14 offset:24064
v_mfma_f32_16x16x32_bf16 v[236:239],a[100:103],a[140:143],v[236:239]
buffer_load_dwordx4 v10,s[12:15],s32 offen offset:1920 lds
v_mfma_f32_16x16x32_bf16 v[240:243],a[104:107],a[112:115],v[240:243]
ds_read_b64_tr_b16 a[96:97],v14 offset:7840
v_mfma_f32_16x16x32_bf16 v[240:243],a[108:111],a[128:131],v[240:243]
ds_read_b128 a[172:175],v12 offset:7168
v_mfma_f32_16x16x32_bf16 v[244:247],a[104:107],a[116:119],v[244:247]
ds_read_b64_tr_b16 a[98:99],v14 offset:8736
v_mfma_f32_16x16x32_bf16 v[244:247],a[108:111],a[132:135],v[244:247]
buffer_load_dwordx4 v11,s[12:15],s32 offen offset:2816 lds
s_add_u32 s35,s35,15360
v_mfma_f32_16x16x32_bf16 v[248:251],a[104:107],a[120:123],v[248:251]
ds_read_b64_tr_b16 a[100:101],v14 offset:23200
v_mfma_f32_16x16x32_bf16 v[248:251],a[108:111],a[136:139],v[248:251]
s_cmp_eq_u32 s35,92160
s_cselect_b32 s35,0,s35
s_add_u32 s32,s32,229376
v_mfma_f32_16x16x32_bf16 v[252:255],a[104:107],a[124:127],v[252:255]
ds_read_b64_tr_b16 a[102:103],v14 offset:24096
v_mfma_f32_16x16x32_bf16 v[252:255],a[108:111],a[140:143],v[252:255]
s_cmp_eq_u32 s32,7340032
s_cselect_b32 s32,0,s32
s_waitcnt lgkmcnt(4)
v_mfma_f32_16x16x32_bf16 v[32:35],a[0:3],a[144:147],v[32:35]
ds_read_b64_tr_b16 a[104:105],v14 offset:7872
v_mfma_f32_16x16x32_bf16 v[32:35],a[4:7],a[160:163],v[32:35]
ds_read_b64_tr_b16 a[106:107],v14 offset:8768
v_mfma_f32_16x16x32_bf16 v[36:39],a[0:3],a[148:151],v[36:39]
ds_read_b64_tr_b16 a[108:109],v14 offset:23232
v_mfma_f32_16x16x32_bf16 v[36:39],a[4:7],a[164:167],v[36:39]
ds_read_b64_tr_b16 a[110:111],v14 offset:24128
v_mfma_f32_16x16x32_bf16 v[40:43],a[0:3],a[152:155],v[40:43]
v_add_u32 v14,s43,v14
v_mfma_f32_16x16x32_bf16 v[40:43],a[4:7],a[168:171],v[40:43]
v_xor_b32 v12,32768,v12
v_mfma_f32_16x16x32_bf16 v[44:47],a[0:3],a[156:159],v[44:47]
v_mfma_f32_16x16x32_bf16 v[44:47],a[4:7],a[172:175],v[44:47]
s_waitcnt vmcnt(16) lgkmcnt(0)
s_barrier
v_mfma_f32_16x16x32_bf16 v[48:51],a[8:11],a[144:147],v[48:51]
ds_read_b64_tr_b16 a[0:1],v14 offset:0
s_add_u32 m0,s34,s40
v_mfma_f32_16x16x32_bf16 v[48:51],a[12:15],a[160:163],v[48:51]
buffer_load_dwordx4 v4,s[8:11],s30 offen sc1 lds
s_add_u32 s37,s37,30720
v_mfma_f32_16x16x32_bf16 v[52:55],a[8:11],a[148:151],v[52:55]
ds_read_b64_tr_b16 a[2:3],v14 offset:896
v_mfma_f32_16x16x32_bf16 v[52:55],a[12:15],a[164:167],v[52:55]
s_cmp_eq_u32 s37,92160
s_cselect_b32 s43,s49,s48
s_cselect_b32 s37,0,s37
v_mfma_f32_16x16x32_bf16 v[56:59],a[8:11],a[152:155],v[56:59]
ds_read_b64_tr_b16 a[4:5],v14 offset:15360
v_accvgpr_read_b32 v16,a176
v_mfma_f32_16x16x32_bf16 v[56:59],a[12:15],a[168:171],v[56:59]
v_accvgpr_read_b32 v17,a177
v_accvgpr_read_b32 v18,a178
v_mfma_f32_16x16x32_bf16 v[60:63],a[8:11],a[156:159],v[60:63]
ds_read_b64_tr_b16 a[6:7],v14 offset:16256
v_accvgpr_read_b32 v19,a179
v_mfma_f32_16x16x32_bf16 v[60:63],a[12:15],a[172:175],v[60:63]
v_accvgpr_read_b32 v20,a180
v_accvgpr_read_b32 v21,a181
v_mfma_f32_16x16x32_bf16 v[64:67],a[16:19],a[144:147],v[64:67]
ds_read_b64_tr_b16 a[8:9],v14 offset:32
v_accvgpr_read_b32 v22,a182
v_mfma_f32_16x16x32_bf16 v[64:67],a[20:23],a[160:163],v[64:67]
v_accvgpr_read_b32 v23,a183
v_add_f32 v16,v16,v20
v_mfma_f32_16x16x32_bf16 v[68:71],a[16:19],a[148:151],v[68:71]
ds_read_b64_tr_b16 a[10:11],v14 offset:928
v_add_f32 v17,v17,v21
v_mfma_f32_16x16x32_bf16 v[68:71],a[20:23],a[164:167],v[68:71]
v_add_f32 v18,v18,v22
v_add_f32 v19,v19,v23
v_mfma_f32_16x16x32_bf16 v[72:75],a[16:19],a[152:155],v[72:75]
ds_read_b64_tr_b16 a[12:13],v14 offset:15392
v_accvgpr_read_b32 v20,a184
v_mfma_f32_16x16x32_bf16 v[72:75],a[20:23],a[168:171],v[72:75]
buffer_load_dwordx4 v4,s[8:11],s30 offen offset:1024 sc1 lds
v_accvgpr_read_b32 v21,a185
v_mfma_f32_16x16x32_bf16 v[76:79],a[16:19],a[156:159],v[76:79]
ds_read_b64_tr_b16 a[14:15],v14 offset:16288
v_accvgpr_read_b32 v22,a186
v_mfma_f32_16x16x32_bf16 v[76:79],a[20:23],a[172:175],v[76:79]
v_accvgpr_read_b32 v23,a187
v_add_f32 v16,v16,v20
v_mfma_f32_16x16x32_bf16 v[80:83],a[24:27],a[144:147],v[80:83]
ds_read_b64_tr_b16 a[16:17],v14 offset:64
v_add_f32 v17,v17,v21
v_mfma_f32_16x16x32_bf16 v[80:83],a[28:31],a[160:163],v[80:83]
v_add_f32 v18,v18,v22
v_add_f32 v19,v19,v23
v_mfma_f32_16x16x32_bf16 v[84:87],a[24:27],a[148:151],v[84:87]
ds_read_b64_tr_b16 a[18:19],v14 offset:960
v_accvgpr_read_b32 v20,a188
v_mfma_f32_16x16x32_bf16 v[84:87],a[28:31],a[164:167],v[84:87]
v_accvgpr_read_b32 v21,a189
v_accvgpr_read_b32 v22,a190
v_mfma_f32_16x16x32_bf16 v[88:91],a[24:27],a[152:155],v[88:91]
ds_read_b64_tr_b16 a[20:21],v14 offset:15424
v_accvgpr_read_b32 v23,a191
v_mfma_f32_16x16x32_bf16 v[88:91],a[28:31],a[168:171],v[88:91]
v_add_f32 v16,v16,v20
v_add_f32 v17,v17,v21
v_mfma_f32_16x16x32_bf16 v[92:95],a[24:27],a[156:159],v[92:95]
ds_read_b64_tr_b16 a[22:23],v14 offset:16320
v_add_f32 v18,v18,v22
v_mfma_f32_16x16x32_bf16 v[92:95],a[28:31],a[172:175],v[92:95]
v_add_f32 v19,v19,v23
v_accvgpr_read_b32 v20,a192
v_mfma_f32_16x16x32_bf16 v[96:99],a[32:35],a[144:147],v[96:99]
ds_read_b64_tr_b16 a[24:25],v14 offset:96
v_accvgpr_read_b32 v21,a193
v_mfma_f32_16x16x32_bf16 v[96:99],a[36:39],a[160:163],v[96:99]
buffer_load_dwordx4 v5,s[8:11],s30 offen offset:2048 sc1 lds
v_accvgpr_read_b32 v22,a194
v_mfma_f32_16x16x32_bf16 v[100:103],a[32:35],a[148:151],v[100:103]
ds_read_b64_tr_b16 a[26:27],v14 offset:992
v_accvgpr_read_b32 v23,a195
v_mfma_f32_16x16x32_bf16 v[100:103],a[36:39],a[164:167],v[100:103]
v_add_f32 v16,v16,v20
v_add_f32 v17,v17,v21
v_mfma_f32_16x16x32_bf16 v[104:107],a[32:35],a[152:155],v[104:107]
ds_read_b64_tr_b16 a[28:29],v14 offset:15456
v_add_f32 v18,v18,v22
v_mfma_f32_16x16x32_bf16 v[104:107],a[36:39],a[168:171],v[104:107]
v_add_f32 v19,v19,v23
v_accvgpr_read_b32 v20,a196
v_mfma_f32_16x16x32_bf16 v[108:111],a[32:35],a[156:159],v[108:111]
ds_read_b64_tr_b16 a[30:31],v14 offset:16352
v_accvgpr_read_b32 v21,a197
v_mfma_f32_16x16x32_bf16 v[108:111],a[36:39],a[172:175],v[108:111]
v_accvgpr_read_b32 v22,a198
v_accvgpr_read_b32 v23,a199
v_mfma_f32_16x16x32_bf16 v[112:115],a[40:43],a[144:147],v[112:115]
ds_read_b64_tr_b16 a[32:33],v14 offset:128
v_add_f32 v16,v16,v20
v_mfma_f32_16x16x32_bf16 v[112:115],a[44:47],a[160:163],v[112:115]
v_add_f32 v17,v17,v21
v_add_f32 v18,v18,v22
v_mfma_f32_16x16x32_bf16 v[116:119],a[40:43],a[148:151],v[116:119]
ds_read_b64_tr_b16 a[34:35],v14 offset:1024
v_add_f32 v19,v19,v23
v_mfma_f32_16x16x32_bf16 v[116:119],a[44:47],a[164:167],v[116:119]
v_accvgpr_read_b32 v20,a200
v_accvgpr_read_b32 v21,a201
v_mfma_f32_16x16x32_bf16 v[120:123],a[40:43],a[152:155],v[120:123]
ds_read_b64_tr_b16 a[36:37],v14 offset:15488
v_accvgpr_read_b32 v22,a202
v_mfma_f32_16x16x32_bf16 v[120:123],a[44:47],a[168:171],v[120:123]
buffer_load_dwordx4 v5,s[8:11],s30 offen offset:3072 sc1 lds
s_add_u32 m0,s34,s52
v_mfma_f32_16x16x32_bf16 v[124:127],a[40:43],a[156:159],v[124:127]
ds_read_b64_tr_b16 a[38:39],v14 offset:16384
v_accvgpr_read_b32 v23,a203
v_mfma_f32_16x16x32_bf16 v[124:127],a[44:47],a[172:175],v[124:127]
v_add_f32 v16,v16,v20
v_add_f32 v17,v17,v21
v_mfma_f32_16x16x32_bf16 v[128:131],a[48:51],a[144:147],v[128:131]
ds_read_b64_tr_b16 a[40:41],v14 offset:160
v_add_f32 v18,v18,v22
v_mfma_f32_16x16x32_bf16 v[128:131],a[52:55],a[160:163],v[128:131]
v_add_f32 v19,v19,v23
v_accvgpr_read_b32 v20,a204
v_mfma_f32_16x16x32_bf16 v[132:135],a[48:51],a[148:151],v[132:135]
ds_read_b64_tr_b16 a[42:43],v14 offset:1056
v_accvgpr_read_b32 v21,a205
v_mfma_f32_16x16x32_bf16 v[132:135],a[52:55],a[164:167],v[132:135]
v_accvgpr_read_b32 v22,a206
v_accvgpr_read_b32 v23,a207
v_mfma_f32_16x16x32_bf16 v[136:139],a[48:51],a[152:155],v[136:139]
ds_read_b64_tr_b16 a[44:45],v14 offset:15520
v_add_f32 v16,v16,v20
v_mfma_f32_16x16x32_bf16 v[136:139],a[52:55],a[168:171],v[136:139]
v_add_f32 v17,v17,v21
v_add_f32 v18,v18,v22
v_mfma_f32_16x16x32_bf16 v[140:143],a[48:51],a[156:159],v[140:143]
ds_read_b64_tr_b16 a[46:47],v14 offset:16416
v_add_f32 v19,v19,v23
v_mfma_f32_16x16x32_bf16 v[140:143],a[52:55],a[172:175],v[140:143]
v_add_f32 v16,v16,v18
v_add_f32 v17,v17,v19
v_mfma_f32_16x16x32_bf16 v[144:147],a[56:59],a[144:147],v[144:147]
ds_read_b64_tr_b16 a[48:49],v14 offset:192
v_mfma_f32_16x16x32_bf16 v[144:147],a[60:63],a[160:163],v[144:147]
v_mfma_f32_16x16x32_bf16 v[148:151],a[56:59],a[148:151],v[148:151]
ds_read_b64_tr_b16 a[50:51],v14 offset:1088
v_mfma_f32_16x16x32_bf16 v[148:151],a[60:63],a[164:167],v[148:151]
buffer_load_dwordx4 v4,s[8:11],s31 offen sc1 lds
v_mfma_f32_16x16x32_bf16 v[152:155],a[56:59],a[152:155],v[152:155]
ds_read_b64_tr_b16 a[52:53],v14 offset:15552
v_mfma_f32_16x16x32_bf16 v[152:155],a[60:63],a[168:171],v[152:155]
v_mfma_f32_16x16x32_bf16 v[156:159],a[56:59],a[156:159],v[156:159]
ds_read_b64_tr_b16 a[54:55],v14 offset:16448
v_mfma_f32_16x16x32_bf16 v[156:159],a[60:63],a[172:175],v[156:159]
v_mfma_f32_16x16x32_bf16 v[160:163],a[64:67],a[144:147],v[160:163]
ds_read_b64_tr_b16 a[56:57],v14 offset:7680
v_mfma_f32_16x16x32_bf16 v[160:163],a[68:71],a[160:163],v[160:163]
v_mfma_f32_16x16x32_bf16 v[164:167],a[64:67],a[148:151],v[164:167]
ds_read_b64_tr_b16 a[58:59],v14 offset:8576
v_mfma_f32_16x16x32_bf16 v[164:167],a[68:71],a[164:167],v[164:167]
v_mfma_f32_16x16x32_bf16 v[168:171],a[64:67],a[152:155],v[168:171]
ds_read_b64_tr_b16 a[60:61],v14 offset:23040
v_mfma_f32_16x16x32_bf16 v[168:171],a[68:71],a[168:171],v[168:171]
v_mfma_f32_16x16x32_bf16 v[172:175],a[64:67],a[156:159],v[172:175]
ds_read_b64_tr_b16 a[62:63],v14 offset:23936
v_mfma_f32_16x16x32_bf16 v[172:175],a[68:71],a[172:175],v[172:175]
buffer_load_dwordx4 v4,s[8:11],s31 offen offset:1024 sc1 lds
v_mfma_f32_16x16x32_bf16 v[176:179],a[72:75],a[144:147],v[176:179]
ds_read_b64_tr_b16 a[64:65],v14 offset:7712
v_mfma_f32_16x16x32_bf16 v[176:179],a[76:79],a[160:163],v[176:179]
v_mfma_f32_16x16x32_bf16 v[180:183],a[72:75],a[148:151],v[180:183]
ds_read_b64_tr_b16 a[66:67],v14 offset:8608
v_mfma_f32_16x16x32_bf16 v[180:183],a[76:79],a[164:167],v[180:183]
v_mfma_f32_16x16x32_bf16 v[184:187],a[72:75],a[152:155],v[184:187]
ds_read_b64_tr_b16 a[68:69],v14 offset:23072
s_waitcnt vmcnt(14)
v_mfma_f32_16x16x32_bf16 v[184:187],a[76:79],a[168:171],v[184:187]
ds_read_b128 a[112:115],v12 offset:0
v_mfma_f32_16x16x32_bf16 v[188:191],a[72:75],a[156:159],v[188:191]
ds_read_b64_tr_b16 a[70:71],v14 offset:23968
v_mfma_f32_16x16x32_bf16 v[188:191],a[76:79],a[172:175],v[188:191]
v_mfma_f32_16x16x32_bf16 v[192:195],a[80:83],a[144:147],v[192:195]
ds_read_b64_tr_b16 a[72:73],v14 offset:7744
v_mfma_f32_16x16x32_bf16 v[192:195],a[84:87],a[160:163],v[192:195]
ds_read_b128 a[128:131],v12 offset:1024
v_mfma_f32_16x16x32_bf16 v[196:199],a[80:83],a[148:151],v[196:199]
ds_read_b64_tr_b16 a[74:75],v14 offset:8640
v_mfma_f32_16x16x32_bf16 v[196:199],a[84:87],a[164:167],v[196:199]
buffer_load_dwordx4 v5,s[8:11],s31 offen offset:2048 sc1 lds
v_mfma_f32_16x16x32_bf16 v[200:203],a[80:83],a[152:155],v[200:203]
ds_read_b64_tr_b16 a[76:77],v14 offset:23104
v_mfma_f32_16x16x32_bf16 v[200:203],a[84:87],a[168:171],v[200:203]
ds_read_b128 a[116:119],v12 offset:2048
v_mfma_f32_16x16x32_bf16 v[204:207],a[80:83],a[156:159],v[204:207]
ds_read_b64_tr_b16 a[78:79],v14 offset:24000
v_mfma_f32_16x16x32_bf16 v[204:207],a[84:87],a[172:175],v[204:207]
v_mfma_f32_16x16x32_bf16 v[208:211],a[88:91],a[144:147],v[208:211]
ds_read_b64_tr_b16 a[80:81],v14 offset:7776
v_mfma_f32_16x16x32_bf16 v[208:211],a[92:95],a[160:163],v[208:211]
ds_read_b128 a[132:135],v12 offset:3072
v_mfma_f32_16x16x32_bf16 v[212:215],a[88:91],a[148:151],v[212:215]
ds_read_b64_tr_b16 a[82:83],v14 offset:8672
v_mfma_f32_16x16x32_bf16 v[212:215],a[92:95],a[164:167],v[212:215]
v_mfma_f32_16x16x32_bf16 v[216:219],a[88:91],a[152:155],v[216:219]
ds_read_b64_tr_b16 a[84:85],v14 offset:23136
v_mfma_f32_16x16x32_bf16 v[216:219],a[92:95],a[168:171],v[216:219]
ds_read_b128 a[120:123],v12 offset:4096
v_mfma_f32_16x16x32_bf16 v[220:223],a[88:91],a[156:159],v[220:223]
ds_read_b64_tr_b16 a[86:87],v14 offset:24032
v_mfma_f32_16x16x32_bf16 v[220:223],a[92:95],a[172:175],v[220:223]
buffer_load_dwordx4 v5,s[8:11],s31 offen offset:3072 sc1 lds
s_add_u32 s30,s30,2048
v_mfma_f32_16x16x32_bf16 v[224:227],a[96:99],a[144:147],v[224:227]
ds_read_b64_tr_b16 a[88:89],v14 offset:7808
s_and_b32 s30,s30,0x7fff
v_mfma_f32_16x16x32_bf16 v[224:227],a[100:103],a[160:163],v[224:227]
s_add_u32 s34,s34,32768
s_cmp_eq_u32 s34,65536
s_cselect_b32 s34,0,s34
ds_read_b128 a[136:139],v12 offset:5120
v_mfma_f32_16x16x32_bf16 v[228:231],a[96:99],a[148:151],v[228:231]
ds_read_b64_tr_b16 a[90:91],v14 offset:8704
s_add_u32 s31,s30,65536
v_mfma_f32_16x16x32_bf16 v[228:231],a[100:103],a[164:167],v[228:231]
v_mfma_f32_16x16x32_bf16 v[232:235],a[96:99],a[152:155],v[232:235]
ds_read_b64_tr_b16 a[92:93],v14 offset:23168
v_mfma_f32_16x16x32_bf16 v[232:235],a[100:103],a[168:171],v[232:235]
ds_read_b128 a[124:127],v12 offset:6144
v_mfma_f32_16x16x32_bf16 v[236:239],a[96:99],a[156:159],v[236:239]
ds_read_b64_tr_b16 a[94:95],v14 offset:24064
v_mfma_f32_16x16x32_bf16 v[236:239],a[100:103],a[172:175],v[236:239]
v_mfma_f32_16x16x32_bf16 v[240:243],a[104:107],a[144:147],v[240:243]
ds_read_b64_tr_b16 a[96:97],v14 offset:7840
v_mfma_f32_16x16x32_bf16 v[240:243],a[108:111],a[160:163],v[240:243]
ds_read_b128 a[140:143],v12 offset:7168
v_mfma_f32_16x16x32_bf16 v[244:247],a[104:107],a[148:151],v[244:247]
ds_read_b64_tr_b16 a[98:99],v14 offset:8736
v_mfma_f32_16x16x32_bf16 v[244:247],a[108:111],a[164:167],v[244:247]
v_mfma_f32_16x16x32_bf16 v[248:251],a[104:107],a[152:155],v[248:251]
ds_read_b64_tr_b16 a[100:101],v14 offset:23200
v_mfma_f32_16x16x32_bf16 v[248:251],a[108:111],a[168:171],v[248:251]
v_mfma_f32_16x16x32_bf16 v[252:255],a[104:107],a[156:159],v[252:255]
ds_read_b64_tr_b16 a[102:103],v14 offset:24096
v_mfma_f32_16x16x32_bf16 v[252:255],a[108:111],a[172:175],v[252:255]
s_waitcnt lgkmcnt(4)
v_mfma_f32_16x16x32_bf16 v[32:35],a[0:3],a[112:115],v[32:35]
ds_read_b64_tr_b16 a[104:105],v14 offset:7872
v_mfma_f32_16x16x32_bf16 v[32:35],a[4:7],a[128:131],v[32:35]
ds_read_b64_tr_b16 a[106:107],v14 offset:8768
v_mfma_f32_16x16x32_bf16 v[36:39],a[0:3],a[116:119],v[36:39]
ds_read_b64_tr_b16 a[108:109],v14 offset:23232
v_mfma_f32_16x16x32_bf16 v[36:39],a[4:7],a[132:135],v[36:39]
ds_read_b64_tr_b16 a[110:111],v14 offset:24128
v_mfma_f32_16x16x32_bf16 v[40:43],a[0:3],a[120:123],v[40:43]
v_add_u32 v14,s43,v14
v_mfma_f32_16x16x32_bf16 v[40:43],a[4:7],a[136:139],v[40:43]
v_xor_b32 v12,32768,v12
v_mfma_f32_16x16x32_bf16 v[44:47],a[0:3],a[124:127],v[44:47]
v_mfma_f32_16x16x32_bf16 v[44:47],a[4:7],a[140:143],v[44:47]
s_waitcnt vmcnt(8) lgkmcnt(0)
s_barrier
v_mfma_f32_16x16x32_bf16 v[48:51],a[8:11],a[112:115],v[48:51]
ds_read_b64_tr_b16 a[0:1],v14 offset:0
s_add_u32 s37,s37,30720
v_mfma_f32_16x16x32_bf16 v[48:51],a[12:15],a[128:131],v[48:51]
buffer_load_dwordx4 a[176:179],v28,s[24:27],s62 offen sc1
v_mfma_f32_16x16x32_bf16 v[52:55],a[8:11],a[116:119],v[52:55]
ds_read_b64_tr_b16 a[2:3],v14 offset:896
v_mfma_f32_16x16x32_bf16 v[52:55],a[12:15],a[132:135],v[52:55]
s_cmp_eq_u32 s37,92160
s_cselect_b32 s43,s49,s48
s_cselect_b32 s37,0,s37
v_mfma_f32_16x16x32_bf16 v[56:59],a[8:11],a[120:123],v[56:59]
ds_read_b64_tr_b16 a[4:5],v14 offset:15360
v_mfma_f32_16x16x32_bf16 v[56:59],a[12:15],a[136:139],v[56:59]
v_mfma_f32_16x16x32_bf16 v[60:63],a[8:11],a[124:127],v[60:63]
ds_read_b64_tr_b16 a[6:7],v14 offset:16256
v_mfma_f32_16x16x32_bf16 v[60:63],a[12:15],a[140:143],v[60:63]
buffer_load_dwordx4 a[180:183],v28,s[24:27],s62 offen offset:256 sc1
v_mfma_f32_16x16x32_bf16 v[64:67],a[16:19],a[112:115],v[64:67]
ds_read_b64_tr_b16 a[8:9],v14 offset:32
v_mfma_f32_16x16x32_bf16 v[64:67],a[20:23],a[128:131],v[64:67]
v_mfma_f32_16x16x32_bf16 v[68:71],a[16:19],a[116:119],v[68:71]
ds_read_b64_tr_b16 a[10:11],v14 offset:928
v_mfma_f32_16x16x32_bf16 v[68:71],a[20:23],a[132:135],v[68:71]
v_mfma_f32_16x16x32_bf16 v[72:75],a[16:19],a[120:123],v[72:75]
ds_read_b64_tr_b16 a[12:13],v14 offset:15392
v_mfma_f32_16x16x32_bf16 v[72:75],a[20:23],a[136:139],v[72:75]
v_mfma_f32_16x16x32_bf16 v[76:79],a[16:19],a[124:127],v[76:79]
ds_read_b64_tr_b16 a[14:15],v14 offset:16288
v_mfma_f32_16x16x32_bf16 v[76:79],a[20:23],a[140:143],v[76:79]
buffer_load_dwordx4 a[184:187],v28,s[24:27],s62 offen offset:512 sc1
v_mfma_f32_16x16x32_bf16 v[80:83],a[24:27],a[112:115],v[80:83]
ds_read_b64_tr_b16 a[16:17],v14 offset:64
v_mfma_f32_16x16x32_bf16 v[80:83],a[28:31],a[128:131],v[80:83]
v_mfma_f32_16x16x32_bf16 v[84:87],a[24:27],a[116:119],v[84:87]
ds_read_b64_tr_b16 a[18:19],v14 offset:960
v_mfma_f32_16x16x32_bf16 v[84:87],a[28:31],a[132:135],v[84:87]
v_mfma_f32_16x16x32_bf16 v[88:91],a[24:27],a[120:123],v[88:91]
ds_read_b64_tr_b16 a[20:21],v14 offset:15424
v_mfma_f32_16x16x32_bf16 v[88:91],a[28:31],a[136:139],v[88:91]
buffer_load_dwordx4 a[188:191],v28,s[24:27],s62 offen offset:768 sc1
v_mfma_f32_16x16x32_bf16 v[92:95],a[24:27],a[124:127],v[92:95]
ds_read_b64_tr_b16 a[22:23],v14 offset:16320
v_mfma_f32_16x16x32_bf16 v[92:95],a[28:31],a[140:143],v[92:95]
v_mfma_f32_16x16x32_bf16 v[96:99],a[32:35],a[112:115],v[96:99]
ds_read_b64_tr_b16 a[24:25],v14 offset:96
v_mfma_f32_16x16x32_bf16 v[96:99],a[36:39],a[128:131],v[96:99]
v_mfma_f32_16x16x32_bf16 v[100:103],a[32:35],a[116:119],v[100:103]
ds_read_b64_tr_b16 a[26:27],v14 offset:992
v_mfma_f32_16x16x32_bf16 v[100:103],a[36:39],a[132:135],v[100:103]
v_mfma_f32_16x16x32_bf16 v[104:107],a[32:35],a[120:123],v[104:107]
ds_read_b64_tr_b16 a[28:29],v14 offset:15456
v_mfma_f32_16x16x32_bf16 v[104:107],a[36:39],a[136:139],v[104:107]
buffer_load_dwordx4 a[192:195],v28,s[24:27],s62 offen offset:1024 sc1
v_mfma_f32_16x16x32_bf16 v[108:111],a[32:35],a[124:127],v[108:111]
ds_read_b64_tr_b16 a[30:31],v14 offset:16352
v_mfma_f32_16x16x32_bf16 v[108:111],a[36:39],a[140:143],v[108:111]
v_mfma_f32_16x16x32_bf16 v[112:115],a[40:43],a[112:115],v[112:115]
ds_read_b64_tr_b16 a[32:33],v14 offset:128
v_mfma_f32_16x16x32_bf16 v[112:115],a[44:47],a[128:131],v[112:115]
v_mfma_f32_16x16x32_bf16 v[116:119],a[40:43],a[116:119],v[116:119]
ds_read_b64_tr_b16 a[34:35],v14 offset:1024
v_mfma_f32_16x16x32_bf16 v[116:119],a[44:47],a[132:135],v[116:119]
buffer_load_dwordx4 a[196:199],v28,s[24:27],s62 offen offset:1280 sc1
v_mfma_f32_16x16x32_bf16 v[120:123],a[40:43],a[120:123],v[120:123]
ds_read_b64_tr_b16 a[36:37],v14 offset:15488
v_mfma_f32_16x16x32_bf16 v[120:123],a[44:47],a[136:139],v[120:123]
v_mfma_f32_16x16x32_bf16 v[124:127],a[40:43],a[124:127],v[124:127]
ds_read_b64_tr_b16 a[38:39],v14 offset:16384
v_mfma_f32_16x16x32_bf16 v[124:127],a[44:47],a[140:143],v[124:127]
v_mfma_f32_16x16x32_bf16 v[128:131],a[48:51],a[112:115],v[128:131]
ds_read_b64_tr_b16 a[40:41],v14 offset:160
v_mfma_f32_16x16x32_bf16 v[128:131],a[52:55],a[128:131],v[128:131]
v_mfma_f32_16x16x32_bf16 v[132:135],a[48:51],a[116:119],v[132:135]
ds_read_b64_tr_b16 a[42:43],v14 offset:1056
v_mfma_f32_16x16x32_bf16 v[132:135],a[52:55],a[132:135],v[132:135]
buffer_load_dwordx4 a[200:203],v28,s[24:27],s62 offen offset:1536 sc1
v_mfma_f32_16x16x32_bf16 v[136:139],a[48:51],a[120:123],v[136:139]
ds_read_b64_tr_b16 a[44:45],v14 offset:15520
v_mfma_f32_16x16x32_bf16 v[136:139],a[52:55],a[136:139],v[136:139]
v_mfma_f32_16x16x32_bf16 v[140:143],a[48:51],a[124:127],v[140:143]
ds_read_b64_tr_b16 a[46:47],v14 offset:16416
v_mfma_f32_16x16x32_bf16 v[140:143],a[52:55],a[140:143],v[140:143]
v_mfma_f32_16x16x32_bf16 v[144:147],a[56:59],a[112:115],v[144:147]
ds_read_b64_tr_b16 a[48:49],v14 offset:192
v_mfma_f32_16x16x32_bf16 v[144:147],a[60:63],a[128:131],v[144:147]
v_mfma_f32_16x16x32_bf16 v[148:151],a[56:59],a[116:119],v[148:151]
ds_read_b64_tr_b16 a[50:51],v14 offset:1088
v_mfma_f32_16x16x32_bf16 v[148:151],a[60:63],a[132:135],v[148:151]
buffer_load_dwordx4 a[204:207],v28,s[24:27],s63 offen sc1
v_mfma_f32_16x16x32_bf16 v[152:155],a[56:59],a[120:123],v[152:155]
ds_read_b64_tr_b16 a[52:53],v14 offset:15552
v_mfma_f32_16x16x32_bf16 v[152:155],a[60:63],a[136:139],v[152:155]
v_mfma_f32_16x16x32_bf16 v[156:159],a[56:59],a[124:127],v[156:159]
ds_read_b64_tr_b16 a[54:55],v14 offset:16448
v_mfma_f32_16x16x32_bf16 v[156:159],a[60:63],a[140:143],v[156:159]
v_mfma_f32_16x16x32_bf16 v[160:163],a[64:67],a[112:115],v[160:163]
ds_read_b64_tr_b16 a[56:57],v14 offset:7680
v_mfma_f32_16x16x32_bf16 v[160:163],a[68:71],a[128:131],v[160:163]
buffer_load_dwordx4 a[208:211],v28,s[24:27],s63 offen offset:256 sc1
v_mfma_f32_16x16x32_bf16 v[164:167],a[64:67],a[116:119],v[164:167]
ds_read_b64_tr_b16 a[58:59],v14 offset:8576
v_mfma_f32_16x16x32_bf16 v[164:167],a[68:71],a[132:135],v[164:167]
v_mfma_f32_16x16x32_bf16 v[168:171],a[64:67],a[120:123],v[168:171]
ds_read_b64_tr_b16 a[60:61],v14 offset:23040
v_mfma_f32_16x16x32_bf16 v[168:171],a[68:71],a[136:139],v[168:171]
v_mfma_f32_16x16x32_bf16 v[172:175],a[64:67],a[124:127],v[172:175]
ds_read_b64_tr_b16 a[62:63],v14 offset:23936
v_mfma_f32_16x16x32_bf16 v[172:175],a[68:71],a[140:143],v[172:175]
v_mfma_f32_16x16x32_bf16 v[176:179],a[72:75],a[112:115],v[176:179]
ds_read_b64_tr_b16 a[64:65],v14 offset:7712
v_mfma_f32_16x16x32_bf16 v[176:179],a[76:79],a[128:131],v[176:179]
buffer_load_dwordx4 a[212:215],v28,s[24:27],s63 offen offset:512 sc1
v_mfma_f32_16x16x32_bf16 v[180:183],a[72:75],a[116:119],v[180:183]
ds_read_b64_tr_b16 a[66:67],v14 offset:8608
v_mfma_f32_16x16x32_bf16 v[180:183],a[76:79],a[132:135],v[180:183]
v_mfma_f32_16x16x32_bf16 v[184:187],a[72:75],a[120:123],v[184:187]
ds_read_b64_tr_b16 a[68:69],v14 offset:23072
s_waitcnt vmcnt(10)
v_mfma_f32_16x16x32_bf16 v[184:187],a[76:79],a[136:139],v[184:187]
ds_read_b128 a[144:147],v12 offset:0
v_mfma_f32_16x16x32_bf16 v[188:191],a[72:75],a[124:127],v[188:191]
ds_read_b64_tr_b16 a[70:71],v14 offset:23968
v_mfma_f32_16x16x32_bf16 v[188:191],a[76:79],a[140:143],v[188:191]
buffer_load_dwordx4 a[216:219],v28,s[24:27],s63 offen offset:768 sc1
v_mfma_f32_16x16x32_bf16 v[192:195],a[80:83],a[112:115],v[192:195]
ds_read_b64_tr_b16 a[72:73],v14 offset:7744
v_mfma_f32_16x16x32_bf16 v[192:195],a[84:87],a[128:131],v[192:195]
ds_read_b128 a[160:163],v12 offset:1024
v_mfma_f32_16x16x32_bf16 v[196:199],a[80:83],a[116:119],v[196:199]
ds_read_b64_tr_b16 a[74:75],v14 offset:8640
v_mfma_f32_16x16x32_bf16 v[196:199],a[84:87],a[132:135],v[196:199]
v_mfma_f32_16x16x32_bf16 v[200:203],a[80:83],a[120:123],v[200:203]
ds_read_b64_tr_b16 a[76:77],v14 offset:23104
v_mfma_f32_16x16x32_bf16 v[200:203],a[84:87],a[136:139],v[200:203]
ds_read_b128 a[148:151],v12 offset:2048
v_mfma_f32_16x16x32_bf16 v[204:207],a[80:83],a[124:127],v[204:207]
ds_read_b64_tr_b16 a[78:79],v14 offset:24000
v_mfma_f32_16x16x32_bf16 v[204:207],a[84:87],a[140:143],v[204:207]
buffer_load_dwordx4 a[220:223],v28,s[24:27],s63 offen offset:1024 sc1
v_mfma_f32_16x16x32_bf16 v[208:211],a[88:91],a[112:115],v[208:211]
ds_read_b64_tr_b16 a[80:81],v14 offset:7776
v_mfma_f32_16x16x32_bf16 v[208:211],a[92:95],a[128:131],v[208:211]
ds_read_b128 a[164:167],v12 offset:3072
v_mfma_f32_16x16x32_bf16 v[212:215],a[88:91],a[116:119],v[212:215]
ds_read_b64_tr_b16 a[82:83],v14 offset:8672
v_mfma_f32_16x16x32_bf16 v[212:215],a[92:95],a[132:135],v[212:215]
v_mfma_f32_16x16x32_bf16 v[216:219],a[88:91],a[120:123],v[216:219]
ds_read_b64_tr_b16 a[84:85],v14 offset:23136
v_mfma_f32_16x16x32_bf16 v[216:219],a[92:95],a[136:139],v[216:219]
ds_read_b128 a[152:155],v12 offset:4096
v_mfma_f32_16x16x32_bf16 v[220:223],a[88:91],a[124:127],v[220:223]
ds_read_b64_tr_b16 a[86:87],v14 offset:24032
v_mfma_f32_16x16x32_bf16 v[220:223],a[92:95],a[140:143],v[220:223]
buffer_load_dwordx4 a[224:227],v28,s[24:27],s63 offen offset:1280 sc1
v_mfma_f32_16x16x32_bf16 v[224:227],a[96:99],a[112:115],v[224:227]
ds_read_b64_tr_b16 a[88:89],v14 offset:7808
v_mfma_f32_16x16x32_bf16 v[224:227],a[100:103],a[128:131],v[224:227]
ds_read_b128 a[168:171],v12 offset:5120
v_mfma_f32_16x16x32_bf16 v[228:231],a[96:99],a[116:119],v[228:231]
ds_read_b64_tr_b16 a[90:91],v14 offset:8704
v_mfma_f32_16x16x32_bf16 v[228:231],a[100:103],a[132:135],v[228:231]
v_mfma_f32_16x16x32_bf16 v[232:235],a[96:99],a[120:123],v[232:235]
ds_read_b64_tr_b16 a[92:93],v14 offset:23168
v_mfma_f32_16x16x32_bf16 v[232:235],a[100:103],a[136:139],v[232:235]
ds_read_b128 a[156:159],v12 offset:6144
v_mfma_f32_16x16x32_bf16 v[236:239],a[96:99],a[124:127],v[236:239]
ds_read_b64_tr_b16 a[94:95],v14 offset:24064
v_mfma_f32_16x16x32_bf16 v[236:239],a[100:103],a[140:143],v[236:239]
buffer_load_dwordx4 a[228:231],v28,s[24:27],s63 offen offset:1536 sc1
v_mfma_f32_16x16x32_bf16 v[240:243],a[104:107],a[112:115],v[240:243]
ds_read_b64_tr_b16 a[96:97],v14 offset:7840
v_mfma_f32_16x16x32_bf16 v[240:243],a[108:111],a[128:131],v[240:243]
ds_read_b128 a[172:175],v12 offset:7168
v_mfma_f32_16x16x32_bf16 v[244:247],a[104:107],a[116:119],v[244:247]
ds_read_b64_tr_b16 a[98:99],v14 offset:8736
v_mfma_f32_16x16x32_bf16 v[244:247],a[108:111],a[132:135],v[244:247]
v_mfma_f32_16x16x32_bf16 v[248:251],a[104:107],a[120:123],v[248:251]
ds_read_b64_tr_b16 a[100:101],v14 offset:23200
v_mfma_f32_16x16x32_bf16 v[248:251],a[108:111],a[136:139],v[248:251]
v_mfma_f32_16x16x32_bf16 v[252:255],a[104:107],a[124:127],v[252:255]
ds_read_b64_tr_b16 a[102:103],v14 offset:24096
v_mfma_f32_16x16x32_bf16 v[252:255],a[108:111],a[140:143],v[252:255]
s_waitcnt lgkmcnt(4)
v_mfma_f32_16x16x32_bf16 v[32:35],a[0:3],a[144:147],v[32:35]
ds_read_b64_tr_b16 a[104:105],v14 offset:7872
v_mfma_f32_16x16x32_bf16 v[32:35],a[4:7],a[160:163],v[32:35]
ds_read_b64_tr_b16 a[106:107],v14 offset:8768
v_mfma_f32_16x16x32_bf16 v[36:39],a[0:3],a[148:151],v[36:39]
ds_read_b64_tr_b16 a[108:109],v14 offset:23232
v_mfma_f32_16x16x32_bf16 v[36:39],a[4:7],a[164:167],v[36:39]
ds_read_b64_tr_b16 a[110:111],v14 offset:24128
v_mfma_f32_16x16x32_bf16 v[40:43],a[0:3],a[152:155],v[40:43]
v_mfma_f32_16x16x32_bf16 v[40:43],a[4:7],a[168:171],v[40:43]
v_mfma_f32_16x16x32_bf16 v[44:47],a[0:3],a[156:159],v[44:47]
v_mfma_f32_16x16x32_bf16 v[44:47],a[4:7],a[172:175],v[44:47]
s_waitcnt lgkmcnt(0)
v_mfma_f32_16x16x32_bf16 v[48:51],a[8:11],a[144:147],v[48:51]
v_mul_f32 v16,s46,v16
v_mul_f32 v17,s46,v17
v_mfma_f32_16x16x32_bf16 v[48:51],a[12:15],a[160:163],v[48:51]
v_fma_f32 v17,-v16,v16,v17
v_max_f32 v17,0,v17
v_mfma_f32_16x16x32_bf16 v[52:55],a[8:11],a[148:151],v[52:55]
v_cvt_pk_bf16_f32 v18,v17,v17
v_cvt_pk_bf16_f32 v8,-v16,-v16
v_mfma_f32_16x16x32_bf16 v[52:55],a[12:15],a[164:167],v[52:55]
v_and_b32 v18,0xffff0000,v18
v_add_f32 v18,s47,v18
v_mfma_f32_16x16x32_bf16 v[56:59],a[8:11],a[152:155],v[56:59]
v_cvt_pk_bf16_f32 v18,v18,v18
v_mov_b32 v9,v8
v_mfma_f32_16x16x32_bf16 v[56:59],a[12:15],a[168:171],v[56:59]
v_and_b32 v18,0xffff0000,v18
v_mfma_f32_16x16x32_bf16 v[60:63],a[8:11],a[156:159],v[60:63]
v_sqrt_f32 v18,v18
v_mfma_f32_16x16x32_bf16 v[60:63],a[12:15],a[172:175],v[60:63]
v_permlane16_swap_b32 v8,v9
v_mfma_f32_16x16x32_bf16 v[64:67],a[16:19],a[144:147],v[64:67]
v_cvt_pk_bf16_f32 v18,v18,v18
v_and_b32 v24,0xffff0000,v18
v_mfma_f32_16x16x32_bf16 v[64:67],a[20:23],a[160:163],v[64:67]
v_mov_b32 v10,v8
v_mov_b32 v11,v9
v_mfma_f32_16x16x32_bf16 v[68:71],a[16:19],a[148:151],v[68:71]
v_mov_b32 v25,v24
v_mfma_f32_16x16x32_bf16 v[68:71],a[20:23],a[164:167],v[68:71]
v_permlane32_swap_b32 v8,v10
v_mfma_f32_16x16x32_bf16 v[72:75],a[16:19],a[152:155],v[72:75]
v_permlane32_swap_b32 v9,v11
v_mfma_f32_16x16x32_bf16 v[72:75],a[20:23],a[168:171],v[72:75]
v_permlane16_swap_b32 v24,v25
v_mfma_f32_16x16x32_bf16 v[76:79],a[16:19],a[156:159],v[76:79]
v_mov_b32 v26,v24
v_mov_b32 v27,v25
v_mfma_f32_16x16x32_bf16 v[76:79],a[20:23],a[172:175],v[76:79]
s_nop 0
v_mfma_f32_16x16x32_bf16 v[80:83],a[24:27],a[144:147],v[80:83]
v_permlane32_swap_b32 v24,v26
v_mfma_f32_16x16x32_bf16 v[80:83],a[28:31],a[160:163],v[80:83]
v_permlane32_swap_b32 v25,v27
v_mfma_f32_16x16x32_bf16 v[84:87],a[24:27],a[148:151],v[84:87]
v_rcp_f32 v16,v24
v_mfma_f32_16x16x32_bf16 v[84:87],a[28:31],a[164:167],v[84:87]
v_rcp_f32 v17,v25
v_mfma_f32_16x16x32_bf16 v[88:91],a[24:27],a[152:155],v[88:91]
v_rcp_f32 v18,v26
v_mfma_f32_16x16x32_bf16 v[88:91],a[28:31],a[168:171],v[88:91]
v_rcp_f32 v19,v27
v_mfma_f32_16x16x32_bf16 v[92:95],a[24:27],a[156:159],v[92:95]
v_cndmask_b32 v8,0,v8,vcc
v_cndmask_b32 v9,0,v9,vcc
v_mfma_f32_16x16x32_bf16 v[92:95],a[28:31],a[172:175],v[92:95]
v_cndmask_b32 v10,0,v10,vcc
v_cndmask_b32 v11,0,v11,vcc
v_mfma_f32_16x16x32_bf16 v[96:99],a[32:35],a[144:147],v[96:99]
v_mul_f32 v20,v16,v16
v_mul_f32 v21,v17,v17
v_mfma_f32_16x16x32_bf16 v[96:99],a[36:39],a[160:163],v[96:99]
v_mul_f32 v22,v18,v18
v_mul_f32 v23,v19,v19
v_mfma_f32_16x16x32_bf16 v[100:103],a[32:35],a[148:151],v[100:103]
v_mul_f32 v24,v24,v24
v_mul_f32 v25,v25,v25
v_mfma_f32_16x16x32_bf16 v[100:103],a[36:39],a[164:167],v[100:103]
v_mul_f32 v26,v26,v26
v_mul_f32 v27,v27,v27
v_mfma_f32_16x16x32_bf16 v[104:107],a[32:35],a[152:155],v[104:107]
v_mul_f32 v20,v20,v16
v_mul_f32 v21,v21,v17
v_mfma_f32_16x16x32_bf16 v[104:107],a[36:39],a[168:171],v[104:107]
v_mul_f32 v22,v22,v18
v_mul_f32 v23,v23,v19
v_mfma_f32_16x16x32_bf16 v[108:111],a[32:35],a[156:159],v[108:111]
v_mul_f32 v16,s44,v16
v_mul_f32 v17,s44,v17
v_mfma_f32_16x16x32_bf16 v[108:111],a[36:39],a[172:175],v[108:111]
v_mul_f32 v18,s44,v18
v_mul_f32 v19,s44,v19
v_mfma_f32_16x16x32_bf16 v[112:115],a[40:43],a[144:147],v[112:115]
v_mul_f32 v20,s45,v20
v_mul_f32 v21,s45,v21
v_mfma_f32_16x16x32_bf16 v[112:115],a[44:47],a[160:163],v[112:115]
v_mul_f32 v22,s45,v22
v_mul_f32 v23,s45,v23
v_mfma_f32_16x16x32_bf16 v[116:119],a[40:43],a[148:151],v[116:119]
v_accvgpr_write_b32 a232,v8
v_accvgpr_write_b32 a233,v8
v_mfma_f32_16x16x32_bf16 v[116:119],a[44:47],a[164:167],v[116:119]
v_accvgpr_write_b32 a234,v8
v_accvgpr_write_b32 a235,v8
v_mfma_f32_16x16x32_bf16 v[120:123],a[40:43],a[152:155],v[120:123]
v_accvgpr_write_b32 a236,v9
v_accvgpr_write_b32 a237,v9
v_mfma_f32_16x16x32_bf16 v[120:123],a[44:47],a[168:171],v[120:123]
v_accvgpr_write_b32 a238,v9
v_accvgpr_write_b32 a239,v9
v_mfma_f32_16x16x32_bf16 v[124:127],a[40:43],a[156:159],v[124:127]
v_accvgpr_write_b32 a240,v10
v_accvgpr_write_b32 a241,v10
v_mfma_f32_16x16x32_bf16 v[124:127],a[44:47],a[172:175],v[124:127]
v_accvgpr_write_b32 a242,v10
v_accvgpr_write_b32 a243,v10
v_mfma_f32_16x16x32_bf16 v[128:131],a[48:51],a[144:147],v[128:131]
v_accvgpr_write_b32 a244,v11
v_accvgpr_write_b32 a245,v11
v_mfma_f32_16x16x32_bf16 v[128:131],a[52:55],a[160:163],v[128:131]
v_accvgpr_write_b32 a246,v11
v_accvgpr_write_b32 a247,v11
v_mfma_f32_16x16x32_bf16 v[132:135],a[48:51],a[148:151],v[132:135]
v_mfma_f32_16x16x32_bf16 v[132:135],a[52:55],a[164:167],v[132:135]
v_mfma_f32_16x16x32_bf16 v[136:139],a[48:51],a[152:155],v[136:139]
v_mfma_f32_16x16x32_bf16 v[136:139],a[52:55],a[168:171],v[136:139]
v_mfma_f32_16x16x32_bf16 v[140:143],a[48:51],a[156:159],v[140:143]
v_mfma_f32_16x16x32_bf16 v[140:143],a[52:55],a[172:175],v[140:143]
v_mfma_f32_16x16x32_bf16 v[144:147],a[56:59],a[144:147],v[144:147]
v_mfma_f32_16x16x32_bf16 v[144:147],a[60:63],a[160:163],v[144:147]
v_mfma_f32_16x16x32_bf16 v[148:151],a[56:59],a[148:151],v[148:151]
v_mfma_f32_16x16x32_bf16 v[148:151],a[60:63],a[164:167],v[148:151]
v_mfma_f32_16x16x32_bf16 v[152:155],a[56:59],a[152:155],v[152:155]
v_mfma_f32_16x16x32_bf16 v[152:155],a[60:63],a[168:171],v[152:155]
v_mfma_f32_16x16x32_bf16 v[156:159],a[56:59],a[156:159],v[156:159]
v_mfma_f32_16x16x32_bf16 v[156:159],a[60:63],a[172:175],v[156:159]
v_mfma_f32_16x16x32_bf16 v[160:163],a[64:67],a[144:147],v[160:163]
v_mfma_f32_16x16x32_bf16 v[160:163],a[68:71],a[160:163],v[160:163]
v_mfma_f32_16x16x32_bf16 v[164:167],a[64:67],a[148:151],v[164:167]
v_mfma_f32_16x16x32_bf16 v[164:167],a[68:71],a[164:167],v[164:167]
v_mfma_f32_16x16x32_bf16 v[168:171],a[64:67],a[152:155],v[168:171]
v_mfma_f32_16x16x32_bf16 v[168:171],a[68:71],a[168:171],v[168:171]
v_mfma_f32_16x16x32_bf16 v[172:175],a[64:67],a[156:159],v[172:175]
v_mfma_f32_16x16x32_bf16 v[172:175],a[68:71],a[172:175],v[172:175]
v_mfma_f32_16x16x32_bf16 v[176:179],a[72:75],a[144:147],v[176:179]
v_mfma_f32_16x16x32_bf16 v[176:179],a[76:79],a[160:163],v[176:179]
v_mfma_f32_16x16x32_bf16 v[180:183],a[72:75],a[148:151],v[180:183]
v_mfma_f32_16x16x32_bf16 v[180:183],a[76:79],a[164:167],v[180:183]
v_mfma_f32_16x16x32_bf16 v[184:187],a[72:75],a[152:155],v[184:187]
v_mfma_f32_16x16x32_bf16 v[184:187],a[76:79],a[168:171],v[184:187]
v_mfma_f32_16x16x32_bf16 v[188:191],a[72:75],a[156:159],v[188:191]
v_mfma_f32_16x16x32_bf16 v[188:191],a[76:79],a[172:175],v[188:191]
v_mfma_f32_16x16x32_bf16 v[192:195],a[80:83],a[144:147],v[192:195]
v_mfma_f32_16x16x32_bf16 v[192:195],a[84:87],a[160:163],v[192:195]
v_mfma_f32_16x16x32_bf16 v[196:199],a[80:83],a[148:151],v[196:199]
v_mfma_f32_16x16x32_bf16 v[196:199],a[84:87],a[164:167],v[196:199]
v_mfma_f32_16x16x32_bf16 v[200:203],a[80:83],a[152:155],v[200:203]
v_mfma_f32_16x16x32_bf16 v[200:203],a[84:87],a[168:171],v[200:203]
v_mfma_f32_16x16x32_bf16 v[204:207],a[80:83],a[156:159],v[204:207]
v_mfma_f32_16x16x32_bf16 v[204:207],a[84:87],a[172:175],v[204:207]
v_mfma_f32_16x16x32_bf16 v[208:211],a[88:91],a[144:147],v[208:211]
v_mfma_f32_16x16x32_bf16 v[208:211],a[92:95],a[160:163],v[208:211]
v_mfma_f32_16x16x32_bf16 v[212:215],a[88:91],a[148:151],v[212:215]
v_mfma_f32_16x16x32_bf16 v[212:215],a[92:95],a[164:167],v[212:215]
v_mfma_f32_16x16x32_bf16 v[216:219],a[88:91],a[152:155],v[216:219]
v_mfma_f32_16x16x32_bf16 v[216:219],a[92:95],a[168:171],v[216:219]
v_mfma_f32_16x16x32_bf16 v[220:223],a[88:91],a[156:159],v[220:223]
v_mfma_f32_16x16x32_bf16 v[220:223],a[92:95],a[172:175],v[220:223]
v_mfma_f32_16x16x32_bf16 v[224:227],a[96:99],a[144:147],v[224:227]
v_mfma_f32_16x16x32_bf16 v[224:227],a[100:103],a[160:163],v[224:227]
v_mfma_f32_16x16x32_bf16 v[228:231],a[96:99],a[148:151],v[228:231]
v_mfma_f32_16x16x32_bf16 v[228:231],a[100:103],a[164:167],v[228:231]
v_mfma_f32_16x16x32_bf16 v[232:235],a[96:99],a[152:155],v[232:235]
v_mfma_f32_16x16x32_bf16 v[232:235],a[100:103],a[168:171],v[232:235]
v_mfma_f32_16x16x32_bf16 v[236:239],a[96:99],a[156:159],v[236:239]
v_mfma_f32_16x16x32_bf16 v[236:239],a[100:103],a[172:175],v[236:239]
v_mfma_f32_16x16x32_bf16 v[240:243],a[104:107],a[144:147],v[240:243]
v_mfma_f32_16x16x32_bf16 v[240:243],a[108:111],a[160:163],v[240:243]
v_mfma_f32_16x16x32_bf16 v[244:247],a[104:107],a[148:151],v[244:247]
v_mfma_f32_16x16x32_bf16 v[244:247],a[108:111],a[164:167],v[244:247]
v_mfma_f32_16x16x32_bf16 v[248:251],a[104:107],a[152:155],v[248:251]
v_mfma_f32_16x16x32_bf16 v[248:251],a[108:111],a[168:171],v[248:251]
v_mfma_f32_16x16x32_bf16 v[252:255],a[104:107],a[156:159],v[252:255]
v_mfma_f32_16x16x32_bf16 v[252:255],a[108:111],a[172:175],v[252:255]
s_waitcnt vmcnt(0)
s_barrier
s_call_b64 s[98:99],Lsub_p3e
s_waitcnt vmcnt(0)
s_barrier
s_cmp_lg_u32 s20,0
s_cbranch_scc1 Lpub204
s_lshl_b32 s18,s86,1
s_lshr_b32 s19,s87,4
s_add_u32 s18,s18,s19
s_and_b32 s19,s87,15
s_lshl_b32 s18,s18,8
s_lshl_b32 s19,s19,2
s_add_u32 s18,s18,s19
s_add_u32 s18,s18,95748096
v_mov_b32 v1,0
v_mov_b32 v3,s94
s_mov_b64 exec,1
buffer_store_dword v3,v1,s[24:27],s18 offen sc1
s_mov_b64 exec,-1
Lpub204:
s_add_u32 s8,s16,12648448
s_addc_u32 s9,s17,0
s_mov_b32 s10,14680064
s_add_u32 s56,s16,4259840
s_addc_u32 s57,s17,0
s_mov_b32 s58,4194304
s_lshl_b32 s23,s84,7
s_lshr_b32 s28,s20,1
s_and_b32 s29,s20,1
s_lshl_b32 s18,s20,5
s_add_u32 s33,s23,s18
s_mul_i32 s19,s33,7168
v_lshlrev_b32 v4,4,v2
v_add_u32 v4,s19,v4
v_add_u32 v5,112640,v4
s_mul_i32 s30,s88,57344
s_mov_b32 s34,0
s_lshl_b32 s40,s20,12
s_and_b32 s54,s85,7
s_lshl_b32 s54,s54,1
s_add_u32 s54,s54,s29
s_lshl_b32 s18,s28,6
s_add_u32 s18,s18,s23
s_lshl_b32 s19,s88,5
s_add_u32 s18,s18,s19
s_mov_b32 s60,32768
s_lshl_b32 s61,s18,11
s_lshl_b32 s19,s54,11
s_add_u32 s19,s19,s61
v_lshlrev_b32 v22,4,v30
v_and_b32 v1,1,v31
v_lshl_add_u32 v22,v1,3,v22
v_lshrrev_b32 v1,1,v31
v_lshl_add_u32 v22,v1,8,v22
v_add_u32 v22,s19,v22
s_lshl_b32 s19,s54,7
s_add_u32 s19,s19,s61
s_mov_b32 s93,s19
v_lshlrev_b32 v18,11,v30
v_and_b32 v1,1,v31
v_lshl_add_u32 v18,v1,5,v18
v_lshrrev_b32 v1,1,v31
v_lshl_add_u32 v18,v1,4,v18
v_add_u32 v18,s19,v18
s_lshl_b32 s18,s18,7
s_lshr_b32 s19,s54,1
s_lshl_b32 s19,s19,8
s_add_u32 s18,s18,s19
s_and_b32 s19,s54,1
s_lshl_b32 s19,s19,3
s_add_u32 s18,s18,s19
v_lshlrev_b32 v19,4,v30
v_add_u32 v19,s18,v19
s_lshl_b32 s18,s28,13
s_lshl_b32 s19,s88,12
v_lshlrev_b32 v1,4,v2
v_add_u32 v1,s18,v1
v_add_u32 v13,s19,v1
s_sub_u32 s19,4096,s19
v_add_u32 v12,s19,v1
s_lshl_b32 s18,s29,13
s_add_u32 s18,s18,16384
v_bfe_u32 v1,v2,2,2
v_lshl_add_u32 v3,v31,3,v1
v_lshlrev_b32 v3,7,v3
v_add_u32 v3,s18,v3
v_and_b32 v0,1,v2
v_lshl_add_u32 v3,v0,3,v3
v_and_b32 v1,2,v1
v_and_b32 v0,1,v31
v_lshl_add_u32 v1,v0,2,v1
v_bfe_u32 v0,v2,1,1
v_or_b32 v1,v1,v0
v_xor_b32 v0,0,v1
v_lshl_add_u32 v14,v0,4,v3
v_xor_b32 v0,2,v1
v_lshl_add_u32 v15,v0,4,v3
v_xor_b32 v0,4,v1
v_lshl_add_u32 v16,v0,4,v3
v_xor_b32 v0,6,v1
v_lshl_add_u32 v17,v0,4,v3
s_lshl_b32 s18,s2,2
s_add_u32 s18,s18,s20
s_xor_b32 s19,s18,4
s_lshl_b32 s18,s18,12
s_add_u32 s18,s18,81854464
s_lshl_b32 s19,s19,12
s_add_u32 s19,s19,81854464
v_lshlrev_b32 v1,4,v2
v_add_u32 v20,s18,v1
v_add_u32 v21,s19,v1
s_mov_b32 s55,4096
s_mov_b32 s36,0
s_mov_b32 s42,0
s_mov_b32 s50,32768
s_mov_b32 s51,0xfffe0000
s_cmp_lg_u32 s20,0
s_cbranch_scc1 Lwbar205
s_and_b32 s18,s84,14
s_add_u32 s18,s18,s88
s_lshl_b32 s18,s18,8
s_add_u32 s18,s18,95748096
v_lshlrev_b32 v1,2,v30
v_lshl_add_u32 v1,v31,8,v1
s_mov_b32 exec_lo,0xffff
s_mov_b32 exec_hi,0
s_mov_b32 s39,131072
Lpoll206:
buffer_load_dword v3,v1,s[24:27],s18 offen sc1
s_waitcnt vmcnt(0)
v_cmp_ne_u32 vcc,s94,v3
s_nop 1
s_cmp_eq_u64 vcc,0
s_cbranch_scc1 Lgot207
s_sleep 1
s_sub_u32 s39,s39,1
s_cmp_lg_u32 s39,0
s_cbranch_scc1 Lpoll206
Lgot207:
s_mov_b64 exec,-1
Lwbar205:
s_barrier
s_add_u32 m0,s34,s40
s_nop 0
buffer_load_dwordx4 v4,s[8:11],s30 offen sc1 lds
buffer_load_dwordx4 v4,s[8:11],s30 offen offset:1024 sc1 lds
buffer_load_dwordx4 v5,s[8:11],s30 offen offset:2048 sc1 lds
buffer_load_dwordx4 v5,s[8:11],s30 offen offset:3072 sc1 lds
s_add_u32 s34,s34,32768
s_cmp_eq_u32 s34,163840
s_cselect_b32 s34,0,s34
s_add_u32 s30,s30,2048
s_add_u32 m0,s34,s40
s_nop 0
buffer_load_dwordx4 v4,s[8:11],s30 offen sc1 lds
buffer_load_dwordx4 v4,s[8:11],s30 offen offset:1024 sc1 lds
buffer_load_dwordx4 v5,s[8:11],s30 offen offset:2048 sc1 lds
buffer_load_dwordx4 v5,s[8:11],s30 offen offset:3072 sc1 lds
s_add_u32 s34,s34,32768
s_cmp_eq_u32 s34,163840
s_cselect_b32 s34,0,s34
s_add_u32 s30,s30,2048
s_add_u32 m0,s34,s40
s_nop 0
buffer_load_dwordx4 v4,s[8:11],s30 offen sc1 lds
buffer_load_dwordx4 v4,s[8:11],s30 offen offset:1024 sc1 lds
buffer_load_dwordx4 v5,s[8:11],s30 offen offset:2048 sc1 lds
buffer_load_dwordx4 v5,s[8:11],s30 offen offset:3072 sc1 lds
s_add_u32 s34,s34,32768
s_cmp_eq_u32 s34,163840
s_cselect_b32 s34,0,s34
s_add_u32 s30,s30,2048
s_waitcnt vmcnt(8)
s_barrier
ds_read_b128 v[96:99],v12 offset:0
ds_read_b64_tr_b16 v[112:113],v14 offset:0
ds_read_b64_tr_b16 v[114:115],v14 offset:512
ds_read_b128 v[128:131],v12 offset:1024
ds_read_b64_tr_b16 v[144:145],v14 offset:4096
ds_read_b64_tr_b16 v[146:147],v14 offset:4608
ds_read_b128 v[100:103],v12 offset:2048
ds_read_b128 v[132:135],v12 offset:3072
ds_read_b128 v[104:107],v13 offset:0
ds_read_b128 v[136:139],v13 offset:1024
ds_read_b128 v[108:111],v13 offset:2048
ds_read_b128 v[140:143],v13 offset:3072
ds_read_b64_tr_b16 v[116:117],v15 offset:0
ds_read_b64_tr_b16 v[118:119],v15 offset:512
ds_read_b64_tr_b16 v[148:149],v15 offset:4096
ds_read_b64_tr_b16 v[150:151],v15 offset:4608
ds_read_b64_tr_b16 v[120:121],v16 offset:0
ds_read_b64_tr_b16 v[122:123],v16 offset:512
ds_read_b64_tr_b16 v[152:153],v16 offset:4096
ds_read_b64_tr_b16 v[154:155],v16 offset:4608
ds_read_b64_tr_b16 v[124:125],v17 offset:0
ds_read_b64_tr_b16 v[126:127],v17 offset:512
ds_read_b64_tr_b16 v[156:157],v17 offset:4096
ds_read_b64_tr_b16 v[158:159],v17 offset:4608
s_add_u32 s36,s36,32768
s_cmp_eq_u32 s36,163840
s_cselect_b32 s42,s51,s50
s_cselect_b32 s36,0,s36
s_waitcnt lgkmcnt(12)
v_mfma_f32_16x16x32_bf16 v[32:35],v[112:115],v[96:99],0
v_add_u32 v12,s42,v12
v_add_u32 v13,s42,v13
v_mfma_f32_16x16x32_bf16 v[32:35],v[144:147],v[128:131],v[32:35]
v_add_u32 v14,s42,v14
v_add_u32 v15,s42,v15
v_mfma_f32_16x16x32_bf16 v[36:39],v[112:115],v[100:103],0
v_add_u32 v16,s42,v16
v_add_u32 v17,s42,v17
v_mfma_f32_16x16x32_bf16 v[36:39],v[144:147],v[132:135],v[36:39]
s_waitcnt vmcnt(4)
s_waitcnt lgkmcnt(0)
s_barrier
ds_read_b128 v[208:211],v12 offset:0
v_mfma_f32_16x16x32_bf16 v[40:43],v[112:115],v[104:107],0
ds_read_b64_tr_b16 v[224:225],v14 offset:0
s_add_u32 m0,s34,s40
v_mfma_f32_16x16x32_bf16 v[40:43],v[144:147],v[136:139],v[40:43]
ds_read_b64_tr_b16 v[226:227],v14 offset:512
buffer_load_dwordx4 v4,s[8:11],s30 offen sc1 lds
v_mfma_f32_16x16x32_bf16 v[44:47],v[112:115],v[108:111],0
ds_read_b128 v[240:243],v12 offset:1024
s_add_u32 s36,s36,32768
v_mfma_f32_16x16x32_bf16 v[44:47],v[144:147],v[140:143],v[44:47]
ds_read_b64_tr_b16 a[0:1],v14 offset:4096
buffer_load_dwordx4 v4,s[8:11],s30 offen offset:1024 sc1 lds
v_mfma_f32_16x16x32_bf16 v[48:51],v[116:119],v[96:99],0
ds_read_b64_tr_b16 a[2:3],v14 offset:4608
v_mfma_f32_16x16x32_bf16 v[48:51],v[148:151],v[128:131],v[48:51]
ds_read_b128 v[212:215],v12 offset:2048
buffer_load_dwordx4 v5,s[8:11],s30 offen offset:2048 sc1 lds
v_mfma_f32_16x16x32_bf16 v[52:55],v[116:119],v[100:103],0
ds_read_b128 v[244:247],v12 offset:3072
v_mfma_f32_16x16x32_bf16 v[52:55],v[148:151],v[132:135],v[52:55]
buffer_load_dwordx4 v5,s[8:11],s30 offen offset:3072 sc1 lds
s_add_u32 s34,s34,32768
v_mfma_f32_16x16x32_bf16 v[56:59],v[116:119],v[104:107],0
ds_read_b128 v[216:219],v13 offset:0
v_mfma_f32_16x16x32_bf16 v[56:59],v[148:151],v[136:139],v[56:59]
ds_read_b128 v[248:251],v13 offset:1024
v_mfma_f32_16x16x32_bf16 v[60:63],v[116:119],v[108:111],0
s_cmp_eq_u32 s34,163840
s_cselect_b32 s34,0,s34
v_mfma_f32_16x16x32_bf16 v[60:63],v[148:151],v[140:143],v[60:63]
ds_read_b128 v[220:223],v13 offset:2048
s_add_u32 s30,s30,2048
v_mfma_f32_16x16x32_bf16 v[64:67],v[120:123],v[96:99],0
s_add_u32 m0,s34,s40
s_nop 0
buffer_load_dwordx4 v4,s[8:11],s30 offen sc1 lds
v_mfma_f32_16x16x32_bf16 v[64:67],v[152:155],v[128:131],v[64:67]
ds_read_b128 v[252:255],v13 offset:3072
buffer_load_dwordx4 v4,s[8:11],s30 offen offset:1024 sc1 lds
v_mfma_f32_16x16x32_bf16 v[68:71],v[120:123],v[100:103],0
ds_read_b64_tr_b16 v[228:229],v15 offset:0
buffer_load_dwordx4 v5,s[8:11],s30 offen offset:2048 sc1 lds
v_mfma_f32_16x16x32_bf16 v[68:71],v[152:155],v[132:135],v[68:71]
ds_read_b64_tr_b16 v[230:231],v15 offset:512
v_mfma_f32_16x16x32_bf16 v[72:75],v[120:123],v[104:107],0
ds_read_b64_tr_b16 a[4:5],v15 offset:4096
ds_read_b64_tr_b16 a[6:7],v15 offset:4608
v_mfma_f32_16x16x32_bf16 v[72:75],v[152:155],v[136:139],v[72:75]
ds_read_b64_tr_b16 v[232:233],v16 offset:0
buffer_load_dwordx4 v5,s[8:11],s30 offen offset:3072 sc1 lds
v_mfma_f32_16x16x32_bf16 v[76:79],v[120:123],v[108:111],0
ds_read_b64_tr_b16 v[234:235],v16 offset:512
s_add_u32 s34,s34,32768
v_mfma_f32_16x16x32_bf16 v[76:79],v[152:155],v[140:143],v[76:79]
ds_read_b64_tr_b16 a[8:9],v16 offset:4096
v_mfma_f32_16x16x32_bf16 v[80:83],v[124:127],v[96:99],0
ds_read_b64_tr_b16 a[10:11],v16 offset:4608
ds_read_b64_tr_b16 v[236:237],v17 offset:0
v_mfma_f32_16x16x32_bf16 v[80:83],v[156:159],v[128:131],v[80:83]
ds_read_b64_tr_b16 v[238:239],v17 offset:512
v_mfma_f32_16x16x32_bf16 v[84:87],v[124:127],v[100:103],0
ds_read_b64_tr_b16 a[12:13],v17 offset:4096
v_mfma_f32_16x16x32_bf16 v[84:87],v[156:159],v[132:135],v[84:87]
ds_read_b64_tr_b16 a[14:15],v17 offset:4608
v_mfma_f32_16x16x32_bf16 v[88:91],v[124:127],v[104:107],0
s_cmp_eq_u32 s34,163840
s_cselect_b32 s34,0,s34
v_mfma_f32_16x16x32_bf16 v[88:91],v[156:159],v[136:139],v[88:91]
s_add_u32 s30,s30,2048
s_add_u32 m0,s34,s40
v_mfma_f32_16x16x32_bf16 v[92:95],v[124:127],v[108:111],0
buffer_load_dwordx4 v4,s[8:11],s30 offen sc1 lds
buffer_load_dwordx4 v4,s[8:11],s30 offen offset:1024 sc1 lds
v_mfma_f32_16x16x32_bf16 v[92:95],v[156:159],v[140:143],v[92:95]
buffer_load_dwordx4 v5,s[8:11],s30 offen offset:2048 sc1 lds
buffer_load_dwordx4 v5,s[8:11],s30 offen offset:3072 sc1 lds
s_add_u32 s34,s34,32768
s_cmp_eq_u32 s34,163840
s_cselect_b32 s34,0,s34
s_add_u32 s30,s30,2048
s_cmp_eq_u32 s36,163840
s_cselect_b32 s42,s51,s50
s_cselect_b32 s36,0,s36
s_waitcnt lgkmcnt(12)
v_mfma_f32_16x16x32_bf16 v[32:35],v[224:227],v[208:211],v[32:35]
v_add_u32 v12,s42,v12
v_add_u32 v13,s42,v13
v_mfma_f32_16x16x32_bf16 v[32:35],a[0:3],v[240:243],v[32:35]
v_add_u32 v14,s42,v14
v_add_u32 v15,s42,v15
v_mfma_f32_16x16x32_bf16 v[36:39],v[224:227],v[212:215],v[36:39]
v_add_u32 v16,s42,v16
v_add_u32 v17,s42,v17
v_mfma_f32_16x16x32_bf16 v[36:39],a[0:3],v[244:247],v[36:39]
s_waitcnt vmcnt(12)
s_waitcnt lgkmcnt(0)
s_barrier
ds_read_b128 v[96:99],v12 offset:0
v_mfma_f32_16x16x32_bf16 v[40:43],v[224:227],v[216:219],v[40:43]
ds_read_b64_tr_b16 v[112:113],v14 offset:0
s_add_u32 m0,s35,s41
v_mfma_f32_16x16x32_bf16 v[40:43],a[0:3],v[248:251],v[40:43]
ds_read_b64_tr_b16 v[114:115],v14 offset:512
buffer_load_dwordx4 v8,s[12:15],s32 offen lds
v_mfma_f32_16x16x32_bf16 v[44:47],v[224:227],v[220:223],v[44:47]
ds_read_b128 v[128:131],v12 offset:1024
s_add_u32 s36,s36,32768
v_mfma_f32_16x16x32_bf16 v[44:47],a[0:3],v[252:255],v[44:47]
ds_read_b64_tr_b16 v[144:145],v14 offset:4096
buffer_load_dwordx4 v9,s[12:15],s32 offen offset:1024 lds
v_mfma_f32_16x16x32_bf16 v[48:51],v[228:231],v[208:211],v[48:51]
ds_read_b64_tr_b16 v[146:147],v14 offset:4608
v_mfma_f32_16x16x32_bf16 v[48:51],a[4:7],v[240:243],v[48:51]
ds_read_b128 v[100:103],v12 offset:2048
buffer_load_dwordx4 v10,s[12:15],s32 offen offset:2048 lds
v_mfma_f32_16x16x32_bf16 v[52:55],v[228:231],v[212:215],v[52:55]
ds_read_b128 v[132:135],v12 offset:3072
v_mfma_f32_16x16x32_bf16 v[52:55],a[4:7],v[244:247],v[52:55]
buffer_load_dwordx4 v11,s[12:15],s32 offen offset:3072 lds
s_add_u32 s35,s35,32768
v_mfma_f32_16x16x32_bf16 v[56:59],v[228:231],v[216:219],v[56:59]
ds_read_b128 v[104:107],v13 offset:0
v_mfma_f32_16x16x32_bf16 v[56:59],a[4:7],v[248:251],v[56:59]
ds_read_b128 v[136:139],v13 offset:1024
v_mfma_f32_16x16x32_bf16 v[60:63],v[228:231],v[220:223],v[60:63]
s_cmp_eq_u32 s35,163840
s_cselect_b32 s35,0,s35
v_mfma_f32_16x16x32_bf16 v[60:63],a[4:7],v[252:255],v[60:63]
ds_read_b128 v[108:111],v13 offset:2048
s_add_u32 s32,s32,131072
v_mfma_f32_16x16x32_bf16 v[64:67],v[232:235],v[208:211],v[64:67]
s_add_u32 m0,s34,s40
s_nop 0
buffer_load_dwordx4 v4,s[8:11],s30 offen sc1 lds
v_mfma_f32_16x16x32_bf16 v[64:67],a[8:11],v[240:243],v[64:67]
ds_read_b128 v[140:143],v13 offset:3072
buffer_load_dwordx4 v4,s[8:11],s30 offen offset:1024 sc1 lds
v_mfma_f32_16x16x32_bf16 v[68:71],v[232:235],v[212:215],v[68:71]
ds_read_b64_tr_b16 v[116:117],v15 offset:0
buffer_load_dwordx4 v5,s[8:11],s30 offen offset:2048 sc1 lds
v_mfma_f32_16x16x32_bf16 v[68:71],a[8:11],v[244:247],v[68:71]
ds_read_b64_tr_b16 v[118:119],v15 offset:512
v_mfma_f32_16x16x32_bf16 v[72:75],v[232:235],v[216:219],v[72:75]
ds_read_b64_tr_b16 v[148:149],v15 offset:4096
ds_read_b64_tr_b16 v[150:151],v15 offset:4608
v_mfma_f32_16x16x32_bf16 v[72:75],a[8:11],v[248:251],v[72:75]
ds_read_b64_tr_b16 v[120:121],v16 offset:0
buffer_load_dwordx4 v5,s[8:11],s30 offen offset:3072 sc1 lds
v_mfma_f32_16x16x32_bf16 v[76:79],v[232:235],v[220:223],v[76:79]
ds_read_b64_tr_b16 v[122:123],v16 offset:512
s_add_u32 s34,s34,32768
v_mfma_f32_16x16x32_bf16 v[76:79],a[8:11],v[252:255],v[76:79]
ds_read_b64_tr_b16 v[152:153],v16 offset:4096
v_mfma_f32_16x16x32_bf16 v[80:83],v[236:239],v[208:211],v[80:83]
ds_read_b64_tr_b16 v[154:155],v16 offset:4608
ds_read_b64_tr_b16 v[124:125],v17 offset:0
v_mfma_f32_16x16x32_bf16 v[80:83],a[12:15],v[240:243],v[80:83]
ds_read_b64_tr_b16 v[126:127],v17 offset:512
v_mfma_f32_16x16x32_bf16 v[84:87],v[236:239],v[212:215],v[84:87]
ds_read_b64_tr_b16 v[156:157],v17 offset:4096
v_mfma_f32_16x16x32_bf16 v[84:87],a[12:15],v[244:247],v[84:87]
ds_read_b64_tr_b16 v[158:159],v17 offset:4608
v_mfma_f32_16x16x32_bf16 v[88:91],v[236:239],v[216:219],v[88:91]
s_cmp_eq_u32 s34,163840
s_cselect_b32 s34,0,s34
v_mfma_f32_16x16x32_bf16 v[88:91],a[12:15],v[248:251],v[88:91]
s_add_u32 s30,s30,2048
s_add_u32 m0,s35,s41
v_mfma_f32_16x16x32_bf16 v[92:95],v[236:239],v[220:223],v[92:95]
buffer_load_dwordx4 v8,s[12:15],s32 offen lds
buffer_load_dwordx4 v9,s[12:15],s32 offen offset:1024 lds
v_mfma_f32_16x16x32_bf16 v[92:95],a[12:15],v[252:255],v[92:95]
buffer_load_dwordx4 v10,s[12:15],s32 offen offset:2048 lds
buffer_load_dwordx4 v11,s[12:15],s32 offen offset:3072 lds
s_add_u32 s35,s35,32768
s_cmp_eq_u32 s35,163840
s_cselect_b32 s35,0,s35
s_add_u32 s32,s32,131072
s_cmp_eq_u32 s36,163840
s_cselect_b32 s42,s51,s50
s_cselect_b32 s36,0,s36
s_waitcnt lgkmcnt(12)
v_mfma_f32_16x16x32_bf16 v[32:35],v[112:115],v[96:99],v[32:35]
v_add_u32 v12,s42,v12
v_add_u32 v13,s42,v13
v_mfma_f32_16x16x32_bf16 v[32:35],v[144:147],v[128:131],v[32:35]
v_add_u32 v14,s42,v14
v_add_u32 v15,s42,v15
v_mfma_f32_16x16x32_bf16 v[36:39],v[112:115],v[100:103],v[36:39]
v_add_u32 v16,s42,v16
v_add_u32 v17,s42,v17
v_mfma_f32_16x16x32_bf16 v[36:39],v[144:147],v[132:135],v[36:39]
s_waitcnt vmcnt(20)
s_waitcnt lgkmcnt(0)
s_barrier
ds_read_b128 v[208:211],v12 offset:0
v_mfma_f32_16x16x32_bf16 v[40:43],v[112:115],v[104:107],v[40:43]
ds_read_b64_tr_b16 v[224:225],v14 offset:0
s_add_u32 m0,s34,s40
v_mfma_f32_16x16x32_bf16 v[40:43],v[144:147],v[136:139],v[40:43]
ds_read_b64_tr_b16 v[226:227],v14 offset:512
buffer_load_dwordx4 v4,s[8:11],s30 offen sc1 lds
v_mfma_f32_16x16x32_bf16 v[44:47],v[112:115],v[108:111],v[44:47]
ds_read_b128 v[240:243],v12 offset:1024
s_add_u32 s36,s36,32768
v_mfma_f32_16x16x32_bf16 v[44:47],v[144:147],v[140:143],v[44:47]
ds_read_b64_tr_b16 a[0:1],v14 offset:4096
v_mfma_f32_16x16x32_bf16 v[48:51],v[116:119],v[96:99],v[48:51]
ds_read_b64_tr_b16 a[2:3],v14 offset:4608
buffer_load_dwordx4 v4,s[8:11],s30 offen offset:1024 sc1 lds
v_mfma_f32_16x16x32_bf16 v[48:51],v[148:151],v[128:131],v[48:51]
ds_read_b128 v[212:215],v12 offset:2048
v_mfma_f32_16x16x32_bf16 v[52:55],v[116:119],v[100:103],v[52:55]
ds_read_b128 v[244:247],v12 offset:3072
v_mfma_f32_16x16x32_bf16 v[52:55],v[148:151],v[132:135],v[52:55]
buffer_load_dwordx4 v5,s[8:11],s30 offen offset:2048 sc1 lds
v_mfma_f32_16x16x32_bf16 v[56:59],v[116:119],v[104:107],v[56:59]
ds_read_b128 v[216:219],v13 offset:0
v_mfma_f32_16x16x32_bf16 v[56:59],v[148:151],v[136:139],v[56:59]
ds_read_b128 v[248:251],v13 offset:1024
v_mfma_f32_16x16x32_bf16 v[60:63],v[116:119],v[108:111],v[60:63]
buffer_load_dwordx4 v5,s[8:11],s30 offen offset:3072 sc1 lds
s_add_u32 s34,s34,32768
v_mfma_f32_16x16x32_bf16 v[60:63],v[148:151],v[140:143],v[60:63]
ds_read_b128 v[220:223],v13 offset:2048
v_mfma_f32_16x16x32_bf16 v[64:67],v[120:123],v[96:99],v[64:67]
s_cmp_eq_u32 s34,163840
s_cselect_b32 s34,0,s34
v_mfma_f32_16x16x32_bf16 v[64:67],v[152:155],v[128:131],v[64:67]
ds_read_b128 v[252:255],v13 offset:3072
s_add_u32 s30,s30,2048
v_mfma_f32_16x16x32_bf16 v[68:71],v[120:123],v[100:103],v[68:71]
ds_read_b64_tr_b16 v[228:229],v15 offset:0
s_add_u32 m0,s35,s41
v_mfma_f32_16x16x32_bf16 v[68:71],v[152:155],v[132:135],v[68:71]
ds_read_b64_tr_b16 v[230:231],v15 offset:512
buffer_load_dwordx4 v8,s[12:15],s32 offen lds
v_mfma_f32_16x16x32_bf16 v[72:75],v[120:123],v[104:107],v[72:75]
ds_read_b64_tr_b16 a[4:5],v15 offset:4096
ds_read_b64_tr_b16 a[6:7],v15 offset:4608
v_mfma_f32_16x16x32_bf16 v[72:75],v[152:155],v[136:139],v[72:75]
ds_read_b64_tr_b16 v[232:233],v16 offset:0
buffer_load_dwordx4 v9,s[12:15],s32 offen offset:1024 lds
v_mfma_f32_16x16x32_bf16 v[76:79],v[120:123],v[108:111],v[76:79]
ds_read_b64_tr_b16 v[234:235],v16 offset:512
v_mfma_f32_16x16x32_bf16 v[76:79],v[152:155],v[140:143],v[76:79]
ds_read_b64_tr_b16 a[8:9],v16 offset:4096
v_mfma_f32_16x16x32_bf16 v[80:83],v[124:127],v[96:99],v[80:83]
ds_read_b64_tr_b16 a[10:11],v16 offset:4608
ds_read_b64_tr_b16 v[236:237],v17 offset:0
v_mfma_f32_16x16x32_bf16 v[80:83],v[156:159],v[128:131],v[80:83]
ds_read_b64_tr_b16 v[238:239],v17 offset:512
buffer_load_dwordx4 v10,s[12:15],s32 offen offset:2048 lds
v_mfma_f32_16x16x32_bf16 v[84:87],v[124:127],v[100:103],v[84:87]
ds_read_b64_tr_b16 a[12:13],v17 offset:4096
v_mfma_f32_16x16x32_bf16 v[84:87],v[156:159],v[132:135],v[84:87]
ds_read_b64_tr_b16 a[14:15],v17 offset:4608
buffer_load_dwordx4 v11,s[12:15],s32 offen offset:3072 lds
v_mfma_f32_16x16x32_bf16 v[88:91],v[124:127],v[104:107],v[88:91]
s_add_u32 s35,s35,32768
v_mfma_f32_16x16x32_bf16 v[88:91],v[156:159],v[136:139],v[88:91]
s_cmp_eq_u32 s35,163840
s_cselect_b32 s35,0,s35
v_mfma_f32_16x16x32_bf16 v[92:95],v[124:127],v[108:111],v[92:95]
s_add_u32 s32,s32,131072
v_mfma_f32_16x16x32_bf16 v[92:95],v[156:159],v[140:143],v[92:95]
s_cmp_eq_u32 s36,163840
s_cselect_b32 s42,s51,s50
s_cselect_b32 s36,0,s36
s_waitcnt lgkmcnt(12)
v_mfma_f32_16x16x32_bf16 v[32:35],v[224:227],v[208:211],v[32:35]
v_add_u32 v12,s42,v12
v_add_u32 v13,s42,v13
v_mfma_f32_16x16x32_bf16 v[32:35],a[0:3],v[240:243],v[32:35]
v_add_u32 v14,s42,v14
v_add_u32 v15,s42,v15
v_mfma_f32_16x16x32_bf16 v[36:39],v[224:227],v[212:215],v[36:39]
v_add_u32 v16,s42,v16
v_add_u32 v17,s42,v17
v_mfma_f32_16x16x32_bf16 v[36:39],a[0:3],v[244:247],v[36:39]
s_waitcnt vmcnt(24)
s_waitcnt lgkmcnt(0)
s_barrier
ds_read_b128 v[96:99],v12 offset:0
v_mfma_f32_16x16x32_bf16 v[40:43],v[224:227],v[216:219],v[40:43]
ds_read_b64_tr_b16 v[112:113],v14 offset:0
s_add_u32 m0,s34,s40
v_mfma_f32_16x16x32_bf16 v[40:43],a[0:3],v[248:251],v[40:43]
ds_read_b64_tr_b16 v[114:115],v14 offset:512
buffer_load_dwordx4 v4,s[8:11],s30 offen sc1 lds
v_mfma_f32_16x16x32_bf16 v[44:47],v[224:227],v[220:223],v[44:47]
ds_read_b128 v[128:131],v12 offset:1024
s_add_u32 s36,s36,32768
v_mfma_f32_16x16x32_bf16 v[44:47],a[0:3],v[252:255],v[44:47]
ds_read_b64_tr_b16 v[144:145],v14 offset:4096
v_mfma_f32_16x16x32_bf16 v[48:51],v[228:231],v[208:211],v[48:51]
ds_read_b64_tr_b16 v[146:147],v14 offset:4608
buffer_load_dwordx4 v4,s[8:11],s30 offen offset:1024 sc1 lds
v_mfma_f32_16x16x32_bf16 v[48:51],a[4:7],v[240:243],v[48:51]
ds_read_b128 v[100:103],v12 offset:2048
v_mfma_f32_16x16x32_bf16 v[52:55],v[228:231],v[212:215],v[52:55]
ds_read_b128 v[132:135],v12 offset:3072
v_mfma_f32_16x16x32_bf16 v[52:55],a[4:7],v[244:247],v[52:55]
buffer_load_dwordx4 v5,s[8:11],s30 offen offset:2048 sc1 lds
v_mfma_f32_16x16x32_bf16 v[56:59],v[228:231],v[216:219],v[56:59]
ds_read_b128 v[104:107],v13 offset:0
v_mfma_f32_16x16x32_bf16 v[56:59],a[4:7],v[248:251],v[56:59]
ds_read_b128 v[136:139],v13 offset:1024
v_mfma_f32_16x16x32_bf16 v[60:63],v[228:231],v[220:223],v[60:63]
buffer_load_dwordx4 v5,s[8:11],s30 offen offset:3072 sc1 lds
s_add_u32 s34,s34,32768
v_mfma_f32_16x16x32_bf16 v[60:63],a[4:7],v[252:255],v[60:63]
ds_read_b128 v[108:111],v13 offset:2048
v_mfma_f32_16x16x32_bf16 v[64:67],v[232:235],v[208:211],v[64:67]
s_cmp_eq_u32 s34,163840
s_cselect_b32 s34,0,s34
v_mfma_f32_16x16x32_bf16 v[64:67],a[8:11],v[240:243],v[64:67]
ds_read_b128 v[140:143],v13 offset:3072
s_add_u32 s30,s30,2048
v_mfma_f32_16x16x32_bf16 v[68:71],v[232:235],v[212:215],v[68:71]
ds_read_b64_tr_b16 v[116:117],v15 offset:0
s_add_u32 m0,s35,s41
v_mfma_f32_16x16x32_bf16 v[68:71],a[8:11],v[244:247],v[68:71]
ds_read_b64_tr_b16 v[118:119],v15 offset:512
buffer_load_dwordx4 v8,s[12:15],s32 offen lds
v_mfma_f32_16x16x32_bf16 v[72:75],v[232:235],v[216:219],v[72:75]
ds_read_b64_tr_b16 v[148:149],v15 offset:4096
ds_read_b64_tr_b16 v[150:151],v15 offset:4608
v_mfma_f32_16x16x32_bf16 v[72:75],a[8:11],v[248:251],v[72:75]
ds_read_b64_tr_b16 v[120:121],v16 offset:0
buffer_load_dwordx4 v9,s[12:15],s32 offen offset:1024 lds
v_mfma_f32_16x16x32_bf16 v[76:79],v[232:235],v[220:223],v[76:79]
ds_read_b64_tr_b16 v[122:123],v16 offset:512
v_mfma_f32_16x16x32_bf16 v[76:79],a[8:11],v[252:255],v[76:79]
ds_read_b64_tr_b16 v[152:153],v16 offset:4096
v_mfma_f32_16x16x32_bf16 v[80:83],v[236:239],v[208:211],v[80:83]
ds_read_b64_tr_b16 v[154:155],v16 offset:4608
ds_read_b64_tr_b16 v[124:125],v17 offset:0
v_mfma_f32_16x16x32_bf16 v[80:83],a[12:15],v[240:243],v[80:83]
ds_read_b64_tr_b16 v[126:127],v17 offset:512
buffer_load_dwordx4 v10,s[12:15],s32 offen offset:2048 lds
v_mfma_f32_16x16x32_bf16 v[84:87],v[236:239],v[212:215],v[84:87]
ds_read_b64_tr_b16 v[156:157],v17 offset:4096
v_mfma_f32_16x16x32_bf16 v[84:87],a[12:15],v[244:247],v[84:87]
ds_read_b64_tr_b16 v[158:159],v17 offset:4608
buffer_load_dwordx4 v11,s[12:15],s32 offen offset:3072 lds
v_mfma_f32_16x16x32_bf16 v[88:91],v[236:239],v[216:219],v[88:91]
s_add_u32 s35,s35,32768
v_mfma_f32_16x16x32_bf16 v[88:91],a[12:15],v[248:251],v[88:91]
s_cmp_eq_u32 s35,163840
s_cselect_b32 s35,0,s35
v_mfma_f32_16x16x32_bf16 v[92:95],v[236:239],v[220:223],v[92:95]
s_add_u32 s32,s32,131072
v_mfma_f32_16x16x32_bf16 v[92:95],a[12:15],v[252:255],v[92:95]
s_cmp_eq_u32 s36,163840
s_cselect_b32 s42,s51,s50
s_cselect_b32 s36,0,s36
s_mov_b32 s38,9
Lp4L208_0:
s_waitcnt lgkmcnt(12)
v_mfma_f32_16x16x32_bf16 v[32:35],v[112:115],v[96:99],v[32:35]
v_add_u32 v12,s42,v12
v_add_u32 v13,s42,v13
v_mfma_f32_16x16x32_bf16 v[32:35],v[144:147],v[128:131],v[32:35]
v_add_u32 v14,s42,v14
v_add_u32 v15,s42,v15
v_mfma_f32_16x16x32_bf16 v[36:39],v[112:115],v[100:103],v[36:39]
v_add_u32 v16,s42,v16
v_add_u32 v17,s42,v17
v_mfma_f32_16x16x32_bf16 v[36:39],v[144:147],v[132:135],v[36:39]
s_waitcnt vmcnt(24)
s_waitcnt lgkmcnt(0)
s_barrier
ds_read_b128 v[208:211],v12 offset:0
v_mfma_f32_16x16x32_bf16 v[40:43],v[112:115],v[104:107],v[40:43]
ds_read_b64_tr_b16 v[224:225],v14 offset:0
s_add_u32 m0,s34,s40
v_mfma_f32_16x16x32_bf16 v[40:43],v[144:147],v[136:139],v[40:43]
ds_read_b64_tr_b16 v[226:227],v14 offset:512
buffer_load_dwordx4 v4,s[8:11],s30 offen sc1 lds
v_mfma_f32_16x16x32_bf16 v[44:47],v[112:115],v[108:111],v[44:47]
ds_read_b128 v[240:243],v12 offset:1024
s_add_u32 s36,s36,32768
v_mfma_f32_16x16x32_bf16 v[44:47],v[144:147],v[140:143],v[44:47]
ds_read_b64_tr_b16 a[0:1],v14 offset:4096
v_mfma_f32_16x16x32_bf16 v[48:51],v[116:119],v[96:99],v[48:51]
ds_read_b64_tr_b16 a[2:3],v14 offset:4608
buffer_load_dwordx4 v4,s[8:11],s30 offen offset:1024 sc1 lds
v_mfma_f32_16x16x32_bf16 v[48:51],v[148:151],v[128:131],v[48:51]
ds_read_b128 v[212:215],v12 offset:2048
v_mfma_f32_16x16x32_bf16 v[52:55],v[116:119],v[100:103],v[52:55]
ds_read_b128 v[244:247],v12 offset:3072
v_mfma_f32_16x16x32_bf16 v[52:55],v[148:151],v[132:135],v[52:55]
buffer_load_dwordx4 v5,s[8:11],s30 offen offset:2048 sc1 lds
v_mfma_f32_16x16x32_bf16 v[56:59],v[116:119],v[104:107],v[56:59]
ds_read_b128 v[216:219],v13 offset:0
v_mfma_f32_16x16x32_bf16 v[56:59],v[148:151],v[136:139],v[56:59]
ds_read_b128 v[248:251],v13 offset:1024
v_mfma_f32_16x16x32_bf16 v[60:63],v[116:119],v[108:111],v[60:63]
buffer_load_dwordx4 v5,s[8:11],s30 offen offset:3072 sc1 lds
s_add_u32 s34,s34,32768
v_mfma_f32_16x16x32_bf16 v[60:63],v[148:151],v[140:143],v[60:63]
ds_read_b128 v[220:223],v13 offset:2048
v_mfma_f32_16x16x32_bf16 v[64:67],v[120:123],v[96:99],v[64:67]
s_cmp_eq_u32 s34,163840
s_cselect_b32 s34,0,s34
v_mfma_f32_16x16x32_bf16 v[64:67],v[152:155],v[128:131],v[64:67]
ds_read_b128 v[252:255],v13 offset:3072
s_add_u32 s30,s30,2048
v_mfma_f32_16x16x32_bf16 v[68:71],v[120:123],v[100:103],v[68:71]
ds_read_b64_tr_b16 v[228:229],v15 offset:0
s_add_u32 m0,s35,s41
v_mfma_f32_16x16x32_bf16 v[68:71],v[152:155],v[132:135],v[68:71]
ds_read_b64_tr_b16 v[230:231],v15 offset:512
buffer_load_dwordx4 v8,s[12:15],s32 offen lds
v_mfma_f32_16x16x32_bf16 v[72:75],v[120:123],v[104:107],v[72:75]
ds_read_b64_tr_b16 a[4:5],v15 offset:4096
ds_read_b64_tr_b16 a[6:7],v15 offset:4608
v_mfma_f32_16x16x32_bf16 v[72:75],v[152:155],v[136:139],v[72:75]
ds_read_b64_tr_b16 v[232:233],v16 offset:0
buffer_load_dwordx4 v9,s[12:15],s32 offen offset:1024 lds
v_mfma_f32_16x16x32_bf16 v[76:79],v[120:123],v[108:111],v[76:79]
ds_read_b64_tr_b16 v[234:235],v16 offset:512
v_mfma_f32_16x16x32_bf16 v[76:79],v[152:155],v[140:143],v[76:79]
ds_read_b64_tr_b16 a[8:9],v16 offset:4096
v_mfma_f32_16x16x32_bf16 v[80:83],v[124:127],v[96:99],v[80:83]
ds_read_b64_tr_b16 a[10:11],v16 offset:4608
ds_read_b64_tr_b16 v[236:237],v17 offset:0
v_mfma_f32_16x16x32_bf16 v[80:83],v[156:159],v[128:131],v[80:83]
ds_read_b64_tr_b16 v[238:239],v17 offset:512
buffer_load_dwordx4 v10,s[12:15],s32 offen offset:2048 lds
v_mfma_f32_16x16x32_bf16 v[84:87],v[124:127],v[100:103],v[84:87]
ds_read_b64_tr_b16 a[12:13],v17 offset:4096
v_mfma_f32_16x16x32_bf16 v[84:87],v[156:159],v[132:135],v[84:87]
ds_read_b64_tr_b16 a[14:15],v17 offset:4608
buffer_load_dwordx4 v11,s[12:15],s32 offen offset:3072 lds
v_mfma_f32_16x16x32_bf16 v[88:91],v[124:127],v[104:107],v[88:91]
s_add_u32 s35,s35,32768
v_mfma_f32_16x16x32_bf16 v[88:91],v[156:159],v[136:139],v[88:91]
s_cmp_eq_u32 s35,163840
s_cselect_b32 s35,0,s35
v_mfma_f32_16x16x32_bf16 v[92:95],v[124:127],v[108:111],v[92:95]
s_add_u32 s32,s32,131072
v_mfma_f32_16x16x32_bf16 v[92:95],v[156:159],v[140:143],v[92:95]
s_cmp_eq_u32 s36,163840
s_cselect_b32 s42,s51,s50
s_cselect_b32 s36,0,s36
s_waitcnt lgkmcnt(12)
v_mfma_f32_16x16x32_bf16 v[32:35],v[224:227],v[208:211],v[32:35]
v_add_u32 v12,s42,v12
v_add_u32 v13,s42,v13
v_mfma_f32_16x16x32_bf16 v[32:35],a[0:3],v[240:243],v[32:35]
v_add_u32 v14,s42,v14
v_add_u32 v15,s42,v15
v_mfma_f32_16x16x32_bf16 v[36:39],v[224:227],v[212:215],v[36:39]
v_add_u32 v16,s42,v16
v_add_u32 v17,s42,v17
v_mfma_f32_16x16x32_bf16 v[36:39],a[0:3],v[244:247],v[36:39]
s_waitcnt vmcnt(24)
s_waitcnt lgkmcnt(0)
s_barrier
ds_read_b128 v[96:99],v12 offset:0
v_mfma_f32_16x16x32_bf16 v[40:43],v[224:227],v[216:219],v[40:43]
ds_read_b64_tr_b16 v[112:113],v14 offset:0
s_add_u32 m0,s34,s40
v_mfma_f32_16x16x32_bf16 v[40:43],a[0:3],v[248:251],v[40:43]
ds_read_b64_tr_b16 v[114:115],v14 offset:512
buffer_load_dwordx4 v4,s[8:11],s30 offen sc1 lds
v_mfma_f32_16x16x32_bf16 v[44:47],v[224:227],v[220:223],v[44:47]
ds_read_b128 v[128:131],v12 offset:1024
s_add_u32 s36,s36,32768
v_mfma_f32_16x16x32_bf16 v[44:47],a[0:3],v[252:255],v[44:47]
ds_read_b64_tr_b16 v[144:145],v14 offset:4096
v_mfma_f32_16x16x32_bf16 v[48:51],v[228:231],v[208:211],v[48:51]
ds_read_b64_tr_b16 v[146:147],v14 offset:4608
buffer_load_dwordx4 v4,s[8:11],s30 offen offset:1024 sc1 lds
v_mfma_f32_16x16x32_bf16 v[48:51],a[4:7],v[240:243],v[48:51]
ds_read_b128 v[100:103],v12 offset:2048
v_mfma_f32_16x16x32_bf16 v[52:55],v[228:231],v[212:215],v[52:55]
ds_read_b128 v[132:135],v12 offset:3072
v_mfma_f32_16x16x32_bf16 v[52:55],a[4:7],v[244:247],v[52:55]
buffer_load_dwordx4 v5,s[8:11],s30 offen offset:2048 sc1 lds
v_mfma_f32_16x16x32_bf16 v[56:59],v[228:231],v[216:219],v[56:59]
ds_read_b128 v[104:107],v13 offset:0
v_mfma_f32_16x16x32_bf16 v[56:59],a[4:7],v[248:251],v[56:59]
ds_read_b128 v[136:139],v13 offset:1024
v_mfma_f32_16x16x32_bf16 v[60:63],v[228:231],v[220:223],v[60:63]
buffer_load_dwordx4 v5,s[8:11],s30 offen offset:3072 sc1 lds
s_add_u32 s34,s34,32768
v_mfma_f32_16x16x32_bf16 v[60:63],a[4:7],v[252:255],v[60:63]
ds_read_b128 v[108:111],v13 offset:2048
v_mfma_f32_16x16x32_bf16 v[64:67],v[232:235],v[208:211],v[64:67]
s_cmp_eq_u32 s34,163840
s_cselect_b32 s34,0,s34
v_mfma_f32_16x16x32_bf16 v[64:67],a[8:11],v[240:243],v[64:67]
ds_read_b128 v[140:143],v13 offset:3072
s_add_u32 s30,s30,2048
v_mfma_f32_16x16x32_bf16 v[68:71],v[232:235],v[212:215],v[68:71]
ds_read_b64_tr_b16 v[116:117],v15 offset:0
s_add_u32 m0,s35,s41
v_mfma_f32_16x16x32_bf16 v[68:71],a[8:11],v[244:247],v[68:71]
ds_read_b64_tr_b16 v[118:119],v15 offset:512
buffer_load_dwordx4 v8,s[12:15],s32 offen lds
v_mfma_f32_16x16x32_bf16 v[72:75],v[232:235],v[216:219],v[72:75]
ds_read_b64_tr_b16 v[148:149],v15 offset:4096
ds_read_b64_tr_b16 v[150:151],v15 offset:4608
v_mfma_f32_16x16x32_bf16 v[72:75],a[8:11],v[248:251],v[72:75]
ds_read_b64_tr_b16 v[120:121],v16 offset:0
buffer_load_dwordx4 v9,s[12:15],s32 offen offset:1024 lds
v_mfma_f32_16x16x32_bf16 v[76:79],v[232:235],v[220:223],v[76:79]
ds_read_b64_tr_b16 v[122:123],v16 offset:512
v_mfma_f32_16x16x32_bf16 v[76:79],a[8:11],v[252:255],v[76:79]
ds_read_b64_tr_b16 v[152:153],v16 offset:4096
v_mfma_f32_16x16x32_bf16 v[80:83],v[236:239],v[208:211],v[80:83]
ds_read_b64_tr_b16 v[154:155],v16 offset:4608
ds_read_b64_tr_b16 v[124:125],v17 offset:0
v_mfma_f32_16x16x32_bf16 v[80:83],a[12:15],v[240:243],v[80:83]
ds_read_b64_tr_b16 v[126:127],v17 offset:512
buffer_load_dwordx4 v10,s[12:15],s32 offen offset:2048 lds
v_mfma_f32_16x16x32_bf16 v[84:87],v[236:239],v[212:215],v[84:87]
ds_read_b64_tr_b16 v[156:157],v17 offset:4096
v_mfma_f32_16x16x32_bf16 v[84:87],a[12:15],v[244:247],v[84:87]
ds_read_b64_tr_b16 v[158:159],v17 offset:4608
buffer_load_dwordx4 v11,s[12:15],s32 offen offset:3072 lds
v_mfma_f32_16x16x32_bf16 v[88:91],v[236:239],v[216:219],v[88:91]
s_add_u32 s35,s35,32768
v_mfma_f32_16x16x32_bf16 v[88:91],a[12:15],v[248:251],v[88:91]
s_cmp_eq_u32 s35,163840
s_cselect_b32 s35,0,s35
v_mfma_f32_16x16x32_bf16 v[92:95],v[236:239],v[220:223],v[92:95]
s_add_u32 s32,s32,131072
v_mfma_f32_16x16x32_bf16 v[92:95],a[12:15],v[252:255],v[92:95]
s_cmp_eq_u32 s36,163840
s_cselect_b32 s42,s51,s50
s_cselect_b32 s36,0,s36
s_sub_u32 s38,s38,1
s_cmp_lg_u32 s38,0
s_cbranch_scc1 Lp4L208_0
s_waitcnt lgkmcnt(12)
v_mfma_f32_16x16x32_bf16 v[32:35],v[112:115],v[96:99],v[32:35]
v_add_u32 v12,s42,v12
v_add_u32 v13,s42,v13
v_mfma_f32_16x16x32_bf16 v[32:35],v[144:147],v[128:131],v[32:35]
v_add_u32 v14,s42,v14
v_add_u32 v15,s42,v15
v_mfma_f32_16x16x32_bf16 v[36:39],v[112:115],v[100:103],v[36:39]
v_add_u32 v16,s42,v16
v_add_u32 v17,s42,v17
v_mfma_f32_16x16x32_bf16 v[36:39],v[144:147],v[132:135],v[36:39]
s_waitcnt vmcnt(24)
s_waitcnt lgkmcnt(0)
s_barrier
ds_read_b128 v[208:211],v12 offset:0
v_mfma_f32_16x16x32_bf16 v[40:43],v[112:115],v[104:107],v[40:43]
ds_read_b64_tr_b16 a[24:25],v14 offset:0
s_add_u32 m0,s34,s40
v_mfma_f32_16x16x32_bf16 v[40:43],v[144:147],v[136:139],v[40:43]
ds_read_b64_tr_b16 a[26:27],v14 offset:512
buffer_load_dwordx4 v4,s[8:11],s30 offen sc1 lds
v_mfma_f32_16x16x32_bf16 v[44:47],v[112:115],v[108:111],v[44:47]
ds_read_b128 v[240:243],v12 offset:1024
s_add_u32 s36,s36,32768
v_mfma_f32_16x16x32_bf16 v[44:47],v[144:147],v[140:143],v[44:47]
ds_read_b64_tr_b16 a[48:49],v14 offset:4096
v_mfma_f32_16x16x32_bf16 v[48:51],v[116:119],v[96:99],v[48:51]
ds_read_b64_tr_b16 a[50:51],v14 offset:4608
buffer_load_dwordx4 v4,s[8:11],s30 offen offset:1024 sc1 lds
v_mfma_f32_16x16x32_bf16 v[48:51],v[148:151],v[128:131],v[48:51]
ds_read_b128 v[212:215],v12 offset:2048
v_mfma_f32_16x16x32_bf16 v[52:55],v[116:119],v[100:103],v[52:55]
ds_read_b128 v[244:247],v12 offset:3072
v_mfma_f32_16x16x32_bf16 v[52:55],v[148:151],v[132:135],v[52:55]
buffer_load_dwordx4 v5,s[8:11],s30 offen offset:2048 sc1 lds
v_mfma_f32_16x16x32_bf16 v[56:59],v[116:119],v[104:107],v[56:59]
ds_read_b64_tr_b16 a[28:29],v15 offset:0
v_mfma_f32_16x16x32_bf16 v[56:59],v[148:151],v[136:139],v[56:59]
ds_read_b64_tr_b16 a[30:31],v15 offset:512
ds_read_b64_tr_b16 a[52:53],v15 offset:4096
v_mfma_f32_16x16x32_bf16 v[60:63],v[116:119],v[108:111],v[60:63]
ds_read_b64_tr_b16 a[54:55],v15 offset:4608
buffer_load_dwordx4 v5,s[8:11],s30 offen offset:3072 sc1 lds
v_mfma_f32_16x16x32_bf16 v[60:63],v[148:151],v[140:143],v[60:63]
ds_read_b64_tr_b16 a[32:33],v16 offset:0
s_add_u32 s34,s34,32768
v_mfma_f32_16x16x32_bf16 v[64:67],v[120:123],v[96:99],v[64:67]
ds_read_b64_tr_b16 a[34:35],v16 offset:512
v_mfma_f32_16x16x32_bf16 v[64:67],v[152:155],v[128:131],v[64:67]
ds_read_b64_tr_b16 a[56:57],v16 offset:4096
ds_read_b64_tr_b16 a[58:59],v16 offset:4608
v_mfma_f32_16x16x32_bf16 v[68:71],v[120:123],v[100:103],v[68:71]
ds_read_b64_tr_b16 a[36:37],v17 offset:0
v_mfma_f32_16x16x32_bf16 v[68:71],v[152:155],v[132:135],v[68:71]
ds_read_b64_tr_b16 a[38:39],v17 offset:512
v_mfma_f32_16x16x32_bf16 v[72:75],v[120:123],v[104:107],v[72:75]
ds_read_b64_tr_b16 a[60:61],v17 offset:4096
ds_read_b64_tr_b16 a[62:63],v17 offset:4608
v_mfma_f32_16x16x32_bf16 v[72:75],v[152:155],v[136:139],v[72:75]
ds_read_b128 a[16:19],v13 offset:0
v_mfma_f32_16x16x32_bf16 v[76:79],v[120:123],v[108:111],v[76:79]
s_cmp_eq_u32 s34,163840
s_cselect_b32 s34,0,s34
v_mfma_f32_16x16x32_bf16 v[76:79],v[152:155],v[140:143],v[76:79]
ds_read_b128 a[40:43],v13 offset:1024
s_add_u32 s30,s30,2048
v_mfma_f32_16x16x32_bf16 v[80:83],v[124:127],v[96:99],v[80:83]
ds_read_b128 a[20:23],v13 offset:2048
s_add_u32 m0,s35,s41
v_mfma_f32_16x16x32_bf16 v[80:83],v[156:159],v[128:131],v[80:83]
buffer_load_dwordx4 v8,s[12:15],s32 offen lds
buffer_load_dwordx4 v9,s[12:15],s32 offen offset:1024 lds
v_mfma_f32_16x16x32_bf16 v[84:87],v[124:127],v[100:103],v[84:87]
ds_read_b128 a[44:47],v13 offset:3072
buffer_load_dwordx4 v10,s[12:15],s32 offen offset:2048 lds
v_mfma_f32_16x16x32_bf16 v[84:87],v[156:159],v[132:135],v[84:87]
buffer_load_dwordx4 v11,s[12:15],s32 offen offset:3072 lds
s_add_u32 s35,s35,32768
v_mfma_f32_16x16x32_bf16 v[88:91],v[124:127],v[104:107],v[88:91]
s_cmp_eq_u32 s35,163840
s_cselect_b32 s35,0,s35
v_mfma_f32_16x16x32_bf16 v[88:91],v[156:159],v[136:139],v[88:91]
s_add_u32 s32,s32,131072
v_mfma_f32_16x16x32_bf16 v[92:95],v[124:127],v[108:111],v[92:95]
v_mfma_f32_16x16x32_bf16 v[92:95],v[156:159],v[140:143],v[92:95]
s_cmp_eq_u32 s36,163840
s_cselect_b32 s42,s51,s50
s_cselect_b32 s36,0,s36
s_waitcnt lgkmcnt(12)
v_mfma_f32_16x16x32_bf16 v[32:35],a[24:27],v[208:211],v[32:35]
v_add_u32 v12,s42,v12
v_add_u32 v13,s42,v13
v_mfma_f32_16x16x32_bf16 v[32:35],a[48:51],v[240:243],v[32:35]
v_add_u32 v14,s42,v14
v_add_u32 v15,s42,v15
v_mfma_f32_16x16x32_bf16 v[36:39],a[24:27],v[212:215],v[36:39]
v_add_u32 v16,s42,v16
v_add_u32 v17,s42,v17
v_mfma_f32_16x16x32_bf16 v[36:39],a[48:51],v[244:247],v[36:39]
s_waitcnt vmcnt(24)
s_waitcnt lgkmcnt(0)
s_barrier
ds_read_b128 v[96:99],v12 offset:0
v_mfma_f32_16x16x32_bf16 v[48:51],a[28:31],v[208:211],v[48:51]
ds_read_b64_tr_b16 a[72:73],v14 offset:0
ds_read_b64_tr_b16 a[74:75],v14 offset:512
s_add_u32 s36,s36,32768
v_mfma_f32_16x16x32_bf16 v[48:51],a[52:55],v[240:243],v[48:51]
ds_read_b128 v[128:131],v12 offset:1024
buffer_load_dwordx2 v[160:161],v22,s[56:59],0 offen sc1
v_mfma_f32_16x16x32_bf16 v[52:55],a[28:31],v[212:215],v[52:55]
ds_read_b64_tr_b16 a[96:97],v14 offset:4096
ds_read_b64_tr_b16 a[98:99],v14 offset:4608
v_mfma_f32_16x16x32_bf16 v[52:55],a[52:55],v[244:247],v[52:55]
ds_read_b128 v[100:103],v12 offset:2048
buffer_load_dwordx2 v[162:163],v22,s[56:59],0 offen offset:512 sc1
v_mfma_f32_16x16x32_bf16 v[64:67],a[32:35],v[208:211],v[64:67]
ds_read_b128 v[132:135],v12 offset:3072
buffer_load_dwordx2 v[164:165],v22,s[56:59],0 offen offset:1024 sc1
v_mfma_f32_16x16x32_bf16 v[64:67],a[56:59],v[240:243],v[64:67]
ds_read_b64_tr_b16 a[76:77],v15 offset:0
ds_read_b64_tr_b16 a[78:79],v15 offset:512
v_mfma_f32_16x16x32_bf16 v[68:71],a[32:35],v[212:215],v[68:71]
ds_read_b64_tr_b16 a[100:101],v15 offset:4096
ds_read_b64_tr_b16 a[102:103],v15 offset:4608
v_mfma_f32_16x16x32_bf16 v[68:71],a[56:59],v[244:247],v[68:71]
ds_read_b64_tr_b16 a[80:81],v16 offset:0
ds_read_b64_tr_b16 a[82:83],v16 offset:512
v_mfma_f32_16x16x32_bf16 v[80:83],a[36:39],v[208:211],v[80:83]
ds_read_b64_tr_b16 a[104:105],v16 offset:4096
ds_read_b64_tr_b16 a[106:107],v16 offset:4608
v_mfma_f32_16x16x32_bf16 v[80:83],a[60:63],v[240:243],v[80:83]
ds_read_b64_tr_b16 a[84:85],v17 offset:0
ds_read_b64_tr_b16 a[86:87],v17 offset:512
v_mfma_f32_16x16x32_bf16 v[84:87],a[36:39],v[212:215],v[84:87]
ds_read_b64_tr_b16 a[108:109],v17 offset:4096
ds_read_b64_tr_b16 a[110:111],v17 offset:4608
v_mfma_f32_16x16x32_bf16 v[84:87],a[60:63],v[244:247],v[84:87]
ds_read_b128 a[64:67],v13 offset:0
ds_read_b128 a[88:91],v13 offset:1024
ds_read_b128 a[68:71],v13 offset:2048
ds_read_b128 a[92:95],v13 offset:3072
buffer_load_dwordx2 v[166:167],v22,s[56:59],0 offen offset:1536 sc1
buffer_load_dwordx2 v[168:169],v22,s[56:59],s60 offen sc1
buffer_load_dwordx2 v[170:171],v22,s[56:59],s60 offen offset:512 sc1
buffer_load_dwordx2 v[172:173],v22,s[56:59],s60 offen offset:1024 sc1
buffer_load_dwordx2 v[174:175],v22,s[56:59],s60 offen offset:1536 sc1
s_cmp_eq_u32 s36,163840
s_cselect_b32 s42,s51,s50
s_cselect_b32 s36,0,s36
s_waitcnt lgkmcnt(12)
v_mfma_f32_16x16x32_bf16 v[32:35],a[72:75],v[96:99],v[32:35]
v_add_u32 v12,s42,v12
v_add_u32 v13,s42,v13
v_mfma_f32_16x16x32_bf16 v[32:35],a[96:99],v[128:131],v[32:35]
v_add_u32 v14,s42,v14
v_add_u32 v15,s42,v15
v_mfma_f32_16x16x32_bf16 v[36:39],a[72:75],v[100:103],v[36:39]
v_add_u32 v16,s42,v16
v_add_u32 v17,s42,v17
v_mfma_f32_16x16x32_bf16 v[36:39],a[96:99],v[132:135],v[36:39]
s_waitcnt vmcnt(24)
s_waitcnt lgkmcnt(0)
s_barrier
ds_read_b128 v[208:211],v12 offset:0
v_mfma_f32_16x16x32_bf16 v[48:51],a[76:79],v[96:99],v[48:51]
ds_read_b64_tr_b16 a[120:121],v14 offset:0
ds_read_b64_tr_b16 a[122:123],v14 offset:512
v_mfma_f32_16x16x32_bf16 v[48:51],a[100:103],v[128:131],v[48:51]
ds_read_b128 v[240:243],v12 offset:1024
s_add_u32 s36,s36,32768
v_mfma_f32_16x16x32_bf16 v[52:55],a[76:79],v[100:103],v[52:55]
ds_read_b64_tr_b16 a[144:145],v14 offset:4096
ds_read_b64_tr_b16 a[146:147],v14 offset:4608
v_mfma_f32_16x16x32_bf16 v[52:55],a[100:103],v[132:135],v[52:55]
ds_read_b128 v[212:215],v12 offset:2048
v_mfma_f32_16x16x32_bf16 v[64:67],a[80:83],v[96:99],v[64:67]
ds_read_b128 v[244:247],v12 offset:3072
v_mfma_f32_16x16x32_bf16 v[64:67],a[104:107],v[128:131],v[64:67]
ds_read_b64_tr_b16 a[124:125],v15 offset:0
ds_read_b64_tr_b16 a[126:127],v15 offset:512
v_mfma_f32_16x16x32_bf16 v[68:71],a[80:83],v[100:103],v[68:71]
ds_read_b64_tr_b16 a[148:149],v15 offset:4096
ds_read_b64_tr_b16 a[150:151],v15 offset:4608
v_mfma_f32_16x16x32_bf16 v[68:71],a[104:107],v[132:135],v[68:71]
ds_read_b64_tr_b16 a[128:129],v16 offset:0
ds_read_b64_tr_b16 a[130:131],v16 offset:512
v_mfma_f32_16x16x32_bf16 v[80:83],a[84:87],v[96:99],v[80:83]
ds_read_b64_tr_b16 a[152:153],v16 offset:4096
ds_read_b64_tr_b16 a[154:155],v16 offset:4608
v_mfma_f32_16x16x32_bf16 v[80:83],a[108:111],v[128:131],v[80:83]
ds_read_b64_tr_b16 a[132:133],v17 offset:0
ds_read_b64_tr_b16 a[134:135],v17 offset:512
v_mfma_f32_16x16x32_bf16 v[84:87],a[84:87],v[100:103],v[84:87]
ds_read_b64_tr_b16 a[156:157],v17 offset:4096
ds_read_b64_tr_b16 a[158:159],v17 offset:4608
v_mfma_f32_16x16x32_bf16 v[84:87],a[108:111],v[132:135],v[84:87]
ds_read_b128 a[112:115],v13 offset:0
ds_read_b128 a[136:139],v13 offset:1024
ds_read_b128 a[116:119],v13 offset:2048
ds_read_b128 a[140:143],v13 offset:3072
s_cmp_eq_u32 s36,163840
s_cselect_b32 s42,s51,s50
s_cselect_b32 s36,0,s36
s_waitcnt lgkmcnt(12)
v_mfma_f32_16x16x32_bf16 v[32:35],a[120:123],v[208:211],v[32:35]
v_add_u32 v12,s42,v12
v_add_u32 v13,s42,v13
v_mfma_f32_16x16x32_bf16 v[32:35],a[144:147],v[240:243],v[32:35]
v_add_u32 v14,s42,v14
v_add_u32 v15,s42,v15
v_mfma_f32_16x16x32_bf16 v[36:39],a[120:123],v[212:215],v[36:39]
v_add_u32 v16,s42,v16
v_add_u32 v17,s42,v17
v_mfma_f32_16x16x32_bf16 v[36:39],a[144:147],v[244:247],v[36:39]
s_waitcnt vmcnt(16)
s_waitcnt lgkmcnt(0)
s_barrier
ds_read_b128 v[96:99],v12 offset:0
v_mfma_f32_16x16x32_bf16 v[48:51],a[124:127],v[208:211],v[48:51]
ds_read_b64_tr_b16 a[168:169],v14 offset:0
ds_read_b64_tr_b16 a[170:171],v14 offset:512
v_mfma_f32_16x16x32_bf16 v[48:51],a[148:151],v[240:243],v[48:51]
ds_read_b128 v[128:131],v12 offset:1024
s_add_u32 s36,s36,32768
v_mfma_f32_16x16x32_bf16 v[52:55],a[124:127],v[212:215],v[52:55]
ds_read_b64_tr_b16 a[192:193],v14 offset:4096
ds_read_b64_tr_b16 a[194:195],v14 offset:4608
v_mfma_f32_16x16x32_bf16 v[52:55],a[148:151],v[244:247],v[52:55]
ds_read_b128 v[100:103],v12 offset:2048
v_mfma_f32_16x16x32_bf16 v[64:67],a[128:131],v[208:211],v[64:67]
ds_read_b128 v[132:135],v12 offset:3072
v_mfma_f32_16x16x32_bf16 v[64:67],a[152:155],v[240:243],v[64:67]
ds_read_b64_tr_b16 a[172:173],v15 offset:0
ds_read_b64_tr_b16 a[174:175],v15 offset:512
v_mfma_f32_16x16x32_bf16 v[68:71],a[128:131],v[212:215],v[68:71]
ds_read_b64_tr_b16 a[196:197],v15 offset:4096
ds_read_b64_tr_b16 a[198:199],v15 offset:4608
v_mfma_f32_16x16x32_bf16 v[68:71],a[152:155],v[244:247],v[68:71]
ds_read_b64_tr_b16 a[176:177],v16 offset:0
ds_read_b64_tr_b16 a[178:179],v16 offset:512
v_mfma_f32_16x16x32_bf16 v[80:83],a[132:135],v[208:211],v[80:83]
ds_read_b64_tr_b16 a[200:201],v16 offset:4096
ds_read_b64_tr_b16 a[202:203],v16 offset:4608
v_mfma_f32_16x16x32_bf16 v[80:83],a[156:159],v[240:243],v[80:83]
ds_read_b64_tr_b16 a[180:181],v17 offset:0
ds_read_b64_tr_b16 a[182:183],v17 offset:512
v_mfma_f32_16x16x32_bf16 v[84:87],a[132:135],v[212:215],v[84:87]
ds_read_b64_tr_b16 a[204:205],v17 offset:4096
ds_read_b64_tr_b16 a[206:207],v17 offset:4608
v_mfma_f32_16x16x32_bf16 v[84:87],a[156:159],v[244:247],v[84:87]
ds_read_b128 a[160:163],v13 offset:0
ds_read_b128 a[184:187],v13 offset:1024
ds_read_b128 a[164:167],v13 offset:2048
ds_read_b128 a[188:191],v13 offset:3072
s_cmp_eq_u32 s36,163840
s_cselect_b32 s42,s51,s50
s_cselect_b32 s36,0,s36
s_waitcnt lgkmcnt(12)
v_mfma_f32_16x16x32_bf16 v[32:35],a[168:171],v[96:99],v[32:35]
v_add_u32 v12,s42,v12
v_add_u32 v13,s42,v13
v_mfma_f32_16x16x32_bf16 v[32:35],a[192:195],v[128:131],v[32:35]
v_add_u32 v14,s42,v14
v_add_u32 v15,s42,v15
v_mfma_f32_16x16x32_bf16 v[36:39],a[168:171],v[100:103],v[36:39]
v_add_u32 v16,s42,v16
v_add_u32 v17,s42,v17
v_mfma_f32_16x16x32_bf16 v[36:39],a[192:195],v[132:135],v[36:39]
s_waitcnt vmcnt(0)
s_waitcnt lgkmcnt(0)
s_barrier
ds_read_b128 v[208:211],v12 offset:0
v_mfma_f32_16x16x32_bf16 v[48:51],a[172:175],v[96:99],v[48:51]
ds_read_b64_tr_b16 a[216:217],v14 offset:0
ds_read_b64_tr_b16 a[218:219],v14 offset:512
v_mfma_f32_16x16x32_bf16 v[48:51],a[196:199],v[128:131],v[48:51]
ds_read_b128 v[240:243],v12 offset:1024
s_add_u32 s36,s36,32768
v_mfma_f32_16x16x32_bf16 v[52:55],a[172:175],v[100:103],v[52:55]
ds_read_b64_tr_b16 a[240:241],v14 offset:4096
ds_read_b64_tr_b16 a[242:243],v14 offset:4608
v_mfma_f32_16x16x32_bf16 v[52:55],a[196:199],v[132:135],v[52:55]
ds_read_b128 v[212:215],v12 offset:2048
v_mfma_f32_16x16x32_bf16 v[64:67],a[176:179],v[96:99],v[64:67]
ds_read_b128 v[244:247],v12 offset:3072
v_mfma_f32_16x16x32_bf16 v[64:67],a[200:203],v[128:131],v[64:67]
ds_read_b64_tr_b16 a[220:221],v15 offset:0
ds_read_b64_tr_b16 a[222:223],v15 offset:512
v_mfma_f32_16x16x32_bf16 v[68:71],a[176:179],v[100:103],v[68:71]
ds_read_b64_tr_b16 a[244:245],v15 offset:4096
ds_read_b64_tr_b16 a[246:247],v15 offset:4608
v_mfma_f32_16x16x32_bf16 v[68:71],a[200:203],v[132:135],v[68:71]
ds_read_b64_tr_b16 a[224:225],v16 offset:0
ds_read_b64_tr_b16 a[226:227],v16 offset:512
v_mfma_f32_16x16x32_bf16 v[80:83],a[180:183],v[96:99],v[80:83]
ds_read_b64_tr_b16 a[248:249],v16 offset:4096
ds_read_b64_tr_b16 a[250:251],v16 offset:4608
v_mfma_f32_16x16x32_bf16 v[80:83],a[204:207],v[128:131],v[80:83]
ds_read_b64_tr_b16 a[228:229],v17 offset:0
ds_read_b64_tr_b16 a[230:231],v17 offset:512
v_mfma_f32_16x16x32_bf16 v[84:87],a[180:183],v[100:103],v[84:87]
ds_read_b64_tr_b16 a[252:253],v17 offset:4096
ds_read_b64_tr_b16 a[254:255],v17 offset:4608
v_mfma_f32_16x16x32_bf16 v[84:87],a[204:207],v[132:135],v[84:87]
ds_read_b128 a[208:211],v13 offset:0
ds_read_b128 a[232:235],v13 offset:1024
ds_read_b128 a[212:215],v13 offset:2048
ds_read_b128 a[236:239],v13 offset:3072
s_cmp_eq_u32 s36,163840
s_cselect_b32 s42,s51,s50
s_cselect_b32 s36,0,s36
s_waitcnt lgkmcnt(12)
v_mfma_f32_16x16x32_bf16 v[32:35],a[216:219],v[208:211],v[32:35]
v_mfma_f32_16x16x32_bf16 v[32:35],a[240:243],v[240:243],v[32:35]
v_mfma_f32_16x16x32_bf16 v[36:39],a[216:219],v[212:215],v[36:39]
v_mfma_f32_16x16x32_bf16 v[36:39],a[240:243],v[244:247],v[36:39]
v_mfma_f32_16x16x32_bf16 v[48:51],a[220:223],v[208:211],v[48:51]
v_mfma_f32_16x16x32_bf16 v[48:51],a[244:247],v[240:243],v[48:51]
v_mfma_f32_16x16x32_bf16 v[52:55],a[220:223],v[212:215],v[52:55]
v_mfma_f32_16x16x32_bf16 v[52:55],a[244:247],v[244:247],v[52:55]
s_waitcnt lgkmcnt(4)
v_mfma_f32_16x16x32_bf16 v[64:67],a[224:227],v[208:211],v[64:67]
v_mfma_f32_16x16x32_bf16 v[64:67],a[248:251],v[240:243],v[64:67]
v_mfma_f32_16x16x32_bf16 v[68:71],a[224:227],v[212:215],v[68:71]
v_mfma_f32_16x16x32_bf16 v[68:71],a[248:251],v[244:247],v[68:71]
v_mfma_f32_16x16x32_bf16 v[80:83],a[228:231],v[208:211],v[80:83]
v_mfma_f32_16x16x32_bf16 v[80:83],a[252:255],v[240:243],v[80:83]
v_mfma_f32_16x16x32_bf16 v[84:87],a[228:231],v[212:215],v[84:87]
v_mfma_f32_16x16x32_bf16 v[84:87],a[252:255],v[244:247],v[84:87]
v_cvt_pk_bf16_f32 v96,v32,v33
v_cvt_pk_bf16_f32 v97,v34,v35
v_cvt_pk_bf16_f32 v98,v48,v49
v_cvt_pk_bf16_f32 v99,v50,v51
v_cvt_pk_bf16_f32 v100,v64,v65
v_cvt_pk_bf16_f32 v101,v66,v67
v_cvt_pk_bf16_f32 v102,v80,v81
v_cvt_pk_bf16_f32 v103,v82,v83
v_cvt_pk_bf16_f32 v104,v36,v37
v_cvt_pk_bf16_f32 v105,v38,v39
v_cvt_pk_bf16_f32 v106,v52,v53
v_cvt_pk_bf16_f32 v107,v54,v55
v_cvt_pk_bf16_f32 v108,v68,v69
v_cvt_pk_bf16_f32 v109,v70,v71
v_cvt_pk_bf16_f32 v110,v84,v85
v_cvt_pk_bf16_f32 v111,v86,v87
buffer_store_dwordx4 v[96:99],v20,s[24:27],0 offen sc1
buffer_store_dwordx4 v[100:103],v20,s[24:27],0 offen offset:1024 sc1
buffer_store_dwordx4 v[104:107],v20,s[24:27],0 offen offset:2048 sc1
buffer_store_dwordx4 v[108:111],v20,s[24:27],0 offen offset:3072 sc1
s_waitcnt lgkmcnt(0)
v_mfma_f32_16x16x32_bf16 v[40:43],a[24:27],a[16:19],v[40:43]
v_lshlrev_b32 v176,16,v160
v_mfma_f32_16x16x32_bf16 v[40:43],a[48:51],a[40:43],v[40:43]
v_and_b32 v177,0xffff0000,v160
v_mfma_f32_16x16x32_bf16 v[40:43],a[72:75],a[64:67],v[40:43]
v_lshlrev_b32 v178,16,v161
v_mfma_f32_16x16x32_bf16 v[40:43],a[96:99],a[88:91],v[40:43]
v_and_b32 v179,0xffff0000,v161
v_mfma_f32_16x16x32_bf16 v[40:43],a[120:123],a[112:115],v[40:43]
v_lshlrev_b32 v180,16,v162
v_mfma_f32_16x16x32_bf16 v[40:43],a[144:147],a[136:139],v[40:43]
v_and_b32 v181,0xffff0000,v162
v_mfma_f32_16x16x32_bf16 v[40:43],a[168:171],a[160:163],v[40:43]
v_lshlrev_b32 v182,16,v163
v_mfma_f32_16x16x32_bf16 v[40:43],a[192:195],a[184:187],v[40:43]
v_and_b32 v183,0xffff0000,v163
v_mfma_f32_16x16x32_bf16 v[40:43],a[216:219],a[208:211],v[40:43]
v_lshlrev_b32 v184,16,v164
v_mfma_f32_16x16x32_bf16 v[40:43],a[240:243],a[232:235],v[40:43]
v_and_b32 v185,0xffff0000,v164
v_mfma_f32_16x16x32_bf16 v[44:47],a[24:27],a[20:23],v[44:47]
v_lshlrev_b32 v186,16,v165
v_mfma_f32_16x16x32_bf16 v[44:47],a[48:51],a[44:47],v[44:47]
v_and_b32 v187,0xffff0000,v165
v_mfma_f32_16x16x32_bf16 v[44:47],a[72:75],a[68:71],v[44:47]
v_lshlrev_b32 v188,16,v166
v_mfma_f32_16x16x32_bf16 v[44:47],a[96:99],a[92:95],v[44:47]
v_and_b32 v189,0xffff0000,v166
v_mfma_f32_16x16x32_bf16 v[44:47],a[120:123],a[116:119],v[44:47]
v_lshlrev_b32 v190,16,v167
v_mfma_f32_16x16x32_bf16 v[44:47],a[144:147],a[140:143],v[44:47]
v_and_b32 v191,0xffff0000,v167
v_mfma_f32_16x16x32_bf16 v[44:47],a[168:171],a[164:167],v[44:47]
v_lshlrev_b32 v192,16,v168
v_mfma_f32_16x16x32_bf16 v[44:47],a[192:195],a[188:191],v[44:47]
v_and_b32 v193,0xffff0000,v168
v_mfma_f32_16x16x32_bf16 v[44:47],a[216:219],a[212:215],v[44:47]
v_lshlrev_b32 v194,16,v169
v_mfma_f32_16x16x32_bf16 v[44:47],a[240:243],a[236:239],v[44:47]
v_and_b32 v195,0xffff0000,v169
v_mfma_f32_16x16x32_bf16 v[56:59],a[28:31],a[16:19],v[56:59]
v_lshlrev_b32 v196,16,v170
v_mfma_f32_16x16x32_bf16 v[56:59],a[52:55],a[40:43],v[56:59]
v_and_b32 v197,0xffff0000,v170
v_mfma_f32_16x16x32_bf16 v[56:59],a[76:79],a[64:67],v[56:59]
v_lshlrev_b32 v198,16,v171
v_mfma_f32_16x16x32_bf16 v[56:59],a[100:103],a[88:91],v[56:59]
v_and_b32 v199,0xffff0000,v171
v_mfma_f32_16x16x32_bf16 v[56:59],a[124:127],a[112:115],v[56:59]
v_lshlrev_b32 v200,16,v172
v_mfma_f32_16x16x32_bf16 v[56:59],a[148:151],a[136:139],v[56:59]
v_and_b32 v201,0xffff0000,v172
v_mfma_f32_16x16x32_bf16 v[56:59],a[172:175],a[160:163],v[56:59]
v_lshlrev_b32 v202,16,v173
v_mfma_f32_16x16x32_bf16 v[56:59],a[196:199],a[184:187],v[56:59]
v_and_b32 v203,0xffff0000,v173
v_mfma_f32_16x16x32_bf16 v[56:59],a[220:223],a[208:211],v[56:59]
v_lshlrev_b32 v204,16,v174
v_mfma_f32_16x16x32_bf16 v[56:59],a[244:247],a[232:235],v[56:59]
v_and_b32 v205,0xffff0000,v174
v_mfma_f32_16x16x32_bf16 v[60:63],a[28:31],a[20:23],v[60:63]
v_lshlrev_b32 v206,16,v175
v_mfma_f32_16x16x32_bf16 v[60:63],a[52:55],a[44:47],v[60:63]
v_and_b32 v207,0xffff0000,v175
v_mfma_f32_16x16x32_bf16 v[60:63],a[76:79],a[68:71],v[60:63]
v_mfma_f32_16x16x32_bf16 v[60:63],a[100:103],a[92:95],v[60:63]
v_mfma_f32_16x16x32_bf16 v[60:63],a[124:127],a[116:119],v[60:63]
v_mfma_f32_16x16x32_bf16 v[60:63],a[148:151],a[140:143],v[60:63]
v_mfma_f32_16x16x32_bf16 v[60:63],a[172:175],a[164:167],v[60:63]
v_mfma_f32_16x16x32_bf16 v[60:63],a[196:199],a[188:191],v[60:63]
v_mfma_f32_16x16x32_bf16 v[60:63],a[220:223],a[212:215],v[60:63]
v_mfma_f32_16x16x32_bf16 v[60:63],a[244:247],a[236:239],v[60:63]
v_mfma_f32_16x16x32_bf16 v[72:75],a[32:35],a[16:19],v[72:75]
v_mfma_f32_16x16x32_bf16 v[72:75],a[56:59],a[40:43],v[72:75]
v_mfma_f32_16x16x32_bf16 v[72:75],a[80:83],a[64:67],v[72:75]
v_mfma_f32_16x16x32_bf16 v[72:75],a[104:107],a[88:91],v[72:75]
v_mfma_f32_16x16x32_bf16 v[72:75],a[128:131],a[112:115],v[72:75]
v_mfma_f32_16x16x32_bf16 v[72:75],a[152:155],a[136:139],v[72:75]
v_mfma_f32_16x16x32_bf16 v[72:75],a[176:179],a[160:163],v[72:75]
v_mfma_f32_16x16x32_bf16 v[72:75],a[200:203],a[184:187],v[72:75]
v_mfma_f32_16x16x32_bf16 v[72:75],a[224:227],a[208:211],v[72:75]
v_mfma_f32_16x16x32_bf16 v[72:75],a[248:251],a[232:235],v[72:75]
v_mfma_f32_16x16x32_bf16 v[76:79],a[32:35],a[20:23],v[76:79]
v_mfma_f32_16x16x32_bf16 v[76:79],a[56:59],a[44:47],v[76:79]
buffer_load_dwordx4 v[128:131],v21,s[24:27],0 offen sc1
v_mfma_f32_16x16x32_bf16 v[76:79],a[80:83],a[68:71],v[76:79]
buffer_load_dwordx4 v[132:135],v21,s[24:27],0 offen offset:1024 sc1
v_mfma_f32_16x16x32_bf16 v[76:79],a[104:107],a[92:95],v[76:79]
buffer_load_dwordx4 v[136:139],v21,s[24:27],0 offen offset:2048 sc1
v_mfma_f32_16x16x32_bf16 v[76:79],a[128:131],a[116:119],v[76:79]
buffer_load_dwordx4 v[140:143],v21,s[24:27],0 offen offset:3072 sc1
v_mfma_f32_16x16x32_bf16 v[76:79],a[152:155],a[140:143],v[76:79]
v_mfma_f32_16x16x32_bf16 v[76:79],a[176:179],a[164:167],v[76:79]
v_mfma_f32_16x16x32_bf16 v[76:79],a[200:203],a[188:191],v[76:79]
v_mfma_f32_16x16x32_bf16 v[76:79],a[224:227],a[212:215],v[76:79]
v_mfma_f32_16x16x32_bf16 v[76:79],a[248:251],a[236:239],v[76:79]
v_mfma_f32_16x16x32_bf16 v[88:91],a[36:39],a[16:19],v[88:91]
v_mfma_f32_16x16x32_bf16 v[88:91],a[60:63],a[40:43],v[88:91]
v_mfma_f32_16x16x32_bf16 v[88:91],a[84:87],a[64:67],v[88:91]
v_mfma_f32_16x16x32_bf16 v[88:91],a[108:111],a[88:91],v[88:91]
v_mfma_f32_16x16x32_bf16 v[88:91],a[132:135],a[112:115],v[88:91]
v_mfma_f32_16x16x32_bf16 v[88:91],a[156:159],a[136:139],v[88:91]
v_mfma_f32_16x16x32_bf16 v[88:91],a[180:183],a[160:163],v[88:91]
v_mfma_f32_16x16x32_bf16 v[88:91],a[204:207],a[184:187],v[88:91]
v_mfma_f32_16x16x32_bf16 v[88:91],a[228:231],a[208:211],v[88:91]
v_mfma_f32_16x16x32_bf16 v[88:91],a[252:255],a[232:235],v[88:91]
v_mfma_f32_16x16x32_bf16 v[92:95],a[36:39],a[20:23],v[92:95]
v_mfma_f32_16x16x32_bf16 v[92:95],a[60:63],a[44:47],v[92:95]
v_mfma_f32_16x16x32_bf16 v[92:95],a[84:87],a[68:71],v[92:95]
v_mfma_f32_16x16x32_bf16 v[92:95],a[108:111],a[92:95],v[92:95]
v_mfma_f32_16x16x32_bf16 v[92:95],a[132:135],a[116:119],v[92:95]
v_mfma_f32_16x16x32_bf16 v[92:95],a[156:159],a[140:143],v[92:95]
v_mfma_f32_16x16x32_bf16 v[92:95],a[180:183],a[164:167],v[92:95]
v_mfma_f32_16x16x32_bf16 v[92:95],a[204:207],a[188:191],v[92:95]
v_mfma_f32_16x16x32_bf16 v[92:95],a[228:231],a[212:215],v[92:95]
v_mfma_f32_16x16x32_bf16 v[92:95],a[252:255],a[236:239],v[92:95]
v_pk_add_f32 v[176:177],v[176:177],v[40:41]
v_pk_add_f32 v[178:179],v[178:179],v[42:43]
v_pk_add_f32 v[180:181],v[180:181],v[56:57]
v_pk_add_f32 v[182:183],v[182:183],v[58:59]
v_pk_add_f32 v[184:185],v[184:185],v[72:73]
v_pk_add_f32 v[186:187],v[186:187],v[74:75]
v_pk_add_f32 v[188:189],v[188:189],v[88:89]
v_pk_add_f32 v[190:191],v[190:191],v[90:91]
v_pk_add_f32 v[192:193],v[192:193],v[44:45]
v_pk_add_f32 v[194:195],v[194:195],v[46:47]
v_pk_add_f32 v[196:197],v[196:197],v[60:61]
v_pk_add_f32 v[198:199],v[198:199],v[62:63]
v_pk_add_f32 v[200:201],v[200:201],v[76:77]
v_pk_add_f32 v[202:203],v[202:203],v[78:79]
v_pk_add_f32 v[204:205],v[204:205],v[92:93]
v_pk_add_f32 v[206:207],v[206:207],v[94:95]
s_mov_b32 s39,65536
Lxpl209:
s_waitcnt vmcnt(0)
v_max3_u32 v1,v128,v129,v130
v_max3_u32 v1,v1,v131,v132
v_max3_u32 v1,v1,v133,v134
v_max3_u32 v1,v1,v135,v136
v_max3_u32 v1,v1,v137,v138
v_max3_u32 v1,v1,v139,v140
v_max3_u32 v1,v1,v141,v142
v_max_u32 v1,v1,v143
v_cmp_eq_u32 vcc,-1,v1
s_nop 1
s_cmp_eq_u64 vcc,0
s_cbranch_scc1 Lxok210
buffer_load_dwordx4 v[128:131],v21,s[24:27],0 offen sc1
buffer_load_dwordx4 v[132:135],v21,s[24:27],0 offen offset:1024 sc1
buffer_load_dwordx4 v[136:139],v21,s[24:27],0 offen offset:2048 sc1
buffer_load_dwordx4 v[140:143],v21,s[24:27],0 offen offset:3072 sc1
s_sub_u32 s39,s39,1
s_cmp_lg_u32 s39,0
s_cbranch_scc1 Lxpl209
s_waitcnt vmcnt(0)
Lxok210:
v_lshlrev_b32 v96,16,v128
v_and_b32 v97,0xffff0000,v128
v_lshlrev_b32 v98,16,v129
v_and_b32 v99,0xffff0000,v129
v_lshlrev_b32 v100,16,v130
v_and_b32 v101,0xffff0000,v130
v_lshlrev_b32 v102,16,v131
v_and_b32 v103,0xffff0000,v131
v_lshlrev_b32 v104,16,v132
v_and_b32 v105,0xffff0000,v132
v_lshlrev_b32 v106,16,v133
v_and_b32 v107,0xffff0000,v133
v_lshlrev_b32 v108,16,v134
v_and_b32 v109,0xffff0000,v134
v_lshlrev_b32 v110,16,v135
v_and_b32 v111,0xffff0000,v135
v_lshlrev_b32 v112,16,v136
v_and_b32 v113,0xffff0000,v136
v_lshlrev_b32 v114,16,v137
v_and_b32 v115,0xffff0000,v137
v_lshlrev_b32 v116,16,v138
v_and_b32 v117,0xffff0000,v138
v_lshlrev_b32 v118,16,v139
v_and_b32 v119,0xffff0000,v139
v_lshlrev_b32 v120,16,v140
v_and_b32 v121,0xffff0000,v140
v_lshlrev_b32 v122,16,v141
v_and_b32 v123,0xffff0000,v141
v_lshlrev_b32 v124,16,v142
v_and_b32 v125,0xffff0000,v142
v_lshlrev_b32 v126,16,v143
v_and_b32 v127,0xffff0000,v143
s_barrier
s_mov_b32 s56,s80
s_mov_b32 s57,s81
s_mov_b32 s58,4194304
v_pk_add_f32 v[176:177],v[176:177],v[96:97]
v_pk_add_f32 v[178:179],v[178:179],v[98:99]
v_pk_add_f32 v[180:181],v[180:181],v[100:101]
v_pk_add_f32 v[182:183],v[182:183],v[102:103]
v_pk_add_f32 v[184:185],v[184:185],v[104:105]
v_pk_add_f32 v[186:187],v[186:187],v[106:107]
v_pk_add_f32 v[188:189],v[188:189],v[108:109]
v_pk_add_f32 v[190:191],v[190:191],v[110:111]
v_pk_add_f32 v[192:193],v[192:193],v[112:113]
v_pk_add_f32 v[194:195],v[194:195],v[114:115]
v_pk_add_f32 v[196:197],v[196:197],v[116:117]
v_pk_add_f32 v[198:199],v[198:199],v[118:119]
v_pk_add_f32 v[200:201],v[200:201],v[120:121]
v_pk_add_f32 v[202:203],v[202:203],v[122:123]
v_pk_add_f32 v[204:205],v[204:205],v[124:125]
v_pk_add_f32 v[206:207],v[206:207],v[126:127]
v_cvt_pk_bf16_f32 v32,v176,v177
v_cvt_pk_bf16_f32 v33,v178,v179
v_cvt_pk_bf16_f32 v34,v180,v181
v_cvt_pk_bf16_f32 v35,v182,v183
v_cvt_pk_bf16_f32 v36,v184,v185
v_cvt_pk_bf16_f32 v37,v186,v187
v_cvt_pk_bf16_f32 v38,v188,v189
v_cvt_pk_bf16_f32 v39,v190,v191
v_cvt_pk_bf16_f32 v40,v192,v193
v_cvt_pk_bf16_f32 v41,v194,v195
v_cvt_pk_bf16_f32 v42,v196,v197
v_cvt_pk_bf16_f32 v43,v198,v199
v_cvt_pk_bf16_f32 v44,v200,v201
v_cvt_pk_bf16_f32 v45,v202,v203
v_cvt_pk_bf16_f32 v46,v204,v205
v_cvt_pk_bf16_f32 v47,v206,v207
s_mul_i32 s18,s20,4608
v_mul_u32_u24 v1,144,v30
v_and_b32 v3,1,v31
v_lshl_add_u32 v1,v3,5,v1
v_lshrrev_b32 v3,1,v31
v_lshl_add_u32 v1,v3,4,v1
v_add_u32 v1,s18,v1
v_lshrrev_b32 v3,3,v2
v_mul_u32_u24 v0,144,v3
v_and_b32 v28,7,v2
v_lshl_add_u32 v0,v28,4,v0
v_add_u32 v0,s18,v0
v_lshlrev_b32 v3,11,v3
v_lshl_add_u32 v3,v28,4,v3
v_add_u32 v3,s93,v3
v_permlane16_swap_b32 v32,v34
v_permlane16_swap_b32 v33,v35
ds_write_b128 v1,v[32:35] offset:0
v_permlane16_swap_b32 v36,v38
v_permlane16_swap_b32 v37,v39
ds_write_b128 v1,v[36:39] offset:64
v_permlane16_swap_b32 v40,v42
v_permlane16_swap_b32 v41,v43
ds_write_b128 v1,v[40:43] offset:2304
v_permlane16_swap_b32 v44,v46
v_permlane16_swap_b32 v45,v47
ds_write_b128 v1,v[44:47] offset:2368
s_waitcnt lgkmcnt(0)
ds_read_b128 v[64:67],v0 offset:0
ds_read_b128 v[68:71],v0 offset:1152
ds_read_b128 v[72:75],v0 offset:2304
ds_read_b128 v[76:79],v0 offset:3456
s_mov_b32 s19,0
s_waitcnt lgkmcnt(3)
buffer_store_dwordx4 v[64:67],v3,s[56:59],s19 offen sc1
s_mov_b32 s19,16384
s_waitcnt lgkmcnt(2)
buffer_store_dwordx4 v[68:71],v3,s[56:59],s19 offen sc1
s_mov_b32 s19,32768
s_waitcnt lgkmcnt(1)
buffer_store_dwordx4 v[72:75],v3,s[56:59],s19 offen sc1
s_mov_b32 s19,49152
s_waitcnt lgkmcnt(0)
buffer_store_dwordx4 v[76:79],v3,s[56:59],s19 offen sc1
s_endpgm
Lsub_p3e:
s_mov_b32 s12,s78
s_mov_b32 s13,s79
s_mov_b32 s14,7340032
s_lshr_b32 s18,s20,1
s_lshl_b32 s18,s18,5
s_and_b32 s19,s85,7
s_lshl_b32 s19,s19,1
s_and_b32 s32,s20,1
s_add_u32 s19,s19,s32
s_lshl_b32 s19,s19,7
v_lshrrev_b32 v3,3,v2
v_add_u32 v3,s18,v3
v_mul_u32_u24 v3,2048,v3
v_add_u32 v3,s19,v3
v_and_b32 v1,1,v31
v_lshlrev_b32 v1,1,v1
v_and_b32 v0,7,v2
v_xor_b32 v1,v1,v0
v_lshl_add_u32 v8,v1,4,v3
v_xor_b32 v1,4,v1
v_lshl_add_u32 v9,v1,4,v3
v_add_u32 v9,15360,v9
v_add_u32 v10,30720,v8
v_add_u32 v11,30720,v9
s_lshl_b32 s41,s32,13
s_lshl_b32 s18,s18,7
s_add_u32 s41,s41,s18
s_add_u32 s41,s41,16384
s_mul_i32 s32,s88,3670016
s_mov_b32 s35,0
v_mfma_f32_16x16x32_bf16 v[32:35],a[176:179],a[232:235],v[32:35]
v_mfma_f32_16x16x32_bf16 v[36:39],a[176:179],a[236:239],v[36:39]
v_mfma_f32_16x16x32_bf16 v[40:43],a[176:179],a[240:243],v[40:43]
s_add_u32 m0,s35,s41
s_nop 0
buffer_load_dwordx4 v8,s[12:15],s32 offen lds
v_mfma_f32_16x16x32_bf16 v[44:47],a[176:179],a[244:247],v[44:47]
v_mfma_f32_16x16x32_bf16 v[48:51],a[180:183],a[232:235],v[48:51]
v_mfma_f32_16x16x32_bf16 v[52:55],a[180:183],a[236:239],v[52:55]
buffer_load_dwordx4 v9,s[12:15],s32 offen offset:1024 lds
v_mfma_f32_16x16x32_bf16 v[56:59],a[180:183],a[240:243],v[56:59]
v_mfma_f32_16x16x32_bf16 v[60:63],a[180:183],a[244:247],v[60:63]
v_mfma_f32_16x16x32_bf16 v[64:67],a[184:187],a[232:235],v[64:67]
buffer_load_dwordx4 v10,s[12:15],s32 offen offset:2048 lds
v_mfma_f32_16x16x32_bf16 v[68:71],a[184:187],a[236:239],v[68:71]
v_mfma_f32_16x16x32_bf16 v[72:75],a[184:187],a[240:243],v[72:75]
v_mfma_f32_16x16x32_bf16 v[76:79],a[184:187],a[244:247],v[76:79]
buffer_load_dwordx4 v11,s[12:15],s32 offen offset:3072 lds
s_add_u32 s35,s35,32768
s_cmp_eq_u32 s35,163840
s_cselect_b32 s35,0,s35
s_add_u32 s32,s32,131072
v_mfma_f32_16x16x32_bf16 v[80:83],a[188:191],a[232:235],v[80:83]
v_mfma_f32_16x16x32_bf16 v[84:87],a[188:191],a[236:239],v[84:87]
v_mfma_f32_16x16x32_bf16 v[88:91],a[188:191],a[240:243],v[88:91]
s_add_u32 m0,s35,s41
s_nop 0
buffer_load_dwordx4 v8,s[12:15],s32 offen lds
v_mfma_f32_16x16x32_bf16 v[92:95],a[188:191],a[244:247],v[92:95]
v_mfma_f32_16x16x32_bf16 v[96:99],a[192:195],a[232:235],v[96:99]
v_mfma_f32_16x16x32_bf16 v[100:103],a[192:195],a[236:239],v[100:103]
buffer_load_dwordx4 v9,s[12:15],s32 offen offset:1024 lds
v_mfma_f32_16x16x32_bf16 v[104:107],a[192:195],a[240:243],v[104:107]
v_mfma_f32_16x16x32_bf16 v[108:111],a[192:195],a[244:247],v[108:111]
v_mfma_f32_16x16x32_bf16 v[112:115],a[196:199],a[232:235],v[112:115]
buffer_load_dwordx4 v10,s[12:15],s32 offen offset:2048 lds
v_mfma_f32_16x16x32_bf16 v[116:119],a[196:199],a[236:239],v[116:119]
v_mfma_f32_16x16x32_bf16 v[120:123],a[196:199],a[240:243],v[120:123]
v_mfma_f32_16x16x32_bf16 v[124:127],a[196:199],a[244:247],v[124:127]
buffer_load_dwordx4 v11,s[12:15],s32 offen offset:3072 lds
s_add_u32 s35,s35,32768
s_cmp_eq_u32 s35,163840
s_cselect_b32 s35,0,s35
s_add_u32 s32,s32,131072
v_mfma_f32_16x16x32_bf16 v[128:131],a[200:203],a[232:235],v[128:131]
v_mfma_f32_16x16x32_bf16 v[132:135],a[200:203],a[236:239],v[132:135]
v_mfma_f32_16x16x32_bf16 v[136:139],a[200:203],a[240:243],v[136:139]
s_add_u32 m0,s35,s41
s_nop 0
buffer_load_dwordx4 v8,s[12:15],s32 offen lds
v_mfma_f32_16x16x32_bf16 v[140:143],a[200:203],a[244:247],v[140:143]
v_mfma_f32_16x16x32_bf16 v[144:147],a[204:207],a[232:235],v[144:147]
v_mfma_f32_16x16x32_bf16 v[148:151],a[204:207],a[236:239],v[148:151]
buffer_load_dwordx4 v9,s[12:15],s32 offen offset:1024 lds
v_mfma_f32_16x16x32_bf16 v[152:155],a[204:207],a[240:243],v[152:155]
v_mfma_f32_16x16x32_bf16 v[156:159],a[204:207],a[244:247],v[156:159]
v_mfma_f32_16x16x32_bf16 v[160:163],a[208:211],a[232:235],v[160:163]
buffer_load_dwordx4 v10,s[12:15],s32 offen offset:2048 lds
v_mfma_f32_16x16x32_bf16 v[164:167],a[208:211],a[236:239],v[164:167]
v_mfma_f32_16x16x32_bf16 v[168:171],a[208:211],a[240:243],v[168:171]
v_mfma_f32_16x16x32_bf16 v[172:175],a[208:211],a[244:247],v[172:175]
buffer_load_dwordx4 v11,s[12:15],s32 offen offset:3072 lds
s_add_u32 s35,s35,32768
s_cmp_eq_u32 s35,163840
s_cselect_b32 s35,0,s35
s_add_u32 s32,s32,131072
v_mfma_f32_16x16x32_bf16 v[176:179],a[212:215],a[232:235],v[176:179]
v_mfma_f32_16x16x32_bf16 v[180:183],a[212:215],a[236:239],v[180:183]
v_mfma_f32_16x16x32_bf16 v[184:187],a[212:215],a[240:243],v[184:187]
s_add_u32 m0,s35,s41
s_nop 0
buffer_load_dwordx4 v8,s[12:15],s32 offen lds
v_mfma_f32_16x16x32_bf16 v[188:191],a[212:215],a[244:247],v[188:191]
v_mfma_f32_16x16x32_bf16 v[192:195],a[216:219],a[232:235],v[192:195]
v_mfma_f32_16x16x32_bf16 v[196:199],a[216:219],a[236:239],v[196:199]
buffer_load_dwordx4 v9,s[12:15],s32 offen offset:1024 lds
v_mfma_f32_16x16x32_bf16 v[200:203],a[216:219],a[240:243],v[200:203]
v_mfma_f32_16x16x32_bf16 v[204:207],a[216:219],a[244:247],v[204:207]
v_mfma_f32_16x16x32_bf16 v[208:211],a[220:223],a[232:235],v[208:211]
buffer_load_dwordx4 v10,s[12:15],s32 offen offset:2048 lds
v_mfma_f32_16x16x32_bf16 v[212:215],a[220:223],a[236:239],v[212:215]
v_mfma_f32_16x16x32_bf16 v[216:219],a[220:223],a[240:243],v[216:219]
v_mfma_f32_16x16x32_bf16 v[220:223],a[220:223],a[244:247],v[220:223]
buffer_load_dwordx4 v11,s[12:15],s32 offen offset:3072 lds
s_add_u32 s35,s35,32768
s_cmp_eq_u32 s35,163840
s_cselect_b32 s35,0,s35
s_add_u32 s32,s32,131072
v_mfma_f32_16x16x32_bf16 v[224:227],a[224:227],a[232:235],v[224:227]
v_mfma_f32_16x16x32_bf16 v[228:231],a[224:227],a[236:239],v[228:231]
v_mfma_f32_16x16x32_bf16 v[232:235],a[224:227],a[240:243],v[232:235]
s_add_u32 m0,s35,s41
s_nop 0
buffer_load_dwordx4 v8,s[12:15],s32 offen lds
v_mfma_f32_16x16x32_bf16 v[236:239],a[224:227],a[244:247],v[236:239]
v_mfma_f32_16x16x32_bf16 v[240:243],a[228:231],a[232:235],v[240:243]
v_mfma_f32_16x16x32_bf16 v[244:247],a[228:231],a[236:239],v[244:247]
buffer_load_dwordx4 v9,s[12:15],s32 offen offset:1024 lds
v_mfma_f32_16x16x32_bf16 v[248:251],a[228:231],a[240:243],v[248:251]
v_mfma_f32_16x16x32_bf16 v[252:255],a[228:231],a[244:247],v[252:255]
buffer_load_dwordx4 v10,s[12:15],s32 offen offset:2048 lds
buffer_load_dwordx4 v11,s[12:15],s32 offen offset:3072 lds
s_add_u32 s35,s35,32768
s_cmp_eq_u32 s35,163840
s_cselect_b32 s35,0,s35
s_add_u32 s32,s32,131072
s_add_u32 s56,s16,12648448
s_addc_u32 s57,s17,0
s_mov_b32 s58,14680064
s_mov_b32 s60,0
s_mov_b32 s61,114688
s_mov_b32 s62,229376
s_mov_b32 s63,344064
v_and_b32 v1,1,v31
v_mul_u32_u24 v1,114176,v1
v_add_u32 v14,v1,v15
v_pk_mul_f32 v[4:5],v[32:33],v[32:33]
v_pk_mul_f32 v[6:7],v[34:35],v[34:35]
v_pk_mul_f32 v[12:13],v[48:49],v[48:49]
v_pk_mul_f32 v[28:29],v[50:51],v[50:51]
v_pk_fma_f32 v[4:5],v[4:5],v[20:21],v[16:17] op_sel:[0,0,0] op_sel_hi:[1,0,0]
v_pk_fma_f32 v[6:7],v[6:7],v[20:21],v[16:17] op_sel:[0,0,0] op_sel_hi:[1,0,0]
v_pk_fma_f32 v[12:13],v[12:13],v[20:21],v[16:17] op_sel:[0,0,0] op_sel_hi:[1,0,0]
v_pk_fma_f32 v[28:29],v[28:29],v[20:21],v[16:17] op_sel:[0,0,0] op_sel_hi:[1,0,0]
v_pk_mul_f32 v[4:5],v[4:5],v[32:33]
v_pk_mul_f32 v[6:7],v[6:7],v[34:35]
v_pk_mul_f32 v[12:13],v[12:13],v[48:49]
v_pk_mul_f32 v[28:29],v[28:29],v[50:51]
v_exp_f32 v4,v4
v_exp_f32 v5,v5
v_exp_f32 v6,v6
v_exp_f32 v7,v7
v_exp_f32 v12,v12
v_exp_f32 v13,v13
v_exp_f32 v28,v28
v_exp_f32 v29,v29
v_pk_mul_f32 v[144:145],v[144:145],v[32:33]
v_pk_mul_f32 v[146:147],v[146:147],v[34:35]
v_pk_mul_f32 v[160:161],v[160:161],v[48:49]
v_pk_mul_f32 v[162:163],v[162:163],v[50:51]
v_pk_fma_f32 v[4:5],v[4:5],v[24:25],v[24:25] op_sel:[0,0,0] op_sel_hi:[1,0,0]
v_pk_fma_f32 v[6:7],v[6:7],v[24:25],v[24:25] op_sel:[0,0,0] op_sel_hi:[1,0,0]
v_pk_fma_f32 v[12:13],v[12:13],v[24:25],v[24:25] op_sel:[0,0,0] op_sel_hi:[1,0,0]
v_pk_fma_f32 v[28:29],v[28:29],v[24:25],v[24:25] op_sel:[0,0,0] op_sel_hi:[1,0,0]
v_rcp_f32 v4,v4
v_rcp_f32 v5,v5
v_rcp_f32 v6,v6
v_rcp_f32 v7,v7
v_rcp_f32 v12,v12
v_rcp_f32 v13,v13
v_rcp_f32 v28,v28
v_rcp_f32 v29,v29
v_pk_mul_f32 v[144:145],v[144:145],v[4:5]
v_pk_mul_f32 v[146:147],v[146:147],v[6:7]
v_pk_mul_f32 v[160:161],v[160:161],v[12:13]
v_pk_mul_f32 v[162:163],v[162:163],v[28:29]
v_cvt_pk_bf16_f32 v32,v144,v145
v_cvt_pk_bf16_f32 v33,v146,v147
v_cvt_pk_bf16_f32 v34,v160,v161
v_cvt_pk_bf16_f32 v35,v162,v163
s_nop 0
v_permlane16_swap_b32 v32,v34
v_permlane16_swap_b32 v33,v35
buffer_store_dwordx4 v[32:35],v15,s[56:59],s60 offen sc1
v_pk_mul_f32 v[4:5],v[64:65],v[64:65]
v_pk_mul_f32 v[6:7],v[66:67],v[66:67]
v_pk_mul_f32 v[12:13],v[80:81],v[80:81]
v_pk_mul_f32 v[28:29],v[82:83],v[82:83]
v_pk_fma_f32 v[4:5],v[4:5],v[20:21],v[16:17] op_sel:[0,0,0] op_sel_hi:[1,0,0]
v_pk_fma_f32 v[6:7],v[6:7],v[20:21],v[16:17] op_sel:[0,0,0] op_sel_hi:[1,0,0]
v_pk_fma_f32 v[12:13],v[12:13],v[20:21],v[16:17] op_sel:[0,0,0] op_sel_hi:[1,0,0]
v_pk_fma_f32 v[28:29],v[28:29],v[20:21],v[16:17] op_sel:[0,0,0] op_sel_hi:[1,0,0]
v_pk_mul_f32 v[4:5],v[4:5],v[64:65]
v_pk_mul_f32 v[6:7],v[6:7],v[66:67]
v_pk_mul_f32 v[12:13],v[12:13],v[80:81]
v_pk_mul_f32 v[28:29],v[28:29],v[82:83]
v_exp_f32 v4,v4
v_exp_f32 v5,v5
v_exp_f32 v6,v6
v_exp_f32 v7,v7
v_exp_f32 v12,v12
v_exp_f32 v13,v13
v_exp_f32 v28,v28
v_exp_f32 v29,v29
v_pk_mul_f32 v[176:177],v[176:177],v[64:65]
v_pk_mul_f32 v[178:179],v[178:179],v[66:67]
v_pk_mul_f32 v[192:193],v[192:193],v[80:81]
v_pk_mul_f32 v[194:195],v[194:195],v[82:83]
v_pk_fma_f32 v[4:5],v[4:5],v[24:25],v[24:25] op_sel:[0,0,0] op_sel_hi:[1,0,0]
v_pk_fma_f32 v[6:7],v[6:7],v[24:25],v[24:25] op_sel:[0,0,0] op_sel_hi:[1,0,0]
v_pk_fma_f32 v[12:13],v[12:13],v[24:25],v[24:25] op_sel:[0,0,0] op_sel_hi:[1,0,0]
v_pk_fma_f32 v[28:29],v[28:29],v[24:25],v[24:25] op_sel:[0,0,0] op_sel_hi:[1,0,0]
v_rcp_f32 v4,v4
v_rcp_f32 v5,v5
v_rcp_f32 v6,v6
v_rcp_f32 v7,v7
v_rcp_f32 v12,v12
v_rcp_f32 v13,v13
v_rcp_f32 v28,v28
v_rcp_f32 v29,v29
v_pk_mul_f32 v[176:177],v[176:177],v[4:5]
v_pk_mul_f32 v[178:179],v[178:179],v[6:7]
v_pk_mul_f32 v[192:193],v[192:193],v[12:13]
v_pk_mul_f32 v[194:195],v[194:195],v[28:29]
v_cvt_pk_bf16_f32 v64,v176,v177
v_cvt_pk_bf16_f32 v65,v178,v179
v_cvt_pk_bf16_f32 v66,v192,v193
v_cvt_pk_bf16_f32 v67,v194,v195
s_nop 0
v_permlane16_swap_b32 v64,v66
v_permlane16_swap_b32 v65,v67
buffer_store_dwordx4 v[64:67],v15,s[56:59],s60 offen offset:1024 sc1
v_pk_mul_f32 v[4:5],v[96:97],v[96:97]
v_pk_mul_f32 v[6:7],v[98:99],v[98:99]
v_pk_mul_f32 v[12:13],v[112:113],v[112:113]
v_pk_mul_f32 v[28:29],v[114:115],v[114:115]
v_pk_fma_f32 v[4:5],v[4:5],v[20:21],v[16:17] op_sel:[0,0,0] op_sel_hi:[1,0,0]
v_pk_fma_f32 v[6:7],v[6:7],v[20:21],v[16:17] op_sel:[0,0,0] op_sel_hi:[1,0,0]
v_pk_fma_f32 v[12:13],v[12:13],v[20:21],v[16:17] op_sel:[0,0,0] op_sel_hi:[1,0,0]
v_pk_fma_f32 v[28:29],v[28:29],v[20:21],v[16:17] op_sel:[0,0,0] op_sel_hi:[1,0,0]
v_pk_mul_f32 v[4:5],v[4:5],v[96:97]
v_pk_mul_f32 v[6:7],v[6:7],v[98:99]
v_pk_mul_f32 v[12:13],v[12:13],v[112:113]
v_pk_mul_f32 v[28:29],v[28:29],v[114:115]
v_exp_f32 v4,v4
v_exp_f32 v5,v5
v_exp_f32 v6,v6
v_exp_f32 v7,v7
v_exp_f32 v12,v12
v_exp_f32 v13,v13
v_exp_f32 v28,v28
v_exp_f32 v29,v29
v_pk_mul_f32 v[208:209],v[208:209],v[96:97]
v_pk_mul_f32 v[210:211],v[210:211],v[98:99]
v_pk_mul_f32 v[224:225],v[224:225],v[112:113]
v_pk_mul_f32 v[226:227],v[226:227],v[114:115]
v_pk_fma_f32 v[4:5],v[4:5],v[24:25],v[24:25] op_sel:[0,0,0] op_sel_hi:[1,0,0]
v_pk_fma_f32 v[6:7],v[6:7],v[24:25],v[24:25] op_sel:[0,0,0] op_sel_hi:[1,0,0]
v_pk_fma_f32 v[12:13],v[12:13],v[24:25],v[24:25] op_sel:[0,0,0] op_sel_hi:[1,0,0]
v_pk_fma_f32 v[28:29],v[28:29],v[24:25],v[24:25] op_sel:[0,0,0] op_sel_hi:[1,0,0]
v_rcp_f32 v4,v4
v_rcp_f32 v5,v5
v_rcp_f32 v6,v6
v_rcp_f32 v7,v7
v_rcp_f32 v12,v12
v_rcp_f32 v13,v13
v_rcp_f32 v28,v28
v_rcp_f32 v29,v29
v_pk_mul_f32 v[208:209],v[208:209],v[4:5]
v_pk_mul_f32 v[210:211],v[210:211],v[6:7]
v_pk_mul_f32 v[224:225],v[224:225],v[12:13]
v_pk_mul_f32 v[226:227],v[226:227],v[28:29]
v_cvt_pk_bf16_f32 v96,v208,v209
v_cvt_pk_bf16_f32 v97,v210,v211
v_cvt_pk_bf16_f32 v98,v224,v225
v_cvt_pk_bf16_f32 v99,v226,v227
s_nop 0
v_permlane16_swap_b32 v96,v98
v_permlane16_swap_b32 v97,v99
buffer_store_dwordx4 v[96:99],v15,s[56:59],s60 offen offset:2048 sc1
v_pk_mul_f32 v[4:5],v[36:37],v[36:37]
v_pk_mul_f32 v[6:7],v[38:39],v[38:39]
v_pk_mul_f32 v[12:13],v[52:53],v[52:53]
v_pk_mul_f32 v[28:29],v[54:55],v[54:55]
v_pk_fma_f32 v[4:5],v[4:5],v[20:21],v[16:17] op_sel:[0,1,1] op_sel_hi:[1,1,1]
v_pk_fma_f32 v[6:7],v[6:7],v[20:21],v[16:17] op_sel:[0,1,1] op_sel_hi:[1,1,1]
v_pk_fma_f32 v[12:13],v[12:13],v[20:21],v[16:17] op_sel:[0,1,1] op_sel_hi:[1,1,1]
v_pk_fma_f32 v[28:29],v[28:29],v[20:21],v[16:17] op_sel:[0,1,1] op_sel_hi:[1,1,1]
v_pk_mul_f32 v[4:5],v[4:5],v[36:37]
v_pk_mul_f32 v[6:7],v[6:7],v[38:39]
v_pk_mul_f32 v[12:13],v[12:13],v[52:53]
v_pk_mul_f32 v[28:29],v[28:29],v[54:55]
v_exp_f32 v4,v4
v_exp_f32 v5,v5
v_exp_f32 v6,v6
v_exp_f32 v7,v7
v_exp_f32 v12,v12
v_exp_f32 v13,v13
v_exp_f32 v28,v28
v_exp_f32 v29,v29
v_pk_mul_f32 v[148:149],v[148:149],v[36:37]
v_pk_mul_f32 v[150:151],v[150:151],v[38:39]
v_pk_mul_f32 v[164:165],v[164:165],v[52:53]
v_pk_mul_f32 v[166:167],v[166:167],v[54:55]
v_pk_fma_f32 v[4:5],v[4:5],v[24:25],v[24:25] op_sel:[0,1,1] op_sel_hi:[1,1,1]
v_pk_fma_f32 v[6:7],v[6:7],v[24:25],v[24:25] op_sel:[0,1,1] op_sel_hi:[1,1,1]
v_pk_fma_f32 v[12:13],v[12:13],v[24:25],v[24:25] op_sel:[0,1,1] op_sel_hi:[1,1,1]
v_pk_fma_f32 v[28:29],v[28:29],v[24:25],v[24:25] op_sel:[0,1,1] op_sel_hi:[1,1,1]
v_rcp_f32 v4,v4
v_rcp_f32 v5,v5
v_rcp_f32 v6,v6
v_rcp_f32 v7,v7
v_rcp_f32 v12,v12
v_rcp_f32 v13,v13
v_rcp_f32 v28,v28
v_rcp_f32 v29,v29
v_pk_mul_f32 v[148:149],v[148:149],v[4:5]
v_pk_mul_f32 v[150:151],v[150:151],v[6:7]
v_pk_mul_f32 v[164:165],v[164:165],v[12:13]
v_pk_mul_f32 v[166:167],v[166:167],v[28:29]
v_cvt_pk_bf16_f32 v36,v148,v149
v_cvt_pk_bf16_f32 v37,v150,v151
v_cvt_pk_bf16_f32 v38,v164,v165
v_cvt_pk_bf16_f32 v39,v166,v167
s_nop 0
v_permlane16_swap_b32 v36,v38
v_permlane16_swap_b32 v37,v39
buffer_store_dwordx4 v[36:39],v15,s[56:59],s61 offen sc1
v_pk_mul_f32 v[4:5],v[68:69],v[68:69]
v_pk_mul_f32 v[6:7],v[70:71],v[70:71]
v_pk_mul_f32 v[12:13],v[84:85],v[84:85]
v_pk_mul_f32 v[28:29],v[86:87],v[86:87]
v_pk_fma_f32 v[4:5],v[4:5],v[20:21],v[16:17] op_sel:[0,1,1] op_sel_hi:[1,1,1]
v_pk_fma_f32 v[6:7],v[6:7],v[20:21],v[16:17] op_sel:[0,1,1] op_sel_hi:[1,1,1]
v_pk_fma_f32 v[12:13],v[12:13],v[20:21],v[16:17] op_sel:[0,1,1] op_sel_hi:[1,1,1]
v_pk_fma_f32 v[28:29],v[28:29],v[20:21],v[16:17] op_sel:[0,1,1] op_sel_hi:[1,1,1]
v_pk_mul_f32 v[4:5],v[4:5],v[68:69]
v_pk_mul_f32 v[6:7],v[6:7],v[70:71]
v_pk_mul_f32 v[12:13],v[12:13],v[84:85]
v_pk_mul_f32 v[28:29],v[28:29],v[86:87]
v_exp_f32 v4,v4
v_exp_f32 v5,v5
v_exp_f32 v6,v6
v_exp_f32 v7,v7
v_exp_f32 v12,v12
v_exp_f32 v13,v13
v_exp_f32 v28,v28
v_exp_f32 v29,v29
v_pk_mul_f32 v[180:181],v[180:181],v[68:69]
v_pk_mul_f32 v[182:183],v[182:183],v[70:71]
v_pk_mul_f32 v[196:197],v[196:197],v[84:85]
v_pk_mul_f32 v[198:199],v[198:199],v[86:87]
v_pk_fma_f32 v[4:5],v[4:5],v[24:25],v[24:25] op_sel:[0,1,1] op_sel_hi:[1,1,1]
v_pk_fma_f32 v[6:7],v[6:7],v[24:25],v[24:25] op_sel:[0,1,1] op_sel_hi:[1,1,1]
v_pk_fma_f32 v[12:13],v[12:13],v[24:25],v[24:25] op_sel:[0,1,1] op_sel_hi:[1,1,1]
v_pk_fma_f32 v[28:29],v[28:29],v[24:25],v[24:25] op_sel:[0,1,1] op_sel_hi:[1,1,1]
v_rcp_f32 v4,v4
v_rcp_f32 v5,v5
v_rcp_f32 v6,v6
v_rcp_f32 v7,v7
v_rcp_f32 v12,v12
v_rcp_f32 v13,v13
v_rcp_f32 v28,v28
v_rcp_f32 v29,v29
v_pk_mul_f32 v[180:181],v[180:181],v[4:5]
v_pk_mul_f32 v[182:183],v[182:183],v[6:7]
v_pk_mul_f32 v[196:197],v[196:197],v[12:13]
v_pk_mul_f32 v[198:199],v[198:199],v[28:29]
v_cvt_pk_bf16_f32 v68,v180,v181
v_cvt_pk_bf16_f32 v69,v182,v183
v_cvt_pk_bf16_f32 v70,v196,v197
v_cvt_pk_bf16_f32 v71,v198,v199
s_nop 0
v_permlane16_swap_b32 v68,v70
v_permlane16_swap_b32 v69,v71
buffer_store_dwordx4 v[68:71],v15,s[56:59],s61 offen offset:1024 sc1
v_pk_mul_f32 v[4:5],v[100:101],v[100:101]
v_pk_mul_f32 v[6:7],v[102:103],v[102:103]
v_pk_mul_f32 v[12:13],v[116:117],v[116:117]
v_pk_mul_f32 v[28:29],v[118:119],v[118:119]
v_pk_fma_f32 v[4:5],v[4:5],v[20:21],v[16:17] op_sel:[0,1,1] op_sel_hi:[1,1,1]
v_pk_fma_f32 v[6:7],v[6:7],v[20:21],v[16:17] op_sel:[0,1,1] op_sel_hi:[1,1,1]
v_pk_fma_f32 v[12:13],v[12:13],v[20:21],v[16:17] op_sel:[0,1,1] op_sel_hi:[1,1,1]
v_pk_fma_f32 v[28:29],v[28:29],v[20:21],v[16:17] op_sel:[0,1,1] op_sel_hi:[1,1,1]
v_pk_mul_f32 v[4:5],v[4:5],v[100:101]
v_pk_mul_f32 v[6:7],v[6:7],v[102:103]
v_pk_mul_f32 v[12:13],v[12:13],v[116:117]
v_pk_mul_f32 v[28:29],v[28:29],v[118:119]
v_exp_f32 v4,v4
v_exp_f32 v5,v5
v_exp_f32 v6,v6
v_exp_f32 v7,v7
v_exp_f32 v12,v12
v_exp_f32 v13,v13
v_exp_f32 v28,v28
v_exp_f32 v29,v29
v_pk_mul_f32 v[212:213],v[212:213],v[100:101]
v_pk_mul_f32 v[214:215],v[214:215],v[102:103]
v_pk_mul_f32 v[228:229],v[228:229],v[116:117]
v_pk_mul_f32 v[230:231],v[230:231],v[118:119]
v_pk_fma_f32 v[4:5],v[4:5],v[24:25],v[24:25] op_sel:[0,1,1] op_sel_hi:[1,1,1]
v_pk_fma_f32 v[6:7],v[6:7],v[24:25],v[24:25] op_sel:[0,1,1] op_sel_hi:[1,1,1]
v_pk_fma_f32 v[12:13],v[12:13],v[24:25],v[24:25] op_sel:[0,1,1] op_sel_hi:[1,1,1]
v_pk_fma_f32 v[28:29],v[28:29],v[24:25],v[24:25] op_sel:[0,1,1] op_sel_hi:[1,1,1]
v_rcp_f32 v4,v4
v_rcp_f32 v5,v5
v_rcp_f32 v6,v6
v_rcp_f32 v7,v7
v_rcp_f32 v12,v12
v_rcp_f32 v13,v13
v_rcp_f32 v28,v28
v_rcp_f32 v29,v29
v_pk_mul_f32 v[212:213],v[212:213],v[4:5]
v_pk_mul_f32 v[214:215],v[214:215],v[6:7]
v_pk_mul_f32 v[228:229],v[228:229],v[12:13]
v_pk_mul_f32 v[230:231],v[230:231],v[28:29]
v_cvt_pk_bf16_f32 v100,v212,v213
v_cvt_pk_bf16_f32 v101,v214,v215
v_cvt_pk_bf16_f32 v102,v228,v229
v_cvt_pk_bf16_f32 v103,v230,v231
s_nop 0
v_permlane16_swap_b32 v100,v102
v_permlane16_swap_b32 v101,v103
buffer_store_dwordx4 v[100:103],v15,s[56:59],s61 offen offset:2048 sc1
v_pk_mul_f32 v[4:5],v[128:129],v[128:129]
v_pk_mul_f32 v[6:7],v[130:131],v[130:131]
v_pk_mul_f32 v[12:13],v[132:133],v[132:133]
v_pk_mul_f32 v[28:29],v[134:135],v[134:135]
v_pk_fma_f32 v[4:5],v[4:5],v[20:21],v[16:17] op_sel:[0,0,0] op_sel_hi:[1,0,0]
v_pk_fma_f32 v[6:7],v[6:7],v[20:21],v[16:17] op_sel:[0,0,0] op_sel_hi:[1,0,0]
v_pk_fma_f32 v[12:13],v[12:13],v[20:21],v[16:17] op_sel:[0,1,1] op_sel_hi:[1,1,1]
v_pk_fma_f32 v[28:29],v[28:29],v[20:21],v[16:17] op_sel:[0,1,1] op_sel_hi:[1,1,1]
v_pk_mul_f32 v[4:5],v[4:5],v[128:129]
v_pk_mul_f32 v[6:7],v[6:7],v[130:131]
v_pk_mul_f32 v[12:13],v[12:13],v[132:133]
v_pk_mul_f32 v[28:29],v[28:29],v[134:135]
v_exp_f32 v4,v4
v_exp_f32 v5,v5
v_exp_f32 v6,v6
v_exp_f32 v7,v7
v_exp_f32 v12,v12
v_exp_f32 v13,v13
v_exp_f32 v28,v28
v_exp_f32 v29,v29
v_pk_mul_f32 v[240:241],v[240:241],v[128:129]
v_pk_mul_f32 v[242:243],v[242:243],v[130:131]
v_pk_mul_f32 v[244:245],v[244:245],v[132:133]
v_pk_mul_f32 v[246:247],v[246:247],v[134:135]
v_pk_fma_f32 v[4:5],v[4:5],v[24:25],v[24:25] op_sel:[0,0,0] op_sel_hi:[1,0,0]
v_pk_fma_f32 v[6:7],v[6:7],v[24:25],v[24:25] op_sel:[0,0,0] op_sel_hi:[1,0,0]
v_pk_fma_f32 v[12:13],v[12:13],v[24:25],v[24:25] op_sel:[0,1,1] op_sel_hi:[1,1,1]
v_pk_fma_f32 v[28:29],v[28:29],v[24:25],v[24:25] op_sel:[0,1,1] op_sel_hi:[1,1,1]
v_rcp_f32 v4,v4
v_rcp_f32 v5,v5
v_rcp_f32 v6,v6
v_rcp_f32 v7,v7
v_rcp_f32 v12,v12
v_rcp_f32 v13,v13
v_rcp_f32 v28,v28
v_rcp_f32 v29,v29
v_pk_mul_f32 v[240:241],v[240:241],v[4:5]
v_pk_mul_f32 v[242:243],v[242:243],v[6:7]
v_pk_mul_f32 v[244:245],v[244:245],v[12:13]
v_pk_mul_f32 v[246:247],v[246:247],v[28:29]
v_cvt_pk_bf16_f32 v128,v240,v241
v_cvt_pk_bf16_f32 v129,v242,v243
v_cvt_pk_bf16_f32 v130,v244,v245
v_cvt_pk_bf16_f32 v131,v246,v247
s_nop 0
v_permlane16_swap_b32 v128,v130
v_permlane16_swap_b32 v129,v131
buffer_store_dwordx4 v[128:131],v14,s[56:59],s60 offen offset:3072 sc1
v_pk_mul_f32 v[4:5],v[40:41],v[40:41]
v_pk_mul_f32 v[6:7],v[42:43],v[42:43]
v_pk_mul_f32 v[12:13],v[56:57],v[56:57]
v_pk_mul_f32 v[28:29],v[58:59],v[58:59]
v_pk_fma_f32 v[4:5],v[4:5],v[22:23],v[18:19] op_sel:[0,0,0] op_sel_hi:[1,0,0]
v_pk_fma_f32 v[6:7],v[6:7],v[22:23],v[18:19] op_sel:[0,0,0] op_sel_hi:[1,0,0]
v_pk_fma_f32 v[12:13],v[12:13],v[22:23],v[18:19] op_sel:[0,0,0] op_sel_hi:[1,0,0]
v_pk_fma_f32 v[28:29],v[28:29],v[22:23],v[18:19] op_sel:[0,0,0] op_sel_hi:[1,0,0]
v_pk_mul_f32 v[4:5],v[4:5],v[40:41]
v_pk_mul_f32 v[6:7],v[6:7],v[42:43]
v_pk_mul_f32 v[12:13],v[12:13],v[56:57]
v_pk_mul_f32 v[28:29],v[28:29],v[58:59]
v_exp_f32 v4,v4
v_exp_f32 v5,v5
v_exp_f32 v6,v6
v_exp_f32 v7,v7
v_exp_f32 v12,v12
v_exp_f32 v13,v13
v_exp_f32 v28,v28
v_exp_f32 v29,v29
v_pk_mul_f32 v[152:153],v[152:153],v[40:41]
v_pk_mul_f32 v[154:155],v[154:155],v[42:43]
v_pk_mul_f32 v[168:169],v[168:169],v[56:57]
v_pk_mul_f32 v[170:171],v[170:171],v[58:59]
v_pk_fma_f32 v[4:5],v[4:5],v[26:27],v[26:27] op_sel:[0,0,0] op_sel_hi:[1,0,0]
v_pk_fma_f32 v[6:7],v[6:7],v[26:27],v[26:27] op_sel:[0,0,0] op_sel_hi:[1,0,0]
v_pk_fma_f32 v[12:13],v[12:13],v[26:27],v[26:27] op_sel:[0,0,0] op_sel_hi:[1,0,0]
v_pk_fma_f32 v[28:29],v[28:29],v[26:27],v[26:27] op_sel:[0,0,0] op_sel_hi:[1,0,0]
v_rcp_f32 v4,v4
v_rcp_f32 v5,v5
v_rcp_f32 v6,v6
v_rcp_f32 v7,v7
v_rcp_f32 v12,v12
v_rcp_f32 v13,v13
v_rcp_f32 v28,v28
v_rcp_f32 v29,v29
v_pk_mul_f32 v[152:153],v[152:153],v[4:5]
v_pk_mul_f32 v[154:155],v[154:155],v[6:7]
v_pk_mul_f32 v[168:169],v[168:169],v[12:13]
v_pk_mul_f32 v[170:171],v[170:171],v[28:29]
v_cvt_pk_bf16_f32 v40,v152,v153
v_cvt_pk_bf16_f32 v41,v154,v155
v_cvt_pk_bf16_f32 v42,v168,v169
v_cvt_pk_bf16_f32 v43,v170,v171
s_nop 0
v_permlane16_swap_b32 v40,v42
v_permlane16_swap_b32 v41,v43
buffer_store_dwordx4 v[40:43],v15,s[56:59],s62 offen sc1
v_pk_mul_f32 v[4:5],v[72:73],v[72:73]
v_pk_mul_f32 v[6:7],v[74:75],v[74:75]
v_pk_mul_f32 v[12:13],v[88:89],v[88:89]
v_pk_mul_f32 v[28:29],v[90:91],v[90:91]
v_pk_fma_f32 v[4:5],v[4:5],v[22:23],v[18:19] op_sel:[0,0,0] op_sel_hi:[1,0,0]
v_pk_fma_f32 v[6:7],v[6:7],v[22:23],v[18:19] op_sel:[0,0,0] op_sel_hi:[1,0,0]
v_pk_fma_f32 v[12:13],v[12:13],v[22:23],v[18:19] op_sel:[0,0,0] op_sel_hi:[1,0,0]
v_pk_fma_f32 v[28:29],v[28:29],v[22:23],v[18:19] op_sel:[0,0,0] op_sel_hi:[1,0,0]
v_pk_mul_f32 v[4:5],v[4:5],v[72:73]
v_pk_mul_f32 v[6:7],v[6:7],v[74:75]
v_pk_mul_f32 v[12:13],v[12:13],v[88:89]
v_pk_mul_f32 v[28:29],v[28:29],v[90:91]
v_exp_f32 v4,v4
v_exp_f32 v5,v5
v_exp_f32 v6,v6
v_exp_f32 v7,v7
v_exp_f32 v12,v12
v_exp_f32 v13,v13
v_exp_f32 v28,v28
v_exp_f32 v29,v29
v_pk_mul_f32 v[184:185],v[184:185],v[72:73]
v_pk_mul_f32 v[186:187],v[186:187],v[74:75]
v_pk_mul_f32 v[200:201],v[200:201],v[88:89]
v_pk_mul_f32 v[202:203],v[202:203],v[90:91]
v_pk_fma_f32 v[4:5],v[4:5],v[26:27],v[26:27] op_sel:[0,0,0] op_sel_hi:[1,0,0]
v_pk_fma_f32 v[6:7],v[6:7],v[26:27],v[26:27] op_sel:[0,0,0] op_sel_hi:[1,0,0]
v_pk_fma_f32 v[12:13],v[12:13],v[26:27],v[26:27] op_sel:[0,0,0] op_sel_hi:[1,0,0]
v_pk_fma_f32 v[28:29],v[28:29],v[26:27],v[26:27] op_sel:[0,0,0] op_sel_hi:[1,0,0]
v_rcp_f32 v4,v4
v_rcp_f32 v5,v5
v_rcp_f32 v6,v6
v_rcp_f32 v7,v7
v_rcp_f32 v12,v12
v_rcp_f32 v13,v13
v_rcp_f32 v28,v28
v_rcp_f32 v29,v29
v_pk_mul_f32 v[184:185],v[184:185],v[4:5]
v_pk_mul_f32 v[186:187],v[186:187],v[6:7]
v_pk_mul_f32 v[200:201],v[200:201],v[12:13]
v_pk_mul_f32 v[202:203],v[202:203],v[28:29]
v_cvt_pk_bf16_f32 v72,v184,v185
v_cvt_pk_bf16_f32 v73,v186,v187
v_cvt_pk_bf16_f32 v74,v200,v201
v_cvt_pk_bf16_f32 v75,v202,v203
s_nop 0
v_permlane16_swap_b32 v72,v74
v_permlane16_swap_b32 v73,v75
buffer_store_dwordx4 v[72:75],v15,s[56:59],s62 offen offset:1024 sc1
v_pk_mul_f32 v[4:5],v[104:105],v[104:105]
v_pk_mul_f32 v[6:7],v[106:107],v[106:107]
v_pk_mul_f32 v[12:13],v[120:121],v[120:121]
v_pk_mul_f32 v[28:29],v[122:123],v[122:123]
v_pk_fma_f32 v[4:5],v[4:5],v[22:23],v[18:19] op_sel:[0,0,0] op_sel_hi:[1,0,0]
v_pk_fma_f32 v[6:7],v[6:7],v[22:23],v[18:19] op_sel:[0,0,0] op_sel_hi:[1,0,0]
v_pk_fma_f32 v[12:13],v[12:13],v[22:23],v[18:19] op_sel:[0,0,0] op_sel_hi:[1,0,0]
v_pk_fma_f32 v[28:29],v[28:29],v[22:23],v[18:19] op_sel:[0,0,0] op_sel_hi:[1,0,0]
v_pk_mul_f32 v[4:5],v[4:5],v[104:105]
v_pk_mul_f32 v[6:7],v[6:7],v[106:107]
v_pk_mul_f32 v[12:13],v[12:13],v[120:121]
v_pk_mul_f32 v[28:29],v[28:29],v[122:123]
v_exp_f32 v4,v4
v_exp_f32 v5,v5
v_exp_f32 v6,v6
v_exp_f32 v7,v7
v_exp_f32 v12,v12
v_exp_f32 v13,v13
v_exp_f32 v28,v28
v_exp_f32 v29,v29
v_pk_mul_f32 v[216:217],v[216:217],v[104:105]
v_pk_mul_f32 v[218:219],v[218:219],v[106:107]
v_pk_mul_f32 v[232:233],v[232:233],v[120:121]
v_pk_mul_f32 v[234:235],v[234:235],v[122:123]
v_pk_fma_f32 v[4:5],v[4:5],v[26:27],v[26:27] op_sel:[0,0,0] op_sel_hi:[1,0,0]
v_pk_fma_f32 v[6:7],v[6:7],v[26:27],v[26:27] op_sel:[0,0,0] op_sel_hi:[1,0,0]
v_pk_fma_f32 v[12:13],v[12:13],v[26:27],v[26:27] op_sel:[0,0,0] op_sel_hi:[1,0,0]
v_pk_fma_f32 v[28:29],v[28:29],v[26:27],v[26:27] op_sel:[0,0,0] op_sel_hi:[1,0,0]
v_rcp_f32 v4,v4
v_rcp_f32 v5,v5
v_rcp_f32 v6,v6
v_rcp_f32 v7,v7
v_rcp_f32 v12,v12
v_rcp_f32 v13,v13
v_rcp_f32 v28,v28
v_rcp_f32 v29,v29
v_pk_mul_f32 v[216:217],v[216:217],v[4:5]
v_pk_mul_f32 v[218:219],v[218:219],v[6:7]
v_pk_mul_f32 v[232:233],v[232:233],v[12:13]
v_pk_mul_f32 v[234:235],v[234:235],v[28:29]
v_cvt_pk_bf16_f32 v104,v216,v217
v_cvt_pk_bf16_f32 v105,v218,v219
v_cvt_pk_bf16_f32 v106,v232,v233
v_cvt_pk_bf16_f32 v107,v234,v235
s_nop 0
v_permlane16_swap_b32 v104,v106
v_permlane16_swap_b32 v105,v107
buffer_store_dwordx4 v[104:107],v15,s[56:59],s62 offen offset:2048 sc1
v_pk_mul_f32 v[4:5],v[44:45],v[44:45]
v_pk_mul_f32 v[6:7],v[46:47],v[46:47]
v_pk_mul_f32 v[12:13],v[60:61],v[60:61]
v_pk_mul_f32 v[28:29],v[62:63],v[62:63]
v_pk_fma_f32 v[4:5],v[4:5],v[22:23],v[18:19] op_sel:[0,1,1] op_sel_hi:[1,1,1]
v_pk_fma_f32 v[6:7],v[6:7],v[22:23],v[18:19] op_sel:[0,1,1] op_sel_hi:[1,1,1]
v_pk_fma_f32 v[12:13],v[12:13],v[22:23],v[18:19] op_sel:[0,1,1] op_sel_hi:[1,1,1]
v_pk_fma_f32 v[28:29],v[28:29],v[22:23],v[18:19] op_sel:[0,1,1] op_sel_hi:[1,1,1]
v_pk_mul_f32 v[4:5],v[4:5],v[44:45]
v_pk_mul_f32 v[6:7],v[6:7],v[46:47]
v_pk_mul_f32 v[12:13],v[12:13],v[60:61]
v_pk_mul_f32 v[28:29],v[28:29],v[62:63]
v_exp_f32 v4,v4
v_exp_f32 v5,v5
v_exp_f32 v6,v6
v_exp_f32 v7,v7
v_exp_f32 v12,v12
v_exp_f32 v13,v13
v_exp_f32 v28,v28
v_exp_f32 v29,v29
v_pk_mul_f32 v[156:157],v[156:157],v[44:45]
v_pk_mul_f32 v[158:159],v[158:159],v[46:47]
v_pk_mul_f32 v[172:173],v[172:173],v[60:61]
v_pk_mul_f32 v[174:175],v[174:175],v[62:63]
v_pk_fma_f32 v[4:5],v[4:5],v[26:27],v[26:27] op_sel:[0,1,1] op_sel_hi:[1,1,1]
v_pk_fma_f32 v[6:7],v[6:7],v[26:27],v[26:27] op_sel:[0,1,1] op_sel_hi:[1,1,1]
v_pk_fma_f32 v[12:13],v[12:13],v[26:27],v[26:27] op_sel:[0,1,1] op_sel_hi:[1,1,1]
v_pk_fma_f32 v[28:29],v[28:29],v[26:27],v[26:27] op_sel:[0,1,1] op_sel_hi:[1,1,1]
v_rcp_f32 v4,v4
v_rcp_f32 v5,v5
v_rcp_f32 v6,v6
v_rcp_f32 v7,v7
v_rcp_f32 v12,v12
v_rcp_f32 v13,v13
v_rcp_f32 v28,v28
v_rcp_f32 v29,v29
v_pk_mul_f32 v[156:157],v[156:157],v[4:5]
v_pk_mul_f32 v[158:159],v[158:159],v[6:7]
v_pk_mul_f32 v[172:173],v[172:173],v[12:13]
v_pk_mul_f32 v[174:175],v[174:175],v[28:29]
v_cvt_pk_bf16_f32 v44,v156,v157
v_cvt_pk_bf16_f32 v45,v158,v159
v_cvt_pk_bf16_f32 v46,v172,v173
v_cvt_pk_bf16_f32 v47,v174,v175
s_nop 0
v_permlane16_swap_b32 v44,v46
v_permlane16_swap_b32 v45,v47
buffer_store_dwordx4 v[44:47],v15,s[56:59],s63 offen sc1
v_pk_mul_f32 v[4:5],v[76:77],v[76:77]
v_pk_mul_f32 v[6:7],v[78:79],v[78:79]
v_pk_mul_f32 v[12:13],v[92:93],v[92:93]
v_pk_mul_f32 v[28:29],v[94:95],v[94:95]
v_pk_fma_f32 v[4:5],v[4:5],v[22:23],v[18:19] op_sel:[0,1,1] op_sel_hi:[1,1,1]
v_pk_fma_f32 v[6:7],v[6:7],v[22:23],v[18:19] op_sel:[0,1,1] op_sel_hi:[1,1,1]
v_pk_fma_f32 v[12:13],v[12:13],v[22:23],v[18:19] op_sel:[0,1,1] op_sel_hi:[1,1,1]
v_pk_fma_f32 v[28:29],v[28:29],v[22:23],v[18:19] op_sel:[0,1,1] op_sel_hi:[1,1,1]
v_pk_mul_f32 v[4:5],v[4:5],v[76:77]
v_pk_mul_f32 v[6:7],v[6:7],v[78:79]
v_pk_mul_f32 v[12:13],v[12:13],v[92:93]
v_pk_mul_f32 v[28:29],v[28:29],v[94:95]
v_exp_f32 v4,v4
v_exp_f32 v5,v5
v_exp_f32 v6,v6
v_exp_f32 v7,v7
v_exp_f32 v12,v12
v_exp_f32 v13,v13
v_exp_f32 v28,v28
v_exp_f32 v29,v29
v_pk_mul_f32 v[188:189],v[188:189],v[76:77]
v_pk_mul_f32 v[190:191],v[190:191],v[78:79]
v_pk_mul_f32 v[204:205],v[204:205],v[92:93]
v_pk_mul_f32 v[206:207],v[206:207],v[94:95]
v_pk_fma_f32 v[4:5],v[4:5],v[26:27],v[26:27] op_sel:[0,1,1] op_sel_hi:[1,1,1]
v_pk_fma_f32 v[6:7],v[6:7],v[26:27],v[26:27] op_sel:[0,1,1] op_sel_hi:[1,1,1]
v_pk_fma_f32 v[12:13],v[12:13],v[26:27],v[26:27] op_sel:[0,1,1] op_sel_hi:[1,1,1]
v_pk_fma_f32 v[28:29],v[28:29],v[26:27],v[26:27] op_sel:[0,1,1] op_sel_hi:[1,1,1]
v_rcp_f32 v4,v4
v_rcp_f32 v5,v5
v_rcp_f32 v6,v6
v_rcp_f32 v7,v7
v_rcp_f32 v12,v12
v_rcp_f32 v13,v13
v_rcp_f32 v28,v28
v_rcp_f32 v29,v29
v_pk_mul_f32 v[188:189],v[188:189],v[4:5]
v_pk_mul_f32 v[190:191],v[190:191],v[6:7]
v_pk_mul_f32 v[204:205],v[204:205],v[12:13]
v_pk_mul_f32 v[206:207],v[206:207],v[28:29]
v_cvt_pk_bf16_f32 v76,v188,v189
v_cvt_pk_bf16_f32 v77,v190,v191
v_cvt_pk_bf16_f32 v78,v204,v205
v_cvt_pk_bf16_f32 v79,v206,v207
s_nop 0
v_permlane16_swap_b32 v76,v78
v_permlane16_swap_b32 v77,v79
buffer_store_dwordx4 v[76:79],v15,s[56:59],s63 offen offset:1024 sc1
v_pk_mul_f32 v[4:5],v[108:109],v[108:109]
v_pk_mul_f32 v[6:7],v[110:111],v[110:111]
v_pk_mul_f32 v[12:13],v[124:125],v[124:125]
v_pk_mul_f32 v[28:29],v[126:127],v[126:127]
v_pk_fma_f32 v[4:5],v[4:5],v[22:23],v[18:19] op_sel:[0,1,1] op_sel_hi:[1,1,1]
v_pk_fma_f32 v[6:7],v[6:7],v[22:23],v[18:19] op_sel:[0,1,1] op_sel_hi:[1,1,1]
v_pk_fma_f32 v[12:13],v[12:13],v[22:23],v[18:19] op_sel:[0,1,1] op_sel_hi:[1,1,1]
v_pk_fma_f32 v[28:29],v[28:29],v[22:23],v[18:19] op_sel:[0,1,1] op_sel_hi:[1,1,1]
v_pk_mul_f32 v[4:5],v[4:5],v[108:109]
v_pk_mul_f32 v[6:7],v[6:7],v[110:111]
v_pk_mul_f32 v[12:13],v[12:13],v[124:125]
v_pk_mul_f32 v[28:29],v[28:29],v[126:127]
v_exp_f32 v4,v4
v_exp_f32 v5,v5
v_exp_f32 v6,v6
v_exp_f32 v7,v7
v_exp_f32 v12,v12
v_exp_f32 v13,v13
v_exp_f32 v28,v28
v_exp_f32 v29,v29
v_pk_mul_f32 v[220:221],v[220:221],v[108:109]
v_pk_mul_f32 v[222:223],v[222:223],v[110:111]
v_pk_mul_f32 v[236:237],v[236:237],v[124:125]
v_pk_mul_f32 v[238:239],v[238:239],v[126:127]
v_pk_fma_f32 v[4:5],v[4:5],v[26:27],v[26:27] op_sel:[0,1,1] op_sel_hi:[1,1,1]
v_pk_fma_f32 v[6:7],v[6:7],v[26:27],v[26:27] op_sel:[0,1,1] op_sel_hi:[1,1,1]
v_pk_fma_f32 v[12:13],v[12:13],v[26:27],v[26:27] op_sel:[0,1,1] op_sel_hi:[1,1,1]
v_pk_fma_f32 v[28:29],v[28:29],v[26:27],v[26:27] op_sel:[0,1,1] op_sel_hi:[1,1,1]
v_rcp_f32 v4,v4
v_rcp_f32 v5,v5
v_rcp_f32 v6,v6
v_rcp_f32 v7,v7
v_rcp_f32 v12,v12
v_rcp_f32 v13,v13
v_rcp_f32 v28,v28
v_rcp_f32 v29,v29
v_pk_mul_f32 v[220:221],v[220:221],v[4:5]
v_pk_mul_f32 v[222:223],v[222:223],v[6:7]
v_pk_mul_f32 v[236:237],v[236:237],v[12:13]
v_pk_mul_f32 v[238:239],v[238:239],v[28:29]
v_cvt_pk_bf16_f32 v108,v220,v221
v_cvt_pk_bf16_f32 v109,v222,v223
v_cvt_pk_bf16_f32 v110,v236,v237
v_cvt_pk_bf16_f32 v111,v238,v239
s_nop 0
v_permlane16_swap_b32 v108,v110
v_permlane16_swap_b32 v109,v111
buffer_store_dwordx4 v[108:111],v15,s[56:59],s63 offen offset:2048 sc1
v_pk_mul_f32 v[4:5],v[136:137],v[136:137]
v_pk_mul_f32 v[6:7],v[138:139],v[138:139]
v_pk_mul_f32 v[12:13],v[140:141],v[140:141]
v_pk_mul_f32 v[28:29],v[142:143],v[142:143]
v_pk_fma_f32 v[4:5],v[4:5],v[22:23],v[18:19] op_sel:[0,0,0] op_sel_hi:[1,0,0]
v_pk_fma_f32 v[6:7],v[6:7],v[22:23],v[18:19] op_sel:[0,0,0] op_sel_hi:[1,0,0]
v_pk_fma_f32 v[12:13],v[12:13],v[22:23],v[18:19] op_sel:[0,1,1] op_sel_hi:[1,1,1]
v_pk_fma_f32 v[28:29],v[28:29],v[22:23],v[18:19] op_sel:[0,1,1] op_sel_hi:[1,1,1]
v_pk_mul_f32 v[4:5],v[4:5],v[136:137]
v_pk_mul_f32 v[6:7],v[6:7],v[138:139]
v_pk_mul_f32 v[12:13],v[12:13],v[140:141]
v_pk_mul_f32 v[28:29],v[28:29],v[142:143]
v_exp_f32 v4,v4
v_exp_f32 v5,v5
v_exp_f32 v6,v6
v_exp_f32 v7,v7
v_exp_f32 v12,v12
v_exp_f32 v13,v13
v_exp_f32 v28,v28
v_exp_f32 v29,v29
v_pk_mul_f32 v[248:249],v[248:249],v[136:137]
v_pk_mul_f32 v[250:251],v[250:251],v[138:139]
v_pk_mul_f32 v[252:253],v[252:253],v[140:141]
v_pk_mul_f32 v[254:255],v[254:255],v[142:143]
v_pk_fma_f32 v[4:5],v[4:5],v[26:27],v[26:27] op_sel:[0,0,0] op_sel_hi:[1,0,0]
v_pk_fma_f32 v[6:7],v[6:7],v[26:27],v[26:27] op_sel:[0,0,0] op_sel_hi:[1,0,0]
v_pk_fma_f32 v[12:13],v[12:13],v[26:27],v[26:27] op_sel:[0,1,1] op_sel_hi:[1,1,1]
v_pk_fma_f32 v[28:29],v[28:29],v[26:27],v[26:27] op_sel:[0,1,1] op_sel_hi:[1,1,1]
v_rcp_f32 v4,v4
v_rcp_f32 v5,v5
v_rcp_f32 v6,v6
v_rcp_f32 v7,v7
v_rcp_f32 v12,v12
v_rcp_f32 v13,v13
v_rcp_f32 v28,v28
v_rcp_f32 v29,v29
v_pk_mul_f32 v[248:249],v[248:249],v[4:5]
v_pk_mul_f32 v[250:251],v[250:251],v[6:7]
v_pk_mul_f32 v[252:253],v[252:253],v[12:13]
v_pk_mul_f32 v[254:255],v[254:255],v[28:29]
v_cvt_pk_bf16_f32 v136,v248,v249
v_cvt_pk_bf16_f32 v137,v250,v251
v_cvt_pk_bf16_f32 v138,v252,v253
v_cvt_pk_bf16_f32 v139,v254,v255
s_nop 0
v_permlane16_swap_b32 v136,v138
v_permlane16_swap_b32 v137,v139
buffer_store_dwordx4 v[136:139],v14,s[56:59],s62 offen offset:3072 sc1
s_setpc_b64 s[98:99]
Lend:
s_endpgm
.section .rodata,"a"
.p2align 6
.amdhsa_kernel interleave_layers__linear_kernel_hedgehog__geglu_ffn__prompt_kernel
  .amdhsa_next_free_vgpr 512
  .amdhsa_next_free_sgpr 100
  .amdhsa_accum_offset 256
  .amdhsa_group_segment_fixed_size 0
  .amdhsa_kernarg_size 88
  .amdhsa_user_sgpr_count 2
  .amdhsa_user_sgpr_kernarg_segment_ptr 1
  .amdhsa_system_sgpr_workgroup_id_x 1
  .amdhsa_float_denorm_mode_32 3
.end_amdhsa_kernel
```
